```python
import torch

def _softmax(x, axis=-1):
    return torch.softmax(x, dim=axis)
def _gelu(x):
    return torch.nn.functional.gelu(x, approximate="tanh")
def _silu(x):
    return torch.nn.functional.silu(x)
def _sigmoid(x):
    return torch.sigmoid(x)
def _layernorm(x, axis=-1, eps=1e-5):
    m = x.mean(dim=axis, keepdim=True)
    v = x.var(dim=axis, keepdim=True, unbiased=False)
    return (x - m) / torch.sqrt(v + eps)
def _scatter_add(tgt, idx, src, axis=0):
    return tgt.clone().index_add_(axis, idx, src)
def _segment_sum(src, seg, n):
    out = torch.zeros((n,) + src.shape[1:], dtype=src.dtype)
    return out.index_add_(0, seg, src)
def _pad(x, pw):
    flat = tuple(v for pair in reversed(pw) for v in pair)
    return torch.nn.functional.pad(x, flat)

kernel_name = 'standalone__attention_interact_autoint__recsys'

def setup_inputs():

    _w = (lambda a: (lambda t: t.to(torch.bfloat16) if t.is_floating_point() else t)(torch.as_tensor(a)))
    B, F = 4096, 100
    D = max(2, (128 // 2) * 2)
    H = 2
    Dh = D // H
    return {
        "e": _w((lambda *s: torch.randn(*s, dtype=torch.bfloat16) * 0.05)(B, F, D).to(float)),
        "wq": _w((lambda *s: torch.randn(*s, dtype=torch.bfloat16) * 1.6)(H, D, Dh).to(float)),
        "wk": _w((lambda *s: torch.randn(*s, dtype=torch.bfloat16) * 1.6)(H, D, Dh).to(float)),
        "wv": _w((lambda *s: torch.randn(*s, dtype=torch.bfloat16) * 0.05)(H, D, Dh).to(float)),
        "wres": _w((lambda *s: torch.randn(*s, dtype=torch.bfloat16) * 0.05)(D, D).to(float)),
    }

def reference(e, wq, wk, wv, wres):
    H, D, Dh = wq.shape[0], wq.shape[1], wq.shape[2]
    B, F = e.shape[0], e.shape[1]
    q = torch.einsum('bfd,hdk->bhfk', e, wq)
    k = torch.einsum('bfd,hdk->bhfk', e, wk)
    v = torch.einsum('bfd,hdk->bhfk', e, wv)
    scale = float(Dh) ** -0.5
    scores = torch.einsum('bhfk,bhgk->bhfg', q, k) * scale
    attn = _softmax(scores, axis=-1)
    attn = (lambda x, dt: x.to(dt))(attn, v.dtype)
    ctx = torch.einsum('bhfg,bhgk->bhfk', attn, v)
    ctx = (lambda x, *d: x.permute(*d))(ctx, 0, 2, 1, 3).reshape(B, F, H * Dh)
    res = torch.einsum('bfd,de->bfe', e, wres)
    out = ctx + res
    mask = (lambda x, dt: x.to(dt))(out > 0, out.dtype)
    return out * mask
```

```asm
; @launch grid=(256,1,1) block=(256,1,1) lds=163840
.amdgcn_target "amdgcn-amd-amdhsa--gfx950"
.text
.globl standalone__attention_interact_autoint__recsys_kernel
.p2align 8
.type standalone__attention_interact_autoint__recsys_kernel,@function
standalone__attention_interact_autoint__recsys_kernel:
s_cmp_ge_u32 s2, 256
s_cbranch_scc1 L_end
s_load_dwordx8 s[4:11], s[0:1], 0
s_load_dwordx4 s[12:15], s[0:1], 32
s_getpc_b64 s[58:59]
L_pc:
v_lshlrev_b32 v2, 7, v0
v_min_u32 v2, L_fast_end-L_pc-4, v2
global_load_dword v104, v2, s[58:59]
v_lshrrev_b32 v1, 6, v0
s_mov_b32 s40, 0x3e38aa3b
v_readfirstlane_b32 s41, v1
s_mov_b32 s18, 104857600
s_mov_b32 s19, 0x20000
s_mov_b32 s22, 104857600
s_mov_b32 s23, 0x20000
s_mov_b32 s26, 32768
s_mov_b32 s27, 0x20000
s_mov_b32 s30, 32768
s_mov_b32 s31, 0x20000
s_mov_b32 s34, 32768
s_mov_b32 s35, 0x20000
s_mov_b32 s38, 32768
s_mov_b32 s39, 0x20000
s_lshr_b32 s42, s41, 1
s_and_b32 s43, s41, 1
s_lshl_b32 s44, s2, 1
s_add_u32 s44, s44, s42
s_mul_i32 s44, s44, 25600
s_mov_b32 s45, 8
s_mov_b32 s3, 64
s_mov_b32 s46, s44
s_mov_b32 s47, 0x7ff00000
s_mov_b32 s56, 50688
s_mov_b32 s96, 0x3b8265d9
s_mov_b32 s97, 0
v_mbcnt_lo_u32_b32 v176, -1, 0
v_mbcnt_hi_u32_b32 v176, -1, v176
v_lshlrev_b32 v191, 4, v176
s_lshl_b32 s54, s41, 13
s_add_u32 s57, s54, 4096
v_and_b32 v177, 16, v176
v_lshlrev_b32 v236, 2, v177
v_lshlrev_b32 v177, 1, v177
v_xor_b32 v178, v191, v177
s_mul_i32 s49, s42, 25344
s_mul_i32 s53, s43, 1056
s_add_u32 s49, s49, s53
s_add_u32 m0, s49, 21120
s_lshl_b32 s55, s43, 10
s_add_u32 s55, s55, s44
s_add_u32 s48, s55, 20480
v_mov_b32 v241, 0
v_bfe_u32 v177, v176, 0, 2
v_lshl_add_u32 v241, v177, 4, v241
v_bfe_u32 v177, v176, 4, 2
v_lshl_add_u32 v241, v177, 6, v241
v_bfe_u32 v177, v176, 2, 2
v_lshl_add_u32 v241, v177, 8, v241
v_xor_b32 v179, 64, v178
s_lshl_b32 s53, s43, 14
v_mov_b32 v184, s53
v_add_u32 v184, 84992, v184
v_bfe_u32 v177, v176, 4, 2
v_lshl_add_u32 v184, v177, 10, v184
v_bfe_u32 v177, v176, 2, 2
v_lshl_add_u32 v184, v177, 7, v184
v_bfe_u32 v177, v176, 3, 1
v_lshl_add_u32 v184, v177, 5, v184
v_bfe_u32 v177, v176, 4, 1
v_lshl_add_u32 v184, v177, 6, v184
v_bfe_u32 v177, v176, 0, 2
v_lshl_add_u32 v184, v177, 3, v184
v_mov_b32 v188, s53
v_add_u32 v188, 50688, v188
v_bfe_u32 v177, v176, 4, 2
v_lshl_add_u32 v188, v177, 10, v188
v_bfe_u32 v177, v176, 2, 2
v_lshl_add_u32 v188, v177, 7, v188
v_bfe_u32 v177, v176, 3, 1
v_lshl_add_u32 v188, v177, 6, v188
v_bfe_u32 v177, v176, 0, 2
v_lshl_add_u32 v188, v177, 4, v188
s_mul_i32 s53, s42, 25344
s_waitcnt lgkmcnt(0)
s_mov_b32 s16, s4
s_mov_b32 s17, s5
s_mov_b32 s24, s6
s_mov_b32 s25, s7
s_mov_b32 s28, s8
s_mov_b32 s29, s9
s_mov_b32 s32, s10
s_mov_b32 s33, s11
s_mov_b32 s36, s12
s_mov_b32 s37, s13
s_mov_b32 s20, s14
s_mov_b32 s21, s15
v_bfe_u32 v177, v176, 2, 2
v_mov_b32 v240, s53
v_mul_u32_u24 v177, 1056, v177
v_add_u32 v240, v177, v240
v_bfe_u32 v177, v176, 0, 2
s_add_u32 s53, s54, 84992
v_lshl_add_u32 v240, v177, 6, v240
v_add_u32 v180, s53, v178
v_add_u32 v181, s53, v179
v_bfe_u32 v177, v176, 4, 2
s_lshl_b32 s53, s41, 12
v_lshl_add_u32 v240, v177, 4, v240
v_mov_b32 v190, s53
v_add_u32 v190, 50688, v190
v_bfe_u32 v177, v176, 3, 1
v_lshl_add_u32 v190, v177, 14, v190
v_bfe_u32 v177, v176, 4, 2
v_lshl_add_u32 v190, v177, 7, v190
v_bfe_u32 v177, v176, 2, 1
v_lshl_add_u32 v190, v177, 6, v190
v_bfe_u32 v177, v176, 5, 1
v_lshl_add_u32 v190, v177, 5, v190
v_bfe_u32 v177, v176, 0, 2
buffer_load_dwordx4 v[112:115], v191, s[24:27], s54 offen offset:0
v_lshl_add_u32 v190, v177, 3, v190
s_lshl_b32 s53, s43, 7
v_mov_b32 v242, s53
buffer_load_dwordx4 v[116:119], v191, s[24:27], s54 offen offset:1024
v_bfe_u32 v177, v176, 0, 4
v_lshl_add_u32 v242, v177, 8, v242
s_mul_i32 s52, s41, 12800
s_add_u32 s52, s52, 101376
buffer_load_dwordx4 v[120:123], v191, s[24:27], s54 offen offset:2048
v_bfe_u32 v177, v176, 4, 2
v_lshl_add_u32 v242, v177, 4, v242
v_mov_b32 v244, s52
v_add_u32 v244, 1088, v244
buffer_load_dwordx4 v[124:127], v191, s[24:27], s54 offen offset:3072
v_bfe_u32 v177, v176, 3, 2
v_lshl_add_u32 v244, v177, 7, v244
v_bfe_u32 v177, v176, 2, 1
buffer_load_dwordx4 v[128:131], v191, s[24:27], s57 offen offset:0
v_lshl_add_u32 v244, v177, 6, v244
v_bfe_u32 v177, v176, 0, 2
v_lshl_add_u32 v244, v177, 3, v244
buffer_load_dwordx4 v[132:135], v191, s[24:27], s57 offen offset:1024
v_bfe_u32 v177, v176, 5, 1
v_lshl_add_u32 v244, v177, 2, v244
v_mov_b32 v243, s52
buffer_load_dwordx4 v[136:139], v191, s[24:27], s57 offen offset:2048
v_bfe_u32 v177, v176, 3, 1
v_lshl_add_u32 v243, v177, 8, v243
v_bfe_u32 v177, v176, 1, 1
v_lshl_add_u32 v243, v177, 7, v243
buffer_load_dwordx4 v[140:143], v191, s[24:27], s57 offen offset:3072
v_bfe_u32 v177, v176, 0, 1
v_lshl_add_u32 v243, v177, 6, v243
v_bfe_u32 v177, v176, 4, 2
buffer_load_dwordx4 v241, s[16:19], s48 offen nt lds
s_add_u32 m0, s49, 23232
s_add_u32 s48, s55, 22528
v_lshl_add_u32 v243, v177, 4, v243
buffer_load_dwordx4 v241, s[16:19], s48 offen nt lds
s_add_u32 m0, s49, 0
s_add_u32 s48, s55, 0
v_bfe_u32 v177, v176, 3, 1
buffer_load_dwordx4 v241, s[16:19], s48 offen nt lds
s_add_u32 m0, s49, 2112
s_add_u32 s48, s55, 2048
v_lshlrev_b32 v177, 5, v177
v_xor_b32 v243, v177, v243
buffer_load_dwordx4 v241, s[16:19], s48 offen nt lds
s_add_u32 m0, s54, 117760
v_bfe_u32 v177, v176, 1, 1
v_lshlrev_b32 v177, 4, v177
buffer_load_dwordx4 v178, s[28:31], s54 offen offset:0 lds
v_xor_b32 v243, v177, v243
v_mov_b32 v245, s52
v_add_u32 v245, 512, v245
buffer_load_dwordx4 v179, s[28:31], s54 offen offset:1024 lds
v_bfe_u32 v177, v176, 2, 2
v_lshl_add_u32 v245, v177, 7, v245
v_bfe_u32 v177, v176, 0, 1
buffer_load_dwordx4 v178, s[28:31], s54 offen offset:2048 lds
v_lshl_add_u32 v245, v177, 6, v245
v_bfe_u32 v177, v176, 4, 2
v_lshl_add_u32 v245, v177, 4, v245
v_bfe_u32 v177, v176, 2, 2
buffer_load_dwordx4 v179, s[28:31], s54 offen offset:3072 lds
s_add_u32 m0, s57, 117760
v_lshlrev_b32 v177, 4, v177
v_xor_b32 v245, v177, v245
buffer_load_dwordx4 v178, s[28:31], s57 offen offset:0 lds
v_mov_b32 v249, s52
v_bfe_u32 v177, v176, 4, 2
v_add_u32 v249, 256, v249
buffer_load_dwordx4 v179, s[28:31], s57 offen offset:1024 lds
v_mul_u32_u24 v177, 272, v177
v_add_u32 v249, v177, v249
v_bfe_u32 v177, v176, 0, 2
buffer_load_dwordx4 v178, s[28:31], s57 offen offset:2048 lds
v_lshl_add_u32 v249, v177, 2, v249
v_bfe_u32 v177, v176, 4, 2
v_mov_b32 v248, s52
v_mul_u32_u24 v177, 272, v177
buffer_load_dwordx4 v179, s[28:31], s57 offen offset:3072 lds
s_add_u32 m0, s49, 12672
v_add_u32 v248, v177, v248
v_bfe_u32 v177, v176, 0, 4
v_lshl_add_u32 v248, v177, 2, v248
v_mov_b32 v96, s52
v_bfe_u32 v177, v176, 0, 3
v_add_u32 v96, 1072, v96
v_mul_u32_u24 v177, 1600, v177
v_add_u32 v96, v177, v96
v_bfe_u32 v177, v176, 2, 2
v_mov_b32 v238, s52
v_mul_u32_u24 v177, 1600, v177
v_add_u32 v238, v177, v238
v_bfe_u32 v177, v176, 0, 2
v_lshl_add_u32 v238, v177, 7, v238
v_bfe_u32 v177, v176, 5, 1
v_lshl_add_u32 v238, v177, 4, v238
v_bfe_u32 v177, v176, 4, 1
v_lshl_add_u32 v238, v177, 3, v238
v_bfe_u32 v177, v176, 0, 2
v_lshlrev_b32 v177, 4, v177
v_xor_b32 v238, v177, v238
v_mov_b32 v237, s52
v_bfe_u32 v177, v176, 4, 2
v_add_u32 v237, 1088, v237
v_mul_u32_u24 v177, 1600, v177
v_add_u32 v237, v177, v237
v_bfe_u32 v177, v176, 0, 4
s_mul_i32 s53, s41, 1088
s_add_u32 s53, s53, 152576
v_lshl_add_u32 v237, v177, 3, v237
v_mov_b32 v246, s53
v_bfe_u32 v177, v176, 4, 2
v_lshl_add_u32 v246, v177, 6, v246
v_bfe_u32 v177, v176, 1, 1
v_lshl_add_u32 v246, v177, 5, v246
v_bfe_u32 v177, v176, 2, 2
v_lshl_add_u32 v246, v177, 3, v246
v_bfe_u32 v177, v176, 0, 1
v_lshl_add_u32 v246, v177, 1, v246
v_mov_b32 v247, s53
v_bfe_u32 v177, v176, 2, 2
v_mov_b32 v182, s52
s_mov_b32 vcc_lo, 0x33333333
s_mov_b32 vcc_hi, 0x33333333
v_lshl_add_u32 v247, v177, 6, v247
v_add_u32 v182, 1072, v182
v_bfe_u32 v177, v176, 0, 1
v_cndmask_b32 v245, v182, v245, vcc
v_lshl_add_u32 v247, v177, 5, v247
v_bfe_u32 v177, v176, 4, 1
v_mov_b32 v182, s53
s_mov_b32 vcc_lo, 0x33333333
s_mov_b32 vcc_hi, 0xcccccccc
v_lshl_add_u32 v247, v177, 4, v247
v_add_u32 v182, 256, v182
v_cndmask_b32 v247, v182, v247, vcc
v_mov_b32 v182, s53
v_bfe_u32 v177, v176, 0, 2
v_add_u32 v182, 256, v182
v_mul_u32_u24 v177, 272, v177
v_mov_b32 v100, 0
v_mov_b32 v101, 0
v_mov_b32 v102, 0
v_mov_b32 v103, 0
v_add_u32 v182, v177, v182
s_waitcnt vmcnt(19)
v_and_b32 v183, 0xffff0000, v113
v_lshlrev_b32 v113, 16, v113
v_mul_f32 v183, s40, v183
v_mul_f32 v113, s40, v113
v_cvt_pk_bf16_f32 v113, v113, v183
v_and_b32 v183, 0xffff0000, v115
v_lshlrev_b32 v115, 16, v115
v_mul_f32 v183, s40, v183
v_mul_f32 v115, s40, v115
v_cvt_pk_bf16_f32 v115, v115, v183
s_waitcnt vmcnt(18)
v_and_b32 v183, 0xffff0000, v117
v_lshlrev_b32 v117, 16, v117
v_mul_f32 v183, s40, v183
v_mul_f32 v117, s40, v117
v_cvt_pk_bf16_f32 v117, v117, v183
v_and_b32 v183, 0xffff0000, v119
v_lshlrev_b32 v119, 16, v119
v_mul_f32 v183, s40, v183
v_mul_f32 v119, s40, v119
v_cvt_pk_bf16_f32 v119, v119, v183
s_waitcnt vmcnt(17)
v_and_b32 v183, 0xffff0000, v121
v_lshlrev_b32 v121, 16, v121
v_mul_f32 v183, s40, v183
v_mul_f32 v121, s40, v121
v_cvt_pk_bf16_f32 v121, v121, v183
v_and_b32 v183, 0xffff0000, v123
v_lshlrev_b32 v123, 16, v123
v_mul_f32 v183, s40, v183
v_mul_f32 v123, s40, v123
v_cvt_pk_bf16_f32 v123, v123, v183
s_waitcnt vmcnt(16)
v_and_b32 v183, 0xffff0000, v125
v_lshlrev_b32 v125, 16, v125
v_mul_f32 v183, s40, v183
v_mul_f32 v125, s40, v125
v_cvt_pk_bf16_f32 v125, v125, v183
v_and_b32 v183, 0xffff0000, v127
v_lshlrev_b32 v127, 16, v127
v_mul_f32 v183, s40, v183
v_mul_f32 v127, s40, v127
v_cvt_pk_bf16_f32 v127, v127, v183
s_waitcnt vmcnt(15)
v_and_b32 v183, 0xffff0000, v129
v_lshlrev_b32 v129, 16, v129
v_mul_f32 v183, s40, v183
v_mul_f32 v129, s40, v129
v_cvt_pk_bf16_f32 v129, v129, v183
v_and_b32 v183, 0xffff0000, v131
v_lshlrev_b32 v131, 16, v131
v_mul_f32 v183, s40, v183
v_mul_f32 v131, s40, v131
v_cvt_pk_bf16_f32 v131, v131, v183
s_waitcnt vmcnt(14)
v_and_b32 v183, 0xffff0000, v133
v_lshlrev_b32 v133, 16, v133
v_mul_f32 v183, s40, v183
v_mul_f32 v133, s40, v133
v_cvt_pk_bf16_f32 v133, v133, v183
v_and_b32 v183, 0xffff0000, v135
v_lshlrev_b32 v135, 16, v135
v_mul_f32 v183, s40, v183
v_mul_f32 v135, s40, v135
v_cvt_pk_bf16_f32 v135, v135, v183
s_waitcnt vmcnt(13)
v_and_b32 v183, 0xffff0000, v137
v_lshlrev_b32 v137, 16, v137
v_mul_f32 v183, s40, v183
v_mul_f32 v137, s40, v137
v_cvt_pk_bf16_f32 v137, v137, v183
v_and_b32 v183, 0xffff0000, v139
v_lshlrev_b32 v139, 16, v139
v_mul_f32 v183, s40, v183
v_mul_f32 v139, s40, v139
v_cvt_pk_bf16_f32 v139, v139, v183
s_waitcnt vmcnt(12)
v_and_b32 v183, 0xffff0000, v141
v_lshlrev_b32 v141, 16, v141
v_mul_f32 v183, s40, v183
v_mul_f32 v141, s40, v141
v_cvt_pk_bf16_f32 v141, v141, v183
v_and_b32 v183, 0xffff0000, v143
v_lshlrev_b32 v143, 16, v143
v_mul_f32 v183, s40, v183
v_mul_f32 v143, s40, v143
v_cvt_pk_bf16_f32 v143, v143, v183
ds_write_b128 v182, v[100:103] offset:0
s_nop 1
v_mov_b32 v182, 64
ds_write_b16 v246, v182 offset:816
s_nop 1
v_and_b32 v182, 0xffff0000, v112
v_lshlrev_b32 v112, 16, v112
v_mul_f32 v182, s40, v182
v_mul_f32 v112, s40, v112
v_cvt_pk_bf16_f32 v112, v112, v182
v_and_b32 v182, 0xffff0000, v114
v_lshlrev_b32 v114, 16, v114
v_mul_f32 v182, s40, v182
v_mul_f32 v114, s40, v114
v_cvt_pk_bf16_f32 v114, v114, v182
v_and_b32 v182, 0xffff0000, v116
v_lshlrev_b32 v116, 16, v116
v_mul_f32 v182, s40, v182
v_mul_f32 v116, s40, v116
v_cvt_pk_bf16_f32 v116, v116, v182
v_and_b32 v182, 0xffff0000, v118
v_lshlrev_b32 v118, 16, v118
v_mul_f32 v182, s40, v182
v_mul_f32 v118, s40, v118
v_cvt_pk_bf16_f32 v118, v118, v182
v_and_b32 v182, 0xffff0000, v120
v_lshlrev_b32 v120, 16, v120
v_mul_f32 v182, s40, v182
v_mul_f32 v120, s40, v120
v_cvt_pk_bf16_f32 v120, v120, v182
v_and_b32 v182, 0xffff0000, v122
v_lshlrev_b32 v122, 16, v122
v_mul_f32 v182, s40, v182
v_mul_f32 v122, s40, v122
v_cvt_pk_bf16_f32 v122, v122, v182
v_and_b32 v182, 0xffff0000, v124
v_lshlrev_b32 v124, 16, v124
v_mul_f32 v182, s40, v182
v_mul_f32 v124, s40, v124
v_cvt_pk_bf16_f32 v124, v124, v182
v_and_b32 v182, 0xffff0000, v126
v_lshlrev_b32 v126, 16, v126
v_mul_f32 v182, s40, v182
v_mul_f32 v126, s40, v126
v_cvt_pk_bf16_f32 v126, v126, v182
v_and_b32 v182, 0xffff0000, v128
v_lshlrev_b32 v128, 16, v128
v_mul_f32 v182, s40, v182
v_mul_f32 v128, s40, v128
v_cvt_pk_bf16_f32 v128, v128, v182
v_and_b32 v182, 0xffff0000, v130
v_lshlrev_b32 v130, 16, v130
v_mul_f32 v182, s40, v182
v_mul_f32 v130, s40, v130
v_cvt_pk_bf16_f32 v130, v130, v182
v_and_b32 v182, 0xffff0000, v132
v_lshlrev_b32 v132, 16, v132
v_mul_f32 v182, s40, v182
v_mul_f32 v132, s40, v132
v_cvt_pk_bf16_f32 v132, v132, v182
v_and_b32 v182, 0xffff0000, v134
v_lshlrev_b32 v134, 16, v134
v_mul_f32 v182, s40, v182
v_mul_f32 v134, s40, v134
v_cvt_pk_bf16_f32 v134, v134, v182
v_and_b32 v182, 0xffff0000, v136
v_lshlrev_b32 v136, 16, v136
v_mul_f32 v182, s40, v182
v_mul_f32 v136, s40, v136
v_cvt_pk_bf16_f32 v136, v136, v182
v_and_b32 v182, 0xffff0000, v138
v_lshlrev_b32 v138, 16, v138
v_mul_f32 v182, s40, v182
v_mul_f32 v138, s40, v138
v_cvt_pk_bf16_f32 v138, v138, v182
v_and_b32 v182, 0xffff0000, v140
v_lshlrev_b32 v140, 16, v140
v_mul_f32 v182, s40, v182
v_mul_f32 v140, s40, v140
v_cvt_pk_bf16_f32 v140, v140, v182
v_and_b32 v182, 0xffff0000, v142
v_lshlrev_b32 v142, 16, v142
v_mul_f32 v182, s40, v182
v_mul_f32 v142, s40, v142
v_cvt_pk_bf16_f32 v142, v142, v182
ds_write_b128 v180, v[112:115] offset:0
ds_write_b128 v181, v[116:119] offset:1024
ds_write_b128 v180, v[120:123] offset:2048
ds_write_b128 v181, v[124:127] offset:3072
ds_write_b128 v180, v[128:131] offset:4096
ds_write_b128 v181, v[132:135] offset:5120
ds_write_b128 v180, v[136:139] offset:6144
ds_write_b128 v181, v[140:143] offset:7168
v_xor_b32 v185, 32, v184
v_xor_b32 v186, 64, v184
v_xor_b32 v187, 96, v184
s_mul_i32 s4, s43, 13107200
s_add_u32 s4, s4, s44
s_add_u32 s4, s4, 24576
s_mul_i32 s5, s43, -52424704
s_add_u32 s5, s5, 104833024
s_add_u32 s48, s4, 0
buffer_load_dwordx4 v241, s[16:19], s48 offen nt lds
s_add_u32 m0, s49, 14784
s_add_u32 s48, s4, 26214400
buffer_load_dwordx4 v241, s[16:19], s48 offen nt lds
s_add_u32 m0, s49, 16896
s_add_u32 s48, s4, 52428800
buffer_load_dwordx4 v241, s[16:19], s48 offen nt lds
s_add_u32 m0, s49, 19008
s_add_u32 s48, s4, 78643200
buffer_load_dwordx4 v241, s[16:19], s48 offen nt lds
s_add_u32 m0, s54, 50688
s_add_u32 s48, s55, 4096
v_xor_b32 v236, v191, v236
buffer_load_dwordx4 v236, s[32:35], s54 offen offset:0 lds
buffer_load_dwordx4 v236, s[32:35], s54 offen offset:1024 lds
buffer_load_dwordx4 v236, s[32:35], s54 offen offset:2048 lds
buffer_load_dwordx4 v236, s[32:35], s54 offen offset:3072 lds
s_add_u32 m0, s57, 50688
s_nop 0
buffer_load_dwordx4 v236, s[32:35], s57 offen offset:0 lds
v_xor_b32 v189, 64, v188
s_lshl_b32 s50, s43, 12
s_add_u32 s50, s50, s44
s_add_u32 s50, s50, 13107200
v_xor_b32 v239, 32, v238
s_xor_b32 s53, s41, 1
s_mul_i32 s53, s53, 1088
v_mov_b32 v255, s53
s_lshl_b32 s53, s41, 9
v_mov_b32 v253, s53
v_add_u32 v253, 156928, v253
v_bfe_u32 v177, v176, 0, 4
v_lshl_add_u32 v253, v177, 4, v253
s_mov_b32 vcc_lo, 0x33333333
s_mov_b32 vcc_hi, 0x33333333
v_mov_b32 v192, 0
v_mov_b32 v177, 0x3f803f80
v_cndmask_b32 v192, v192, v177, vcc
s_mov_b32 vcc_lo, 0xaaaaaaaa
s_mov_b32 vcc_hi, 0xaaaaaaaa
v_mov_b32 v250, 0x44444444
v_mov_b32 v177, 0xeeeeeeee
v_cndmask_b32 v250, v250, v177, vcc
s_mov_b32 vcc_lo, 0x0
s_mov_b32 vcc_hi, 0xaaaaaaaa
v_mov_b32 v177, 0xe4eeeeee
v_cndmask_b32 v250, v250, v177, vcc
buffer_load_dwordx4 v236, s[32:35], s57 offen offset:1024 lds
s_mov_b32 vcc_lo, 0xffff
s_mov_b32 vcc_hi, 0xffff
v_mov_b32 v251, 0x0c0c0c0c
v_mov_b32 v177, 0x07060302
v_cndmask_b32 v251, v251, v177, vcc
s_mov_b32 vcc_lo, 0xffff0000
s_mov_b32 vcc_hi, 0xffff0000
v_mov_b32 v252, 0x0c0c0c0c
v_mov_b32 v177, 0x07060302
v_cndmask_b32 v252, v252, v177, vcc
s_mov_b32 s51, -32
v_mov_b32 v193, v192
v_mov_b32 v194, v192
v_mov_b32 v195, v192
v_mov_b32 v126, 0
v_mov_b32 v127, 0
v_mov_b32 v254, 0
v_add_u32 v255, 153392, v255
v_mov_b32 v142, 0
s_waitcnt vmcnt(10) lgkmcnt(0)
s_barrier
ds_read_b64_tr_b16 a[64:65], v184 offset:32768
ds_read_b64_tr_b16 a[66:67], v184 offset:33280
ds_read_b128 v[196:199], v240 offset:0
ds_read_b64_tr_b16 a[68:69], v184 offset:36864
ds_read_b64_tr_b16 a[70:71], v184 offset:37376
buffer_load_dwordx4 v236, s[32:35], s57 offen offset:2048 lds
ds_read_b128 v[200:203], v240 offset:256
ds_read_b64_tr_b16 a[72:73], v184 offset:40960
ds_read_b64_tr_b16 a[74:75], v184 offset:41472
ds_read_b128 v[208:211], v240 offset:512
ds_read_b64_tr_b16 a[76:77], v184 offset:45056
ds_read_b64_tr_b16 a[78:79], v184 offset:45568
ds_read_b128 v[224:227], v240 offset:768
ds_read_b64_tr_b16 a[92:93], v185 offset:45056
ds_read_b64_tr_b16 a[94:95], v185 offset:45568
ds_read_b64_tr_b16 a[88:89], v185 offset:40960
ds_read_b64_tr_b16 a[90:91], v185 offset:41472
ds_read_b64_tr_b16 a[84:85], v185 offset:36864
ds_read_b64_tr_b16 a[86:87], v185 offset:37376
ds_read_b64_tr_b16 a[80:81], v185 offset:32768
ds_read_b64_tr_b16 a[82:83], v185 offset:33280
s_waitcnt lgkmcnt(15)
v_mfma_f32_16x16x32_bf16 v[228:231], a[64:67], v[196:199], 0
ds_read_b64_tr_b16 a[96:97], v186 offset:32768
ds_read_b64_tr_b16 a[98:99], v186 offset:33280
s_waitcnt lgkmcnt(15)
v_mfma_f32_16x16x32_bf16 v[228:231], a[68:71], v[200:203], v[228:231]
s_waitcnt lgkmcnt(14)
ds_read_b64_tr_b16 a[100:101], v186 offset:36864
s_waitcnt lgkmcnt(14)
v_mfma_f32_16x16x32_bf16 v[228:231], a[72:75], v[208:211], v[228:231]
s_waitcnt lgkmcnt(11)
ds_read_b64_tr_b16 a[102:103], v186 offset:37376
ds_read_b64_tr_b16 a[104:105], v186 offset:40960
v_mfma_f32_16x16x32_bf16 v[228:231], a[76:79], v[224:227], v[228:231]
s_waitcnt lgkmcnt(9)
ds_read_b64_tr_b16 a[106:107], v186 offset:41472
ds_read_b64_tr_b16 a[108:109], v186 offset:45056
v_mfma_f32_16x16x32_bf16 v[232:235], a[92:95], v[224:227], 0
s_waitcnt lgkmcnt(9)
buffer_load_dwordx4 v236, s[32:35], s57 offen offset:3072 lds
s_add_u32 m0, s49, 4224
v_mfma_f32_16x16x32_bf16 v[232:235], a[88:91], v[208:211], v[232:235]
s_waitcnt lgkmcnt(7)
ds_read_b64_tr_b16 a[110:111], v186 offset:45568
v_cvt_pk_bf16_f32 v0, v228, v229
v_mfma_f32_16x16x32_bf16 v[232:235], a[84:87], v[200:203], v[232:235]
s_waitcnt lgkmcnt(6)
ds_read_b64_tr_b16 a[124:125], v187 offset:45056
v_cvt_pk_bf16_f32 v1, v230, v231
v_mfma_f32_16x16x32_bf16 v[232:235], a[80:83], v[196:199], v[232:235]
s_waitcnt lgkmcnt(6)
ds_read_b64_tr_b16 a[126:127], v187 offset:45568
ds_read_b64_tr_b16 a[116:117], v187 offset:36864
v_mfma_f32_16x16x32_bf16 v[228:231], a[96:99], v[196:199], 0
s_waitcnt lgkmcnt(6)
ds_read_b64_tr_b16 a[118:119], v187 offset:37376
ds_read_b64_tr_b16 a[112:113], v187 offset:32768
v_mfma_f32_16x16x32_bf16 v[228:231], a[100:103], v[200:203], v[228:231]
s_waitcnt lgkmcnt(6)
ds_read_b64_tr_b16 a[114:115], v187 offset:33280
v_cvt_pk_bf16_f32 v2, v232, v233
v_mfma_f32_16x16x32_bf16 v[228:231], a[104:107], v[208:211], v[228:231]
ds_read_b64_tr_b16 a[120:121], v187 offset:40960
s_waitcnt lgkmcnt(7)
v_mfma_f32_16x16x32_bf16 v[228:231], a[108:111], v[224:227], v[228:231]
ds_read_b64_tr_b16 a[122:123], v187 offset:41472
v_cvt_pk_bf16_f32 v3, v234, v235
v_mov_b32 v143, 0
s_nop 1
s_waitcnt lgkmcnt(6)
v_mfma_f32_16x16x32_bf16 v[232:235], a[124:127], v[224:227], 0
s_waitcnt lgkmcnt(5)
buffer_load_dwordx4 v[144:147], v191, s[36:39], s54 offen offset:0
s_waitcnt lgkmcnt(4)
v_mfma_f32_16x16x32_bf16 v[232:235], a[116:119], v[200:203], v[232:235]
s_waitcnt lgkmcnt(3)
ds_read_b128 v[204:207], v240 offset:21632
s_waitcnt lgkmcnt(3)
v_mfma_f32_16x16x32_bf16 v[232:235], a[112:115], v[196:199], v[232:235]
ds_read_b128 v[212:215], v240 offset:21888
ds_read_b128 v[216:219], v240 offset:21376
ds_read_b128 v[220:223], v240 offset:21120
ds_read_b64_tr_b16 a[4:5], v184 offset:4096
ds_read_b64_tr_b16 a[6:7], v184 offset:4608
s_waitcnt lgkmcnt(6)
v_mfma_f32_16x16x32_bf16 v[232:235], a[120:123], v[208:211], v[232:235]
ds_read_b64_tr_b16 a[0:1], v184 offset:0
ds_read_b64_tr_b16 a[2:3], v184 offset:512
ds_read_b64_tr_b16 a[8:9], v184 offset:8192
ds_read_b64_tr_b16 a[10:11], v184 offset:8704
ds_read_b64_tr_b16 a[12:13], v184 offset:12288
ds_read_b64_tr_b16 a[14:15], v184 offset:12800
ds_read_b64_tr_b16 a[16:17], v185 offset:0
ds_read_b64_tr_b16 a[18:19], v185 offset:512
ds_read_b64_tr_b16 a[20:21], v185 offset:4096
s_waitcnt lgkmcnt(14)
v_mfma_f32_16x16x32_bf16 v[196:199], a[120:123], v[204:207], 0
ds_read_b64_tr_b16 a[28:29], v185 offset:12288
s_waitcnt lgkmcnt(14)
v_mfma_f32_16x16x32_bf16 v[196:199], a[124:127], v[212:215], v[196:199]
s_waitcnt lgkmcnt(12)
ds_read_b64_tr_b16 a[30:31], v185 offset:12800
ds_read_b64_tr_b16 a[24:25], v185 offset:8192
v_mfma_f32_16x16x32_bf16 v[196:199], a[116:119], v[216:219], v[196:199]
buffer_load_dwordx4 v[148:151], v191, s[36:39], s54 offen offset:1024
ds_read_b64_tr_b16 a[26:27], v185 offset:8704
v_mfma_f32_16x16x32_bf16 v[196:199], a[112:115], v[220:223], v[196:199]
ds_read_b64_tr_b16 a[22:23], v185 offset:4608
ds_read_b64_tr_b16 a[32:33], v186 offset:0
v_mfma_f32_16x16x32_bf16 v[200:203], a[96:99], v[220:223], 0
ds_read_b64_tr_b16 a[34:35], v186 offset:512
ds_read_b64_tr_b16 a[36:37], v186 offset:4096
v_mfma_f32_16x16x32_bf16 v[200:203], a[100:103], v[216:219], v[200:203]
ds_read_b64_tr_b16 a[38:39], v186 offset:4608
ds_read_b64_tr_b16 a[40:41], v186 offset:8192
v_mfma_f32_16x16x32_bf16 v[200:203], a[104:107], v[204:207], v[200:203]
ds_read_b64_tr_b16 a[42:43], v186 offset:8704
v_cvt_pk_bf16_f32 v46, v196, v197
v_mfma_f32_16x16x32_bf16 v[200:203], a[108:111], v[212:215], v[200:203]
ds_read_b64_tr_b16 a[44:45], v186 offset:12288
v_cvt_pk_bf16_f32 v47, v198, v199
v_mfma_f32_16x16x32_bf16 v[208:211], a[92:95], v[212:215], 0
ds_read_b64_tr_b16 a[46:47], v186 offset:12800
ds_read_b64_tr_b16 a[60:61], v187 offset:12288
v_mfma_f32_16x16x32_bf16 v[208:211], a[88:91], v[204:207], v[208:211]
s_waitcnt lgkmcnt(15)
ds_read_b64_tr_b16 a[62:63], v187 offset:12800
v_cvt_pk_bf16_f32 v44, v200, v201
v_mfma_f32_16x16x32_bf16 v[208:211], a[84:87], v[216:219], v[208:211]
ds_read_b64_tr_b16 a[56:57], v187 offset:8192
v_cvt_pk_bf16_f32 v45, v202, v203
v_mfma_f32_16x16x32_bf16 v[208:211], a[80:83], v[220:223], v[208:211]
buffer_load_dwordx4 v[152:155], v191, s[36:39], s54 offen offset:2048
ds_read_b64_tr_b16 a[58:59], v187 offset:8704
v_mfma_f32_16x16x32_bf16 v[196:199], a[64:67], v[220:223], 0
s_waitcnt lgkmcnt(15)
ds_read_b64_tr_b16 a[52:53], v187 offset:4096
ds_read_b64_tr_b16 a[54:55], v187 offset:4608
v_mfma_f32_16x16x32_bf16 v[196:199], a[72:75], v[204:207], v[196:199]
ds_read_b64_tr_b16 a[48:49], v187 offset:0
ds_read_b64_tr_b16 a[50:51], v187 offset:512
v_mfma_f32_16x16x32_bf16 v[196:199], a[76:79], v[212:215], v[196:199]
s_waitcnt lgkmcnt(15)
v_cvt_pk_bf16_f32 v4, v228, v229
v_cvt_pk_bf16_f32 v5, v230, v231
v_mfma_f32_16x16x32_bf16 v[196:199], a[68:71], v[216:219], v[196:199]
v_cvt_pk_bf16_f32 v6, v232, v233
v_cvt_pk_bf16_f32 v7, v234, v235
v_mfma_f32_16x16x32_bf16 v[200:203], a[4:7], v[216:219], 0
v_cvt_pk_bf16_f32 v42, v208, v209
v_cvt_pk_bf16_f32 v43, v210, v211
v_mfma_f32_16x16x32_bf16 v[200:203], a[0:3], v[220:223], v[200:203]
s_waitcnt lgkmcnt(13)
v_subrev_u32 v184, 34304, v184
v_cvt_pk_bf16_f32 v40, v196, v197
v_mfma_f32_16x16x32_bf16 v[200:203], a[8:11], v[204:207], v[200:203]
s_waitcnt lgkmcnt(11)
v_cvt_pk_bf16_f32 v41, v198, v199
v_subrev_u32 v185, 34304, v185
v_mfma_f32_16x16x32_bf16 v[200:203], a[12:15], v[212:215], v[200:203]
s_waitcnt lgkmcnt(10)
v_subrev_u32 v186, 34304, v186
v_subrev_u32 v187, 34304, v187
v_mfma_f32_16x16x32_bf16 v[196:199], a[28:31], v[212:215], 0
s_waitcnt lgkmcnt(9)
buffer_load_dwordx4 v[156:159], v191, s[36:39], s54 offen offset:3072
v_mfma_f32_16x16x32_bf16 v[196:199], a[24:27], v[204:207], v[196:199]
s_waitcnt lgkmcnt(7)
v_cvt_pk_bf16_f32 v104, v200, v201
v_cvt_pk_bf16_f32 v105, v202, v203
v_mfma_f32_16x16x32_bf16 v[196:199], a[20:23], v[216:219], v[196:199]
s_waitcnt lgkmcnt(6)
v_mfma_f32_16x16x32_bf16 v[196:199], a[16:19], v[220:223], v[196:199]
s_waitcnt lgkmcnt(5)
s_nop 1
v_mfma_f32_16x16x32_bf16 v[200:203], a[32:35], v[220:223], 0
s_waitcnt lgkmcnt(4)
s_nop 1
v_mfma_f32_16x16x32_bf16 v[200:203], a[36:39], v[216:219], v[200:203]
s_waitcnt lgkmcnt(2)
v_cvt_pk_bf16_f32 v106, v196, v197
v_cvt_pk_bf16_f32 v107, v198, v199
v_mfma_f32_16x16x32_bf16 v[200:203], a[40:43], v[204:207], v[200:203]
s_waitcnt lgkmcnt(0)
v_mfma_f32_16x16x32_bf16 v[200:203], a[44:47], v[212:215], v[200:203]
s_nop 2
v_mfma_f32_16x16x32_bf16 v[196:199], a[60:63], v[212:215], 0
s_waitcnt vmcnt(12)
s_barrier
v_mfma_f32_16x16x32_bf16 v[196:199], a[56:59], v[204:207], v[196:199]
buffer_load_dwordx4 v[160:163], v191, s[36:39], s57 offen offset:0
v_cvt_pk_bf16_f32 v108, v200, v201
v_mfma_f32_16x16x32_bf16 v[196:199], a[52:55], v[216:219], v[196:199]
ds_read_b128 v[48:51], v240 offset:12672
v_cvt_pk_bf16_f32 v109, v202, v203
v_mfma_f32_16x16x32_bf16 v[196:199], a[48:51], v[220:223], v[196:199]
ds_read_b128 v[52:55], v240 offset:12928
ds_read_b128 v[56:59], v240 offset:13184
ds_read_b128 v[60:63], v240 offset:13440
ds_read_b128 v[64:67], v240 offset:16896
ds_read_b128 v[68:71], v240 offset:17152
s_nop 2
v_cvt_pk_bf16_f32 v110, v196, v197
v_cvt_pk_bf16_f32 v111, v198, v199
s_nop 1
v_mfma_f32_16x16x32_bf16 v[196:199], v[4:7], v[108:111], 0
ds_read_b128 v[72:75], v240 offset:17408
ds_read_b128 v[76:79], v240 offset:17664
v_mfma_f32_16x16x32_bf16 v[196:199], v[0:3], v[104:107], v[196:199]
ds_write_b128 v96, v[100:103] offset:0
v_mfma_f32_16x16x32_bf16 v[200:203], v[40:43], v[104:107], 0
s_waitcnt lgkmcnt(8)
buffer_load_dwordx4 v[164:167], v191, s[36:39], s57 offen offset:1024
s_nop 0
v_mfma_f32_16x16x32_bf16 v[200:203], v[44:47], v[108:111], v[200:203]
s_waitcnt lgkmcnt(7)
s_nop 1
v_mfma_f32_16x16x32_bf16 v[208:211], a[64:67], v[48:51], 0
s_waitcnt lgkmcnt(6)
v_exp_f32 v196, v196
v_mfma_f32_16x16x32_bf16 v[208:211], a[68:71], v[52:55], v[208:211]
s_waitcnt lgkmcnt(5)
v_exp_f32 v197, v197
v_mfma_f32_16x16x32_bf16 v[208:211], a[72:75], v[56:59], v[208:211]
v_exp_f32 v198, v198
v_mfma_f32_16x16x32_bf16 v[208:211], a[76:79], v[60:63], v[208:211]
v_exp_f32 v199, v199
v_mfma_f32_16x16x32_bf16 v[224:227], a[92:95], v[60:63], 0
v_cvt_pk_bf16_f32 v112, v196, v197
v_cvt_pk_bf16_f32 v113, v198, v199
v_mfma_f32_16x16x32_bf16 v[224:227], a[88:91], v[56:59], v[224:227]
s_waitcnt lgkmcnt(3)
v_exp_f32 v200, v200
v_mfma_f32_16x16x32_bf16 v[224:227], a[84:87], v[52:55], v[224:227]
v_cvt_pk_bf16_f32 v80, v208, v209
v_cvt_pk_bf16_f32 v82, v210, v211
v_mfma_f32_16x16x32_bf16 v[224:227], a[80:83], v[48:51], v[224:227]
buffer_load_dwordx4 v[168:171], v191, s[36:39], s57 offen offset:2048
s_nop 0
v_mfma_f32_16x16x32_bf16 v[196:199], a[96:99], v[48:51], 0
s_waitcnt lgkmcnt(1)
v_exp_f32 v201, v201
v_mfma_f32_16x16x32_bf16 v[196:199], a[100:103], v[52:55], v[196:199]
v_exp_f32 v202, v202
v_mfma_f32_16x16x32_bf16 v[196:199], a[104:107], v[56:59], v[196:199]
v_exp_f32 v203, v203
v_mfma_f32_16x16x32_bf16 v[196:199], a[108:111], v[60:63], v[196:199]
v_cvt_pk_bf16_f32 v122, v200, v201
v_cvt_pk_bf16_f32 v123, v202, v203
v_mfma_f32_16x16x32_bf16 v[208:211], a[124:127], v[60:63], 0
v_cvt_pk_bf16_f32 v81, v224, v225
v_cvt_pk_bf16_f32 v83, v226, v227
v_mfma_f32_16x16x32_bf16 v[208:211], a[116:119], v[52:55], v[208:211]
ds_write_b64 v238, v[80:81] offset:0
v_mfma_f32_16x16x32_bf16 v[208:211], a[112:115], v[48:51], v[208:211]
ds_write_b64 v238, v[82:83] offset:64
v_mfma_f32_16x16x32_bf16 v[208:211], a[120:123], v[56:59], v[208:211]
buffer_load_dwordx4 v[172:175], v191, s[36:39], s57 offen offset:3072
v_mfma_f32_16x16x32_bf16 v[200:203], a[56:59], v[56:59], 0
v_cvt_pk_bf16_f32 v84, v196, v197
v_cvt_pk_bf16_f32 v86, v198, v199
v_mfma_f32_16x16x32_bf16 v[200:203], a[60:63], v[60:63], v[200:203]
v_xor_b32 v191, 96, v190
s_nop 0
v_mfma_f32_16x16x32_bf16 v[200:203], a[52:55], v[52:55], v[200:203]
s_waitcnt vmcnt(8)
s_barrier
v_mfma_f32_16x16x32_bf16 v[200:203], a[48:51], v[48:51], v[200:203]
ds_read_b64_tr_b16 a[128:129], v188 offset:0
ds_read_b64_tr_b16 a[130:131], v188 offset:512
v_mfma_f32_16x16x32_bf16 v[196:199], a[32:35], v[48:51], 0
ds_read_b64_tr_b16 a[132:133], v188 offset:4096
ds_read_b64_tr_b16 a[134:135], v188 offset:4608
v_mfma_f32_16x16x32_bf16 v[196:199], a[36:39], v[52:55], v[196:199]
ds_read_b64_tr_b16 a[136:137], v188 offset:8192
ds_read_b64_tr_b16 a[138:139], v188 offset:8704
v_mfma_f32_16x16x32_bf16 v[196:199], a[40:43], v[56:59], v[196:199]
ds_read_b64_tr_b16 a[140:141], v188 offset:12288
v_cvt_pk_bf16_f32 v93, v200, v201
v_mfma_f32_16x16x32_bf16 v[196:199], a[44:47], v[60:63], v[196:199]
buffer_load_dwordx4 v241, s[16:19], s48 offen nt lds
v_mfma_f32_16x16x32_bf16 v[224:227], a[28:31], v[60:63], 0
s_add_u32 m0, s49, 6336
s_add_u32 s48, s55, 6144
v_cvt_pk_bf16_f32 v95, v202, v203
v_mfma_f32_16x16x32_bf16 v[224:227], a[24:27], v[56:59], v[224:227]
ds_read_b64_tr_b16 a[142:143], v188 offset:12800
v_cvt_pk_bf16_f32 v85, v208, v209
v_mfma_f32_16x16x32_bf16 v[224:227], a[20:23], v[52:55], v[224:227]
ds_read_b64_tr_b16 a[156:157], v188 offset:12296
v_cvt_pk_bf16_f32 v92, v196, v197
v_mfma_f32_16x16x32_bf16 v[224:227], a[16:19], v[48:51], v[224:227]
ds_read_b64_tr_b16 a[158:159], v188 offset:12808
v_cvt_pk_bf16_f32 v94, v198, v199
v_mfma_f32_16x16x32_bf16 v[200:203], a[0:3], v[48:51], 0
ds_read_b64_tr_b16 a[152:153], v188 offset:8200
v_cvt_pk_bf16_f32 v87, v210, v211
v_mfma_f32_16x16x32_bf16 v[200:203], a[4:7], v[52:55], v[200:203]
ds_read_b64_tr_b16 a[154:155], v188 offset:8712
ds_read_b64_tr_b16 a[148:149], v188 offset:4104
v_mfma_f32_16x16x32_bf16 v[200:203], a[8:11], v[56:59], v[200:203]
s_waitcnt lgkmcnt(11)
ds_read_b64_tr_b16 a[150:151], v188 offset:4616
v_cvt_pk_bf16_f32 v89, v224, v225
v_mfma_f32_16x16x32_bf16 v[200:203], a[12:15], v[60:63], v[200:203]
s_waitcnt lgkmcnt(10)
ds_read_b64_tr_b16 a[144:145], v188 offset:8
v_cvt_pk_bf16_f32 v91, v226, v227
v_mfma_f32_16x16x32_bf16 v[196:199], v[48:51], a[128:131], 0
s_waitcnt lgkmcnt(9)
buffer_load_dwordx4 v241, s[16:19], s48 offen nt lds
v_mfma_f32_16x16x32_bf16 v[196:199], v[52:55], a[132:135], v[196:199]
s_add_u32 m0, s49, 8448
s_add_u32 s48, s55, 8192
v_cvt_pk_bf16_f32 v88, v200, v201
v_mfma_f32_16x16x32_bf16 v[196:199], v[56:59], a[136:139], v[196:199]
s_waitcnt lgkmcnt(7)
ds_read_b64_tr_b16 a[146:147], v188 offset:520
v_cvt_pk_bf16_f32 v90, v202, v203
v_mfma_f32_16x16x32_bf16 v[196:199], v[60:63], a[140:143], v[196:199]
ds_read_b64_tr_b16 a[160:161], v189 offset:0
ds_read_b64_tr_b16 a[162:163], v189 offset:512
v_mfma_f32_16x16x32_bf16 v[200:203], v[80:83], v[88:91], 0
s_waitcnt lgkmcnt(8)
ds_read_b64_tr_b16 a[164:165], v189 offset:4096
ds_read_b64_tr_b16 a[166:167], v189 offset:4608
v_mfma_f32_16x16x32_bf16 v[200:203], v[84:87], v[92:95], v[200:203]
s_waitcnt lgkmcnt(8)
ds_read_b64_tr_b16 a[168:169], v189 offset:8192
ds_read_b64_tr_b16 a[170:171], v189 offset:8704
v_mfma_f32_16x16x32_bf16 v[208:211], v[60:63], a[156:159], 0
s_waitcnt lgkmcnt(8)
ds_read_b64_tr_b16 a[172:173], v189 offset:12288
ds_read_b64_tr_b16 a[174:175], v189 offset:12800
v_mfma_f32_16x16x32_bf16 v[208:211], v[56:59], a[152:155], v[208:211]
s_waitcnt lgkmcnt(9)
ds_read_b64_tr_b16 a[188:189], v189 offset:12296
ds_read_b64_tr_b16 a[190:191], v189 offset:12808
v_mfma_f32_16x16x32_bf16 v[208:211], v[52:55], a[148:151], v[208:211]
s_waitcnt lgkmcnt(10)
ds_read_b64_tr_b16 a[184:185], v189 offset:8200
ds_read_b64_tr_b16 a[186:187], v189 offset:8712
v_mfma_f32_16x16x32_bf16 v[208:211], v[48:51], a[144:147], v[208:211]
s_waitcnt lgkmcnt(10)
buffer_load_dwordx4 v241, s[16:19], s48 offen nt lds
v_mfma_f32_16x16x32_bf16 v[224:227], v[48:51], a[160:163], 0
s_add_u32 m0, s49, 10560
s_add_u32 s48, s55, 10240
s_waitcnt lgkmcnt(8)
v_mfma_f32_16x16x32_bf16 v[224:227], v[52:55], a[164:167], v[224:227]
s_waitcnt lgkmcnt(6)
ds_read_b64_tr_b16 a[180:181], v189 offset:4104
ds_read_b64_tr_b16 a[182:183], v189 offset:4616
v_mfma_f32_16x16x32_bf16 v[224:227], v[56:59], a[168:171], v[224:227]
s_waitcnt lgkmcnt(6)
ds_read_b64_tr_b16 a[176:177], v189 offset:8
ds_read_b64_tr_b16 a[178:179], v189 offset:520
v_mfma_f32_16x16x32_bf16 v[224:227], v[60:63], a[172:175], v[224:227]
s_waitcnt lgkmcnt(6)
ds_write_b64 v239, v[84:85] offset:0
v_mfma_f32_16x16x32_bf16 v[228:231], v[60:63], a[188:191], 0
s_waitcnt lgkmcnt(5)
ds_write_b64 v239, v[86:87] offset:64
v_mfma_f32_16x16x32_bf16 v[228:231], v[56:59], a[184:187], v[228:231]
ds_read_b128 v[96:99], v243 offset:0
v_mov_b64 v[232:233], s[96:97]
v_mov_b64 v[234:235], s[96:97]
v_cvt_pk_bf16_f32 v196, v196, v197
s_waitcnt lgkmcnt(5)
v_mfma_f32_16x16x32_bf16 v[228:231], v[52:55], a[180:183], v[228:231]
v_cvt_pk_bf16_f32 v197, v198, v199
s_waitcnt lgkmcnt(3)
v_mfma_f32_16x16x32_bf16 v[228:231], v[48:51], a[176:179], v[228:231]
s_barrier
buffer_load_dwordx4 v241, s[16:19], s48 offen nt lds
s_add_u32 m0, s49, 12672
s_add_u32 s48, s55, 12288
ds_write_b64 v237, v[196:197] offset:0
s_waitcnt lgkmcnt(1)
v_smfmac_f32_16x16x64_bf16 v[232:235], v[96:99], v[104:111], v250
ds_write_b64 v238, v[88:89] offset:512
v_mfma_f32_16x16x32_bf16 v[196:199], a[0:3], v[64:67], 0
ds_write_b64 v238, v[90:91] offset:576
v_mfma_f32_16x16x32_bf16 v[196:199], a[4:7], v[68:71], v[196:199]
ds_write_b64 v239, v[92:93] offset:512
v_mfma_f32_16x16x32_bf16 v[196:199], a[8:11], v[72:75], v[196:199]
ds_write_b64 v239, v[94:95] offset:576
v_mfma_f32_16x16x32_bf16 v[196:199], a[12:15], v[76:79], v[196:199]
v_cvt_pk_bf16_f32 v208, v208, v209
buffer_load_dwordx4 v241, s[16:19], s48 offen nt lds
s_add_u32 m0, s49, 14784
s_add_u32 s48, s55, 14336
v_cvt_pk_bf16_f32 v209, v210, v211
s_nop 2
v_cvt_pk_bf16_f32 v88, v196, v197
v_cvt_pk_bf16_f32 v90, v198, v199
v_mfma_f32_16x16x32_bf16 v[196:199], a[28:31], v[76:79], 0
ds_write_b64 v237, v[208:209] offset:128
v_mfma_f32_16x16x32_bf16 v[196:199], a[24:27], v[72:75], v[196:199]
v_exp_f32 v200, v200
v_mfma_f32_16x16x32_bf16 v[196:199], a[20:23], v[68:71], v[196:199]
v_exp_f32 v201, v201
v_mfma_f32_16x16x32_bf16 v[196:199], a[16:19], v[64:67], v[196:199]
v_exp_f32 v202, v202
v_mfma_f32_16x16x32_bf16 v[208:211], a[32:35], v[64:67], 0
v_exp_f32 v203, v203
v_mfma_f32_16x16x32_bf16 v[208:211], a[36:39], v[68:71], v[208:211]
v_add_f32 v182, v200, v201
v_cvt_pk_bf16_f32 v200, v200, v201
v_mfma_f32_16x16x32_bf16 v[208:211], a[40:43], v[72:75], v[208:211]
buffer_load_dwordx4 v241, s[16:19], s48 offen nt lds
s_add_u32 m0, s49, 16896
v_mfma_f32_16x16x32_bf16 v[208:211], a[44:47], v[76:79], v[208:211]
s_add_u32 s48, s55, 16384
v_cvt_pk_bf16_f32 v89, v196, v197
v_cvt_pk_bf16_f32 v91, v198, v199
v_mfma_f32_16x16x32_bf16 v[196:199], a[60:63], v[76:79], 0
ds_write_b64 v238, v[88:89] offset:6912
v_mfma_f32_16x16x32_bf16 v[196:199], a[52:55], v[68:71], v[196:199]
ds_write_b64 v238, v[90:91] offset:6976
v_mfma_f32_16x16x32_bf16 v[196:199], a[48:51], v[64:67], v[196:199]
v_cvt_pk_bf16_f32 v92, v208, v209
v_cvt_pk_bf16_f32 v94, v210, v211
v_mfma_f32_16x16x32_bf16 v[196:199], a[56:59], v[72:75], v[196:199]
v_add_f32 v183, v202, v203
v_cvt_pk_bf16_f32 v201, v202, v203
v_mfma_f32_16x16x32_bf16 v[208:211], a[120:123], v[72:75], 0
v_add_f32 v202, v182, v183
v_xor_b32 v188, 32, v190
v_mfma_f32_16x16x32_bf16 v[208:211], a[124:127], v[76:79], v[208:211]
s_mov_b32 exec_lo, 0xf0000f
s_mov_b32 exec_hi, 0xf0000f00
ds_write_b96 v253, v[200:202] offset:0
s_mov_b64 exec, -1
v_mfma_f32_16x16x32_bf16 v[208:211], a[116:119], v[68:71], v[208:211]
buffer_load_dwordx4 v241, s[16:19], s48 offen nt lds
s_add_u32 m0, s49, 19008
v_mfma_f32_16x16x32_bf16 v[208:211], a[112:115], v[64:67], v[208:211]
s_add_u32 s48, s55, 18432
v_cvt_pk_bf16_f32 v93, v196, v197
v_cvt_pk_bf16_f32 v95, v198, v199
v_mfma_f32_16x16x32_bf16 v[196:199], a[96:99], v[64:67], 0
ds_write_b64 v239, v[92:93] offset:6912
v_mfma_f32_16x16x32_bf16 v[196:199], a[100:103], v[68:71], v[196:199]
ds_write_b64 v239, v[94:95] offset:6976
v_mfma_f32_16x16x32_bf16 v[196:199], a[104:107], v[72:75], v[196:199]
v_cvt_pk_bf16_f32 v85, v208, v209
v_cvt_pk_bf16_f32 v87, v210, v211
v_mfma_f32_16x16x32_bf16 v[196:199], a[108:111], v[76:79], v[196:199]
v_cvt_pk_bf16_f32 v224, v224, v225
v_cvt_pk_bf16_f32 v225, v226, v227
v_mfma_f32_16x16x32_bf16 v[200:203], a[92:95], v[76:79], 0
ds_write_b64 v237, v[224:225] offset:256
v_mfma_f32_16x16x32_bf16 v[200:203], a[88:91], v[72:75], v[200:203]
v_xor_b32 v189, 64, v190
v_cvt_pk_bf16_f32 v228, v228, v229
v_mfma_f32_16x16x32_bf16 v[200:203], a[84:87], v[68:71], v[200:203]
buffer_load_dwordx4 v241, s[16:19], s48 offen nt lds
v_cvt_pk_bf16_f32 v84, v196, v197
v_mfma_f32_16x16x32_bf16 v[200:203], a[80:83], v[64:67], v[200:203]
v_cvt_pk_bf16_f32 v86, v198, v199
v_cvt_pk_bf16_f32 v229, v230, v231
v_mfma_f32_16x16x32_bf16 v[196:199], a[64:67], v[64:67], 0
ds_write_b64 v237, v[228:229] offset:384
v_mfma_f32_16x16x32_bf16 v[196:199], a[68:71], v[68:71], v[196:199]
s_mul_i32 s48, s43, 3168
s_add_u32 s49, s49, s48
s_add_u32 s49, s49, 50688
s_mov_b32 s48, 8192
v_mfma_f32_16x16x32_bf16 v[196:199], a[72:75], v[72:75], v[196:199]
v_cvt_pk_bf16_f32 v81, v200, v201
v_cvt_pk_bf16_f32 v83, v202, v203
v_mfma_f32_16x16x32_bf16 v[196:199], a[76:79], v[76:79], v[196:199]
s_waitcnt vmcnt(15)
ds_write_b64 v190, v[144:145] offset:0
v_mfma_f32_16x16x32_bf16 v[200:203], v[76:79], a[188:191], 0
ds_write_b64 v188, v[146:147] offset:0
v_mfma_f32_16x16x32_bf16 v[200:203], v[72:75], a[184:187], v[200:203]
s_waitcnt vmcnt(14)
ds_write_b64 v190, v[148:149] offset:512
v_mfma_f32_16x16x32_bf16 v[200:203], v[68:71], a[180:183], v[200:203]
ds_write_b64 v188, v[150:151] offset:512
v_mfma_f32_16x16x32_bf16 v[200:203], v[64:67], a[176:179], v[200:203]
s_waitcnt vmcnt(13)
ds_write_b64 v189, v[152:153] offset:1024
v_cvt_pk_bf16_f32 v80, v196, v197
v_cvt_pk_bf16_f32 v82, v198, v199
v_add_f32 v232, v232, v233
v_add_f32 v234, v234, v235
v_mfma_f32_16x16x32_bf16 v[196:199], v[80:83], v[88:91], 0
ds_write_b64 v191, v[154:155] offset:1024
v_mfma_f32_16x16x32_bf16 v[196:199], v[84:87], v[92:95], v[196:199]
s_waitcnt vmcnt(12)
ds_write_b64 v189, v[156:157] offset:1536
v_mfma_f32_16x16x32_bf16 v[208:211], v[64:67], a[160:163], 0
ds_write_b64 v191, v[158:159] offset:1536
v_mfma_f32_16x16x32_bf16 v[208:211], v[68:71], a[164:167], v[208:211]
s_waitcnt vmcnt(11)
ds_write_b64 v190, v[160:161] offset:2048
v_mfma_f32_16x16x32_bf16 v[208:211], v[72:75], a[168:171], v[208:211]
ds_write_b64 v188, v[162:163] offset:2048
v_mfma_f32_16x16x32_bf16 v[208:211], v[76:79], a[172:175], v[208:211]
s_waitcnt vmcnt(10)
ds_write_b64 v190, v[164:165] offset:2560
v_mfma_f32_16x16x32_bf16 v[224:227], v[76:79], a[156:159], 0
ds_write_b64 v188, v[166:167] offset:2560
v_mfma_f32_16x16x32_bf16 v[224:227], v[72:75], a[152:155], v[224:227]
s_waitcnt vmcnt(9)
ds_write_b64 v189, v[168:169] offset:3072
v_mfma_f32_16x16x32_bf16 v[224:227], v[68:71], a[148:151], v[224:227]
ds_write_b64 v191, v[170:171] offset:3072
v_mfma_f32_16x16x32_bf16 v[224:227], v[64:67], a[144:147], v[224:227]
s_waitcnt vmcnt(8)
ds_write_b64 v189, v[172:173] offset:3584
v_mfma_f32_16x16x32_bf16 v[228:231], v[64:67], a[128:131], 0
ds_write_b64 v191, v[174:175] offset:3584
v_mfma_f32_16x16x32_bf16 v[228:231], v[72:75], a[136:139], v[228:231]
ds_write_b64 v238, v[80:81] offset:6400
v_mfma_f32_16x16x32_bf16 v[228:231], v[76:79], a[140:143], v[228:231]
ds_write_b64 v238, v[82:83] offset:6464
v_mfma_f32_16x16x32_bf16 v[228:231], v[68:71], a[132:135], v[228:231]
ds_write_b64 v239, v[84:85] offset:6400
v_exp_f32 v196, v196
s_waitcnt lgkmcnt(3)
s_barrier
v_exp_f32 v197, v197
v_exp_f32 v198, v198
v_exp_f32 v199, v199
v_cvt_pk_bf16_f32 v200, v200, v201
v_add_f32 v182, v196, v197
v_cvt_pk_bf16_f32 v201, v202, v203
v_cvt_pk_bf16_f32 v196, v196, v197
v_add_f32 v183, v198, v199
v_cvt_pk_bf16_f32 v197, v198, v199
v_add_f32 v198, v182, v183
v_cvt_pk_bf16_f32 v208, v208, v209
v_cvt_pk_bf16_f32 v209, v210, v211
v_cvt_pk_bf16_f32 v224, v224, v225
v_cvt_pk_bf16_f32 v225, v226, v227
ds_write_b64 v237, v[200:201] offset:6784
s_mov_b32 exec_lo, 0xf0000f
s_mov_b32 exec_hi, 0xf0000f00
ds_write_b96 v253, v[196:198] offset:256
s_mov_b64 exec, -1
ds_write_b64 v237, v[208:209] offset:6656
ds_write_b64 v237, v[224:225] offset:6528
ds_read_b128 v[196:199], v240 offset:256
v_exp_f32 v232, v232
v_exp_f32 v234, v234
v_cvt_pk_bf16_f32 v228, v228, v229
v_perm_b32 v124, v234, v232, v251
v_perm_b32 v125, v234, v232, v252
v_cvt_pk_bf16_f32 v229, v230, v231
ds_read_b128 v[232:235], v240 offset:0
ds_read_b128 v[200:203], v240 offset:512
ds_read_b128 v[208:211], v240 offset:768
ds_write_b64 v237, v[228:229] offset:6400
ds_read_b64_tr_b16 a[192:193], v184 offset:0
ds_read_b64_tr_b16 a[194:195], v184 offset:512
ds_read_b64_tr_b16 a[196:197], v184 offset:4096
ds_read_b64_tr_b16 a[198:199], v184 offset:4608
s_waitcnt lgkmcnt(8)
v_mfma_f32_16x16x32_bf16 v[224:227], v[196:199], a[132:135], 0
ds_read_b64_tr_b16 a[200:201], v184 offset:8192
ds_read_b64_tr_b16 a[202:203], v184 offset:8704
ds_read_b64_tr_b16 a[204:205], v184 offset:12288
ds_read_b64_tr_b16 a[206:207], v184 offset:12800
ds_read_b64_tr_b16 a[208:209], v185 offset:0
ds_read_b64_tr_b16 a[210:211], v185 offset:512
ds_read_b64_tr_b16 a[212:213], v185 offset:4096
ds_read_b64_tr_b16 a[214:215], v185 offset:4608
s_waitcnt lgkmcnt(15)
v_mfma_f32_16x16x32_bf16 v[224:227], v[232:235], a[128:131], v[224:227]
s_waitcnt lgkmcnt(13)
ds_read_b64_tr_b16 a[216:217], v185 offset:8192
ds_read_b64_tr_b16 a[218:219], v185 offset:8704
v_mfma_f32_16x16x32_bf16 v[224:227], v[200:203], a[136:139], v[224:227]
ds_read_b64_tr_b16 a[220:221], v185 offset:12288
ds_read_b64_tr_b16 a[222:223], v185 offset:12800
v_mfma_f32_16x16x32_bf16 v[224:227], v[208:211], a[140:143], v[224:227]
ds_read_b64_tr_b16 a[224:225], v186 offset:0
ds_read_b64_tr_b16 a[226:227], v186 offset:512
v_mfma_f32_16x16x32_bf16 v[228:231], v[208:211], a[156:159], 0
ds_read_b64_tr_b16 a[228:229], v186 offset:4096
ds_read_b64_tr_b16 a[230:231], v186 offset:4608
v_mfma_f32_16x16x32_bf16 v[228:231], v[200:203], a[152:155], v[228:231]
ds_read_b64_tr_b16 a[232:233], v186 offset:8192
ds_read_b64_tr_b16 a[234:235], v186 offset:8704
v_mfma_f32_16x16x32_bf16 v[228:231], v[196:199], a[148:151], v[228:231]
ds_read_b64_tr_b16 a[236:237], v186 offset:12288
v_cvt_pk_bf16_f32 v48, v224, v225
v_mfma_f32_16x16x32_bf16 v[228:231], v[232:235], a[144:147], v[228:231]
ds_read_b64_tr_b16 a[238:239], v186 offset:12800
v_cvt_pk_bf16_f32 v49, v226, v227
v_mfma_f32_16x16x32_bf16 v[224:227], v[232:235], a[160:163], 0
ds_read_b64_tr_b16 a[240:241], v187 offset:0
ds_read_b64_tr_b16 a[242:243], v187 offset:512
v_mfma_f32_16x16x32_bf16 v[224:227], v[196:199], a[164:167], v[224:227]
ds_read_b64_tr_b16 a[244:245], v187 offset:4096
ds_read_b64_tr_b16 a[246:247], v187 offset:4608
v_mfma_f32_16x16x32_bf16 v[224:227], v[200:203], a[168:171], v[224:227]
s_waitcnt lgkmcnt(15)
ds_read_b64_tr_b16 a[248:249], v187 offset:8192
v_cvt_pk_bf16_f32 v52, v228, v229
v_mfma_f32_16x16x32_bf16 v[224:227], v[208:211], a[172:175], v[224:227]
ds_read_b64_tr_b16 a[250:251], v187 offset:8704
v_cvt_pk_bf16_f32 v53, v230, v231
v_mfma_f32_16x16x32_bf16 v[228:231], v[208:211], a[188:191], 0
ds_read_b64_tr_b16 a[252:253], v187 offset:12288
ds_read_b64_tr_b16 a[254:255], v187 offset:12800
v_mfma_f32_16x16x32_bf16 v[228:231], v[196:199], a[180:183], v[228:231]
ds_write_b64 v239, v[86:87] offset:6464
v_mfma_f32_16x16x32_bf16 v[228:231], v[232:235], a[176:179], v[228:231]
s_waitcnt lgkmcnt(15)
ds_read2_b32 v[100:101], v244 offset0:0 offset1:8
v_cvt_pk_bf16_f32 v56, v224, v225
v_mfma_f32_16x16x32_bf16 v[228:231], v[200:203], a[184:187], v[228:231]
v_cvt_pk_bf16_f32 v57, v226, v227
s_nop 0
v_mfma_f32_16x16x32_bf16 v[196:199], v[204:207], a[184:187], 0
s_nop 2
v_mfma_f32_16x16x32_bf16 v[196:199], v[212:215], a[188:191], v[196:199]
s_waitcnt lgkmcnt(14)
v_cvt_pk_bf16_f32 v60, v228, v229
v_cvt_pk_bf16_f32 v61, v230, v231
v_mfma_f32_16x16x32_bf16 v[196:199], v[216:219], a[180:183], v[196:199]
s_waitcnt vmcnt(4) lgkmcnt(2)
s_barrier
v_mfma_f32_16x16x32_bf16 v[196:199], v[220:223], a[176:179], v[196:199]
s_bfe_i32 s57, s3, 0x10000
v_add_u32 v243, 1600, v243
v_add_u32 v244, 1600, v244
v_mfma_f32_16x16x32_bf16 v[200:203], v[220:223], a[160:163], 0
s_add_u32 s53, s46, 0
s_add_u32 s52, s46, 20480
s_and_b32 s54, s57, s5
v_mfma_f32_16x16x32_bf16 v[200:203], v[216:219], a[164:167], v[200:203]
s_lshr_b32 s3, s3, 1
v_cvt_pk_bf16_f32 v94, v196, v197
v_cvt_pk_bf16_f32 v95, v198, v199
v_mfma_f32_16x16x32_bf16 v[200:203], v[204:207], a[168:171], v[200:203]
s_sub_u32 s45, s45, 1
s_mov_b32 s47, s46
v_mfma_f32_16x16x32_bf16 v[200:203], v[212:215], a[172:175], v[200:203]
s_waitcnt vmcnt(0)
s_barrier
v_mfma_f32_16x16x32_bf16 v[196:199], v[212:215], a[156:159], 0
s_add_u32 m0, s49, 0
s_mov_b32 s98, s50
s_add_u32 s99, s98, s51
v_mfma_f32_16x16x32_bf16 v[196:199], v[204:207], a[152:155], v[196:199]
s_add_u32 s100, s99, s51
v_cvt_pk_bf16_f32 v90, v200, v201
v_cvt_pk_bf16_f32 v91, v202, v203
v_mfma_f32_16x16x32_bf16 v[196:199], v[216:219], a[148:151], v[196:199]
s_add_u32 s101, s100, s51
s_add_u32 s50, s50, 13107200
s_sub_u32 s50, s50, s54
v_mfma_f32_16x16x32_bf16 v[196:199], v[220:223], a[144:147], v[196:199]
s_waitcnt lgkmcnt(0)
s_nop 1
v_mfma_f32_16x16x32_bf16 v[200:203], v[220:223], a[128:131], 0
s_nop 2
v_mfma_f32_16x16x32_bf16 v[200:203], v[216:219], a[132:135], v[200:203]
v_cvt_pk_bf16_f32 v86, v196, v197
v_cvt_pk_bf16_f32 v87, v198, v199
v_mfma_f32_16x16x32_bf16 v[200:203], v[204:207], a[136:139], v[200:203]
v_mfma_f32_16x16x32_bf16 v[200:203], v[212:215], a[140:143], v[200:203]
s_nop 2
v_mfma_f32_16x16x32_bf16 v[144:147], a[192:195], v[220:223], 0
s_nop 2
v_mfma_f32_16x16x32_bf16 v[144:147], a[196:199], v[216:219], v[144:147]
v_cvt_pk_bf16_f32 v82, v200, v201
v_cvt_pk_bf16_f32 v83, v202, v203
v_mfma_f32_16x16x32_bf16 v[144:147], a[200:203], v[204:207], v[144:147]
v_mfma_f32_16x16x32_bf16 v[144:147], a[204:207], v[212:215], v[144:147]
v_mfma_f32_16x16x32_bf16 v[148:151], a[220:223], v[212:215], 0
v_mfma_f32_16x16x32_bf16 v[148:151], a[216:219], v[204:207], v[148:151]
v_mfma_f32_16x16x32_bf16 v[148:151], a[212:215], v[216:219], v[148:151]
v_mfma_f32_16x16x32_bf16 v[148:151], a[208:211], v[220:223], v[148:151]
ds_read_b128 v[196:199], v240 offset:4224
ds_read_b128 v[200:203], v240 offset:4480
v_mfma_f32_16x16x32_bf16 v[152:155], a[224:227], v[220:223], 0
ds_read_b128 v[208:211], v240 offset:4736
ds_read_b128 v[224:227], v240 offset:4992
v_mfma_f32_16x16x32_bf16 v[152:155], a[228:231], v[216:219], v[152:155]
v_mfma_f32_16x16x32_bf16 v[152:155], a[232:235], v[204:207], v[152:155]
v_mfma_f32_16x16x32_bf16 v[152:155], a[236:239], v[212:215], v[152:155]
v_mfma_f32_16x16x32_bf16 v[156:159], a[252:255], v[212:215], 0
ds_read_b128 v[212:215], v240 offset:9216
v_mfma_f32_16x16x32_bf16 v[156:159], a[248:251], v[204:207], v[156:159]
ds_read_b128 v[204:207], v240 offset:8960
v_mfma_f32_16x16x32_bf16 v[156:159], a[244:247], v[216:219], v[156:159]
s_waitcnt lgkmcnt(5)
ds_read_b128 v[216:219], v240 offset:8704
v_mfma_f32_16x16x32_bf16 v[156:159], a[240:243], v[220:223], v[156:159]
s_waitcnt lgkmcnt(5)
ds_read_b128 v[220:223], v240 offset:8448
v_mfma_f32_16x16x32_bf16 v[228:231], a[64:67], v[196:199], 0
s_waitcnt lgkmcnt(5)
v_mfma_f32_16x16x32_bf16 v[228:231], a[68:71], v[200:203], v[228:231]
s_waitcnt lgkmcnt(4)
v_mfma_f32_16x16x32_bf16 v[228:231], a[72:75], v[208:211], v[228:231]
v_mfma_f32_16x16x32_bf16 v[228:231], a[76:79], v[224:227], v[228:231]
s_nop 2
v_mfma_f32_16x16x32_bf16 v[232:235], a[92:95], v[224:227], 0
s_nop 2
v_mfma_f32_16x16x32_bf16 v[232:235], a[88:91], v[208:211], v[232:235]
v_cvt_pk_bf16_f32 v8, v228, v229
v_cvt_pk_bf16_f32 v9, v230, v231
v_mfma_f32_16x16x32_bf16 v[232:235], a[84:87], v[200:203], v[232:235]
v_mfma_f32_16x16x32_bf16 v[232:235], a[80:83], v[196:199], v[232:235]
s_nop 2
v_mfma_f32_16x16x32_bf16 v[228:231], a[96:99], v[196:199], 0
s_nop 2
v_mfma_f32_16x16x32_bf16 v[228:231], a[100:103], v[200:203], v[228:231]
s_waitcnt lgkmcnt(3)
v_cvt_pk_bf16_f32 v10, v232, v233
v_cvt_pk_bf16_f32 v11, v234, v235
v_mfma_f32_16x16x32_bf16 v[228:231], a[104:107], v[208:211], v[228:231]
s_waitcnt lgkmcnt(2)
v_mfma_f32_16x16x32_bf16 v[228:231], a[108:111], v[224:227], v[228:231]
s_waitcnt lgkmcnt(1)
s_nop 1
v_mfma_f32_16x16x32_bf16 v[232:235], a[124:127], v[224:227], 0
s_waitcnt lgkmcnt(0)
ds_read_b128 v[224:227], v240 offset:12672
s_nop 0
v_mfma_f32_16x16x32_bf16 v[232:235], a[116:119], v[200:203], v[232:235]
ds_read_b128 v[200:203], v240 offset:12928
v_cvt_pk_bf16_f32 v12, v228, v229
v_mfma_f32_16x16x32_bf16 v[232:235], a[112:115], v[196:199], v[232:235]
ds_read_b128 v[196:199], v240 offset:13184
v_cvt_pk_bf16_f32 v13, v230, v231
v_mfma_f32_16x16x32_bf16 v[232:235], a[120:123], v[208:211], v[232:235]
ds_read_b128 v[208:211], v240 offset:13440
s_nop 0
v_mfma_f32_16x16x32_bf16 v[228:231], a[120:123], v[204:207], 0
s_nop 2
v_mfma_f32_16x16x32_bf16 v[228:231], a[124:127], v[212:215], v[228:231]
s_nop 0
v_cvt_pk_bf16_f32 v14, v232, v233
v_cvt_pk_bf16_f32 v15, v234, v235
v_mfma_f32_16x16x32_bf16 v[228:231], a[116:119], v[216:219], v[228:231]
v_mfma_f32_16x16x32_bf16 v[228:231], a[112:115], v[220:223], v[228:231]
s_nop 2
v_mfma_f32_16x16x32_bf16 v[232:235], a[96:99], v[220:223], 0
s_nop 2
v_mfma_f32_16x16x32_bf16 v[232:235], a[100:103], v[216:219], v[232:235]
v_cvt_pk_bf16_f32 v22, v228, v229
v_cvt_pk_bf16_f32 v23, v230, v231
v_mfma_f32_16x16x32_bf16 v[232:235], a[104:107], v[204:207], v[232:235]
v_mfma_f32_16x16x32_bf16 v[232:235], a[108:111], v[212:215], v[232:235]
s_nop 2
v_mfma_f32_16x16x32_bf16 v[228:231], a[92:95], v[212:215], 0
s_nop 2
v_mfma_f32_16x16x32_bf16 v[228:231], a[88:91], v[204:207], v[228:231]
s_waitcnt lgkmcnt(3)
v_cvt_pk_bf16_f32 v20, v232, v233
v_cvt_pk_bf16_f32 v21, v234, v235
v_mfma_f32_16x16x32_bf16 v[228:231], a[84:87], v[216:219], v[228:231]
s_waitcnt lgkmcnt(2)
v_mfma_f32_16x16x32_bf16 v[228:231], a[80:83], v[220:223], v[228:231]
s_waitcnt lgkmcnt(1)
s_nop 1
v_mfma_f32_16x16x32_bf16 v[232:235], a[64:67], v[220:223], 0
s_waitcnt lgkmcnt(0)
s_nop 1
v_mfma_f32_16x16x32_bf16 v[232:235], a[68:71], v[216:219], v[232:235]
v_cvt_pk_bf16_f32 v18, v228, v229
v_cvt_pk_bf16_f32 v19, v230, v231
v_mfma_f32_16x16x32_bf16 v[232:235], a[72:75], v[204:207], v[232:235]
v_mfma_f32_16x16x32_bf16 v[232:235], a[76:79], v[212:215], v[232:235]
s_nop 2
v_mfma_f32_16x16x32_bf16 v[228:231], v[220:223], a[128:131], 0
s_nop 2
v_mfma_f32_16x16x32_bf16 v[228:231], v[216:219], a[132:135], v[228:231]
v_cvt_pk_bf16_f32 v16, v232, v233
v_cvt_pk_bf16_f32 v17, v234, v235
v_mfma_f32_16x16x32_bf16 v[228:231], v[204:207], a[136:139], v[228:231]
v_mfma_f32_16x16x32_bf16 v[228:231], v[212:215], a[140:143], v[228:231]
s_nop 2
v_mfma_f32_16x16x32_bf16 v[232:235], v[212:215], a[156:159], 0
s_nop 2
v_mfma_f32_16x16x32_bf16 v[232:235], v[204:207], a[152:155], v[232:235]
v_cvt_pk_bf16_f32 v64, v228, v229
v_cvt_pk_bf16_f32 v65, v230, v231
v_mfma_f32_16x16x32_bf16 v[232:235], v[216:219], a[148:151], v[232:235]
v_mfma_f32_16x16x32_bf16 v[232:235], v[220:223], a[144:147], v[232:235]
s_nop 2
v_mfma_f32_16x16x32_bf16 v[228:231], v[220:223], a[160:163], 0
s_nop 2
v_mfma_f32_16x16x32_bf16 v[228:231], v[216:219], a[164:167], v[228:231]
v_cvt_pk_bf16_f32 v68, v232, v233
v_cvt_pk_bf16_f32 v69, v234, v235
v_mfma_f32_16x16x32_bf16 v[228:231], v[204:207], a[168:171], v[228:231]
v_mfma_f32_16x16x32_bf16 v[228:231], v[212:215], a[172:175], v[228:231]
s_nop 2
v_mfma_f32_16x16x32_bf16 v[232:235], v[212:215], a[188:191], 0
ds_read_b128 v[212:215], v240 offset:17664
s_nop 0
v_mfma_f32_16x16x32_bf16 v[232:235], v[204:207], a[184:187], v[232:235]
ds_read_b128 v[204:207], v240 offset:17408
v_cvt_pk_bf16_f32 v72, v228, v229
v_mfma_f32_16x16x32_bf16 v[232:235], v[216:219], a[180:183], v[232:235]
ds_read_b128 v[216:219], v240 offset:17152
v_cvt_pk_bf16_f32 v73, v230, v231
v_mfma_f32_16x16x32_bf16 v[232:235], v[220:223], a[176:179], v[232:235]
ds_read_b128 v[220:223], v240 offset:16896
s_nop 0
v_mfma_f32_16x16x32_bf16 v[228:231], v[12:15], v[108:111], 0
s_nop 2
v_mfma_f32_16x16x32_bf16 v[228:231], v[8:11], v[104:107], v[228:231]
buffer_load_dwordx4 v241, s[16:19], s98 offen offset:0 nt lds
v_cvt_pk_bf16_f32 v76, v232, v233
v_cvt_pk_bf16_f32 v77, v234, v235
v_mfma_f32_16x16x32_bf16 v[232:235], v[16:19], v[104:107], 0
buffer_load_dwordx4 v241, s[16:19], s99 offen offset:1056 nt lds
v_mfma_f32_16x16x32_bf16 v[232:235], v[20:23], v[108:111], v[232:235]
s_add_u32 s98, s98, s48
s_add_u32 s99, s98, s51
v_exp_f32 v228, v228
v_exp_f32 v229, v229
v_exp_f32 v230, v230
v_exp_f32 v231, v231
v_cvt_pk_bf16_f32 v114, v228, v229
v_cvt_pk_bf16_f32 v115, v230, v231
v_mfma_f32_16x16x32_bf16 v[228:231], a[64:67], v[224:227], 0
v_exp_f32 v232, v232
v_mfma_f32_16x16x32_bf16 v[228:231], a[68:71], v[200:203], v[228:231]
v_exp_f32 v233, v233
v_mfma_f32_16x16x32_bf16 v[228:231], a[72:75], v[196:199], v[228:231]
s_waitcnt lgkmcnt(3)
v_exp_f32 v234, v234
v_mfma_f32_16x16x32_bf16 v[228:231], a[76:79], v[208:211], v[228:231]
s_waitcnt lgkmcnt(2)
v_exp_f32 v235, v235
v_cvt_pk_bf16_f32 v116, v232, v233
v_cvt_pk_bf16_f32 v117, v234, v235
v_mfma_f32_16x16x32_bf16 v[232:235], a[92:95], v[208:211], 0
s_waitcnt lgkmcnt(1)
s_nop 0
v_mfma_f32_16x16x32_bf16 v[232:235], a[88:91], v[196:199], v[232:235]
s_waitcnt lgkmcnt(0)
v_cvt_pk_bf16_f32 v24, v228, v229
v_cvt_pk_bf16_f32 v25, v230, v231
v_mfma_f32_16x16x32_bf16 v[232:235], a[84:87], v[200:203], v[232:235]
v_mfma_f32_16x16x32_bf16 v[232:235], a[80:83], v[224:227], v[232:235]
s_nop 2
v_mfma_f32_16x16x32_bf16 v[228:231], a[96:99], v[224:227], 0
s_nop 2
v_mfma_f32_16x16x32_bf16 v[228:231], a[100:103], v[200:203], v[228:231]
v_cvt_pk_bf16_f32 v26, v232, v233
v_cvt_pk_bf16_f32 v27, v234, v235
v_mfma_f32_16x16x32_bf16 v[228:231], a[104:107], v[196:199], v[228:231]
v_mfma_f32_16x16x32_bf16 v[228:231], a[108:111], v[208:211], v[228:231]
s_nop 2
v_mfma_f32_16x16x32_bf16 v[232:235], a[124:127], v[208:211], 0
s_nop 2
v_mfma_f32_16x16x32_bf16 v[232:235], a[116:119], v[200:203], v[232:235]
buffer_load_dwordx4 v241, s[16:19], s100 offen offset:2112 nt lds
v_mfma_f32_16x16x32_bf16 v[232:235], a[112:115], v[224:227], v[232:235]
buffer_load_dwordx4 v241, s[16:19], s101 offen offset:3168 nt lds
v_mfma_f32_16x16x32_bf16 v[232:235], a[120:123], v[196:199], v[232:235]
s_add_u32 m0, s49, 8448
ds_read_b128 v[196:199], v240 offset:0
ds_read_b128 v[200:203], v240 offset:256
v_mfma_f32_16x16x32_bf16 v[208:211], a[120:123], v[204:207], 0
s_add_u32 s100, s99, s51
ds_read_b128 v[224:227], v240 offset:512
v_cvt_pk_bf16_f32 v28, v228, v229
v_mfma_f32_16x16x32_bf16 v[208:211], a[124:127], v[212:215], v[208:211]
s_add_u32 s101, s100, s51
v_cvt_pk_bf16_f32 v30, v232, v233
v_cvt_pk_bf16_f32 v31, v234, v235
v_mfma_f32_16x16x32_bf16 v[208:211], a[116:119], v[216:219], v[208:211]
v_cvt_pk_bf16_f32 v29, v230, v231
v_mfma_f32_16x16x32_bf16 v[208:211], a[112:115], v[220:223], v[208:211]
ds_read_b128 v[228:231], v240 offset:768
s_nop 0
v_mfma_f32_16x16x32_bf16 v[232:235], a[96:99], v[220:223], 0
s_nop 2
v_mfma_f32_16x16x32_bf16 v[232:235], a[100:103], v[216:219], v[232:235]
s_nop 0
v_cvt_pk_bf16_f32 v38, v208, v209
v_cvt_pk_bf16_f32 v39, v210, v211
v_mfma_f32_16x16x32_bf16 v[232:235], a[104:107], v[204:207], v[232:235]
v_mfma_f32_16x16x32_bf16 v[232:235], a[108:111], v[212:215], v[232:235]
s_nop 2
v_mfma_f32_16x16x32_bf16 v[208:211], a[92:95], v[212:215], 0
s_nop 2
v_mfma_f32_16x16x32_bf16 v[208:211], a[88:91], v[204:207], v[208:211]
v_cvt_pk_bf16_f32 v36, v232, v233
v_cvt_pk_bf16_f32 v37, v234, v235
v_mfma_f32_16x16x32_bf16 v[208:211], a[84:87], v[216:219], v[208:211]
v_mfma_f32_16x16x32_bf16 v[208:211], a[80:83], v[220:223], v[208:211]
s_nop 2
v_mfma_f32_16x16x32_bf16 v[232:235], a[64:67], v[220:223], 0
s_waitcnt lgkmcnt(2)
s_nop 1
v_mfma_f32_16x16x32_bf16 v[232:235], a[68:71], v[216:219], v[232:235]
buffer_load_dwordx4 v241, s[16:19], s98 offen offset:0 nt lds
v_mfma_f32_16x16x32_bf16 v[232:235], a[72:75], v[204:207], v[232:235]
buffer_load_dwordx4 v241, s[16:19], s99 offen offset:1056 nt lds
v_mfma_f32_16x16x32_bf16 v[232:235], a[76:79], v[212:215], v[232:235]
s_waitcnt lgkmcnt(1)
v_cvt_pk_bf16_f32 v34, v208, v209
v_cvt_pk_bf16_f32 v35, v210, v211
v_mfma_f32_16x16x32_bf16 v[160:163], a[192:195], v[196:199], 0
s_add_u32 s98, s98, s48
s_add_u32 s99, s98, s51
s_nop 0
v_mfma_f32_16x16x32_bf16 v[160:163], a[196:199], v[200:203], v[160:163]
s_waitcnt lgkmcnt(0)
v_cvt_pk_bf16_f32 v32, v232, v233
v_cvt_pk_bf16_f32 v33, v234, v235
v_mfma_f32_16x16x32_bf16 v[160:163], a[200:203], v[224:227], v[160:163]
v_mfma_f32_16x16x32_bf16 v[160:163], a[204:207], v[228:231], v[160:163]
v_mfma_f32_16x16x32_bf16 v[208:211], v[28:31], v[108:111], 0
v_mfma_f32_16x16x32_bf16 v[208:211], v[24:27], v[104:107], v[208:211]
s_nop 2
v_mfma_f32_16x16x32_bf16 v[232:235], v[32:35], v[104:107], 0
s_nop 2
v_mfma_f32_16x16x32_bf16 v[232:235], v[36:39], v[108:111], v[232:235]
v_exp_f32 v208, v208
v_mfma_f32_16x16x32_bf16 v[164:167], a[220:223], v[228:231], 0
v_exp_f32 v209, v209
v_mfma_f32_16x16x32_bf16 v[164:167], a[216:219], v[224:227], v[164:167]
v_exp_f32 v210, v210
v_mfma_f32_16x16x32_bf16 v[164:167], a[212:215], v[200:203], v[164:167]
v_exp_f32 v211, v211
v_mfma_f32_16x16x32_bf16 v[164:167], a[208:211], v[196:199], v[164:167]
v_cvt_pk_bf16_f32 v118, v208, v209
v_cvt_pk_bf16_f32 v119, v210, v211
v_mfma_f32_16x16x32_bf16 v[168:171], a[224:227], v[196:199], 0
v_exp_f32 v232, v232
v_mfma_f32_16x16x32_bf16 v[168:171], a[228:231], v[200:203], v[168:171]
buffer_load_dwordx4 v241, s[16:19], s100 offen offset:2112 nt lds
v_mfma_f32_16x16x32_bf16 v[168:171], a[232:235], v[224:227], v[168:171]
buffer_load_dwordx4 v241, s[16:19], s101 offen offset:3168 nt lds
v_mfma_f32_16x16x32_bf16 v[168:171], a[236:239], v[228:231], v[168:171]
s_add_u32 m0, s49, 16896
v_exp_f32 v233, v233
v_mfma_f32_16x16x32_bf16 v[172:175], a[252:255], v[228:231], 0
s_add_u32 s100, s99, s51
v_exp_f32 v234, v234
v_mfma_f32_16x16x32_bf16 v[172:175], a[248:251], v[224:227], v[172:175]
s_add_u32 s101, s100, s51
v_exp_f32 v235, v235
v_mfma_f32_16x16x32_bf16 v[172:175], a[244:247], v[200:203], v[172:175]
s_and_b32 s51, s57, 13106176
v_cvt_pk_bf16_f32 v120, v232, v233
v_cvt_pk_bf16_f32 v121, v234, v235
v_mfma_f32_16x16x32_bf16 v[172:175], a[240:243], v[196:199], v[172:175]
s_lshl3_add_u32 s48, s51, 8192
s_sub_u32 s49, s49, s56
s_sub_u32 s51, s51, 32
v_mfma_f32_16x16x32_bf16 v[208:211], a[0:3], v[196:199], 0
v_mfma_f32_16x16x32_bf16 v[208:211], a[4:7], v[200:203], v[208:211]
v_mfma_f32_16x16x32_bf16 v[208:211], a[8:11], v[224:227], v[208:211]
v_mfma_f32_16x16x32_bf16 v[208:211], a[12:15], v[228:231], v[208:211]
s_nop 2
v_mfma_f32_16x16x32_bf16 v[232:235], a[28:31], v[228:231], 0
s_nop 2
v_mfma_f32_16x16x32_bf16 v[232:235], a[24:27], v[224:227], v[232:235]
v_cvt_pk_bf16_f32 v104, v208, v209
v_cvt_pk_bf16_f32 v105, v210, v211
v_mfma_f32_16x16x32_bf16 v[232:235], a[20:23], v[200:203], v[232:235]
v_mfma_f32_16x16x32_bf16 v[232:235], a[16:19], v[196:199], v[232:235]
s_nop 2
v_mfma_f32_16x16x32_bf16 v[208:211], a[32:35], v[196:199], 0
s_nop 2
v_mfma_f32_16x16x32_bf16 v[208:211], a[36:39], v[200:203], v[208:211]
buffer_load_dwordx4 v241, s[16:19], s98 offen offset:0 nt lds
v_mfma_f32_16x16x32_bf16 v[208:211], a[40:43], v[224:227], v[208:211]
buffer_load_dwordx4 v241, s[16:19], s99 offen offset:1056 nt lds
v_mfma_f32_16x16x32_bf16 v[208:211], a[44:47], v[228:231], v[208:211]
v_cvt_pk_bf16_f32 v106, v232, v233
v_cvt_pk_bf16_f32 v107, v234, v235
v_mfma_f32_16x16x32_bf16 v[232:235], a[60:63], v[228:231], 0
ds_read_b128 v[228:231], v245 offset:0
v_add_u32 v245, 1600, v245
v_mfma_f32_16x16x32_bf16 v[232:235], a[56:59], v[224:227], v[232:235]
s_nop 1
v_cvt_pk_bf16_f32 v108, v208, v209
v_mfma_f32_16x16x32_bf16 v[232:235], a[52:55], v[200:203], v[232:235]
v_cvt_pk_bf16_f32 v109, v210, v211
v_mov_b64 v[200:201], s[96:97]
v_mfma_f32_16x16x32_bf16 v[232:235], a[48:51], v[196:199], v[232:235]
v_mov_b64 v[202:203], s[96:97]
s_nop 0
v_mfma_f32_16x16x32_bf16 v[196:199], v[220:223], a[128:131], 0
s_nop 2
v_mfma_f32_16x16x32_bf16 v[196:199], v[216:219], a[132:135], v[196:199]
s_nop 0
v_cvt_pk_bf16_f32 v110, v232, v233
v_cvt_pk_bf16_f32 v111, v234, v235
v_mfma_f32_16x16x32_bf16 v[196:199], v[204:207], a[136:139], v[196:199]
v_mfma_f32_16x16x32_bf16 v[196:199], v[212:215], a[140:143], v[196:199]
s_nop 2
v_smfmac_f32_16x16x64_bf16 v[200:203], v[96:99], v[104:111], v250
s_nop 2
v_mfma_f32_16x16x32_bf16 v[208:211], v[0:3], v[104:107], 0
v_cvt_pk_bf16_f32 v80, v196, v197
v_cvt_pk_bf16_f32 v81, v198, v199
v_mfma_f32_16x16x32_bf16 v[208:211], v[4:7], v[108:111], v[208:211]
v_mov_b64 v[176:177], 0
v_mov_b64 v[178:179], 0
v_mfma_f32_16x16x32_bf16 v[196:199], v[12:15], v[108:111], 0
v_mov_b64 v[180:181], 0
v_mov_b64 v[182:183], 0
v_mfma_f32_16x16x32_bf16 v[196:199], v[8:11], v[104:107], v[196:199]
v_mov_b64 v[184:185], 0
v_mov_b64 v[186:187], 0
v_mfma_f32_16x16x32_bf16 v[224:227], v[212:215], a[156:159], 0
buffer_load_dwordx4 v241, s[16:19], s100 offen offset:2112 nt lds
v_mfma_f32_16x16x32_bf16 v[224:227], v[204:207], a[152:155], v[224:227]
buffer_load_dwordx4 v241, s[16:19], s101 offen offset:3168 nt lds
v_mfma_f32_16x16x32_bf16 v[224:227], v[216:219], a[148:151], v[224:227]
s_waitcnt lgkmcnt(0)
v_add_f32 v200, v200, v201
v_add_f32 v202, v202, v203
v_mfma_f32_16x16x32_bf16 v[224:227], v[220:223], a[144:147], v[224:227]
v_exp_f32 v200, v200
v_smfmac_f32_16x16x64_bf16 v[176:179], v[228:231], v[0:7], v250
s_nop 2
v_smfmac_f32_16x16x64_bf16 v[180:183], v[228:231], v[16:23], v250
s_nop 1
v_cvt_pk_bf16_f32 v84, v224, v225
v_smfmac_f32_16x16x64_bf16 v[184:187], v[228:231], v[32:39], v250
v_cvt_pk_bf16_f32 v85, v226, v227
v_mfma_f32_16x16x32_bf16 v[224:227], v[220:223], a[160:163], 0
v_exp_f32 v202, v202
v_mfma_f32_16x16x32_bf16 v[224:227], v[216:219], a[164:167], v[224:227]
v_perm_b32 v140, v202, v200, v251
v_perm_b32 v141, v202, v200, v252
v_mfma_f32_16x16x32_bf16 v[224:227], v[204:207], a[168:171], v[224:227]
v_exp_f32 v196, v196
v_mfma_f32_16x16x32_bf16 v[224:227], v[212:215], a[172:175], v[224:227]
v_exp_f32 v197, v197
v_smfmac_f32_16x16x64_bf16 v[178:181], v[228:231], v[8:15], v250
v_mov_b64 v[200:201], 0
v_smfmac_f32_16x16x64_bf16 v[182:185], v[228:231], v[24:31], v250
v_cvt_pk_bf16_f32 v130, v196, v197
v_smfmac_f32_16x16x64_bf16 v[186:189], v[228:231], v[40:47], v250
ds_read_b128 v[228:231], v240 offset:12672
v_add_f32 v176, v176, v177
v_mfma_f32_16x16x32_bf16 v[232:235], v[212:215], a[188:191], 0
v_exp_f32 v198, v198
v_mfma_f32_16x16x32_bf16 v[232:235], v[204:207], a[184:187], v[232:235]
v_exp_f32 v199, v199
v_mfma_f32_16x16x32_bf16 v[232:235], v[216:219], a[180:183], v[232:235]
v_cvt_pk_bf16_f32 v131, v198, v199
v_cvt_pk_bf16_f32 v88, v224, v225
v_mfma_f32_16x16x32_bf16 v[232:235], v[220:223], a[176:179], v[232:235]
v_cvt_pk_bf16_f32 v89, v226, v227
v_add_f32 v178, v178, v179
v_smfmac_f32_16x16x64_bf16 v[200:203], v[192:195], v[112:119], v250
ds_read_b128 v[224:227], v240 offset:12928
v_add_f32 v180, v180, v181
v_smfmac_f32_16x16x64_bf16 v[200:203], v[192:195], v[120:127], v250 abid:1
v_exp_f32 v208, v208
v_exp_f32 v209, v209
v_exp_f32 v210, v210
v_exp_f32 v211, v211
v_cvt_pk_bf16_f32 v128, v208, v209
s_nop 2
v_add_f32 v200, v200, v201
v_rcp_f32 v253, v200
s_nop 0
v_max3_f32 v254, v254, v200, v253
v_mfma_f32_16x16x32_bf16 v[200:203], v[20:23], v[108:111], 0
v_cvt_pk_bf16_f32 v129, v210, v211
v_cvt_pk_bf16_f32 v92, v232, v233
v_mfma_f32_16x16x32_bf16 v[200:203], v[16:19], v[104:107], v[200:203]
ds_read_b128 v[208:211], v240 offset:13184
v_cvt_pk_bf16_f32 v93, v234, v235
v_mfma_f32_16x16x32_bf16 v[196:199], v[24:27], v[104:107], 0
s_waitcnt lgkmcnt(2)
ds_read_b128 v[232:235], v240 offset:13440
v_add_f32 v182, v182, v183
v_mfma_f32_16x16x32_bf16 v[196:199], v[28:31], v[108:111], v[196:199]
s_waitcnt lgkmcnt(2)
v_exp_f32 v200, v200
v_exp_f32 v201, v201
v_exp_f32 v202, v202
v_exp_f32 v203, v203
v_cvt_pk_bf16_f32 v132, v200, v201
v_cvt_pk_bf16_f32 v133, v202, v203
v_mfma_f32_16x16x32_bf16 v[200:203], v[228:231], a[128:131], 0
v_exp_f32 v196, v196
v_mfma_f32_16x16x32_bf16 v[200:203], v[224:227], a[132:135], v[200:203]
s_waitcnt lgkmcnt(1)
v_exp_f32 v197, v197
v_mfma_f32_16x16x32_bf16 v[200:203], v[208:211], a[136:139], v[200:203]
s_waitcnt lgkmcnt(0)
v_exp_f32 v198, v198
v_mfma_f32_16x16x32_bf16 v[200:203], v[232:235], a[140:143], v[200:203]
v_exp_f32 v199, v199
v_cvt_pk_bf16_f32 v134, v196, v197
v_cvt_pk_bf16_f32 v135, v198, v199
v_mfma_f32_16x16x32_bf16 v[196:199], v[232:235], a[156:159], 0
v_exp_f32 v176, v176
v_mfma_f32_16x16x32_bf16 v[196:199], v[208:211], a[152:155], v[196:199]
v_exp_f32 v178, v178
v_mfma_f32_16x16x32_bf16 v[196:199], v[224:227], a[148:151], v[196:199]
v_cvt_pk_bf16_f32 v66, v200, v201
v_cvt_pk_bf16_f32 v67, v202, v203
v_mfma_f32_16x16x32_bf16 v[196:199], v[228:231], a[144:147], v[196:199]
v_exp_f32 v180, v180
v_mfma_f32_16x16x32_bf16 v[200:203], v[228:231], a[160:163], 0
v_exp_f32 v182, v182
v_mfma_f32_16x16x32_bf16 v[200:203], v[224:227], a[164:167], v[200:203]
v_add_f32 v184, v184, v185
v_add_f32 v186, v186, v187
v_mfma_f32_16x16x32_bf16 v[200:203], v[208:211], a[168:171], v[200:203]
s_nop 0
v_cvt_pk_bf16_f32 v70, v196, v197
v_cvt_pk_bf16_f32 v71, v198, v199
v_mfma_f32_16x16x32_bf16 v[200:203], v[232:235], a[172:175], v[200:203]
v_exp_f32 v184, v184
v_mfma_f32_16x16x32_bf16 v[196:199], v[232:235], a[188:191], 0
ds_read_b128 v[232:235], v240 offset:4224
v_add_f32 v188, v176, v178
v_mfma_f32_16x16x32_bf16 v[196:199], v[208:211], a[184:187], v[196:199]
ds_read_b128 v[208:211], v240 offset:4480
v_add_f32 v188, v188, v180
v_mfma_f32_16x16x32_bf16 v[196:199], v[224:227], a[180:183], v[196:199]
ds_read_b128 v[224:227], v240 offset:4736
v_add_f32 v188, v188, v182
v_mfma_f32_16x16x32_bf16 v[196:199], v[228:231], a[176:179], v[196:199]
v_exp_f32 v186, v186
v_add_f32 v188, v188, v184
v_add_f32 v188, v188, v186
v_cvt_pk_bf16_f32 v177, v176, v178
v_cvt_pk_bf16_f32 v181, v180, v182
v_add_f32_dpp v188, v188, v188 row_ror:8 row_mask:0xf bank_mask:0xf
v_cvt_pk_bf16_f32 v185, v184, v186
s_nop 0
v_add_f32_dpp v188, v188, v188 row_ror:4 row_mask:0xf bank_mask:0xf
ds_write_b16 v246, v177 offset:0
ds_write_b16_d16_hi v246, v177 offset:4
ds_write_b16 v246, v181 offset:272
ds_write_b16_d16_hi v246, v181 offset:276
ds_write_b16 v246, v185 offset:544
ds_write_b32 v249, v188 offset:0
ds_write_b16_d16_hi v246, v185 offset:548
v_cvt_pk_bf16_f32 v78, v196, v197
v_cvt_pk_bf16_f32 v79, v198, v199
v_mfma_f32_32x32x16_bf16 v[176:191], v[100:103], v[124:127], 0
ds_read_b128 v[236:239], v247 offset:544
v_cvt_pk_bf16_f32 v74, v200, v201
v_cvt_pk_bf16_f32 v75, v202, v203
v_add_u32 v249, 1600, v249
v_mfma_f32_16x16x32_bf16 v[196:199], v[32:35], v[104:107], 0
s_waitcnt lgkmcnt(10)
ds_read_b128 v[200:203], v240 offset:4992
v_mfma_f32_16x16x32_bf16 v[196:199], v[36:39], v[108:111], v[196:199]
s_waitcnt lgkmcnt(10)
s_nop 1
v_mfma_f32_16x16x32_bf16 v[228:231], v[232:235], a[128:131], 0
s_waitcnt lgkmcnt(9)
s_nop 1
v_mfma_f32_16x16x32_bf16 v[228:231], v[208:211], a[132:135], v[228:231]
v_exp_f32 v196, v196
v_mfma_f32_16x16x32_bf16 v[228:231], v[224:227], a[136:139], v[228:231]
v_exp_f32 v197, v197
v_exp_f32 v198, v198
v_cvt_pk_bf16_f32 v136, v196, v197
s_waitcnt lgkmcnt(0)
v_mfma_f32_16x16x32_bf16 v[228:231], v[200:203], a[140:143], v[228:231]
v_exp_f32 v199, v199
s_nop 0
v_cvt_pk_bf16_f32 v137, v198, v199
v_mfma_f32_16x16x32_bf16 v[196:199], v[200:203], a[156:159], 0
s_nop 2
v_mfma_f32_16x16x32_bf16 v[196:199], v[224:227], a[152:155], v[196:199]
v_cvt_pk_bf16_f32 v50, v228, v229
v_cvt_pk_bf16_f32 v51, v230, v231
v_mfma_f32_16x16x32_bf16 v[196:199], v[208:211], a[148:151], v[196:199]
v_mfma_f32_16x16x32_bf16 v[196:199], v[232:235], a[144:147], v[196:199]
s_nop 2
v_mfma_f32_16x16x32_bf16 v[228:231], v[232:235], a[160:163], 0
s_nop 2
v_mfma_f32_16x16x32_bf16 v[228:231], v[208:211], a[164:167], v[228:231]
v_cvt_pk_bf16_f32 v54, v196, v197
v_cvt_pk_bf16_f32 v55, v198, v199
v_mfma_f32_16x16x32_bf16 v[228:231], v[224:227], a[168:171], v[228:231]
v_mfma_f32_16x16x32_bf16 v[228:231], v[200:203], a[172:175], v[228:231]
s_nop 2
v_mfma_f32_16x16x32_bf16 v[196:199], v[200:203], a[188:191], 0
s_nop 2
v_mfma_f32_16x16x32_bf16 v[196:199], v[224:227], a[184:187], v[196:199]
v_cvt_pk_bf16_f32 v58, v228, v229
v_cvt_pk_bf16_f32 v59, v230, v231
v_mfma_f32_16x16x32_bf16 v[196:199], v[208:211], a[180:183], v[196:199]
ds_read_b128 v[228:231], v247 offset:272
v_mfma_f32_16x16x32_bf16 v[196:199], v[232:235], a[176:179], v[196:199]
s_nop 2
v_mfma_f32_16x16x32_bf16 v[200:203], v[40:43], v[104:107], 0
s_nop 2
v_mfma_f32_16x16x32_bf16 v[200:203], v[44:47], v[108:111], v[200:203]
v_cvt_pk_bf16_f32 v62, v196, v197
v_cvt_pk_bf16_f32 v63, v198, v199
v_mfma_f32_16x16x32_bf16 v[176:179], v[48:51], v[112:115], v[176:179]
v_mov_b64 v[196:197], 0
v_mov_b64 v[198:199], 0
v_mfma_f32_16x16x32_bf16 v[176:179], v[64:67], v[116:119], v[176:179]
s_nop 0
v_mfma_f32_16x16x32_bf16 v[176:179], v[80:83], v[120:123], v[176:179]
v_exp_f32 v200, v200
v_mfma_f32_16x16x32_bf16 v[180:183], v[84:87], v[120:123], v[180:183]
v_exp_f32 v201, v201
v_mfma_f32_16x16x32_bf16 v[180:183], v[52:55], v[112:115], v[180:183]
v_exp_f32 v202, v202
v_mfma_f32_16x16x32_bf16 v[180:183], v[68:71], v[116:119], v[180:183]
v_exp_f32 v203, v203
v_mfma_f32_16x16x32_bf16 v[184:187], v[72:75], v[116:119], v[184:187]
v_fmac_f32 v144, v176, v253
v_fmac_f32 v145, v177, v253
v_mfma_f32_16x16x32_bf16 v[184:187], v[88:91], v[120:123], v[184:187]
v_cvt_pk_bf16_f32 v144, v144, v145
v_fmac_f32 v146, v178, v253
v_mfma_f32_16x16x32_bf16 v[184:187], v[56:59], v[112:115], v[184:187]
v_fmac_f32 v149, v181, v253
v_cvt_pk_bf16_f32 v138, v200, v201
v_mfma_f32_16x16x32_bf16 v[188:191], v[60:63], v[112:115], v[188:191]
s_waitcnt lgkmcnt(0)
v_cvt_pk_bf16_f32 v139, v202, v203
v_fmac_f32 v147, v179, v253
v_mfma_f32_16x16x32_bf16 v[188:191], v[76:79], v[116:119], v[188:191]
s_nop 0
v_fmac_f32 v152, v184, v253
v_fmac_f32 v155, v187, v253
v_mfma_f32_16x16x32_bf16 v[188:191], v[92:95], v[120:123], v[188:191]
v_fmac_f32 v154, v186, v253
v_fmac_f32 v153, v185, v253
v_mfma_f32_16x16x32_bf16 v[208:211], a[0:3], v[220:223], 0
v_cvt_pk_bf16_f32 v152, v152, v153
v_cvt_pk_bf16_f32 v153, v154, v155
v_mfma_f32_16x16x32_bf16 v[208:211], a[4:7], v[216:219], v[208:211]
v_pk_max_i16 v152, v152, 0
v_pk_max_i16 v153, v153, 0
v_mfma_f32_16x16x32_bf16 v[208:211], a[8:11], v[204:207], v[208:211]
v_fmac_f32 v157, v189, v253
v_fmac_f32 v158, v190, v253
v_mfma_f32_16x16x32_bf16 v[208:211], a[12:15], v[212:215], v[208:211]
v_fmac_f32 v156, v188, v253
v_cvt_pk_bf16_f32 v154, v156, v157
v_mfma_f32_16x16x32_bf16 v[224:227], a[28:31], v[212:215], 0
v_fmac_f32 v159, v191, v253
v_cvt_pk_bf16_f32 v155, v158, v159
v_mfma_f32_16x16x32_bf16 v[224:227], a[24:27], v[204:207], v[224:227]
v_pk_max_i16 v155, v155, 0
v_cvt_pk_bf16_f32 v145, v146, v147
v_mfma_f32_16x16x32_bf16 v[224:227], a[20:23], v[216:219], v[224:227]
v_cvt_pk_bf16_f32 v105, v210, v211
v_cvt_pk_bf16_f32 v104, v208, v209
v_mfma_f32_16x16x32_bf16 v[224:227], a[16:19], v[220:223], v[224:227]
ds_read_b128 v[208:211], v247 offset:0
v_fmac_f32 v151, v183, v253
v_mfma_f32_16x16x32_bf16 v[232:235], a[32:35], v[220:223], 0
v_fmac_f32 v150, v182, v253
v_cvt_pk_bf16_f32 v147, v150, v151
v_mfma_f32_16x16x32_bf16 v[232:235], a[36:39], v[216:219], v[232:235]
v_fmac_f32 v148, v180, v253
v_cvt_pk_bf16_f32 v146, v148, v149
v_mfma_f32_16x16x32_bf16 v[232:235], a[40:43], v[204:207], v[232:235]
v_cvt_pk_bf16_f32 v106, v224, v225
v_cvt_pk_bf16_f32 v107, v226, v227
v_mfma_f32_16x16x32_bf16 v[232:235], a[44:47], v[212:215], v[232:235]
s_nop 2
v_mfma_f32_16x16x32_bf16 v[224:227], a[60:63], v[212:215], 0
s_nop 2
v_mfma_f32_16x16x32_bf16 v[224:227], a[56:59], v[204:207], v[224:227]
v_cvt_pk_bf16_f32 v108, v232, v233
v_mov_b64 v[232:233], 0
v_mfma_f32_16x16x32_bf16 v[224:227], a[52:55], v[216:219], v[224:227]
s_waitcnt lgkmcnt(0)
v_cvt_pk_bf16_f32 v109, v234, v235
v_mov_b64 v[234:235], 0
v_mfma_f32_16x16x32_bf16 v[224:227], a[48:51], v[220:223], v[224:227]
s_nop 2
v_smfmac_f32_16x16x64_bf16 v[196:199], v[208:211], v[48:55], v250
s_nop 2
v_smfmac_f32_16x16x64_bf16 v[196:199], v[228:231], v[64:71], v250
v_cvt_pk_bf16_f32 v110, v224, v225
v_smfmac_f32_16x16x64_bf16 v[196:199], v[236:239], v[80:87], v250
v_cvt_pk_bf16_f32 v111, v226, v227
v_smfmac_f32_16x16x64_bf16 v[232:235], v[236:239], v[88:95], v250
v_mov_b64 v[226:227], s[96:97]
v_smfmac_f32_16x16x64_bf16 v[232:235], v[228:231], v[72:79], v250
v_mov_b64 v[224:225], s[96:97]
v_smfmac_f32_16x16x64_bf16 v[232:235], v[208:211], v[56:63], v250
s_nop 1
v_add_f32 v196, v196, v197
v_smfmac_f32_16x16x64_bf16 v[224:227], v[96:99], v[104:111], v250
v_add_f32 v198, v198, v199
v_mfma_f32_16x16x32_bf16 v[208:211], v[0:3], v[104:107], 0
ds_write2_b32 v248, v196, v198 offset0:0 offset1:16
v_mfma_f32_16x16x32_bf16 v[208:211], v[4:7], v[108:111], v[208:211]
s_nop 7
s_waitcnt lgkmcnt(0)
s_branch L_entryf
L_spin:
ds_read_u16 v196, v255 offset:0
s_waitcnt lgkmcnt(0)
v_cmp_lt_u32 vcc, s45, v196
s_nop 1
s_cbranch_vccnz L_spin
s_branch L_back
.p2align 6
L_loopf:
buffer_store_dwordx4 v[168:171], v242, s[20:23], s53 offen offset:64 nt
v_exp_f32 v198, v198
v_exp_f32 v199, v199
v_mfma_f32_16x16x32_bf16 v[220:223], a[60:63], v[216:219], 0
s_add_u32 s52, s47, 8192
v_cvt_pk_bf16_f32 v108, v236, v237
v_cvt_pk_bf16_f32 v109, v238, v239
v_mfma_f32_16x16x32_bf16 v[220:223], a[56:59], v[228:231], v[220:223]
s_add_u32 s53, s47, 12288
v_exp_f32 v209, v209
v_mfma_f32_16x16x32_bf16 v[220:223], a[52:55], v[212:215], v[220:223]
s_bfe_i32 s57, s3, 0x10000
v_exp_f32 v210, v210
v_mfma_f32_16x16x32_bf16 v[220:223], a[48:51], v[224:227], v[220:223]
s_and_b32 s54, s57, s5
v_exp_f32 v211, v211
v_mfma_f32_16x16x32_bf16 v[160:163], a[192:195], v[224:227], 0
s_lshr_b32 s3, s3, 1
v_exp_f32 v208, v208
v_mfma_f32_16x16x32_bf16 v[160:163], a[196:199], v[212:215], v[160:163]
s_mov_b32 s47, s46
v_cvt_pk_bf16_f32 v114, v208, v209
v_cvt_pk_bf16_f32 v111, v222, v223
v_mfma_f32_16x16x32_bf16 v[160:163], a[200:203], v[228:231], v[160:163]
ds_read_u16 v196, v255 offset:0
v_cvt_pk_bf16_f32 v110, v220, v221
v_mfma_f32_16x16x32_bf16 v[160:163], a[204:207], v[216:219], v[160:163]
v_cvt_pk_bf16_f32 v115, v210, v211
v_mov_b64 v[208:209], s[96:97]
v_mfma_f32_16x16x32_bf16 v[164:167], a[220:223], v[216:219], 0
v_mov_b64 v[210:211], s[96:97]
v_cvt_pk_bf16_f32 v121, v198, v199
v_mfma_f32_16x16x32_bf16 v[164:167], a[216:219], v[228:231], v[164:167]
v_exp_f32 v206, v206
v_mfma_f32_16x16x32_bf16 v[164:167], a[212:215], v[212:215], v[164:167]
v_exp_f32 v207, v207
v_mfma_f32_16x16x32_bf16 v[164:167], a[208:211], v[224:227], v[164:167]
v_exp_f32 v204, v204
v_mfma_f32_16x16x32_bf16 v[168:171], a[224:227], v[224:227], 0
s_waitcnt lgkmcnt(0)
v_cmp_lt_u32 vcc, s45, v196
v_cvt_pk_bf16_f32 v113, v206, v207
v_mfma_f32_16x16x32_bf16 v[168:171], a[228:231], v[212:215], v[168:171]
s_cbranch_vccnz L_spin
L_back:
ds_read_b128 v[196:199], v240 offset:0
ds_read_b128 v[220:223], v240 offset:256
v_mfma_f32_16x16x32_bf16 v[168:171], a[232:235], v[228:231], v[168:171]
s_mov_b32 s98, s50
ds_read_b128 v[236:239], v240 offset:512
s_add_u32 s99, s98, s51
v_mfma_f32_16x16x32_bf16 v[168:171], a[236:239], v[216:219], v[168:171]
s_add_u32 s100, s99, s51
v_exp_f32 v205, v205
v_mfma_f32_16x16x32_bf16 v[172:175], a[252:255], v[216:219], 0
s_add_u32 s101, s100, s51
v_cvt_pk_bf16_f32 v112, v204, v205
s_add_u32 m0, s49, 0
v_mfma_f32_16x16x32_bf16 v[172:175], a[248:251], v[228:231], v[172:175]
s_sub_u32 s45, s45, 1
v_exp_f32 v200, v200
v_mfma_f32_16x16x32_bf16 v[172:175], a[244:247], v[212:215], v[172:175]
s_add_u32 s50, s50, 13107200
v_exp_f32 v201, v201
v_mfma_f32_16x16x32_bf16 v[172:175], a[240:243], v[224:227], v[172:175]
s_waitcnt lgkmcnt(2)
v_exp_f32 v202, v202
v_smfmac_f32_16x16x64_bf16 v[208:211], v[96:99], v[104:111], v250
s_sub_u32 s50, s50, s54
ds_read_b128 v[96:99], v243 offset:0
v_cvt_pk_bf16_f32 v118, v200, v201
v_mfma_f32_16x16x32_bf16 v[212:215], v[0:3], v[104:107], 0
v_exp_f32 v203, v203
v_mfma_f32_16x16x32_bf16 v[212:215], v[4:7], v[108:111], v[212:215]
v_cvt_pk_bf16_f32 v119, v202, v203
v_add_u32 v243, 1600, v243
v_mfma_f32_16x16x32_bf16 v[204:207], v[12:15], v[108:111], 0
ds_read_b128 v[200:203], v240 offset:768
v_add_f32 v210, v210, v211
v_mfma_f32_16x16x32_bf16 v[204:207], v[8:11], v[104:107], v[204:207]
s_waitcnt lgkmcnt(3)
v_exp_f32 v234, v234
v_mfma_f32_16x16x32_bf16 v[216:219], a[64:67], v[196:199], 0
s_waitcnt lgkmcnt(2)
v_exp_f32 v233, v233
v_mfma_f32_16x16x32_bf16 v[216:219], a[68:71], v[220:223], v[216:219]
v_mov_b64 v[224:225], 0
v_add_f32 v208, v208, v209
v_mfma_f32_16x16x32_bf16 v[216:219], a[72:75], v[236:239], v[216:219]
v_exp_f32 v235, v235
v_exp_f32 v232, v232
v_cvt_pk_bf16_f32 v123, v234, v235
s_waitcnt lgkmcnt(0)
v_mfma_f32_16x16x32_bf16 v[216:219], a[76:79], v[200:203], v[216:219]
buffer_load_dwordx4 v241, s[16:19], s98 offen offset:0 nt lds
v_mfma_f32_16x16x32_bf16 v[228:231], a[92:95], v[200:203], 0
buffer_load_dwordx4 v241, s[16:19], s99 offen offset:1056 nt lds
v_mfma_f32_16x16x32_bf16 v[228:231], a[88:91], v[236:239], v[228:231]
s_add_u32 s98, s98, s48
v_cvt_pk_bf16_f32 v122, v232, v233
s_add_u32 s99, s98, s51
v_mfma_f32_16x16x32_bf16 v[228:231], a[84:87], v[220:223], v[228:231]
v_exp_f32 v205, v205
v_mfma_f32_16x16x32_bf16 v[228:231], a[80:83], v[196:199], v[228:231]
v_exp_f32 v206, v206
v_smfmac_f32_16x16x64_bf16 v[224:227], v[192:195], v[112:119], v250
v_cvt_pk_bf16_f32 v0, v216, v217
v_smfmac_f32_16x16x64_bf16 v[224:227], v[192:195], v[120:127], v250 abid:1
v_cvt_pk_bf16_f32 v1, v218, v219
v_mfma_f32_16x16x32_bf16 v[232:235], a[96:99], v[196:199], 0
ds_read_b128 v[216:219], v240 offset:4224
s_nop 0
v_mfma_f32_16x16x32_bf16 v[232:235], a[100:103], v[220:223], v[232:235]
v_exp_f32 v207, v207
v_mfma_f32_16x16x32_bf16 v[232:235], a[104:107], v[236:239], v[232:235]
v_cvt_pk_bf16_f32 v131, v206, v207
v_add_f32 v224, v224, v225
v_mfma_f32_16x16x32_bf16 v[232:235], a[108:111], v[200:203], v[232:235]
v_exp_f32 v204, v204
s_nop 0
v_cvt_pk_bf16_f32 v130, v204, v205
v_mfma_f32_16x16x32_bf16 v[204:207], a[124:127], v[200:203], 0
ds_read_b128 v[200:203], v240 offset:4736
v_cvt_pk_bf16_f32 v2, v228, v229
v_mfma_f32_16x16x32_bf16 v[204:207], a[120:123], v[236:239], v[204:207]
v_exp_f32 v210, v210
v_mfma_f32_16x16x32_bf16 v[204:207], a[116:119], v[220:223], v[204:207]
v_exp_f32 v208, v208
v_mfma_f32_16x16x32_bf16 v[204:207], a[112:115], v[196:199], v[204:207]
v_perm_b32 v141, v210, v208, v252
v_perm_b32 v140, v210, v208, v251
v_mfma_f32_16x16x32_bf16 v[176:179], v[48:51], v[112:115], v[176:179]
ds_read_b128 v[208:211], v240 offset:4992
v_cvt_pk_bf16_f32 v3, v230, v231
v_mfma_f32_16x16x32_bf16 v[176:179], v[64:67], v[116:119], v[176:179]
ds_read_b128 v[228:231], v240 offset:4480
v_cvt_pk_bf16_f32 v5, v234, v235
v_mfma_f32_16x16x32_bf16 v[176:179], v[80:83], v[120:123], v[176:179]
v_cvt_pk_bf16_f32 v7, v206, v207
v_cvt_pk_bf16_f32 v6, v204, v205
v_mfma_f32_16x16x32_bf16 v[180:183], v[84:87], v[120:123], v[180:183]
v_exp_f32 v214, v214
v_mfma_f32_16x16x32_bf16 v[180:183], v[52:55], v[112:115], v[180:183]
v_exp_f32 v215, v215
v_mfma_f32_16x16x32_bf16 v[180:183], v[68:71], v[116:119], v[180:183]
s_waitcnt lgkmcnt(3)
v_exp_f32 v212, v212
v_mfma_f32_16x16x32_bf16 v[184:187], v[72:75], v[116:119], v[184:187]
v_exp_f32 v213, v213
v_mfma_f32_16x16x32_bf16 v[184:187], v[88:91], v[120:123], v[184:187]
v_cvt_pk_bf16_f32 v128, v212, v213
v_cvt_pk_bf16_f32 v129, v214, v215
v_mfma_f32_16x16x32_bf16 v[184:187], v[56:59], v[112:115], v[184:187]
v_cvt_pk_bf16_f32 v4, v232, v233
v_mfma_f32_16x16x32_bf16 v[188:191], v[60:63], v[112:115], v[188:191]
s_waitcnt lgkmcnt(2)
v_rcp_f32 v253, v224
v_mfma_f32_16x16x32_bf16 v[188:191], v[76:79], v[116:119], v[188:191]
v_fmac_f32 v149, v181, v253
v_fmac_f32 v150, v182, v253
v_mfma_f32_16x16x32_bf16 v[188:191], v[92:95], v[120:123], v[188:191]
v_fmac_f32 v155, v187, v253
v_fmac_f32 v152, v184, v253
v_mfma_f32_16x16x32_bf16 v[196:199], v[16:19], v[104:107], 0
v_fmac_f32 v153, v185, v253
v_cvt_pk_bf16_f32 v152, v152, v153
v_mfma_f32_16x16x32_bf16 v[196:199], v[20:23], v[108:111], v[196:199]
s_waitcnt lgkmcnt(1)
v_max3_f32 v254, v254, v224, v253
v_fmac_f32 v156, v188, v253
v_mfma_f32_16x16x32_bf16 v[204:207], v[28:31], v[108:111], 0
s_waitcnt lgkmcnt(0)
v_fmac_f32 v159, v191, v253
v_fmac_f32 v146, v178, v253
v_mfma_f32_16x16x32_bf16 v[204:207], v[24:27], v[104:107], v[204:207]
v_fmac_f32 v144, v176, v253
v_fmac_f32 v145, v177, v253
v_mfma_f32_16x16x32_bf16 v[212:215], a[124:127], v[208:211], 0
v_exp_f32 v199, v199
v_mfma_f32_16x16x32_bf16 v[212:215], a[120:123], v[200:203], v[212:215]
v_exp_f32 v196, v196
v_mfma_f32_16x16x32_bf16 v[212:215], a[116:119], v[228:231], v[212:215]
s_nop 0
v_exp_f32 v204, v204
v_mfma_f32_16x16x32_bf16 v[212:215], a[112:115], v[216:219], v[212:215]
ds_read_b128 v[220:223], v240 offset:8704
ds_read_b128 v[224:227], v240 offset:8448
v_mfma_f32_16x16x32_bf16 v[232:235], a[96:99], v[216:219], 0
v_exp_f32 v207, v207
v_mfma_f32_16x16x32_bf16 v[232:235], a[100:103], v[228:231], v[232:235]
v_exp_f32 v205, v205
v_mfma_f32_16x16x32_bf16 v[232:235], a[104:107], v[200:203], v[232:235]
v_cvt_pk_bf16_f32 v134, v204, v205
v_cvt_pk_bf16_f32 v15, v214, v215
v_mfma_f32_16x16x32_bf16 v[232:235], a[108:111], v[208:211], v[232:235]
v_exp_f32 v206, v206
v_mfma_f32_16x16x32_bf16 v[236:239], a[92:95], v[208:211], 0
v_cvt_pk_bf16_f32 v135, v206, v207
v_cvt_pk_bf16_f32 v14, v212, v213
v_mfma_f32_16x16x32_bf16 v[236:239], a[88:91], v[200:203], v[236:239]
ds_read_b128 v[212:215], v240 offset:8960
v_fmac_f32 v148, v180, v253
v_mfma_f32_16x16x32_bf16 v[236:239], a[84:87], v[228:231], v[236:239]
v_cvt_pk_bf16_f32 v12, v232, v233
v_cvt_pk_bf16_f32 v13, v234, v235
v_mfma_f32_16x16x32_bf16 v[236:239], a[80:83], v[216:219], v[236:239]
ds_read_b128 v[232:235], v240 offset:9216
v_fmac_f32 v151, v183, v253
v_mfma_f32_16x16x32_bf16 v[204:207], a[64:67], v[216:219], 0
v_exp_f32 v198, v198
v_mfma_f32_16x16x32_bf16 v[204:207], a[72:75], v[200:203], v[204:207]
v_exp_f32 v197, v197
v_mfma_f32_16x16x32_bf16 v[204:207], a[76:79], v[208:211], v[204:207]
s_waitcnt lgkmcnt(3)
v_cvt_pk_bf16_f32 v133, v198, v199
v_cvt_pk_bf16_f32 v132, v196, v197
v_mfma_f32_16x16x32_bf16 v[204:207], a[68:71], v[228:231], v[204:207]
s_waitcnt lgkmcnt(2)
v_cvt_pk_bf16_f32 v144, v144, v145
v_fmac_f32 v154, v186, v253
v_mfma_f32_16x16x32_bf16 v[200:203], a[68:71], v[220:223], 0
s_waitcnt lgkmcnt(1)
v_fmac_f32 v147, v179, v253
v_cvt_pk_bf16_f32 v145, v146, v147
v_mfma_f32_16x16x32_bf16 v[200:203], a[64:67], v[224:227], v[200:203]
s_waitcnt lgkmcnt(0)
v_cvt_pk_bf16_f32 v146, v148, v149
v_fmac_f32 v157, v189, v253
v_mfma_f32_16x16x32_bf16 v[200:203], a[72:75], v[212:215], v[200:203]
v_cvt_pk_bf16_f32 v147, v150, v151
v_pk_max_i16 v147, v147, 0
v_mfma_f32_16x16x32_bf16 v[200:203], a[76:79], v[232:235], v[200:203]
v_fmac_f32 v158, v190, v253
v_pk_max_i16 v146, v146, 0
v_mfma_f32_16x16x32_bf16 v[196:199], a[92:95], v[232:235], 0
ds_read_b128 v[208:211], v240 offset:13184
v_cvt_pk_bf16_f32 v153, v154, v155
v_mfma_f32_16x16x32_bf16 v[196:199], a[88:91], v[212:215], v[196:199]
ds_read_b128 v[216:219], v240 offset:12928
v_cvt_pk_bf16_f32 v154, v156, v157
v_mfma_f32_16x16x32_bf16 v[196:199], a[84:87], v[220:223], v[196:199]
ds_read_b128 v[228:231], v240 offset:12672
v_cvt_pk_bf16_f32 v16, v200, v201
v_mfma_f32_16x16x32_bf16 v[196:199], a[80:83], v[224:227], v[196:199]
v_cvt_pk_bf16_f32 v17, v202, v203
v_pk_max_i16 v154, v154, 0
v_mfma_f32_16x16x32_bf16 v[200:203], a[96:99], v[224:227], 0
v_pk_max_i16 v153, v153, 0
v_cvt_pk_bf16_f32 v155, v158, v159
v_mfma_f32_16x16x32_bf16 v[200:203], a[100:103], v[220:223], v[200:203]
v_pk_max_i16 v155, v155, 0
v_pk_max_i16 v145, v145, 0
v_mfma_f32_16x16x32_bf16 v[200:203], a[104:107], v[212:215], v[200:203]
v_pk_max_i16 v152, v152, 0
v_pk_max_i16 v144, v144, 0
v_mfma_f32_16x16x32_bf16 v[200:203], a[108:111], v[232:235], v[200:203]
v_cvt_pk_bf16_f32 v19, v198, v199
v_cvt_pk_bf16_f32 v18, v196, v197
v_mfma_f32_32x32x16_bf16 v[176:191], v[100:103], v[140:143], 0
buffer_store_dwordx4 v[144:147], v242, s[20:23], s52 offen offset:0 nt
buffer_store_dwordx4 v[152:155], v242, s[20:23], s52 offen offset:64 nt
buffer_load_dwordx4 v241, s[16:19], s100 offen offset:2112 nt lds
buffer_load_dwordx4 v241, s[16:19], s101 offen offset:3168 nt lds
v_cvt_pk_bf16_f32 v8, v204, v205
v_cvt_pk_bf16_f32 v21, v202, v203
v_mfma_f32_16x16x32_bf16 v[196:199], a[124:127], v[232:235], 0
s_add_u32 s100, s99, s51
ds_read2_b32 v[100:101], v244 offset0:0 offset1:8
v_cvt_pk_bf16_f32 v20, v200, v201
v_mfma_f32_16x16x32_bf16 v[196:199], a[120:123], v[212:215], v[196:199]
s_add_u32 s101, s100, s51
v_cvt_pk_bf16_f32 v9, v206, v207
v_cvt_pk_bf16_f32 v11, v238, v239
v_mfma_f32_16x16x32_bf16 v[196:199], a[116:119], v[220:223], v[196:199]
s_add_u32 m0, s49, 8448
ds_read_b128 v[204:207], v240 offset:13440
v_cvt_pk_bf16_f32 v10, v236, v237
v_mfma_f32_16x16x32_bf16 v[196:199], a[112:115], v[224:227], v[196:199]
s_waitcnt lgkmcnt(3)
v_add_u32 v244, 1600, v244
s_add_u32 s52, s46, 20480
v_mfma_f32_16x16x32_bf16 v[200:203], v[36:39], v[108:111], 0
s_waitcnt lgkmcnt(2)
s_nop 1
v_mfma_f32_16x16x32_bf16 v[200:203], v[32:35], v[104:107], v[200:203]
v_cvt_pk_bf16_f32 v22, v196, v197
v_cvt_pk_bf16_f32 v23, v198, v199
v_mfma_f32_16x16x32_bf16 v[196:199], v[40:43], v[104:107], 0
s_nop 2
v_mfma_f32_16x16x32_bf16 v[196:199], v[44:47], v[108:111], v[196:199]
s_nop 1
s_waitcnt lgkmcnt(0)
v_mfma_f32_16x16x32_bf16 v[212:215], a[124:127], v[204:207], 0
v_exp_f32 v203, v203
v_mfma_f32_16x16x32_bf16 v[212:215], a[120:123], v[208:211], v[212:215]
v_exp_f32 v202, v202
v_mfma_f32_16x16x32_bf16 v[212:215], a[116:119], v[216:219], v[212:215]
v_exp_f32 v198, v198
v_mfma_f32_16x16x32_bf16 v[212:215], a[112:115], v[228:231], v[212:215]
ds_read_b128 v[220:223], v240 offset:17152
ds_read_b128 v[224:227], v240 offset:16896
v_mfma_f32_16x16x32_bf16 v[232:235], a[96:99], v[228:231], 0
ds_read_b128 v[236:239], v240 offset:17408
v_cvt_pk_bf16_f32 v137, v202, v203
v_mfma_f32_16x16x32_bf16 v[232:235], a[100:103], v[216:219], v[232:235]
v_exp_f32 v196, v196
v_mfma_f32_16x16x32_bf16 v[232:235], a[104:107], v[208:211], v[232:235]
v_cvt_pk_bf16_f32 v31, v214, v215
v_cvt_pk_bf16_f32 v30, v212, v213
v_mfma_f32_16x16x32_bf16 v[232:235], a[108:111], v[204:207], v[232:235]
buffer_load_dwordx4 v241, s[16:19], s98 offen offset:0 nt lds
v_mfma_f32_16x16x32_bf16 v[212:215], a[92:95], v[204:207], 0
buffer_load_dwordx4 v241, s[16:19], s99 offen offset:1056 nt lds
v_mfma_f32_16x16x32_bf16 v[212:215], a[88:91], v[208:211], v[212:215]
s_add_u32 s98, s98, s48
v_exp_f32 v197, v197
v_mfma_f32_16x16x32_bf16 v[212:215], a[84:87], v[216:219], v[212:215]
s_add_u32 s99, s98, s51
v_exp_f32 v199, v199
v_mfma_f32_16x16x32_bf16 v[212:215], a[80:83], v[228:231], v[212:215]
v_cvt_pk_bf16_f32 v138, v196, v197
v_cvt_pk_bf16_f32 v139, v198, v199
v_mfma_f32_16x16x32_bf16 v[196:199], a[64:67], v[228:231], 0
v_exp_f32 v200, v200
v_mfma_f32_16x16x32_bf16 v[196:199], a[72:75], v[208:211], v[196:199]
v_exp_f32 v201, v201
v_mfma_f32_16x16x32_bf16 v[196:199], a[76:79], v[204:207], v[196:199]
s_waitcnt lgkmcnt(2)
v_cvt_pk_bf16_f32 v136, v200, v201
v_cvt_pk_bf16_f32 v26, v212, v213
v_mfma_f32_16x16x32_bf16 v[196:199], a[68:71], v[216:219], v[196:199]
s_waitcnt lgkmcnt(1)
ds_read_b128 v[200:203], v240 offset:17664
v_cvt_pk_bf16_f32 v27, v214, v215
v_mfma_f32_16x16x32_bf16 v[204:207], a[68:71], v[220:223], 0
s_waitcnt lgkmcnt(1)
v_cvt_pk_bf16_f32 v29, v234, v235
v_cvt_pk_bf16_f32 v28, v232, v233
v_mfma_f32_16x16x32_bf16 v[204:207], a[64:67], v[224:227], v[204:207]
v_cvt_pk_bf16_f32 v24, v196, v197
v_cvt_pk_bf16_f32 v25, v198, v199
v_mfma_f32_16x16x32_bf16 v[204:207], a[72:75], v[236:239], v[204:207]
s_waitcnt lgkmcnt(0)
v_mfma_f32_16x16x32_bf16 v[204:207], a[76:79], v[200:203], v[204:207]
ds_read_b128 v[228:231], v240 offset:21120
ds_read_b128 v[216:219], v240 offset:21376
v_mfma_f32_16x16x32_bf16 v[212:215], a[92:95], v[200:203], 0
ds_read_b128 v[208:211], v240 offset:21632
ds_read_b128 v[196:199], v240 offset:21888
v_mfma_f32_16x16x32_bf16 v[212:215], a[88:91], v[236:239], v[212:215]
s_nop 1
v_cvt_pk_bf16_f32 v32, v204, v205
v_mfma_f32_16x16x32_bf16 v[212:215], a[84:87], v[220:223], v[212:215]
v_mov_b64 v[204:205], 0
v_cvt_pk_bf16_f32 v33, v206, v207
v_mfma_f32_16x16x32_bf16 v[212:215], a[80:83], v[224:227], v[212:215]
s_nop 2
v_mfma_f32_16x16x32_bf16 v[232:235], a[96:99], v[224:227], 0
s_nop 2
v_mfma_f32_16x16x32_bf16 v[232:235], a[100:103], v[220:223], v[232:235]
v_cvt_pk_bf16_f32 v35, v214, v215
v_cvt_pk_bf16_f32 v34, v212, v213
v_mfma_f32_16x16x32_bf16 v[232:235], a[104:107], v[236:239], v[232:235]
s_waitcnt lgkmcnt(0)
v_mfma_f32_16x16x32_bf16 v[232:235], a[108:111], v[200:203], v[232:235]
s_nop 2
v_smfmac_f32_16x16x64_bf16 v[204:207], v[192:195], v[128:135], v250
s_nop 2
v_smfmac_f32_16x16x64_bf16 v[204:207], v[192:195], v[136:143], v250 abid:1
v_cvt_pk_bf16_f32 v37, v234, v235
v_mfma_f32_16x16x32_bf16 v[212:215], a[124:127], v[200:203], 0
v_cvt_pk_bf16_f32 v36, v232, v233
s_nop 0
v_mfma_f32_16x16x32_bf16 v[212:215], a[120:123], v[236:239], v[212:215]
s_nop 1
v_mfma_f32_16x16x32_bf16 v[212:215], a[116:119], v[220:223], v[212:215]
v_add_f32 v204, v204, v205
v_mfma_f32_16x16x32_bf16 v[212:215], a[112:115], v[224:227], v[212:215]
v_rcp_f32 v253, v204
v_mfma_f32_16x16x32_bf16 v[176:179], v[48:51], v[128:131], v[176:179]
v_max3_f32 v254, v254, v204, v253
s_nop 0
v_mfma_f32_16x16x32_bf16 v[176:179], v[64:67], v[132:135], v[176:179]
s_nop 1
v_mfma_f32_16x16x32_bf16 v[176:179], v[80:83], v[136:139], v[176:179]
v_cvt_pk_bf16_f32 v38, v212, v213
v_cvt_pk_bf16_f32 v39, v214, v215
v_mfma_f32_16x16x32_bf16 v[180:183], v[84:87], v[136:139], v[180:183]
s_nop 2
v_mfma_f32_16x16x32_bf16 v[180:183], v[52:55], v[128:131], v[180:183]
s_nop 0
v_fmac_f32 v162, v178, v253
v_fmac_f32 v163, v179, v253
v_mfma_f32_16x16x32_bf16 v[180:183], v[68:71], v[132:135], v[180:183]
v_fmac_f32 v160, v176, v253
v_fmac_f32 v161, v177, v253
v_mfma_f32_16x16x32_bf16 v[184:187], v[72:75], v[132:135], v[184:187]
v_cvt_pk_bf16_f32 v160, v160, v161
v_pk_max_i16 v160, v160, 0
v_mfma_f32_16x16x32_bf16 v[184:187], v[88:91], v[136:139], v[184:187]
v_cvt_pk_bf16_f32 v161, v162, v163
v_pk_max_i16 v161, v161, 0
v_mfma_f32_16x16x32_bf16 v[184:187], v[56:59], v[128:131], v[184:187]
v_fmac_f32 v166, v182, v253
v_fmac_f32 v167, v183, v253
v_mfma_f32_16x16x32_bf16 v[188:191], v[60:63], v[128:131], v[188:191]
v_fmac_f32 v164, v180, v253
v_fmac_f32 v165, v181, v253
v_mfma_f32_16x16x32_bf16 v[188:191], v[76:79], v[132:135], v[188:191]
v_cvt_pk_bf16_f32 v162, v164, v165
v_pk_max_i16 v162, v162, 0
v_mfma_f32_16x16x32_bf16 v[188:191], v[92:95], v[136:139], v[188:191]
v_fmac_f32 v168, v184, v253
v_fmac_f32 v169, v185, v253
v_mfma_f32_16x16x32_bf16 v[200:203], a[124:127], v[196:199], 0
v_fmac_f32 v170, v186, v253
v_fmac_f32 v171, v187, v253
v_mfma_f32_16x16x32_bf16 v[200:203], a[120:123], v[208:211], v[200:203]
v_cvt_pk_bf16_f32 v168, v168, v169
v_cvt_pk_bf16_f32 v169, v170, v171
v_mfma_f32_16x16x32_bf16 v[200:203], a[116:119], v[216:219], v[200:203]
v_fmac_f32 v173, v189, v253
v_fmac_f32 v172, v188, v253
v_mfma_f32_16x16x32_bf16 v[200:203], a[112:115], v[228:231], v[200:203]
v_fmac_f32 v175, v191, v253
v_cvt_pk_bf16_f32 v170, v172, v173
v_mfma_f32_16x16x32_bf16 v[204:207], a[96:99], v[228:231], 0
v_fmac_f32 v174, v190, v253
v_cvt_pk_bf16_f32 v163, v166, v167
v_mfma_f32_16x16x32_bf16 v[204:207], a[100:103], v[216:219], v[204:207]
v_pk_max_i16 v163, v163, 0
v_cvt_pk_bf16_f32 v171, v174, v175
v_mfma_f32_16x16x32_bf16 v[204:207], a[104:107], v[208:211], v[204:207]
v_cvt_pk_bf16_f32 v47, v202, v203
v_cvt_pk_bf16_f32 v46, v200, v201
v_mfma_f32_16x16x32_bf16 v[204:207], a[108:111], v[196:199], v[204:207]
v_pk_max_i16 v171, v171, 0
v_pk_max_i16 v168, v168, 0
v_mfma_f32_16x16x32_bf16 v[200:203], a[92:95], v[196:199], 0
v_pk_max_i16 v169, v169, 0
v_pk_max_i16 v170, v170, 0
v_mfma_f32_16x16x32_bf16 v[200:203], a[88:91], v[208:211], v[200:203]
s_nop 1
v_cvt_pk_bf16_f32 v44, v204, v205
v_mfma_f32_16x16x32_bf16 v[200:203], a[84:87], v[216:219], v[200:203]
v_cvt_pk_bf16_f32 v45, v206, v207
v_mfma_f32_16x16x32_bf16 v[200:203], a[80:83], v[228:231], v[200:203]
s_nop 2
v_mfma_f32_16x16x32_bf16 v[204:207], a[64:67], v[228:231], 0
s_nop 2
v_mfma_f32_16x16x32_bf16 v[204:207], a[72:75], v[208:211], v[204:207]
v_cvt_pk_bf16_f32 v42, v200, v201
v_cvt_pk_bf16_f32 v43, v202, v203
v_mfma_f32_16x16x32_bf16 v[204:207], a[76:79], v[196:199], v[204:207]
v_mfma_f32_16x16x32_bf16 v[204:207], a[68:71], v[216:219], v[204:207]
ds_read_b128 v[200:203], v245 offset:0
v_add_u32 v245, 1600, v245
v_mfma_f32_16x16x32_bf16 v[212:215], a[4:7], v[216:219], 0
s_nop 2
v_mfma_f32_16x16x32_bf16 v[212:215], a[0:3], v[228:231], v[212:215]
s_nop 0
v_cvt_pk_bf16_f32 v41, v206, v207
v_cvt_pk_bf16_f32 v40, v204, v205
v_mfma_f32_16x16x32_bf16 v[212:215], a[8:11], v[208:211], v[212:215]
v_mfma_f32_16x16x32_bf16 v[212:215], a[12:15], v[196:199], v[212:215]
s_nop 2
v_mfma_f32_16x16x32_bf16 v[204:207], a[28:31], v[196:199], 0
s_nop 2
v_mfma_f32_16x16x32_bf16 v[204:207], a[24:27], v[208:211], v[204:207]
v_cvt_pk_bf16_f32 v104, v212, v213
v_cvt_pk_bf16_f32 v105, v214, v215
v_mfma_f32_16x16x32_bf16 v[204:207], a[20:23], v[216:219], v[204:207]
v_mfma_f32_16x16x32_bf16 v[204:207], a[16:19], v[228:231], v[204:207]
buffer_load_dwordx4 v241, s[16:19], s100 offen offset:2112 nt lds
v_mfma_f32_16x16x32_bf16 v[212:215], a[32:35], v[228:231], 0
buffer_load_dwordx4 v241, s[16:19], s101 offen offset:3168 nt lds
v_mfma_f32_16x16x32_bf16 v[212:215], a[36:39], v[216:219], v[212:215]
s_add_u32 s100, s99, s51
v_mov_b64 v[178:179], 0
v_mov_b64 v[176:177], 0
v_mfma_f32_16x16x32_bf16 v[212:215], a[40:43], v[208:211], v[212:215]
s_add_u32 m0, s49, 16896
v_mov_b64 v[182:183], 0
v_mov_b64 v[180:181], 0
v_mfma_f32_16x16x32_bf16 v[212:215], a[44:47], v[196:199], v[212:215]
s_add_u32 s101, s100, s51
v_mov_b64 v[186:187], 0
v_mov_b64 v[184:185], 0
v_mfma_f32_16x16x32_bf16 v[220:223], a[60:63], v[196:199], 0
s_waitcnt lgkmcnt(0)
v_cvt_pk_bf16_f32 v107, v206, v207
v_cvt_pk_bf16_f32 v106, v204, v205
v_mfma_f32_16x16x32_bf16 v[220:223], a[56:59], v[208:211], v[220:223]
s_and_b32 s51, s57, 13106176
v_cvt_pk_bf16_f32 v108, v212, v213
v_cvt_pk_bf16_f32 v109, v214, v215
v_mfma_f32_16x16x32_bf16 v[220:223], a[52:55], v[216:219], v[220:223]
s_lshl3_add_u32 s48, s51, 8192
s_sub_u32 s49, s49, s56
s_sub_u32 s51, s51, 32
v_mfma_f32_16x16x32_bf16 v[220:223], a[48:51], v[228:231], v[220:223]
s_nop 2
v_smfmac_f32_16x16x64_bf16 v[176:179], v[200:203], v[0:7], v250
s_nop 2
v_smfmac_f32_16x16x64_bf16 v[180:183], v[200:203], v[16:23], v250
v_cvt_pk_bf16_f32 v111, v222, v223
v_smfmac_f32_16x16x64_bf16 v[184:187], v[200:203], v[32:39], v250
v_cvt_pk_bf16_f32 v110, v220, v221
v_mfma_f32_16x16x32_bf16 v[144:147], a[192:195], v[228:231], 0
v_add_f32 v176, v176, v177
v_mfma_f32_16x16x32_bf16 v[144:147], a[196:199], v[216:219], v[144:147]
v_exp_f32 v176, v176
v_mfma_f32_16x16x32_bf16 v[144:147], a[200:203], v[208:211], v[144:147]
v_mfma_f32_16x16x32_bf16 v[144:147], a[204:207], v[196:199], v[144:147]
v_smfmac_f32_16x16x64_bf16 v[178:181], v[200:203], v[8:15], v250
s_nop 2
v_smfmac_f32_16x16x64_bf16 v[182:185], v[200:203], v[24:31], v250
s_nop 2
v_smfmac_f32_16x16x64_bf16 v[186:189], v[200:203], v[40:47], v250
v_add_f32 v178, v178, v179
v_mfma_f32_16x16x32_bf16 v[148:151], a[220:223], v[196:199], 0
v_add_f32 v180, v180, v181
s_nop 0
v_mfma_f32_16x16x32_bf16 v[148:151], a[216:219], v[208:211], v[148:151]
v_exp_f32 v180, v180
v_mfma_f32_16x16x32_bf16 v[148:151], a[212:215], v[216:219], v[148:151]
v_add_f32 v184, v184, v185
v_add_f32 v182, v182, v183
v_mfma_f32_16x16x32_bf16 v[148:151], a[208:211], v[228:231], v[148:151]
v_add_f32 v186, v186, v187
v_mfma_f32_16x16x32_bf16 v[152:155], a[224:227], v[228:231], 0
v_exp_f32 v178, v178
v_mfma_f32_16x16x32_bf16 v[152:155], a[228:231], v[216:219], v[152:155]
v_mov_b64 v[200:201], s[96:97]
v_mov_b64 v[202:203], s[96:97]
v_mfma_f32_16x16x32_bf16 v[152:155], a[232:235], v[208:211], v[152:155]
v_add_f32 v188, v176, v178
v_add_f32 v188, v188, v180
v_mfma_f32_16x16x32_bf16 v[152:155], a[236:239], v[196:199], v[152:155]
v_exp_f32 v184, v184
v_mfma_f32_16x16x32_bf16 v[156:159], a[252:255], v[196:199], 0
v_exp_f32 v182, v182
v_mfma_f32_16x16x32_bf16 v[156:159], a[248:251], v[208:211], v[156:159]
v_add_f32 v188, v188, v182
v_add_f32 v188, v188, v184
v_mfma_f32_16x16x32_bf16 v[156:159], a[244:247], v[216:219], v[156:159]
v_exp_f32 v186, v186
v_mfma_f32_16x16x32_bf16 v[156:159], a[240:243], v[228:231], v[156:159]
v_add_f32 v188, v188, v186
v_cvt_pk_bf16_f32 v177, v176, v178
v_smfmac_f32_16x16x64_bf16 v[200:203], v[96:99], v[104:111], v250
ds_write_b16 v246, v177 offset:0
v_cvt_pk_bf16_f32 v181, v180, v182
v_mfma_f32_16x16x32_bf16 v[204:207], v[0:3], v[104:107], 0
ds_write_b16_d16_hi v246, v177 offset:4
v_cvt_pk_bf16_f32 v185, v184, v186
v_mfma_f32_16x16x32_bf16 v[204:207], v[4:7], v[108:111], v[204:207]
ds_write_b16 v246, v181 offset:272
v_add_f32_dpp v188, v188, v188 row_ror:8 row_mask:0xf bank_mask:0xf
v_mfma_f32_16x16x32_bf16 v[212:215], v[228:231], a[128:131], 0
ds_write_b16_d16_hi v246, v181 offset:276
v_add_f32 v200, v200, v201
v_mfma_f32_16x16x32_bf16 v[212:215], v[216:219], a[132:135], v[212:215]
ds_write_b16 v246, v185 offset:544
v_add_f32 v202, v202, v203
v_mfma_f32_16x16x32_bf16 v[212:215], v[208:211], a[136:139], v[212:215]
ds_write_b16_d16_hi v246, v185 offset:548
v_add_f32_dpp v188, v188, v188 row_ror:4 row_mask:0xf bank_mask:0xf
v_mfma_f32_16x16x32_bf16 v[212:215], v[196:199], a[140:143], v[212:215]
ds_write_b32 v249, v188 offset:0
ds_read_b128 v[224:227], v240 offset:4224
v_mfma_f32_16x16x32_bf16 v[232:235], v[196:199], a[156:159], 0
ds_read_b128 v[220:223], v240 offset:4480
v_add_u32 v249, 1600, v249
v_mfma_f32_16x16x32_bf16 v[232:235], v[208:211], a[152:155], v[232:235]
v_exp_f32 v207, v207
v_mfma_f32_16x16x32_bf16 v[232:235], v[216:219], a[148:151], v[232:235]
v_exp_f32 v204, v204
v_mfma_f32_16x16x32_bf16 v[232:235], v[228:231], a[144:147], v[232:235]
v_exp_f32 v205, v205
v_mfma_f32_16x16x32_bf16 v[236:239], v[228:231], a[160:163], 0
v_exp_f32 v206, v206
v_mfma_f32_16x16x32_bf16 v[236:239], v[216:219], a[164:167], v[236:239]
v_cvt_pk_bf16_f32 v113, v206, v207
v_cvt_pk_bf16_f32 v112, v204, v205
v_mfma_f32_16x16x32_bf16 v[236:239], v[208:211], a[168:171], v[236:239]
s_nop 0
v_cvt_pk_bf16_f32 v87, v234, v235
v_cvt_pk_bf16_f32 v86, v232, v233
v_mfma_f32_16x16x32_bf16 v[236:239], v[196:199], a[172:175], v[236:239]
v_cvt_pk_bf16_f32 v83, v214, v215
v_cvt_pk_bf16_f32 v82, v212, v213
v_mfma_f32_16x16x32_bf16 v[232:235], v[196:199], a[188:191], 0
ds_read_b128 v[212:215], v240 offset:4992
s_nop 0
v_mfma_f32_16x16x32_bf16 v[232:235], v[208:211], a[184:187], v[232:235]
v_exp_f32 v200, v200
v_mfma_f32_16x16x32_bf16 v[232:235], v[216:219], a[180:183], v[232:235]
v_exp_f32 v202, v202
v_mfma_f32_16x16x32_bf16 v[232:235], v[228:231], a[176:179], v[232:235]
v_perm_b32 v124, v202, v200, v251
v_perm_b32 v125, v202, v200, v252
v_mfma_f32_16x16x32_bf16 v[196:199], v[8:11], v[104:107], 0
s_waitcnt lgkmcnt(2)
ds_read_b128 v[200:203], v240 offset:4736
v_cvt_pk_bf16_f32 v91, v238, v239
v_mfma_f32_16x16x32_bf16 v[196:199], v[12:15], v[108:111], v[196:199]
s_waitcnt lgkmcnt(2)
v_cvt_pk_bf16_f32 v95, v234, v235
v_cvt_pk_bf16_f32 v94, v232, v233
v_mfma_f32_16x16x32_bf16 v[204:207], v[20:23], v[108:111], 0
v_cvt_pk_bf16_f32 v90, v236, v237
s_nop 0
v_mfma_f32_16x16x32_bf16 v[204:207], v[16:19], v[104:107], v[204:207]
s_nop 0
v_exp_f32 v196, v196
v_mfma_f32_16x16x32_bf16 v[208:211], v[24:27], v[104:107], 0
s_waitcnt lgkmcnt(1)
v_exp_f32 v197, v197
v_mfma_f32_16x16x32_bf16 v[208:211], v[28:31], v[108:111], v[208:211]
v_exp_f32 v198, v198
v_mfma_f32_16x16x32_bf16 v[216:219], v[212:215], a[188:191], 0
s_waitcnt lgkmcnt(0)
v_exp_f32 v206, v206
v_mfma_f32_16x16x32_bf16 v[216:219], v[200:203], a[184:187], v[216:219]
v_exp_f32 v204, v204
v_mfma_f32_16x16x32_bf16 v[216:219], v[220:223], a[180:183], v[216:219]
s_nop 0
v_exp_f32 v211, v211
v_mfma_f32_16x16x32_bf16 v[216:219], v[224:227], a[176:179], v[216:219]
ds_read_b128 v[228:231], v240 offset:0
v_cvt_pk_bf16_f32 v114, v196, v197
v_mfma_f32_16x16x32_bf16 v[232:235], v[224:227], a[160:163], 0
ds_read_b128 v[236:239], v240 offset:512
s_nop 0
v_mfma_f32_16x16x32_bf16 v[232:235], v[220:223], a[164:167], v[232:235]
v_exp_f32 v209, v209
v_mfma_f32_16x16x32_bf16 v[232:235], v[200:203], a[168:171], v[232:235]
v_cvt_pk_bf16_f32 v63, v218, v219
v_cvt_pk_bf16_f32 v62, v216, v217
v_mfma_f32_16x16x32_bf16 v[232:235], v[212:215], a[172:175], v[232:235]
v_exp_f32 v208, v208
v_mfma_f32_16x16x32_bf16 v[216:219], v[212:215], a[156:159], 0
v_exp_f32 v210, v210
v_mfma_f32_16x16x32_bf16 v[216:219], v[200:203], a[152:155], v[216:219]
v_cvt_pk_bf16_f32 v119, v210, v211
v_cvt_pk_bf16_f32 v118, v208, v209
v_mfma_f32_16x16x32_bf16 v[216:219], v[220:223], a[148:151], v[216:219]
v_exp_f32 v207, v207
v_mfma_f32_16x16x32_bf16 v[216:219], v[224:227], a[144:147], v[216:219]
v_exp_f32 v205, v205
v_mfma_f32_16x16x32_bf16 v[208:211], v[224:227], a[128:131], 0
v_cvt_pk_bf16_f32 v116, v204, v205
v_cvt_pk_bf16_f32 v117, v206, v207
v_mfma_f32_16x16x32_bf16 v[208:211], v[220:223], a[132:135], v[208:211]
v_exp_f32 v199, v199
v_mfma_f32_16x16x32_bf16 v[208:211], v[200:203], a[136:139], v[208:211]
v_cvt_pk_bf16_f32 v115, v198, v199
v_cvt_pk_bf16_f32 v58, v232, v233
v_mfma_f32_16x16x32_bf16 v[208:211], v[212:215], a[140:143], v[208:211]
ds_read_b128 v[196:199], v240 offset:256
v_cvt_pk_bf16_f32 v59, v234, v235
v_mfma_f32_32x32x16_bf16 v[176:191], v[100:103], v[124:127], 0
buffer_store_dwordx4 v[160:163], v242, s[20:23], s53 offen offset:0 nt
buffer_store_dwordx4 v[168:171], v242, s[20:23], s53 offen offset:64 nt
buffer_load_dwordx4 v241, s[16:19], s98 offen offset:0 nt lds
buffer_load_dwordx4 v241, s[16:19], s99 offen offset:1056 nt lds
buffer_load_dwordx4 v241, s[16:19], s100 offen offset:2112 nt lds
buffer_load_dwordx4 v241, s[16:19], s101 offen offset:3168 nt lds
v_mfma_f32_16x16x32_bf16 v[200:203], v[36:39], v[108:111], 0
s_waitcnt lgkmcnt(1)
ds_read_b128 v[232:235], v240 offset:768
v_cvt_pk_bf16_f32 v50, v208, v209
v_mfma_f32_16x16x32_bf16 v[200:203], v[32:35], v[104:107], v[200:203]
s_add_u32 s53, s46, 0
v_cvt_pk_bf16_f32 v51, v210, v211
v_cvt_pk_bf16_f32 v54, v216, v217
v_mfma_f32_16x16x32_bf16 v[204:207], v[40:43], v[104:107], 0
s_waitcnt lgkmcnt(1)
v_cvt_pk_bf16_f32 v55, v218, v219
s_nop 0
v_mfma_f32_16x16x32_bf16 v[204:207], v[44:47], v[108:111], v[204:207]
v_exp_f32 v201, v201
v_mfma_f32_16x16x32_bf16 v[208:211], v[228:231], a[128:131], 0
v_exp_f32 v200, v200
v_mfma_f32_16x16x32_bf16 v[208:211], v[196:199], a[132:135], v[208:211]
v_exp_f32 v203, v203
v_mfma_f32_16x16x32_bf16 v[208:211], v[236:239], a[136:139], v[208:211]
s_waitcnt lgkmcnt(0)
v_exp_f32 v202, v202
v_mfma_f32_16x16x32_bf16 v[208:211], v[232:235], a[140:143], v[208:211]
v_cvt_pk_bf16_f32 v121, v202, v203
v_cvt_pk_bf16_f32 v120, v200, v201
v_mfma_f32_16x16x32_bf16 v[212:215], v[232:235], a[156:159], 0
v_exp_f32 v205, v205
v_mfma_f32_16x16x32_bf16 v[212:215], v[236:239], a[152:155], v[212:215]
v_exp_f32 v207, v207
v_mfma_f32_16x16x32_bf16 v[212:215], v[196:199], a[148:151], v[212:215]
v_exp_f32 v204, v204
v_mfma_f32_16x16x32_bf16 v[212:215], v[228:231], a[144:147], v[212:215]
v_exp_f32 v206, v206
v_mfma_f32_16x16x32_bf16 v[216:219], v[228:231], a[160:163], 0
v_cvt_pk_bf16_f32 v123, v206, v207
v_cvt_pk_bf16_f32 v122, v204, v205
v_mfma_f32_16x16x32_bf16 v[216:219], v[196:199], a[164:167], v[216:219]
v_cvt_pk_bf16_f32 v48, v208, v209
v_cvt_pk_bf16_f32 v49, v210, v211
v_mfma_f32_16x16x32_bf16 v[216:219], v[236:239], a[168:171], v[216:219]
v_cvt_pk_bf16_f32 v52, v212, v213
v_cvt_pk_bf16_f32 v53, v214, v215
v_mfma_f32_16x16x32_bf16 v[216:219], v[232:235], a[172:175], v[216:219]
s_nop 2
v_mfma_f32_16x16x32_bf16 v[200:203], v[232:235], a[188:191], 0
s_nop 2
v_mfma_f32_16x16x32_bf16 v[200:203], v[236:239], a[184:187], v[200:203]
v_cvt_pk_bf16_f32 v57, v218, v219
v_cvt_pk_bf16_f32 v56, v216, v217
v_mfma_f32_16x16x32_bf16 v[200:203], v[196:199], a[180:183], v[200:203]
v_mfma_f32_16x16x32_bf16 v[200:203], v[228:231], a[176:179], v[200:203]
s_nop 2
v_mfma_f32_16x16x32_bf16 v[204:207], a[0:3], v[228:231], 0
s_nop 2
v_mfma_f32_16x16x32_bf16 v[204:207], a[4:7], v[196:199], v[204:207]
v_cvt_pk_bf16_f32 v60, v200, v201
v_cvt_pk_bf16_f32 v61, v202, v203
v_mfma_f32_16x16x32_bf16 v[204:207], a[8:11], v[236:239], v[204:207]
v_mfma_f32_16x16x32_bf16 v[204:207], a[12:15], v[232:235], v[204:207]
s_nop 2
v_mfma_f32_16x16x32_bf16 v[200:203], a[28:31], v[232:235], 0
s_nop 2
v_mfma_f32_16x16x32_bf16 v[200:203], a[24:27], v[236:239], v[200:203]
v_cvt_pk_bf16_f32 v104, v204, v205
v_cvt_pk_bf16_f32 v105, v206, v207
v_mfma_f32_16x16x32_bf16 v[200:203], a[20:23], v[196:199], v[200:203]
v_mfma_f32_16x16x32_bf16 v[200:203], a[16:19], v[228:231], v[200:203]
s_nop 2
v_mfma_f32_16x16x32_bf16 v[204:207], a[32:35], v[228:231], 0
s_nop 2
v_mfma_f32_16x16x32_bf16 v[204:207], a[36:39], v[196:199], v[204:207]
v_cvt_pk_bf16_f32 v107, v202, v203
v_cvt_pk_bf16_f32 v106, v200, v201
v_mfma_f32_16x16x32_bf16 v[204:207], a[40:43], v[236:239], v[204:207]
v_mov_b64 v[208:209], 0
v_mfma_f32_16x16x32_bf16 v[204:207], a[44:47], v[232:235], v[204:207]
s_nop 2
v_mfma_f32_16x16x32_bf16 v[200:203], a[60:63], v[232:235], 0
s_nop 2
v_mfma_f32_16x16x32_bf16 v[200:203], a[56:59], v[236:239], v[200:203]
v_cvt_pk_bf16_f32 v108, v204, v205
v_cvt_pk_bf16_f32 v109, v206, v207
v_mfma_f32_16x16x32_bf16 v[200:203], a[52:55], v[196:199], v[200:203]
v_mfma_f32_16x16x32_bf16 v[200:203], a[48:51], v[228:231], v[200:203]
s_nop 2
v_smfmac_f32_16x16x64_bf16 v[208:211], v[192:195], v[112:119], v250
s_nop 2
v_smfmac_f32_16x16x64_bf16 v[208:211], v[192:195], v[120:127], v250 abid:1
ds_read_b128 v[204:207], v240 offset:8448
v_cvt_pk_bf16_f32 v110, v200, v201
v_mfma_f32_16x16x32_bf16 v[160:163], a[192:195], v[228:231], 0
ds_read_b128 v[212:215], v240 offset:8704
v_cvt_pk_bf16_f32 v111, v202, v203
v_mfma_f32_16x16x32_bf16 v[160:163], a[196:199], v[196:199], v[160:163]
ds_read_b128 v[220:223], v240 offset:9216
ds_read_b128 v[216:219], v240 offset:8960
v_mfma_f32_16x16x32_bf16 v[160:163], a[200:203], v[236:239], v[160:163]
v_add_f32 v208, v208, v209
v_mfma_f32_16x16x32_bf16 v[160:163], a[204:207], v[232:235], v[160:163]
v_rcp_f32 v253, v208
v_mfma_f32_16x16x32_bf16 v[164:167], a[220:223], v[232:235], 0
v_max3_f32 v254, v254, v208, v253
v_mfma_f32_16x16x32_bf16 v[164:167], a[216:219], v[236:239], v[164:167]
v_mfma_f32_16x16x32_bf16 v[164:167], a[212:215], v[196:199], v[164:167]
v_mfma_f32_16x16x32_bf16 v[164:167], a[208:211], v[228:231], v[164:167]
v_mfma_f32_16x16x32_bf16 v[168:171], a[224:227], v[228:231], 0
v_mfma_f32_16x16x32_bf16 v[168:171], a[228:231], v[196:199], v[168:171]
v_mov_b64 v[202:203], s[96:97]
v_mov_b64 v[200:201], s[96:97]
v_mfma_f32_16x16x32_bf16 v[168:171], a[232:235], v[236:239], v[168:171]
v_mfma_f32_16x16x32_bf16 v[168:171], a[236:239], v[232:235], v[168:171]
v_mfma_f32_16x16x32_bf16 v[172:175], a[252:255], v[232:235], 0
s_waitcnt lgkmcnt(3)
v_mfma_f32_16x16x32_bf16 v[172:175], a[248:251], v[236:239], v[172:175]
s_waitcnt lgkmcnt(2)
v_mfma_f32_16x16x32_bf16 v[172:175], a[244:247], v[196:199], v[172:175]
s_waitcnt lgkmcnt(0)
v_mfma_f32_16x16x32_bf16 v[172:175], a[240:243], v[228:231], v[172:175]
v_smfmac_f32_16x16x64_bf16 v[200:203], v[96:99], v[104:111], v250
s_nop 2
v_mfma_f32_16x16x32_bf16 v[196:199], v[0:3], v[104:107], 0
s_nop 2
v_mfma_f32_16x16x32_bf16 v[196:199], v[4:7], v[108:111], v[196:199]
v_add_f32 v200, v200, v201
v_add_f32 v202, v202, v203
v_mfma_f32_16x16x32_bf16 v[208:211], v[12:15], v[108:111], 0
v_exp_f32 v200, v200
v_mfma_f32_16x16x32_bf16 v[208:211], v[8:11], v[104:107], v[208:211]
v_exp_f32 v202, v202
v_mfma_f32_16x16x32_bf16 v[224:227], v[204:207], a[128:131], 0
s_nop 0
v_exp_f32 v198, v198
v_mfma_f32_16x16x32_bf16 v[224:227], v[212:215], a[132:135], v[224:227]
v_exp_f32 v199, v199
v_mfma_f32_16x16x32_bf16 v[224:227], v[216:219], a[136:139], v[224:227]
s_nop 0
v_exp_f32 v211, v211
v_mfma_f32_16x16x32_bf16 v[224:227], v[220:223], a[140:143], v[224:227]
ds_read_b128 v[228:231], v240 offset:12672
v_cvt_pk_bf16_f32 v129, v198, v199
v_mfma_f32_16x16x32_bf16 v[232:235], v[220:223], a[156:159], 0
v_exp_f32 v210, v210
v_mfma_f32_16x16x32_bf16 v[232:235], v[216:219], a[152:155], v[232:235]
v_exp_f32 v208, v208
v_mfma_f32_16x16x32_bf16 v[232:235], v[212:215], a[148:151], v[232:235]
v_exp_f32 v209, v209
v_mfma_f32_16x16x32_bf16 v[232:235], v[204:207], a[144:147], v[232:235]
v_cvt_pk_bf16_f32 v131, v210, v211
v_cvt_pk_bf16_f32 v130, v208, v209
v_mfma_f32_16x16x32_bf16 v[236:239], v[204:207], a[160:163], 0
v_exp_f32 v197, v197
v_mfma_f32_16x16x32_bf16 v[236:239], v[212:215], a[164:167], v[236:239]
v_exp_f32 v196, v196
v_mfma_f32_16x16x32_bf16 v[236:239], v[216:219], a[168:171], v[236:239]
s_nop 0
v_cvt_pk_bf16_f32 v68, v232, v233
v_cvt_pk_bf16_f32 v69, v234, v235
v_mfma_f32_16x16x32_bf16 v[236:239], v[220:223], a[172:175], v[236:239]
v_cvt_pk_bf16_f32 v128, v196, v197
v_cvt_pk_bf16_f32 v64, v224, v225
v_mfma_f32_16x16x32_bf16 v[232:235], v[220:223], a[188:191], 0
ds_read_b128 v[196:199], v240 offset:13440
v_cvt_pk_bf16_f32 v65, v226, v227
v_mfma_f32_16x16x32_bf16 v[232:235], v[216:219], a[184:187], v[232:235]
ds_read_b128 v[224:227], v240 offset:13184
v_perm_b32 v140, v202, v200, v251
v_mfma_f32_16x16x32_bf16 v[232:235], v[212:215], a[180:183], v[232:235]
v_perm_b32 v141, v202, v200, v252
v_cvt_pk_bf16_f32 v73, v238, v239
v_mfma_f32_16x16x32_bf16 v[232:235], v[204:207], a[176:179], v[232:235]
ds_read_b128 v[200:203], v240 offset:12928
v_cvt_pk_bf16_f32 v72, v236, v237
v_mfma_f32_16x16x32_bf16 v[204:207], v[20:23], v[108:111], 0
s_waitcnt lgkmcnt(3)
s_nop 1
v_mfma_f32_16x16x32_bf16 v[204:207], v[16:19], v[104:107], v[204:207]
s_nop 0
v_cvt_pk_bf16_f32 v76, v232, v233
v_cvt_pk_bf16_f32 v77, v234, v235
v_mfma_f32_16x16x32_bf16 v[208:211], v[24:27], v[104:107], 0
s_waitcnt lgkmcnt(2)
s_nop 1
v_mfma_f32_16x16x32_bf16 v[208:211], v[28:31], v[108:111], v[208:211]
s_waitcnt lgkmcnt(1)
v_exp_f32 v204, v204
v_mfma_f32_16x16x32_bf16 v[212:215], v[196:199], a[188:191], 0
v_exp_f32 v205, v205
v_mfma_f32_16x16x32_bf16 v[212:215], v[224:227], a[184:187], v[212:215]
s_waitcnt lgkmcnt(0)
v_exp_f32 v207, v207
v_mfma_f32_16x16x32_bf16 v[212:215], v[200:203], a[180:183], v[212:215]
v_exp_f32 v206, v206
v_mfma_f32_16x16x32_bf16 v[212:215], v[228:231], a[176:179], v[212:215]
ds_read_b128 v[216:219], v240 offset:17152
ds_read_b128 v[220:223], v240 offset:16896
v_mfma_f32_16x16x32_bf16 v[232:235], v[228:231], a[160:163], 0
v_cvt_pk_bf16_f32 v133, v206, v207
v_cvt_pk_bf16_f32 v132, v204, v205
v_mfma_f32_16x16x32_bf16 v[232:235], v[200:203], a[164:167], v[232:235]
ds_read_b128 v[204:207], v240 offset:17408
v_mfma_f32_16x16x32_bf16 v[232:235], v[224:227], a[168:171], v[232:235]
v_cvt_pk_bf16_f32 v78, v212, v213
v_cvt_pk_bf16_f32 v79, v214, v215
v_mfma_f32_16x16x32_bf16 v[232:235], v[196:199], a[172:175], v[232:235]
ds_read_b128 v[212:215], v240 offset:17664
s_nop 0
v_mfma_f32_16x16x32_bf16 v[236:239], v[196:199], a[156:159], 0
v_exp_f32 v208, v208
v_mfma_f32_16x16x32_bf16 v[236:239], v[224:227], a[152:155], v[236:239]
v_exp_f32 v210, v210
v_mfma_f32_16x16x32_bf16 v[236:239], v[200:203], a[148:151], v[236:239]
s_nop 0
v_cvt_pk_bf16_f32 v74, v232, v233
v_cvt_pk_bf16_f32 v75, v234, v235
v_mfma_f32_16x16x32_bf16 v[236:239], v[228:231], a[144:147], v[236:239]
v_exp_f32 v211, v211
v_mfma_f32_16x16x32_bf16 v[232:235], v[228:231], a[128:131], 0
v_exp_f32 v209, v209
v_mfma_f32_16x16x32_bf16 v[232:235], v[224:227], a[136:139], v[232:235]
v_cvt_pk_bf16_f32 v134, v208, v209
v_cvt_pk_bf16_f32 v135, v210, v211
v_mfma_f32_16x16x32_bf16 v[232:235], v[196:199], a[140:143], v[232:235]
s_waitcnt lgkmcnt(3)
v_cvt_pk_bf16_f32 v71, v238, v239
v_cvt_pk_bf16_f32 v70, v236, v237
v_mfma_f32_16x16x32_bf16 v[232:235], v[200:203], a[132:135], v[232:235]
s_waitcnt lgkmcnt(2)
s_nop 1
v_mfma_f32_16x16x32_bf16 v[196:199], v[216:219], a[132:135], 0
s_waitcnt lgkmcnt(1)
s_nop 1
v_mfma_f32_16x16x32_bf16 v[196:199], v[220:223], a[128:131], v[196:199]
s_waitcnt lgkmcnt(0)
v_cvt_pk_bf16_f32 v67, v234, v235
v_cvt_pk_bf16_f32 v66, v232, v233
v_mfma_f32_16x16x32_bf16 v[196:199], v[204:207], a[136:139], v[196:199]
v_mfma_f32_16x16x32_bf16 v[196:199], v[212:215], a[140:143], v[196:199]
s_nop 2
v_mfma_f32_16x16x32_bf16 v[200:203], v[212:215], a[156:159], 0
s_nop 2
v_mfma_f32_16x16x32_bf16 v[200:203], v[204:207], a[152:155], v[200:203]
v_cvt_pk_bf16_f32 v81, v198, v199
v_cvt_pk_bf16_f32 v80, v196, v197
v_mfma_f32_16x16x32_bf16 v[200:203], v[216:219], a[148:151], v[200:203]
v_mfma_f32_16x16x32_bf16 v[200:203], v[220:223], a[144:147], v[200:203]
s_nop 2
v_mfma_f32_16x16x32_bf16 v[196:199], v[220:223], a[160:163], 0
s_nop 2
v_mfma_f32_16x16x32_bf16 v[196:199], v[216:219], a[164:167], v[196:199]
v_cvt_pk_bf16_f32 v84, v200, v201
v_cvt_pk_bf16_f32 v85, v202, v203
v_mfma_f32_16x16x32_bf16 v[196:199], v[204:207], a[168:171], v[196:199]
v_mfma_f32_16x16x32_bf16 v[196:199], v[212:215], a[172:175], v[196:199]
s_nop 2
v_mfma_f32_16x16x32_bf16 v[200:203], v[212:215], a[188:191], 0
s_nop 2
v_mfma_f32_16x16x32_bf16 v[200:203], v[204:207], a[184:187], v[200:203]
v_cvt_pk_bf16_f32 v89, v198, v199
v_cvt_pk_bf16_f32 v88, v196, v197
v_mfma_f32_16x16x32_bf16 v[200:203], v[216:219], a[180:183], v[200:203]
v_mfma_f32_16x16x32_bf16 v[200:203], v[220:223], a[176:179], v[200:203]
s_nop 2
v_mfma_f32_16x16x32_bf16 v[196:199], v[36:39], v[108:111], 0
s_nop 2
v_mfma_f32_16x16x32_bf16 v[196:199], v[32:35], v[104:107], v[196:199]
v_cvt_pk_bf16_f32 v92, v200, v201
v_cvt_pk_bf16_f32 v93, v202, v203
v_mfma_f32_16x16x32_bf16 v[200:203], v[40:43], v[104:107], 0
s_nop 2
v_mfma_f32_16x16x32_bf16 v[200:203], v[44:47], v[108:111], v[200:203]
s_nop 0
v_exp_f32 v199, v199
v_mfma_f32_16x16x32_bf16 v[176:179], v[48:51], v[112:115], v[176:179]
v_exp_f32 v196, v196
v_mfma_f32_16x16x32_bf16 v[176:179], v[64:67], v[116:119], v[176:179]
v_exp_f32 v197, v197
v_mfma_f32_16x16x32_bf16 v[176:179], v[80:83], v[120:123], v[176:179]
v_exp_f32 v198, v198
v_mfma_f32_16x16x32_bf16 v[180:183], v[84:87], v[120:123], v[180:183]
v_cvt_pk_bf16_f32 v136, v196, v197
v_cvt_pk_bf16_f32 v137, v198, v199
v_mfma_f32_16x16x32_bf16 v[180:183], v[52:55], v[112:115], v[180:183]
v_exp_f32 v200, v200
v_mfma_f32_16x16x32_bf16 v[180:183], v[68:71], v[116:119], v[180:183]
s_nop 0
v_fmac_f32 v144, v176, v253
v_fmac_f32 v145, v177, v253
v_mfma_f32_16x16x32_bf16 v[184:187], v[72:75], v[116:119], v[184:187]
v_cvt_pk_bf16_f32 v144, v144, v145
v_fmac_f32 v146, v178, v253
v_mfma_f32_16x16x32_bf16 v[184:187], v[88:91], v[120:123], v[184:187]
s_nop 0
v_fmac_f32 v149, v181, v253
v_fmac_f32 v147, v179, v253
v_mfma_f32_16x16x32_bf16 v[184:187], v[56:59], v[112:115], v[184:187]
v_cvt_pk_bf16_f32 v145, v146, v147
v_fmac_f32 v151, v183, v253
v_mfma_f32_16x16x32_bf16 v[188:191], v[60:63], v[112:115], v[188:191]
v_fmac_f32 v150, v182, v253
v_cvt_pk_bf16_f32 v147, v150, v151
v_mfma_f32_16x16x32_bf16 v[188:191], v[76:79], v[116:119], v[188:191]
v_fmac_f32 v148, v180, v253
v_cvt_pk_bf16_f32 v146, v148, v149
v_mfma_f32_16x16x32_bf16 v[188:191], v[92:95], v[120:123], v[188:191]
v_fmac_f32 v152, v184, v253
v_fmac_f32 v155, v187, v253
v_mfma_f32_16x16x32_bf16 v[208:211], a[0:3], v[220:223], 0
v_fmac_f32 v154, v186, v253
v_fmac_f32 v153, v185, v253
v_mfma_f32_16x16x32_bf16 v[208:211], a[4:7], v[216:219], v[208:211]
v_cvt_pk_bf16_f32 v152, v152, v153
v_cvt_pk_bf16_f32 v153, v154, v155
v_mfma_f32_16x16x32_bf16 v[208:211], a[8:11], v[204:207], v[208:211]
v_fmac_f32 v157, v189, v253
v_fmac_f32 v156, v188, v253
v_mfma_f32_16x16x32_bf16 v[208:211], a[12:15], v[212:215], v[208:211]
v_cvt_pk_bf16_f32 v154, v156, v157
v_fmac_f32 v158, v190, v253
v_mfma_f32_16x16x32_bf16 v[224:227], a[28:31], v[212:215], 0
v_fmac_f32 v159, v191, v253
v_cvt_pk_bf16_f32 v155, v158, v159
v_mfma_f32_16x16x32_bf16 v[224:227], a[24:27], v[204:207], v[224:227]
v_pk_max_i16 v155, v155, 0
v_pk_max_i16 v152, v152, 0
v_mfma_f32_16x16x32_bf16 v[224:227], a[20:23], v[216:219], v[224:227]
v_cvt_pk_bf16_f32 v105, v210, v211
v_cvt_pk_bf16_f32 v104, v208, v209
v_mfma_f32_16x16x32_bf16 v[224:227], a[16:19], v[220:223], v[224:227]
ds_read_b128 v[208:211], v247 offset:0
ds_read_b128 v[228:231], v247 offset:272
v_mfma_f32_16x16x32_bf16 v[232:235], a[32:35], v[220:223], 0
ds_read_b128 v[236:239], v247 offset:544
v_pk_max_i16 v153, v153, 0
v_mfma_f32_16x16x32_bf16 v[232:235], a[36:39], v[216:219], v[232:235]
v_mov_b64 v[196:197], 0
v_mov_b64 v[198:199], 0
v_mfma_f32_16x16x32_bf16 v[232:235], a[40:43], v[204:207], v[232:235]
v_cvt_pk_bf16_f32 v106, v224, v225
v_cvt_pk_bf16_f32 v107, v226, v227
v_mfma_f32_16x16x32_bf16 v[232:235], a[44:47], v[212:215], v[232:235]
v_exp_f32 v201, v201
v_mfma_f32_16x16x32_bf16 v[224:227], a[60:63], v[212:215], 0
v_exp_f32 v203, v203
v_mfma_f32_16x16x32_bf16 v[224:227], a[56:59], v[204:207], v[224:227]
v_exp_f32 v202, v202
v_mfma_f32_16x16x32_bf16 v[224:227], a[52:55], v[216:219], v[224:227]
s_waitcnt lgkmcnt(2)
v_cvt_pk_bf16_f32 v138, v200, v201
v_cvt_pk_bf16_f32 v108, v232, v233
v_mfma_f32_16x16x32_bf16 v[224:227], a[48:51], v[220:223], v[224:227]
s_waitcnt lgkmcnt(1)
v_mov_b64 v[232:233], 0
v_cvt_pk_bf16_f32 v109, v234, v235
v_smfmac_f32_16x16x64_bf16 v[196:199], v[208:211], v[48:55], v250
s_waitcnt lgkmcnt(0)
v_mov_b64 v[234:235], 0
v_smfmac_f32_16x16x64_bf16 v[196:199], v[228:231], v[64:71], v250
s_nop 0
v_cvt_pk_bf16_f32 v110, v224, v225
v_smfmac_f32_16x16x64_bf16 v[196:199], v[236:239], v[80:87], v250
v_cvt_pk_bf16_f32 v111, v226, v227
v_smfmac_f32_16x16x64_bf16 v[232:235], v[236:239], v[88:95], v250
v_mov_b64 v[226:227], s[96:97]
v_smfmac_f32_16x16x64_bf16 v[232:235], v[228:231], v[72:79], v250
v_mov_b64 v[224:225], s[96:97]
v_smfmac_f32_16x16x64_bf16 v[232:235], v[208:211], v[56:63], v250
s_nop 1
v_add_f32 v196, v196, v197
v_smfmac_f32_16x16x64_bf16 v[224:227], v[96:99], v[104:111], v250
v_add_f32 v198, v198, v199
v_mfma_f32_16x16x32_bf16 v[208:211], v[0:3], v[104:107], 0
ds_write2_b32 v248, v196, v198 offset0:0 offset1:16
v_mfma_f32_16x16x32_bf16 v[208:211], v[4:7], v[108:111], v[208:211]
v_cvt_pk_bf16_f32 v139, v202, v203
L_entryf:
v_pk_max_i16 v146, v146, 0
v_mfma_f32_16x16x32_bf16 v[196:199], v[12:15], v[108:111], 0
v_pk_max_i16 v145, v145, 0
v_pk_max_i16 v147, v147, 0
v_mfma_f32_16x16x32_bf16 v[196:199], v[8:11], v[104:107], v[196:199]
v_pk_max_i16 v144, v144, 0
v_pk_max_i16 v154, v154, 0
v_mfma_f32_16x16x32_bf16 v[200:203], v[16:19], v[104:107], 0
v_exp_f32 v210, v210
v_mfma_f32_16x16x32_bf16 v[200:203], v[20:23], v[108:111], v[200:203]
v_exp_f32 v209, v209
v_mfma_f32_32x32x16_bf16 v[176:191], v[100:103], v[140:143], 0
buffer_store_dwordx4 v[144:147], v242, s[20:23], s52 offen offset:0 nt
buffer_store_dwordx4 v[152:155], v242, s[20:23], s52 offen offset:64 nt
v_exp_f32 v198, v198
v_exp_f32 v197, v197
v_mfma_f32_16x16x32_bf16 v[144:147], a[192:195], v[220:223], 0
s_add_u32 s52, s46, 16384
v_exp_f32 v196, v196
v_mfma_f32_16x16x32_bf16 v[144:147], a[196:199], v[216:219], v[144:147]
v_mov_b64 v[228:229], 0
v_cvt_pk_bf16_f32 v114, v196, v197
v_mfma_f32_16x16x32_bf16 v[144:147], a[200:203], v[204:207], v[144:147]
v_exp_f32 v199, v199
v_mfma_f32_16x16x32_bf16 v[144:147], a[204:207], v[212:215], v[144:147]
v_cvt_pk_bf16_f32 v115, v198, v199
v_add_f32 v226, v226, v227
v_mfma_f32_16x16x32_bf16 v[148:151], a[220:223], v[212:215], 0
v_exp_f32 v211, v211
v_mfma_f32_16x16x32_bf16 v[148:151], a[216:219], v[204:207], v[148:151]
v_cvt_pk_bf16_f32 v113, v210, v211
v_add_f32 v224, v224, v225
v_mfma_f32_16x16x32_bf16 v[148:151], a[212:215], v[216:219], v[148:151]
v_exp_f32 v208, v208
v_mfma_f32_16x16x32_bf16 v[148:151], a[208:211], v[220:223], v[148:151]
v_cvt_pk_bf16_f32 v112, v208, v209
v_add_f32 v232, v232, v233
v_smfmac_f32_16x16x64_bf16 v[228:231], v[192:195], v[128:135], v250
v_add_f32 v234, v234, v235
v_smfmac_f32_16x16x64_bf16 v[228:231], v[192:195], v[136:143], v250 abid:1
ds_write2_b32 v248, v232, v234 offset0:32 offset1:48
v_mfma_f32_16x16x32_bf16 v[152:155], a[224:227], v[220:223], 0
v_exp_f32 v203, v203
v_mfma_f32_16x16x32_bf16 v[152:155], a[228:231], v[216:219], v[152:155]
v_exp_f32 v201, v201
v_mfma_f32_16x16x32_bf16 v[152:155], a[232:235], v[204:207], v[152:155]
v_exp_f32 v200, v200
v_mfma_f32_16x16x32_bf16 v[152:155], a[236:239], v[212:215], v[152:155]
v_exp_f32 v202, v202
v_mfma_f32_16x16x32_bf16 v[156:159], a[252:255], v[212:215], 0
v_cvt_pk_bf16_f32 v117, v202, v203
v_cvt_pk_bf16_f32 v116, v200, v201
v_mfma_f32_16x16x32_bf16 v[156:159], a[248:251], v[204:207], v[156:159]
ds_read_b128 v[212:215], v240 offset:4736
ds_read_b128 v[208:211], v240 offset:4480
v_mfma_f32_16x16x32_bf16 v[156:159], a[244:247], v[216:219], v[156:159]
ds_read_b128 v[204:207], v240 offset:4224
ds_read_b128 v[216:219], v240 offset:4992
v_mfma_f32_16x16x32_bf16 v[156:159], a[240:243], v[220:223], v[156:159]
v_exp_f32 v224, v224
v_mfma_f32_16x16x32_bf16 v[176:179], v[48:51], v[128:131], v[176:179]
v_exp_f32 v226, v226
v_mfma_f32_16x16x32_bf16 v[176:179], v[64:67], v[132:135], v[176:179]
v_perm_b32 v124, v226, v224, v251
v_perm_b32 v125, v226, v224, v252
v_mfma_f32_16x16x32_bf16 v[176:179], v[80:83], v[136:139], v[176:179]
v_add_f32 v228, v228, v229
v_add_u32 v248, 1600, v248
v_mfma_f32_16x16x32_bf16 v[180:183], v[84:87], v[136:139], v[180:183]
v_rcp_f32 v253, v228
v_mfma_f32_16x16x32_bf16 v[180:183], v[52:55], v[128:131], v[180:183]
v_max3_f32 v254, v254, v228, v253
s_nop 0
v_mfma_f32_16x16x32_bf16 v[180:183], v[68:71], v[132:135], v[180:183]
v_fmac_f32 v161, v177, v253
v_fmac_f32 v160, v176, v253
v_mfma_f32_16x16x32_bf16 v[184:187], v[72:75], v[132:135], v[184:187]
v_fmac_f32 v162, v178, v253
v_cvt_pk_bf16_f32 v160, v160, v161
v_mfma_f32_16x16x32_bf16 v[184:187], v[88:91], v[136:139], v[184:187]
v_fmac_f32 v163, v179, v253
v_cvt_pk_bf16_f32 v161, v162, v163
v_mfma_f32_16x16x32_bf16 v[184:187], v[56:59], v[128:131], v[184:187]
v_fmac_f32 v165, v181, v253
v_fmac_f32 v164, v180, v253
v_mfma_f32_16x16x32_bf16 v[188:191], v[60:63], v[128:131], v[188:191]
v_fmac_f32 v167, v183, v253
v_fmac_f32 v166, v182, v253
v_mfma_f32_16x16x32_bf16 v[188:191], v[76:79], v[132:135], v[188:191]
s_waitcnt lgkmcnt(2)
v_cvt_pk_bf16_f32 v162, v164, v165
v_cvt_pk_bf16_f32 v163, v166, v167
v_mfma_f32_16x16x32_bf16 v[188:191], v[92:95], v[136:139], v[188:191]
s_waitcnt lgkmcnt(0)
v_fmac_f32 v171, v187, v253
v_fmac_f32 v169, v185, v253
v_mfma_f32_16x16x32_bf16 v[196:199], v[24:27], v[104:107], 0
v_fmac_f32 v168, v184, v253
v_fmac_f32 v170, v186, v253
v_mfma_f32_16x16x32_bf16 v[196:199], v[28:31], v[108:111], v[196:199]
s_nop 0
v_fmac_f32 v174, v190, v253
v_fmac_f32 v172, v188, v253
v_mfma_f32_16x16x32_bf16 v[200:203], v[36:39], v[108:111], 0
v_fmac_f32 v173, v189, v253
v_fmac_f32 v175, v191, v253
v_mfma_f32_16x16x32_bf16 v[200:203], v[32:35], v[104:107], v[200:203]
v_cvt_pk_bf16_f32 v168, v168, v169
v_cvt_pk_bf16_f32 v169, v170, v171
v_mfma_f32_16x16x32_bf16 v[220:223], v[40:43], v[104:107], 0
v_cvt_pk_bf16_f32 v171, v174, v175
v_pk_max_i16 v161, v161, 0
v_mfma_f32_16x16x32_bf16 v[220:223], v[44:47], v[108:111], v[220:223]
v_pk_max_i16 v162, v162, 0
v_pk_max_i16 v163, v163, 0
v_mfma_f32_16x16x32_bf16 v[224:227], a[0:3], v[204:207], 0
v_cvt_pk_bf16_f32 v170, v172, v173
v_pk_max_i16 v169, v169, 0
v_mfma_f32_16x16x32_bf16 v[224:227], a[4:7], v[208:211], v[224:227]
v_pk_max_i16 v171, v171, 0
v_pk_max_i16 v160, v160, 0
v_mfma_f32_16x16x32_bf16 v[224:227], a[8:11], v[212:215], v[224:227]
v_pk_max_i16 v168, v168, 0
v_pk_max_i16 v170, v170, 0
v_mfma_f32_16x16x32_bf16 v[224:227], a[12:15], v[216:219], v[224:227]
v_exp_f32 v196, v196
v_mfma_f32_16x16x32_bf16 v[228:231], a[28:31], v[216:219], 0
v_exp_f32 v198, v198
v_mfma_f32_16x16x32_bf16 v[228:231], a[24:27], v[212:215], v[228:231]
v_exp_f32 v199, v199
v_mfma_f32_16x16x32_bf16 v[228:231], a[20:23], v[208:211], v[228:231]
v_exp_f32 v197, v197
v_mfma_f32_16x16x32_bf16 v[228:231], a[16:19], v[204:207], v[228:231]
v_cvt_pk_bf16_f32 v118, v196, v197
v_cvt_pk_bf16_f32 v119, v198, v199
v_mfma_f32_16x16x32_bf16 v[232:235], a[32:35], v[204:207], 0
v_exp_f32 v223, v223
v_mfma_f32_16x16x32_bf16 v[232:235], a[36:39], v[208:211], v[232:235]
v_exp_f32 v201, v201
v_mfma_f32_16x16x32_bf16 v[232:235], a[40:43], v[212:215], v[232:235]
v_exp_f32 v220, v220
v_mfma_f32_16x16x32_bf16 v[232:235], a[44:47], v[216:219], v[232:235]
v_exp_f32 v221, v221
v_mfma_f32_32x32x16_bf16 v[176:191], v[100:103], v[124:127], 0
buffer_store_dwordx4 v[160:163], v242, s[20:23], s53 offen offset:0 nt
buffer_store_dwordx4 v[168:171], v242, s[20:23], s53 offen offset:64 nt
v_exp_f32 v222, v222
v_exp_f32 v203, v203
v_mfma_f32_16x16x32_bf16 v[196:199], a[60:63], v[216:219], 0
s_add_u32 s53, s46, 4096
v_exp_f32 v202, v202
v_mfma_f32_16x16x32_bf16 v[196:199], a[56:59], v[212:215], v[196:199]
s_add_u32 s46, s46, 13107200
v_exp_f32 v200, v200
v_mfma_f32_16x16x32_bf16 v[196:199], a[52:55], v[208:211], v[196:199]
v_cvt_pk_bf16_f32 v121, v202, v203
v_cvt_pk_bf16_f32 v122, v220, v221
v_mfma_f32_16x16x32_bf16 v[196:199], a[48:51], v[204:207], v[196:199]
v_cvt_pk_bf16_f32 v123, v222, v223
v_cvt_pk_bf16_f32 v120, v200, v201
v_mfma_f32_16x16x32_bf16 v[160:163], a[192:195], v[204:207], 0
v_cvt_pk_bf16_f32 v109, v234, v235
v_cvt_pk_bf16_f32 v108, v232, v233
v_mfma_f32_16x16x32_bf16 v[160:163], a[196:199], v[208:211], v[160:163]
v_cvt_pk_bf16_f32 v106, v228, v229
v_cvt_pk_bf16_f32 v105, v226, v227
v_mfma_f32_16x16x32_bf16 v[160:163], a[200:203], v[212:215], v[160:163]
v_cvt_pk_bf16_f32 v110, v196, v197
v_cvt_pk_bf16_f32 v111, v198, v199
v_mfma_f32_16x16x32_bf16 v[160:163], a[204:207], v[216:219], v[160:163]
v_cvt_pk_bf16_f32 v104, v224, v225
v_cvt_pk_bf16_f32 v107, v230, v231
v_mfma_f32_16x16x32_bf16 v[164:167], a[220:223], v[216:219], 0
v_mfma_f32_16x16x32_bf16 v[164:167], a[216:219], v[212:215], v[164:167]
v_mov_b64 v[196:197], 0
v_mfma_f32_16x16x32_bf16 v[164:167], a[212:215], v[208:211], v[164:167]
v_mfma_f32_16x16x32_bf16 v[164:167], a[208:211], v[204:207], v[164:167]
v_mfma_f32_16x16x32_bf16 v[168:171], a[224:227], v[204:207], 0
v_mfma_f32_16x16x32_bf16 v[168:171], a[228:231], v[208:211], v[168:171]
v_mfma_f32_16x16x32_bf16 v[168:171], a[232:235], v[212:215], v[168:171]
v_mfma_f32_16x16x32_bf16 v[168:171], a[236:239], v[216:219], v[168:171]
v_mov_b64 v[200:201], s[96:97]
v_mov_b64 v[202:203], s[96:97]
v_smfmac_f32_16x16x64_bf16 v[196:199], v[192:195], v[112:119], v250
v_smfmac_f32_16x16x64_bf16 v[196:199], v[192:195], v[120:127], v250 abid:1
s_nop 2
v_mfma_f32_16x16x32_bf16 v[172:175], a[252:255], v[216:219], 0
s_nop 2
v_mfma_f32_16x16x32_bf16 v[172:175], a[248:251], v[212:215], v[172:175]
v_add_f32 v196, v196, v197
v_mfma_f32_16x16x32_bf16 v[172:175], a[244:247], v[208:211], v[172:175]
v_rcp_f32 v253, v196
v_mfma_f32_16x16x32_bf16 v[172:175], a[240:243], v[204:207], v[172:175]
v_max3_f32 v254, v254, v196, v253
v_smfmac_f32_16x16x64_bf16 v[200:203], v[96:99], v[104:111], v250
s_nop 2
v_mfma_f32_16x16x32_bf16 v[196:199], v[0:3], v[104:107], 0
s_nop 2
v_mfma_f32_16x16x32_bf16 v[196:199], v[4:7], v[108:111], v[196:199]
v_add_f32 v202, v202, v203
v_add_f32 v200, v200, v201
v_mfma_f32_16x16x32_bf16 v[204:207], v[12:15], v[108:111], 0
v_exp_f32 v200, v200
v_mfma_f32_16x16x32_bf16 v[204:207], v[8:11], v[104:107], v[204:207]
ds_read_b128 v[212:215], v240 offset:9216
ds_read_b128 v[224:227], v240 offset:8960
v_mfma_f32_16x16x32_bf16 v[216:219], v[16:19], v[104:107], 0
ds_read_b128 v[208:211], v240 offset:8448
ds_read_b128 v[220:223], v240 offset:8704
v_mfma_f32_16x16x32_bf16 v[216:219], v[20:23], v[108:111], v[216:219]
v_exp_f32 v202, v202
v_mfma_f32_16x16x32_bf16 v[176:179], v[48:51], v[112:115], v[176:179]
v_perm_b32 v141, v202, v200, v252
v_perm_b32 v140, v202, v200, v251
v_mfma_f32_16x16x32_bf16 v[176:179], v[64:67], v[116:119], v[176:179]
v_exp_f32 v198, v198
v_mfma_f32_16x16x32_bf16 v[176:179], v[80:83], v[120:123], v[176:179]
v_exp_f32 v199, v199
v_mfma_f32_16x16x32_bf16 v[180:183], v[84:87], v[120:123], v[180:183]
v_exp_f32 v196, v196
v_mfma_f32_16x16x32_bf16 v[180:183], v[52:55], v[112:115], v[180:183]
v_exp_f32 v197, v197
v_mfma_f32_16x16x32_bf16 v[180:183], v[68:71], v[116:119], v[180:183]
v_cvt_pk_bf16_f32 v129, v198, v199
v_cvt_pk_bf16_f32 v128, v196, v197
v_mfma_f32_16x16x32_bf16 v[184:187], v[72:75], v[116:119], v[184:187]
v_exp_f32 v204, v204
v_mfma_f32_16x16x32_bf16 v[184:187], v[88:91], v[120:123], v[184:187]
v_exp_f32 v205, v205
v_mfma_f32_16x16x32_bf16 v[184:187], v[56:59], v[112:115], v[184:187]
v_exp_f32 v206, v206
v_mfma_f32_16x16x32_bf16 v[188:191], v[60:63], v[112:115], v[188:191]
v_exp_f32 v207, v207
v_mfma_f32_16x16x32_bf16 v[188:191], v[76:79], v[116:119], v[188:191]
s_waitcnt lgkmcnt(2)
v_cvt_pk_bf16_f32 v131, v206, v207
v_cvt_pk_bf16_f32 v130, v204, v205
v_mfma_f32_16x16x32_bf16 v[188:191], v[92:95], v[120:123], v[188:191]
s_waitcnt lgkmcnt(0)
v_fmac_f32 v155, v187, v253
v_fmac_f32 v144, v176, v253
v_mfma_f32_16x16x32_bf16 v[200:203], v[24:27], v[104:107], 0
v_fmac_f32 v153, v185, v253
v_fmac_f32 v152, v184, v253
v_mfma_f32_16x16x32_bf16 v[200:203], v[28:31], v[108:111], v[200:203]
s_nop 0
v_fmac_f32 v158, v190, v253
v_fmac_f32 v157, v189, v253
v_mfma_f32_16x16x32_bf16 v[228:231], v[36:39], v[108:111], 0
v_fmac_f32 v145, v177, v253
v_fmac_f32 v148, v180, v253
v_mfma_f32_16x16x32_bf16 v[228:231], v[32:35], v[104:107], v[228:231]
v_fmac_f32 v159, v191, v253
v_cvt_pk_bf16_f32 v152, v152, v153
v_mfma_f32_16x16x32_bf16 v[232:235], v[40:43], v[104:107], 0
v_fmac_f32 v146, v178, v253
v_cvt_pk_bf16_f32 v144, v144, v145
v_mfma_f32_16x16x32_bf16 v[232:235], v[44:47], v[108:111], v[232:235]
v_fmac_f32 v147, v179, v253
v_cvt_pk_bf16_f32 v145, v146, v147
v_mfma_f32_16x16x32_bf16 v[236:239], a[0:3], v[208:211], 0
v_fmac_f32 v151, v183, v253
v_pk_max_i16 v145, v145, 0
v_mfma_f32_16x16x32_bf16 v[236:239], a[4:7], v[220:223], v[236:239]
v_fmac_f32 v154, v186, v253
v_fmac_f32 v150, v182, v253
v_mfma_f32_16x16x32_bf16 v[236:239], a[8:11], v[224:227], v[236:239]
v_fmac_f32 v156, v188, v253
v_cvt_pk_bf16_f32 v153, v154, v155
v_mfma_f32_16x16x32_bf16 v[236:239], a[12:15], v[212:215], v[236:239]
v_cvt_pk_bf16_f32 v154, v156, v157
v_pk_max_i16 v154, v154, 0
v_mfma_f32_16x16x32_bf16 v[196:199], a[28:31], v[212:215], 0
v_cvt_pk_bf16_f32 v147, v150, v151
v_pk_max_i16 v153, v153, 0
v_mfma_f32_16x16x32_bf16 v[196:199], a[24:27], v[224:227], v[196:199]
v_fmac_f32 v149, v181, v253
v_cvt_pk_bf16_f32 v146, v148, v149
v_mfma_f32_16x16x32_bf16 v[196:199], a[20:23], v[220:223], v[196:199]
v_cvt_pk_bf16_f32 v155, v158, v159
v_pk_max_i16 v155, v155, 0
v_mfma_f32_16x16x32_bf16 v[196:199], a[16:19], v[208:211], v[196:199]
v_pk_max_i16 v147, v147, 0
v_pk_max_i16 v144, v144, 0
v_mfma_f32_16x16x32_bf16 v[204:207], a[32:35], v[208:211], 0
v_pk_max_i16 v152, v152, 0
v_pk_max_i16 v146, v146, 0
v_mfma_f32_16x16x32_bf16 v[204:207], a[36:39], v[220:223], v[204:207]
v_cvt_pk_bf16_f32 v105, v238, v239
v_cvt_pk_bf16_f32 v104, v236, v237
v_mfma_f32_16x16x32_bf16 v[204:207], a[40:43], v[224:227], v[204:207]
v_cvt_pk_bf16_f32 v107, v198, v199
v_cvt_pk_bf16_f32 v106, v196, v197
v_mfma_f32_16x16x32_bf16 v[204:207], a[44:47], v[212:215], v[204:207]
v_exp_f32 v217, v217
v_mfma_f32_32x32x16_bf16 v[176:191], v[100:103], v[140:143], 0
buffer_store_dwordx4 v[144:147], v242, s[20:23], s52 offen offset:0 nt
buffer_store_dwordx4 v[152:155], v242, s[20:23], s52 offen offset:64 nt
v_exp_f32 v216, v216
v_exp_f32 v230, v230
v_mfma_f32_16x16x32_bf16 v[196:199], a[60:63], v[212:215], 0
v_exp_f32 v219, v219
v_mfma_f32_16x16x32_bf16 v[196:199], a[56:59], v[224:227], v[196:199]
v_cvt_pk_bf16_f32 v132, v216, v217
v_cvt_pk_bf16_f32 v109, v206, v207
v_mfma_f32_16x16x32_bf16 v[196:199], a[52:55], v[220:223], v[196:199]
v_exp_f32 v218, v218
v_mfma_f32_16x16x32_bf16 v[196:199], a[48:51], v[208:211], v[196:199]
v_cvt_pk_bf16_f32 v133, v218, v219
v_cvt_pk_bf16_f32 v108, v204, v205
v_mfma_f32_16x16x32_bf16 v[144:147], a[192:195], v[208:211], 0
v_exp_f32 v201, v201
v_mfma_f32_16x16x32_bf16 v[144:147], a[196:199], v[220:223], v[144:147]
v_exp_f32 v203, v203
v_mfma_f32_16x16x32_bf16 v[144:147], a[200:203], v[224:227], v[144:147]
v_exp_f32 v202, v202
v_mfma_f32_16x16x32_bf16 v[144:147], a[204:207], v[212:215], v[144:147]
v_exp_f32 v200, v200
v_mfma_f32_16x16x32_bf16 v[148:151], a[220:223], v[212:215], 0
v_cvt_pk_bf16_f32 v135, v202, v203
v_cvt_pk_bf16_f32 v134, v200, v201
v_mfma_f32_16x16x32_bf16 v[148:151], a[216:219], v[224:227], v[148:151]
v_exp_f32 v229, v229
v_mfma_f32_16x16x32_bf16 v[148:151], a[212:215], v[220:223], v[148:151]
v_exp_f32 v228, v228
v_mfma_f32_16x16x32_bf16 v[148:151], a[208:211], v[208:211], v[148:151]
v_exp_f32 v231, v231
v_mfma_f32_16x16x32_bf16 v[152:155], a[224:227], v[208:211], 0
v_cvt_pk_bf16_f32 v136, v228, v229
v_cvt_pk_bf16_f32 v137, v230, v231
v_mfma_f32_16x16x32_bf16 v[152:155], a[228:231], v[220:223], v[152:155]
v_mov_b64 v[200:201], 0
v_cvt_pk_bf16_f32 v110, v196, v197
v_mfma_f32_16x16x32_bf16 v[152:155], a[232:235], v[224:227], v[152:155]
v_exp_f32 v235, v235
v_mfma_f32_16x16x32_bf16 v[152:155], a[236:239], v[212:215], v[152:155]
v_exp_f32 v232, v232
v_mfma_f32_16x16x32_bf16 v[156:159], a[252:255], v[212:215], 0
v_exp_f32 v234, v234
v_mfma_f32_16x16x32_bf16 v[156:159], a[248:251], v[224:227], v[156:159]
v_cvt_pk_bf16_f32 v139, v234, v235
v_cvt_pk_bf16_f32 v111, v198, v199
v_mfma_f32_16x16x32_bf16 v[156:159], a[244:247], v[220:223], v[156:159]
v_exp_f32 v233, v233
v_mfma_f32_16x16x32_bf16 v[156:159], a[240:243], v[208:211], v[156:159]
v_cvt_pk_bf16_f32 v138, v232, v233
v_mov_b64 v[198:199], s[96:97]
v_smfmac_f32_16x16x64_bf16 v[200:203], v[192:195], v[128:135], v250
v_mov_b64 v[196:197], s[96:97]
v_smfmac_f32_16x16x64_bf16 v[200:203], v[192:195], v[136:143], v250 abid:1
s_nop 2
v_smfmac_f32_16x16x64_bf16 v[196:199], v[96:99], v[104:111], v250
s_nop 2
v_mfma_f32_16x16x32_bf16 v[204:207], v[0:3], v[104:107], 0
v_add_f32 v200, v200, v201
s_nop 0
v_mfma_f32_16x16x32_bf16 v[204:207], v[4:7], v[108:111], v[204:207]
v_rcp_f32 v253, v200
v_mfma_f32_16x16x32_bf16 v[208:211], v[12:15], v[108:111], 0
v_max3_f32 v254, v254, v200, v253
v_add_f32 v198, v198, v199
v_mfma_f32_16x16x32_bf16 v[208:211], v[8:11], v[104:107], v[208:211]
ds_read_b128 v[224:227], v240 offset:12672
v_add_f32 v196, v196, v197
v_mfma_f32_16x16x32_bf16 v[220:223], v[16:19], v[104:107], 0
ds_read_b128 v[216:219], v240 offset:13440
ds_read_b128 v[228:231], v240 offset:13184
v_mfma_f32_16x16x32_bf16 v[220:223], v[20:23], v[108:111], v[220:223]
ds_read_b128 v[212:215], v240 offset:12928
v_add_u32 v240, s56, v240
v_mfma_f32_16x16x32_bf16 v[176:179], v[48:51], v[128:131], v[176:179]
s_sub_u32 s56, 0, s56
v_exp_f32 v196, v196
v_mfma_f32_16x16x32_bf16 v[176:179], v[64:67], v[132:135], v[176:179]
v_exp_f32 v198, v198
v_mfma_f32_16x16x32_bf16 v[176:179], v[80:83], v[136:139], v[176:179]
v_perm_b32 v125, v198, v196, v252
v_perm_b32 v124, v198, v196, v251
v_mfma_f32_16x16x32_bf16 v[180:183], v[84:87], v[136:139], v[180:183]
v_exp_f32 v220, v220
v_mfma_f32_16x16x32_bf16 v[180:183], v[52:55], v[128:131], v[180:183]
v_exp_f32 v222, v222
v_mfma_f32_16x16x32_bf16 v[180:183], v[68:71], v[132:135], v[180:183]
v_exp_f32 v223, v223
v_mfma_f32_16x16x32_bf16 v[184:187], v[72:75], v[132:135], v[184:187]
v_exp_f32 v221, v221
v_mfma_f32_16x16x32_bf16 v[184:187], v[88:91], v[136:139], v[184:187]
v_cvt_pk_bf16_f32 v116, v220, v221
v_cvt_pk_bf16_f32 v117, v222, v223
v_mfma_f32_16x16x32_bf16 v[184:187], v[56:59], v[128:131], v[184:187]
s_nop 0
v_fmac_f32 v167, v183, v253
v_fmac_f32 v160, v176, v253
v_mfma_f32_16x16x32_bf16 v[188:191], v[60:63], v[128:131], v[188:191]
v_mov_b32 v196, s45
v_fmac_f32 v161, v177, v253
v_mfma_f32_16x16x32_bf16 v[188:191], v[76:79], v[132:135], v[188:191]
s_waitcnt lgkmcnt(3)
v_cvt_pk_bf16_f32 v160, v160, v161
v_fmac_f32 v168, v184, v253
v_mfma_f32_16x16x32_bf16 v[188:191], v[92:95], v[136:139], v[188:191]
s_waitcnt lgkmcnt(1)
v_fmac_f32 v171, v187, v253
v_fmac_f32 v169, v185, v253
v_mfma_f32_16x16x32_bf16 v[200:203], v[24:27], v[104:107], 0
s_waitcnt lgkmcnt(0)
v_cvt_pk_bf16_f32 v168, v168, v169
v_pk_max_i16 v168, v168, 0
v_mfma_f32_16x16x32_bf16 v[200:203], v[28:31], v[108:111], v[200:203]
s_waitcnt vmcnt(6)
ds_write_b16 v246, v196 offset:816
v_fmac_f32 v172, v188, v253
v_fmac_f32 v173, v189, v253
v_mfma_f32_16x16x32_bf16 v[196:199], v[36:39], v[108:111], 0
v_fmac_f32 v174, v190, v253
v_fmac_f32 v166, v182, v253
v_mfma_f32_16x16x32_bf16 v[196:199], v[32:35], v[104:107], v[196:199]
v_fmac_f32 v163, v179, v253
v_fmac_f32 v164, v180, v253
v_mfma_f32_16x16x32_bf16 v[232:235], v[40:43], v[104:107], 0
v_fmac_f32 v162, v178, v253
v_cvt_pk_bf16_f32 v161, v162, v163
v_mfma_f32_16x16x32_bf16 v[232:235], v[44:47], v[108:111], v[232:235]
v_fmac_f32 v170, v186, v253
v_cvt_pk_bf16_f32 v169, v170, v171
v_mfma_f32_16x16x32_bf16 v[236:239], a[0:3], v[224:227], 0
v_cvt_pk_bf16_f32 v170, v172, v173
v_pk_max_i16 v169, v169, 0
v_mfma_f32_16x16x32_bf16 v[236:239], a[4:7], v[212:215], v[236:239]
v_fmac_f32 v165, v181, v253
v_cvt_pk_bf16_f32 v162, v164, v165
v_mfma_f32_16x16x32_bf16 v[236:239], a[8:11], v[228:231], v[236:239]
v_pk_max_i16 v162, v162, 0
v_pk_max_i16 v170, v170, 0
v_mfma_f32_16x16x32_bf16 v[236:239], a[12:15], v[216:219], v[236:239]
v_fmac_f32 v175, v191, v253
v_cvt_pk_bf16_f32 v171, v174, v175
v_mfma_f32_16x16x32_bf16 v[220:223], a[28:31], v[216:219], 0
v_pk_max_i16 v161, v161, 0
v_cvt_pk_bf16_f32 v163, v166, v167
v_mfma_f32_16x16x32_bf16 v[220:223], a[24:27], v[228:231], v[220:223]
v_pk_max_i16 v163, v163, 0
v_pk_max_i16 v160, v160, 0
v_mfma_f32_16x16x32_bf16 v[220:223], a[20:23], v[212:215], v[220:223]
v_cvt_pk_bf16_f32 v105, v238, v239
v_cvt_pk_bf16_f32 v104, v236, v237
v_mfma_f32_16x16x32_bf16 v[220:223], a[16:19], v[224:227], v[220:223]
v_pk_max_i16 v171, v171, 0
s_nop 0
v_mfma_f32_16x16x32_bf16 v[236:239], a[32:35], v[224:227], 0
v_exp_f32 v197, v197
v_mfma_f32_16x16x32_bf16 v[236:239], a[36:39], v[212:215], v[236:239]
v_exp_f32 v196, v196
v_mfma_f32_16x16x32_bf16 v[236:239], a[40:43], v[228:231], v[236:239]
s_nop 0
v_cvt_pk_bf16_f32 v106, v220, v221
v_cvt_pk_bf16_f32 v107, v222, v223
v_mfma_f32_16x16x32_bf16 v[236:239], a[44:47], v[216:219], v[236:239]
v_cvt_pk_bf16_f32 v120, v196, v197
s_nop 0
v_mfma_f32_32x32x16_bf16 v[176:191], v[100:103], v[124:127], 0
s_cmp_lg_u32 s45, 0
buffer_store_dwordx4 v[160:163], v242, s[20:23], s53 offen offset:0 nt
s_cbranch_scc1 L_loopf
buffer_store_dwordx4 v[168:171], v242, s[20:23], s53 offen offset:64 nt
v_mfma_f32_16x16x32_bf16 v[220:223], a[60:63], v[216:219], 0
s_barrier
v_mfma_f32_16x16x32_bf16 v[220:223], a[56:59], v[228:231], v[220:223]
s_add_u32 s52, s47, 8192
v_exp_f32 v198, v198
v_mfma_f32_16x16x32_bf16 v[220:223], a[52:55], v[212:215], v[220:223]
s_lshl_b32 s55, s41, 9
v_exp_f32 v199, v199
v_mfma_f32_16x16x32_bf16 v[220:223], a[48:51], v[224:227], v[220:223]
s_add_u32 s53, s47, 12288
v_cvt_pk_bf16_f32 v121, v198, v199
v_cvt_pk_bf16_f32 v108, v236, v237
v_mfma_f32_16x16x32_bf16 v[160:163], a[192:195], v[224:227], 0
v_mov_b64 v[196:197], s[96:97]
v_mov_b64 v[198:199], s[96:97]
v_mfma_f32_16x16x32_bf16 v[160:163], a[196:199], v[212:215], v[160:163]
s_nop 0
v_cvt_pk_bf16_f32 v111, v222, v223
v_cvt_pk_bf16_f32 v110, v220, v221
v_mfma_f32_16x16x32_bf16 v[160:163], a[200:203], v[228:231], v[160:163]
v_cvt_pk_bf16_f32 v109, v238, v239
v_mbcnt_lo_u32_b32 v243, -1, 0
v_mfma_f32_16x16x32_bf16 v[160:163], a[204:207], v[216:219], v[160:163]
v_exp_f32 v200, v200
v_mfma_f32_16x16x32_bf16 v[164:167], a[220:223], v[216:219], 0
v_exp_f32 v201, v201
v_mfma_f32_16x16x32_bf16 v[164:167], a[216:219], v[228:231], v[164:167]
v_exp_f32 v202, v202
v_mfma_f32_16x16x32_bf16 v[164:167], a[212:215], v[212:215], v[164:167]
v_exp_f32 v203, v203
v_mfma_f32_16x16x32_bf16 v[164:167], a[208:211], v[224:227], v[164:167]
v_cvt_pk_bf16_f32 v119, v202, v203
v_cvt_pk_bf16_f32 v118, v200, v201
v_mfma_f32_16x16x32_bf16 v[168:171], a[224:227], v[224:227], 0
v_exp_f32 v206, v206
v_mfma_f32_16x16x32_bf16 v[168:171], a[228:231], v[212:215], v[168:171]
v_exp_f32 v209, v209
v_mfma_f32_16x16x32_bf16 v[168:171], a[232:235], v[228:231], v[168:171]
v_exp_f32 v210, v210
v_mfma_f32_16x16x32_bf16 v[168:171], a[236:239], v[216:219], v[168:171]
v_exp_f32 v207, v207
v_mfma_f32_16x16x32_bf16 v[172:175], a[252:255], v[216:219], 0
ds_read_b128 v[216:219], v240 offset:768
v_cvt_pk_bf16_f32 v113, v206, v207
v_mfma_f32_16x16x32_bf16 v[172:175], a[248:251], v[228:231], v[172:175]
v_exp_f32 v211, v211
v_mfma_f32_16x16x32_bf16 v[172:175], a[244:247], v[212:215], v[172:175]
ds_read_b128 v[212:215], v240 offset:512
v_cvt_pk_bf16_f32 v115, v210, v211
v_mfma_f32_16x16x32_bf16 v[172:175], a[240:243], v[224:227], v[172:175]
v_exp_f32 v208, v208
v_smfmac_f32_16x16x64_bf16 v[196:199], v[96:99], v[104:111], v250
s_mul_i32 s54, s41, 12800
s_add_u32 s54, s54, 101376
v_cvt_pk_bf16_f32 v114, v208, v209
v_mfma_f32_16x16x32_bf16 v[200:203], v[0:3], v[104:107], 0
ds_read_b128 v[208:211], v240 offset:256
v_mov_b64 v[224:225], 0
v_mfma_f32_16x16x32_bf16 v[200:203], v[4:7], v[108:111], v[200:203]
v_exp_f32 v204, v204
v_mfma_f32_16x16x32_bf16 v[220:223], v[12:15], v[108:111], 0
v_exp_f32 v205, v205
v_mfma_f32_16x16x32_bf16 v[220:223], v[8:11], v[104:107], v[220:223]
v_cvt_pk_bf16_f32 v112, v204, v205
v_add_f32 v196, v196, v197
v_mfma_f32_16x16x32_bf16 v[228:231], v[16:19], v[104:107], 0
ds_read_b128 v[204:207], v240 offset:0
v_add_f32 v198, v198, v199
v_mfma_f32_16x16x32_bf16 v[228:231], v[20:23], v[108:111], v[228:231]
v_exp_f32 v234, v234
v_smfmac_f32_16x16x64_bf16 v[224:227], v[192:195], v[112:119], v250
s_mov_b32 vcc_lo, 0xf0000f
s_mov_b32 vcc_hi, 0xf0000f00
v_exp_f32 v233, v233
v_exp_f32 v235, v235
v_exp_f32 v232, v232
v_cvt_pk_bf16_f32 v123, v234, v235
v_cvt_pk_bf16_f32 v122, v232, v233
v_exp_f32 v196, v196
v_mbcnt_hi_u32_b32 v243, -1, v243
v_smfmac_f32_16x16x64_bf16 v[224:227], v[192:195], v[120:127], v250 abid:1
s_waitcnt lgkmcnt(3)
s_lshl_b32 s48, s43, 7
s_add_u32 s48, s48, s44
s_add_u32 s48, s48, 0
v_mfma_f32_16x16x32_bf16 v[176:179], v[80:83], v[120:123], v[176:179]
s_waitcnt lgkmcnt(2)
v_exp_f32 v198, v198
v_mfma_f32_16x16x32_bf16 v[176:179], v[64:67], v[116:119], v[176:179]
v_perm_b32 v140, v198, v196, v251
v_perm_b32 v141, v198, v196, v252
v_mfma_f32_16x16x32_bf16 v[176:179], v[48:51], v[112:115], v[176:179]
s_waitcnt lgkmcnt(1)
v_add_f32 v224, v224, v225
v_bfe_u32 v244, v243, 2, 2
v_mfma_f32_16x16x32_bf16 v[196:199], v[24:27], v[104:107], 0
v_rcp_f32 v253, v224
v_mfma_f32_16x16x32_bf16 v[196:199], v[28:31], v[108:111], v[196:199]
v_max3_f32 v254, v254, v224, v253
v_mov_b32 v245, s54
v_mfma_f32_16x16x32_bf16 v[180:183], v[52:55], v[112:115], v[180:183]
v_fmac_f32 v144, v176, v253
v_fmac_f32 v145, v177, v253
v_mfma_f32_16x16x32_bf16 v[180:183], v[68:71], v[116:119], v[180:183]
s_waitcnt lgkmcnt(0)
v_fmac_f32 v146, v178, v253
v_fmac_f32 v147, v179, v253
v_mfma_f32_16x16x32_bf16 v[180:183], v[84:87], v[120:123], v[180:183]
v_cvt_pk_bf16_f32 v144, v144, v145
v_cvt_pk_bf16_f32 v145, v146, v147
v_mfma_f32_16x16x32_bf16 v[232:235], v[32:35], v[104:107], 0
v_pk_max_i16 v144, v144, 0
v_pk_max_i16 v145, v145, 0
v_mfma_f32_16x16x32_bf16 v[232:235], v[36:39], v[108:111], v[232:235]
v_mul_u32_u24 v244, 1600, v244
v_add_u32 v245, v244, v245
v_mfma_f32_16x16x32_bf16 v[184:187], v[56:59], v[112:115], v[184:187]
v_fmac_f32 v148, v180, v253
v_fmac_f32 v149, v181, v253
v_mfma_f32_16x16x32_bf16 v[184:187], v[72:75], v[116:119], v[184:187]
v_fmac_f32 v150, v182, v253
v_fmac_f32 v151, v183, v253
v_mfma_f32_16x16x32_bf16 v[184:187], v[88:91], v[120:123], v[184:187]
v_cvt_pk_bf16_f32 v146, v148, v149
v_cvt_pk_bf16_f32 v147, v150, v151
v_mfma_f32_16x16x32_bf16 v[224:227], v[40:43], v[104:107], 0
v_pk_max_i16 v146, v146, 0
v_pk_max_i16 v147, v147, 0
v_mfma_f32_16x16x32_bf16 v[224:227], v[44:47], v[108:111], v[224:227]
v_bfe_u32 v244, v243, 0, 2
v_mul_u32_u24 v244, 272, v244
v_mfma_f32_16x16x32_bf16 v[188:191], v[60:63], v[112:115], v[188:191]
v_fmac_f32 v152, v184, v253
v_fmac_f32 v153, v185, v253
v_mfma_f32_16x16x32_bf16 v[188:191], v[76:79], v[116:119], v[188:191]
v_fmac_f32 v154, v186, v253
v_fmac_f32 v155, v187, v253
v_mfma_f32_16x16x32_bf16 v[188:191], v[92:95], v[120:123], v[188:191]
v_cvt_pk_bf16_f32 v152, v152, v153
v_cvt_pk_bf16_f32 v153, v154, v155
v_mfma_f32_16x16x32_bf16 v[0:3], a[192:195], v[204:207], 0
v_pk_max_i16 v152, v152, 0
v_pk_max_i16 v153, v153, 0
v_mfma_f32_16x16x32_bf16 v[0:3], a[196:199], v[208:211], v[0:3]
v_add_u32 v245, v244, v245
v_bfe_u32 v244, v243, 4, 2
v_mfma_f32_16x16x32_bf16 v[0:3], a[200:203], v[212:215], v[0:3]
v_fmac_f32 v156, v188, v253
v_fmac_f32 v157, v189, v253
v_mfma_f32_16x16x32_bf16 v[0:3], a[204:207], v[216:219], v[0:3]
v_fmac_f32 v158, v190, v253
v_fmac_f32 v159, v191, v253
v_mfma_f32_16x16x32_bf16 v[4:7], a[220:223], v[216:219], 0
v_cvt_pk_bf16_f32 v154, v156, v157
v_cvt_pk_bf16_f32 v155, v158, v159
v_mfma_f32_16x16x32_bf16 v[4:7], a[216:219], v[212:215], v[4:7]
v_pk_max_i16 v154, v154, 0
v_pk_max_i16 v155, v155, 0
v_mfma_f32_16x16x32_bf16 v[4:7], a[212:215], v[208:211], v[4:7]
v_lshl_add_u32 v245, v244, 4, v245
v_mov_b32 v249, s54
v_mfma_f32_16x16x32_bf16 v[4:7], a[208:211], v[204:207], v[4:7]
v_bfe_u32 v244, v243, 2, 2
v_add_u32 v249, 256, v249
v_mfma_f32_16x16x32_bf16 v[8:11], a[224:227], v[204:207], 0
ds_read_b128 v[236:239], v240 offset:4480
v_mul_u32_u24 v244, 1600, v244
v_mfma_f32_16x16x32_bf16 v[8:11], a[228:231], v[208:211], v[8:11]
v_add_u32 v249, v244, v249
v_bfe_u32 v244, v243, 0, 2
v_mfma_f32_16x16x32_bf16 v[8:11], a[232:235], v[212:215], v[8:11]
v_mul_u32_u24 v244, 272, v244
v_add_u32 v249, v244, v249
v_mfma_f32_16x16x32_bf16 v[8:11], a[236:239], v[216:219], v[8:11]
v_mov_b32 v247, s54
v_bfe_u32 v244, v243, 4, 2
v_mfma_f32_16x16x32_bf16 v[12:15], a[252:255], v[216:219], 0
ds_read_b128 v[216:219], v240 offset:4736
v_add_u32 v247, 1088, v247
v_mfma_f32_16x16x32_bf16 v[12:15], a[248:251], v[212:215], v[12:15]
ds_read_b128 v[212:215], v240 offset:4992
v_mul_u32_u24 v244, 1600, v244
v_mfma_f32_16x16x32_bf16 v[12:15], a[244:247], v[208:211], v[12:15]
ds_read_b128 v[208:211], v245 offset:0
v_add_u32 v247, v244, v247
v_mfma_f32_16x16x32_bf16 v[12:15], a[240:243], v[204:207], v[12:15]
ds_read_b128 v[204:207], v245 offset:64
v_bfe_u32 v244, v243, 0, 4
v_mfma_f32_32x32x16_bf16 v[176:191], v[100:103], v[140:143], 0
buffer_store_dwordx4 v[144:147], v242, s[20:23], s52 offen offset:0 nt
buffer_store_dwordx4 v[152:155], v242, s[20:23], s52 offen offset:64 nt
v_lshl_add_u32 v247, v244, 3, v247
ds_read_b64 v[32:33], v247 offset:0
ds_read_b64 v[34:35], v247 offset:6400
ds_read_b64 v[36:37], v247 offset:128
ds_read_b64 v[38:39], v247 offset:6528
ds_read_b64 v[40:41], v247 offset:256
ds_read_b64 v[42:43], v247 offset:6656
ds_read_b64 v[44:45], v247 offset:384
ds_read_b64 v[46:47], v247 offset:6784
v_mov_b32 v248, s55
v_add_u32 v248, 156928, v248
v_bfe_u32 v244, v243, 0, 4
v_lshl_add_u32 v248, v244, 4, v248
ds_read_b64 v[104:105], v248 offset:0
ds_read_b32 v110, v248 offset:8
ds_read_b64 v[108:109], v248 offset:256
ds_read_b32 v111, v248 offset:264
v_mov_b64 v[106:107], 0
v_exp_f32 v200, v200
v_exp_f32 v201, v201
v_exp_f32 v202, v202
v_exp_f32 v203, v203
v_cvt_pk_bf16_f32 v128, v200, v201
v_cvt_pk_bf16_f32 v129, v202, v203
ds_read_b128 v[200:203], v245 offset:128
v_exp_f32 v220, v220
s_waitcnt lgkmcnt(4)
v_cndmask_b32 v104, 0, v104, vcc
v_cndmask_b32 v105, 0, v105, vcc
v_exp_f32 v221, v221
v_mov_b32 v246, 24576
v_mfma_f32_16x16x32_bf16 v[208:211], v[32:35], v[104:107], v[208:211]
s_waitcnt lgkmcnt(1)
v_exp_f32 v222, v222
v_mfma_f32_16x16x32_bf16 v[204:207], v[36:39], v[104:107], v[204:207]
v_exp_f32 v223, v223
v_cvt_pk_bf16_f32 v130, v220, v221
v_cvt_pk_bf16_f32 v131, v222, v223
v_bfe_u32 v244, v243, 0, 2
s_waitcnt lgkmcnt(0)
v_mfma_f32_16x16x32_bf16 v[200:203], v[40:43], v[104:107], v[200:203]
ds_read_b128 v[220:223], v245 offset:192
v_exp_f32 v228, v228
v_exp_f32 v229, v229
v_exp_f32 v230, v230
v_exp_f32 v231, v231
v_cvt_pk_bf16_f32 v132, v228, v229
v_cvt_pk_bf16_f32 v133, v230, v231
ds_read_b128 v[228:231], v249 offset:0
v_exp_f32 v232, v232
v_exp_f32 v233, v233
v_exp_f32 v196, v196
v_cvt_pk_bf16_f32 v136, v232, v233
s_waitcnt lgkmcnt(1)
v_mfma_f32_16x16x32_bf16 v[220:223], v[44:47], v[104:107], v[220:223]
v_exp_f32 v197, v197
v_exp_f32 v198, v198
v_exp_f32 v199, v199
v_exp_f32 v234, v234
v_exp_f32 v235, v235
v_cvt_pk_bf16_f32 v134, v196, v197
v_cvt_pk_bf16_f32 v135, v198, v199
v_mov_b64 v[232:233], 0
v_cvt_pk_bf16_f32 v137, v234, v235
v_lshl_add_u32 v246, v244, 8, v246
v_smfmac_f32_16x16x64_bf16 v[232:235], v[192:195], v[128:135], v250
s_waitcnt lgkmcnt(0)
ds_read_b128 v[196:199], v240 offset:4224
v_exp_f32 v224, v224
v_exp_f32 v225, v225
v_exp_f32 v226, v226
v_exp_f32 v227, v227
v_cvt_pk_bf16_f32 v138, v224, v225
v_cvt_pk_bf16_f32 v139, v226, v227
v_add_f32 v228, v228, v229
v_add_f32 v230, v230, v231
v_smfmac_f32_16x16x64_bf16 v[232:235], v[192:195], v[136:143], v250 abid:1
ds_read_b128 v[224:227], v245 offset:6400
v_add_f32 v228, v228, v110
v_add_f32 v228, v228, v230
v_rcp_f32 v229, v228
v_bfe_u32 v244, v243, 2, 2
s_waitcnt lgkmcnt(1)
v_mfma_f32_16x16x32_bf16 v[16:19], a[192:195], v[196:199], 0
v_fmac_f32 v8, v200, v229
v_fmac_f32 v9, v201, v229
v_mfma_f32_16x16x32_bf16 v[16:19], a[196:199], v[236:239], v[16:19]
v_fmac_f32 v0, v208, v229
v_fmac_f32 v1, v209, v229
v_mfma_f32_16x16x32_bf16 v[16:19], a[200:203], v[216:219], v[16:19]
v_fmac_f32 v10, v202, v229
v_fmac_f32 v11, v203, v229
v_mfma_f32_16x16x32_bf16 v[16:19], a[204:207], v[212:215], v[16:19]
ds_read_b128 v[200:203], v245 offset:6528
v_fmac_f32 v2, v210, v229
v_mfma_f32_16x16x32_bf16 v[20:23], a[220:223], v[212:215], 0
v_mul_u32_u24 v244, 13107200, v244
v_fmac_f32 v3, v211, v229
v_mfma_f32_16x16x32_bf16 v[20:23], a[216:219], v[216:219], v[20:23]
v_cvt_pk_bf16_f32 v0, v0, v1
v_cvt_pk_bf16_f32 v8, v8, v9
v_mfma_f32_16x16x32_bf16 v[20:23], a[212:215], v[236:239], v[20:23]
v_fmac_f32 v4, v204, v229
v_fmac_f32 v5, v205, v229
v_mfma_f32_16x16x32_bf16 v[20:23], a[208:211], v[196:199], v[20:23]
v_fmac_f32 v6, v206, v229
v_fmac_f32 v7, v207, v229
v_mfma_f32_16x16x32_bf16 v[24:27], a[224:227], v[196:199], 0
ds_read_b128 v[204:207], v245 offset:6592
v_cndmask_b32 v108, 0, v108, vcc
v_mfma_f32_16x16x32_bf16 v[24:27], a[228:231], v[236:239], v[24:27]
v_cndmask_b32 v109, 0, v109, vcc
v_add_f32 v232, v232, v233
v_mfma_f32_16x16x32_bf16 v[24:27], a[232:235], v[216:219], v[24:27]
v_rcp_f32 v253, v232
v_mfma_f32_16x16x32_bf16 v[24:27], a[236:239], v[212:215], v[24:27]
s_waitcnt lgkmcnt(2)
v_max3_f32 v254, v254, v228, v229
v_max3_f32 v254, v254, v232, v253
v_mfma_f32_16x16x32_bf16 v[28:31], a[252:255], v[212:215], 0
ds_read_b128 v[232:235], v245 offset:6464
ds_read_b128 v[212:215], v249 offset:6400
v_mfma_f32_16x16x32_bf16 v[28:31], a[248:251], v[216:219], v[28:31]
v_add_u32 v246, v244, v246
v_cvt_pk_bf16_f32 v1, v2, v3
v_mfma_f32_16x16x32_bf16 v[28:31], a[244:247], v[236:239], v[28:31]
v_fmac_f32 v12, v220, v229
v_fmac_f32 v13, v221, v229
v_mfma_f32_16x16x32_bf16 v[28:31], a[240:243], v[196:199], v[28:31]
v_fmac_f32 v14, v222, v229
v_fmac_f32 v15, v223, v229
v_mfma_f32_16x16x32_bf16 v[176:179], v[48:51], v[128:131], v[176:179]
s_waitcnt lgkmcnt(3)
v_cvt_pk_bf16_f32 v9, v10, v11
v_bfe_u32 v244, v243, 4, 2
v_mfma_f32_16x16x32_bf16 v[176:179], v[64:67], v[132:135], v[176:179]
v_cvt_pk_bf16_f32 v2, v4, v5
v_cvt_pk_bf16_f32 v3, v6, v7
v_mfma_f32_16x16x32_bf16 v[176:179], v[80:83], v[136:139], v[176:179]
s_waitcnt lgkmcnt(0)
v_cvt_pk_bf16_f32 v10, v12, v13
v_cvt_pk_bf16_f32 v11, v14, v15
v_mfma_f32_16x16x32_bf16 v[180:183], v[84:87], v[136:139], v[180:183]
v_lshl_add_u32 v246, v244, 4, v246
v_pk_max_i16 v0, v0, 0
v_mfma_f32_16x16x32_bf16 v[180:183], v[52:55], v[128:131], v[180:183]
v_pk_max_i16 v1, v1, 0
v_pk_max_i16 v2, v2, 0
v_mfma_f32_16x16x32_bf16 v[180:183], v[68:71], v[132:135], v[180:183]
v_pk_max_i16 v3, v3, 0
v_pk_max_i16 v8, v8, 0
v_mfma_f32_16x16x32_bf16 v[184:187], v[72:75], v[132:135], v[184:187]
v_pk_max_i16 v9, v9, 0
v_pk_max_i16 v10, v10, 0
v_mfma_f32_16x16x32_bf16 v[184:187], v[88:91], v[136:139], v[184:187]
v_pk_max_i16 v11, v11, 0
v_fmac_f32 v160, v176, v253
v_mfma_f32_16x16x32_bf16 v[184:187], v[56:59], v[128:131], v[184:187]
buffer_store_dwordx4 v[0:3], v246, s[20:23], s48 offen offset:0 nt
buffer_store_dwordx4 v[8:11], v246, s[20:23], s48 offen offset:64 nt
v_fmac_f32 v161, v177, v253
v_fmac_f32 v162, v178, v253
v_fmac_f32 v163, v179, v253
v_cvt_pk_bf16_f32 v160, v160, v161
v_mfma_f32_16x16x32_bf16 v[188:191], v[60:63], v[128:131], v[188:191]
s_nop 0
v_fmac_f32 v168, v184, v253
v_fmac_f32 v169, v185, v253
v_mfma_f32_16x16x32_bf16 v[188:191], v[76:79], v[132:135], v[188:191]
v_fmac_f32 v170, v186, v253
v_fmac_f32 v171, v187, v253
v_mfma_f32_16x16x32_bf16 v[188:191], v[92:95], v[136:139], v[188:191]
v_cvt_pk_bf16_f32 v168, v168, v169
v_fmac_f32 v164, v180, v253
v_mfma_f32_16x16x32_bf16 v[224:227], v[32:35], v[106:109], v[224:227]
v_fmac_f32 v165, v181, v253
v_fmac_f32 v166, v182, v253
v_mfma_f32_16x16x32_bf16 v[232:235], v[36:39], v[106:109], v[232:235]
v_fmac_f32 v167, v183, v253
v_cvt_pk_bf16_f32 v161, v162, v163
v_mfma_f32_16x16x32_bf16 v[200:203], v[40:43], v[106:109], v[200:203]
v_fmac_f32 v172, v188, v253
v_fmac_f32 v173, v189, v253
v_mfma_f32_16x16x32_bf16 v[204:207], v[44:47], v[106:109], v[204:207]
v_fmac_f32 v174, v190, v253
v_fmac_f32 v175, v191, v253
v_cvt_pk_bf16_f32 v169, v170, v171
v_cvt_pk_bf16_f32 v162, v164, v165
v_cvt_pk_bf16_f32 v163, v166, v167
v_cvt_pk_bf16_f32 v170, v172, v173
v_cvt_pk_bf16_f32 v171, v174, v175
v_pk_max_i16 v160, v160, 0
v_pk_max_i16 v161, v161, 0
v_pk_max_i16 v162, v162, 0
v_pk_max_i16 v163, v163, 0
v_pk_max_i16 v168, v168, 0
v_pk_max_i16 v169, v169, 0
v_pk_max_i16 v170, v170, 0
v_pk_max_i16 v171, v171, 0
buffer_store_dwordx4 v[160:163], v242, s[20:23], s53 offen offset:0 nt
buffer_store_dwordx4 v[168:171], v242, s[20:23], s53 offen offset:64 nt
v_add_f32 v212, v212, v213
v_add_f32 v214, v214, v215
v_add_f32 v212, v212, v111
v_add_f32 v212, v212, v214
v_rcp_f32 v213, v212
s_lshl_b32 s51, s43, 7
s_add_u32 s51, s51, s44
s_add_u32 s51, s51, 52428800
v_fmac_f32 v16, v224, v213
v_fmac_f32 v17, v225, v213
v_fmac_f32 v24, v200, v213
v_fmac_f32 v25, v201, v213
v_fmac_f32 v18, v226, v213
v_fmac_f32 v19, v227, v213
v_cvt_pk_bf16_f32 v16, v16, v17
v_fmac_f32 v26, v202, v213
v_fmac_f32 v27, v203, v213
v_cvt_pk_bf16_f32 v24, v24, v25
v_fmac_f32 v20, v232, v213
v_fmac_f32 v21, v233, v213
v_fmac_f32 v22, v234, v213
v_fmac_f32 v23, v235, v213
v_cvt_pk_bf16_f32 v17, v18, v19
v_fmac_f32 v28, v204, v213
v_fmac_f32 v29, v205, v213
v_fmac_f32 v30, v206, v213
v_fmac_f32 v31, v207, v213
v_cvt_pk_bf16_f32 v25, v26, v27
v_cvt_pk_bf16_f32 v18, v20, v21
v_cvt_pk_bf16_f32 v19, v22, v23
v_cvt_pk_bf16_f32 v26, v28, v29
v_cvt_pk_bf16_f32 v27, v30, v31
v_pk_max_i16 v16, v16, 0
v_pk_max_i16 v17, v17, 0
v_pk_max_i16 v18, v18, 0
v_pk_max_i16 v19, v19, 0
v_pk_max_i16 v24, v24, 0
v_pk_max_i16 v25, v25, 0
v_pk_max_i16 v26, v26, 0
v_pk_max_i16 v27, v27, 0
buffer_store_dwordx4 v[16:19], v246, s[20:23], s51 offen offset:0 nt
buffer_store_dwordx4 v[24:27], v246, s[20:23], s51 offen offset:64 nt
v_max3_f32 v254, v254, v212, v213
v_mov_b32 v1, 0x53800000
v_cmp_nle_f32 vcc, v254, v1
s_lshl_b32 s52, s41, 2
s_add_u32 s52, s52, 158976
s_or_b32 s3, vcc_lo, vcc_hi
v_mov_b32 v2, s52
v_mov_b32 v3, s3
ds_write_b32 v2, v3
v_mov_b32 v2, 158976
s_waitcnt lgkmcnt(0)
s_barrier
ds_read_b128 v[4:7], v2
s_waitcnt lgkmcnt(0)
v_or_b32 v4, v4, v5
v_or3_b32 v4, v4, v6, v7
s_nop 0
v_readfirstlane_b32 s3, v4
s_nop 3
s_cmp_eq_u32 s3, 0
s_cbranch_scc1 L_end
L_fast_end:
s_waitcnt vmcnt(0)
s_barrier
s_mov_b32 s45, 8
s_mov_b32 s3, 64
s_mov_b32 s46, s44
s_mov_b32 s47, 0x7ff00000
s_mov_b32 s56, 50688
v_mbcnt_lo_u32_b32 v48, -1, 0
v_mbcnt_hi_u32_b32 v48, -1, v48
v_lshlrev_b32 v53, 4, v48
s_lshl_b32 s54, s41, 13
s_add_u32 s57, s54, 4096
v_and_b32 v49, 16, v48
v_lshlrev_b32 v52, 2, v49
v_lshlrev_b32 v49, 1, v49
v_xor_b32 v50, v53, v49
s_mul_i32 s49, s42, 25344
s_mul_i32 s53, s43, 1056
s_add_u32 s49, s49, s53
s_add_u32 m0, s49, 0
s_lshl_b32 s55, s43, 10
s_add_u32 s55, s55, s44
s_add_u32 s48, s55, 0
v_mov_b32 v237, 0
v_bfe_u32 v49, v48, 0, 2
v_lshl_add_u32 v237, v49, 4, v237
v_bfe_u32 v49, v48, 4, 2
v_lshl_add_u32 v237, v49, 6, v237
v_bfe_u32 v49, v48, 2, 2
v_lshl_add_u32 v237, v49, 8, v237
v_xor_b32 v51, 64, v50
s_lshl_b32 s53, s43, 14
v_mov_b32 v248, s53
v_add_u32 v248, 50688, v248
v_bfe_u32 v49, v48, 4, 2
v_lshl_add_u32 v248, v49, 10, v248
v_bfe_u32 v49, v48, 2, 2
v_lshl_add_u32 v248, v49, 7, v248
v_bfe_u32 v49, v48, 3, 1
v_lshl_add_u32 v248, v49, 5, v248
v_bfe_u32 v49, v48, 4, 1
v_lshl_add_u32 v248, v49, 6, v248
v_bfe_u32 v49, v48, 0, 2
v_lshl_add_u32 v248, v49, 3, v248
v_mov_b32 v252, s53
v_add_u32 v252, 116224, v252
v_bfe_u32 v49, v48, 4, 2
v_lshl_add_u32 v252, v49, 10, v252
v_bfe_u32 v49, v48, 2, 2
v_lshl_add_u32 v252, v49, 7, v252
v_bfe_u32 v49, v48, 3, 1
v_lshl_add_u32 v252, v49, 6, v252
v_bfe_u32 v49, v48, 0, 2
v_lshl_add_u32 v252, v49, 4, v252
s_mul_i32 s53, s42, 25344
v_bfe_u32 v49, v48, 2, 2
v_mov_b32 v236, s53
v_mul_u32_u24 v49, 1056, v49
v_add_u32 v236, v49, v236
v_bfe_u32 v49, v48, 0, 2
s_add_u32 s53, s54, 83456
v_lshl_add_u32 v236, v49, 6, v236
v_add_u32 v104, s53, v50
v_add_u32 v105, s53, v51
v_bfe_u32 v49, v48, 4, 2
s_lshl_b32 s53, s41, 12
v_lshl_add_u32 v236, v49, 4, v236
v_mov_b32 v54, s53
v_add_u32 v54, 50688, v54
v_bfe_u32 v49, v48, 3, 1
v_lshl_add_u32 v54, v49, 14, v54
v_bfe_u32 v49, v48, 4, 2
v_lshl_add_u32 v54, v49, 7, v54
v_bfe_u32 v49, v48, 2, 1
v_lshl_add_u32 v54, v49, 6, v54
v_bfe_u32 v49, v48, 5, 1
v_lshl_add_u32 v54, v49, 5, v54
v_bfe_u32 v49, v48, 0, 2
v_lshl_add_u32 v54, v49, 3, v54
s_lshl_b32 s53, s43, 7
v_mov_b32 v239, s53
v_bfe_u32 v49, v48, 0, 4
v_lshl_add_u32 v239, v49, 8, v239
s_mul_i32 s52, s41, 12288
s_add_u32 s52, s52, 101376
v_bfe_u32 v49, v48, 4, 2
v_lshl_add_u32 v239, v49, 4, v239
v_mov_b32 v241, s52
v_add_u32 v241, 8192, v241
v_bfe_u32 v49, v48, 4, 2
v_lshl_add_u32 v241, v49, 1, v241
v_bfe_u32 v49, v48, 0, 4
v_lshl_add_u32 v241, v49, 3, v241
buffer_load_dwordx4 v[152:155], v53, s[24:27], s54 offen offset:0
v_mov_b32 v240, s52
v_bfe_u32 v49, v48, 2, 2
v_lshl_add_u32 v240, v49, 7, v240
buffer_load_dwordx4 v[156:159], v53, s[24:27], s54 offen offset:1024
v_lshlrev_b32 v49, 2, v48
v_xor_b32 v49, v49, v48
v_and_b32 v49, 48, v49
buffer_load_dwordx4 v[160:163], v53, s[24:27], s54 offen offset:2048
s_lshl_b32 s53, s41, 10
v_add_u32 v240, v49, v240
v_mov_b32 v254, s53
v_add_u32 v254, 150528, v254
buffer_load_dwordx4 v[164:167], v53, s[24:27], s54 offen offset:3072
v_bfe_u32 v49, v48, 0, 6
v_mov_b32 v40, 0
v_mov_b32 v41, 0
buffer_load_dwordx4 v[168:171], v53, s[24:27], s57 offen offset:0
v_mov_b32 v42, 0
v_mov_b32 v43, 0
v_lshl_add_u32 v254, v49, 4, v254
buffer_load_dwordx4 v[172:175], v53, s[24:27], s57 offen offset:1024
ds_write_b128 v254, v[40:43] offset:0
buffer_load_dwordx4 v[176:179], v53, s[24:27], s57 offen offset:2048
ds_write_b128 v254, v[40:43] offset:256
buffer_load_dwordx4 v[180:183], v53, s[24:27], s57 offen offset:3072
buffer_load_dwordx4 v237, s[16:19], s48 offen nt lds
s_add_u32 m0, s49, 2112
s_add_u32 s48, s55, 2048
v_mov_b32 v245, s52
v_add_u32 v245, 4096, v245
buffer_load_dwordx4 v237, s[16:19], s48 offen nt lds
s_add_u32 m0, s49, 4224
s_add_u32 s48, s55, 4096
v_bfe_u32 v49, v48, 0, 2
buffer_load_dwordx4 v237, s[16:19], s48 offen nt lds
s_add_u32 m0, s49, 6336
s_add_u32 s48, s55, 6144
s_mov_b32 vcc_lo, 0x11111111
s_mov_b32 vcc_hi, 0x11111111
buffer_load_dwordx4 v237, s[16:19], s48 offen nt lds
s_add_u32 m0, s54, 50688
v_lshl_add_u32 v245, v49, 7, v245
v_mov_b32 v254, 150528
v_lshlrev_b32 v49, 4, v48
buffer_load_dwordx4 v50, s[28:31], s54 offen offset:0 lds
v_cndmask_b32 v240, v254, v240, vcc
v_xor_b32 v49, v49, v48
v_and_b32 v49, 48, v49
buffer_load_dwordx4 v51, s[28:31], s54 offen offset:1024 lds
s_mov_b32 vcc_lo, 0xf000f
s_mov_b32 vcc_hi, 0xf000f
v_add_u32 v245, v49, v245
buffer_load_dwordx4 v50, s[28:31], s54 offen offset:2048 lds
v_cndmask_b32 v242, v254, v245, vcc
s_mov_b32 vcc_lo, 0xf000f0
s_mov_b32 vcc_hi, 0xf000f0
buffer_load_dwordx4 v51, s[28:31], s54 offen offset:3072 lds
s_add_u32 m0, s57, 50688
v_cndmask_b32 v243, v254, v245, vcc
s_mov_b32 vcc_lo, 0xf000f00
s_mov_b32 vcc_hi, 0xf000f00
buffer_load_dwordx4 v50, s[28:31], s57 offen offset:0 lds
v_cndmask_b32 v244, v254, v245, vcc
s_mov_b32 vcc_lo, 0xf000f000
s_mov_b32 vcc_hi, 0xf000f000
v_mov_b32 v246, s52
buffer_load_dwordx4 v51, s[28:31], s57 offen offset:1024 lds
v_add_u32 v246, 4096, v246
v_bfe_u32 v49, v48, 0, 2
v_cndmask_b32 v245, v254, v245, vcc
buffer_load_dwordx4 v50, s[28:31], s57 offen offset:2048 lds
v_lshl_add_u32 v246, v49, 7, v246
v_mov_b32 v254, 154880
v_bfe_u32 v49, v48, 2, 2
buffer_load_dwordx4 v51, s[28:31], s57 offen offset:3072 lds
s_add_u32 m0, s49, 16896
s_mov_b32 vcc_lo, 0xf000f
s_mov_b32 vcc_hi, 0xf000f
v_lshl_add_u32 v254, v49, 3, v254
v_cndmask_b32 v246, v254, v246, vcc
v_xor_b32 v249, 32, v248
v_xor_b32 v250, 64, v248
v_xor_b32 v251, 96, v248
s_mul_i32 s4, s43, 13107200
s_add_u32 s4, s4, s44
s_add_u32 s4, s4, 24576
s_add_u32 s5, s55, 104857600
s_sub_u32 s5, s5, s4
s_add_u32 s48, s4, 0
v_xor_b32 v52, v53, v52
v_xor_b32 v55, 96, v54
v_xor_b32 v253, 64, v252
v_lshlrev_b32 v49, 4, v48
v_xor_b32 v49, v49, v48
v_and_b32 v49, 48, v49
v_add_u32 v246, v49, v246
v_add_u32 v246, v49, v246
v_mov_b32 v50, s52
v_bfe_u32 v49, v48, 0, 4
v_lshl_add_u32 v50, v49, 7, v50
v_lshlrev_b32 v49, 4, v48
v_xor_b32 v49, v49, v48
v_and_b32 v49, 48, v49
v_add_u32 v50, v49, v50
v_mov_b32 v51, s52
v_add_u32 v51, 8192, v51
v_bfe_u32 v49, v48, 4, 2
v_lshl_add_u32 v51, v49, 9, v51
v_bfe_u32 v49, v48, 0, 4
v_lshl_add_u32 v51, v49, 3, v51
s_add_u32 s50, s55, 13107200
s_mov_b32 s51, 2048
v_xor_b32 v247, 32, v48
s_mov_b32 s52, 0x7ff00000
v_lshlrev_b32 v247, 2, v247
s_waitcnt vmcnt(19)
v_and_b32 v254, 0xffff0000, v152
buffer_load_dwordx4 v237, s[16:19], s48 offen nt lds
s_add_u32 m0, s49, 19008
s_add_u32 s48, s4, 26214400
v_and_b32 v255, 0xffff0000, v153
v_lshlrev_b32 v152, 16, v152
v_lshlrev_b32 v153, 16, v153
v_mul_f32 v254, s40, v254
v_mul_f32 v152, s40, v152
v_mul_f32 v255, s40, v255
v_mul_f32 v153, s40, v153
v_cvt_pk_bf16_f32 v152, v152, v254
v_cvt_pk_bf16_f32 v153, v153, v255
v_and_b32 v254, 0xffff0000, v154
v_and_b32 v255, 0xffff0000, v155
v_lshlrev_b32 v154, 16, v154
v_lshlrev_b32 v155, 16, v155
v_mul_f32 v254, s40, v254
v_mul_f32 v154, s40, v154
v_mul_f32 v255, s40, v255
v_mul_f32 v155, s40, v155
v_cvt_pk_bf16_f32 v154, v154, v254
v_cvt_pk_bf16_f32 v155, v155, v255
s_waitcnt vmcnt(19)
v_and_b32 v254, 0xffff0000, v156
v_and_b32 v255, 0xffff0000, v157
v_lshlrev_b32 v156, 16, v156
v_lshlrev_b32 v157, 16, v157
v_mul_f32 v254, s40, v254
v_mul_f32 v156, s40, v156
v_mul_f32 v255, s40, v255
v_mul_f32 v157, s40, v157
v_cvt_pk_bf16_f32 v156, v156, v254
buffer_load_dwordx4 v237, s[16:19], s48 offen nt lds
s_add_u32 m0, s49, 21120
s_add_u32 s48, s4, 52428800
v_cvt_pk_bf16_f32 v157, v157, v255
v_and_b32 v254, 0xffff0000, v158
v_and_b32 v255, 0xffff0000, v159
v_lshlrev_b32 v158, 16, v158
v_lshlrev_b32 v159, 16, v159
v_mul_f32 v254, s40, v254
v_mul_f32 v158, s40, v158
v_mul_f32 v255, s40, v255
v_mul_f32 v159, s40, v159
v_cvt_pk_bf16_f32 v158, v158, v254
v_cvt_pk_bf16_f32 v159, v159, v255
s_waitcnt vmcnt(19)
v_and_b32 v254, 0xffff0000, v160
v_and_b32 v255, 0xffff0000, v161
v_lshlrev_b32 v160, 16, v160
v_lshlrev_b32 v161, 16, v161
v_mul_f32 v254, s40, v254
v_mul_f32 v160, s40, v160
v_mul_f32 v255, s40, v255
v_mul_f32 v161, s40, v161
v_cvt_pk_bf16_f32 v160, v160, v254
v_cvt_pk_bf16_f32 v161, v161, v255
v_and_b32 v254, 0xffff0000, v162
v_and_b32 v255, 0xffff0000, v163
v_lshlrev_b32 v162, 16, v162
v_lshlrev_b32 v163, 16, v163
v_mul_f32 v254, s40, v254
v_mul_f32 v162, s40, v162
v_mul_f32 v255, s40, v255
v_mul_f32 v163, s40, v163
v_cvt_pk_bf16_f32 v162, v162, v254
buffer_load_dwordx4 v237, s[16:19], s48 offen nt lds
s_add_u32 m0, s49, 23232
s_add_u32 s48, s4, 78643200
ds_write_b128 v104, v[152:155] offset:0
ds_write_b128 v105, v[156:159] offset:1024
v_cvt_pk_bf16_f32 v163, v163, v255
s_waitcnt vmcnt(19)
v_and_b32 v254, 0xffff0000, v164
v_and_b32 v255, 0xffff0000, v165
v_lshlrev_b32 v164, 16, v164
v_lshlrev_b32 v165, 16, v165
v_mul_f32 v254, s40, v254
v_mul_f32 v164, s40, v164
v_mul_f32 v255, s40, v255
v_mul_f32 v165, s40, v165
v_cvt_pk_bf16_f32 v164, v164, v254
v_cvt_pk_bf16_f32 v165, v165, v255
v_and_b32 v254, 0xffff0000, v166
v_and_b32 v255, 0xffff0000, v167
v_lshlrev_b32 v166, 16, v166
v_lshlrev_b32 v167, 16, v167
v_mul_f32 v254, s40, v254
buffer_load_dwordx4 v237, s[16:19], s48 offen nt lds
s_add_u32 m0, s54, 116224
s_add_u32 s48, s55, 8192
ds_write_b128 v104, v[160:163] offset:2048
v_mul_f32 v166, s40, v166
v_mul_f32 v255, s40, v255
v_mul_f32 v167, s40, v167
v_cvt_pk_bf16_f32 v166, v166, v254
v_cvt_pk_bf16_f32 v167, v167, v255
s_waitcnt vmcnt(19)
v_and_b32 v254, 0xffff0000, v168
v_and_b32 v255, 0xffff0000, v169
v_lshlrev_b32 v168, 16, v168
v_lshlrev_b32 v169, 16, v169
v_mul_f32 v254, s40, v254
v_mul_f32 v168, s40, v168
v_mul_f32 v255, s40, v255
v_mul_f32 v169, s40, v169
v_cvt_pk_bf16_f32 v168, v168, v254
v_cvt_pk_bf16_f32 v169, v169, v255
v_and_b32 v254, 0xffff0000, v170
v_and_b32 v255, 0xffff0000, v171
v_lshlrev_b32 v170, 16, v170
v_lshlrev_b32 v171, 16, v171
v_mul_f32 v254, s40, v254
v_mul_f32 v170, s40, v170
v_mul_f32 v255, s40, v255
v_mul_f32 v171, s40, v171
buffer_load_dwordx4 v52, s[32:35], s54 offen offset:0 lds
ds_write_b128 v105, v[164:167] offset:3072
v_cvt_pk_bf16_f32 v170, v170, v254
v_cvt_pk_bf16_f32 v171, v171, v255
s_waitcnt vmcnt(19)
v_and_b32 v254, 0xffff0000, v172
v_and_b32 v255, 0xffff0000, v173
v_lshlrev_b32 v172, 16, v172
v_lshlrev_b32 v173, 16, v173
v_mul_f32 v254, s40, v254
v_mul_f32 v172, s40, v172
v_mul_f32 v255, s40, v255
v_mul_f32 v173, s40, v173
v_cvt_pk_bf16_f32 v172, v172, v254
v_cvt_pk_bf16_f32 v173, v173, v255
v_and_b32 v254, 0xffff0000, v174
v_and_b32 v255, 0xffff0000, v175
v_lshlrev_b32 v174, 16, v174
v_lshlrev_b32 v175, 16, v175
v_mul_f32 v254, s40, v254
v_mul_f32 v174, s40, v174
v_mul_f32 v255, s40, v255
v_mul_f32 v175, s40, v175
v_cvt_pk_bf16_f32 v174, v174, v254
v_cvt_pk_bf16_f32 v175, v175, v255
s_waitcnt vmcnt(18)
v_and_b32 v254, 0xffff0000, v176
v_and_b32 v255, 0xffff0000, v177
v_lshlrev_b32 v176, 16, v176
buffer_load_dwordx4 v52, s[32:35], s54 offen offset:1024 lds
ds_write_b128 v104, v[168:171] offset:4096
v_lshlrev_b32 v177, 16, v177
v_mul_f32 v254, s40, v254
v_mul_f32 v176, s40, v176
v_mul_f32 v255, s40, v255
v_mul_f32 v177, s40, v177
v_cvt_pk_bf16_f32 v176, v176, v254
v_cvt_pk_bf16_f32 v177, v177, v255
v_and_b32 v254, 0xffff0000, v178
v_and_b32 v255, 0xffff0000, v179
v_lshlrev_b32 v178, 16, v178
v_lshlrev_b32 v179, 16, v179
v_mul_f32 v254, s40, v254
v_mul_f32 v178, s40, v178
v_mul_f32 v255, s40, v255
v_mul_f32 v179, s40, v179
v_cvt_pk_bf16_f32 v178, v178, v254
v_cvt_pk_bf16_f32 v179, v179, v255
s_waitcnt vmcnt(18)
v_and_b32 v254, 0xffff0000, v180
v_and_b32 v255, 0xffff0000, v181
v_lshlrev_b32 v180, 16, v180
v_lshlrev_b32 v181, 16, v181
v_mul_f32 v254, s40, v254
v_mul_f32 v180, s40, v180
v_mul_f32 v255, s40, v255
v_mul_f32 v181, s40, v181
buffer_load_dwordx4 v52, s[32:35], s54 offen offset:2048 lds
ds_write_b128 v105, v[172:175] offset:5120
ds_write_b128 v104, v[176:179] offset:6144
v_cvt_pk_bf16_f32 v180, v180, v254
v_cvt_pk_bf16_f32 v181, v181, v255
v_and_b32 v254, 0xffff0000, v182
v_and_b32 v255, 0xffff0000, v183
v_lshlrev_b32 v182, 16, v182
v_lshlrev_b32 v183, 16, v183
v_mul_f32 v254, s40, v254
v_mul_f32 v182, s40, v182
v_mul_f32 v255, s40, v255
v_mul_f32 v183, s40, v183
v_cvt_pk_bf16_f32 v182, v182, v254
v_cvt_pk_bf16_f32 v183, v183, v255
ds_write_b128 v105, v[180:183] offset:7168
buffer_load_dwordx4 v52, s[32:35], s54 offen offset:3072 lds
s_add_u32 m0, s57, 116224
v_xor_b32 v254, 32, v54
v_xor_b32 v255, 64, v54
s_mov_b32 s53, 0x7ff00000
buffer_load_dwordx4 v52, s[32:35], s57 offen offset:0 lds
buffer_load_dwordx4 v52, s[32:35], s57 offen offset:1024 lds
s_waitcnt vmcnt(10) lgkmcnt(0)
s_barrier
ds_read_b64_tr_b16 a[64:65], v248 offset:0
ds_read_b64_tr_b16 a[66:67], v248 offset:512
ds_read_b128 v[188:191], v236 offset:0
ds_read_b64_tr_b16 a[68:69], v248 offset:4096
ds_read_b64_tr_b16 a[70:71], v248 offset:4608
buffer_load_dwordx4 v52, s[32:35], s57 offen offset:2048 lds
ds_read_b128 v[196:199], v236 offset:256
ds_read_b64_tr_b16 a[72:73], v248 offset:8192
ds_read_b64_tr_b16 a[74:75], v248 offset:8704
ds_read_b128 v[200:203], v236 offset:512
ds_read_b64_tr_b16 a[76:77], v248 offset:12288
ds_read_b64_tr_b16 a[78:79], v248 offset:12800
ds_read_b128 v[204:207], v236 offset:768
ds_read_b64_tr_b16 a[92:93], v249 offset:12288
ds_read_b64_tr_b16 a[94:95], v249 offset:12800
ds_read_b64_tr_b16 a[88:89], v249 offset:8192
ds_read_b64_tr_b16 a[90:91], v249 offset:8704
ds_read_b64_tr_b16 a[84:85], v249 offset:4096
ds_read_b64_tr_b16 a[86:87], v249 offset:4608
ds_read_b64_tr_b16 a[80:81], v249 offset:0
ds_read_b64_tr_b16 a[82:83], v249 offset:512
s_waitcnt lgkmcnt(15)
v_mfma_f32_16x16x32_bf16 v[192:195], a[64:67], v[188:191], 0
ds_read_b64_tr_b16 a[96:97], v250 offset:0
ds_read_b64_tr_b16 a[98:99], v250 offset:512
s_waitcnt lgkmcnt(15)
v_mfma_f32_16x16x32_bf16 v[192:195], a[68:71], v[196:199], v[192:195]
s_waitcnt lgkmcnt(14)
ds_read_b64_tr_b16 a[100:101], v250 offset:4096
s_waitcnt lgkmcnt(14)
v_mfma_f32_16x16x32_bf16 v[192:195], a[72:75], v[200:203], v[192:195]
s_waitcnt lgkmcnt(11)
ds_read_b64_tr_b16 a[102:103], v250 offset:4608
ds_read_b64_tr_b16 a[104:105], v250 offset:8192
v_mfma_f32_16x16x32_bf16 v[192:195], a[76:79], v[204:207], v[192:195]
s_waitcnt lgkmcnt(9)
ds_read_b64_tr_b16 a[106:107], v250 offset:8704
ds_read_b64_tr_b16 a[108:109], v250 offset:12288
v_mfma_f32_16x16x32_bf16 v[208:211], a[92:95], v[204:207], 0
s_waitcnt lgkmcnt(7)
buffer_load_dwordx4 v52, s[32:35], s57 offen offset:3072 lds
s_add_u32 m0, s49, 8448
v_mfma_f32_16x16x32_bf16 v[208:211], a[88:91], v[200:203], v[208:211]
ds_read_b64_tr_b16 a[110:111], v250 offset:12800
v_cvt_pk_bf16_f32 v0, v192, v193
v_mfma_f32_16x16x32_bf16 v[208:211], a[84:87], v[196:199], v[208:211]
s_waitcnt lgkmcnt(6)
ds_read_b64_tr_b16 a[124:125], v251 offset:12288
v_cvt_pk_bf16_f32 v1, v194, v195
v_mfma_f32_16x16x32_bf16 v[208:211], a[80:83], v[188:191], v[208:211]
s_waitcnt lgkmcnt(6)
ds_read_b64_tr_b16 a[126:127], v251 offset:12800
ds_read_b64_tr_b16 a[120:121], v251 offset:8192
v_mfma_f32_16x16x32_bf16 v[192:195], a[96:99], v[188:191], 0
s_waitcnt lgkmcnt(6)
ds_read_b64_tr_b16 a[122:123], v251 offset:8704
ds_read_b64_tr_b16 a[116:117], v251 offset:4096
v_mfma_f32_16x16x32_bf16 v[192:195], a[100:103], v[196:199], v[192:195]
s_waitcnt lgkmcnt(6)
ds_read_b64_tr_b16 a[118:119], v251 offset:4608
v_cvt_pk_bf16_f32 v2, v208, v209
v_mfma_f32_16x16x32_bf16 v[192:195], a[104:107], v[200:203], v[192:195]
ds_read_b64_tr_b16 a[112:113], v251 offset:0
s_waitcnt lgkmcnt(7)
v_mfma_f32_16x16x32_bf16 v[192:195], a[108:111], v[204:207], v[192:195]
ds_read_b64_tr_b16 a[114:115], v251 offset:512
v_cvt_pk_bf16_f32 v3, v210, v211
ds_read_b128 v[184:187], v236 offset:4992
s_waitcnt lgkmcnt(7)
v_mfma_f32_16x16x32_bf16 v[208:211], a[124:127], v[204:207], 0
s_waitcnt lgkmcnt(6)
buffer_load_dwordx4 v[120:123], v53, s[36:39], s54 offen offset:0
s_waitcnt lgkmcnt(5)
v_mfma_f32_16x16x32_bf16 v[208:211], a[120:123], v[200:203], v[208:211]
s_waitcnt lgkmcnt(4)
ds_read_b128 v[216:219], v236 offset:4736
s_waitcnt lgkmcnt(4)
v_mfma_f32_16x16x32_bf16 v[208:211], a[116:119], v[196:199], v[208:211]
ds_read_b128 v[204:207], v236 offset:4480
v_cvt_pk_bf16_f32 v5, v194, v195
v_cvt_pk_bf16_f32 v4, v192, v193
s_waitcnt lgkmcnt(3)
v_mfma_f32_16x16x32_bf16 v[208:211], a[112:115], v[188:191], v[208:211]
ds_read_b128 v[192:195], v236 offset:4224
s_waitcnt lgkmcnt(3)
v_mfma_f32_16x16x32_bf16 v[200:203], a[124:127], v[184:187], 0
ds_read_b64_tr_b16 a[0:1], v248 offset:32768
ds_read_b64_tr_b16 a[2:3], v248 offset:33280
v_mfma_f32_16x16x32_bf16 v[220:223], a[92:95], v[184:187], 0
ds_read_b64_tr_b16 a[4:5], v248 offset:36864
s_waitcnt lgkmcnt(5)
v_mfma_f32_16x16x32_bf16 v[200:203], a[120:123], v[216:219], v[200:203]
ds_read_b64_tr_b16 a[6:7], v248 offset:37376
s_waitcnt lgkmcnt(5)
v_mfma_f32_16x16x32_bf16 v[200:203], a[116:119], v[204:207], v[200:203]
ds_read_b64_tr_b16 a[8:9], v248 offset:40960
v_cvt_pk_bf16_f32 v6, v208, v209
v_mfma_f32_16x16x32_bf16 v[220:223], a[88:91], v[216:219], v[220:223]
buffer_load_dwordx4 v[124:127], v53, s[36:39], s54 offen offset:1024
s_waitcnt lgkmcnt(5)
v_mfma_f32_16x16x32_bf16 v[200:203], a[112:115], v[192:195], v[200:203]
ds_read_b64_tr_b16 a[10:11], v248 offset:41472
v_cvt_pk_bf16_f32 v7, v210, v211
v_mfma_f32_16x16x32_bf16 v[208:211], a[96:99], v[192:195], 0
s_waitcnt lgkmcnt(4)
ds_read_b64_tr_b16 a[12:13], v248 offset:45056
ds_read_b64_tr_b16 a[14:15], v248 offset:45568
v_mfma_f32_16x16x32_bf16 v[208:211], a[100:103], v[204:207], v[208:211]
s_waitcnt lgkmcnt(5)
ds_read_b64_tr_b16 a[16:17], v249 offset:32768
ds_read_b64_tr_b16 a[18:19], v249 offset:33280
v_mfma_f32_16x16x32_bf16 v[208:211], a[104:107], v[216:219], v[208:211]
s_waitcnt lgkmcnt(6)
ds_read_b64_tr_b16 a[20:21], v249 offset:36864
ds_read_b64_tr_b16 a[22:23], v249 offset:37376
v_mfma_f32_16x16x32_bf16 v[208:211], a[108:111], v[184:187], v[208:211]
s_waitcnt lgkmcnt(7)
ds_read_b64_tr_b16 a[24:25], v249 offset:40960
ds_read_b64_tr_b16 a[26:27], v249 offset:41472
v_mfma_f32_16x16x32_bf16 v[220:223], a[84:87], v[204:207], v[220:223]
ds_read_b64_tr_b16 a[28:29], v249 offset:45056
ds_read_b64_tr_b16 a[30:31], v249 offset:45568
v_mfma_f32_16x16x32_bf16 v[220:223], a[80:83], v[192:195], v[220:223]
s_waitcnt lgkmcnt(10)
ds_read_b64_tr_b16 a[32:33], v250 offset:32768
ds_read_b64_tr_b16 a[34:35], v250 offset:33280
v_mfma_f32_16x16x32_bf16 v[188:191], a[64:67], v[192:195], 0
s_waitcnt lgkmcnt(10)
ds_read_b64_tr_b16 a[36:37], v250 offset:36864
ds_read_b64_tr_b16 a[38:39], v250 offset:37376
v_mfma_f32_16x16x32_bf16 v[188:191], a[72:75], v[216:219], v[188:191]
s_waitcnt lgkmcnt(10)
buffer_load_dwordx4 v[128:131], v53, s[36:39], s54 offen offset:2048
ds_read_b64_tr_b16 a[40:41], v250 offset:40960
v_mfma_f32_16x16x32_bf16 v[188:191], a[76:79], v[184:187], v[188:191]
s_waitcnt lgkmcnt(9)
ds_read_b64_tr_b16 a[42:43], v250 offset:41472
ds_read_b64_tr_b16 a[44:45], v250 offset:45056
v_mfma_f32_16x16x32_bf16 v[188:191], a[68:71], v[204:207], v[188:191]
s_waitcnt lgkmcnt(9)
ds_read_b64_tr_b16 a[46:47], v250 offset:45568
ds_read_b64_tr_b16 a[48:49], v251 offset:32768
ds_read_b64_tr_b16 a[50:51], v251 offset:33280
ds_read_b64_tr_b16 a[52:53], v251 offset:36864
ds_read_b64_tr_b16 a[54:55], v251 offset:37376
ds_read_b64_tr_b16 a[56:57], v251 offset:40960
ds_read_b64_tr_b16 a[58:59], v251 offset:41472
s_waitcnt vmcnt(11)
s_barrier
ds_read_b128 v[56:59], v236 offset:16896
ds_read_b128 v[60:63], v236 offset:17152
ds_read_b128 v[64:67], v236 offset:17408
ds_read_b128 v[68:71], v236 offset:17664
ds_read_b128 v[72:75], v236 offset:21120
ds_read_b128 v[76:79], v236 offset:21376
ds_read_b128 v[80:83], v236 offset:21632
ds_read_b128 v[84:87], v236 offset:21888
ds_read_b64_tr_b16 a[60:61], v251 offset:45056
ds_read_b64_tr_b16 a[62:63], v251 offset:45568
v_cvt_pk_bf16_f32 v14, v200, v201
buffer_load_dwordx4 v[132:135], v53, s[36:39], s54 offen offset:3072
v_cvt_pk_bf16_f32 v15, v202, v203
v_cvt_pk_bf16_f32 v9, v190, v191
v_cvt_pk_bf16_f32 v8, v188, v189
v_cvt_pk_bf16_f32 v13, v210, v211
v_cvt_pk_bf16_f32 v12, v208, v209
v_cvt_pk_bf16_f32 v10, v220, v221
v_cvt_pk_bf16_f32 v11, v222, v223
s_waitcnt lgkmcnt(9)
v_mfma_f32_16x16x32_bf16 v[156:159], a[64:67], v[56:59], 0
s_waitcnt lgkmcnt(7)
v_mfma_f32_16x16x32_bf16 v[156:159], a[68:71], v[60:63], v[156:159]
s_waitcnt lgkmcnt(3)
v_mfma_f32_16x16x32_bf16 v[156:159], a[72:75], v[64:67], v[156:159]
s_waitcnt lgkmcnt(0)
v_mfma_f32_16x16x32_bf16 v[156:159], a[76:79], v[68:71], v[156:159]
s_nop 2
v_mfma_f32_16x16x32_bf16 v[160:163], a[92:95], v[68:71], 0
s_nop 2
v_mfma_f32_16x16x32_bf16 v[160:163], a[88:91], v[64:67], v[160:163]
s_waitcnt vmcnt(4)
s_barrier
v_mfma_f32_16x16x32_bf16 v[160:163], a[84:87], v[60:63], v[160:163]
buffer_load_dwordx4 v[136:139], v53, s[36:39], s57 offen offset:0
ds_read_b64_tr_b16 a[128:129], v252 offset:0
v_mfma_f32_16x16x32_bf16 v[160:163], a[80:83], v[56:59], v[160:163]
ds_read_b64_tr_b16 a[130:131], v252 offset:512
ds_read_b64_tr_b16 a[132:133], v252 offset:4096
v_mfma_f32_16x16x32_bf16 v[164:167], a[96:99], v[56:59], 0
ds_read_b64_tr_b16 a[134:135], v252 offset:4608
ds_read_b64_tr_b16 a[136:137], v252 offset:8192
v_mfma_f32_16x16x32_bf16 v[164:167], a[100:103], v[60:63], v[164:167]
ds_read_b64_tr_b16 a[138:139], v252 offset:8704
ds_read_b64_tr_b16 a[140:141], v252 offset:12288
v_mfma_f32_16x16x32_bf16 v[164:167], a[104:107], v[64:67], v[164:167]
ds_read_b64_tr_b16 a[142:143], v252 offset:12800
ds_read_b64_tr_b16 a[144:145], v252 offset:8
v_mfma_f32_16x16x32_bf16 v[164:167], a[108:111], v[68:71], v[164:167]
ds_read_b64_tr_b16 a[146:147], v252 offset:520
ds_read_b64_tr_b16 a[148:149], v252 offset:4104
v_mfma_f32_16x16x32_bf16 v[168:171], a[124:127], v[68:71], 0
s_waitcnt lgkmcnt(10)
ds_read_b64_tr_b16 a[150:151], v252 offset:4616
v_cvt_pk_bf16_f32 v88, v156, v157
v_mfma_f32_16x16x32_bf16 v[168:171], a[120:123], v[64:67], v[168:171]
s_waitcnt lgkmcnt(9)
ds_read_b64_tr_b16 a[152:153], v252 offset:8200
v_cvt_pk_bf16_f32 v89, v158, v159
v_mfma_f32_16x16x32_bf16 v[168:171], a[116:119], v[60:63], v[168:171]
s_waitcnt lgkmcnt(8)
ds_read_b64_tr_b16 a[154:155], v252 offset:8712
ds_read_b64_tr_b16 a[156:157], v252 offset:12296
v_mfma_f32_16x16x32_bf16 v[168:171], a[112:115], v[56:59], v[168:171]
s_waitcnt lgkmcnt(8)
buffer_load_dwordx4 v[140:143], v53, s[36:39], s57 offen offset:1024
ds_read_b64_tr_b16 a[158:159], v252 offset:12808
v_mfma_f32_16x16x32_bf16 v[172:175], a[64:67], v[72:75], 0
s_waitcnt lgkmcnt(7)
ds_read_b64_tr_b16 a[160:161], v253 offset:0
v_cvt_pk_bf16_f32 v90, v160, v161
v_mfma_f32_16x16x32_bf16 v[172:175], a[68:71], v[76:79], v[172:175]
s_waitcnt lgkmcnt(6)
ds_read_b64_tr_b16 a[162:163], v253 offset:512
v_cvt_pk_bf16_f32 v91, v162, v163
v_mfma_f32_16x16x32_bf16 v[172:175], a[72:75], v[80:83], v[172:175]
s_waitcnt lgkmcnt(6)
ds_read_b64_tr_b16 a[164:165], v253 offset:4096
ds_read_b64_tr_b16 a[166:167], v253 offset:4608
v_mfma_f32_16x16x32_bf16 v[172:175], a[76:79], v[84:87], v[172:175]
s_waitcnt lgkmcnt(7)
ds_read_b64_tr_b16 a[168:169], v253 offset:8192
ds_read_b64_tr_b16 a[170:171], v253 offset:8704
v_mfma_f32_16x16x32_bf16 v[176:179], a[92:95], v[84:87], 0
s_waitcnt lgkmcnt(7)
ds_read_b64_tr_b16 a[172:173], v253 offset:12288
v_cvt_pk_bf16_f32 v92, v164, v165
v_mfma_f32_16x16x32_bf16 v[176:179], a[88:91], v[80:83], v[176:179]
s_waitcnt lgkmcnt(7)
ds_read_b64_tr_b16 a[174:175], v253 offset:12800
v_cvt_pk_bf16_f32 v93, v166, v167
v_mfma_f32_16x16x32_bf16 v[176:179], a[84:87], v[76:79], v[176:179]
s_waitcnt lgkmcnt(7)
ds_read_b64_tr_b16 a[176:177], v253 offset:8
ds_read_b64_tr_b16 a[178:179], v253 offset:520
v_mfma_f32_16x16x32_bf16 v[176:179], a[80:83], v[72:75], v[176:179]
s_waitcnt lgkmcnt(8)
ds_read_b64_tr_b16 a[180:181], v253 offset:4104
ds_read_b64_tr_b16 a[182:183], v253 offset:4616
v_mfma_f32_16x16x32_bf16 v[180:183], a[96:99], v[72:75], 0
s_waitcnt lgkmcnt(8)
buffer_load_dwordx4 v[144:147], v53, s[36:39], s57 offen offset:2048
v_cvt_pk_bf16_f32 v94, v168, v169
v_mfma_f32_16x16x32_bf16 v[180:183], a[100:103], v[76:79], v[180:183]
s_waitcnt lgkmcnt(6)
ds_read_b64_tr_b16 a[184:185], v253 offset:8200
v_cvt_pk_bf16_f32 v95, v170, v171
v_mfma_f32_16x16x32_bf16 v[180:183], a[104:107], v[80:83], v[180:183]
s_waitcnt lgkmcnt(6)
ds_read_b64_tr_b16 a[186:187], v253 offset:8712
ds_read_b64_tr_b16 a[188:189], v253 offset:12296
v_mfma_f32_16x16x32_bf16 v[180:183], a[108:111], v[84:87], v[180:183]
s_waitcnt lgkmcnt(7)
ds_read_b64_tr_b16 a[190:191], v253 offset:12808
v_cvt_pk_bf16_f32 v96, v172, v173
v_mfma_f32_16x16x32_bf16 v[152:155], a[124:127], v[84:87], 0
s_waitcnt lgkmcnt(6)
v_cvt_pk_bf16_f32 v97, v174, v175
v_cvt_pk_bf16_f32 v98, v176, v177
v_mfma_f32_16x16x32_bf16 v[152:155], a[120:123], v[80:83], v[152:155]
s_waitcnt lgkmcnt(4)
v_cvt_pk_bf16_f32 v99, v178, v179
v_cvt_pk_bf16_f32 v100, v180, v181
v_mfma_f32_16x16x32_bf16 v[152:155], a[116:119], v[76:79], v[152:155]
v_cvt_pk_bf16_f32 v101, v182, v183
v_mov_b32 v253, 0
v_mfma_f32_16x16x32_bf16 v[152:155], a[112:115], v[72:75], v[152:155]
s_waitcnt lgkmcnt(3)
v_mov_b32 v252, 1.0
s_nop 0
v_mfma_f32_16x16x32_bf16 v[156:159], a[0:3], v[56:59], 0
s_waitcnt lgkmcnt(1)
s_nop 1
v_mfma_f32_16x16x32_bf16 v[156:159], a[4:7], v[60:63], v[156:159]
s_waitcnt lgkmcnt(0)
buffer_load_dwordx4 v[148:151], v53, s[36:39], s57 offen offset:3072
v_cvt_pk_bf16_f32 v102, v152, v153
v_mfma_f32_16x16x32_bf16 v[156:159], a[8:11], v[64:67], v[156:159]
v_cvt_pk_bf16_f32 v103, v154, v155
v_mfma_f32_16x16x32_bf16 v[156:159], a[12:15], v[68:71], v[156:159]
s_nop 2
v_mfma_f32_16x16x32_bf16 v[160:163], a[28:31], v[68:71], 0
s_nop 2
v_mfma_f32_16x16x32_bf16 v[160:163], a[24:27], v[64:67], v[160:163]
v_cvt_pk_bf16_f32 v104, v156, v157
v_cvt_pk_bf16_f32 v105, v158, v159
v_mfma_f32_16x16x32_bf16 v[160:163], a[20:23], v[60:63], v[160:163]
v_mfma_f32_16x16x32_bf16 v[160:163], a[16:19], v[56:59], v[160:163]
s_nop 2
v_mfma_f32_16x16x32_bf16 v[164:167], a[32:35], v[56:59], 0
s_nop 2
v_mfma_f32_16x16x32_bf16 v[164:167], a[36:39], v[60:63], v[164:167]
v_cvt_pk_bf16_f32 v106, v160, v161
v_cvt_pk_bf16_f32 v107, v162, v163
v_mfma_f32_16x16x32_bf16 v[164:167], a[40:43], v[64:67], v[164:167]
buffer_load_dwordx4 v237, s[16:19], s48 offen nt lds
s_add_u32 m0, s49, 10560
v_mfma_f32_16x16x32_bf16 v[164:167], a[44:47], v[68:71], v[164:167]
s_add_u32 s48, s55, 10240
s_nop 1
v_mfma_f32_16x16x32_bf16 v[168:171], a[60:63], v[68:71], 0
s_nop 2
v_mfma_f32_16x16x32_bf16 v[168:171], a[56:59], v[64:67], v[168:171]
v_cvt_pk_bf16_f32 v108, v164, v165
v_cvt_pk_bf16_f32 v109, v166, v167
v_mfma_f32_16x16x32_bf16 v[168:171], a[52:55], v[60:63], v[168:171]
v_mfma_f32_16x16x32_bf16 v[168:171], a[48:51], v[56:59], v[168:171]
s_nop 2
v_mfma_f32_16x16x32_bf16 v[172:175], a[0:3], v[72:75], 0
s_waitcnt vmcnt(8)
ds_write_b64 v54, v[120:121] offset:0
v_mfma_f32_16x16x32_bf16 v[172:175], a[4:7], v[76:79], v[172:175]
ds_write_b64 v254, v[122:123] offset:0
v_mfma_f32_16x16x32_bf16 v[172:175], a[8:11], v[80:83], v[172:175]
buffer_load_dwordx4 v237, s[16:19], s48 offen nt lds
v_mfma_f32_16x16x32_bf16 v[172:175], a[12:15], v[84:87], v[172:175]
s_add_u32 m0, s49, 12672
s_add_u32 s48, s55, 12288
v_cvt_pk_bf16_f32 v110, v168, v169
v_mfma_f32_16x16x32_bf16 v[176:179], a[28:31], v[84:87], 0
s_waitcnt vmcnt(8)
ds_write_b64 v54, v[124:125] offset:512
v_mfma_f32_16x16x32_bf16 v[176:179], a[24:27], v[80:83], v[176:179]
ds_write_b64 v254, v[126:127] offset:512
v_mfma_f32_16x16x32_bf16 v[176:179], a[20:23], v[76:79], v[176:179]
s_waitcnt vmcnt(7)
ds_write_b64 v255, v[128:129] offset:1024
v_mfma_f32_16x16x32_bf16 v[176:179], a[16:19], v[72:75], v[176:179]
ds_write_b64 v55, v[130:131] offset:1024
v_mfma_f32_16x16x32_bf16 v[180:183], a[32:35], v[72:75], 0
s_waitcnt vmcnt(6)
ds_write_b64 v255, v[132:133] offset:1536
v_mfma_f32_16x16x32_bf16 v[180:183], a[36:39], v[76:79], v[180:183]
ds_write_b64 v55, v[134:135] offset:1536
v_mfma_f32_16x16x32_bf16 v[180:183], a[40:43], v[80:83], v[180:183]
buffer_load_dwordx4 v237, s[16:19], s48 offen nt lds
s_add_u32 m0, s49, 14784
v_mfma_f32_16x16x32_bf16 v[180:183], a[44:47], v[84:87], v[180:183]
s_add_u32 s48, s55, 14336
v_cvt_pk_bf16_f32 v111, v170, v171
v_cvt_pk_bf16_f32 v112, v172, v173
v_mfma_f32_16x16x32_bf16 v[152:155], a[60:63], v[84:87], 0
s_waitcnt vmcnt(6)
ds_write_b64 v54, v[136:137] offset:2048
v_mfma_f32_16x16x32_bf16 v[152:155], a[56:59], v[80:83], v[152:155]
ds_write_b64 v254, v[138:139] offset:2048
v_mfma_f32_16x16x32_bf16 v[152:155], a[52:55], v[76:79], v[152:155]
s_waitcnt vmcnt(5)
ds_write_b64 v54, v[140:141] offset:2560
v_mfma_f32_16x16x32_bf16 v[152:155], a[48:51], v[72:75], v[152:155]
ds_write_b64 v254, v[142:143] offset:2560
v_mfma_f32_16x16x32_bf16 v[156:159], v[56:59], a[128:131], 0
s_waitcnt vmcnt(4)
ds_write_b64 v255, v[144:145] offset:3072
v_mfma_f32_16x16x32_bf16 v[156:159], v[60:63], a[132:135], v[156:159]
ds_write_b64 v55, v[146:147] offset:3072
v_mfma_f32_16x16x32_bf16 v[156:159], v[64:67], a[136:139], v[156:159]
buffer_load_dwordx4 v237, s[16:19], s48 offen nt lds
s_add_u32 m0, s49, 16896
v_mfma_f32_16x16x32_bf16 v[156:159], v[68:71], a[140:143], v[156:159]
s_add_u32 s48, s55, 16384
buffer_load_dwordx4 v237, s[16:19], s48 offen nt lds
s_add_u32 m0, s49, 19008
v_mfma_f32_16x16x32_bf16 v[160:163], v[68:71], a[156:159], 0
s_add_u32 s48, s55, 18432
buffer_load_dwordx4 v237, s[16:19], s48 offen nt lds
s_add_u32 m0, s49, 21120
v_mfma_f32_16x16x32_bf16 v[160:163], v[64:67], a[152:155], v[160:163]
s_add_u32 s48, s55, 20480
buffer_load_dwordx4 v237, s[16:19], s48 offen nt lds
s_add_u32 m0, s49, 23232
v_mfma_f32_16x16x32_bf16 v[160:163], v[60:63], a[148:151], v[160:163]
s_add_u32 s48, s55, 22528
buffer_load_dwordx4 v237, s[16:19], s48 offen nt lds
v_cvt_pk_bf16_f32 v113, v174, v175
v_mfma_f32_16x16x32_bf16 v[160:163], v[56:59], a[144:147], v[160:163]
s_add_u32 s49, s49, 50688
v_cvt_pk_bf16_f32 v114, v176, v177
v_cvt_pk_bf16_f32 v115, v178, v179
v_mfma_f32_16x16x32_bf16 v[164:167], v[56:59], a[160:163], 0
s_waitcnt vmcnt(8)
ds_write_b64 v255, v[148:149] offset:3584
v_mfma_f32_16x16x32_bf16 v[164:167], v[60:63], a[164:167], v[164:167]
ds_write_b64 v55, v[150:151] offset:3584
v_mfma_f32_16x16x32_bf16 v[164:167], v[64:67], a[168:171], v[164:167]
v_cvt_pk_bf16_f32 v116, v180, v181
v_cvt_pk_bf16_f32 v117, v182, v183
v_mfma_f32_16x16x32_bf16 v[164:167], v[68:71], a[172:175], v[164:167]
v_cvt_pk_bf16_f32 v118, v152, v153
v_cvt_pk_bf16_f32 v119, v154, v155
v_mfma_f32_16x16x32_bf16 v[168:171], v[68:71], a[188:191], 0
v_cvt_pk_bf16_f32 v156, v156, v157
v_cvt_pk_bf16_f32 v157, v158, v159
v_mfma_f32_16x16x32_bf16 v[168:171], v[64:67], a[184:187], v[168:171]
v_cvt_pk_bf16_f32 v160, v160, v161
v_cvt_pk_bf16_f32 v161, v162, v163
v_mfma_f32_16x16x32_bf16 v[168:171], v[60:63], a[180:183], v[168:171]
s_waitcnt lgkmcnt(0)
s_barrier
v_mfma_f32_16x16x32_bf16 v[168:171], v[56:59], a[176:179], v[168:171]
ds_read_b64_tr_b16 a[192:193], v248 offset:0
ds_read_b64_tr_b16 a[194:195], v248 offset:512
v_mfma_f32_16x16x32_bf16 v[172:175], v[72:75], a[128:131], 0
ds_read_b64_tr_b16 a[196:197], v248 offset:4096
ds_read_b64_tr_b16 a[198:199], v248 offset:4608
v_mfma_f32_16x16x32_bf16 v[172:175], v[76:79], a[132:135], v[172:175]
ds_read_b64_tr_b16 a[200:201], v248 offset:8192
ds_read_b64_tr_b16 a[202:203], v248 offset:8704
v_mfma_f32_16x16x32_bf16 v[172:175], v[80:83], a[136:139], v[172:175]
ds_read_b64_tr_b16 a[204:205], v248 offset:12288
ds_read_b64_tr_b16 a[206:207], v248 offset:12800
v_mfma_f32_16x16x32_bf16 v[172:175], v[84:87], a[140:143], v[172:175]
ds_read_b64_tr_b16 a[208:209], v249 offset:0
ds_read_b64_tr_b16 a[210:211], v249 offset:512
v_mfma_f32_16x16x32_bf16 v[176:179], v[84:87], a[156:159], 0
ds_read_b64_tr_b16 a[212:213], v249 offset:4096
ds_read_b64_tr_b16 a[214:215], v249 offset:4608
v_mfma_f32_16x16x32_bf16 v[176:179], v[80:83], a[152:155], v[176:179]
s_waitcnt lgkmcnt(10)
ds_read_b64_tr_b16 a[216:217], v249 offset:8192
ds_read_b64_tr_b16 a[218:219], v249 offset:8704
v_mfma_f32_16x16x32_bf16 v[176:179], v[76:79], a[148:151], v[176:179]
s_waitcnt lgkmcnt(10)
ds_read_b64_tr_b16 a[220:221], v249 offset:12288
ds_read_b64_tr_b16 a[222:223], v249 offset:12800
v_mfma_f32_16x16x32_bf16 v[176:179], v[72:75], a[144:147], v[176:179]
s_waitcnt lgkmcnt(10)
ds_read_b64_tr_b16 a[224:225], v250 offset:0
ds_read_b64_tr_b16 a[226:227], v250 offset:512
v_mfma_f32_16x16x32_bf16 v[180:183], v[72:75], a[160:163], 0
s_waitcnt lgkmcnt(10)
ds_read_b64_tr_b16 a[228:229], v250 offset:4096
ds_read_b64_tr_b16 a[230:231], v250 offset:4608
v_mfma_f32_16x16x32_bf16 v[180:183], v[76:79], a[164:167], v[180:183]
s_waitcnt lgkmcnt(10)
ds_read_b64_tr_b16 a[232:233], v250 offset:8192
ds_read_b64_tr_b16 a[234:235], v250 offset:8704
v_mfma_f32_16x16x32_bf16 v[180:183], v[80:83], a[168:171], v[180:183]
s_waitcnt lgkmcnt(10)
ds_read_b64_tr_b16 a[236:237], v250 offset:12288
ds_read_b64_tr_b16 a[238:239], v250 offset:12800
v_mfma_f32_16x16x32_bf16 v[180:183], v[84:87], a[172:175], v[180:183]
s_waitcnt lgkmcnt(10)
ds_read_b64_tr_b16 a[240:241], v251 offset:0
ds_read_b64_tr_b16 a[242:243], v251 offset:512
v_mfma_f32_16x16x32_bf16 v[152:155], v[84:87], a[188:191], 0
s_waitcnt lgkmcnt(10)
ds_read_b64_tr_b16 a[244:245], v251 offset:4096
ds_read_b64_tr_b16 a[246:247], v251 offset:4608
v_mfma_f32_16x16x32_bf16 v[152:155], v[80:83], a[184:187], v[152:155]
s_waitcnt lgkmcnt(10)
ds_read_b64_tr_b16 a[248:249], v251 offset:8192
ds_read_b64_tr_b16 a[250:251], v251 offset:8704
v_mfma_f32_16x16x32_bf16 v[152:155], v[76:79], a[180:183], v[152:155]
s_waitcnt lgkmcnt(10)
ds_read_b64_tr_b16 a[252:253], v251 offset:12288
ds_read_b64_tr_b16 a[254:255], v251 offset:12800
v_mfma_f32_16x16x32_bf16 v[152:155], v[72:75], a[176:179], v[152:155]
s_waitcnt lgkmcnt(10)
ds_write_b128 v50, v[88:91] offset:0
ds_write_b128 v50, v[104:107] offset:4096
ds_write_b64 v51, v[156:157] offset:0
ds_write_b128 v50, v[92:95] offset:64
ds_write_b128 v50, v[108:111] offset:4160
ds_write_b64 v51, v[160:161] offset:128
v_cvt_pk_bf16_f32 v164, v164, v165
v_cvt_pk_bf16_f32 v165, v166, v167
v_cvt_pk_bf16_f32 v168, v168, v169
v_cvt_pk_bf16_f32 v169, v170, v171
v_cvt_pk_bf16_f32 v172, v172, v173
v_cvt_pk_bf16_f32 v173, v174, v175
v_cvt_pk_bf16_f32 v176, v176, v177
v_cvt_pk_bf16_f32 v177, v178, v179
v_cvt_pk_bf16_f32 v180, v180, v181
v_cvt_pk_bf16_f32 v181, v182, v183
v_cvt_pk_bf16_f32 v152, v152, v153
v_cvt_pk_bf16_f32 v153, v154, v155
v_mov_b32 v105, 0
v_mov_b32 v107, 0
v_mov_b32 v109, 0
v_mov_b32 v111, 0
v_mov_b32 v133, 0
v_mov_b32 v134, 0
v_mov_b32 v135, 0
v_mov_b32 v149, 0
v_mov_b32 v150, 0
v_mov_b32 v151, 0
v_mov_b32 v248, 1.0
v_mov_b32 v249, 1.0
v_mov_b32 v251, 1.0
ds_write_b64 v51, v[164:165] offset:256
ds_write_b64 v51, v[168:169] offset:384
ds_write_b128 v50, v[96:99] offset:2048
ds_write_b128 v50, v[112:115] offset:6144
ds_write_b64 v51, v[172:173] offset:2048
ds_write_b64 v51, v[176:177] offset:2176
s_waitcnt vmcnt(4)
s_barrier
ds_read_b128 v[200:203], v236 offset:8704
ds_read_b128 v[212:215], v236 offset:8448
ds_read_b128 v[224:227], v236 offset:8960
ds_read_b128 v[228:231], v236 offset:9216
ds_read_b128 v[192:195], v236 offset:13440
ds_read_b128 v[204:207], v236 offset:12928
ds_read_b128 v[208:211], v236 offset:12672
ds_write_b128 v50, v[100:103] offset:2112
ds_write_b128 v50, v[116:119] offset:6208
s_waitcnt lgkmcnt(8)
v_mfma_f32_16x16x32_bf16 v[184:187], a[68:71], v[200:203], 0
s_waitcnt lgkmcnt(6)
ds_write_b64 v51, v[180:181] offset:2304
v_mfma_f32_16x16x32_bf16 v[184:187], a[64:67], v[212:215], v[184:187]
s_waitcnt lgkmcnt(2)
ds_write_b64 v51, v[152:153] offset:2432
v_mfma_f32_16x16x32_bf16 v[184:187], a[72:75], v[224:227], v[184:187]
v_mfma_f32_16x16x32_bf16 v[184:187], a[76:79], v[228:231], v[184:187]
s_nop 2
v_mfma_f32_16x16x32_bf16 v[188:191], a[92:95], v[228:231], 0
s_nop 2
v_mfma_f32_16x16x32_bf16 v[188:191], a[88:91], v[224:227], v[188:191]
v_cvt_pk_bf16_f32 v16, v184, v185
v_cvt_pk_bf16_f32 v17, v186, v187
v_mfma_f32_16x16x32_bf16 v[188:191], a[84:87], v[200:203], v[188:191]
ds_read_b128 v[184:187], v236 offset:13184
v_mfma_f32_16x16x32_bf16 v[188:191], a[80:83], v[212:215], v[188:191]
s_nop 2
v_mfma_f32_16x16x32_bf16 v[196:199], a[96:99], v[212:215], 0
s_nop 2
v_mfma_f32_16x16x32_bf16 v[196:199], a[100:103], v[200:203], v[196:199]
v_cvt_pk_bf16_f32 v18, v188, v189
v_cvt_pk_bf16_f32 v19, v190, v191
v_mfma_f32_16x16x32_bf16 v[196:199], a[104:107], v[224:227], v[196:199]
v_mfma_f32_16x16x32_bf16 v[196:199], a[108:111], v[228:231], v[196:199]
s_nop 2
v_mfma_f32_16x16x32_bf16 v[188:191], a[124:127], v[228:231], 0
s_waitcnt lgkmcnt(0)
s_nop 1
v_mfma_f32_16x16x32_bf16 v[188:191], a[116:119], v[200:203], v[188:191]
v_cvt_pk_bf16_f32 v21, v198, v199
v_cvt_pk_bf16_f32 v20, v196, v197
v_mfma_f32_16x16x32_bf16 v[188:191], a[112:115], v[212:215], v[188:191]
v_mfma_f32_16x16x32_bf16 v[188:191], a[120:123], v[224:227], v[188:191]
s_nop 2
v_mfma_f32_16x16x32_bf16 v[196:199], a[120:123], v[184:187], 0
s_nop 2
v_mfma_f32_16x16x32_bf16 v[196:199], a[124:127], v[192:195], v[196:199]
v_cvt_pk_bf16_f32 v23, v190, v191
v_cvt_pk_bf16_f32 v22, v188, v189
v_mfma_f32_16x16x32_bf16 v[196:199], a[116:119], v[204:207], v[196:199]
v_mfma_f32_16x16x32_bf16 v[196:199], a[112:115], v[208:211], v[196:199]
s_nop 2
v_mfma_f32_16x16x32_bf16 v[188:191], a[96:99], v[208:211], 0
s_nop 2
v_mfma_f32_16x16x32_bf16 v[188:191], a[100:103], v[204:207], v[188:191]
v_cvt_pk_bf16_f32 v30, v196, v197
v_cvt_pk_bf16_f32 v31, v198, v199
v_mfma_f32_16x16x32_bf16 v[188:191], a[104:107], v[184:187], v[188:191]
v_mfma_f32_16x16x32_bf16 v[188:191], a[108:111], v[192:195], v[188:191]
s_nop 2
v_mfma_f32_16x16x32_bf16 v[212:215], a[92:95], v[192:195], 0
s_nop 2
v_mfma_f32_16x16x32_bf16 v[212:215], a[88:91], v[184:187], v[212:215]
v_cvt_pk_bf16_f32 v29, v190, v191
v_cvt_pk_bf16_f32 v28, v188, v189
v_mfma_f32_16x16x32_bf16 v[212:215], a[84:87], v[204:207], v[212:215]
v_mfma_f32_16x16x32_bf16 v[212:215], a[80:83], v[208:211], v[212:215]
s_nop 2
v_mfma_f32_16x16x32_bf16 v[188:191], a[64:67], v[208:211], 0
s_nop 2
v_mfma_f32_16x16x32_bf16 v[188:191], a[72:75], v[184:187], v[188:191]
v_cvt_pk_bf16_f32 v27, v214, v215
v_cvt_pk_bf16_f32 v26, v212, v213
v_mfma_f32_16x16x32_bf16 v[188:191], a[76:79], v[192:195], v[188:191]
s_waitcnt vmcnt(0)
s_barrier
v_mfma_f32_16x16x32_bf16 v[188:191], a[68:71], v[204:207], v[188:191]
s_mov_b32 s48, s50
ds_read_b128 v[196:199], v236 offset:17152
ds_read_b128 v[200:203], v236 offset:16896
ds_read_b128 v[216:219], v236 offset:17408
ds_read_b128 v[220:223], v236 offset:17664
ds_read_u16 v108, v241 offset:256
ds_read_b128 v[204:207], v236 offset:21376
ds_read_b128 v[208:211], v236 offset:21120
ds_read_b128 v[52:55], v240 offset:64
v_cvt_pk_bf16_f32 v24, v188, v189
v_cvt_pk_bf16_f32 v25, v190, v191
s_add_u32 m0, s49, 0
s_add_u32 s50, s50, 13107200
buffer_load_dwordx4 v237, s[16:19], s48 offen nt lds
ds_read_b128 v[192:195], v236 offset:21888
ds_read_b128 v[48:51], v240 offset:0
ds_read_u16 v110, v241 offset:384
v_add_u32 v240, 0x200, v240
s_add_u32 s48, s48, s51
s_add_u32 m0, s49, 2112
ds_read_u16 v106, v241 offset:128
buffer_load_dwordx4 v237, s[16:19], s48 offen nt lds
s_waitcnt lgkmcnt(11)
v_mfma_f32_16x16x32_bf16 v[184:187], a[68:71], v[196:199], 0
s_waitcnt lgkmcnt(9)
ds_read_u16 v104, v241 offset:0
s_add_u32 m0, s49, 4224
v_mfma_f32_16x16x32_bf16 v[184:187], a[64:67], v[200:203], v[184:187]
s_waitcnt lgkmcnt(6)
s_add_u32 s48, s48, s51
buffer_load_dwordx4 v237, s[16:19], s48 offen nt lds
v_mfma_f32_16x16x32_bf16 v[184:187], a[72:75], v[216:219], v[184:187]
s_add_u32 m0, s49, 6336
s_add_u32 s48, s48, s51
buffer_load_dwordx4 v237, s[16:19], s48 offen nt lds
v_mfma_f32_16x16x32_bf16 v[184:187], a[76:79], v[220:223], v[184:187]
s_add_u32 m0, s49, 8448
s_add_u32 s48, s48, s51
buffer_load_dwordx4 v237, s[16:19], s48 offen nt lds
v_mfma_f32_16x16x32_bf16 v[188:191], a[92:95], v[220:223], 0
s_add_u32 m0, s49, 10560
s_mov_b32 s47, s46
s_add_u32 s48, s48, s51
v_mfma_f32_16x16x32_bf16 v[188:191], a[88:91], v[216:219], v[188:191]
s_bfe_i32 s57, s3, 0x10000
buffer_load_dwordx4 v237, s[16:19], s48 offen nt lds
v_cvt_pk_bf16_f32 v32, v184, v185
v_mfma_f32_16x16x32_bf16 v[188:191], a[84:87], v[196:199], v[188:191]
s_and_b32 s54, s57, s5
v_cvt_pk_bf16_f32 v33, v186, v187
s_sub_u32 s45, s45, 1
v_mfma_f32_16x16x32_bf16 v[188:191], a[80:83], v[200:203], v[188:191]
s_sub_u32 s50, s50, s54
s_add_u32 s52, s46, 20480
s_lshr_b32 s3, s3, 1
v_mfma_f32_16x16x32_bf16 v[184:187], a[96:99], v[200:203], 0
s_waitcnt lgkmcnt(0)
s_nop 1
v_mfma_f32_16x16x32_bf16 v[184:187], a[100:103], v[196:199], v[184:187]
v_cvt_pk_bf16_f32 v35, v190, v191
v_cvt_pk_bf16_f32 v34, v188, v189
v_mfma_f32_16x16x32_bf16 v[184:187], a[104:107], v[216:219], v[184:187]
v_mfma_f32_16x16x32_bf16 v[184:187], a[108:111], v[220:223], v[184:187]
s_nop 2
v_mfma_f32_16x16x32_bf16 v[188:191], a[124:127], v[220:223], 0
s_nop 2
v_mfma_f32_16x16x32_bf16 v[188:191], a[120:123], v[216:219], v[188:191]
v_cvt_pk_bf16_f32 v37, v186, v187
v_cvt_pk_bf16_f32 v36, v184, v185
v_mfma_f32_16x16x32_bf16 v[188:191], a[116:119], v[196:199], v[188:191]
ds_read_b128 v[196:199], v236 offset:21632
v_mfma_f32_16x16x32_bf16 v[188:191], a[112:115], v[200:203], v[188:191]
s_nop 7
v_cvt_pk_bf16_f32 v39, v190, v191
v_cvt_pk_bf16_f32 v38, v188, v189
s_nop 7
s_waitcnt lgkmcnt(0)
s_branch L_entrys
.p2align 6
L_loops:
s_waitcnt vmcnt(8)
s_barrier
v_mfma_f32_16x16x32_bf16 v[176:179], a[224:227], v[220:223], 0
s_add_u32 s52, s47, 8192
v_exp_f32 v187, v187
v_mfma_f32_16x16x32_bf16 v[176:179], a[228:231], v[224:227], v[176:179]
s_add_u32 s53, s47, 12288
v_add_f32 v248, v184, v185
v_add_f32 v248, v248, v186
v_mfma_f32_16x16x32_bf16 v[176:179], a[232:235], v[212:215], v[176:179]
s_mov_b32 s47, s46
v_add_f32 v248, v248, v187
v_cvt_pk_bf16_f32 v120, v184, v185
v_mfma_f32_16x16x32_bf16 v[176:179], a[236:239], v[216:219], v[176:179]
s_bfe_i32 s57, s3, 0x10000
v_cvt_pk_bf16_f32 v121, v186, v187
v_sub_f32 v193, v193, v254
v_mfma_f32_16x16x32_bf16 v[180:183], a[252:255], v[216:219], 0
s_and_b32 s54, s57, s5
v_exp_f32 v188, v188
v_mfma_f32_16x16x32_bf16 v[180:183], a[248:251], v[212:215], v[180:183]
s_sub_u32 s45, s45, 1
v_exp_f32 v190, v190
v_mfma_f32_16x16x32_bf16 v[180:183], a[244:247], v[224:227], v[180:183]
s_lshr_b32 s3, s3, 1
v_sub_f32 v194, v194, v254
v_add_f32 v248, v248, v188
v_mfma_f32_16x16x32_bf16 v[180:183], a[240:243], v[220:223], v[180:183]
v_exp_f32 v189, v189
v_mfma_f32_16x16x32_bf16 v[212:215], v[0:3], v[112:115], 0
v_add_f32 v248, v248, v189
v_sub_f32 v191, v191, v254
v_mfma_f32_16x16x32_bf16 v[212:215], v[4:7], v[116:119], v[212:215]
v_exp_f32 v191, v191
v_mfma_f32_16x16x32_bf16 v[216:219], v[12:15], v[116:119], 0
v_sub_f32 v195, v195, v254
v_sub_f32 v192, v192, v254
v_mfma_f32_16x16x32_bf16 v[216:219], v[8:11], v[112:115], v[216:219]
v_exp_f32 v192, v192
v_mfma_f32_16x16x32_bf16 v[220:223], v[16:19], v[112:115], 0
v_exp_f32 v194, v194
v_mfma_f32_16x16x32_bf16 v[220:223], v[20:23], v[116:119], v[220:223]
v_exp_f32 v193, v193
v_mfma_f32_16x16x32_bf16 v[224:227], v[28:31], v[116:119], 0
v_add_f32 v248, v248, v190
v_add_f32 v248, v248, v191
v_mfma_f32_16x16x32_bf16 v[224:227], v[24:27], v[112:115], v[224:227]
v_exp_f32 v195, v195
v_mfma_f32_16x16x32_bf16 v[228:231], v[32:35], v[112:115], 0
v_add_f32 v248, v248, v192
v_add_f32 v248, v248, v193
v_mfma_f32_16x16x32_bf16 v[228:231], v[36:39], v[116:119], v[228:231]
v_add_f32 v248, v248, v194
v_add_f32 v248, v248, v195
v_mfma_f32_16x16x32_bf16 v[232:235], v[44:47], v[116:119], 0
v_cvt_pk_bf16_f32 v123, v190, v191
v_cvt_pk_bf16_f32 v122, v188, v189
v_mfma_f32_16x16x32_bf16 v[232:235], v[40:43], v[112:115], v[232:235]
s_mov_b32 s48, s50
ds_read_b128 v[188:191], v236 offset:0
v_cvt_pk_bf16_f32 v125, v194, v195
v_mfma_f32_16x16x32_bf16 v[184:187], v[48:51], v[112:115], 0
s_add_u32 m0, s49, 0
ds_read_b128 v[48:51], v240 offset:0
v_cvt_pk_bf16_f32 v124, v192, v193
v_mfma_f32_16x16x32_bf16 v[184:187], v[52:55], v[116:119], v[184:187]
s_add_u32 s50, s50, 13107200
buffer_load_dwordx4 v237, s[16:19], s48 offen nt lds
v_sub_f32 v196, v196, v254
v_sub_f32 v197, v197, v254
v_sub_f32 v199, v199, v254
v_sub_f32 v198, v198, v254
v_exp_f32 v196, v196
v_exp_f32 v197, v197
v_add_f32 v248, v248, v196
v_add_f32 v248, v248, v197
v_exp_f32 v198, v198
s_waitcnt lgkmcnt(1)
v_mfma_f32_16x16x32_bf16 v[192:195], a[64:67], v[188:191], 0
s_sub_u32 s50, s50, s54
ds_read_b128 v[52:55], v240 offset:64
v_exp_f32 v199, v199
v_add_f32 v248, v248, v198
v_add_f32 v248, v248, v199
v_cvt_pk_bf16_f32 v126, v196, v197
v_cvt_pk_bf16_f32 v127, v198, v199
ds_read_b128 v[196:199], v236 offset:256
v_sub_f32 v200, v200, v254
v_sub_f32 v203, v203, v254
v_sub_f32 v201, v201, v254
v_exp_f32 v201, v201
v_sub_f32 v202, v202, v254
v_exp_f32 v202, v202
v_exp_f32 v200, v200
v_exp_f32 v203, v203
v_add_f32 v248, v248, v200
v_add_f32 v248, v248, v201
v_add_f32 v248, v248, v202
v_add_f32 v248, v248, v203
v_cvt_pk_bf16_f32 v128, v200, v201
v_cvt_pk_bf16_f32 v129, v202, v203
v_sub_f32 v204, v204, v254
v_sub_f32 v205, v205, v254
s_waitcnt lgkmcnt(0)
v_mfma_f32_16x16x32_bf16 v[192:195], a[68:71], v[196:199], v[192:195]
ds_read_b128 v[200:203], v236 offset:512
v_exp_f32 v204, v204
v_sub_f32 v206, v206, v254
v_add_f32 v248, v248, v204
v_exp_f32 v206, v206
v_sub_f32 v207, v207, v254
v_exp_f32 v205, v205
v_exp_f32 v207, v207
v_add_f32 v248, v248, v205
v_cvt_pk_bf16_f32 v130, v204, v205
v_add_f32 v248, v248, v206
v_add_f32 v248, v248, v207
v_cvt_pk_bf16_f32 v131, v206, v207
v_sub_f32 v208, v208, v254
v_exp_f32 v208, v208
v_max3_f32 v254, v212, v213, v214
s_waitcnt lgkmcnt(0)
v_mfma_f32_16x16x32_bf16 v[192:195], a[72:75], v[200:203], v[192:195]
ds_read_b128 v[204:207], v236 offset:768
v_add_f32 v248, v248, v208
v_cvt_pk_bf16_f32 v132, v208, 0
v_max3_f32 v254, v254, v215, v216
v_max3_f32 v254, v254, v217, v218
v_max3_f32 v254, v254, v219, v220
v_max3_f32 v254, v254, v221, v222
v_max3_f32 v254, v254, v223, v224
v_max3_f32 v254, v254, v225, v226
v_max3_f32 v254, v254, v227, v228
v_max3_f32 v254, v254, v229, v230
v_max3_f32 v254, v254, v231, v232
v_max3_f32 v254, v254, v233, v234
v_max3_f32 v254, v254, v235, v184
v_add_u32 v240, 0x200, v240
ds_swizzle_b32 v250, v248 offset:0x401F
ds_swizzle_b32 v255, v254 offset:0x401F
s_waitcnt lgkmcnt(2)
v_mfma_f32_16x16x32_bf16 v[192:195], a[76:79], v[204:207], v[192:195]
s_nop 2
v_mfma_f32_16x16x32_bf16 v[208:211], a[92:95], v[204:207], 0
s_nop 2
v_mfma_f32_16x16x32_bf16 v[208:211], a[88:91], v[200:203], v[208:211]
v_cvt_pk_bf16_f32 v0, v192, v193
v_cvt_pk_bf16_f32 v1, v194, v195
v_mfma_f32_16x16x32_bf16 v[208:211], a[84:87], v[196:199], v[208:211]
v_mfma_f32_16x16x32_bf16 v[208:211], a[80:83], v[188:191], v[208:211]
s_waitcnt lgkmcnt(0)
v_add_f32 v248, v248, v250
v_max_f32 v254, v254, v255
v_mfma_f32_16x16x32_bf16 v[192:195], a[96:99], v[188:191], 0
ds_bpermute_b32 v250, v247, v248
v_mfma_f32_16x16x32_bf16 v[192:195], a[100:103], v[196:199], v[192:195]
ds_bpermute_b32 v255, v247, v254
v_mfma_f32_16x16x32_bf16 v[192:195], a[104:107], v[200:203], v[192:195]
v_cvt_pk_bf16_f32 v2, v208, v209
v_cvt_pk_bf16_f32 v3, v210, v211
v_mfma_f32_16x16x32_bf16 v[192:195], a[108:111], v[204:207], v[192:195]
s_nop 2
v_mfma_f32_16x16x32_bf16 v[208:211], a[124:127], v[204:207], 0
s_nop 2
v_mfma_f32_16x16x32_bf16 v[208:211], a[120:123], v[200:203], v[208:211]
v_cvt_pk_bf16_f32 v5, v194, v195
v_cvt_pk_bf16_f32 v4, v192, v193
v_mfma_f32_16x16x32_bf16 v[208:211], a[116:119], v[196:199], v[208:211]
s_waitcnt lgkmcnt(1)
v_add_f32 v248, v248, v250
v_mfma_f32_16x16x32_bf16 v[208:211], a[112:115], v[188:191], v[208:211]
s_waitcnt lgkmcnt(0)
v_rcp_f32 v251, v248
v_mfma_f32_16x16x32_bf16 v[188:191], v[56:59], v[120:123], 0
v_max_f32 v254, v254, v255
v_sub_f32 v214, v214, v254
v_mfma_f32_16x16x32_bf16 v[188:191], v[104:107], v[132:135], v[188:191]
s_add_u32 s48, s48, s51
v_sub_f32 v215, v215, v254
v_cvt_pk_bf16_f32 v6, v208, v209
v_mfma_f32_16x16x32_bf16 v[188:191], v[72:75], v[124:127], v[188:191]
s_add_u32 m0, s49, 2112
v_cvt_pk_bf16_f32 v7, v210, v211
v_sub_f32 v212, v212, v254
v_mfma_f32_16x16x32_bf16 v[188:191], v[88:91], v[128:131], v[188:191]
buffer_load_dwordx4 v237, s[16:19], s48 offen nt lds
v_sub_f32 v213, v213, v254
v_mfma_f32_16x16x32_bf16 v[196:199], v[92:95], v[128:131], 0
v_exp_f32 v212, v212
v_mfma_f32_16x16x32_bf16 v[196:199], v[76:79], v[124:127], v[196:199]
v_exp_f32 v214, v214
v_mfma_f32_16x16x32_bf16 v[196:199], v[106:109], v[132:135], v[196:199]
v_exp_f32 v213, v213
v_mfma_f32_16x16x32_bf16 v[196:199], v[60:63], v[120:123], v[196:199]
ds_read_b128 v[204:207], v236 offset:4480
v_sub_f32 v216, v216, v254
v_mfma_f32_16x16x32_bf16 v[200:203], v[64:67], v[120:123], 0
ds_read_b128 v[192:195], v236 offset:4224
v_sub_f32 v217, v217, v254
v_mfma_f32_16x16x32_bf16 v[200:203], v[108:111], v[132:135], v[200:203]
v_exp_f32 v215, v215
v_mfma_f32_16x16x32_bf16 v[200:203], v[80:83], v[124:127], v[200:203]
v_exp_f32 v217, v217
v_mfma_f32_16x16x32_bf16 v[200:203], v[96:99], v[128:131], v[200:203]
v_sub_f32 v218, v218, v254
v_add_f32 v249, v212, v213
v_mfma_f32_16x16x32_bf16 v[208:211], v[100:103], v[128:131], 0
v_add_f32 v249, v249, v214
v_add_f32 v249, v249, v215
v_mfma_f32_16x16x32_bf16 v[208:211], v[84:87], v[124:127], v[208:211]
s_waitcnt lgkmcnt(1)
v_exp_f32 v216, v216
v_mfma_f32_16x16x32_bf16 v[208:211], v[110:113], v[132:135], v[208:211]
s_waitcnt lgkmcnt(0)
v_sub_f32 v219, v219, v254
v_sub_f32 v220, v220, v254
v_mfma_f32_16x16x32_bf16 v[208:211], v[68:71], v[120:123], v[208:211]
v_exp_f32 v218, v218
v_sub_f32 v223, v223, v254
v_add_f32 v249, v249, v216
v_add_f32 v249, v249, v217
v_exp_f32 v219, v219
v_add_f32 v249, v249, v218
v_add_f32 v249, v249, v219
v_exp_f32 v220, v220
v_sub_f32 v224, v224, v254
v_exp_f32 v223, v223
v_sub_f32 v221, v221, v254
v_exp_f32 v224, v224
v_exp_f32 v221, v221
v_sub_f32 v222, v222, v254
v_sub_f32 v225, v225, v254
v_add_f32 v249, v249, v220
v_add_f32 v249, v249, v221
v_exp_f32 v222, v222
v_exp_f32 v225, v225
v_add_f32 v249, v249, v222
v_add_f32 v249, v249, v223
v_add_f32 v249, v249, v224
v_sub_f32 v226, v226, v254
v_add_f32 v249, v249, v225
v_exp_f32 v226, v226
v_sub_f32 v227, v227, v254
v_exp_f32 v227, v227
v_sub_f32 v228, v228, v254
v_exp_f32 v228, v228
v_add_f32 v249, v249, v226
v_sub_f32 v232, v232, v254
v_sub_f32 v229, v229, v254
v_sub_f32 v230, v230, v254
v_exp_f32 v230, v230
v_exp_f32 v229, v229
v_add_f32 v249, v249, v227
v_add_f32 v249, v249, v228
v_add_f32 v249, v249, v229
v_exp_f32 v232, v232
v_sub_f32 v233, v233, v254
v_exp_f32 v233, v233
v_sub_f32 v231, v231, v254
v_exp_f32 v231, v231
v_sub_f32 v234, v234, v254
v_sub_f32 v235, v235, v254
v_add_f32 v249, v249, v230
v_add_f32 v249, v249, v231
v_add_f32 v249, v249, v232
v_exp_f32 v234, v234
v_exp_f32 v235, v235
v_sub_f32 v184, v184, v254
v_exp_f32 v184, v184
v_add_f32 v249, v249, v233
v_cvt_pk_bf16_f32 v148, v184, 0
v_add_f32 v249, v249, v234
v_add_f32 v249, v249, v235
v_add_f32 v249, v249, v184
v_fmac_f32 v161, v201, v251
v_fmac_f32 v163, v203, v251
v_fmac_f32 v160, v200, v251
v_fmac_f32 v162, v202, v251
ds_read_b128 v[184:187], v236 offset:4992
v_cvt_pk_bf16_f32 v138, v216, v217
v_cvt_pk_bf16_f32 v139, v218, v219
v_fmac_f32 v167, v211, v251
v_fmac_f32 v165, v209, v251
v_fmac_f32 v166, v210, v251
v_fmac_f32 v164, v208, v251
v_cvt_pk_bf16_f32 v140, v220, v221
v_cvt_pk_bf16_f32 v141, v222, v223
v_fmac_f32 v155, v191, v251
v_fmac_f32 v154, v190, v251
v_fmac_f32 v152, v188, v251
v_fmac_f32 v153, v189, v251
v_cvt_pk_bf16_f32 v137, v214, v215
v_cvt_pk_bf16_f32 v136, v212, v213
v_cvt_pk_bf16_f32 v143, v226, v227
v_cvt_pk_bf16_f32 v142, v224, v225
v_cvt_pk_bf16_f32 v145, v230, v231
v_cvt_pk_bf16_f32 v144, v228, v229
v_fmac_f32 v156, v196, v251
v_fmac_f32 v157, v197, v251
s_waitcnt lgkmcnt(0)
v_mfma_f32_16x16x32_bf16 v[200:203], a[124:127], v[184:187], 0
ds_read_b128 v[216:219], v236 offset:4736
v_fmac_f32 v158, v198, v251
v_fmac_f32 v159, v199, v251
v_cvt_pk_bf16_f32 v147, v234, v235
v_cvt_pk_bf16_f32 v146, v232, v233
v_cvt_pk_bf16_f32 v160, v160, v161
v_cvt_pk_bf16_f32 v161, v162, v163
v_cvt_pk_bf16_f32 v163, v166, v167
v_cvt_pk_bf16_f32 v162, v164, v165
v_cvt_pk_bf16_f32 v152, v152, v153
v_cvt_pk_bf16_f32 v153, v154, v155
v_pk_max_i16 v160, v160, 0
v_pk_max_i16 v162, v162, 0
v_pk_max_i16 v153, v153, 0
v_pk_max_i16 v161, v161, 0
v_pk_max_i16 v163, v163, 0
v_cvt_pk_bf16_f32 v155, v158, v159
v_pk_max_i16 v155, v155, 0
v_pk_max_i16 v152, v152, 0
v_cvt_pk_bf16_f32 v154, v156, v157
v_pk_max_i16 v154, v154, 0
s_waitcnt lgkmcnt(0)
v_mfma_f32_16x16x32_bf16 v[200:203], a[120:123], v[216:219], v[200:203]
ds_swizzle_b32 v250, v249 offset:0x401F
buffer_store_dwordx4 v[152:155], v239, s[20:23], s52 offen offset:0 nt
buffer_store_dwordx4 v[160:163], v239, s[20:23], s52 offen offset:64 nt
s_add_u32 s52, s46, 20480
v_mfma_f32_16x16x32_bf16 v[200:203], a[116:119], v[204:207], v[200:203]
v_mfma_f32_16x16x32_bf16 v[200:203], a[112:115], v[192:195], v[200:203]
s_nop 2
v_mfma_f32_16x16x32_bf16 v[208:211], a[96:99], v[192:195], 0
s_waitcnt lgkmcnt(0)
v_add_f32 v249, v249, v250
v_mfma_f32_16x16x32_bf16 v[208:211], a[100:103], v[204:207], v[208:211]
s_add_u32 m0, s49, 4224
ds_bpermute_b32 v250, v247, v249
v_mfma_f32_16x16x32_bf16 v[208:211], a[104:107], v[216:219], v[208:211]
s_add_u32 s48, s48, s51
buffer_load_dwordx4 v237, s[16:19], s48 offen nt lds
v_cvt_pk_bf16_f32 v14, v200, v201
v_mfma_f32_16x16x32_bf16 v[208:211], a[108:111], v[184:187], v[208:211]
ds_read_b128 v[212:215], v236 offset:8448
v_cvt_pk_bf16_f32 v15, v202, v203
v_mfma_f32_16x16x32_bf16 v[220:223], a[92:95], v[184:187], 0
ds_read_b128 v[200:203], v236 offset:8704
ds_read_b128 v[224:227], v236 offset:8960
v_mfma_f32_16x16x32_bf16 v[220:223], a[88:91], v[216:219], v[220:223]
ds_read_b128 v[228:231], v236 offset:9216
v_mfma_f32_16x16x32_bf16 v[220:223], a[84:87], v[204:207], v[220:223]
v_cvt_pk_bf16_f32 v13, v210, v211
v_cvt_pk_bf16_f32 v12, v208, v209
v_mfma_f32_16x16x32_bf16 v[220:223], a[80:83], v[192:195], v[220:223]
s_waitcnt lgkmcnt(4)
v_add_f32 v249, v249, v250
s_nop 0
v_mfma_f32_16x16x32_bf16 v[188:191], a[64:67], v[192:195], 0
v_rcp_f32 v252, v249
v_mfma_f32_16x16x32_bf16 v[188:191], a[72:75], v[216:219], v[188:191]
s_waitcnt lgkmcnt(3)
s_nop 0
v_cvt_pk_bf16_f32 v10, v220, v221
v_mfma_f32_16x16x32_bf16 v[188:191], a[76:79], v[184:187], v[188:191]
s_waitcnt lgkmcnt(1)
v_cvt_pk_bf16_f32 v11, v222, v223
v_mfma_f32_16x16x32_bf16 v[188:191], a[68:71], v[204:207], v[188:191]
s_waitcnt lgkmcnt(0)
s_nop 1
v_mfma_f32_16x16x32_bf16 v[184:187], a[68:71], v[200:203], 0
s_nop 2
v_mfma_f32_16x16x32_bf16 v[184:187], a[64:67], v[212:215], v[184:187]
v_cvt_pk_bf16_f32 v9, v190, v191
v_cvt_pk_bf16_f32 v8, v188, v189
v_mfma_f32_16x16x32_bf16 v[184:187], a[72:75], v[224:227], v[184:187]
v_mfma_f32_16x16x32_bf16 v[184:187], a[76:79], v[228:231], v[184:187]
s_nop 2
v_mfma_f32_16x16x32_bf16 v[188:191], a[92:95], v[228:231], 0
s_nop 2
v_mfma_f32_16x16x32_bf16 v[188:191], a[88:91], v[224:227], v[188:191]
v_cvt_pk_bf16_f32 v16, v184, v185
v_cvt_pk_bf16_f32 v17, v186, v187
v_mfma_f32_16x16x32_bf16 v[188:191], a[84:87], v[200:203], v[188:191]
v_mfma_f32_16x16x32_bf16 v[188:191], a[80:83], v[212:215], v[188:191]
ds_read_b128 v[184:187], v236 offset:13184
ds_read_b128 v[192:195], v236 offset:13440
v_mfma_f32_16x16x32_bf16 v[196:199], a[96:99], v[212:215], 0
ds_read_b128 v[204:207], v236 offset:12928
ds_read_b128 v[208:211], v236 offset:12672
v_mfma_f32_16x16x32_bf16 v[196:199], a[100:103], v[200:203], v[196:199]
s_add_u32 m0, s49, 6336
s_add_u32 s48, s48, s51
v_cvt_pk_bf16_f32 v18, v188, v189
v_mfma_f32_16x16x32_bf16 v[196:199], a[104:107], v[224:227], v[196:199]
buffer_load_dwordx4 v237, s[16:19], s48 offen nt lds
v_cvt_pk_bf16_f32 v19, v190, v191
v_mfma_f32_16x16x32_bf16 v[196:199], a[108:111], v[228:231], v[196:199]
s_nop 2
v_mfma_f32_16x16x32_bf16 v[188:191], a[124:127], v[228:231], 0
s_nop 2
v_mfma_f32_16x16x32_bf16 v[188:191], a[116:119], v[200:203], v[188:191]
s_waitcnt lgkmcnt(2)
v_cvt_pk_bf16_f32 v21, v198, v199
v_cvt_pk_bf16_f32 v20, v196, v197
v_mfma_f32_16x16x32_bf16 v[188:191], a[112:115], v[212:215], v[188:191]
s_waitcnt lgkmcnt(0)
v_mfma_f32_16x16x32_bf16 v[188:191], a[120:123], v[224:227], v[188:191]
s_nop 2
v_mfma_f32_16x16x32_bf16 v[196:199], a[120:123], v[184:187], 0
s_nop 2
v_mfma_f32_16x16x32_bf16 v[196:199], a[124:127], v[192:195], v[196:199]
v_cvt_pk_bf16_f32 v23, v190, v191
v_cvt_pk_bf16_f32 v22, v188, v189
v_mfma_f32_16x16x32_bf16 v[196:199], a[116:119], v[204:207], v[196:199]
v_mfma_f32_16x16x32_bf16 v[196:199], a[112:115], v[208:211], v[196:199]
s_nop 2
v_mfma_f32_16x16x32_bf16 v[188:191], a[96:99], v[208:211], 0
s_nop 2
v_mfma_f32_16x16x32_bf16 v[188:191], a[100:103], v[204:207], v[188:191]
v_cvt_pk_bf16_f32 v30, v196, v197
v_cvt_pk_bf16_f32 v31, v198, v199
v_mfma_f32_16x16x32_bf16 v[188:191], a[104:107], v[184:187], v[188:191]
v_mfma_f32_16x16x32_bf16 v[188:191], a[108:111], v[192:195], v[188:191]
ds_read_b128 v[196:199], v236 offset:17152
ds_read_b128 v[200:203], v236 offset:16896
v_mfma_f32_16x16x32_bf16 v[212:215], a[92:95], v[192:195], 0
ds_read_b128 v[216:219], v236 offset:17408
ds_read_b128 v[220:223], v236 offset:17664
v_mfma_f32_16x16x32_bf16 v[212:215], a[88:91], v[184:187], v[212:215]
s_nop 1
v_cvt_pk_bf16_f32 v29, v190, v191
v_mfma_f32_16x16x32_bf16 v[212:215], a[84:87], v[204:207], v[212:215]
v_cvt_pk_bf16_f32 v28, v188, v189
v_mfma_f32_16x16x32_bf16 v[212:215], a[80:83], v[208:211], v[212:215]
s_nop 2
v_mfma_f32_16x16x32_bf16 v[188:191], a[64:67], v[208:211], 0
s_nop 2
v_mfma_f32_16x16x32_bf16 v[188:191], a[72:75], v[184:187], v[188:191]
s_add_u32 m0, s49, 8448
v_cvt_pk_bf16_f32 v27, v214, v215
v_cvt_pk_bf16_f32 v26, v212, v213
v_mfma_f32_16x16x32_bf16 v[188:191], a[76:79], v[192:195], v[188:191]
s_add_u32 s48, s48, s51
buffer_load_dwordx4 v237, s[16:19], s48 offen nt lds
v_mfma_f32_16x16x32_bf16 v[188:191], a[68:71], v[204:207], v[188:191]
s_waitcnt lgkmcnt(0)
s_nop 1
v_mfma_f32_16x16x32_bf16 v[184:187], a[68:71], v[196:199], 0
s_nop 2
v_mfma_f32_16x16x32_bf16 v[184:187], a[64:67], v[200:203], v[184:187]
v_cvt_pk_bf16_f32 v24, v188, v189
v_cvt_pk_bf16_f32 v25, v190, v191
v_mfma_f32_16x16x32_bf16 v[184:187], a[72:75], v[216:219], v[184:187]
v_mfma_f32_16x16x32_bf16 v[184:187], a[76:79], v[220:223], v[184:187]
s_nop 2
v_mfma_f32_16x16x32_bf16 v[188:191], a[92:95], v[220:223], 0
s_nop 2
v_mfma_f32_16x16x32_bf16 v[188:191], a[88:91], v[216:219], v[188:191]
v_cvt_pk_bf16_f32 v32, v184, v185
v_cvt_pk_bf16_f32 v33, v186, v187
v_mfma_f32_16x16x32_bf16 v[188:191], a[84:87], v[196:199], v[188:191]
v_mfma_f32_16x16x32_bf16 v[188:191], a[80:83], v[200:203], v[188:191]
s_nop 2
v_mfma_f32_16x16x32_bf16 v[184:187], a[96:99], v[200:203], 0
s_nop 2
v_mfma_f32_16x16x32_bf16 v[184:187], a[100:103], v[196:199], v[184:187]
v_cvt_pk_bf16_f32 v35, v190, v191
v_cvt_pk_bf16_f32 v34, v188, v189
v_mfma_f32_16x16x32_bf16 v[184:187], a[104:107], v[216:219], v[184:187]
v_mfma_f32_16x16x32_bf16 v[184:187], a[108:111], v[220:223], v[184:187]
s_nop 2
v_mfma_f32_16x16x32_bf16 v[188:191], a[124:127], v[220:223], 0
s_nop 2
v_mfma_f32_16x16x32_bf16 v[188:191], a[120:123], v[216:219], v[188:191]
v_cvt_pk_bf16_f32 v37, v186, v187
v_cvt_pk_bf16_f32 v36, v184, v185
v_mfma_f32_16x16x32_bf16 v[188:191], a[116:119], v[196:199], v[188:191]
v_mfma_f32_16x16x32_bf16 v[188:191], a[112:115], v[200:203], v[188:191]
s_nop 2
v_mfma_f32_16x16x32_bf16 v[184:187], v[56:59], v[136:139], 0
s_nop 2
v_mfma_f32_16x16x32_bf16 v[184:187], v[104:107], v[148:151], v[184:187]
s_add_u32 m0, s49, 10560
ds_read_u16 v104, v241 offset:0
v_cvt_pk_bf16_f32 v39, v190, v191
v_mfma_f32_16x16x32_bf16 v[184:187], v[72:75], v[140:143], v[184:187]
s_add_u32 s48, s48, s51
buffer_load_dwordx4 v237, s[16:19], s48 offen nt lds
v_cvt_pk_bf16_f32 v38, v188, v189
v_mfma_f32_16x16x32_bf16 v[184:187], v[88:91], v[144:147], v[184:187]
s_nop 2
v_mfma_f32_16x16x32_bf16 v[188:191], v[92:95], v[144:147], 0
s_nop 2
v_mfma_f32_16x16x32_bf16 v[188:191], v[76:79], v[140:143], v[188:191]
v_fmac_f32 v170, v186, v252
v_fmac_f32 v168, v184, v252
v_mfma_f32_16x16x32_bf16 v[188:191], v[106:109], v[148:151], v[188:191]
ds_read_u16 v106, v241 offset:128
v_fmac_f32 v171, v187, v252
v_mfma_f32_16x16x32_bf16 v[188:191], v[60:63], v[136:139], v[188:191]
s_waitcnt lgkmcnt(1)
ds_read_b128 v[192:195], v236 offset:21888
v_fmac_f32 v169, v185, v252
v_mfma_f32_16x16x32_bf16 v[200:203], v[64:67], v[136:139], 0
ds_read_b128 v[196:199], v236 offset:21632
ds_read_b128 v[204:207], v236 offset:21376
v_mfma_f32_16x16x32_bf16 v[200:203], v[108:111], v[148:151], v[200:203]
ds_read_b128 v[208:211], v236 offset:21120
v_fmac_f32 v174, v190, v252
v_mfma_f32_16x16x32_bf16 v[200:203], v[80:83], v[140:143], v[200:203]
ds_read_u16 v108, v241 offset:256
v_fmac_f32 v175, v191, v252
v_mfma_f32_16x16x32_bf16 v[200:203], v[96:99], v[144:147], v[200:203]
v_fmac_f32 v172, v188, v252
v_fmac_f32 v173, v189, v252
v_mfma_f32_16x16x32_bf16 v[184:187], v[100:103], v[144:147], 0
s_waitcnt lgkmcnt(5)
v_cvt_pk_bf16_f32 v168, v168, v169
v_cvt_pk_bf16_f32 v169, v170, v171
v_mfma_f32_16x16x32_bf16 v[184:187], v[84:87], v[140:143], v[184:187]
s_waitcnt lgkmcnt(4)
v_fmac_f32 v178, v202, v252
v_fmac_f32 v176, v200, v252
v_mfma_f32_16x16x32_bf16 v[184:187], v[110:113], v[148:151], v[184:187]
s_waitcnt lgkmcnt(2)
ds_read_u16 v110, v241 offset:384
v_fmac_f32 v177, v201, v252
v_mfma_f32_16x16x32_bf16 v[184:187], v[68:71], v[136:139], v[184:187]
L_entrys:
s_waitcnt lgkmcnt(2)
v_fmac_f32 v179, v203, v252
v_cvt_pk_bf16_f32 v176, v176, v177
v_mfma_f32_16x16x32_bf16 v[188:191], a[124:127], v[192:195], 0
s_waitcnt lgkmcnt(1)
v_cvt_pk_bf16_f32 v177, v178, v179
v_cvt_pk_bf16_f32 v171, v174, v175
v_mfma_f32_16x16x32_bf16 v[188:191], a[120:123], v[196:199], v[188:191]
v_fmac_f32 v180, v184, v252
v_fmac_f32 v181, v185, v252
v_mfma_f32_16x16x32_bf16 v[188:191], a[116:119], v[204:207], v[188:191]
v_fmac_f32 v183, v187, v252
v_fmac_f32 v182, v186, v252
v_mfma_f32_16x16x32_bf16 v[188:191], a[112:115], v[208:211], v[188:191]
v_cvt_pk_bf16_f32 v178, v180, v181
v_cvt_pk_bf16_f32 v170, v172, v173
v_mfma_f32_16x16x32_bf16 v[184:187], a[96:99], v[208:211], 0
s_waitcnt lgkmcnt(0)
v_cvt_pk_bf16_f32 v179, v182, v183
v_pk_max_i16 v168, v168, 0
v_mfma_f32_16x16x32_bf16 v[184:187], a[100:103], v[204:207], v[184:187]
s_add_u32 s48, s48, s51
v_cvt_pk_bf16_f32 v46, v188, v189
v_cvt_pk_bf16_f32 v47, v190, v191
v_mfma_f32_16x16x32_bf16 v[184:187], a[104:107], v[196:199], v[184:187]
s_add_u32 m0, s49, 12672
v_pk_max_i16 v176, v176, 0
v_pk_max_i16 v170, v170, 0
v_mfma_f32_16x16x32_bf16 v[184:187], a[108:111], v[192:195], v[184:187]
buffer_load_dwordx4 v237, s[16:19], s48 offen nt lds
v_pk_max_i16 v179, v179, 0
v_mfma_f32_16x16x32_bf16 v[188:191], a[92:95], v[192:195], 0
v_pk_max_i16 v178, v178, 0
v_pk_max_i16 v169, v169, 0
v_mfma_f32_16x16x32_bf16 v[188:191], a[88:91], v[196:199], v[188:191]
v_pk_max_i16 v177, v177, 0
v_pk_max_i16 v171, v171, 0
v_mfma_f32_16x16x32_bf16 v[188:191], a[84:87], v[204:207], v[188:191]
buffer_store_dwordx4 v[168:171], v239, s[20:23], s53 offen offset:0 nt
buffer_store_dwordx4 v[176:179], v239, s[20:23], s53 offen offset:64 nt
v_cvt_pk_bf16_f32 v44, v184, v185
v_cvt_pk_bf16_f32 v45, v186, v187
v_add_u32 v241, 0x200, v241
s_add_u32 s53, s46, 0
v_mfma_f32_16x16x32_bf16 v[188:191], a[80:83], v[208:211], v[188:191]
s_nop 2
v_mfma_f32_16x16x32_bf16 v[184:187], a[64:67], v[208:211], 0
s_nop 2
v_mfma_f32_16x16x32_bf16 v[184:187], a[72:75], v[196:199], v[184:187]
v_cvt_pk_bf16_f32 v42, v188, v189
v_cvt_pk_bf16_f32 v43, v190, v191
v_mfma_f32_16x16x32_bf16 v[184:187], a[76:79], v[192:195], v[184:187]
v_mfma_f32_16x16x32_bf16 v[184:187], a[68:71], v[204:207], v[184:187]
s_nop 2
v_mfma_f32_16x16x32_bf16 v[188:191], a[4:7], v[204:207], 0
s_nop 2
v_mfma_f32_16x16x32_bf16 v[188:191], a[0:3], v[208:211], v[188:191]
v_cvt_pk_bf16_f32 v41, v186, v187
v_cvt_pk_bf16_f32 v40, v184, v185
v_mfma_f32_16x16x32_bf16 v[188:191], a[8:11], v[196:199], v[188:191]
v_mfma_f32_16x16x32_bf16 v[188:191], a[12:15], v[192:195], v[188:191]
s_nop 2
v_mfma_f32_16x16x32_bf16 v[184:187], a[28:31], v[192:195], 0
s_nop 2
v_mfma_f32_16x16x32_bf16 v[184:187], a[24:27], v[196:199], v[184:187]
v_cvt_pk_bf16_f32 v112, v188, v189
v_cvt_pk_bf16_f32 v113, v190, v191
v_mfma_f32_16x16x32_bf16 v[184:187], a[20:23], v[204:207], v[184:187]
v_mfma_f32_16x16x32_bf16 v[184:187], a[16:19], v[208:211], v[184:187]
s_nop 2
v_mfma_f32_16x16x32_bf16 v[188:191], a[32:35], v[208:211], 0
s_nop 2
v_mfma_f32_16x16x32_bf16 v[188:191], a[36:39], v[204:207], v[188:191]
s_add_u32 m0, s49, 14784
v_cvt_pk_bf16_f32 v114, v184, v185
v_cvt_pk_bf16_f32 v115, v186, v187
v_mfma_f32_16x16x32_bf16 v[188:191], a[40:43], v[196:199], v[188:191]
s_add_u32 s48, s48, s51
buffer_load_dwordx4 v237, s[16:19], s48 offen nt lds
v_mfma_f32_16x16x32_bf16 v[188:191], a[44:47], v[192:195], v[188:191]
s_nop 2
v_mfma_f32_16x16x32_bf16 v[184:187], a[60:63], v[192:195], 0
s_nop 2
v_mfma_f32_16x16x32_bf16 v[184:187], a[56:59], v[196:199], v[184:187]
v_cvt_pk_bf16_f32 v116, v188, v189
v_cvt_pk_bf16_f32 v117, v190, v191
v_mfma_f32_16x16x32_bf16 v[184:187], a[52:55], v[204:207], v[184:187]
v_mfma_f32_16x16x32_bf16 v[184:187], a[48:51], v[208:211], v[184:187]
s_nop 2
v_mfma_f32_16x16x32_bf16 v[152:155], a[192:195], v[208:211], 0
s_nop 2
v_mfma_f32_16x16x32_bf16 v[152:155], a[196:199], v[204:207], v[152:155]
v_cvt_pk_bf16_f32 v118, v184, v185
v_cvt_pk_bf16_f32 v119, v186, v187
v_mfma_f32_16x16x32_bf16 v[152:155], a[200:203], v[196:199], v[152:155]
v_mfma_f32_16x16x32_bf16 v[152:155], a[204:207], v[192:195], v[152:155]
v_mfma_f32_16x16x32_bf16 v[156:159], a[220:223], v[192:195], 0
v_mfma_f32_16x16x32_bf16 v[156:159], a[216:219], v[196:199], v[156:159]
v_mfma_f32_16x16x32_bf16 v[156:159], a[212:215], v[204:207], v[156:159]
v_mfma_f32_16x16x32_bf16 v[156:159], a[208:211], v[208:211], v[156:159]
v_mfma_f32_16x16x32_bf16 v[160:163], a[224:227], v[208:211], 0
v_mfma_f32_16x16x32_bf16 v[160:163], a[228:231], v[204:207], v[160:163]
v_mfma_f32_16x16x32_bf16 v[160:163], a[232:235], v[196:199], v[160:163]
v_mfma_f32_16x16x32_bf16 v[160:163], a[236:239], v[192:195], v[160:163]
v_mfma_f32_16x16x32_bf16 v[164:167], a[252:255], v[192:195], 0
v_mfma_f32_16x16x32_bf16 v[164:167], a[248:251], v[196:199], v[164:167]
s_add_u32 s48, s48, s51
s_add_u32 m0, s49, 16896
v_mfma_f32_16x16x32_bf16 v[164:167], a[244:247], v[204:207], v[164:167]
buffer_load_dwordx4 v237, s[16:19], s48 offen nt lds
v_mfma_f32_16x16x32_bf16 v[164:167], a[240:243], v[208:211], v[164:167]
v_mfma_f32_16x16x32_bf16 v[184:187], v[0:3], v[112:115], 0
v_mfma_f32_16x16x32_bf16 v[184:187], v[4:7], v[116:119], v[184:187]
s_nop 2
v_mfma_f32_16x16x32_bf16 v[188:191], v[12:15], v[116:119], 0
s_nop 2
v_mfma_f32_16x16x32_bf16 v[188:191], v[8:11], v[112:115], v[188:191]
v_max3_f32 v254, v184, v185, v186
s_nop 0
v_mfma_f32_16x16x32_bf16 v[200:203], v[16:19], v[112:115], 0
s_nop 2
v_mfma_f32_16x16x32_bf16 v[200:203], v[20:23], v[116:119], v[200:203]
s_nop 0
v_max3_f32 v254, v254, v187, v188
v_max3_f32 v254, v254, v189, v190
v_mfma_f32_16x16x32_bf16 v[212:215], v[28:31], v[116:119], 0
s_nop 2
v_mfma_f32_16x16x32_bf16 v[212:215], v[24:27], v[112:115], v[212:215]
v_max3_f32 v254, v254, v191, v200
v_max3_f32 v254, v254, v201, v202
v_mfma_f32_16x16x32_bf16 v[216:219], v[32:35], v[112:115], 0
s_nop 2
v_mfma_f32_16x16x32_bf16 v[216:219], v[36:39], v[116:119], v[216:219]
s_nop 0
v_max3_f32 v254, v254, v203, v212
v_max3_f32 v254, v254, v213, v214
v_mfma_f32_16x16x32_bf16 v[220:223], v[44:47], v[116:119], 0
s_nop 2
v_mfma_f32_16x16x32_bf16 v[220:223], v[40:43], v[112:115], v[220:223]
v_max3_f32 v254, v254, v215, v216
v_max3_f32 v254, v254, v217, v218
v_mfma_f32_16x16x32_bf16 v[224:227], v[48:51], v[112:115], 0
s_nop 2
v_mfma_f32_16x16x32_bf16 v[224:227], v[52:55], v[116:119], v[224:227]
s_nop 0
v_max3_f32 v254, v254, v219, v220
v_max3_f32 v254, v254, v221, v222
v_mfma_f32_16x16x32_bf16 v[228:231], v[208:211], a[128:131], 0
s_nop 2
v_mfma_f32_16x16x32_bf16 v[228:231], v[204:207], a[132:135], v[228:231]
v_max3_f32 v254, v254, v223, v224
v_mfma_f32_16x16x32_bf16 v[228:231], v[196:199], a[136:139], v[228:231]
ds_swizzle_b32 v255, v254 offset:0x401F
v_mfma_f32_16x16x32_bf16 v[228:231], v[192:195], a[140:143], v[228:231]
s_add_u32 m0, s49, 19008
s_add_u32 s48, s48, s51
buffer_load_dwordx4 v237, s[16:19], s48 offen nt lds
v_mfma_f32_16x16x32_bf16 v[232:235], v[192:195], a[156:159], 0
s_nop 2
v_mfma_f32_16x16x32_bf16 v[232:235], v[196:199], a[152:155], v[232:235]
v_cvt_pk_bf16_f32 v91, v230, v231
v_cvt_pk_bf16_f32 v90, v228, v229
v_mfma_f32_16x16x32_bf16 v[232:235], v[204:207], a[148:151], v[232:235]
v_mfma_f32_16x16x32_bf16 v[232:235], v[208:211], a[144:147], v[232:235]
s_nop 2
v_mfma_f32_16x16x32_bf16 v[228:231], v[208:211], a[160:163], 0
s_waitcnt lgkmcnt(0)
v_max_f32 v254, v254, v255
s_nop 0
v_mfma_f32_16x16x32_bf16 v[228:231], v[204:207], a[164:167], v[228:231]
ds_bpermute_b32 v255, v247, v254
v_mfma_f32_16x16x32_bf16 v[228:231], v[196:199], a[168:171], v[228:231]
v_cvt_pk_bf16_f32 v95, v234, v235
v_cvt_pk_bf16_f32 v94, v232, v233
v_mfma_f32_16x16x32_bf16 v[228:231], v[192:195], a[172:175], v[228:231]
s_nop 2
v_mfma_f32_16x16x32_bf16 v[232:235], v[192:195], a[188:191], 0
ds_read_b128 v[192:195], v236 offset:4224
s_nop 0
v_mfma_f32_16x16x32_bf16 v[232:235], v[204:207], a[180:183], v[232:235]
ds_read_b128 v[204:207], v236 offset:4480
v_cvt_pk_bf16_f32 v99, v230, v231
v_mfma_f32_16x16x32_bf16 v[232:235], v[208:211], a[176:179], v[232:235]
ds_read_b128 v[208:211], v236 offset:4736
v_cvt_pk_bf16_f32 v98, v228, v229
v_mfma_f32_16x16x32_bf16 v[232:235], v[196:199], a[184:187], v[232:235]
s_waitcnt lgkmcnt(3)
ds_read_b128 v[196:199], v236 offset:4992
v_max_f32 v254, v254, v255
v_sub_f32 v184, v184, v254
v_sub_f32 v185, v185, v254
v_exp_f32 v184, v184
v_exp_f32 v185, v185
v_sub_f32 v187, v187, v254
v_cvt_pk_bf16_f32 v103, v234, v235
v_cvt_pk_bf16_f32 v102, v232, v233
v_add_f32 v248, v184, v185
v_sub_f32 v186, v186, v254
v_exp_f32 v186, v186
v_cvt_pk_bf16_f32 v120, v184, v185
v_add_f32 v248, v248, v186
s_waitcnt lgkmcnt(1)
v_mfma_f32_16x16x32_bf16 v[228:231], v[208:211], a[184:187], 0
v_sub_f32 v188, v188, v254
s_waitcnt lgkmcnt(0)
v_mfma_f32_16x16x32_bf16 v[228:231], v[196:199], a[188:191], v[228:231]
v_exp_f32 v187, v187
v_mfma_f32_16x16x32_bf16 v[228:231], v[204:207], a[180:183], v[228:231]
v_cvt_pk_bf16_f32 v121, v186, v187
v_add_f32 v248, v248, v187
v_mfma_f32_16x16x32_bf16 v[228:231], v[192:195], a[176:179], v[228:231]
v_sub_f32 v189, v189, v254
v_sub_f32 v190, v190, v254
v_mfma_f32_16x16x32_bf16 v[232:235], v[192:195], a[160:163], 0
v_exp_f32 v189, v189
v_mfma_f32_16x16x32_bf16 v[232:235], v[204:207], a[164:167], v[232:235]
v_exp_f32 v190, v190
v_mfma_f32_16x16x32_bf16 v[232:235], v[208:211], a[168:171], v[232:235]
s_nop 0
v_cvt_pk_bf16_f32 v71, v230, v231
v_cvt_pk_bf16_f32 v70, v228, v229
v_mfma_f32_16x16x32_bf16 v[232:235], v[196:199], a[172:175], v[232:235]
s_add_u32 s48, s48, s51
v_exp_f32 v188, v188
v_mfma_f32_16x16x32_bf16 v[228:231], v[196:199], a[156:159], 0
s_add_u32 m0, s49, 21120
v_add_f32 v248, v248, v188
v_sub_f32 v191, v191, v254
v_mfma_f32_16x16x32_bf16 v[228:231], v[208:211], a[152:155], v[228:231]
buffer_load_dwordx4 v237, s[16:19], s48 offen nt lds
v_cvt_pk_bf16_f32 v66, v232, v233
v_mfma_f32_16x16x32_bf16 v[228:231], v[204:207], a[148:151], v[228:231]
v_cvt_pk_bf16_f32 v67, v234, v235
v_add_f32 v248, v248, v189
v_mfma_f32_16x16x32_bf16 v[228:231], v[192:195], a[144:147], v[228:231]
v_exp_f32 v191, v191
v_mfma_f32_16x16x32_bf16 v[232:235], v[192:195], a[128:131], 0
ds_read_b128 v[192:195], v236 offset:0
v_cvt_pk_bf16_f32 v122, v188, v189
v_mfma_f32_16x16x32_bf16 v[232:235], v[208:211], a[136:139], v[232:235]
ds_read_b128 v[208:211], v236 offset:256
v_add_f32 v248, v248, v190
v_mfma_f32_16x16x32_bf16 v[232:235], v[196:199], a[140:143], v[232:235]
ds_read_b128 v[196:199], v236 offset:512
v_cvt_pk_bf16_f32 v62, v228, v229
v_mfma_f32_16x16x32_bf16 v[232:235], v[204:207], a[132:135], v[232:235]
ds_read_b128 v[204:207], v236 offset:768
v_cvt_pk_bf16_f32 v63, v230, v231
v_add_f32 v248, v248, v191
v_cvt_pk_bf16_f32 v123, v190, v191
v_sub_f32 v200, v200, v254
v_exp_f32 v200, v200
v_sub_f32 v201, v201, v254
v_exp_f32 v201, v201
v_cvt_pk_bf16_f32 v59, v234, v235
v_cvt_pk_bf16_f32 v58, v232, v233
v_sub_f32 v203, v203, v254
s_waitcnt lgkmcnt(2)
v_mfma_f32_16x16x32_bf16 v[228:231], v[208:211], a[132:135], 0
ds_read_b128 v[188:191], v242 offset:64
v_sub_f32 v202, v202, v254
v_mfma_f32_16x16x32_bf16 v[228:231], v[192:195], a[128:131], v[228:231]
s_waitcnt lgkmcnt(2)
v_exp_f32 v203, v203
v_mfma_f32_16x16x32_bf16 v[228:231], v[196:199], a[136:139], v[228:231]
s_waitcnt lgkmcnt(1)
v_exp_f32 v202, v202
v_mfma_f32_16x16x32_bf16 v[228:231], v[204:207], a[140:143], v[228:231]
v_add_f32 v248, v248, v200
v_add_f32 v248, v248, v201
v_mfma_f32_16x16x32_bf16 v[184:187], v[204:207], a[156:159], 0
v_add_f32 v248, v248, v202
v_add_f32 v248, v248, v203
v_mfma_f32_16x16x32_bf16 v[184:187], v[196:199], a[152:155], v[184:187]
v_cvt_pk_bf16_f32 v124, v200, v201
v_cvt_pk_bf16_f32 v125, v202, v203
v_mfma_f32_16x16x32_bf16 v[184:187], v[208:211], a[148:151], v[184:187]
s_waitcnt lgkmcnt(0)
v_cvt_pk_bf16_f32 v56, v228, v229
v_cvt_pk_bf16_f32 v57, v230, v231
v_mfma_f32_16x16x32_bf16 v[184:187], v[192:195], a[144:147], v[184:187]
v_sub_f32 v212, v212, v254
v_sub_f32 v213, v213, v254
v_mfma_f32_16x16x32_bf16 v[228:231], v[192:195], a[160:163], 0
v_exp_f32 v212, v212
v_mfma_f32_16x16x32_bf16 v[228:231], v[208:211], a[164:167], v[228:231]
v_sub_f32 v214, v214, v254
v_add_f32 v248, v248, v212
v_mfma_f32_16x16x32_bf16 v[228:231], v[196:199], a[168:171], v[228:231]
v_cvt_pk_bf16_f32 v60, v184, v185
v_cvt_pk_bf16_f32 v61, v186, v187
v_mfma_f32_16x16x32_bf16 v[228:231], v[204:207], a[172:175], v[228:231]
s_add_u32 m0, s49, 23232
ds_read_b128 v[184:187], v242 offset:0
v_sub_f32 v215, v215, v254
v_mfma_f32_16x16x32_bf16 v[232:235], v[204:207], a[188:191], 0
s_add_u32 s48, s48, s51
buffer_load_dwordx4 v237, s[16:19], s48 offen nt lds
v_sub_f32 v216, v216, v254
v_mfma_f32_16x16x32_bf16 v[232:235], v[196:199], a[184:187], v[232:235]
s_sub_u32 s49, s49, s56
v_exp_f32 v213, v213
v_mfma_f32_16x16x32_bf16 v[232:235], v[208:211], a[180:183], v[232:235]
s_and_b32 s51, s57, 26212352
v_exp_f32 v214, v214
v_mfma_f32_16x16x32_bf16 v[232:235], v[192:195], a[176:179], v[232:235]
s_add_u32 s51, s51, 2048
v_cvt_pk_bf16_f32 v126, v212, v213
v_add_f32 v248, v248, v213
v_mfma_f32_16x16x32_bf16 v[200:203], v[4:7], v[188:191], 0
v_add_f32 v248, v248, v214
s_waitcnt lgkmcnt(0)
v_mfma_f32_16x16x32_bf16 v[200:203], v[0:3], v[184:187], v[200:203]
s_nop 0
v_cvt_pk_bf16_f32 v69, v234, v235
v_cvt_pk_bf16_f32 v68, v232, v233
v_mfma_f32_16x16x32_bf16 v[232:235], v[32:35], v[184:187], 0
ds_read_b128 v[184:187], v245 offset:64
v_sub_f32 v218, v218, v254
v_mfma_f32_16x16x32_bf16 v[232:235], v[36:39], v[188:191], v[232:235]
ds_read_b128 v[188:191], v243 offset:0
v_exp_f32 v215, v215
s_nop 0
v_add_f32 v248, v248, v215
v_cvt_pk_bf16_f32 v127, v214, v215
ds_read_b128 v[212:215], v243 offset:64
v_exp_f32 v216, v216
v_sub_f32 v217, v217, v254
v_add_f32 v248, v248, v216
v_exp_f32 v218, v218
v_sub_f32 v219, v219, v254
v_exp_f32 v217, v217
v_exp_f32 v219, v219
v_cvt_pk_bf16_f32 v128, v216, v217
v_cvt_pk_bf16_f32 v129, v218, v219
v_add_f32 v248, v248, v217
v_add_f32 v248, v248, v218
v_add_f32 v248, v248, v219
v_cvt_pk_bf16_f32 v64, v228, v229
v_cvt_pk_bf16_f32 v65, v230, v231
v_sub_f32 v220, v220, v254
v_sub_f32 v221, v221, v254
s_waitcnt lgkmcnt(0)
v_mfma_f32_16x16x32_bf16 v[200:203], v[12:15], v[212:215], v[200:203]
ds_read_b128 v[216:219], v244 offset:0
ds_read_b128 v[228:231], v245 offset:0
v_mfma_f32_16x16x32_bf16 v[200:203], v[8:11], v[188:191], v[200:203]
v_exp_f32 v220, v220
v_mfma_f32_16x16x32_bf16 v[232:235], v[40:43], v[188:191], v[232:235]
ds_read_b128 v[188:191], v244 offset:64
v_add_f32 v248, v248, v220
v_mfma_f32_16x16x32_bf16 v[232:235], v[44:47], v[212:215], v[232:235]
v_exp_f32 v221, v221
v_sub_f32 v223, v223, v254
v_add_f32 v248, v248, v221
v_exp_f32 v223, v223
v_sub_f32 v222, v222, v254
v_exp_f32 v222, v222
v_cvt_pk_bf16_f32 v130, v220, v221
v_mov_b32 v221, 0xff800000
v_add_f32 v248, v248, v222
v_cvt_pk_bf16_f32 v131, v222, v223
v_add_f32 v248, v248, v223
v_sub_f32 v224, v224, v254
v_exp_f32 v224, v224
s_waitcnt lgkmcnt(0)
v_mfma_f32_16x16x32_bf16 v[200:203], v[20:23], v[188:191], v[200:203]
v_cvt_pk_bf16_f32 v132, v224, 0
v_add_f32 v248, v248, v224
v_mfma_f32_16x16x32_bf16 v[200:203], v[16:19], v[216:219], v[200:203]
ds_swizzle_b32 v250, v248 offset:0x401F
v_add_u32 v245, 0x200, v245
v_mfma_f32_16x16x32_bf16 v[232:235], v[48:51], v[216:219], v[232:235]
v_add_u32 v244, 0x200, v244
v_add_u32 v243, 0x200, v243
v_mfma_f32_16x16x32_bf16 v[232:235], v[52:55], v[188:191], v[232:235]
v_add_u32 v242, 0x200, v242
s_nop 0
v_mfma_f32_16x16x32_bf16 v[200:203], v[24:27], v[228:231], v[200:203]
s_nop 2
v_mfma_f32_16x16x32_bf16 v[200:203], v[28:31], v[184:187], v[200:203]
s_nop 0
v_mov_b32_dpp v233, v221 quad_perm:[0,1,2,3] row_mask:0xf bank_mask:0xc
v_mov_b32_dpp v232, v221 quad_perm:[0,1,2,3] row_mask:0xf bank_mask:0x8
v_mfma_f32_16x16x32_bf16 v[184:187], a[0:3], v[192:195], 0
v_mov_b32_dpp v234, v221 quad_perm:[0,1,2,3] row_mask:0xf bank_mask:0xc
v_mov_b32_dpp v235, v221 quad_perm:[0,1,2,3] row_mask:0xf bank_mask:0xc
v_mfma_f32_16x16x32_bf16 v[184:187], a[4:7], v[208:211], v[184:187]
s_waitcnt lgkmcnt(0)
v_max3_f32 v223, v200, v201, v202
v_max3_f32 v223, v223, v203, v232
v_mfma_f32_16x16x32_bf16 v[184:187], a[8:11], v[196:199], v[184:187]
v_max3_f32 v223, v223, v233, v234
v_max_f32 v223, v223, v235
v_mfma_f32_16x16x32_bf16 v[184:187], a[12:15], v[204:207], v[184:187]
s_nop 0
v_max_f32_dpp v223, v223, v223 row_ror:8 row_mask:0xf bank_mask:0xf
v_add_f32 v248, v248, v250
v_mfma_f32_16x16x32_bf16 v[188:191], a[28:31], v[204:207], 0
ds_bpermute_b32 v250, v247, v248
v_mfma_f32_16x16x32_bf16 v[188:191], a[24:27], v[196:199], v[188:191]
v_max_f32_dpp v223, v223, v223 row_ror:4 row_mask:0xf bank_mask:0xf
v_mfma_f32_16x16x32_bf16 v[188:191], a[20:23], v[208:211], v[188:191]
ds_swizzle_b32 v221, v223 offset:0x401F
v_cvt_pk_bf16_f32 v113, v186, v187
v_mfma_f32_16x16x32_bf16 v[188:191], a[16:19], v[192:195], v[188:191]
v_cvt_pk_bf16_f32 v112, v184, v185
s_nop 0
v_mfma_f32_16x16x32_bf16 v[184:187], a[32:35], v[192:195], 0
s_nop 2
v_mfma_f32_16x16x32_bf16 v[184:187], a[36:39], v[208:211], v[184:187]
s_nop 0
v_cvt_pk_bf16_f32 v115, v190, v191
v_cvt_pk_bf16_f32 v114, v188, v189
v_mfma_f32_16x16x32_bf16 v[184:187], a[40:43], v[196:199], v[184:187]
s_waitcnt lgkmcnt(1)
v_add_f32 v248, v248, v250
v_mfma_f32_16x16x32_bf16 v[184:187], a[44:47], v[204:207], v[184:187]
v_rcp_f32 v251, v248
v_mfma_f32_16x16x32_bf16 v[188:191], a[60:63], v[204:207], 0
s_waitcnt lgkmcnt(0)
v_max_f32 v223, v223, v221
s_nop 0
v_mfma_f32_16x16x32_bf16 v[188:191], a[56:59], v[196:199], v[188:191]
ds_bpermute_b32 v221, v247, v223
v_mfma_f32_16x16x32_bf16 v[188:191], a[52:55], v[208:211], v[188:191]
v_cvt_pk_bf16_f32 v117, v186, v187
v_cvt_pk_bf16_f32 v116, v184, v185
v_mfma_f32_16x16x32_bf16 v[188:191], a[48:51], v[192:195], v[188:191]
s_nop 2
v_mfma_f32_16x16x32_bf16 v[168:171], a[192:195], v[192:195], 0
s_nop 2
v_mfma_f32_16x16x32_bf16 v[168:171], a[196:199], v[208:211], v[168:171]
v_cvt_pk_bf16_f32 v119, v190, v191
v_cvt_pk_bf16_f32 v118, v188, v189
v_mfma_f32_16x16x32_bf16 v[168:171], a[200:203], v[196:199], v[168:171]
v_mfma_f32_16x16x32_bf16 v[168:171], a[204:207], v[204:207], v[168:171]
s_waitcnt lgkmcnt(0)
v_max_f32 v223, v223, v221
v_sub_f32 v200, v200, v223
v_mfma_f32_16x16x32_bf16 v[172:175], a[220:223], v[204:207], 0
v_exp_f32 v200, v200
v_mfma_f32_16x16x32_bf16 v[172:175], a[216:219], v[196:199], v[172:175]
v_sub_f32 v201, v201, v223
v_sub_f32 v202, v202, v223
v_mfma_f32_16x16x32_bf16 v[172:175], a[212:215], v[208:211], v[172:175]
v_exp_f32 v202, v202
v_mfma_f32_16x16x32_bf16 v[172:175], a[208:211], v[192:195], v[172:175]
v_exp_f32 v201, v201
v_mfma_f32_16x16x32_bf16 v[176:179], a[224:227], v[192:195], 0
v_add_f32 v220, v200, v201
v_add_f32 v220, v220, v202
v_mfma_f32_16x16x32_bf16 v[176:179], a[228:231], v[208:211], v[176:179]
v_sub_f32 v203, v203, v223
v_sub_f32 v233, v233, v223
v_mfma_f32_16x16x32_bf16 v[176:179], a[232:235], v[196:199], v[176:179]
v_exp_f32 v233, v233
v_mfma_f32_16x16x32_bf16 v[176:179], a[236:239], v[204:207], v[176:179]
v_exp_f32 v203, v203
v_mfma_f32_16x16x32_bf16 v[180:183], a[252:255], v[204:207], 0
v_sub_f32 v232, v232, v223
v_sub_f32 v234, v234, v223
v_mfma_f32_16x16x32_bf16 v[180:183], a[248:251], v[196:199], v[180:183]
v_exp_f32 v232, v232
v_mfma_f32_16x16x32_bf16 v[180:183], a[244:247], v[208:211], v[180:183]
v_exp_f32 v234, v234
v_mfma_f32_16x16x32_bf16 v[180:183], a[240:243], v[192:195], v[180:183]
v_add_f32 v220, v220, v203
v_add_f32 v220, v220, v232
v_mfma_f32_16x16x32_bf16 v[184:187], v[0:3], v[112:115], 0
v_add_f32 v220, v220, v233
v_add_f32 v220, v220, v234
v_mfma_f32_16x16x32_bf16 v[184:187], v[4:7], v[116:119], v[184:187]
v_sub_f32 v235, v235, v223
v_cvt_pk_bf16_f32 v200, v200, v201
v_mfma_f32_16x16x32_bf16 v[188:191], v[12:15], v[116:119], 0
v_exp_f32 v235, v235
v_mfma_f32_16x16x32_bf16 v[188:191], v[8:11], v[112:115], v[188:191]
v_add_f32 v220, v220, v235
v_cvt_pk_bf16_f32 v201, v202, v203
v_mfma_f32_16x16x32_bf16 v[192:195], v[16:19], v[112:115], 0
v_cvt_pk_bf16_f32 v202, v232, v233
v_cvt_pk_bf16_f32 v203, v234, v235
v_mfma_f32_16x16x32_bf16 v[192:195], v[20:23], v[116:119], v[192:195]
ds_read_b128 v[196:199], v236 offset:8448
v_add_f32_dpp v220, v220, v220 row_ror:8 row_mask:0xf bank_mask:0xf
v_mfma_f32_16x16x32_bf16 v[208:211], v[28:31], v[116:119], 0
ds_read_b128 v[204:207], v236 offset:8704
v_add_f32_dpp v220, v220, v220 row_ror:4 row_mask:0xf bank_mask:0xf
v_mfma_f32_16x16x32_bf16 v[208:211], v[24:27], v[112:115], v[208:211]
ds_write_b32 v246, v220 offset:4096
ds_read_b128 v[212:215], v236 offset:8960
v_mfma_f32_16x16x32_bf16 v[216:219], v[32:35], v[112:115], 0
ds_read_b128 v[224:227], v236 offset:9216
v_max3_f32 v254, v184, v185, v186
v_mfma_f32_16x16x32_bf16 v[216:219], v[36:39], v[116:119], v[216:219]
v_max3_f32 v254, v254, v187, v188
v_max3_f32 v254, v254, v189, v190
v_mfma_f32_16x16x32_bf16 v[228:231], v[44:47], v[116:119], 0
v_max3_f32 v254, v254, v191, v192
v_max3_f32 v254, v254, v193, v194
v_mfma_f32_16x16x32_bf16 v[228:231], v[40:43], v[112:115], v[228:231]
s_waitcnt lgkmcnt(4)
v_max3_f32 v254, v254, v195, v208
v_max3_f32 v254, v254, v209, v210
v_mfma_f32_16x16x32_bf16 v[232:235], v[48:51], v[112:115], 0
s_waitcnt lgkmcnt(3)
v_max3_f32 v254, v254, v211, v216
v_max3_f32 v254, v254, v217, v218
v_mfma_f32_16x16x32_bf16 v[232:235], v[52:55], v[116:119], v[232:235]
s_waitcnt lgkmcnt(1)
v_max3_f32 v254, v254, v219, v228
v_max3_f32 v254, v254, v229, v230
v_mfma_f32_16x16x32_bf16 v[220:223], v[196:199], a[128:131], 0
s_waitcnt lgkmcnt(0)
s_nop 1
v_mfma_f32_16x16x32_bf16 v[220:223], v[204:207], a[132:135], v[220:223]
v_max3_f32 v254, v254, v231, v232
v_mfma_f32_16x16x32_bf16 v[220:223], v[212:215], a[136:139], v[220:223]
ds_swizzle_b32 v255, v254 offset:0x401F
v_mfma_f32_16x16x32_bf16 v[220:223], v[224:227], a[140:143], v[220:223]
s_nop 7
v_cvt_pk_bf16_f32 v73, v222, v223
v_cvt_pk_bf16_f32 v72, v220, v221
v_mfma_f32_16x16x32_bf16 v[220:223], v[224:227], a[156:159], 0
v_mfma_f32_16x16x32_bf16 v[220:223], v[212:215], a[152:155], v[220:223]
v_mfma_f32_16x16x32_bf16 v[220:223], v[204:207], a[148:151], v[220:223]
s_waitcnt lgkmcnt(0)
v_max_f32 v254, v254, v255
v_mfma_f32_16x16x32_bf16 v[220:223], v[196:199], a[144:147], v[220:223]
ds_bpermute_b32 v255, v247, v254
s_nop 6
v_cvt_pk_bf16_f32 v76, v220, v221
v_cvt_pk_bf16_f32 v77, v222, v223
v_mfma_f32_16x16x32_bf16 v[220:223], v[196:199], a[160:163], 0
v_mfma_f32_16x16x32_bf16 v[220:223], v[204:207], a[164:167], v[220:223]
v_mfma_f32_16x16x32_bf16 v[220:223], v[212:215], a[168:171], v[220:223]
s_waitcnt lgkmcnt(0)
v_max_f32 v254, v254, v255
v_mfma_f32_16x16x32_bf16 v[220:223], v[224:227], a[172:175], v[220:223]
v_sub_f32 v184, v184, v254
v_exp_f32 v184, v184
v_sub_f32 v185, v185, v254
v_sub_f32 v187, v187, v254
v_exp_f32 v185, v185
s_nop 2
v_cvt_pk_bf16_f32 v81, v222, v223
v_cvt_pk_bf16_f32 v80, v220, v221
v_mfma_f32_16x16x32_bf16 v[220:223], v[224:227], a[188:191], 0
ds_read_b128 v[224:227], v236 offset:12672
v_add_f32 v249, v184, v185
v_mfma_f32_16x16x32_bf16 v[220:223], v[204:207], a[180:183], v[220:223]
ds_read_b128 v[204:207], v236 offset:12928
v_sub_f32 v186, v186, v254
v_mfma_f32_16x16x32_bf16 v[220:223], v[196:199], a[176:179], v[220:223]
ds_read_b128 v[196:199], v236 offset:13184
v_cvt_pk_bf16_f32 v136, v184, v185
v_mfma_f32_16x16x32_bf16 v[220:223], v[212:215], a[184:187], v[220:223]
ds_read_b128 v[212:215], v236 offset:13440
v_exp_f32 v186, v186
v_exp_f32 v187, v187
v_add_f32 v249, v249, v186
v_add_f32 v249, v249, v187
v_cvt_pk_bf16_f32 v137, v186, v187
v_sub_f32 v189, v189, v254
v_sub_f32 v188, v188, v254
v_cvt_pk_bf16_f32 v84, v220, v221
v_cvt_pk_bf16_f32 v85, v222, v223
v_exp_f32 v188, v188
v_exp_f32 v189, v189
v_sub_f32 v191, v191, v254
s_waitcnt lgkmcnt(1)
v_mfma_f32_16x16x32_bf16 v[184:187], v[196:199], a[184:187], 0
v_sub_f32 v190, v190, v254
s_waitcnt lgkmcnt(0)
v_mfma_f32_16x16x32_bf16 v[184:187], v[212:215], a[188:191], v[184:187]
v_exp_f32 v190, v190
v_mfma_f32_16x16x32_bf16 v[184:187], v[204:207], a[180:183], v[184:187]
v_exp_f32 v191, v191
v_mfma_f32_16x16x32_bf16 v[184:187], v[224:227], a[176:179], v[184:187]
v_add_f32 v249, v249, v188
v_add_f32 v249, v249, v189
v_mfma_f32_16x16x32_bf16 v[220:223], v[224:227], a[160:163], 0
v_add_f32 v249, v249, v190
v_cvt_pk_bf16_f32 v139, v190, v191
v_mfma_f32_16x16x32_bf16 v[220:223], v[204:207], a[164:167], v[220:223]
v_cvt_pk_bf16_f32 v138, v188, v189
v_add_f32 v249, v249, v191
v_mfma_f32_16x16x32_bf16 v[220:223], v[196:199], a[168:171], v[220:223]
v_cvt_pk_bf16_f32 v86, v184, v185
v_cvt_pk_bf16_f32 v87, v186, v187
v_mfma_f32_16x16x32_bf16 v[220:223], v[212:215], a[172:175], v[220:223]
v_sub_f32 v192, v192, v254
v_sub_f32 v194, v194, v254
v_mfma_f32_16x16x32_bf16 v[184:187], v[212:215], a[156:159], 0
v_exp_f32 v192, v192
v_mfma_f32_16x16x32_bf16 v[184:187], v[196:199], a[152:155], v[184:187]
v_add_f32 v249, v249, v192
v_sub_f32 v193, v193, v254
v_mfma_f32_16x16x32_bf16 v[184:187], v[204:207], a[148:151], v[184:187]
v_cvt_pk_bf16_f32 v83, v222, v223
v_cvt_pk_bf16_f32 v82, v220, v221
v_mfma_f32_16x16x32_bf16 v[184:187], v[224:227], a[144:147], v[184:187]
v_exp_f32 v193, v193
v_mfma_f32_16x16x32_bf16 v[220:223], v[224:227], a[128:131], 0
ds_read_b128 v[224:227], v236 offset:16896
v_sub_f32 v209, v209, v254
v_mfma_f32_16x16x32_bf16 v[220:223], v[196:199], a[136:139], v[220:223]
ds_read_b128 v[196:199], v236 offset:17152
v_sub_f32 v208, v208, v254
v_mfma_f32_16x16x32_bf16 v[220:223], v[212:215], a[140:143], v[220:223]
ds_read_b128 v[212:215], v236 offset:17408
v_cvt_pk_bf16_f32 v79, v186, v187
v_mfma_f32_16x16x32_bf16 v[220:223], v[204:207], a[132:135], v[220:223]
ds_read_b128 v[204:207], v236 offset:17664
v_cvt_pk_bf16_f32 v78, v184, v185
v_exp_f32 v208, v208
v_exp_f32 v209, v209
v_exp_f32 v194, v194
v_add_f32 v249, v249, v193
v_add_f32 v249, v249, v194
v_sub_f32 v195, v195, v254
v_cvt_pk_bf16_f32 v74, v220, v221
v_cvt_pk_bf16_f32 v75, v222, v223
s_waitcnt lgkmcnt(2)
v_mfma_f32_16x16x32_bf16 v[184:187], v[196:199], a[132:135], 0
v_exp_f32 v195, v195
v_mfma_f32_16x16x32_bf16 v[184:187], v[224:227], a[128:131], v[184:187]
s_waitcnt lgkmcnt(1)
v_sub_f32 v216, v216, v254
v_sub_f32 v211, v211, v254
v_mfma_f32_16x16x32_bf16 v[184:187], v[212:215], a[136:139], v[184:187]
s_waitcnt lgkmcnt(0)
v_sub_f32 v210, v210, v254
v_add_f32 v249, v249, v195
v_mfma_f32_16x16x32_bf16 v[184:187], v[204:207], a[140:143], v[184:187]
v_exp_f32 v211, v211
v_mfma_f32_16x16x32_bf16 v[220:223], v[204:207], a[156:159], 0
v_exp_f32 v210, v210
v_mfma_f32_16x16x32_bf16 v[220:223], v[212:215], a[152:155], v[220:223]
v_add_f32 v249, v249, v208
v_sub_f32 v219, v219, v254
v_mfma_f32_16x16x32_bf16 v[220:223], v[196:199], a[148:151], v[220:223]
s_nop 0
v_cvt_pk_bf16_f32 v89, v186, v187
v_cvt_pk_bf16_f32 v88, v184, v185
v_mfma_f32_16x16x32_bf16 v[220:223], v[224:227], a[144:147], v[220:223]
v_exp_f32 v216, v216
v_mfma_f32_16x16x32_bf16 v[184:187], v[224:227], a[160:163], 0
v_sub_f32 v217, v217, v254
v_add_f32 v249, v249, v209
v_mfma_f32_16x16x32_bf16 v[184:187], v[196:199], a[164:167], v[184:187]
v_sub_f32 v228, v228, v254
v_add_f32 v249, v249, v210
v_mfma_f32_16x16x32_bf16 v[184:187], v[212:215], a[168:171], v[184:187]
v_exp_f32 v217, v217
v_mfma_f32_16x16x32_bf16 v[184:187], v[204:207], a[172:175], v[184:187]
v_sub_f32 v229, v229, v254
v_sub_f32 v218, v218, v254
v_mfma_f32_16x16x32_bf16 v[188:191], v[204:207], a[188:191], 0
v_exp_f32 v218, v218
v_mfma_f32_16x16x32_bf16 v[188:191], v[212:215], a[184:187], v[188:191]
v_add_f32 v249, v249, v211
v_add_f32 v249, v249, v216
v_mfma_f32_16x16x32_bf16 v[188:191], v[196:199], a[180:183], v[188:191]
v_cvt_pk_bf16_f32 v96, v184, v185
v_cvt_pk_bf16_f32 v97, v186, v187
v_mfma_f32_16x16x32_bf16 v[188:191], v[224:227], a[176:179], v[188:191]
v_exp_f32 v219, v219
v_mfma_f32_16x16x32_bf16 v[184:187], a[0:3], v[224:227], 0
v_add_f32 v249, v249, v217
v_add_f32 v249, v249, v218
v_mfma_f32_16x16x32_bf16 v[184:187], a[4:7], v[196:199], v[184:187]
v_add_f32 v249, v249, v219
v_cvt_pk_bf16_f32 v144, v216, v217
v_mfma_f32_16x16x32_bf16 v[184:187], a[8:11], v[212:215], v[184:187]
v_cvt_pk_bf16_f32 v100, v188, v189
v_cvt_pk_bf16_f32 v101, v190, v191
v_mfma_f32_16x16x32_bf16 v[184:187], a[12:15], v[204:207], v[184:187]
v_cvt_pk_bf16_f32 v145, v218, v219
v_cvt_pk_bf16_f32 v92, v220, v221
v_mfma_f32_16x16x32_bf16 v[188:191], a[28:31], v[204:207], 0
v_cvt_pk_bf16_f32 v93, v222, v223
v_sub_f32 v232, v232, v254
v_mfma_f32_16x16x32_bf16 v[188:191], a[24:27], v[212:215], v[188:191]
v_exp_f32 v228, v228
v_mfma_f32_16x16x32_bf16 v[188:191], a[20:23], v[196:199], v[188:191]
v_cvt_pk_bf16_f32 v112, v184, v185
v_cvt_pk_bf16_f32 v113, v186, v187
v_mfma_f32_16x16x32_bf16 v[188:191], a[16:19], v[224:227], v[188:191]
v_exp_f32 v229, v229
v_mfma_f32_16x16x32_bf16 v[184:187], a[32:35], v[224:227], 0
v_add_f32 v249, v249, v228
v_sub_f32 v231, v231, v254
v_mfma_f32_16x16x32_bf16 v[184:187], a[36:39], v[196:199], v[184:187]
v_exp_f32 v232, v232
v_mfma_f32_16x16x32_bf16 v[184:187], a[40:43], v[212:215], v[184:187]
s_nop 0
v_cvt_pk_bf16_f32 v115, v190, v191
v_cvt_pk_bf16_f32 v114, v188, v189
v_mfma_f32_16x16x32_bf16 v[184:187], a[44:47], v[204:207], v[184:187]
v_sub_f32 v230, v230, v254
v_add_f32 v249, v249, v229
v_mfma_f32_16x16x32_bf16 v[188:191], a[60:63], v[204:207], 0
v_cvt_pk_bf16_f32 v140, v192, v193
v_mov_b32 v192, v202
v_mfma_f32_16x16x32_bf16 v[188:191], a[56:59], v[212:215], v[188:191]
v_cvt_pk_bf16_f32 v142, v208, v209
v_mov_b32_dpp v209, v201 row_ror:8 row_mask:0xf bank_mask:0xf
v_mfma_f32_16x16x32_bf16 v[188:191], a[52:55], v[196:199], v[188:191]
v_cvt_pk_bf16_f32 v116, v184, v185
v_cvt_pk_bf16_f32 v117, v186, v187
v_mfma_f32_16x16x32_bf16 v[188:191], a[48:51], v[224:227], v[188:191]
v_mov_b32_dpp v208, v200 row_ror:8 row_mask:0xf bank_mask:0xf
v_cvt_pk_bf16_f32 v143, v210, v211
v_mfma_f32_16x16x32_bf16 v[216:219], v[56:59], v[120:123], 0
v_mov_b32_dpp v211, v201 row_ror:4 row_mask:0xf bank_mask:0xf
v_mov_b32_dpp v210, v200 row_ror:4 row_mask:0xf bank_mask:0xf
v_mfma_f32_16x16x32_bf16 v[216:219], v[104:107], v[132:135], v[216:219]
v_cvt_pk_bf16_f32 v141, v194, v195
v_mov_b32_dpp v194, v202 row_ror:12 row_mask:0xf bank_mask:0xf
v_mfma_f32_16x16x32_bf16 v[216:219], v[72:75], v[124:127], v[216:219]
v_cvt_pk_bf16_f32 v118, v188, v189
v_cvt_pk_bf16_f32 v119, v190, v191
v_mfma_f32_16x16x32_bf16 v[216:219], v[88:91], v[128:131], v[216:219]
v_mov_b32_dpp v195, v203 row_ror:12 row_mask:0xf bank_mask:0xf
v_mov_b32 v193, v203
v_mfma_f32_16x16x32_bf16 v[220:223], v[92:95], v[128:131], 0
v_mov_b32_dpp v203, v201 row_ror:12 row_mask:0xf bank_mask:0xf
v_mov_b32_dpp v202, v200 row_ror:12 row_mask:0xf bank_mask:0xf
v_mfma_f32_16x16x32_bf16 v[220:223], v[76:79], v[124:127], v[220:223]
v_exp_f32 v230, v230
v_mfma_f32_16x16x32_bf16 v[220:223], v[106:109], v[132:135], v[220:223]
v_fmac_f32 v154, v218, v251
v_fmac_f32 v152, v216, v251
v_mfma_f32_16x16x32_bf16 v[220:223], v[60:63], v[120:123], v[220:223]
v_fmac_f32 v155, v219, v251
v_fmac_f32 v153, v217, v251
v_mfma_f32_16x16x32_bf16 v[188:191], v[64:67], v[120:123], 0
v_exp_f32 v231, v231
v_mfma_f32_16x16x32_bf16 v[188:191], v[108:111], v[132:135], v[188:191]
v_add_f32 v249, v249, v230
v_add_f32 v249, v249, v231
v_mfma_f32_16x16x32_bf16 v[188:191], v[80:83], v[124:127], v[188:191]
v_cvt_pk_bf16_f32 v146, v228, v229
v_cvt_pk_bf16_f32 v147, v230, v231
v_mfma_f32_16x16x32_bf16 v[188:191], v[96:99], v[128:131], v[188:191]
v_add_f32 v249, v249, v232
v_fmac_f32 v156, v220, v251
v_mfma_f32_16x16x32_bf16 v[184:187], v[100:103], v[128:131], 0
ds_swizzle_b32 v250, v249 offset:0x401F
v_fmac_f32 v158, v222, v251
v_mfma_f32_16x16x32_bf16 v[184:187], v[84:87], v[124:127], v[184:187]
v_fmac_f32 v157, v221, v251
v_fmac_f32 v159, v223, v251
v_mfma_f32_16x16x32_bf16 v[184:187], v[68:71], v[120:123], v[184:187]
v_fmac_f32 v161, v189, v251
v_fmac_f32 v160, v188, v251
v_mfma_f32_16x16x32_bf16 v[184:187], v[110:113], v[132:135], v[184:187]
v_mov_b32_dpp v132, v192 row_ror:8 row_mask:0xf bank_mask:0xf
v_fmac_f32 v163, v191, v251
v_fmac_f32 v162, v190, v251
v_mfma_f32_16x16x32_bf16 v[216:219], v[110:113], v[132:135], 0
v_cvt_pk_bf16_f32 v152, v152, v153
v_cvt_pk_bf16_f32 v153, v154, v155
v_mfma_f32_16x16x32_bf16 v[216:219], v[84:87], v[208:211], v[216:219]
s_nop 0
v_fmac_f32 v167, v187, v251
v_fmac_f32 v164, v184, v251
v_mfma_f32_16x16x32_bf16 v[216:219], v[100:103], v[192:195], v[216:219]
s_waitcnt lgkmcnt(0)
v_fmac_f32 v165, v185, v251
v_fmac_f32 v166, v186, v251
v_mfma_f32_16x16x32_bf16 v[216:219], v[68:71], v[200:203], v[216:219]
v_add_f32 v249, v249, v250
v_pk_max_i16 v153, v153, 0
v_mfma_f32_16x16x32_bf16 v[188:191], v[64:67], v[200:203], 0
ds_bpermute_b32 v250, v247, v249
v_mfma_f32_16x16x32_bf16 v[188:191], v[80:83], v[208:211], v[188:191]
v_cvt_pk_bf16_f32 v160, v160, v161
v_cvt_pk_bf16_f32 v161, v162, v163
v_mfma_f32_16x16x32_bf16 v[188:191], v[96:99], v[192:195], v[188:191]
v_cvt_pk_bf16_f32 v216, v216, v217
v_cvt_pk_bf16_f32 v217, v218, v219
v_mfma_f32_16x16x32_bf16 v[188:191], v[108:111], v[132:135], v[188:191]
ds_write_b64 v246, v[216:217] offset:24
v_mfma_f32_16x16x32_bf16 v[228:231], v[106:109], v[132:135], 0
v_cvt_pk_bf16_f32 v162, v164, v165
v_pk_max_i16 v160, v160, 0
v_mfma_f32_16x16x32_bf16 v[228:231], v[76:79], v[208:211], v[228:231]
v_pk_max_i16 v161, v161, 0
v_cvt_pk_bf16_f32 v163, v166, v167
v_mfma_f32_16x16x32_bf16 v[228:231], v[92:95], v[192:195], v[228:231]
s_waitcnt lgkmcnt(1)
v_cvt_pk_bf16_f32 v188, v188, v189
v_cvt_pk_bf16_f32 v189, v190, v191
v_mfma_f32_16x16x32_bf16 v[228:231], v[60:63], v[200:203], v[228:231]
ds_write_b64 v246, v[188:189] offset:16
v_mfma_f32_16x16x32_bf16 v[184:187], v[56:59], v[200:203], 0
v_pk_max_i16 v163, v163, 0
v_cvt_pk_bf16_f32 v155, v158, v159
v_mfma_f32_16x16x32_bf16 v[184:187], v[72:75], v[208:211], v[184:187]
v_pk_max_i16 v162, v162, 0
v_cvt_pk_bf16_f32 v154, v156, v157
v_mfma_f32_16x16x32_bf16 v[184:187], v[88:91], v[192:195], v[184:187]
v_cvt_pk_bf16_f32 v228, v228, v229
v_cvt_pk_bf16_f32 v229, v230, v231
v_mfma_f32_16x16x32_bf16 v[184:187], v[104:107], v[132:135], v[184:187]
ds_write_b64 v246, v[228:229] offset:8
v_mfma_f32_16x16x32_bf16 v[188:191], v[0:3], v[112:115], 0
v_pk_max_i16 v154, v154, 0
v_pk_max_i16 v152, v152, 0
v_mfma_f32_16x16x32_bf16 v[188:191], v[4:7], v[116:119], v[188:191]
v_pk_max_i16 v155, v155, 0
v_add_f32 v249, v249, v250
v_mfma_f32_16x16x32_bf16 v[192:195], v[12:15], v[116:119], 0
buffer_store_dwordx4 v[152:155], v239, s[20:23], s52 offen offset:0 nt
buffer_store_dwordx4 v[160:163], v239, s[20:23], s52 offen offset:64 nt
v_cvt_pk_bf16_f32 v184, v184, v185
v_cvt_pk_bf16_f32 v185, v186, v187
v_rcp_f32 v252, v249
v_max3_f32 v254, v188, v189, v190
v_cvt_pk_bf16_f32 v148, v232, 0
s_add_u32 s52, s46, 16384
v_mfma_f32_16x16x32_bf16 v[192:195], v[8:11], v[112:115], v[192:195]
ds_write_b64 v246, v[184:185] offset:0
v_mfma_f32_16x16x32_bf16 v[200:203], v[16:19], v[112:115], 0
s_nop 0
v_add_u32 v246, 0x200, v246
s_nop 0
v_mfma_f32_16x16x32_bf16 v[200:203], v[20:23], v[116:119], v[200:203]
s_nop 1
v_max3_f32 v254, v254, v191, v192
v_mfma_f32_16x16x32_bf16 v[184:187], v[28:31], v[116:119], 0
v_max3_f32 v254, v254, v193, v194
s_nop 0
v_mfma_f32_16x16x32_bf16 v[184:187], v[24:27], v[112:115], v[184:187]
s_nop 0
v_max3_f32 v254, v254, v195, v200
v_max3_f32 v254, v254, v201, v202
v_mfma_f32_16x16x32_bf16 v[208:211], v[32:35], v[112:115], 0
s_nop 2
v_mfma_f32_16x16x32_bf16 v[208:211], v[36:39], v[116:119], v[208:211]
v_max3_f32 v254, v254, v203, v184
v_max3_f32 v254, v254, v185, v186
v_mfma_f32_16x16x32_bf16 v[216:219], v[44:47], v[116:119], 0
s_nop 2
v_mfma_f32_16x16x32_bf16 v[216:219], v[40:43], v[112:115], v[216:219]
s_nop 0
v_max3_f32 v254, v254, v187, v208
v_max3_f32 v254, v254, v209, v210
v_mfma_f32_16x16x32_bf16 v[220:223], v[48:51], v[112:115], 0
s_nop 2
v_mfma_f32_16x16x32_bf16 v[220:223], v[52:55], v[116:119], v[220:223]
v_max3_f32 v254, v254, v211, v216
v_max3_f32 v254, v254, v217, v218
v_mfma_f32_16x16x32_bf16 v[152:155], a[192:195], v[224:227], 0
s_nop 2
v_mfma_f32_16x16x32_bf16 v[152:155], a[196:199], v[196:199], v[152:155]
s_nop 0
v_max3_f32 v254, v254, v219, v220
v_mfma_f32_16x16x32_bf16 v[152:155], a[200:203], v[212:215], v[152:155]
ds_swizzle_b32 v255, v254 offset:0x401F
v_mfma_f32_16x16x32_bf16 v[152:155], a[204:207], v[204:207], v[152:155]
v_mfma_f32_16x16x32_bf16 v[156:159], a[220:223], v[204:207], 0
v_mfma_f32_16x16x32_bf16 v[156:159], a[216:219], v[212:215], v[156:159]
v_mfma_f32_16x16x32_bf16 v[156:159], a[212:215], v[196:199], v[156:159]
v_mfma_f32_16x16x32_bf16 v[156:159], a[208:211], v[224:227], v[156:159]
v_mfma_f32_16x16x32_bf16 v[160:163], a[224:227], v[224:227], 0
s_waitcnt lgkmcnt(0)
v_max_f32 v254, v254, v255
v_mfma_f32_16x16x32_bf16 v[160:163], a[228:231], v[196:199], v[160:163]
ds_bpermute_b32 v255, v247, v254
v_mfma_f32_16x16x32_bf16 v[160:163], a[232:235], v[212:215], v[160:163]
v_mfma_f32_16x16x32_bf16 v[160:163], a[236:239], v[204:207], v[160:163]
v_mfma_f32_16x16x32_bf16 v[164:167], a[252:255], v[204:207], 0
v_mfma_f32_16x16x32_bf16 v[164:167], a[248:251], v[212:215], v[164:167]
v_mfma_f32_16x16x32_bf16 v[164:167], a[244:247], v[196:199], v[164:167]
v_mfma_f32_16x16x32_bf16 v[164:167], a[240:243], v[224:227], v[164:167]
s_waitcnt lgkmcnt(0)
v_max_f32 v254, v254, v255
v_sub_f32 v188, v188, v254
v_mfma_f32_16x16x32_bf16 v[196:199], v[56:59], v[136:139], 0
v_sub_f32 v190, v190, v254
v_sub_f32 v189, v189, v254
v_mfma_f32_16x16x32_bf16 v[196:199], v[104:107], v[148:151], v[196:199]
v_exp_f32 v189, v189
v_mfma_f32_16x16x32_bf16 v[196:199], v[72:75], v[140:143], v[196:199]
v_exp_f32 v188, v188
v_mfma_f32_16x16x32_bf16 v[196:199], v[88:91], v[144:147], v[196:199]
v_add_f32 v248, v188, v189
v_sub_f32 v191, v191, v254
v_mfma_f32_16x16x32_bf16 v[204:207], v[92:95], v[144:147], 0
v_exp_f32 v191, v191
v_mfma_f32_16x16x32_bf16 v[204:207], v[76:79], v[140:143], v[204:207]
v_exp_f32 v190, v190
v_mfma_f32_16x16x32_bf16 v[204:207], v[106:109], v[148:151], v[204:207]
v_cvt_pk_bf16_f32 v120, v188, v189
v_add_f32 v248, v248, v190
v_mfma_f32_16x16x32_bf16 v[204:207], v[60:63], v[136:139], v[204:207]
ds_read_b128 v[212:215], v236 offset:4224
v_add_f32 v248, v248, v191
v_mfma_f32_16x16x32_bf16 v[228:231], v[64:67], v[136:139], 0
ds_read_b128 v[224:227], v236 offset:4480
v_cvt_pk_bf16_f32 v121, v190, v191
v_mfma_f32_16x16x32_bf16 v[228:231], v[108:111], v[148:151], v[228:231]
v_fmac_f32 v170, v198, v252
v_fmac_f32 v171, v199, v252
v_mfma_f32_16x16x32_bf16 v[228:231], v[80:83], v[140:143], v[228:231]
v_fmac_f32 v168, v196, v252
v_fmac_f32 v169, v197, v252
v_mfma_f32_16x16x32_bf16 v[228:231], v[96:99], v[144:147], v[228:231]
ds_read_b128 v[196:199], v236 offset:4736
v_fmac_f32 v175, v207, v252
v_mfma_f32_16x16x32_bf16 v[232:235], v[100:103], v[144:147], 0
v_fmac_f32 v172, v204, v252
v_fmac_f32 v174, v206, v252
v_mfma_f32_16x16x32_bf16 v[232:235], v[84:87], v[140:143], v[232:235]
s_waitcnt lgkmcnt(2)
v_fmac_f32 v173, v205, v252
v_fmac_f32 v177, v229, v252
v_mfma_f32_16x16x32_bf16 v[232:235], v[110:113], v[148:151], v[232:235]
s_waitcnt lgkmcnt(1)
ds_read_b128 v[204:207], v236 offset:4992
v_fmac_f32 v176, v228, v252
v_mfma_f32_16x16x32_bf16 v[232:235], v[68:71], v[136:139], v[232:235]
v_fmac_f32 v178, v230, v252
v_fmac_f32 v179, v231, v252
v_mfma_f32_16x16x32_bf16 v[188:191], a[0:3], v[212:215], 0
v_cvt_pk_bf16_f32 v176, v176, v177
v_cvt_pk_bf16_f32 v168, v168, v169
v_mfma_f32_16x16x32_bf16 v[188:191], a[4:7], v[224:227], v[188:191]
s_waitcnt lgkmcnt(1)
v_cvt_pk_bf16_f32 v169, v170, v171
v_fmac_f32 v181, v233, v252
v_mfma_f32_16x16x32_bf16 v[188:191], a[8:11], v[196:199], v[188:191]
v_fmac_f32 v182, v234, v252
v_fmac_f32 v180, v232, v252
v_fmac_f32 v183, v235, v252
v_cvt_pk_bf16_f32 v170, v172, v173
v_pk_max_i16 v170, v170, 0
s_waitcnt lgkmcnt(0)
v_mfma_f32_16x16x32_bf16 v[188:191], a[12:15], v[204:207], v[188:191]
v_cvt_pk_bf16_f32 v171, v174, v175
v_pk_max_i16 v176, v176, 0
v_mfma_f32_16x16x32_bf16 v[232:235], a[28:31], v[204:207], 0
v_pk_max_i16 v171, v171, 0
v_cvt_pk_bf16_f32 v177, v178, v179
v_mfma_f32_16x16x32_bf16 v[232:235], a[24:27], v[196:199], v[232:235]
v_cvt_pk_bf16_f32 v178, v180, v181
v_pk_max_i16 v177, v177, 0
v_mfma_f32_16x16x32_bf16 v[232:235], a[20:23], v[224:227], v[232:235]
v_cvt_pk_bf16_f32 v112, v188, v189
v_cvt_pk_bf16_f32 v113, v190, v191
v_mfma_f32_16x16x32_bf16 v[232:235], a[16:19], v[212:215], v[232:235]
v_pk_max_i16 v168, v168, 0
v_cvt_pk_bf16_f32 v179, v182, v183
v_mfma_f32_16x16x32_bf16 v[188:191], a[32:35], v[212:215], 0
v_pk_max_i16 v179, v179, 0
v_pk_max_i16 v169, v169, 0
v_mfma_f32_16x16x32_bf16 v[188:191], a[36:39], v[224:227], v[188:191]
v_pk_max_i16 v178, v178, 0
v_sub_f32 v192, v192, v254
v_mfma_f32_16x16x32_bf16 v[188:191], a[40:43], v[196:199], v[188:191]
buffer_store_dwordx4 v[168:171], v239, s[20:23], s53 offen offset:0 nt
buffer_store_dwordx4 v[176:179], v239, s[20:23], s53 offen offset:64 nt
v_sub_f32 v193, v193, v254
v_exp_f32 v192, v192
v_exp_f32 v193, v193
v_sub_f32 v195, v195, v254
v_exp_f32 v195, v195
v_mfma_f32_16x16x32_bf16 v[188:191], a[44:47], v[204:207], v[188:191]
s_add_u32 s53, s46, 4096
v_add_f32 v248, v248, v192
v_sub_f32 v194, v194, v254
v_mfma_f32_16x16x32_bf16 v[228:231], a[60:63], v[204:207], 0
s_add_u32 s46, s46, 13107200
v_cvt_pk_bf16_f32 v114, v232, v233
v_cvt_pk_bf16_f32 v115, v234, v235
v_mfma_f32_16x16x32_bf16 v[228:231], a[56:59], v[196:199], v[228:231]
v_cvt_pk_bf16_f32 v117, v190, v191
v_cvt_pk_bf16_f32 v116, v188, v189
v_mfma_f32_16x16x32_bf16 v[228:231], a[52:55], v[224:227], v[228:231]
v_exp_f32 v194, v194
v_mfma_f32_16x16x32_bf16 v[228:231], a[48:51], v[212:215], v[228:231]
v_add_f32 v248, v248, v193
v_add_f32 v248, v248, v194
v_mfma_f32_16x16x32_bf16 v[168:171], a[192:195], v[212:215], 0
v_add_f32 v248, v248, v195
v_cvt_pk_bf16_f32 v122, v192, v193
v_mfma_f32_16x16x32_bf16 v[168:171], a[196:199], v[224:227], v[168:171]
v_cvt_pk_bf16_f32 v123, v194, v195
v_sub_f32 v201, v201, v254
v_mfma_f32_16x16x32_bf16 v[168:171], a[200:203], v[196:199], v[168:171]
v_cvt_pk_bf16_f32 v119, v230, v231
v_cvt_pk_bf16_f32 v118, v228, v229
v_mfma_f32_16x16x32_bf16 v[168:171], a[204:207], v[204:207], v[168:171]
v_sub_f32 v202, v202, v254
v_sub_f32 v200, v200, v254
v_mfma_f32_16x16x32_bf16 v[172:175], a[220:223], v[204:207], 0
v_exp_f32 v200, v200
v_mfma_f32_16x16x32_bf16 v[172:175], a[216:219], v[196:199], v[172:175]
v_exp_f32 v202, v202
v_mfma_f32_16x16x32_bf16 v[172:175], a[212:215], v[224:227], v[172:175]
v_exp_f32 v201, v201
v_mfma_f32_16x16x32_bf16 v[172:175], a[208:211], v[212:215], v[172:175]
v_sub_f32 v203, v203, v254
v_add_f32 v248, v248, v200
v_mfma_f32_16x16x32_bf16 v[176:179], a[224:227], v[212:215], 0
v_exp_f32 v203, v203
v_mfma_f32_16x16x32_bf16 v[176:179], a[228:231], v[224:227], v[176:179]
v_cvt_pk_bf16_f32 v125, v202, v203
v_add_f32 v248, v248, v201
v_mfma_f32_16x16x32_bf16 v[176:179], a[232:235], v[196:199], v[176:179]
v_add_f32 v248, v248, v202
v_cvt_pk_bf16_f32 v124, v200, v201
v_mfma_f32_16x16x32_bf16 v[176:179], a[236:239], v[204:207], v[176:179]
v_add_f32 v248, v248, v203
v_sub_f32 v184, v184, v254
v_mfma_f32_16x16x32_bf16 v[180:183], a[252:255], v[204:207], 0
v_sub_f32 v185, v185, v254
v_sub_f32 v187, v187, v254
v_mfma_f32_16x16x32_bf16 v[180:183], a[248:251], v[196:199], v[180:183]
v_sub_f32 v186, v186, v254
v_sub_f32 v220, v220, v254
v_mfma_f32_16x16x32_bf16 v[180:183], a[244:247], v[224:227], v[180:183]
v_exp_f32 v184, v184
v_mfma_f32_16x16x32_bf16 v[180:183], a[240:243], v[212:215], v[180:183]
v_add_f32 v248, v248, v184
v_sub_f32 v216, v216, v254
v_mfma_f32_16x16x32_bf16 v[188:191], v[0:3], v[112:115], 0
v_exp_f32 v187, v187
v_mfma_f32_16x16x32_bf16 v[188:191], v[4:7], v[116:119], v[188:191]
v_exp_f32 v186, v186
v_mfma_f32_16x16x32_bf16 v[192:195], v[12:15], v[116:119], 0
v_exp_f32 v185, v185
v_mfma_f32_16x16x32_bf16 v[192:195], v[8:11], v[112:115], v[192:195]
v_add_f32 v248, v248, v185
v_add_f32 v248, v248, v186
v_mfma_f32_16x16x32_bf16 v[196:199], v[16:19], v[112:115], 0
v_add_f32 v248, v248, v187
v_cvt_pk_bf16_f32 v127, v186, v187
v_mfma_f32_16x16x32_bf16 v[196:199], v[20:23], v[116:119], v[196:199]
v_cvt_pk_bf16_f32 v126, v184, v185
v_sub_f32 v218, v218, v254
v_mfma_f32_16x16x32_bf16 v[200:203], v[28:31], v[116:119], 0
v_exp_f32 v220, v220
v_mfma_f32_16x16x32_bf16 v[200:203], v[24:27], v[112:115], v[200:203]
v_cvt_pk_bf16_f32 v132, v220, 0
v_sub_f32 v217, v217, v254
v_mfma_f32_16x16x32_bf16 v[204:207], v[32:35], v[112:115], 0
v_sub_f32 v211, v211, v254
v_sub_f32 v210, v210, v254
v_mfma_f32_16x16x32_bf16 v[204:207], v[36:39], v[116:119], v[204:207]
v_sub_f32 v219, v219, v254
v_sub_f32 v208, v208, v254
v_mfma_f32_16x16x32_bf16 v[212:215], v[44:47], v[116:119], 0
v_sub_f32 v209, v209, v254
v_max3_f32 v254, v188, v189, v190
v_mfma_f32_16x16x32_bf16 v[212:215], v[40:43], v[112:115], v[212:215]
v_exp_f32 v209, v209
v_mfma_f32_16x16x32_bf16 v[224:227], v[48:51], v[112:115], 0
v_exp_f32 v208, v208
v_mfma_f32_16x16x32_bf16 v[224:227], v[52:55], v[116:119], v[224:227]
v_exp_f32 v217, v217
v_mfma_f32_16x16x32_bf16 v[184:187], v[56:59], v[120:123], 0
v_exp_f32 v210, v210
v_mfma_f32_16x16x32_bf16 v[184:187], v[104:107], v[132:135], v[184:187]
v_exp_f32 v218, v218
v_mfma_f32_16x16x32_bf16 v[184:187], v[72:75], v[124:127], v[184:187]
v_exp_f32 v211, v211
v_exp_f32 v216, v216
v_exp_f32 v219, v219
v_cvt_pk_bf16_f32 v129, v210, v211
v_cvt_pk_bf16_f32 v131, v218, v219
v_cvt_pk_bf16_f32 v130, v216, v217
v_cvt_pk_bf16_f32 v128, v208, v209
v_add_f32 v248, v248, v208
v_add_f32 v248, v248, v209
v_mfma_f32_16x16x32_bf16 v[184:187], v[88:91], v[128:131], v[184:187]
v_add_f32 v248, v248, v210
v_add_f32 v248, v248, v211
v_mfma_f32_16x16x32_bf16 v[208:211], v[92:95], v[128:131], 0
v_max3_f32 v254, v254, v191, v192
v_max3_f32 v254, v254, v193, v194
v_mfma_f32_16x16x32_bf16 v[208:211], v[76:79], v[124:127], v[208:211]
v_max3_f32 v254, v254, v195, v196
v_max3_f32 v254, v254, v197, v198
v_mfma_f32_16x16x32_bf16 v[208:211], v[106:109], v[132:135], v[208:211]
v_max3_f32 v254, v254, v199, v200
v_max3_f32 v254, v254, v201, v202
v_mfma_f32_16x16x32_bf16 v[208:211], v[60:63], v[120:123], v[208:211]
v_max3_f32 v254, v254, v203, v204
v_max3_f32 v254, v254, v205, v206
v_mfma_f32_16x16x32_bf16 v[228:231], v[64:67], v[120:123], 0
v_max3_f32 v254, v254, v207, v212
v_max3_f32 v254, v254, v213, v214
v_mfma_f32_16x16x32_bf16 v[228:231], v[108:111], v[132:135], v[228:231]
v_max3_f32 v254, v254, v215, v224
v_add_f32 v248, v248, v216
v_mfma_f32_16x16x32_bf16 v[228:231], v[80:83], v[124:127], v[228:231]
ds_swizzle_b32 v255, v254 offset:0x401F
v_add_f32 v248, v248, v217
v_mfma_f32_16x16x32_bf16 v[228:231], v[96:99], v[128:131], v[228:231]
v_add_f32 v248, v248, v218
v_add_f32 v248, v248, v219
v_mfma_f32_16x16x32_bf16 v[232:235], v[100:103], v[128:131], 0
ds_read_b128 v[216:219], v236 offset:8448
v_add_f32 v248, v248, v220
v_mfma_f32_16x16x32_bf16 v[232:235], v[84:87], v[124:127], v[232:235]
ds_read_b128 v[220:223], v236 offset:8704
ds_swizzle_b32 v250, v248 offset:0x401F
v_mfma_f32_16x16x32_bf16 v[232:235], v[110:113], v[132:135], v[232:235]
v_mfma_f32_16x16x32_bf16 v[232:235], v[68:71], v[120:123], v[232:235]
s_waitcnt lgkmcnt(3)
v_max_f32 v254, v254, v255
ds_bpermute_b32 v255, v247, v254
s_waitcnt lgkmcnt(1)
v_add_f32 v248, v248, v250
ds_bpermute_b32 v250, v247, v248
s_waitcnt lgkmcnt(1)
v_max_f32 v254, v254, v255
v_sub_f32 v188, v188, v254
v_exp_f32 v188, v188
v_sub_f32 v189, v189, v254
v_sub_f32 v190, v190, v254
v_sub_f32 v191, v191, v254
v_exp_f32 v189, v189
v_exp_f32 v191, v191
v_exp_f32 v190, v190
v_add_f32 v249, v188, v189
v_add_f32 v249, v249, v190
v_add_f32 v249, v249, v191
v_cvt_pk_bf16_f32 v137, v190, v191
v_cvt_pk_bf16_f32 v136, v188, v189
v_mfma_f32_16x16x32_bf16 v[188:191], a[0:3], v[216:219], 0
s_waitcnt lgkmcnt(0)
v_sub_f32 v192, v192, v254
v_sub_f32 v195, v195, v254
v_mfma_f32_16x16x32_bf16 v[188:191], a[4:7], v[220:223], v[188:191]
v_exp_f32 v192, v192
v_sub_f32 v193, v193, v254
v_sub_f32 v194, v194, v254
v_exp_f32 v195, v195
v_exp_f32 v193, v193
v_exp_f32 v194, v194
v_add_f32 v249, v249, v192
v_add_f32 v249, v249, v193
v_add_f32 v249, v249, v194
v_add_f32 v249, v249, v195
v_cvt_pk_bf16_f32 v139, v194, v195
v_cvt_pk_bf16_f32 v138, v192, v193
ds_read_b128 v[192:195], v236 offset:8960
v_sub_f32 v198, v198, v254
v_sub_f32 v197, v197, v254
v_sub_f32 v196, v196, v254
v_exp_f32 v196, v196
v_exp_f32 v198, v198
v_sub_f32 v202, v202, v254
v_sub_f32 v200, v200, v254
v_exp_f32 v197, v197
v_sub_f32 v201, v201, v254
v_sub_f32 v199, v199, v254
v_exp_f32 v199, v199
v_exp_f32 v200, v200
v_add_f32 v249, v249, v196
v_add_f32 v249, v249, v197
v_add_f32 v249, v249, v198
s_waitcnt lgkmcnt(0)
v_mfma_f32_16x16x32_bf16 v[188:191], a[8:11], v[192:195], v[188:191]
v_sub_f32 v203, v203, v254
v_add_f32 v249, v249, v199
v_add_f32 v249, v249, v200
v_exp_f32 v201, v201
v_exp_f32 v202, v202
v_exp_f32 v203, v203
v_sub_f32 v204, v204, v254
v_exp_f32 v204, v204
v_add_f32 v249, v249, v201
v_add_f32 v249, v249, v202
v_add_f32 v249, v249, v203
v_sub_f32 v205, v205, v254
v_sub_f32 v206, v206, v254
v_exp_f32 v205, v205
v_exp_f32 v206, v206
v_add_f32 v249, v249, v204
v_add_f32 v249, v249, v205
v_sub_f32 v207, v207, v254
v_exp_f32 v207, v207
v_add_f32 v249, v249, v206
v_add_f32 v249, v249, v207
v_cvt_pk_bf16_f32 v145, v206, v207
v_cvt_pk_bf16_f32 v144, v204, v205
ds_read_b128 v[204:207], v236 offset:9216
v_add_f32 v248, v248, v250
v_rcp_f32 v251, v248
v_sub_f32 v212, v212, v254
v_fmac_f32 v152, v184, v251
v_fmac_f32 v153, v185, v251
v_fmac_f32 v155, v187, v251
v_fmac_f32 v154, v186, v251
v_fmac_f32 v157, v209, v251
v_fmac_f32 v159, v211, v251
v_fmac_f32 v158, v210, v251
v_fmac_f32 v156, v208, v251
v_exp_f32 v212, v212
v_sub_f32 v213, v213, v254
v_exp_f32 v213, v213
v_sub_f32 v214, v214, v254
v_exp_f32 v214, v214
s_waitcnt lgkmcnt(0)
v_mfma_f32_16x16x32_bf16 v[188:191], a[12:15], v[204:207], v[188:191]
v_sub_f32 v215, v215, v254
v_add_f32 v249, v249, v212
v_mfma_f32_16x16x32_bf16 v[184:187], a[28:31], v[204:207], 0
v_exp_f32 v215, v215
v_mfma_f32_16x16x32_bf16 v[184:187], a[24:27], v[192:195], v[184:187]
v_add_f32 v249, v249, v213
v_add_f32 v249, v249, v214
v_mfma_f32_16x16x32_bf16 v[184:187], a[20:23], v[220:223], v[184:187]
v_add_f32 v249, v249, v215
v_cvt_pk_bf16_f32 v147, v214, v215
v_mfma_f32_16x16x32_bf16 v[184:187], a[16:19], v[216:219], v[184:187]
v_cvt_pk_bf16_f32 v146, v212, v213
v_fmac_f32 v163, v231, v251
v_mfma_f32_16x16x32_bf16 v[208:211], a[32:35], v[216:219], 0
v_fmac_f32 v161, v229, v251
v_cvt_pk_bf16_f32 v152, v152, v153
v_mfma_f32_16x16x32_bf16 v[208:211], a[36:39], v[220:223], v[208:211]
v_fmac_f32 v167, v235, v251
v_fmac_f32 v160, v228, v251
v_mfma_f32_16x16x32_bf16 v[208:211], a[40:43], v[192:195], v[208:211]
v_fmac_f32 v164, v232, v251
v_cvt_pk_bf16_f32 v160, v160, v161
v_mfma_f32_16x16x32_bf16 v[208:211], a[44:47], v[204:207], v[208:211]
v_cvt_pk_bf16_f32 v153, v154, v155
v_cvt_pk_bf16_f32 v154, v156, v157
v_mfma_f32_16x16x32_bf16 v[212:215], a[60:63], v[204:207], 0
v_fmac_f32 v166, v234, v251
v_fmac_f32 v162, v230, v251
v_mfma_f32_16x16x32_bf16 v[212:215], a[56:59], v[192:195], v[212:215]
v_fmac_f32 v165, v233, v251
v_cvt_pk_bf16_f32 v155, v158, v159
v_mfma_f32_16x16x32_bf16 v[212:215], a[52:55], v[220:223], v[212:215]
v_cvt_pk_bf16_f32 v161, v162, v163
v_cvt_pk_bf16_f32 v162, v164, v165
v_mfma_f32_16x16x32_bf16 v[212:215], a[48:51], v[216:219], v[212:215]
v_cvt_pk_bf16_f32 v163, v166, v167
v_pk_max_i16 v162, v162, 0
v_pk_max_i16 v161, v161, 0
v_pk_max_i16 v163, v163, 0
v_pk_max_i16 v153, v153, 0
v_pk_max_i16 v155, v155, 0
v_pk_max_i16 v152, v152, 0
v_pk_max_i16 v160, v160, 0
v_pk_max_i16 v154, v154, 0
buffer_store_dwordx4 v[152:155], v239, s[20:23], s52 offen offset:0 nt
buffer_store_dwordx4 v[160:163], v239, s[20:23], s52 offen offset:64 nt
v_cvt_pk_bf16_f32 v112, v188, v189
v_cvt_pk_bf16_f32 v113, v190, v191
v_cvt_pk_bf16_f32 v114, v184, v185
v_cvt_pk_bf16_f32 v115, v186, v187
v_cvt_pk_bf16_f32 v118, v212, v213
v_cvt_pk_bf16_f32 v119, v214, v215
v_cvt_pk_bf16_f32 v116, v208, v209
v_cvt_pk_bf16_f32 v117, v210, v211
v_mfma_f32_16x16x32_bf16 v[152:155], a[192:195], v[216:219], 0
v_sub_f32 v224, v224, v254
v_cvt_pk_bf16_f32 v142, v200, v201
v_mfma_f32_16x16x32_bf16 v[152:155], a[196:199], v[220:223], v[152:155]
v_exp_f32 v224, v224
v_mfma_f32_16x16x32_bf16 v[152:155], a[200:203], v[192:195], v[152:155]
v_cvt_pk_bf16_f32 v141, v198, v199
v_cvt_pk_bf16_f32 v140, v196, v197
v_mfma_f32_16x16x32_bf16 v[152:155], a[204:207], v[204:207], v[152:155]
v_add_f32 v249, v249, v224
v_cvt_pk_bf16_f32 v143, v202, v203
v_mfma_f32_16x16x32_bf16 v[156:159], a[220:223], v[204:207], 0
ds_swizzle_b32 v250, v249 offset:0x401F
v_cvt_pk_bf16_f32 v148, v224, 0
v_mfma_f32_16x16x32_bf16 v[156:159], a[216:219], v[192:195], v[156:159]
v_mfma_f32_16x16x32_bf16 v[156:159], a[212:215], v[220:223], v[156:159]
v_mfma_f32_16x16x32_bf16 v[156:159], a[208:211], v[216:219], v[156:159]
v_mfma_f32_16x16x32_bf16 v[160:163], a[224:227], v[216:219], 0
v_mfma_f32_16x16x32_bf16 v[160:163], a[228:231], v[220:223], v[160:163]
v_mfma_f32_16x16x32_bf16 v[160:163], a[232:235], v[192:195], v[160:163]
s_waitcnt lgkmcnt(0)
v_add_f32 v249, v249, v250
v_mfma_f32_16x16x32_bf16 v[160:163], a[236:239], v[204:207], v[160:163]
ds_bpermute_b32 v250, v247, v249
v_mfma_f32_16x16x32_bf16 v[164:167], a[252:255], v[204:207], 0
v_mfma_f32_16x16x32_bf16 v[164:167], a[248:251], v[192:195], v[164:167]
v_mfma_f32_16x16x32_bf16 v[164:167], a[244:247], v[220:223], v[164:167]
v_mfma_f32_16x16x32_bf16 v[164:167], a[240:243], v[216:219], v[164:167]
v_mfma_f32_16x16x32_bf16 v[184:187], v[0:3], v[112:115], 0
v_mfma_f32_16x16x32_bf16 v[184:187], v[4:7], v[116:119], v[184:187]
s_waitcnt lgkmcnt(0)
v_add_f32 v249, v249, v250
s_nop 0
v_mfma_f32_16x16x32_bf16 v[188:191], v[12:15], v[116:119], 0
v_rcp_f32 v252, v249
v_mfma_f32_16x16x32_bf16 v[188:191], v[8:11], v[112:115], v[188:191]
s_nop 1
v_max3_f32 v254, v184, v185, v186
v_mfma_f32_16x16x32_bf16 v[192:195], v[16:19], v[112:115], 0
s_nop 2
v_mfma_f32_16x16x32_bf16 v[192:195], v[20:23], v[116:119], v[192:195]
v_max3_f32 v254, v254, v187, v188
v_max3_f32 v254, v254, v189, v190
v_mfma_f32_16x16x32_bf16 v[196:199], v[28:31], v[116:119], 0
s_nop 2
v_mfma_f32_16x16x32_bf16 v[196:199], v[24:27], v[112:115], v[196:199]
s_nop 0
v_max3_f32 v254, v254, v191, v192
v_max3_f32 v254, v254, v193, v194
v_mfma_f32_16x16x32_bf16 v[200:203], v[32:35], v[112:115], 0
s_nop 2
v_mfma_f32_16x16x32_bf16 v[200:203], v[36:39], v[116:119], v[200:203]
v_max3_f32 v254, v254, v195, v196
v_max3_f32 v254, v254, v197, v198
v_mfma_f32_16x16x32_bf16 v[204:207], v[44:47], v[116:119], 0
s_nop 2
v_mfma_f32_16x16x32_bf16 v[204:207], v[40:43], v[112:115], v[204:207]
s_nop 0
v_max3_f32 v254, v254, v199, v200
v_max3_f32 v254, v254, v201, v202
v_mfma_f32_16x16x32_bf16 v[208:211], v[48:51], v[112:115], 0
s_nop 2
v_mfma_f32_16x16x32_bf16 v[208:211], v[52:55], v[116:119], v[208:211]
v_max3_f32 v254, v254, v203, v204
v_max3_f32 v254, v254, v205, v206
v_mfma_f32_16x16x32_bf16 v[212:215], v[56:59], v[136:139], 0
s_nop 2
v_mfma_f32_16x16x32_bf16 v[212:215], v[104:107], v[148:151], v[212:215]
s_nop 0
v_max3_f32 v254, v254, v207, v208
v_mfma_f32_16x16x32_bf16 v[212:215], v[72:75], v[140:143], v[212:215]
ds_swizzle_b32 v255, v254 offset:0x401F
v_mfma_f32_16x16x32_bf16 v[212:215], v[88:91], v[144:147], v[212:215]
s_nop 2
v_mfma_f32_16x16x32_bf16 v[216:219], v[92:95], v[144:147], 0
s_nop 2
v_mfma_f32_16x16x32_bf16 v[216:219], v[76:79], v[140:143], v[216:219]
v_fmac_f32 v169, v213, v252
v_fmac_f32 v168, v212, v252
v_mfma_f32_16x16x32_bf16 v[216:219], v[106:109], v[148:151], v[216:219]
v_fmac_f32 v171, v215, v252
v_fmac_f32 v170, v214, v252
v_mfma_f32_16x16x32_bf16 v[216:219], v[60:63], v[136:139], v[216:219]
ds_read_b128 v[220:223], v236 offset:12672
ds_read_b128 v[224:227], v236 offset:12928
v_mfma_f32_16x16x32_bf16 v[228:231], v[64:67], v[136:139], 0
s_waitcnt lgkmcnt(2)
ds_read_b128 v[212:215], v236 offset:13184
v_cvt_pk_bf16_f32 v168, v168, v169
v_mfma_f32_16x16x32_bf16 v[228:231], v[108:111], v[148:151], v[228:231]
s_nop 0
v_fmac_f32 v172, v216, v252
v_fmac_f32 v174, v218, v252
v_mfma_f32_16x16x32_bf16 v[228:231], v[80:83], v[140:143], v[228:231]
v_fmac_f32 v173, v217, v252
v_fmac_f32 v175, v219, v252
v_mfma_f32_16x16x32_bf16 v[228:231], v[96:99], v[144:147], v[228:231]
ds_read_b128 v[216:219], v236 offset:13440
v_cvt_pk_bf16_f32 v169, v170, v171
v_mfma_f32_16x16x32_bf16 v[232:235], v[100:103], v[144:147], 0
v_cvt_pk_bf16_f32 v170, v172, v173
v_cvt_pk_bf16_f32 v171, v174, v175
v_mfma_f32_16x16x32_bf16 v[232:235], v[84:87], v[140:143], v[232:235]
s_waitcnt lgkmcnt(2)
v_pk_max_i16 v170, v170, 0
v_fmac_f32 v178, v230, v252
v_mfma_f32_16x16x32_bf16 v[232:235], v[110:113], v[148:151], v[232:235]
s_waitcnt lgkmcnt(1)
v_fmac_f32 v179, v231, v252
v_fmac_f32 v176, v228, v252
v_mfma_f32_16x16x32_bf16 v[232:235], v[68:71], v[136:139], v[232:235]
v_fmac_f32 v177, v229, v252
v_cvt_pk_bf16_f32 v176, v176, v177
v_mfma_f32_16x16x32_bf16 v[228:231], a[0:3], v[220:223], 0
v_cvt_pk_bf16_f32 v177, v178, v179
v_pk_max_i16 v169, v169, 0
v_mfma_f32_16x16x32_bf16 v[228:231], a[4:7], v[224:227], v[228:231]
s_waitcnt lgkmcnt(0)
v_pk_max_i16 v171, v171, 0
v_fmac_f32 v182, v234, v252
v_mfma_f32_16x16x32_bf16 v[228:231], a[8:11], v[212:215], v[228:231]
v_fmac_f32 v181, v233, v252
v_fmac_f32 v183, v235, v252
v_mfma_f32_16x16x32_bf16 v[228:231], a[12:15], v[216:219], v[228:231]
v_fmac_f32 v180, v232, v252
v_cvt_pk_bf16_f32 v179, v182, v183
v_mfma_f32_16x16x32_bf16 v[232:235], a[28:31], v[216:219], 0
v_cvt_pk_bf16_f32 v178, v180, v181
v_pk_max_i16 v178, v178, 0
v_mfma_f32_16x16x32_bf16 v[232:235], a[24:27], v[212:215], v[232:235]
v_pk_max_i16 v179, v179, 0
v_pk_max_i16 v176, v176, 0
v_mfma_f32_16x16x32_bf16 v[232:235], a[20:23], v[224:227], v[232:235]
v_cvt_pk_bf16_f32 v113, v230, v231
v_cvt_pk_bf16_f32 v112, v228, v229
v_mfma_f32_16x16x32_bf16 v[232:235], a[16:19], v[220:223], v[232:235]
v_pk_max_i16 v168, v168, 0
v_pk_max_i16 v177, v177, 0
v_mfma_f32_16x16x32_bf16 v[228:231], a[32:35], v[220:223], 0
buffer_store_dwordx4 v[168:171], v239, s[20:23], s53 offen offset:0 nt
buffer_store_dwordx4 v[176:179], v239, s[20:23], s53 offen offset:64 nt
v_add_u32 v236, s56, v236
v_max_f32 v254, v254, v255
s_sub_u32 s56, 0, s56
v_cvt_pk_bf16_f32 v115, v234, v235
v_cvt_pk_bf16_f32 v114, v232, v233
v_mfma_f32_16x16x32_bf16 v[228:231], a[36:39], v[224:227], v[228:231]
ds_bpermute_b32 v255, v247, v254
v_mfma_f32_16x16x32_bf16 v[228:231], a[40:43], v[212:215], v[228:231]
v_mfma_f32_16x16x32_bf16 v[228:231], a[44:47], v[216:219], v[228:231]
s_nop 2
v_mfma_f32_16x16x32_bf16 v[232:235], a[60:63], v[216:219], 0
s_nop 2
v_mfma_f32_16x16x32_bf16 v[232:235], a[56:59], v[212:215], v[232:235]
v_cvt_pk_bf16_f32 v116, v228, v229
v_cvt_pk_bf16_f32 v117, v230, v231
v_mfma_f32_16x16x32_bf16 v[232:235], a[52:55], v[224:227], v[232:235]
v_mfma_f32_16x16x32_bf16 v[232:235], a[48:51], v[220:223], v[232:235]
s_waitcnt lgkmcnt(0)
v_max_f32 v254, v254, v255
v_sub_f32 v184, v184, v254
v_mfma_f32_16x16x32_bf16 v[168:171], a[192:195], v[220:223], 0
v_exp_f32 v184, v184
v_mfma_f32_16x16x32_bf16 v[168:171], a[196:199], v[224:227], v[168:171]
v_sub_f32 v185, v185, v254
v_sub_f32 v186, v186, v254
v_mfma_f32_16x16x32_bf16 v[168:171], a[200:203], v[212:215], v[168:171]
v_cvt_pk_bf16_f32 v119, v234, v235
v_cvt_pk_bf16_f32 v118, v232, v233
v_mfma_f32_16x16x32_bf16 v[168:171], a[204:207], v[216:219], v[168:171]
v_exp_f32 v186, v186
v_mfma_f32_16x16x32_bf16 v[172:175], a[220:223], v[216:219], 0
v_exp_f32 v185, v185
v_mfma_f32_16x16x32_bf16 v[172:175], a[216:219], v[212:215], v[172:175]
v_sub_f32 v189, v189, v254
v_sub_f32 v187, v187, v254
v_mfma_f32_16x16x32_bf16 v[172:175], a[212:215], v[224:227], v[172:175]
v_sub_f32 v188, v188, v254
v_sub_f32 v190, v190, v254
v_mfma_f32_16x16x32_bf16 v[172:175], a[208:211], v[220:223], v[172:175]
s_cmp_lg_u32 s45, 0
s_cbranch_scc1 L_loops
v_mfma_f32_16x16x32_bf16 v[176:179], a[224:227], v[220:223], 0
s_waitcnt vmcnt(8)
s_barrier
v_mfma_f32_16x16x32_bf16 v[176:179], a[228:231], v[224:227], v[176:179]
s_add_u32 s52, s47, 8192
ds_read_b128 v[232:235], v236 offset:0
v_add_f32 v248, v184, v185
v_mfma_f32_16x16x32_bf16 v[176:179], a[232:235], v[212:215], v[176:179]
s_add_u32 s53, s47, 12288
v_exp_f32 v188, v188
v_mfma_f32_16x16x32_bf16 v[176:179], a[236:239], v[216:219], v[176:179]
v_add_f32 v248, v248, v186
v_sub_f32 v191, v191, v254
v_mfma_f32_16x16x32_bf16 v[180:183], a[252:255], v[216:219], 0
v_exp_f32 v187, v187
v_mfma_f32_16x16x32_bf16 v[180:183], a[248:251], v[212:215], v[180:183]
v_exp_f32 v190, v190
v_mfma_f32_16x16x32_bf16 v[180:183], a[244:247], v[224:227], v[180:183]
v_add_f32 v248, v248, v187
v_add_f32 v248, v248, v188
v_mfma_f32_16x16x32_bf16 v[180:183], a[240:243], v[220:223], v[180:183]
s_waitcnt lgkmcnt(0)
v_exp_f32 v189, v189
v_mfma_f32_16x16x32_bf16 v[228:231], v[0:3], v[112:115], 0
v_add_f32 v248, v248, v189
v_add_f32 v248, v248, v190
v_mfma_f32_16x16x32_bf16 v[228:231], v[4:7], v[116:119], v[228:231]
v_exp_f32 v191, v191
v_cvt_pk_bf16_f32 v122, v188, v189
v_add_f32 v248, v248, v191
v_cvt_pk_bf16_f32 v123, v190, v191
v_mfma_f32_16x16x32_bf16 v[188:191], v[12:15], v[116:119], 0
v_sub_f32 v193, v193, v254
v_sub_f32 v194, v194, v254
v_mfma_f32_16x16x32_bf16 v[188:191], v[8:11], v[112:115], v[188:191]
v_sub_f32 v195, v195, v254
v_exp_f32 v194, v194
v_sub_f32 v192, v192, v254
v_exp_f32 v192, v192
v_sub_f32 v196, v196, v254
v_exp_f32 v193, v193
v_sub_f32 v197, v197, v254
v_sub_f32 v199, v199, v254
v_sub_f32 v198, v198, v254
v_exp_f32 v195, v195
v_add_f32 v248, v248, v192
v_add_f32 v248, v248, v193
v_exp_f32 v196, v196
v_exp_f32 v197, v197
v_add_f32 v248, v248, v194
v_add_f32 v248, v248, v195
v_add_f32 v248, v248, v196
v_add_f32 v248, v248, v197
v_exp_f32 v198, v198
v_sub_f32 v200, v200, v254
v_sub_f32 v203, v203, v254
v_exp_f32 v199, v199
v_sub_f32 v201, v201, v254
v_exp_f32 v201, v201
v_sub_f32 v202, v202, v254
v_exp_f32 v202, v202
v_add_f32 v248, v248, v198
v_exp_f32 v200, v200
v_add_f32 v248, v248, v199
v_add_f32 v248, v248, v200
v_add_f32 v248, v248, v201
v_exp_f32 v203, v203
v_add_f32 v248, v248, v202
v_add_f32 v248, v248, v203
v_cvt_pk_bf16_f32 v128, v200, v201
v_cvt_pk_bf16_f32 v129, v202, v203
v_mfma_f32_16x16x32_bf16 v[200:203], v[16:19], v[112:115], 0
v_sub_f32 v204, v204, v254
v_sub_f32 v205, v205, v254
v_mfma_f32_16x16x32_bf16 v[200:203], v[20:23], v[116:119], v[200:203]
v_exp_f32 v204, v204
v_sub_f32 v206, v206, v254
v_add_f32 v248, v248, v204
v_exp_f32 v206, v206
v_sub_f32 v207, v207, v254
v_exp_f32 v205, v205
v_exp_f32 v207, v207
v_add_f32 v248, v248, v205
v_add_f32 v248, v248, v206
v_add_f32 v248, v248, v207
v_cvt_pk_bf16_f32 v130, v204, v205
v_cvt_pk_bf16_f32 v131, v206, v207
v_mfma_f32_16x16x32_bf16 v[204:207], v[28:31], v[116:119], 0
v_sub_f32 v208, v208, v254
v_cvt_pk_bf16_f32 v120, v184, v185
v_mfma_f32_16x16x32_bf16 v[204:207], v[24:27], v[112:115], v[204:207]
v_exp_f32 v208, v208
s_nop 0
v_add_f32 v248, v248, v208
v_cvt_pk_bf16_f32 v132, v208, 0
v_mfma_f32_16x16x32_bf16 v[208:211], v[32:35], v[112:115], 0
ds_swizzle_b32 v250, v248 offset:0x401F
v_cvt_pk_bf16_f32 v121, v186, v187
v_mfma_f32_16x16x32_bf16 v[208:211], v[36:39], v[116:119], v[208:211]
ds_read_b128 v[184:187], v236 offset:256
v_cvt_pk_bf16_f32 v126, v196, v197
v_mfma_f32_16x16x32_bf16 v[212:215], v[44:47], v[116:119], 0
v_cvt_pk_bf16_f32 v125, v194, v195
v_cvt_pk_bf16_f32 v127, v198, v199
v_mfma_f32_16x16x32_bf16 v[212:215], v[40:43], v[112:115], v[212:215]
ds_read_b128 v[196:199], v236 offset:768
v_cvt_pk_bf16_f32 v124, v192, v193
v_mfma_f32_16x16x32_bf16 v[216:219], v[48:51], v[112:115], 0
ds_read_b128 v[192:195], v236 offset:512
v_max3_f32 v254, v228, v229, v230
v_mfma_f32_16x16x32_bf16 v[216:219], v[52:55], v[116:119], v[216:219]
v_max3_f32 v254, v254, v231, v188
v_max3_f32 v254, v254, v189, v190
v_mfma_f32_16x16x32_bf16 v[220:223], v[56:59], v[120:123], 0
s_waitcnt lgkmcnt(3)
v_add_f32 v248, v248, v250
v_max3_f32 v254, v254, v191, v200
v_mfma_f32_16x16x32_bf16 v[220:223], v[104:107], v[132:135], v[220:223]
s_waitcnt lgkmcnt(2)
ds_bpermute_b32 v250, v247, v248
v_mfma_f32_16x16x32_bf16 v[220:223], v[72:75], v[124:127], v[220:223]
v_max3_f32 v254, v254, v201, v202
v_max3_f32 v254, v254, v203, v204
v_mfma_f32_16x16x32_bf16 v[220:223], v[88:91], v[128:131], v[220:223]
s_waitcnt lgkmcnt(2)
v_max3_f32 v254, v254, v205, v206
v_max3_f32 v254, v254, v207, v208
v_mfma_f32_16x16x32_bf16 v[224:227], v[92:95], v[128:131], 0
s_waitcnt lgkmcnt(1)
v_max3_f32 v254, v254, v209, v210
v_max3_f32 v254, v254, v211, v212
v_mfma_f32_16x16x32_bf16 v[224:227], v[76:79], v[124:127], v[224:227]
v_max3_f32 v254, v254, v213, v214
v_max3_f32 v254, v254, v215, v216
v_mfma_f32_16x16x32_bf16 v[224:227], v[106:109], v[132:135], v[224:227]
ds_swizzle_b32 v255, v254 offset:0x401F
v_mbcnt_lo_u32_b32 v242, -1, 0
v_mfma_f32_16x16x32_bf16 v[224:227], v[60:63], v[120:123], v[224:227]
s_waitcnt lgkmcnt(1)
v_add_f32 v248, v248, v250
v_rcp_f32 v251, v248
s_nop 0
v_fmac_f32 v152, v220, v251
v_fmac_f32 v153, v221, v251
v_fmac_f32 v154, v222, v251
v_fmac_f32 v155, v223, v251
v_mfma_f32_16x16x32_bf16 v[220:223], v[64:67], v[120:123], 0
v_fmac_f32 v156, v224, v251
v_fmac_f32 v157, v225, v251
v_mfma_f32_16x16x32_bf16 v[220:223], v[108:111], v[132:135], v[220:223]
v_fmac_f32 v158, v226, v251
v_fmac_f32 v159, v227, v251
v_mfma_f32_16x16x32_bf16 v[220:223], v[80:83], v[124:127], v[220:223]
s_waitcnt lgkmcnt(0)
v_cvt_pk_bf16_f32 v152, v152, v153
v_cvt_pk_bf16_f32 v153, v154, v155
v_mfma_f32_16x16x32_bf16 v[220:223], v[96:99], v[128:131], v[220:223]
v_cvt_pk_bf16_f32 v154, v156, v157
v_cvt_pk_bf16_f32 v155, v158, v159
v_mfma_f32_16x16x32_bf16 v[224:227], v[100:103], v[128:131], 0
v_pk_max_i16 v152, v152, 0
v_pk_max_i16 v153, v153, 0
v_mfma_f32_16x16x32_bf16 v[224:227], v[84:87], v[124:127], v[224:227]
v_max_f32 v254, v254, v255
v_pk_max_i16 v154, v154, 0
v_mfma_f32_16x16x32_bf16 v[224:227], v[110:113], v[132:135], v[224:227]
ds_bpermute_b32 v255, v247, v254
v_mfma_f32_16x16x32_bf16 v[224:227], v[68:71], v[120:123], v[224:227]
v_fmac_f32 v160, v220, v251
v_fmac_f32 v161, v221, v251
v_mfma_f32_16x16x32_bf16 v[0:3], a[192:195], v[232:235], 0
v_fmac_f32 v162, v222, v251
v_fmac_f32 v163, v223, v251
v_mfma_f32_16x16x32_bf16 v[0:3], a[196:199], v[184:187], v[0:3]
v_cvt_pk_bf16_f32 v160, v160, v161
v_cvt_pk_bf16_f32 v161, v162, v163
v_mfma_f32_16x16x32_bf16 v[0:3], a[200:203], v[192:195], v[0:3]
v_fmac_f32 v164, v224, v251
v_fmac_f32 v165, v225, v251
v_mfma_f32_16x16x32_bf16 v[0:3], a[204:207], v[196:199], v[0:3]
v_fmac_f32 v166, v226, v251
v_fmac_f32 v167, v227, v251
v_mfma_f32_16x16x32_bf16 v[4:7], a[220:223], v[196:199], 0
s_waitcnt lgkmcnt(0)
v_max_f32 v254, v254, v255
v_sub_f32 v228, v228, v254
v_mfma_f32_16x16x32_bf16 v[4:7], a[216:219], v[192:195], v[4:7]
v_sub_f32 v229, v229, v254
v_sub_f32 v230, v230, v254
v_mfma_f32_16x16x32_bf16 v[4:7], a[212:215], v[184:187], v[4:7]
v_exp_f32 v228, v228
v_mfma_f32_16x16x32_bf16 v[4:7], a[208:211], v[232:235], v[4:7]
ds_read_b128 v[220:223], v236 offset:4224
v_sub_f32 v231, v231, v254
v_mfma_f32_16x16x32_bf16 v[8:11], a[224:227], v[232:235], 0
v_exp_f32 v229, v229
v_mfma_f32_16x16x32_bf16 v[8:11], a[228:231], v[184:187], v[8:11]
v_exp_f32 v230, v230
v_mfma_f32_16x16x32_bf16 v[8:11], a[232:235], v[192:195], v[8:11]
v_exp_f32 v231, v231
v_mfma_f32_16x16x32_bf16 v[8:11], a[236:239], v[196:199], v[8:11]
v_add_f32 v249, v228, v229
v_add_f32 v249, v249, v230
v_mfma_f32_16x16x32_bf16 v[12:15], a[252:255], v[196:199], 0
ds_read_b128 v[196:199], v236 offset:4736
v_add_f32 v249, v249, v231
v_mfma_f32_16x16x32_bf16 v[12:15], a[248:251], v[192:195], v[12:15]
s_waitcnt lgkmcnt(1)
ds_read_b128 v[192:195], v236 offset:4992
v_cvt_pk_bf16_f32 v136, v228, v229
v_mfma_f32_16x16x32_bf16 v[12:15], a[244:247], v[184:187], v[12:15]
v_cvt_pk_bf16_f32 v137, v230, v231
v_sub_f32 v188, v188, v254
v_mfma_f32_16x16x32_bf16 v[12:15], a[240:243], v[232:235], v[12:15]
ds_read_b128 v[228:231], v236 offset:4480
v_sub_f32 v189, v189, v254
v_mfma_f32_16x16x32_bf16 v[16:19], a[192:195], v[220:223], 0
v_exp_f32 v188, v188
v_exp_f32 v189, v189
v_sub_f32 v190, v190, v254
v_cvt_pk_bf16_f32 v138, v188, v189
v_sub_f32 v191, v191, v254
v_exp_f32 v190, v190
v_exp_f32 v191, v191
v_sub_f32 v216, v216, v254
v_cvt_pk_bf16_f32 v139, v190, v191
v_exp_f32 v216, v216
v_sub_f32 v200, v200, v254
v_cvt_pk_bf16_f32 v148, v216, 0
s_waitcnt lgkmcnt(0)
v_mfma_f32_16x16x32_bf16 v[16:19], a[196:199], v[228:231], v[16:19]
v_sub_f32 v201, v201, v254
v_sub_f32 v202, v202, v254
v_mfma_f32_16x16x32_bf16 v[16:19], a[200:203], v[196:199], v[16:19]
v_exp_f32 v200, v200
v_mfma_f32_16x16x32_bf16 v[16:19], a[204:207], v[192:195], v[16:19]
v_exp_f32 v201, v201
v_mfma_f32_16x16x32_bf16 v[20:23], a[220:223], v[192:195], 0
v_exp_f32 v202, v202
v_mfma_f32_16x16x32_bf16 v[20:23], a[216:219], v[196:199], v[20:23]
v_sub_f32 v203, v203, v254
v_sub_f32 v204, v204, v254
v_mfma_f32_16x16x32_bf16 v[20:23], a[212:215], v[228:231], v[20:23]
v_exp_f32 v203, v203
v_mfma_f32_16x16x32_bf16 v[20:23], a[208:211], v[220:223], v[20:23]
v_exp_f32 v204, v204
v_mfma_f32_16x16x32_bf16 v[24:27], a[224:227], v[220:223], 0
v_sub_f32 v205, v205, v254
v_sub_f32 v206, v206, v254
v_mfma_f32_16x16x32_bf16 v[24:27], a[228:231], v[228:231], v[24:27]
v_exp_f32 v205, v205
v_mfma_f32_16x16x32_bf16 v[24:27], a[232:235], v[196:199], v[24:27]
v_exp_f32 v206, v206
v_mfma_f32_16x16x32_bf16 v[24:27], a[236:239], v[192:195], v[24:27]
v_sub_f32 v207, v207, v254
v_cvt_pk_bf16_f32 v140, v200, v201
v_mfma_f32_16x16x32_bf16 v[28:31], a[252:255], v[192:195], 0
v_exp_f32 v207, v207
v_mfma_f32_16x16x32_bf16 v[28:31], a[248:251], v[196:199], v[28:31]
v_cvt_pk_bf16_f32 v141, v202, v203
v_cvt_pk_bf16_f32 v142, v204, v205
v_mfma_f32_16x16x32_bf16 v[28:31], a[244:247], v[228:231], v[28:31]
v_cvt_pk_bf16_f32 v143, v206, v207
v_sub_f32 v208, v208, v254
v_mfma_f32_16x16x32_bf16 v[28:31], a[240:243], v[220:223], v[28:31]
v_sub_f32 v209, v209, v254
v_sub_f32 v210, v210, v254
v_mfma_f32_16x16x32_bf16 v[228:231], v[56:59], v[136:139], 0
v_exp_f32 v208, v208
v_mfma_f32_16x16x32_bf16 v[228:231], v[104:107], v[148:151], v[228:231]
v_exp_f32 v209, v209
v_mfma_f32_16x16x32_bf16 v[228:231], v[72:75], v[140:143], v[228:231]
v_exp_f32 v210, v210
v_sub_f32 v211, v211, v254
v_exp_f32 v211, v211
v_sub_f32 v212, v212, v254
v_exp_f32 v212, v212
v_sub_f32 v213, v213, v254
v_exp_f32 v213, v213
v_sub_f32 v214, v214, v254
v_exp_f32 v214, v214
v_sub_f32 v215, v215, v254
v_exp_f32 v215, v215
v_cvt_pk_bf16_f32 v144, v208, v209
v_cvt_pk_bf16_f32 v145, v210, v211
v_cvt_pk_bf16_f32 v146, v212, v213
v_cvt_pk_bf16_f32 v147, v214, v215
v_cvt_pk_bf16_f32 v162, v164, v165
v_cvt_pk_bf16_f32 v163, v166, v167
v_mfma_f32_16x16x32_bf16 v[228:231], v[88:91], v[144:147], v[228:231]
v_pk_max_i16 v155, v155, 0
v_pk_max_i16 v160, v160, 0
v_mfma_f32_16x16x32_bf16 v[192:195], v[92:95], v[144:147], 0
v_pk_max_i16 v161, v161, 0
v_pk_max_i16 v162, v162, 0
v_mfma_f32_16x16x32_bf16 v[192:195], v[76:79], v[140:143], v[192:195]
v_pk_max_i16 v163, v163, 0
v_mbcnt_hi_u32_b32 v242, -1, v242
v_mfma_f32_16x16x32_bf16 v[192:195], v[106:109], v[148:151], v[192:195]
buffer_store_dwordx4 v[152:155], v239, s[20:23], s52 offen offset:0 nt
buffer_store_dwordx4 v[160:163], v239, s[20:23], s52 offen offset:64 nt
s_mul_i32 s54, s41, 12288
s_add_u32 s54, s54, 105472
v_mov_b32 v244, s54
v_bfe_u32 v243, v242, 0, 4
v_lshl_add_u32 v244, v243, 7, v244
v_lshlrev_b32 v243, 4, v242
v_xor_b32 v243, v243, v242
v_and_b32 v243, 48, v243
v_mfma_f32_16x16x32_bf16 v[192:195], v[60:63], v[136:139], v[192:195]
v_add_u32 v244, v243, v244
v_add_u32 v244, v243, v244
v_mfma_f32_16x16x32_bf16 v[220:223], v[64:67], v[136:139], 0
ds_read_b128 v[184:187], v244 offset:0
ds_read_b128 v[232:235], v244 offset:16
v_mfma_f32_16x16x32_bf16 v[220:223], v[108:111], v[148:151], v[220:223]
ds_read_b128 v[196:199], v244 offset:2048
v_add_f32 v249, v249, v188
v_mfma_f32_16x16x32_bf16 v[220:223], v[80:83], v[140:143], v[220:223]
ds_read_b32 v188, v244 offset:4096
v_add_f32 v249, v249, v189
v_mfma_f32_16x16x32_bf16 v[220:223], v[96:99], v[144:147], v[220:223]
v_add_f32 v249, v249, v190
v_add_f32 v249, v249, v191
v_mfma_f32_16x16x32_bf16 v[224:227], v[100:103], v[144:147], 0
v_mov_b32 v245, 24576
v_bfe_u32 v243, v242, 0, 2
v_mfma_f32_16x16x32_bf16 v[224:227], v[84:87], v[140:143], v[224:227]
v_lshl_add_u32 v245, v243, 8, v245
v_bfe_u32 v243, v242, 2, 2
v_mfma_f32_16x16x32_bf16 v[224:227], v[110:113], v[148:151], v[224:227]
s_waitcnt lgkmcnt(2)
v_lshlrev_b32 v190, 16, v184
v_lshlrev_b32 v191, 16, v185
v_mfma_f32_16x16x32_bf16 v[224:227], v[68:71], v[136:139], v[224:227]
s_waitcnt lgkmcnt(1)
s_waitcnt lgkmcnt(0)
ds_swizzle_b32 v189, v188 offset:0x401F
v_and_b32 v184, 0xffff0000, v184
v_and_b32 v185, 0xffff0000, v185
v_mul_u32_u24 v243, 13107200, v243
v_add_u32 v245, v243, v245
s_lshl_b32 s48, s43, 7
s_add_u32 s48, s48, s44
s_add_u32 s48, s48, 0
v_bfe_u32 v243, v242, 4, 2
v_lshl_add_u32 v245, v243, 4, v245
v_add_f32 v249, v249, v200
v_add_f32 v249, v249, v201
v_add_f32 v249, v249, v202
v_add_f32 v249, v249, v203
ds_read_b128 v[200:203], v244 offset:2064
v_add_f32 v249, v249, v204
ds_read_b32 v204, v244 offset:6144
v_add_f32 v249, v249, v205
v_add_f32 v249, v249, v206
v_add_f32 v249, v249, v207
v_add_f32 v249, v249, v208
v_add_f32 v249, v249, v209
v_add_f32 v249, v249, v210
v_add_f32 v249, v249, v211
v_add_f32 v249, v249, v212
v_add_f32 v249, v249, v213
v_add_f32 v249, v249, v214
v_add_f32 v249, v249, v215
v_add_f32 v249, v249, v216
ds_swizzle_b32 v250, v249 offset:0x401F
v_lshlrev_b32 v206, 16, v196
v_lshlrev_b32 v207, 16, v197
v_and_b32 v196, 0xffff0000, v196
v_and_b32 v197, 0xffff0000, v197
s_waitcnt lgkmcnt(1)
ds_swizzle_b32 v205, v204 offset:0x401F
v_add_f32 v188, v188, v189
ds_bpermute_b32 v189, v247, v188
s_lshl_b32 s51, s43, 7
s_add_u32 s51, s51, s44
s_add_u32 s51, s51, 52428800
s_waitcnt lgkmcnt(2)
v_add_f32 v249, v249, v250
ds_bpermute_b32 v250, v247, v249
s_waitcnt lgkmcnt(2)
v_add_f32 v204, v204, v205
ds_bpermute_b32 v205, v247, v204
s_waitcnt lgkmcnt(2)
v_add_f32 v188, v188, v189
v_rcp_f32 v189, v188
s_nop 0
v_fmac_f32 v0, v190, v189
v_fmac_f32 v2, v191, v189
v_lshlrev_b32 v190, 16, v186
v_lshlrev_b32 v191, 16, v187
v_fmac_f32 v4, v190, v189
v_fmac_f32 v6, v191, v189
v_lshlrev_b32 v190, 16, v232
v_lshlrev_b32 v191, 16, v233
v_and_b32 v232, 0xffff0000, v232
v_fmac_f32 v8, v190, v189
v_fmac_f32 v10, v191, v189
v_fmac_f32 v1, v184, v189
v_fmac_f32 v9, v232, v189
v_and_b32 v233, 0xffff0000, v233
v_lshlrev_b32 v190, 16, v234
v_lshlrev_b32 v191, 16, v235
v_fmac_f32 v3, v185, v189
v_and_b32 v186, 0xffff0000, v186
v_and_b32 v187, 0xffff0000, v187
v_fmac_f32 v11, v233, v189
v_and_b32 v234, 0xffff0000, v234
v_and_b32 v235, 0xffff0000, v235
v_cvt_pk_bf16_f32 v0, v0, v1
v_cvt_pk_bf16_f32 v8, v8, v9
v_fmac_f32 v5, v186, v189
v_fmac_f32 v7, v187, v189
v_fmac_f32 v12, v190, v189
v_fmac_f32 v13, v234, v189
v_fmac_f32 v14, v191, v189
v_fmac_f32 v15, v235, v189
v_cvt_pk_bf16_f32 v1, v2, v3
v_cvt_pk_bf16_f32 v9, v10, v11
v_cvt_pk_bf16_f32 v2, v4, v5
v_cvt_pk_bf16_f32 v3, v6, v7
v_cvt_pk_bf16_f32 v10, v12, v13
v_cvt_pk_bf16_f32 v11, v14, v15
v_pk_max_i16 v0, v0, 0
v_pk_max_i16 v1, v1, 0
v_pk_max_i16 v2, v2, 0
v_pk_max_i16 v3, v3, 0
v_pk_max_i16 v8, v8, 0
v_pk_max_i16 v9, v9, 0
v_pk_max_i16 v10, v10, 0
v_pk_max_i16 v11, v11, 0
buffer_store_dwordx4 v[0:3], v245, s[20:23], s48 offen offset:0 nt
buffer_store_dwordx4 v[8:11], v245, s[20:23], s48 offen offset:64 nt
s_waitcnt lgkmcnt(1)
v_add_f32 v249, v249, v250
v_rcp_f32 v252, v249
s_nop 0
v_fmac_f32 v168, v228, v252
v_fmac_f32 v169, v229, v252
v_fmac_f32 v176, v220, v252
v_fmac_f32 v177, v221, v252
v_fmac_f32 v170, v230, v252
v_fmac_f32 v171, v231, v252
v_cvt_pk_bf16_f32 v168, v168, v169
v_fmac_f32 v178, v222, v252
v_fmac_f32 v179, v223, v252
v_cvt_pk_bf16_f32 v176, v176, v177
v_fmac_f32 v172, v192, v252
v_fmac_f32 v173, v193, v252
v_fmac_f32 v174, v194, v252
v_fmac_f32 v175, v195, v252
v_cvt_pk_bf16_f32 v169, v170, v171
v_fmac_f32 v180, v224, v252
v_fmac_f32 v181, v225, v252
v_fmac_f32 v182, v226, v252
v_fmac_f32 v183, v227, v252
v_cvt_pk_bf16_f32 v177, v178, v179
v_cvt_pk_bf16_f32 v170, v172, v173
v_cvt_pk_bf16_f32 v171, v174, v175
v_cvt_pk_bf16_f32 v178, v180, v181
v_cvt_pk_bf16_f32 v179, v182, v183
v_pk_max_i16 v168, v168, 0
v_pk_max_i16 v169, v169, 0
v_pk_max_i16 v170, v170, 0
v_pk_max_i16 v171, v171, 0
v_pk_max_i16 v176, v176, 0
v_pk_max_i16 v177, v177, 0
v_pk_max_i16 v178, v178, 0
v_pk_max_i16 v179, v179, 0
buffer_store_dwordx4 v[168:171], v239, s[20:23], s53 offen offset:0 nt
buffer_store_dwordx4 v[176:179], v239, s[20:23], s53 offen offset:64 nt
s_waitcnt lgkmcnt(0)
v_add_f32 v204, v204, v205
v_rcp_f32 v205, v204
s_nop 0
v_fmac_f32 v16, v206, v205
v_fmac_f32 v18, v207, v205
v_lshlrev_b32 v206, 16, v198
v_lshlrev_b32 v207, 16, v199
v_fmac_f32 v20, v206, v205
v_fmac_f32 v22, v207, v205
v_lshlrev_b32 v206, 16, v200
v_lshlrev_b32 v207, 16, v201
v_and_b32 v200, 0xffff0000, v200
v_fmac_f32 v24, v206, v205
v_fmac_f32 v26, v207, v205
v_fmac_f32 v17, v196, v205
v_fmac_f32 v25, v200, v205
v_and_b32 v201, 0xffff0000, v201
v_lshlrev_b32 v206, 16, v202
v_lshlrev_b32 v207, 16, v203
v_fmac_f32 v19, v197, v205
v_and_b32 v198, 0xffff0000, v198
v_and_b32 v199, 0xffff0000, v199
v_fmac_f32 v27, v201, v205
v_and_b32 v202, 0xffff0000, v202
v_and_b32 v203, 0xffff0000, v203
v_cvt_pk_bf16_f32 v16, v16, v17
v_cvt_pk_bf16_f32 v24, v24, v25
v_fmac_f32 v21, v198, v205
v_fmac_f32 v23, v199, v205
v_fmac_f32 v28, v206, v205
v_fmac_f32 v29, v202, v205
v_fmac_f32 v30, v207, v205
v_fmac_f32 v31, v203, v205
v_cvt_pk_bf16_f32 v17, v18, v19
v_cvt_pk_bf16_f32 v25, v26, v27
v_cvt_pk_bf16_f32 v18, v20, v21
v_cvt_pk_bf16_f32 v19, v22, v23
v_cvt_pk_bf16_f32 v26, v28, v29
v_cvt_pk_bf16_f32 v27, v30, v31
v_pk_max_i16 v16, v16, 0
v_pk_max_i16 v17, v17, 0
v_pk_max_i16 v18, v18, 0
v_pk_max_i16 v19, v19, 0
v_pk_max_i16 v24, v24, 0
v_pk_max_i16 v25, v25, 0
v_pk_max_i16 v26, v26, 0
v_pk_max_i16 v27, v27, 0
buffer_store_dwordx4 v[16:19], v245, s[20:23], s51 offen offset:0 nt
buffer_store_dwordx4 v[24:27], v245, s[20:23], s51 offen offset:64 nt
L_end:
s_endpgm
.section .rodata,"a"
.p2align 6
.amdhsa_kernel standalone__attention_interact_autoint__recsys_kernel
  .amdhsa_next_free_vgpr 512
  .amdhsa_next_free_sgpr 102
  .amdhsa_accum_offset 256
  .amdhsa_group_segment_fixed_size 0
  .amdhsa_kernarg_size 64
  .amdhsa_user_sgpr_count 2
  .amdhsa_user_sgpr_kernarg_segment_ptr 1
  .amdhsa_system_sgpr_workgroup_id_x 1
.end_amdhsa_kernel
```

```asm
; @launch grid=(256,1,1) block=(256,1,1) lds=163840
.amdgcn_target "amdgcn-amd-amdhsa--gfx950"
.text
.globl standalone__attention_interact_autoint__recsys_kernel
.p2align 8
.type standalone__attention_interact_autoint__recsys_kernel,@function
standalone__attention_interact_autoint__recsys_kernel:
s_cmp_ge_u32 s2, 256
s_cbranch_scc1 L_end
s_load_dwordx2 s[24:25], s[0:1], 8
s_load_dwordx2 s[16:17], s[0:1], 0
s_load_dwordx2 s[28:29], s[0:1], 16
s_load_dwordx2 s[32:33], s[0:1], 24
s_load_dwordx2 s[36:37], s[0:1], 32
s_load_dwordx2 s[20:21], s[0:1], 40
s_getpc_b64 s[58:59]
L_pc:
s_lshl_b32 s3, s2, 9
s_and_b32 s3, s3, 0x7000
v_lshrrev_b32 v2, 3, v0
v_lshl_add_u32 v2, v2, 7, s3
v_min_u32 v2, L_fast_end-L_pc-4, v2
global_load_dword v104, v2, s[58:59]
v_lshrrev_b32 v1, 6, v0
s_mov_b32 s19, 0x20000
v_readfirstlane_b32 s41, v1
s_mov_b32 s18, 104857600
s_mov_b32 s26, 32768
s_mov_b32 s27, s19
s_lshr_b32 s42, s41, 1
s_and_b32 s43, s41, 1
s_lshl1_add_u32 s44, s2, s42
s_mul_i32 s44, s44, 25600
s_lshl_b32 s54, s41, 13
s_mul_i32 s49, s42, 25344
s_mul_i32 s53, s43, 1056
s_add_u32 s49, s49, s53
s_lshl_b32 s55, s43, 10
s_add_u32 s55, s55, s44
s_add_u32 s57, s54, 4096
s_add_u32 m0, s49, 21120
s_add_u32 s48, s55, 20480
v_and_b32 v176, 63, v0
v_lshlrev_b32 v183, 4, v176
v_and_b32 v241, 48, v183
v_and_b32 v177, 48, v176
v_lshl_add_u32 v241, v177, 2, v241
v_and_b32 v177, 12, v176
v_lshl_add_u32 v241, v177, 6, v241
s_waitcnt lgkmcnt(0)
buffer_load_dwordx4 v[112:115], v183, s[24:27], s54 offen offset:0
buffer_load_dwordx4 v[116:119], v183, s[24:27], s54 offen offset:1024
buffer_load_dwordx4 v[120:123], v183, s[24:27], s54 offen offset:2048
buffer_load_dwordx4 v[124:127], v183, s[24:27], s54 offen offset:3072
buffer_load_dwordx4 v[128:131], v183, s[24:27], s57 offen offset:0
buffer_load_dwordx4 v[132:135], v183, s[24:27], s57 offen offset:1024
buffer_load_dwordx4 v[136:139], v183, s[24:27], s57 offen offset:2048
buffer_load_dwordx4 v[140:143], v183, s[24:27], s57 offen offset:3072
buffer_load_dwordx4 v241, s[16:19], s48 offen nt lds
s_add_u32 m0, s49, 23232
s_add_u32 s48, s55, 22528
buffer_load_dwordx4 v241, s[16:19], s48 offen nt lds
s_add_u32 m0, s49, 0
s_add_u32 s48, s55, 0
buffer_load_dwordx4 v241, s[16:19], s48 offen nt lds
s_add_u32 m0, s49, 2112
s_add_u32 s48, s55, 2048
buffer_load_dwordx4 v241, s[16:19], s48 offen nt lds
s_mov_b32 s40, 0x3e38aa3b
s_mov_b32 s22, s18
s_mov_b32 s23, s19
s_mov_b32 s30, s26
s_mov_b32 s31, s19
s_mov_b32 s34, s26
s_mov_b32 s35, s19
s_mov_b32 s38, s26
s_mov_b32 s39, s19
s_mov_b32 s45, 8
s_mov_b32 s3, 64
s_mov_b32 s46, s44
s_mov_b32 s47, 0x7ff00000
s_mov_b32 s56, 50688
s_mov_b32 s96, 0x3b8265d9
s_mov_b32 s97, 0
s_mul_i32 s98, s42, 25344
s_lshl_b32 s53, s43, 13
s_add_u32 s98, s98, s53
s_add_u32 s53, s98, 4224
s_add_u32 m0, s98, 101376
v_and_b32 v177, 16, v176
v_lshlrev_b32 v188, 2, v177
v_lshlrev_b32 v177, 1, v177
v_xor_b32 v178, v183, v177
v_add_u32 v180, s53, v178
v_xor_b32 v179, 64, v178
v_add_u32 v181, s53, v179
s_mul_i32 s4, s43, 13107200
s_add_u32 s4, s4, s44
s_add_u32 s4, s4, 24576
s_mul_i32 s5, s43, -52424704
s_add_u32 s5, s5, 104833024
s_add_u32 s99, s4, 0
s_add_u32 s100, s4, 26212288
s_mul_i32 s53, s43, 25344
s_add_u32 s7, s53, 4224
v_lshrrev_b32 v82, 4, v176
v_lshl_add_u32 v184, v82, 10, s7
v_bfe_u32 v83, v176, 2, 2
v_lshl_add_u32 v184, v83, 7, v184
v_bfe_u32 v84, v176, 3, 1
v_lshl_add_u32 v184, v84, 5, v184
v_bfe_u32 v85, v176, 4, 1
v_lshl_add_u32 v184, v85, 6, v184
v_and_b32 v86, 3, v176
v_lshl_add_u32 v184, v86, 3, v184
v_xor_b32 v185, 32, v184
v_xor_b32 v186, 64, v184
s_mul_i32 s53, s42, 25344
v_lshl_add_u32 v240, v86, 6, s53
v_lshl_add_u32 v240, v82, 4, v240
s_mov_b32 s6, 1056
v_mad_u32_u24 v240, v83, s6, v240
s_waitcnt vmcnt(11)
v_and_b32 v168, 0xffff0000, v112
v_and_b32 v169, 0xffff0000, v113
v_and_b32 v170, 0xffff0000, v114
v_and_b32 v171, 0xffff0000, v115
v_lshlrev_b32 v112, 16, v112
v_lshlrev_b32 v113, 16, v113
v_lshlrev_b32 v114, 16, v114
v_lshlrev_b32 v115, 16, v115
v_mul_f32 v168, s40, v168
v_mul_f32 v112, s40, v112
v_mul_f32 v169, s40, v169
v_mul_f32 v113, s40, v113
v_mul_f32 v170, s40, v170
v_mul_f32 v114, s40, v114
v_mul_f32 v171, s40, v171
v_mul_f32 v115, s40, v115
v_cvt_pk_bf16_f32 v112, v112, v168
v_cvt_pk_bf16_f32 v113, v113, v169
v_cvt_pk_bf16_f32 v114, v114, v170
v_cvt_pk_bf16_f32 v115, v115, v171
ds_write_b128 v180, v[112:115] offset:0
buffer_load_dwordx4 v178, s[28:31], s54 offen offset:0 lds
buffer_load_dwordx4 v179, s[28:31], s54 offen offset:1024 lds
buffer_load_dwordx4 v178, s[28:31], s54 offen offset:2048 lds
buffer_load_dwordx4 v179, s[28:31], s54 offen offset:3072 lds
s_add_u32 m0, s98, 105472
s_waitcnt vmcnt(14)
v_and_b32 v168, 0xffff0000, v116
v_and_b32 v169, 0xffff0000, v117
v_and_b32 v170, 0xffff0000, v118
v_and_b32 v171, 0xffff0000, v119
v_lshlrev_b32 v116, 16, v116
v_lshlrev_b32 v117, 16, v117
v_lshlrev_b32 v118, 16, v118
v_lshlrev_b32 v119, 16, v119
v_mul_f32 v168, s40, v168
v_mul_f32 v116, s40, v116
v_mul_f32 v169, s40, v169
v_mul_f32 v117, s40, v117
v_mul_f32 v170, s40, v170
v_mul_f32 v118, s40, v118
v_mul_f32 v171, s40, v171
v_mul_f32 v119, s40, v119
v_cvt_pk_bf16_f32 v116, v116, v168
v_cvt_pk_bf16_f32 v117, v117, v169
v_cvt_pk_bf16_f32 v118, v118, v170
v_cvt_pk_bf16_f32 v119, v119, v171
ds_write_b128 v181, v[116:119] offset:1024
buffer_load_dwordx4 v178, s[28:31], s57 offen offset:0 lds
buffer_load_dwordx4 v179, s[28:31], s57 offen offset:1024 lds
buffer_load_dwordx4 v178, s[28:31], s57 offen offset:2048 lds
buffer_load_dwordx4 v179, s[28:31], s57 offen offset:3072 lds
s_add_u32 m0, s49, 50688
s_waitcnt vmcnt(17)
v_and_b32 v168, 0xffff0000, v120
v_and_b32 v169, 0xffff0000, v121
v_and_b32 v170, 0xffff0000, v122
v_and_b32 v171, 0xffff0000, v123
v_lshlrev_b32 v120, 16, v120
v_lshlrev_b32 v121, 16, v121
v_lshlrev_b32 v122, 16, v122
v_lshlrev_b32 v123, 16, v123
v_mul_f32 v168, s40, v168
v_mul_f32 v120, s40, v120
v_mul_f32 v169, s40, v169
v_mul_f32 v121, s40, v121
v_mul_f32 v170, s40, v170
v_mul_f32 v122, s40, v122
v_mul_f32 v171, s40, v171
v_mul_f32 v123, s40, v123
v_cvt_pk_bf16_f32 v120, v120, v168
v_cvt_pk_bf16_f32 v121, v121, v169
v_cvt_pk_bf16_f32 v122, v122, v170
v_cvt_pk_bf16_f32 v123, v123, v171
ds_write_b128 v180, v[120:123] offset:2048
s_waitcnt vmcnt(16)
v_and_b32 v168, 0xffff0000, v124
v_and_b32 v169, 0xffff0000, v125
v_and_b32 v170, 0xffff0000, v126
v_and_b32 v171, 0xffff0000, v127
v_lshlrev_b32 v124, 16, v124
v_lshlrev_b32 v125, 16, v125
v_lshlrev_b32 v126, 16, v126
v_lshlrev_b32 v127, 16, v127
v_mul_f32 v168, s40, v168
v_mul_f32 v124, s40, v124
v_mul_f32 v169, s40, v169
v_mul_f32 v125, s40, v125
v_mul_f32 v170, s40, v170
v_mul_f32 v126, s40, v126
v_mul_f32 v171, s40, v171
v_mul_f32 v127, s40, v127
v_cvt_pk_bf16_f32 v124, v124, v168
v_cvt_pk_bf16_f32 v125, v125, v169
v_cvt_pk_bf16_f32 v126, v126, v170
v_cvt_pk_bf16_f32 v127, v127, v171
ds_write_b128 v181, v[124:127] offset:3072
s_waitcnt vmcnt(15)
v_and_b32 v168, 0xffff0000, v128
v_and_b32 v169, 0xffff0000, v129
v_and_b32 v170, 0xffff0000, v130
v_and_b32 v171, 0xffff0000, v131
v_lshlrev_b32 v128, 16, v128
v_lshlrev_b32 v129, 16, v129
v_lshlrev_b32 v130, 16, v130
v_lshlrev_b32 v131, 16, v131
v_mul_f32 v168, s40, v168
v_mul_f32 v128, s40, v128
v_mul_f32 v169, s40, v169
v_mul_f32 v129, s40, v129
v_mul_f32 v170, s40, v170
v_mul_f32 v130, s40, v130
v_mul_f32 v171, s40, v171
v_mul_f32 v131, s40, v131
v_cvt_pk_bf16_f32 v128, v128, v168
v_cvt_pk_bf16_f32 v129, v129, v169
v_cvt_pk_bf16_f32 v130, v130, v170
v_cvt_pk_bf16_f32 v131, v131, v171
ds_write_b128 v180, v[128:131] offset:4096
s_waitcnt vmcnt(14)
v_and_b32 v168, 0xffff0000, v132
v_and_b32 v169, 0xffff0000, v133
v_and_b32 v170, 0xffff0000, v134
v_and_b32 v171, 0xffff0000, v135
v_lshlrev_b32 v132, 16, v132
v_lshlrev_b32 v133, 16, v133
v_lshlrev_b32 v134, 16, v134
v_lshlrev_b32 v135, 16, v135
v_mul_f32 v168, s40, v168
v_mul_f32 v132, s40, v132
v_mul_f32 v169, s40, v169
v_mul_f32 v133, s40, v133
v_mul_f32 v170, s40, v170
v_mul_f32 v134, s40, v134
v_mul_f32 v171, s40, v171
v_mul_f32 v135, s40, v135
v_cvt_pk_bf16_f32 v132, v132, v168
v_cvt_pk_bf16_f32 v133, v133, v169
v_cvt_pk_bf16_f32 v134, v134, v170
v_cvt_pk_bf16_f32 v135, v135, v171
ds_write_b128 v181, v[132:135] offset:5120
s_waitcnt vmcnt(13)
v_and_b32 v168, 0xffff0000, v136
v_and_b32 v169, 0xffff0000, v137
v_and_b32 v170, 0xffff0000, v138
v_and_b32 v171, 0xffff0000, v139
v_lshlrev_b32 v136, 16, v136
v_lshlrev_b32 v137, 16, v137
v_lshlrev_b32 v138, 16, v138
v_lshlrev_b32 v139, 16, v139
v_mul_f32 v168, s40, v168
v_mul_f32 v136, s40, v136
v_mul_f32 v169, s40, v169
v_mul_f32 v137, s40, v137
v_mul_f32 v170, s40, v170
v_mul_f32 v138, s40, v138
v_mul_f32 v171, s40, v171
v_mul_f32 v139, s40, v139
v_cvt_pk_bf16_f32 v136, v136, v168
v_cvt_pk_bf16_f32 v137, v137, v169
v_cvt_pk_bf16_f32 v138, v138, v170
v_cvt_pk_bf16_f32 v139, v139, v171
ds_write_b128 v180, v[136:139] offset:6144
s_waitcnt vmcnt(12)
v_and_b32 v168, 0xffff0000, v140
v_and_b32 v169, 0xffff0000, v141
v_and_b32 v170, 0xffff0000, v142
v_and_b32 v171, 0xffff0000, v143
v_lshlrev_b32 v140, 16, v140
v_lshlrev_b32 v141, 16, v141
v_lshlrev_b32 v142, 16, v142
v_lshlrev_b32 v143, 16, v143
v_mul_f32 v168, s40, v168
v_mul_f32 v140, s40, v140
v_mul_f32 v169, s40, v169
v_mul_f32 v141, s40, v141
v_mul_f32 v170, s40, v170
v_mul_f32 v142, s40, v142
v_mul_f32 v171, s40, v171
v_mul_f32 v143, s40, v143
v_cvt_pk_bf16_f32 v140, v140, v168
v_cvt_pk_bf16_f32 v141, v141, v169
v_cvt_pk_bf16_f32 v142, v142, v170
v_cvt_pk_bf16_f32 v143, v143, v171
ds_write_b128 v181, v[140:143] offset:7168
buffer_load_dwordx4 v241, s[16:19], s99 offen offset:0 nt lds
buffer_load_dwordx4 v241, s[16:19], s100 offen offset:2112 nt lds
s_add_u32 m0, s49, 54912
s_add_u32 s99, s4, 52428800
buffer_load_dwordx4 v241, s[16:19], s99 offen offset:0 nt lds
s_add_u32 s100, s4, 78641088
buffer_load_dwordx4 v241, s[16:19], s100 offen offset:2112 nt lds
s_add_u32 m0, s98, 59648
s_add_u32 s99, s55, 4096
s_add_u32 s100, s55, 4032
s_waitcnt vmcnt(12) lgkmcnt(0)
s_barrier
ds_read_b64_tr_b16 a[4:5], v184 offset:4096
ds_read_b128 v[220:223], v240 offset:21376
ds_read_b64_tr_b16 a[6:7], v184 offset:4608
ds_read_b128 v[204:207], v240 offset:21632
ds_read_b64_tr_b16 a[8:9], v184 offset:8192
ds_read_b128 v[212:215], v240 offset:21888
ds_read_b64_tr_b16 a[10:11], v184 offset:8704
ds_read_b128 v[224:227], v240 offset:21120
ds_read_b64_tr_b16 a[12:13], v184 offset:12288
ds_read_b128 v[196:199], v240 offset:0
ds_read_b64_tr_b16 a[14:15], v184 offset:12800
ds_read_b128 v[200:203], v240 offset:256
ds_read_b64_tr_b16 a[0:1], v184 offset:0
ds_read_b128 v[208:211], v240 offset:512
ds_read_b64_tr_b16 a[2:3], v184 offset:512
ds_read_b128 v[216:219], v240 offset:768
ds_read_b64_tr_b16 a[16:17], v185 offset:0
ds_read_b64_tr_b16 a[18:19], v185 offset:512
ds_read_b64_tr_b16 a[20:21], v185 offset:4096
ds_read_b64_tr_b16 a[22:23], v185 offset:4608
ds_read_b64_tr_b16 a[24:25], v185 offset:8192
ds_read_b64_tr_b16 a[26:27], v185 offset:8704
ds_read_b64_tr_b16 a[28:29], v185 offset:12288
ds_read_b64_tr_b16 a[30:31], v185 offset:12800
ds_read_b64_tr_b16 a[32:33], v186 offset:0
ds_read_b64_tr_b16 a[34:35], v186 offset:512
ds_read_b64_tr_b16 a[36:37], v186 offset:4096
ds_read_b64_tr_b16 a[38:39], v186 offset:4608
s_waitcnt lgkmcnt(15)
v_mfma_f32_16x16x32_bf16 v[228:231], a[4:7], v[220:223], 0
s_mov_b32 s51, -32
ds_read_b64_tr_b16 a[40:41], v186 offset:8192
v_xor_b32 v187, 96, v184
v_mfma_f32_16x16x32_bf16 v[228:231], a[8:11], v[204:207], v[228:231]
s_waitcnt lgkmcnt(14)
ds_read_b64_tr_b16 a[42:43], v186 offset:8704
v_add_u32 v184, 97152, v184
v_mfma_f32_16x16x32_bf16 v[228:231], a[12:15], v[212:215], v[228:231]
ds_read_b64_tr_b16 a[44:45], v186 offset:12288
v_lshrrev_b32 v80, 3, v176
v_mfma_f32_16x16x32_bf16 v[228:231], a[0:3], v[224:227], v[228:231]
ds_read_b64_tr_b16 a[46:47], v186 offset:12800
v_lshlrev_b32 v182, 8, v80
v_mfma_f32_16x16x32_bf16 v[232:235], a[0:3], v[196:199], 0
ds_read_b64_tr_b16 a[48:49], v187 offset:0
v_and_b32 v81, 7, v176
v_mfma_f32_16x16x32_bf16 v[232:235], a[4:7], v[200:203], v[232:235]
s_waitcnt lgkmcnt(15)
ds_read_b64_tr_b16 a[50:51], v187 offset:512
v_cvt_pk_bf16_f32 v104, v228, v229
v_mfma_f32_16x16x32_bf16 v[232:235], a[8:11], v[208:211], v[232:235]
s_waitcnt lgkmcnt(10)
ds_read_b64_tr_b16 a[52:53], v187 offset:4096
v_cvt_pk_bf16_f32 v105, v230, v231
v_mfma_f32_16x16x32_bf16 v[232:235], a[12:15], v[216:219], v[232:235]
ds_read_b64_tr_b16 a[54:55], v187 offset:4608
v_lshl_add_u32 v182, v81, 4, v182
v_mfma_f32_16x16x32_bf16 v[228:231], a[28:31], v[216:219], 0
ds_read_b64_tr_b16 a[56:57], v187 offset:8192
v_xor_b32 v182, v182, v188
v_mfma_f32_16x16x32_bf16 v[228:231], a[24:27], v[208:211], v[228:231]
ds_read_b64_tr_b16 a[58:59], v187 offset:8704
v_xor_b32 v188, v183, v188
v_mfma_f32_16x16x32_bf16 v[228:231], a[20:23], v[200:203], v[228:231]
ds_read_b64_tr_b16 a[60:61], v187 offset:12288
v_cvt_pk_bf16_f32 v160, v232, v233
v_mfma_f32_16x16x32_bf16 v[228:231], a[16:19], v[196:199], v[228:231]
s_waitcnt lgkmcnt(13)
ds_read_b64_tr_b16 a[62:63], v187 offset:12800
v_cvt_pk_bf16_f32 v161, v234, v235
v_mfma_f32_16x16x32_bf16 v[232:235], a[16:19], v[224:227], 0
s_waitcnt vmcnt(4)
s_barrier
v_mfma_f32_16x16x32_bf16 v[232:235], a[28:31], v[212:215], v[232:235]
s_waitcnt lgkmcnt(10)
ds_read_b64_tr_b16 a[64:65], v184 offset:0
v_cvt_pk_bf16_f32 v162, v228, v229
v_mfma_f32_16x16x32_bf16 v[232:235], a[24:27], v[204:207], v[232:235]
s_waitcnt lgkmcnt(10)
ds_read_b64_tr_b16 a[66:67], v184 offset:512
v_cvt_pk_bf16_f32 v163, v230, v231
v_mfma_f32_16x16x32_bf16 v[232:235], a[20:23], v[220:223], v[232:235]
s_waitcnt lgkmcnt(10)
ds_read_b64_tr_b16 a[68:69], v184 offset:4096
v_add_u32 v185, 97152, v185
v_mfma_f32_16x16x32_bf16 v[228:231], a[36:39], v[220:223], 0
s_waitcnt lgkmcnt(10)
ds_read_b64_tr_b16 a[70:71], v184 offset:4608
v_add_u32 v186, 97152, v186
v_mfma_f32_16x16x32_bf16 v[228:231], a[40:43], v[204:207], v[228:231]
s_waitcnt lgkmcnt(10)
ds_read_b64_tr_b16 a[72:73], v184 offset:8192
v_cvt_pk_bf16_f32 v106, v232, v233
v_mfma_f32_16x16x32_bf16 v[228:231], a[44:47], v[212:215], v[228:231]
s_waitcnt lgkmcnt(10)
ds_read_b64_tr_b16 a[74:75], v184 offset:8704
v_cvt_pk_bf16_f32 v107, v234, v235
v_mfma_f32_16x16x32_bf16 v[228:231], a[32:35], v[224:227], v[228:231]
s_waitcnt lgkmcnt(10)
ds_read_b64_tr_b16 a[76:77], v184 offset:12288
v_add_u32 v187, 97152, v187
v_mfma_f32_16x16x32_bf16 v[232:235], a[32:35], v[196:199], 0
s_waitcnt lgkmcnt(10)
ds_read_b64_tr_b16 a[78:79], v184 offset:12800
v_and_b32 v88, 1, v176
v_mfma_f32_16x16x32_bf16 v[232:235], a[36:39], v[200:203], v[232:235]
s_waitcnt lgkmcnt(10)
ds_read_b64_tr_b16 a[80:81], v185 offset:0
v_cvt_pk_bf16_f32 v108, v228, v229
v_mfma_f32_16x16x32_bf16 v[232:235], a[40:43], v[208:211], v[232:235]
s_waitcnt lgkmcnt(9)
ds_read_b64_tr_b16 a[82:83], v185 offset:512
v_cvt_pk_bf16_f32 v109, v230, v231
v_mfma_f32_16x16x32_bf16 v[232:235], a[44:47], v[216:219], v[232:235]
buffer_load_dwordx4 v188, s[32:35], s54 offen offset:0 lds
v_mfma_f32_16x16x32_bf16 v[228:231], a[60:63], v[216:219], 0
buffer_load_dwordx4 v188, s[32:35], s54 offen offset:1024 lds
v_mfma_f32_16x16x32_bf16 v[228:231], a[52:55], v[200:203], v[228:231]
ds_read_b64_tr_b16 a[84:85], v185 offset:4096
v_bfe_u32 v87, v176, 1, 1
v_mfma_f32_16x16x32_bf16 v[228:231], a[48:51], v[196:199], v[228:231]
s_waitcnt lgkmcnt(10)
ds_read_b64_tr_b16 a[86:87], v185 offset:4608
v_cvt_pk_bf16_f32 v164, v232, v233
v_mfma_f32_16x16x32_bf16 v[228:231], a[56:59], v[208:211], v[228:231]
s_waitcnt lgkmcnt(10)
ds_read_b64_tr_b16 a[88:89], v185 offset:8192
v_cvt_pk_bf16_f32 v165, v234, v235
v_mfma_f32_16x16x32_bf16 v[232:235], a[56:59], v[204:207], 0
s_waitcnt lgkmcnt(10)
ds_read_b64_tr_b16 a[90:91], v185 offset:8704
v_mov_b32 v100, 0
v_mfma_f32_16x16x32_bf16 v[232:235], a[60:63], v[212:215], v[232:235]
s_waitcnt lgkmcnt(10)
ds_read_b64_tr_b16 a[92:93], v185 offset:12288
v_cvt_pk_bf16_f32 v166, v228, v229
v_mfma_f32_16x16x32_bf16 v[232:235], a[52:55], v[220:223], v[232:235]
s_waitcnt lgkmcnt(10)
ds_read_b64_tr_b16 a[94:95], v185 offset:12800
v_cvt_pk_bf16_f32 v167, v230, v231
v_mfma_f32_16x16x32_bf16 v[232:235], a[48:51], v[224:227], v[232:235]
s_waitcnt lgkmcnt(10)
ds_read_b64_tr_b16 a[96:97], v186 offset:0
v_lshrrev_b32 v92, 5, v176
v_mfma_f32_16x16x32_bf16 v[228:231], a[64:67], v[224:227], 0
s_waitcnt lgkmcnt(10)
ds_read_b64_tr_b16 a[98:99], v186 offset:512
v_lshlrev_b32 v16, 4, v86
v_mfma_f32_16x16x32_bf16 v[228:231], a[68:71], v[220:223], v[228:231]
s_waitcnt lgkmcnt(10)
ds_read_b64_tr_b16 a[100:101], v186 offset:4096
v_cvt_pk_bf16_f32 v110, v232, v233
v_mfma_f32_16x16x32_bf16 v[228:231], a[72:75], v[204:207], v[228:231]
s_waitcnt lgkmcnt(10)
ds_read_b64_tr_b16 a[102:103], v186 offset:4608
v_cvt_pk_bf16_f32 v111, v234, v235
v_mfma_f32_16x16x32_bf16 v[228:231], a[76:79], v[212:215], v[228:231]
s_waitcnt lgkmcnt(10)
ds_read_b64_tr_b16 a[104:105], v186 offset:8192
v_lshlrev_b32 v93, 5, v84
v_mfma_f32_16x16x32_bf16 v[232:235], a[76:79], v[216:219], 0
buffer_load_dwordx4 v188, s[32:35], s54 offen offset:2048 lds
v_mfma_f32_16x16x32_bf16 v[232:235], a[64:67], v[196:199], v[232:235]
buffer_load_dwordx4 v188, s[32:35], s54 offen offset:3072 lds
v_mfma_f32_16x16x32_bf16 v[232:235], a[68:71], v[200:203], v[232:235]
s_waitcnt lgkmcnt(7)
ds_read_b64_tr_b16 a[106:107], v186 offset:8704
s_add_u32 m0, s98, 63744
v_mfma_f32_16x16x32_bf16 v[232:235], a[72:75], v[208:211], v[232:235]
ds_read_b64_tr_b16 a[108:109], v186 offset:12288
v_cvt_pk_bf16_f32 v40, v228, v229
v_cvt_pk_bf16_f32 v41, v230, v231
v_mfma_f32_16x16x32_bf16 v[228:231], a[88:91], v[208:211], 0
ds_read_b64_tr_b16 a[110:111], v186 offset:12800
v_lshlrev_b32 v94, 4, v87
v_mfma_f32_16x16x32_bf16 v[228:231], a[84:87], v[200:203], v[228:231]
s_waitcnt lgkmcnt(8)
ds_read_b64_tr_b16 a[112:113], v187 offset:0
v_cvt_pk_bf16_f32 v0, v232, v233
v_mfma_f32_16x16x32_bf16 v[228:231], a[80:83], v[196:199], v[228:231]
ds_read_b64_tr_b16 a[114:115], v187 offset:512
v_cvt_pk_bf16_f32 v1, v234, v235
v_mfma_f32_16x16x32_bf16 v[228:231], a[92:95], v[216:219], v[228:231]
ds_read_b64_tr_b16 a[116:117], v187 offset:4096
v_and_b32 v89, 15, v176
v_mfma_f32_16x16x32_bf16 v[232:235], a[92:95], v[212:215], 0
s_waitcnt lgkmcnt(10)
ds_read_b64_tr_b16 a[118:119], v187 offset:4608
v_lshlrev_b32 v95, 4, v83
v_mfma_f32_16x16x32_bf16 v[232:235], a[88:91], v[204:207], v[232:235]
s_waitcnt lgkmcnt(10)
ds_read_b64_tr_b16 a[120:121], v187 offset:8192
v_cvt_pk_bf16_f32 v2, v228, v229
v_mfma_f32_16x16x32_bf16 v[232:235], a[84:87], v[220:223], v[232:235]
s_waitcnt lgkmcnt(10)
ds_read_b64_tr_b16 a[122:123], v187 offset:8704
v_cvt_pk_bf16_f32 v3, v230, v231
v_mfma_f32_16x16x32_bf16 v[232:235], a[80:83], v[224:227], v[232:235]
s_waitcnt lgkmcnt(10)
ds_read_b64_tr_b16 a[124:125], v187 offset:12288
v_mov_b32 v177, 158992
v_mfma_f32_16x16x32_bf16 v[228:231], a[96:99], v[224:227], 0
s_waitcnt lgkmcnt(9)
ds_read_b64_tr_b16 a[126:127], v187 offset:12800
v_mov_b32 v192, 0
v_mfma_f32_16x16x32_bf16 v[228:231], a[100:103], v[220:223], v[228:231]
s_waitcnt lgkmcnt(8)
buffer_load_dwordx4 v188, s[32:35], s57 offen offset:0 lds
v_mfma_f32_16x16x32_bf16 v[228:231], a[104:107], v[204:207], v[228:231]
buffer_load_dwordx4 v188, s[32:35], s57 offen offset:1024 lds
v_mfma_f32_16x16x32_bf16 v[228:231], a[108:111], v[212:215], v[228:231]
v_cvt_pk_bf16_f32 v42, v232, v233
v_cvt_pk_bf16_f32 v43, v234, v235
v_mfma_f32_16x16x32_bf16 v[232:235], a[108:111], v[216:219], 0
s_mul_i32 s53, s41, 1088
s_add_u32 s53, s53, 152576
v_lshl_add_u32 v247, v83, 6, s53
v_mfma_f32_16x16x32_bf16 v[232:235], a[96:99], v[196:199], v[232:235]
s_add_u32 s8, s53, 256
v_cvt_pk_bf16_f32 v44, v228, v229
v_cvt_pk_bf16_f32 v45, v230, v231
v_mfma_f32_16x16x32_bf16 v[232:235], a[100:103], v[200:203], v[232:235]
s_waitcnt lgkmcnt(2)
v_lshl_add_u32 v247, v88, 5, v247
v_lshl_add_u32 v247, v85, 4, v247
v_mfma_f32_16x16x32_bf16 v[232:235], a[104:107], v[208:211], v[232:235]
s_add_u32 s9, s53, 256
s_mov_b32 vcc_lo, 0x33333333
s_mov_b32 vcc_hi, 0xcccccccc
v_mfma_f32_16x16x32_bf16 v[228:231], a[120:123], v[208:211], 0
v_mov_b32 v174, s8
v_cndmask_b32 v247, v174, v247, vcc
v_mfma_f32_16x16x32_bf16 v[228:231], a[116:119], v[200:203], v[228:231]
s_waitcnt lgkmcnt(0)
v_cvt_pk_bf16_f32 v4, v232, v233
v_cvt_pk_bf16_f32 v5, v234, v235
v_mfma_f32_16x16x32_bf16 v[228:231], a[112:115], v[196:199], v[228:231]
s_mov_b32 s8, 272
v_lshl_add_u32 v174, v83, 2, s9
v_lshl_add_u32 v246, v82, 6, s53
v_mfma_f32_16x16x32_bf16 v[228:231], a[124:127], v[216:219], v[228:231]
s_mul_i32 s53, s43, 25344
v_mad_u32_u24 v174, v86, s8, v174
v_lshl_add_u32 v246, v87, 5, v246
v_mfma_f32_16x16x32_bf16 v[196:199], a[124:127], v[212:215], 0
s_add_u32 s10, s53, 59648
ds_write_b32 v174, v100 offset:0
v_mfma_f32_16x16x32_bf16 v[196:199], a[120:123], v[204:207], v[196:199]
s_lshl_b32 s53, s43, 7
v_cvt_pk_bf16_f32 v6, v228, v229
v_cvt_pk_bf16_f32 v7, v230, v231
v_mfma_f32_16x16x32_bf16 v[196:199], a[116:119], v[220:223], v[196:199]
buffer_load_dwordx4 v188, s[32:35], s57 offen offset:2048 lds
v_mfma_f32_16x16x32_bf16 v[196:199], a[112:115], v[224:227], v[196:199]
buffer_load_dwordx4 v188, s[32:35], s57 offen offset:3072 lds
v_mfma_f32_16x16x32_bf16 v[200:203], v[4:7], v[108:111], 0
s_add_u32 m0, s49, 4224
v_lshl_add_u32 v246, v83, 3, v246
v_lshl_add_u32 v246, v88, 1, v246
v_mfma_f32_16x16x32_bf16 v[200:203], v[0:3], v[104:107], v[200:203]
v_mov_b32 v174, 64
v_lshl_add_u32 v242, v89, 8, s53
v_mfma_f32_16x16x32_bf16 v[208:211], v[40:43], v[104:107], 0
ds_write_b16 v246, v174 offset:816
v_cvt_pk_bf16_f32 v46, v196, v197
v_cvt_pk_bf16_f32 v47, v198, v199
s_mul_i32 s52, s41, 12800
s_add_u32 s52, s52, 101376
v_mfma_f32_16x16x32_bf16 v[208:211], v[44:47], v[108:111], v[208:211]
s_add_u32 s14, s52, 256
v_lshl_add_u32 v172, v86, 7, s52
v_lshl_add_u32 v249, v86, 2, s14
v_mfma_f32_16x16x32_bf16 v[196:199], v[44:47], v[164:167], 0
s_mov_b32 s14, 1600
v_lshl_add_u32 v172, v92, 4, v172
v_lshl_add_u32 v172, v85, 3, v172
v_mfma_f32_16x16x32_bf16 v[196:199], v[40:43], v[160:163], v[196:199]
s_add_u32 s12, s52, 512
v_mad_u32_u24 v172, v83, s14, v172
v_xor_b32 v172, v16, v172
v_mfma_f32_16x16x32_bf16 v[216:219], v[0:3], v[160:163], 0
s_add_u32 s13, s52, 1072
v_xor_b32 v173, 32, v172
v_lshl_add_u32 v243, v84, 8, s52
v_mfma_f32_16x16x32_bf16 v[216:219], v[4:7], v[164:167], v[216:219]
s_add_u32 s11, s52, 1088
v_exp_f32 v196, v196
v_exp_f32 v197, v197
v_exp_f32 v198, v198
v_exp_f32 v199, v199
v_cvt_pk_bf16_f32 v138, v196, v197
v_cvt_pk_bf16_f32 v139, v198, v199
v_exp_f32 v200, v200
v_exp_f32 v201, v201
v_exp_f32 v202, v202
v_exp_f32 v203, v203
s_waitcnt vmcnt(8) lgkmcnt(0)
s_barrier
ds_read_b128 v[48:51], v240 offset:50688
ds_read_b128 v[52:55], v240 offset:50944
ds_read_b128 v[56:59], v240 offset:51200
ds_read_b128 v[60:63], v240 offset:51456
ds_read_b128 v[64:67], v240 offset:54912
ds_read_b128 v[68:71], v240 offset:55168
ds_read_b128 v[72:75], v240 offset:55424
ds_read_b128 v[76:79], v240 offset:55680
v_lshl_add_u32 v243, v87, 7, v243
v_lshl_add_u32 v243, v88, 6, v243
v_cvt_pk_bf16_f32 v112, v200, v201
v_cvt_pk_bf16_f32 v113, v202, v203
v_lshl_add_u32 v243, v82, 4, v243
v_xor_b32 v243, v93, v243
v_xor_b32 v243, v94, v243
v_lshl_add_u32 v245, v83, 7, s12
v_lshl_add_u32 v245, v88, 6, v245
s_xor_b32 s53, s41, 1
s_mul_i32 s53, s53, 1088
v_lshl_add_u32 v245, v82, 4, v245
v_xor_b32 v245, v95, v245
s_waitcnt lgkmcnt(7)
v_mfma_f32_16x16x32_bf16 v[228:231], a[64:67], v[48:51], 0
s_waitcnt lgkmcnt(5)
buffer_load_dwordx4 v241, s[16:19], s99 offen offset:0 nt lds
v_mfma_f32_16x16x32_bf16 v[228:231], a[68:71], v[52:55], v[228:231]
s_waitcnt lgkmcnt(4)
buffer_load_dwordx4 v241, s[16:19], s100 offen offset:2112 nt lds
v_mfma_f32_16x16x32_bf16 v[228:231], a[72:75], v[56:59], v[228:231]
s_add_u32 m0, s49, 8448
s_add_u32 s99, s55, 8192
s_add_u32 s100, s55, 8128
v_mfma_f32_16x16x32_bf16 v[228:231], a[76:79], v[60:63], v[228:231]
s_add_u32 s9, s53, 153392
s_mov_b32 vcc_lo, 0x33333333
s_mov_b32 vcc_hi, 0x33333333
v_mfma_f32_16x16x32_bf16 v[232:235], a[92:95], v[60:63], 0
s_lshl_b32 s53, s41, 9
v_mov_b32 v174, s13
v_lshl_add_u32 v190, v82, 10, s10
v_mfma_f32_16x16x32_bf16 v[232:235], a[88:91], v[56:59], v[232:235]
s_add_u32 s10, s53, 156928
s_lshl_b32 s57, s43, 14
s_lshl_b32 s53, s42, 7
s_add_u32 s57, s57, s53
v_mfma_f32_16x16x32_bf16 v[232:235], a[84:87], v[52:55], v[232:235]
s_add_u32 s15, s52, 1072
v_cvt_pk_bf16_f32 v144, v228, v229
v_cvt_pk_bf16_f32 v146, v230, v231
v_mfma_f32_16x16x32_bf16 v[232:235], a[80:83], v[48:51], v[232:235]
s_add_u32 s7, s52, 1088
buffer_load_dwordx4 v241, s[16:19], s99 offen offset:0 nt lds
v_mfma_f32_16x16x32_bf16 v[228:231], a[96:99], v[48:51], 0
s_add_u32 s99, s55, 12288
buffer_load_dwordx4 v241, s[16:19], s100 offen offset:2112 nt lds
v_mfma_f32_16x16x32_bf16 v[228:231], a[100:103], v[52:55], v[228:231]
s_add_u32 m0, s49, 12672
s_add_u32 s100, s55, 12224
v_cvt_pk_bf16_f32 v145, v232, v233
v_mfma_f32_16x16x32_bf16 v[228:231], a[104:107], v[56:59], v[228:231]
s_waitcnt lgkmcnt(0)
v_cvt_pk_bf16_f32 v147, v234, v235
v_cndmask_b32 v245, v174, v245, vcc
v_mfma_f32_16x16x32_bf16 v[228:231], a[108:111], v[60:63], v[228:231]
s_mov_b32 vcc_lo, 0xf0000f
s_mov_b32 vcc_hi, 0xf0000f00
v_lshl_add_u32 v175, v89, 4, s10
v_mfma_f32_16x16x32_bf16 v[232:235], a[124:127], v[60:63], 0
v_cndmask_b32 v175, v177, v175, vcc
v_mov_b32 v177, 0x3f803f80
v_mfma_f32_16x16x32_bf16 v[232:235], a[116:119], v[52:55], v[232:235]
s_nop 0
v_cvt_pk_bf16_f32 v148, v228, v229
v_cvt_pk_bf16_f32 v150, v230, v231
v_mfma_f32_16x16x32_bf16 v[232:235], a[112:115], v[48:51], v[232:235]
buffer_load_dwordx4 v241, s[16:19], s99 offen offset:0 nt lds
v_mfma_f32_16x16x32_bf16 v[232:235], a[120:123], v[56:59], v[232:235]
s_add_u32 s99, s55, 16384
buffer_load_dwordx4 v241, s[16:19], s100 offen offset:2112 nt lds
v_mfma_f32_16x16x32_bf16 v[228:231], a[56:59], v[56:59], 0
s_add_u32 m0, s49, 16896
s_add_u32 s100, s55, 16320
v_mov_b32 v250, 0x44444444
v_mfma_f32_16x16x32_bf16 v[228:231], a[60:63], v[60:63], v[228:231]
s_nop 0
v_cvt_pk_bf16_f32 v149, v232, v233
v_cvt_pk_bf16_f32 v151, v234, v235
v_mfma_f32_16x16x32_bf16 v[228:231], a[52:55], v[52:55], v[228:231]
ds_write_b32 v172, v144 offset:0
v_mfma_f32_16x16x32_bf16 v[228:231], a[48:51], v[48:51], v[228:231]
ds_write_b32 v172, v145 offset:4
v_mfma_f32_16x16x32_bf16 v[232:235], a[32:35], v[48:51], 0
ds_write_b32 v172, v146 offset:64
v_mfma_f32_16x16x32_bf16 v[232:235], a[36:39], v[52:55], v[232:235]
buffer_load_dwordx4 v241, s[16:19], s99 offen offset:0 nt lds
v_mfma_f32_16x16x32_bf16 v[232:235], a[40:43], v[56:59], v[232:235]
s_add_u32 s99, s57, 0
buffer_load_dwordx4 v241, s[16:19], s100 offen offset:2112 nt lds
v_mfma_f32_16x16x32_bf16 v[232:235], a[44:47], v[60:63], v[232:235]
s_add_u32 m0, s98, 59648
s_add_u32 s100, s57, 1024
v_cvt_pk_bf16_f32 v157, v228, v229
v_mfma_f32_16x16x32_bf16 v[236:239], a[28:31], v[60:63], 0
ds_write_b32 v172, v147 offset:68
v_mfma_f32_16x16x32_bf16 v[236:239], a[24:27], v[56:59], v[236:239]
s_waitcnt vmcnt(8)
s_barrier
v_mfma_f32_16x16x32_bf16 v[236:239], a[20:23], v[52:55], v[236:239]
ds_write_b32 v173, v148 offset:0
v_mfma_f32_16x16x32_bf16 v[236:239], a[16:19], v[48:51], v[236:239]
ds_write_b32 v173, v149 offset:4
v_cvt_pk_bf16_f32 v159, v230, v231
v_mfma_f32_16x16x32_bf16 v[228:231], a[0:3], v[48:51], 0
ds_write_b32 v173, v150 offset:64
v_mfma_f32_16x16x32_bf16 v[228:231], a[8:11], v[56:59], v[228:231]
ds_write_b32 v173, v151 offset:68
v_mfma_f32_16x16x32_bf16 v[228:231], a[12:15], v[60:63], v[228:231]
ds_read_b128 v[96:99], v243 offset:0
v_cvt_pk_bf16_f32 v156, v232, v233
v_mfma_f32_16x16x32_bf16 v[228:231], a[4:7], v[52:55], v[228:231]
v_cvt_pk_bf16_f32 v158, v234, v235
v_cvt_pk_bf16_f32 v153, v236, v237
v_mfma_f32_16x16x32_bf16 v[232:235], a[4:7], v[68:71], 0
v_cvt_pk_bf16_f32 v155, v238, v239
v_mov_b64 v[236:237], s[96:97]
v_mfma_f32_16x16x32_bf16 v[232:235], a[0:3], v[64:67], v[232:235]
s_mov_b32 vcc_lo, 0x33333333
s_mov_b32 vcc_hi, 0x33333333
v_cvt_pk_bf16_f32 v152, v228, v229
v_mfma_f32_16x16x32_bf16 v[232:235], a[8:11], v[72:75], v[232:235]
v_cvt_pk_bf16_f32 v154, v230, v231
v_cndmask_b32 v192, v192, v177, vcc
v_mfma_f32_16x16x32_bf16 v[232:235], a[12:15], v[76:79], v[232:235]
s_mov_b32 vcc_lo, 0xaaaaaaaa
s_mov_b32 vcc_hi, 0xaaaaaaaa
v_mov_b32 v177, 0xeeeeeeee
v_mfma_f32_16x16x32_bf16 v[228:231], v[144:147], v[152:155], 0
s_waitcnt lgkmcnt(0)
v_cndmask_b32 v250, v250, v177, vcc
v_mov_b32 v177, 0xe4eeeeee
v_mfma_f32_16x16x32_bf16 v[228:231], v[148:151], v[156:159], v[228:231]
s_mov_b32 vcc_lo, 0x0
s_mov_b32 vcc_hi, 0xaaaaaaaa
v_cndmask_b32 v250, v250, v177, vcc
v_mov_b64 v[238:239], s[96:97]
v_cvt_pk_bf16_f32 v32, v232, v233
v_cvt_pk_bf16_f32 v34, v234, v235
v_smfmac_f32_16x16x64_bf16 v[236:239], v[96:99], v[104:111], v250
s_mov_b32 vcc_lo, 0xffff
s_mov_b32 vcc_hi, 0xffff
v_mov_b64 v[232:233], s[96:97]
v_mov_b64 v[234:235], s[96:97]
v_lshl_add_u32 v190, v83, 7, v190
v_lshl_add_u32 v190, v84, 6, v190
v_smfmac_f32_16x16x64_bf16 v[232:235], v[96:99], v[160:167], v250
s_lshl_b32 s50, s43, 12
s_add_u32 s50, s50, s44
s_add_u32 s50, s50, 13107200
v_mfma_f32_16x16x32_bf16 v[196:199], a[28:31], v[76:79], 0
v_lshl_add_u32 v190, v86, 4, v190
v_xor_b32 v191, 64, v190
v_mfma_f32_16x16x32_bf16 v[196:199], a[24:27], v[72:75], v[196:199]
ds_read_b64_tr_b16 a[176:177], v191 offset:8
v_bfe_u32 v90, v176, 3, 2
v_mfma_f32_16x16x32_bf16 v[196:199], a[20:23], v[68:71], v[196:199]
ds_read_b64_tr_b16 a[178:179], v191 offset:520
v_mov_b32 v251, 0x0c0c0c0c
v_mfma_f32_16x16x32_bf16 v[196:199], a[16:19], v[64:67], v[196:199]
ds_read_b64_tr_b16 a[180:181], v191 offset:4104
v_exp_f32 v228, v228
v_exp_f32 v229, v229
v_exp_f32 v230, v230
v_add_f32 v168, v228, v229
s_nop 2
v_cvt_pk_bf16_f32 v33, v196, v197
v_cvt_pk_bf16_f32 v35, v198, v199
v_mfma_f32_16x16x32_bf16 v[196:199], a[32:35], v[64:67], 0
ds_read_b64_tr_b16 a[182:183], v191 offset:4616
v_cvt_pk_bf16_f32 v228, v228, v229
v_mfma_f32_16x16x32_bf16 v[196:199], a[36:39], v[68:71], v[196:199]
ds_read_b64_tr_b16 a[184:185], v191 offset:8200
v_mov_b32 v177, 0x07060302
v_mfma_f32_16x16x32_bf16 v[196:199], a[40:43], v[72:75], v[196:199]
ds_read_b64_tr_b16 a[186:187], v191 offset:8712
v_bfe_u32 v91, v176, 2, 1
v_mfma_f32_16x16x32_bf16 v[196:199], a[44:47], v[76:79], v[196:199]
ds_read_b64_tr_b16 a[188:189], v191 offset:12296
v_lshl_add_u32 v244, v90, 7, s11
v_mfma_f32_16x16x32_bf16 v[200:203], a[60:63], v[76:79], 0
ds_read_b64_tr_b16 a[190:191], v191 offset:12808
v_lshl_add_u32 v174, v90, 2, s15
v_mfma_f32_16x16x32_bf16 v[200:203], a[52:55], v[68:71], v[200:203]
ds_read_b64_tr_b16 a[160:161], v191 offset:0
v_cndmask_b32 v251, v251, v177, vcc
v_mfma_f32_16x16x32_bf16 v[200:203], a[48:51], v[64:67], v[200:203]
ds_read_b64_tr_b16 a[162:163], v191 offset:512
v_cvt_pk_bf16_f32 v36, v196, v197
v_mfma_f32_16x16x32_bf16 v[200:203], a[56:59], v[72:75], v[200:203]
s_waitcnt lgkmcnt(9)
ds_read_b64_tr_b16 a[164:165], v191 offset:4096
v_cvt_pk_bf16_f32 v38, v198, v199
v_mfma_f32_16x16x32_bf16 v[196:199], a[120:123], v[72:75], 0
s_waitcnt lgkmcnt(9)
ds_read_b64_tr_b16 a[166:167], v191 offset:4608
v_add_f32 v236, v236, v237
v_mfma_f32_16x16x32_bf16 v[196:199], a[124:127], v[76:79], v[196:199]
s_waitcnt lgkmcnt(9)
ds_read_b64_tr_b16 a[168:169], v191 offset:8192
v_cvt_pk_bf16_f32 v37, v200, v201
v_mfma_f32_16x16x32_bf16 v[196:199], a[116:119], v[68:71], v[196:199]
ds_read_b64_tr_b16 a[170:171], v191 offset:8704
v_cvt_pk_bf16_f32 v39, v202, v203
v_mfma_f32_16x16x32_bf16 v[196:199], a[112:115], v[64:67], v[196:199]
ds_read_b64_tr_b16 a[172:173], v191 offset:12288
v_add_f32 v238, v238, v239
v_mfma_f32_16x16x32_bf16 v[200:203], a[96:99], v[64:67], 0
ds_read_b64_tr_b16 a[174:175], v191 offset:12800
v_lshl_add_u32 v244, v91, 6, v244
v_mfma_f32_16x16x32_bf16 v[200:203], a[100:103], v[68:71], v[200:203]
s_waitcnt lgkmcnt(12)
ds_read_b64_tr_b16 a[144:145], v190 offset:8
v_cvt_pk_bf16_f32 v29, v196, v197
v_mfma_f32_16x16x32_bf16 v[200:203], a[104:107], v[72:75], v[200:203]
s_waitcnt lgkmcnt(12)
ds_read_b64_tr_b16 a[146:147], v190 offset:520
v_cvt_pk_bf16_f32 v31, v198, v199
v_mfma_f32_16x16x32_bf16 v[200:203], a[108:111], v[76:79], v[200:203]
s_waitcnt lgkmcnt(12)
ds_read_b64_tr_b16 a[148:149], v190 offset:4104
v_mov_b32 v252, 0x0c0c0c0c
v_mfma_f32_16x16x32_bf16 v[196:199], a[92:95], v[76:79], 0
s_waitcnt lgkmcnt(12)
ds_read_b64_tr_b16 a[150:151], v190 offset:4616
v_mov_b32 v177, 0x07060302
v_mfma_f32_16x16x32_bf16 v[196:199], a[88:91], v[72:75], v[196:199]
s_waitcnt lgkmcnt(12)
ds_read_b64_tr_b16 a[152:153], v190 offset:8200
v_cvt_pk_bf16_f32 v28, v200, v201
v_mfma_f32_16x16x32_bf16 v[196:199], a[84:87], v[68:71], v[196:199]
s_waitcnt lgkmcnt(12)
ds_read_b64_tr_b16 a[154:155], v190 offset:8712
v_cvt_pk_bf16_f32 v30, v202, v203
v_mfma_f32_16x16x32_bf16 v[196:199], a[80:83], v[64:67], v[196:199]
s_waitcnt lgkmcnt(12)
ds_read_b64_tr_b16 a[156:157], v190 offset:12296
v_lshl_add_u32 v189, v89, 3, s7
v_mfma_f32_16x16x32_bf16 v[200:203], a[64:67], v[64:67], 0
s_waitcnt lgkmcnt(12)
ds_read_b64_tr_b16 a[158:159], v190 offset:12808
v_lshl_add_u32 v248, v89, 2, s52
v_mfma_f32_16x16x32_bf16 v[200:203], a[68:71], v[68:71], v[200:203]
s_waitcnt lgkmcnt(12)
ds_read_b64_tr_b16 a[128:129], v190 offset:0
v_cvt_pk_bf16_f32 v25, v196, v197
v_mfma_f32_16x16x32_bf16 v[200:203], a[72:75], v[72:75], v[200:203]
s_waitcnt lgkmcnt(12)
ds_read_b64_tr_b16 a[130:131], v190 offset:512
v_cvt_pk_bf16_f32 v27, v198, v199
v_mfma_f32_16x16x32_bf16 v[200:203], a[76:79], v[76:79], v[200:203]
s_waitcnt lgkmcnt(12)
ds_read_b64_tr_b16 a[132:133], v190 offset:4096
v_mad_u32_u24 v189, v82, s14, v189
v_mfma_f32_16x16x32_bf16 v[196:199], v[76:79], a[188:191], 0
s_waitcnt lgkmcnt(12)
ds_read_b64_tr_b16 a[134:135], v190 offset:4608
v_mad_u32_u24 v249, v82, s8, v249
v_mfma_f32_16x16x32_bf16 v[196:199], v[72:75], a[184:187], v[196:199]
s_waitcnt lgkmcnt(12)
ds_read_b64_tr_b16 a[136:137], v190 offset:8192
v_cvt_pk_bf16_f32 v24, v200, v201
v_mfma_f32_16x16x32_bf16 v[196:199], v[68:71], a[180:183], v[196:199]
s_waitcnt lgkmcnt(12)
ds_read_b64_tr_b16 a[138:139], v190 offset:8704
v_cvt_pk_bf16_f32 v26, v202, v203
v_mfma_f32_16x16x32_bf16 v[196:199], v[64:67], a[176:179], v[196:199]
s_waitcnt lgkmcnt(12)
ds_read_b64_tr_b16 a[140:141], v190 offset:12288
v_lshl_add_u32 v242, v82, 4, v242
v_mfma_f32_16x16x32_bf16 v[200:203], v[24:27], v[32:35], 0
s_waitcnt lgkmcnt(12)
ds_read_b64_tr_b16 a[142:143], v190 offset:12800
v_mad_u32_u24 v248, v82, s8, v248
v_mfma_f32_16x16x32_bf16 v[200:203], v[28:31], v[36:39], v[200:203]
s_waitcnt lgkmcnt(12)
ds_write_b32 v175, v228 offset:0
v_exp_f32 v231, v231
s_nop 0
v_cvt_pk_bf16_f32 v229, v230, v231
v_add_f32 v169, v230, v231
v_add_f32 v230, v168, v169
ds_write_b32 v175, v229 offset:4
ds_write_b32 v175, v230 offset:8
v_cvt_pk_bf16_f32 v14, v196, v197
v_cvt_pk_bf16_f32 v15, v198, v199
v_mfma_f32_16x16x32_bf16 v[228:231], v[64:67], a[160:163], 0
s_waitcnt lgkmcnt(11)
v_exp_f32 v208, v208
v_mfma_f32_16x16x32_bf16 v[228:231], v[68:71], a[164:167], v[228:231]
s_waitcnt lgkmcnt(10)
v_exp_f32 v209, v209
v_mfma_f32_16x16x32_bf16 v[228:231], v[72:75], a[168:171], v[228:231]
s_waitcnt lgkmcnt(9)
v_exp_f32 v210, v210
v_mfma_f32_16x16x32_bf16 v[228:231], v[76:79], a[172:175], v[228:231]
s_waitcnt lgkmcnt(8)
v_exp_f32 v211, v211
v_mfma_f32_16x16x32_bf16 v[196:199], v[76:79], a[156:159], 0
s_waitcnt lgkmcnt(7)
v_cvt_pk_bf16_f32 v122, v208, v209
v_cvt_pk_bf16_f32 v123, v210, v211
v_mfma_f32_16x16x32_bf16 v[196:199], v[72:75], a[152:155], v[196:199]
s_waitcnt lgkmcnt(6)
v_cvt_pk_bf16_f32 v12, v228, v229
v_cvt_pk_bf16_f32 v13, v230, v231
v_mfma_f32_16x16x32_bf16 v[196:199], v[68:71], a[148:151], v[196:199]
s_waitcnt lgkmcnt(5)
v_exp_f32 v200, v200
v_mfma_f32_16x16x32_bf16 v[196:199], v[64:67], a[144:147], v[196:199]
s_waitcnt lgkmcnt(4)
v_exp_f32 v201, v201
v_mfma_f32_16x16x32_bf16 v[208:211], v[64:67], a[128:131], 0
s_waitcnt lgkmcnt(3)
v_add_f32 v168, v200, v201
v_cvt_pk_bf16_f32 v200, v200, v201
v_mfma_f32_16x16x32_bf16 v[208:211], v[72:75], a[136:139], v[208:211]
ds_write_b32 v175, v200 offset:256
v_mfma_f32_16x16x32_bf16 v[208:211], v[76:79], a[140:143], v[208:211]
v_cvt_pk_bf16_f32 v10, v196, v197
v_cvt_pk_bf16_f32 v11, v198, v199
v_mfma_f32_16x16x32_bf16 v[208:211], v[68:71], a[132:135], v[208:211]
v_exp_f32 v202, v202
v_mfma_f32_16x16x32_bf16 v[196:199], v[52:55], a[132:135], 0
v_exp_f32 v203, v203
v_mfma_f32_16x16x32_bf16 v[196:199], v[48:51], a[128:131], v[196:199]
v_cvt_pk_bf16_f32 v201, v202, v203
v_add_f32 v169, v202, v203
v_mfma_f32_16x16x32_bf16 v[196:199], v[56:59], a[136:139], v[196:199]
ds_write_b32 v175, v201 offset:260
v_mfma_f32_16x16x32_bf16 v[196:199], v[60:63], a[140:143], v[196:199]
v_add_f32 v202, v168, v169
v_cvt_pk_bf16_f32 v8, v208, v209
v_mfma_f32_16x16x32_bf16 v[228:231], v[60:63], a[156:159], 0
s_waitcnt vmcnt(4)
s_barrier
v_mfma_f32_16x16x32_bf16 v[228:231], v[56:59], a[152:155], v[228:231]
ds_write_b32 v175, v202 offset:264
v_mfma_f32_16x16x32_bf16 v[228:231], v[52:55], a[148:151], v[228:231]
v_exp_f32 v216, v216
v_mfma_f32_16x16x32_bf16 v[228:231], v[48:51], a[144:147], v[228:231]
v_exp_f32 v217, v217
v_mfma_f32_16x16x32_bf16 v[200:203], v[48:51], a[160:163], 0
v_exp_f32 v218, v218
v_mfma_f32_16x16x32_bf16 v[200:203], v[52:55], a[164:167], v[200:203]
v_exp_f32 v219, v219
v_mfma_f32_16x16x32_bf16 v[200:203], v[56:59], a[168:171], v[200:203]
v_cvt_pk_bf16_f32 v128, v216, v217
v_cvt_pk_bf16_f32 v129, v218, v219
v_mfma_f32_16x16x32_bf16 v[200:203], v[60:63], a[172:175], v[200:203]
v_cvt_pk_bf16_f32 v18, v228, v229
v_cvt_pk_bf16_f32 v19, v230, v231
v_mfma_f32_16x16x32_bf16 v[228:231], v[60:63], a[188:191], 0
v_cvt_pk_bf16_f32 v9, v210, v211
v_lshl_add_u32 v244, v86, 3, v244
v_mfma_f32_16x16x32_bf16 v[228:231], v[52:55], a[180:183], v[228:231]
ds_read_b128 v[208:211], v240 offset:256
v_cvt_pk_bf16_f32 v16, v196, v197
v_mfma_f32_16x16x32_bf16 v[228:231], v[48:51], a[176:179], v[228:231]
v_cvt_pk_bf16_f32 v17, v198, v199
v_cvt_pk_bf16_f32 v20, v200, v201
v_mfma_f32_16x16x32_bf16 v[228:231], v[56:59], a[184:187], v[228:231]
ds_read_b128 v[196:199], v240 offset:0
v_cvt_pk_bf16_f32 v21, v202, v203
v_mfma_f32_16x16x32_bf16 v[216:219], v[204:207], a[184:187], 0
ds_read_b128 v[200:203], v240 offset:768
v_add_f32 v232, v232, v233
v_mfma_f32_16x16x32_bf16 v[216:219], v[212:215], a[188:191], v[216:219]
s_mov_b32 vcc_lo, 0xffff0000
s_mov_b32 vcc_hi, 0xffff0000
v_cvt_pk_bf16_f32 v22, v228, v229
v_mfma_f32_16x16x32_bf16 v[216:219], v[220:223], a[180:183], v[216:219]
v_cvt_pk_bf16_f32 v23, v230, v231
v_cndmask_b32 v252, v252, v177, vcc
v_mfma_f32_16x16x32_bf16 v[216:219], v[224:227], a[176:179], v[216:219]
v_exp_f32 v236, v236
v_mfma_f32_16x16x32_bf16 v[228:231], v[224:227], a[160:163], 0
v_exp_f32 v238, v238
v_mfma_f32_16x16x32_bf16 v[228:231], v[220:223], a[164:167], v[228:231]
v_perm_b32 v124, v238, v236, v251
v_perm_b32 v125, v238, v236, v252
v_mfma_f32_16x16x32_bf16 v[228:231], v[204:207], a[168:171], v[228:231]
ds_read_b128 v[236:239], v240 offset:512
v_cvt_pk_bf16_f32 v94, v216, v217
v_mfma_f32_16x16x32_bf16 v[228:231], v[212:215], a[172:175], v[228:231]
v_cvt_pk_bf16_f32 v95, v218, v219
v_add_f32 v234, v234, v235
v_mfma_f32_16x16x32_bf16 v[216:219], v[212:215], a[156:159], 0
s_mul_i32 s48, s43, 3168
s_add_u32 s49, s49, s48
s_add_u32 s49, s49, 50688
s_mov_b32 s48, 8192
v_mfma_f32_16x16x32_bf16 v[216:219], v[204:207], a[152:155], v[216:219]
v_cvt_pk_bf16_f32 v90, v228, v229
v_cvt_pk_bf16_f32 v91, v230, v231
v_mfma_f32_16x16x32_bf16 v[216:219], v[220:223], a[148:151], v[216:219]
s_waitcnt lgkmcnt(3)
v_exp_f32 v232, v232
v_mfma_f32_16x16x32_bf16 v[216:219], v[224:227], a[144:147], v[216:219]
v_exp_f32 v234, v234
v_mfma_f32_16x16x32_bf16 v[228:231], v[224:227], a[128:131], 0
s_waitcnt lgkmcnt(2)
v_perm_b32 v140, v234, v232, v251
v_perm_b32 v141, v234, v232, v252
v_mfma_f32_16x16x32_bf16 v[228:231], v[204:207], a[136:139], v[228:231]
s_waitcnt lgkmcnt(1)
v_mad_u32_u24 v174, v81, s14, v174
v_cvt_pk_bf16_f32 v86, v216, v217
v_mfma_f32_16x16x32_bf16 v[228:231], v[212:215], a[140:143], v[228:231]
ds_write_b32 v174, v100 offset:0
v_mfma_f32_16x16x32_bf16 v[228:231], v[220:223], a[132:135], v[228:231]
ds_read_b128 v[224:227], v240 offset:4224
v_cvt_pk_bf16_f32 v87, v218, v219
v_mfma_f32_16x16x32_bf16 v[216:219], v[208:211], a[132:135], 0
s_waitcnt lgkmcnt(2)
ds_read_b128 v[220:223], v240 offset:4480
ds_read_b128 v[204:207], v240 offset:4736
v_mfma_f32_16x16x32_bf16 v[216:219], v[196:199], a[128:131], v[216:219]
ds_read_b128 v[212:215], v240 offset:4992
v_cvt_pk_bf16_f32 v82, v228, v229
v_mfma_f32_16x16x32_bf16 v[216:219], v[236:239], a[136:139], v[216:219]
v_cvt_pk_bf16_f32 v83, v230, v231
v_lshl_add_u32 v244, v92, 2, v244
v_mfma_f32_16x16x32_bf16 v[216:219], v[200:203], a[140:143], v[216:219]
v_mov_b32 v193, v192
v_mov_b32 v194, v192
v_mfma_f32_16x16x32_bf16 v[228:231], v[200:203], a[156:159], 0
ds_write_b32 v189, v14 offset:6784
v_mfma_f32_16x16x32_bf16 v[228:231], v[236:239], a[152:155], v[228:231]
ds_write_b32 v189, v15 offset:6788
v_mfma_f32_16x16x32_bf16 v[228:231], v[208:211], a[148:151], v[228:231]
ds_write_b32 v189, v12 offset:6656
v_mfma_f32_16x16x32_bf16 v[228:231], v[196:199], a[144:147], v[228:231]
ds_write_b32 v189, v13 offset:6660
v_cvt_pk_bf16_f32 v48, v216, v217
v_cvt_pk_bf16_f32 v49, v218, v219
v_mfma_f32_16x16x32_bf16 v[216:219], v[196:199], a[160:163], 0
ds_write_b32 v189, v10 offset:6528
v_mfma_f32_16x16x32_bf16 v[216:219], v[208:211], a[164:167], v[216:219]
ds_write_b32 v189, v11 offset:6532
v_mfma_f32_16x16x32_bf16 v[216:219], v[236:239], a[168:171], v[216:219]
ds_write_b32 v189, v8 offset:6400
v_mfma_f32_16x16x32_bf16 v[216:219], v[200:203], a[172:175], v[216:219]
ds_write_b32 v189, v9 offset:6404
v_cvt_pk_bf16_f32 v52, v228, v229
v_cvt_pk_bf16_f32 v53, v230, v231
v_mfma_f32_16x16x32_bf16 v[228:231], v[200:203], a[188:191], 0
s_waitcnt lgkmcnt(9)
buffer_load_dwordx4 v182, s[36:39], s99 offen offset:0 lds
v_mfma_f32_16x16x32_bf16 v[228:231], v[236:239], a[184:187], v[228:231]
s_add_u32 s99, s57, 2048
buffer_load_dwordx4 v182, s[36:39], s100 offen offset:1024 lds
v_mfma_f32_16x16x32_bf16 v[228:231], v[208:211], a[180:183], v[228:231]
s_waitcnt lgkmcnt(8)
s_add_u32 s100, s57, 3072
v_cvt_pk_bf16_f32 v56, v216, v217
v_mfma_f32_16x16x32_bf16 v[228:231], v[196:199], a[176:179], v[228:231]
v_cvt_pk_bf16_f32 v57, v218, v219
v_mov_b32 v195, v192
v_mfma_f32_16x16x32_bf16 v[196:199], a[64:67], v[224:227], 0
v_mov_b32 v126, 0
v_mov_b32 v127, 0
v_mfma_f32_16x16x32_bf16 v[196:199], a[68:71], v[220:223], v[196:199]
v_mov_b32 v101, 0
v_mov_b32 v102, 0
v_mfma_f32_16x16x32_bf16 v[196:199], a[72:75], v[204:207], v[196:199]
v_cvt_pk_bf16_f32 v60, v228, v229
v_cvt_pk_bf16_f32 v61, v230, v231
v_mfma_f32_16x16x32_bf16 v[196:199], a[76:79], v[212:215], v[196:199]
v_mov_b32 v103, 0
v_mov_b32 v254, 0
v_mfma_f32_16x16x32_bf16 v[200:203], a[92:95], v[212:215], 0
buffer_load_dwordx4 v182, s[36:39], s99 offen offset:2048 lds
v_mfma_f32_16x16x32_bf16 v[200:203], a[88:91], v[204:207], v[200:203]
s_add_u32 s99, s57, 8192
buffer_load_dwordx4 v182, s[36:39], s100 offen offset:3072 lds
v_mfma_f32_16x16x32_bf16 v[200:203], a[84:87], v[220:223], v[200:203]
s_add_u32 m0, s98, 63744
s_add_u32 s100, s57, 9216
v_cvt_pk_bf16_f32 v8, v196, v197
v_mfma_f32_16x16x32_bf16 v[200:203], a[80:83], v[224:227], v[200:203]
v_cvt_pk_bf16_f32 v9, v198, v199
v_mov_b32 v142, 0
v_mfma_f32_16x16x32_bf16 v[196:199], a[96:99], v[224:227], 0
v_mov_b32 v143, 0
v_mov_b32 v255, s9
v_mfma_f32_16x16x32_bf16 v[196:199], a[100:103], v[220:223], v[196:199]
s_nop 1
v_cvt_pk_bf16_f32 v10, v200, v201
v_mfma_f32_16x16x32_bf16 v[196:199], a[104:107], v[204:207], v[196:199]
v_cvt_pk_bf16_f32 v11, v202, v203
v_mfma_f32_16x16x32_bf16 v[196:199], a[108:111], v[212:215], v[196:199]
ds_write_b32 v189, v16 offset:0
v_mfma_f32_16x16x32_bf16 v[200:203], a[124:127], v[212:215], 0
buffer_load_dwordx4 v182, s[36:39], s99 offen offset:0 lds
v_mfma_f32_16x16x32_bf16 v[200:203], a[120:123], v[204:207], v[200:203]
s_add_u32 s99, s57, 10240
buffer_load_dwordx4 v182, s[36:39], s100 offen offset:1024 lds
v_mfma_f32_16x16x32_bf16 v[200:203], a[116:119], v[220:223], v[200:203]
s_add_u32 s100, s57, 11264
v_cvt_pk_bf16_f32 v12, v196, v197
v_cvt_pk_bf16_f32 v13, v198, v199
v_mfma_f32_16x16x32_bf16 v[200:203], a[112:115], v[224:227], v[200:203]
ds_write_b32 v189, v17 offset:4
v_mfma_f32_16x16x32_bf16 v[196:199], v[224:227], a[128:131], 0
ds_write_b32 v189, v18 offset:128
v_mfma_f32_16x16x32_bf16 v[196:199], v[220:223], a[132:135], v[196:199]
ds_write_b32 v189, v19 offset:132
v_mfma_f32_16x16x32_bf16 v[196:199], v[204:207], a[136:139], v[196:199]
s_nop 1
v_cvt_pk_bf16_f32 v14, v200, v201
v_mfma_f32_16x16x32_bf16 v[196:199], v[212:215], a[140:143], v[196:199]
v_cvt_pk_bf16_f32 v15, v202, v203
s_nop 1
v_mfma_f32_16x16x32_bf16 v[200:203], v[12:15], v[108:111], 0
buffer_load_dwordx4 v182, s[36:39], s99 offen offset:2048 lds
v_mfma_f32_16x16x32_bf16 v[200:203], v[8:11], v[104:107], v[200:203]
buffer_load_dwordx4 v182, s[36:39], s100 offen offset:3072 lds
v_mfma_f32_16x16x32_bf16 v[208:211], v[8:11], v[160:163], 0
s_waitcnt vmcnt(8)
s_barrier
v_mfma_f32_16x16x32_bf16 v[208:211], v[12:15], v[164:167], v[208:211]
s_mov_b32 s98, s50
ds_read_b128 v[216:219], v240 offset:8704
v_cvt_pk_bf16_f32 v50, v196, v197
v_mfma_f32_16x16x32_bf16 v[228:231], v[212:215], a[156:159], 0
s_add_u32 s99, s98, s51
ds_read_b128 v[232:235], v240 offset:8960
v_cvt_pk_bf16_f32 v51, v198, v199
v_mfma_f32_16x16x32_bf16 v[228:231], v[204:207], a[152:155], v[228:231]
s_add_u32 s100, s99, s51
ds_read_b128 v[196:199], v240 offset:8448
s_add_u32 m0, s49, 0
v_mfma_f32_16x16x32_bf16 v[228:231], v[220:223], a[148:151], v[228:231]
s_add_u32 s101, s100, s51
v_exp_f32 v200, v200
v_mfma_f32_16x16x32_bf16 v[228:231], v[224:227], a[144:147], v[228:231]
v_exp_f32 v201, v201
v_mfma_f32_16x16x32_bf16 v[236:239], v[224:227], a[160:163], 0
v_exp_f32 v202, v202
v_mfma_f32_16x16x32_bf16 v[236:239], v[220:223], a[164:167], v[236:239]
v_exp_f32 v203, v203
v_mfma_f32_16x16x32_bf16 v[236:239], v[204:207], a[168:171], v[236:239]
v_cvt_pk_bf16_f32 v114, v200, v201
v_cvt_pk_bf16_f32 v115, v202, v203
v_mfma_f32_16x16x32_bf16 v[236:239], v[212:215], a[172:175], v[236:239]
ds_read_b128 v[200:203], v240 offset:9216
v_cvt_pk_bf16_f32 v54, v228, v229
v_cvt_pk_bf16_f32 v55, v230, v231
v_mfma_f32_16x16x32_bf16 v[228:231], v[212:215], a[188:191], 0
v_exp_f32 v208, v208
v_mfma_f32_16x16x32_bf16 v[228:231], v[204:207], a[184:187], v[228:231]
v_exp_f32 v209, v209
v_mfma_f32_16x16x32_bf16 v[228:231], v[220:223], a[180:183], v[228:231]
s_waitcnt lgkmcnt(1)
v_cvt_pk_bf16_f32 v58, v236, v237
v_cvt_pk_bf16_f32 v59, v238, v239
v_mfma_f32_16x16x32_bf16 v[228:231], v[224:227], a[176:179], v[228:231]
v_exp_f32 v210, v210
v_mfma_f32_16x16x32_bf16 v[236:239], a[64:67], v[196:199], 0
ds_write_b32 v189, v20 offset:256
v_mfma_f32_16x16x32_bf16 v[236:239], a[68:71], v[216:219], v[236:239]
s_waitcnt lgkmcnt(1)
ds_write_b32 v189, v21 offset:260
v_mfma_f32_16x16x32_bf16 v[236:239], a[72:75], v[232:235], v[236:239]
ds_write_b32 v189, v22 offset:384
v_mfma_f32_16x16x32_bf16 v[236:239], a[76:79], v[200:203], v[236:239]
ds_write_b32 v189, v23 offset:388
v_cvt_pk_bf16_f32 v62, v228, v229
v_cvt_pk_bf16_f32 v63, v230, v231
v_mfma_f32_16x16x32_bf16 v[228:231], a[92:95], v[200:203], 0
ds_read2_b32 v[100:101], v244 offset0:0 offset1:8
v_cvt_pk_bf16_f32 v130, v208, v209
v_mfma_f32_16x16x32_bf16 v[228:231], a[88:91], v[232:235], v[228:231]
s_nop 0
v_cvt_pk_bf16_f32 v16, v236, v237
v_cvt_pk_bf16_f32 v17, v238, v239
v_mfma_f32_16x16x32_bf16 v[228:231], a[84:87], v[216:219], v[228:231]
v_exp_f32 v211, v211
v_mfma_f32_16x16x32_bf16 v[228:231], a[80:83], v[196:199], v[228:231]
v_cvt_pk_bf16_f32 v131, v210, v211
s_nop 0
v_mfma_f32_16x16x32_bf16 v[236:239], a[96:99], v[196:199], 0
ds_write_b32 v172, v152 offset:512
v_mfma_f32_16x16x32_bf16 v[236:239], a[100:103], v[216:219], v[236:239]
ds_write_b32 v172, v153 offset:516
v_mfma_f32_16x16x32_bf16 v[236:239], a[104:107], v[232:235], v[236:239]
s_nop 0
v_cvt_pk_bf16_f32 v18, v228, v229
v_cvt_pk_bf16_f32 v19, v230, v231
v_mfma_f32_16x16x32_bf16 v[236:239], a[108:111], v[200:203], v[236:239]
ds_write_b32 v172, v154 offset:576
v_mfma_f32_16x16x32_bf16 v[208:211], a[124:127], v[200:203], 0
ds_write_b32 v172, v155 offset:580
v_mfma_f32_16x16x32_bf16 v[208:211], a[120:123], v[232:235], v[208:211]
ds_write_b32 v173, v156 offset:512
v_mfma_f32_16x16x32_bf16 v[208:211], a[116:119], v[216:219], v[208:211]
s_nop 1
v_cvt_pk_bf16_f32 v20, v236, v237
v_mfma_f32_16x16x32_bf16 v[208:211], a[112:115], v[196:199], v[208:211]
v_cvt_pk_bf16_f32 v21, v238, v239
s_nop 0
v_mfma_f32_16x16x32_bf16 v[228:231], v[196:199], a[128:131], 0
ds_write_b32 v173, v157 offset:516
v_mfma_f32_16x16x32_bf16 v[228:231], v[216:219], a[132:135], v[228:231]
s_waitcnt lgkmcnt(6)
ds_write_b32 v173, v158 offset:576
v_mfma_f32_16x16x32_bf16 v[228:231], v[232:235], a[136:139], v[228:231]
v_cvt_pk_bf16_f32 v22, v208, v209
v_cvt_pk_bf16_f32 v23, v210, v211
v_mfma_f32_16x16x32_bf16 v[228:231], v[200:203], a[140:143], v[228:231]
ds_read_b128 v[224:227], v240 offset:16896
ds_read_b128 v[220:223], v240 offset:17152
v_mfma_f32_16x16x32_bf16 v[208:211], v[20:23], v[108:111], 0
ds_read_b128 v[204:207], v240 offset:17408
ds_read_b128 v[212:215], v240 offset:17664
v_mfma_f32_16x16x32_bf16 v[208:211], v[16:19], v[104:107], v[208:211]
s_nop 1
v_cvt_pk_bf16_f32 v64, v228, v229
v_mfma_f32_16x16x32_bf16 v[236:239], v[16:19], v[160:163], 0
v_cvt_pk_bf16_f32 v65, v230, v231
s_nop 0
v_mfma_f32_16x16x32_bf16 v[236:239], v[20:23], v[164:167], v[236:239]
s_nop 0
v_exp_f32 v208, v208
v_mfma_f32_16x16x32_bf16 v[228:231], v[200:203], a[156:159], 0
ds_write_b32 v173, v159 offset:580
v_mfma_f32_16x16x32_bf16 v[228:231], v[232:235], a[152:155], v[228:231]
ds_write_b32 v172, v32 offset:6912
v_mfma_f32_16x16x32_bf16 v[228:231], v[216:219], a[148:151], v[228:231]
ds_write_b32 v172, v33 offset:6916
v_mfma_f32_16x16x32_bf16 v[228:231], v[196:199], a[144:147], v[228:231]
v_exp_f32 v209, v209
v_exp_f32 v210, v210
v_exp_f32 v211, v211
v_cvt_pk_bf16_f32 v116, v208, v209
v_cvt_pk_bf16_f32 v117, v210, v211
v_mfma_f32_16x16x32_bf16 v[208:211], v[196:199], a[160:163], 0
v_exp_f32 v236, v236
v_mfma_f32_16x16x32_bf16 v[208:211], v[216:219], a[164:167], v[208:211]
v_cvt_pk_bf16_f32 v68, v228, v229
v_cvt_pk_bf16_f32 v69, v230, v231
v_mfma_f32_16x16x32_bf16 v[208:211], v[232:235], a[168:171], v[208:211]
v_exp_f32 v237, v237
v_mfma_f32_16x16x32_bf16 v[208:211], v[200:203], a[172:175], v[208:211]
s_waitcnt lgkmcnt(5)
v_exp_f32 v238, v238
v_mfma_f32_16x16x32_bf16 v[228:231], v[200:203], a[188:191], 0
s_waitcnt lgkmcnt(3)
ds_write_b32 v172, v34 offset:6976
v_mfma_f32_16x16x32_bf16 v[228:231], v[232:235], a[184:187], v[228:231]
ds_write_b32 v172, v35 offset:6980
v_mfma_f32_16x16x32_bf16 v[228:231], v[216:219], a[180:183], v[228:231]
ds_write_b32 v173, v36 offset:6912
v_mfma_f32_16x16x32_bf16 v[228:231], v[196:199], a[176:179], v[228:231]
ds_write_b32 v173, v37 offset:6916
v_mfma_f32_16x16x32_bf16 v[196:199], a[64:67], v[224:227], 0
ds_write_b32 v173, v38 offset:6976
v_mfma_f32_16x16x32_bf16 v[196:199], a[68:71], v[220:223], v[196:199]
ds_write_b32 v173, v39 offset:6980
v_mfma_f32_16x16x32_bf16 v[196:199], a[72:75], v[204:207], v[196:199]
v_cvt_pk_bf16_f32 v72, v208, v209
v_cvt_pk_bf16_f32 v73, v210, v211
v_mfma_f32_16x16x32_bf16 v[196:199], a[76:79], v[212:215], v[196:199]
buffer_load_dwordx4 v241, s[16:19], s98 offen offset:0 nt lds
v_mfma_f32_16x16x32_bf16 v[200:203], a[92:95], v[212:215], 0
buffer_load_dwordx4 v241, s[16:19], s99 offen offset:1056 nt lds
v_mfma_f32_16x16x32_bf16 v[200:203], a[88:91], v[204:207], v[200:203]
v_cvt_pk_bf16_f32 v76, v228, v229
v_cvt_pk_bf16_f32 v77, v230, v231
v_mfma_f32_16x16x32_bf16 v[200:203], a[84:87], v[220:223], v[200:203]
s_nop 0
v_cvt_pk_bf16_f32 v32, v196, v197
v_cvt_pk_bf16_f32 v33, v198, v199
v_mfma_f32_16x16x32_bf16 v[200:203], a[80:83], v[224:227], v[200:203]
v_exp_f32 v239, v239
v_mfma_f32_16x16x32_bf16 v[196:199], a[96:99], v[224:227], 0
v_cvt_pk_bf16_f32 v132, v236, v237
v_cvt_pk_bf16_f32 v133, v238, v239
v_mfma_f32_16x16x32_bf16 v[196:199], a[100:103], v[220:223], v[196:199]
ds_write_b32 v172, v24 offset:6400
v_mfma_f32_16x16x32_bf16 v[196:199], a[104:107], v[204:207], v[196:199]
s_nop 0
v_cvt_pk_bf16_f32 v34, v200, v201
v_cvt_pk_bf16_f32 v35, v202, v203
v_mfma_f32_16x16x32_bf16 v[196:199], a[108:111], v[212:215], v[196:199]
buffer_load_dwordx4 v241, s[16:19], s100 offen offset:2112 nt lds
v_mfma_f32_16x16x32_bf16 v[208:211], a[124:127], v[212:215], 0
buffer_load_dwordx4 v241, s[16:19], s101 offen offset:3168 nt lds
v_mfma_f32_16x16x32_bf16 v[208:211], a[120:123], v[204:207], v[208:211]
ds_write_b32 v172, v25 offset:6404
v_mfma_f32_16x16x32_bf16 v[208:211], a[116:119], v[220:223], v[208:211]
s_nop 1
v_cvt_pk_bf16_f32 v36, v196, v197
v_mfma_f32_16x16x32_bf16 v[208:211], a[112:115], v[224:227], v[208:211]
v_cvt_pk_bf16_f32 v37, v198, v199
s_nop 0
v_mfma_f32_16x16x32_bf16 v[196:199], v[224:227], a[128:131], 0
ds_write_b32 v172, v26 offset:6464
v_mfma_f32_16x16x32_bf16 v[196:199], v[220:223], a[132:135], v[196:199]
ds_write_b32 v172, v27 offset:6468
v_mfma_f32_16x16x32_bf16 v[196:199], v[204:207], a[136:139], v[196:199]
s_nop 0
v_cvt_pk_bf16_f32 v38, v208, v209
v_cvt_pk_bf16_f32 v39, v210, v211
v_mfma_f32_16x16x32_bf16 v[196:199], v[212:215], a[140:143], v[196:199]
ds_write_b32 v173, v28 offset:6400
v_mfma_f32_16x16x32_bf16 v[200:203], v[36:39], v[108:111], 0
ds_write_b32 v173, v29 offset:6404
v_mfma_f32_16x16x32_bf16 v[200:203], v[32:35], v[104:107], v[200:203]
ds_write_b32 v173, v30 offset:6464
s_nop 2
v_cvt_pk_bf16_f32 v80, v196, v197
v_cvt_pk_bf16_f32 v81, v198, v199
v_mfma_f32_16x16x32_bf16 v[196:199], v[32:35], v[160:163], 0
s_nop 0
v_exp_f32 v200, v200
v_mfma_f32_16x16x32_bf16 v[196:199], v[36:39], v[164:167], v[196:199]
ds_read_b128 v[208:211], v240 offset:12672
ds_read_b128 v[216:219], v240 offset:12928
v_mfma_f32_16x16x32_bf16 v[228:231], v[212:215], a[156:159], 0
ds_read_b128 v[232:235], v240 offset:13184
s_nop 0
v_mfma_f32_16x16x32_bf16 v[228:231], v[204:207], a[152:155], v[228:231]
v_exp_f32 v201, v201
v_mfma_f32_16x16x32_bf16 v[228:231], v[220:223], a[148:151], v[228:231]
v_exp_f32 v202, v202
v_mfma_f32_16x16x32_bf16 v[228:231], v[224:227], a[144:147], v[228:231]
v_exp_f32 v203, v203
v_mfma_f32_16x16x32_bf16 v[236:239], v[224:227], a[160:163], 0
v_cvt_pk_bf16_f32 v120, v200, v201
v_cvt_pk_bf16_f32 v121, v202, v203
v_mfma_f32_16x16x32_bf16 v[236:239], v[220:223], a[164:167], v[236:239]
ds_read_b128 v[200:203], v240 offset:13440
s_nop 0
v_mfma_f32_16x16x32_bf16 v[236:239], v[204:207], a[168:171], v[236:239]
v_cvt_pk_bf16_f32 v84, v228, v229
v_cvt_pk_bf16_f32 v85, v230, v231
v_mfma_f32_16x16x32_bf16 v[236:239], v[212:215], a[172:175], v[236:239]
v_exp_f32 v196, v196
v_mfma_f32_16x16x32_bf16 v[228:231], v[212:215], a[188:191], 0
v_exp_f32 v197, v197
v_mfma_f32_16x16x32_bf16 v[228:231], v[204:207], a[184:187], v[228:231]
v_exp_f32 v198, v198
v_mfma_f32_16x16x32_bf16 v[228:231], v[220:223], a[180:183], v[228:231]
s_waitcnt lgkmcnt(3)
v_exp_f32 v199, v199
v_mfma_f32_16x16x32_bf16 v[228:231], v[224:227], a[176:179], v[228:231]
s_waitcnt lgkmcnt(2)
v_cvt_pk_bf16_f32 v88, v236, v237
v_cvt_pk_bf16_f32 v89, v238, v239
v_mfma_f32_16x16x32_bf16 v[236:239], a[64:67], v[208:211], 0
s_waitcnt vmcnt(4)
s_barrier
v_mfma_f32_16x16x32_bf16 v[236:239], a[68:71], v[216:219], v[236:239]
s_waitcnt lgkmcnt(0)
ds_read_b64_tr_b16 a[192:193], v190 offset:0
v_cvt_pk_bf16_f32 v92, v228, v229
v_mfma_f32_16x16x32_bf16 v[236:239], a[72:75], v[232:235], v[236:239]
ds_read_b64_tr_b16 a[194:195], v190 offset:512
v_cvt_pk_bf16_f32 v93, v230, v231
v_mfma_f32_16x16x32_bf16 v[236:239], a[76:79], v[200:203], v[236:239]
ds_read_b64_tr_b16 a[196:197], v190 offset:4096
v_cvt_pk_bf16_f32 v136, v196, v197
v_mfma_f32_16x16x32_bf16 v[228:231], a[92:95], v[200:203], 0
ds_read_b64_tr_b16 a[198:199], v190 offset:4608
v_cvt_pk_bf16_f32 v137, v198, v199
v_mfma_f32_16x16x32_bf16 v[228:231], a[88:91], v[232:235], v[228:231]
ds_read_b64_tr_b16 a[200:201], v190 offset:8192
v_mfma_f32_16x16x32_bf16 v[228:231], a[84:87], v[216:219], v[228:231]
ds_read_b64_tr_b16 a[202:203], v190 offset:8704
v_cvt_pk_bf16_f32 v24, v236, v237
v_mfma_f32_16x16x32_bf16 v[228:231], a[80:83], v[208:211], v[228:231]
ds_read_b64_tr_b16 a[204:205], v190 offset:12288
v_cvt_pk_bf16_f32 v25, v238, v239
v_mfma_f32_16x16x32_bf16 v[236:239], a[96:99], v[208:211], 0
ds_read_b64_tr_b16 a[206:207], v190 offset:12800
s_nop 0
v_mfma_f32_16x16x32_bf16 v[236:239], a[100:103], v[216:219], v[236:239]
ds_read_b64_tr_b16 a[208:209], v190 offset:8
v_mfma_f32_16x16x32_bf16 v[236:239], a[104:107], v[232:235], v[236:239]
ds_read_b64_tr_b16 a[210:211], v190 offset:520
v_cvt_pk_bf16_f32 v26, v228, v229
v_mfma_f32_16x16x32_bf16 v[236:239], a[108:111], v[200:203], v[236:239]
ds_read_b64_tr_b16 a[212:213], v190 offset:4104
v_cvt_pk_bf16_f32 v27, v230, v231
v_mfma_f32_16x16x32_bf16 v[228:231], a[124:127], v[200:203], 0
ds_read_b64_tr_b16 a[214:215], v190 offset:4616
s_nop 0
v_mfma_f32_16x16x32_bf16 v[228:231], a[120:123], v[232:235], v[228:231]
ds_read_b64_tr_b16 a[216:217], v190 offset:8200
v_mfma_f32_16x16x32_bf16 v[228:231], a[116:119], v[216:219], v[228:231]
s_waitcnt lgkmcnt(12)
ds_read_b64_tr_b16 a[218:219], v190 offset:8712
v_cvt_pk_bf16_f32 v28, v236, v237
v_mfma_f32_16x16x32_bf16 v[228:231], a[112:115], v[208:211], v[228:231]
s_waitcnt lgkmcnt(12)
ds_read_b64_tr_b16 a[220:221], v190 offset:12296
v_cvt_pk_bf16_f32 v29, v238, v239
v_mfma_f32_16x16x32_bf16 v[196:199], v[208:211], a[128:131], 0
s_waitcnt lgkmcnt(12)
ds_read_b64_tr_b16 a[222:223], v190 offset:12808
s_nop 0
v_mfma_f32_16x16x32_bf16 v[196:199], v[216:219], a[132:135], v[196:199]
s_waitcnt lgkmcnt(12)
ds_read_b64_tr_b16 a[224:225], v191 offset:0
v_cvt_pk_bf16_f32 v30, v228, v229
v_mfma_f32_16x16x32_bf16 v[196:199], v[232:235], a[136:139], v[196:199]
s_waitcnt lgkmcnt(12)
ds_read_b64_tr_b16 a[226:227], v191 offset:512
v_mfma_f32_16x16x32_bf16 v[196:199], v[200:203], a[140:143], v[196:199]
s_waitcnt lgkmcnt(12)
ds_write_b32 v173, v31 offset:6468
s_nop 1
v_cvt_pk_bf16_f32 v31, v230, v231
s_nop 1
v_mfma_f32_16x16x32_bf16 v[236:239], v[28:31], v[108:111], 0
s_waitcnt lgkmcnt(11)
ds_read_b128 v[228:231], v245 offset:0
v_cvt_pk_bf16_f32 v66, v196, v197
v_mfma_f32_16x16x32_bf16 v[236:239], v[24:27], v[104:107], v[236:239]
s_waitcnt lgkmcnt(11)
v_cvt_pk_bf16_f32 v67, v198, v199
v_mov_b64 v[176:177], 0
v_mfma_f32_16x16x32_bf16 v[196:199], v[24:27], v[160:163], 0
s_waitcnt lgkmcnt(10)
v_mov_b64 v[178:179], 0
v_mov_b64 v[180:181], 0
v_mfma_f32_16x16x32_bf16 v[196:199], v[28:31], v[164:167], v[196:199]
s_waitcnt lgkmcnt(9)
v_exp_f32 v236, v236
v_exp_f32 v237, v237
v_exp_f32 v238, v238
v_exp_f32 v239, v239
v_cvt_pk_bf16_f32 v118, v236, v237
v_cvt_pk_bf16_f32 v119, v238, v239
v_mfma_f32_16x16x32_bf16 v[236:239], v[200:203], a[156:159], 0
s_waitcnt lgkmcnt(6)
v_mov_b64 v[182:183], 0
v_mov_b64 v[184:185], 0
v_mfma_f32_16x16x32_bf16 v[236:239], v[232:235], a[152:155], v[236:239]
s_waitcnt lgkmcnt(5)
v_mov_b64 v[186:187], 0
v_mfma_f32_16x16x32_bf16 v[236:239], v[216:219], a[148:151], v[236:239]
s_waitcnt lgkmcnt(0)
ds_read_b128 v[160:163], v240 offset:21120
ds_read_b128 v[164:167], v240 offset:21376
v_mfma_f32_16x16x32_bf16 v[236:239], v[208:211], a[144:147], v[236:239]
ds_read_b128 v[168:171], v240 offset:21632
ds_read_b128 v[172:175], v240 offset:21888
v_smfmac_f32_16x16x64_bf16 v[176:179], v[228:231], v[0:7], v250
s_nop 2
v_smfmac_f32_16x16x64_bf16 v[180:183], v[228:231], v[16:23], v250
ds_read_b64_tr_b16 a[228:229], v191 offset:4096
v_cvt_pk_bf16_f32 v70, v236, v237
v_smfmac_f32_16x16x64_bf16 v[184:187], v[228:231], v[32:39], v250
ds_read_b64_tr_b16 a[230:231], v191 offset:4608
v_cvt_pk_bf16_f32 v71, v238, v239
v_mfma_f32_16x16x32_bf16 v[236:239], v[208:211], a[160:163], 0
ds_read_b64_tr_b16 a[232:233], v191 offset:8192
v_add_f32 v176, v176, v177
v_mfma_f32_16x16x32_bf16 v[236:239], v[216:219], a[164:167], v[236:239]
ds_read_b64_tr_b16 a[234:235], v191 offset:8704
v_mfma_f32_16x16x32_bf16 v[236:239], v[232:235], a[168:171], v[236:239]
ds_read_b64_tr_b16 a[236:237], v191 offset:12288
v_mfma_f32_16x16x32_bf16 v[236:239], v[200:203], a[172:175], v[236:239]
ds_read_b64_tr_b16 a[238:239], v191 offset:12800
s_nop 0
v_smfmac_f32_16x16x64_bf16 v[178:181], v[228:231], v[8:15], v250
ds_read_b64_tr_b16 a[240:241], v191 offset:8
s_nop 0
v_smfmac_f32_16x16x64_bf16 v[182:185], v[228:231], v[24:31], v250
ds_read_b64_tr_b16 a[242:243], v191 offset:520
s_nop 0
v_smfmac_f32_16x16x64_bf16 v[186:189], v[228:231], v[40:47], v250
ds_read_b64_tr_b16 a[244:245], v191 offset:4104
v_cvt_pk_bf16_f32 v74, v236, v237
v_mfma_f32_16x16x32_bf16 v[228:231], v[200:203], a[188:191], 0
ds_read_b64_tr_b16 a[246:247], v191 offset:4616
v_mov_b64 v[200:201], 0
v_mfma_f32_16x16x32_bf16 v[228:231], v[232:235], a[184:187], v[228:231]
s_waitcnt lgkmcnt(12)
ds_read_b64_tr_b16 a[248:249], v191 offset:8200
ds_read_b128 v[232:235], v240 offset:512
v_mfma_f32_16x16x32_bf16 v[228:231], v[216:219], a[180:183], v[228:231]
s_waitcnt lgkmcnt(12)
ds_read_b64_tr_b16 a[250:251], v191 offset:8712
ds_read_b128 v[216:219], v240 offset:0
v_mfma_f32_16x16x32_bf16 v[228:231], v[208:211], a[176:179], v[228:231]
ds_read_b64_tr_b16 a[252:253], v191 offset:12296
v_cvt_pk_bf16_f32 v75, v238, v239
v_smfmac_f32_16x16x64_bf16 v[200:203], v[192:195], v[112:119], v250
s_waitcnt lgkmcnt(14)
ds_read_b64_tr_b16 a[254:255], v191 offset:12808
ds_read_b128 v[236:239], v240 offset:768
v_smfmac_f32_16x16x64_bf16 v[200:203], v[192:195], v[120:127], v250 abid:1
s_waitcnt lgkmcnt(15)
ds_read_b128 v[208:211], v240 offset:256
v_add_f32 v178, v178, v179
v_mfma_f32_16x16x32_bf16 v[144:147], a[192:195], v[160:163], 0
s_waitcnt lgkmcnt(15)
v_exp_f32 v176, v176
v_mfma_f32_16x16x32_bf16 v[144:147], a[196:199], v[164:167], v[144:147]
s_waitcnt lgkmcnt(14)
v_exp_f32 v178, v178
v_mfma_f32_16x16x32_bf16 v[144:147], a[200:203], v[168:171], v[144:147]
s_waitcnt lgkmcnt(13)
v_add_f32 v180, v180, v181
v_add_f32 v182, v182, v183
v_mfma_f32_16x16x32_bf16 v[144:147], a[204:207], v[172:175], v[144:147]
s_waitcnt lgkmcnt(12)
v_exp_f32 v180, v180
v_mfma_f32_16x16x32_bf16 v[148:151], a[220:223], v[172:175], 0
s_waitcnt lgkmcnt(2)
s_barrier
v_mfma_f32_16x16x32_bf16 v[148:151], a[216:219], v[168:171], v[148:151]
s_add_u32 s98, s98, s48
v_exp_f32 v182, v182
v_mfma_f32_16x16x32_bf16 v[148:151], a[212:215], v[164:167], v[148:151]
s_add_u32 s99, s98, s51
v_add_f32 v184, v184, v185
v_add_f32 v186, v186, v187
v_mfma_f32_16x16x32_bf16 v[148:151], a[208:211], v[160:163], v[148:151]
s_add_u32 s100, s99, s51
v_exp_f32 v184, v184
v_mfma_f32_16x16x32_bf16 v[152:155], a[224:227], v[160:163], 0
s_add_u32 m0, s49, 8448
v_add_f32 v188, v176, v178
v_cvt_pk_bf16_f32 v177, v176, v178
v_mfma_f32_16x16x32_bf16 v[152:155], a[228:231], v[164:167], v[152:155]
s_add_u32 s101, s100, s51
ds_write_b16 v246, v177 offset:0
v_mfma_f32_16x16x32_bf16 v[152:155], a[232:235], v[168:171], v[152:155]
s_waitcnt lgkmcnt(2)
ds_write_b16_d16_hi v246, v177 offset:4
v_mfma_f32_16x16x32_bf16 v[152:155], a[236:239], v[172:175], v[152:155]
buffer_load_dwordx4 v241, s[16:19], s98 offen offset:0 nt lds
v_mfma_f32_16x16x32_bf16 v[156:159], a[252:255], v[172:175], 0
buffer_load_dwordx4 v241, s[16:19], s99 offen offset:1056 nt lds
v_mfma_f32_16x16x32_bf16 v[156:159], a[244:247], v[164:167], v[156:159]
s_add_u32 s98, s98, s48
v_exp_f32 v186, v186
v_mfma_f32_16x16x32_bf16 v[156:159], a[240:243], v[160:163], v[156:159]
s_add_u32 s99, s98, s51
v_add_f32 v188, v188, v180
v_add_f32 v188, v188, v182
v_mfma_f32_16x16x32_bf16 v[156:159], a[248:251], v[168:171], v[156:159]
buffer_load_dwordx4 v241, s[16:19], s100 offen offset:2112 nt lds
v_mfma_f32_16x16x32_bf16 v[172:175], a[248:251], v[232:235], 0
buffer_load_dwordx4 v241, s[16:19], s101 offen offset:3168 nt lds
v_mfma_f32_16x16x32_bf16 v[172:175], a[252:255], v[236:239], v[172:175]
s_add_u32 s100, s99, s51
v_add_f32 v188, v188, v184
s_waitcnt lgkmcnt(2)
v_mfma_f32_16x16x32_bf16 v[172:175], a[244:247], v[208:211], v[172:175]
s_add_u32 m0, s49, 16896
v_add_f32 v188, v188, v186
v_cvt_pk_bf16_f32 v181, v180, v182
v_mfma_f32_16x16x32_bf16 v[172:175], a[240:243], v[216:219], v[172:175]
s_add_u32 s101, s100, s51
ds_write_b16 v246, v181 offset:272
v_add_f32_dpp v188, v188, v188 row_ror:8 row_mask:0xf bank_mask:0xf
v_cvt_pk_bf16_f32 v185, v184, v186
s_nop 0
v_add_f32_dpp v188, v188, v188 row_ror:4 row_mask:0xf bank_mask:0xf
ds_write_b16_d16_hi v246, v181 offset:276
ds_write_b16 v246, v185 offset:544
ds_write_b32 v249, v188 offset:0
ds_write_b16_d16_hi v246, v185 offset:548
v_cvt_pk_bf16_f32 v78, v228, v229
v_cvt_pk_bf16_f32 v79, v230, v231
v_mfma_f32_32x32x16_bf16 v[176:191], v[100:103], v[124:127], 0
s_bfe_i32 s57, s3, 0x10000
ds_read_b128 v[228:231], v247 offset:272
v_exp_f32 v196, v196
v_exp_f32 v197, v197
v_add_f32 v200, v200, v201
v_mfma_f32_16x16x32_bf16 v[168:171], a[224:227], v[216:219], 0
s_sub_u32 s45, s45, 1
v_exp_f32 v198, v198
v_mfma_f32_16x16x32_bf16 v[168:171], a[228:231], v[208:211], v[168:171]
s_add_u32 s53, s46, 0
v_exp_f32 v199, v199
v_mfma_f32_16x16x32_bf16 v[168:171], a[232:235], v[232:235], v[168:171]
s_and_b32 s51, s57, 13106176
v_cvt_pk_bf16_f32 v134, v196, v197
v_cvt_pk_bf16_f32 v135, v198, v199
v_mfma_f32_16x16x32_bf16 v[168:171], a[236:239], v[236:239], v[168:171]
buffer_load_dwordx4 v241, s[16:19], s98 offen offset:0 nt lds
v_mfma_f32_16x16x32_bf16 v[164:167], a[220:223], v[236:239], 0
buffer_load_dwordx4 v241, s[16:19], s99 offen offset:1056 nt lds
v_mfma_f32_16x16x32_bf16 v[164:167], a[216:219], v[232:235], v[164:167]
s_add_u32 s52, s46, 20480
v_mov_b64 v[196:197], 0
v_mov_b64 v[198:199], 0
v_mfma_f32_16x16x32_bf16 v[164:167], a[212:215], v[208:211], v[164:167]
s_and_b32 s54, s57, s5
v_rcp_f32 v253, v200
v_mfma_f32_16x16x32_bf16 v[164:167], a[208:211], v[216:219], v[164:167]
buffer_load_dwordx4 v241, s[16:19], s100 offen offset:2112 nt lds
v_mfma_f32_16x16x32_bf16 v[160:163], a[192:195], v[216:219], 0
buffer_load_dwordx4 v241, s[16:19], s101 offen offset:3168 nt lds
v_mfma_f32_16x16x32_bf16 v[160:163], a[196:199], v[208:211], v[160:163]
s_lshl3_add_u32 s48, s51, 8192
v_add_u32 v243, 1600, v243
v_add_u32 v245, 1600, v245
v_mfma_f32_16x16x32_bf16 v[160:163], a[200:203], v[232:235], v[160:163]
s_lshr_b32 s3, s3, 1
v_add_u32 v244, 1600, v244
v_max3_f32 v254, v254, v200, v253
v_mfma_f32_16x16x32_bf16 v[160:163], a[204:207], v[236:239], v[160:163]
s_waitcnt lgkmcnt(0)
ds_read_b128 v[236:239], v247 offset:544
v_add_u32 v249, 1600, v249
v_mfma_f32_16x16x32_bf16 v[176:179], v[48:51], v[112:115], v[176:179]
s_mov_b32 s47, s46
s_add_u32 s50, s50, 13107200
s_sub_u32 s50, s50, s54
v_mfma_f32_16x16x32_bf16 v[176:179], v[64:67], v[116:119], v[176:179]
s_sub_u32 s49, s49, s56
s_sub_u32 s51, s51, 32
v_mfma_f32_16x16x32_bf16 v[176:179], v[80:83], v[120:123], v[176:179]
s_nop 2
v_mfma_f32_16x16x32_bf16 v[180:183], v[84:87], v[120:123], v[180:183]
s_nop 2
v_mfma_f32_16x16x32_bf16 v[180:183], v[52:55], v[112:115], v[180:183]
v_fmac_f32 v144, v176, v253
v_fmac_f32 v145, v177, v253
v_mfma_f32_16x16x32_bf16 v[180:183], v[68:71], v[116:119], v[180:183]
v_cvt_pk_bf16_f32 v144, v144, v145
v_fmac_f32 v146, v178, v253
v_mfma_f32_16x16x32_bf16 v[184:187], v[72:75], v[116:119], v[184:187]
v_fmac_f32 v147, v179, v253
v_cvt_pk_bf16_f32 v145, v146, v147
v_mfma_f32_16x16x32_bf16 v[184:187], v[88:91], v[120:123], v[184:187]
s_nop 1
v_fmac_f32 v149, v181, v253
v_mfma_f32_16x16x32_bf16 v[184:187], v[56:59], v[112:115], v[184:187]
v_fmac_f32 v151, v183, v253
v_fmac_f32 v150, v182, v253
v_mfma_f32_16x16x32_bf16 v[188:191], v[60:63], v[112:115], v[188:191]
v_cvt_pk_bf16_f32 v147, v150, v151
v_fmac_f32 v148, v180, v253
v_mfma_f32_16x16x32_bf16 v[188:191], v[76:79], v[116:119], v[188:191]
v_cvt_pk_bf16_f32 v146, v148, v149
v_mfma_f32_16x16x32_bf16 v[188:191], v[92:95], v[120:123], v[188:191]
v_fmac_f32 v152, v184, v253
v_fmac_f32 v155, v187, v253
v_mfma_f32_16x16x32_bf16 v[208:211], a[0:3], v[224:227], 0
s_waitcnt lgkmcnt(0)
v_fmac_f32 v154, v186, v253
v_fmac_f32 v153, v185, v253
v_mfma_f32_16x16x32_bf16 v[208:211], a[4:7], v[220:223], v[208:211]
v_cvt_pk_bf16_f32 v152, v152, v153
v_fmac_f32 v157, v189, v253
v_mfma_f32_16x16x32_bf16 v[208:211], a[8:11], v[204:207], v[208:211]
v_fmac_f32 v158, v190, v253
v_fmac_f32 v156, v188, v253
v_mfma_f32_16x16x32_bf16 v[208:211], a[12:15], v[212:215], v[208:211]
v_cvt_pk_bf16_f32 v153, v154, v155
v_cvt_pk_bf16_f32 v154, v156, v157
v_mfma_f32_16x16x32_bf16 v[216:219], a[28:31], v[212:215], 0
v_fmac_f32 v159, v191, v253
v_cvt_pk_bf16_f32 v155, v158, v159
v_mfma_f32_16x16x32_bf16 v[216:219], a[24:27], v[204:207], v[216:219]
v_pk_max_i16 v155, v155, 0
v_pk_max_i16 v152, v152, 0
v_mfma_f32_16x16x32_bf16 v[216:219], a[20:23], v[220:223], v[216:219]
v_cvt_pk_bf16_f32 v105, v210, v211
v_cvt_pk_bf16_f32 v104, v208, v209
v_mfma_f32_16x16x32_bf16 v[216:219], a[16:19], v[224:227], v[216:219]
ds_read_b128 v[208:211], v247 offset:0
v_pk_max_i16 v153, v153, 0
v_mfma_f32_16x16x32_bf16 v[232:235], a[32:35], v[224:227], 0
s_nop 2
v_mfma_f32_16x16x32_bf16 v[232:235], a[36:39], v[220:223], v[232:235]
s_nop 0
v_cvt_pk_bf16_f32 v106, v216, v217
v_cvt_pk_bf16_f32 v107, v218, v219
v_mfma_f32_16x16x32_bf16 v[232:235], a[40:43], v[204:207], v[232:235]
v_mfma_f32_16x16x32_bf16 v[232:235], a[44:47], v[212:215], v[232:235]
s_nop 2
v_mfma_f32_16x16x32_bf16 v[216:219], a[60:63], v[212:215], 0
s_nop 2
v_mfma_f32_16x16x32_bf16 v[216:219], a[56:59], v[204:207], v[216:219]
v_cvt_pk_bf16_f32 v108, v232, v233
v_mov_b64 v[232:233], 0
v_mfma_f32_16x16x32_bf16 v[216:219], a[52:55], v[220:223], v[216:219]
s_waitcnt lgkmcnt(0)
v_cvt_pk_bf16_f32 v109, v234, v235
v_mov_b64 v[234:235], 0
v_mfma_f32_16x16x32_bf16 v[216:219], a[48:51], v[224:227], v[216:219]
s_nop 2
v_smfmac_f32_16x16x64_bf16 v[196:199], v[208:211], v[48:55], v250
s_nop 2
v_smfmac_f32_16x16x64_bf16 v[196:199], v[228:231], v[64:71], v250
v_cvt_pk_bf16_f32 v110, v216, v217
v_smfmac_f32_16x16x64_bf16 v[196:199], v[236:239], v[80:87], v250
v_cvt_pk_bf16_f32 v111, v218, v219
v_smfmac_f32_16x16x64_bf16 v[232:235], v[236:239], v[88:95], v250
v_mov_b64 v[218:219], s[96:97]
v_smfmac_f32_16x16x64_bf16 v[232:235], v[228:231], v[72:79], v250
v_mov_b64 v[216:217], s[96:97]
v_smfmac_f32_16x16x64_bf16 v[232:235], v[208:211], v[56:63], v250
s_nop 1
v_add_f32 v196, v196, v197
v_smfmac_f32_16x16x64_bf16 v[216:219], v[96:99], v[104:111], v250
v_add_f32 v198, v198, v199
v_mfma_f32_16x16x32_bf16 v[208:211], v[0:3], v[104:107], 0
ds_write2_b32 v248, v196, v198 offset0:0 offset1:16
v_mfma_f32_16x16x32_bf16 v[208:211], v[4:7], v[108:111], v[208:211]
s_nop 7
s_waitcnt lgkmcnt(0)
s_branch L_entryf
L_spin:
ds_read_u16 v196, v255 offset:0
s_waitcnt lgkmcnt(0)
v_cmp_lt_u32 vcc, s45, v196
s_nop 1
s_cbranch_vccnz L_spin
s_branch L_back
.p2align 6
L_loopf:
buffer_store_dwordx4 v[168:171], v242, s[20:23], s53 offen offset:64 nt
v_exp_f32 v199, v199
v_exp_f32 v198, v198
v_mfma_f32_16x16x32_bf16 v[220:223], a[60:63], v[216:219], 0
s_add_u32 s52, s47, 8192
v_cvt_pk_bf16_f32 v109, v238, v239
v_cvt_pk_bf16_f32 v108, v236, v237
v_mfma_f32_16x16x32_bf16 v[220:223], a[56:59], v[228:231], v[220:223]
s_add_u32 s53, s47, 12288
v_exp_f32 v209, v209
v_mfma_f32_16x16x32_bf16 v[220:223], a[52:55], v[212:215], v[220:223]
s_bfe_i32 s57, s3, 0x10000
v_exp_f32 v210, v210
v_mfma_f32_16x16x32_bf16 v[220:223], a[48:51], v[224:227], v[220:223]
s_and_b32 s54, s57, s5
v_exp_f32 v208, v208
v_mfma_f32_16x16x32_bf16 v[160:163], a[192:195], v[224:227], 0
s_lshr_b32 s3, s3, 1
v_exp_f32 v211, v211
v_mfma_f32_16x16x32_bf16 v[160:163], a[196:199], v[212:215], v[160:163]
s_mov_b32 s47, s46
v_cvt_pk_bf16_f32 v115, v210, v211
v_cvt_pk_bf16_f32 v110, v220, v221
v_mfma_f32_16x16x32_bf16 v[160:163], a[200:203], v[228:231], v[160:163]
ds_read_u16 v196, v255 offset:0
v_cvt_pk_bf16_f32 v111, v222, v223
v_mfma_f32_16x16x32_bf16 v[160:163], a[204:207], v[216:219], v[160:163]
v_cvt_pk_bf16_f32 v114, v208, v209
v_cvt_pk_bf16_f32 v121, v198, v199
v_mfma_f32_16x16x32_bf16 v[164:167], a[220:223], v[216:219], 0
v_exp_f32 v205, v205
v_mfma_f32_16x16x32_bf16 v[164:167], a[216:219], v[228:231], v[164:167]
v_exp_f32 v204, v204
v_mfma_f32_16x16x32_bf16 v[164:167], a[212:215], v[212:215], v[164:167]
v_exp_f32 v207, v207
v_mfma_f32_16x16x32_bf16 v[164:167], a[208:211], v[224:227], v[164:167]
v_cvt_pk_bf16_f32 v112, v204, v205
v_mfma_f32_16x16x32_bf16 v[168:171], a[224:227], v[224:227], 0
s_waitcnt lgkmcnt(0)
v_cmp_lt_u32 vcc, s45, v196
s_nop 0
v_mfma_f32_16x16x32_bf16 v[168:171], a[228:231], v[212:215], v[168:171]
s_cbranch_vccnz L_spin
L_back:
ds_read_b128 v[196:199], v240 offset:0
ds_read_b128 v[220:223], v240 offset:256
v_mfma_f32_16x16x32_bf16 v[168:171], a[232:235], v[228:231], v[168:171]
s_mov_b32 s98, s50
ds_read_b128 v[236:239], v240 offset:512
s_add_u32 s99, s98, s51
v_mfma_f32_16x16x32_bf16 v[168:171], a[236:239], v[216:219], v[168:171]
s_add_u32 s100, s99, s51
v_exp_f32 v206, v206
v_mfma_f32_16x16x32_bf16 v[172:175], a[252:255], v[216:219], 0
s_add_u32 s101, s100, s51
v_mov_b64 v[218:219], s[96:97]
v_mov_b64 v[216:217], s[96:97]
v_mfma_f32_16x16x32_bf16 v[172:175], a[248:251], v[228:231], v[172:175]
s_add_u32 m0, s49, 0
v_cvt_pk_bf16_f32 v113, v206, v207
s_sub_u32 s45, s45, 1
v_mfma_f32_16x16x32_bf16 v[172:175], a[244:247], v[212:215], v[172:175]
s_add_u32 s50, s50, 13107200
v_exp_f32 v203, v203
v_mfma_f32_16x16x32_bf16 v[172:175], a[240:243], v[224:227], v[172:175]
s_waitcnt lgkmcnt(2)
v_exp_f32 v202, v202
v_smfmac_f32_16x16x64_bf16 v[216:219], v[96:99], v[104:111], v250
s_sub_u32 s50, s50, s54
ds_read_b128 v[96:99], v243 offset:0
v_cvt_pk_bf16_f32 v119, v202, v203
v_mfma_f32_16x16x32_bf16 v[208:211], v[0:3], v[104:107], 0
v_exp_f32 v200, v200
v_mfma_f32_16x16x32_bf16 v[208:211], v[4:7], v[108:111], v[208:211]
v_exp_f32 v201, v201
v_mfma_f32_16x16x32_bf16 v[212:215], v[12:15], v[108:111], 0
v_cvt_pk_bf16_f32 v118, v200, v201
v_add_f32 v218, v218, v219
v_mfma_f32_16x16x32_bf16 v[212:215], v[8:11], v[104:107], v[212:215]
s_waitcnt lgkmcnt(2)
ds_read_b128 v[200:203], v240 offset:768
v_add_f32 v216, v216, v217
v_mfma_f32_16x16x32_bf16 v[204:207], a[64:67], v[196:199], 0
s_waitcnt lgkmcnt(2)
v_exp_f32 v234, v234
v_mfma_f32_16x16x32_bf16 v[204:207], a[68:71], v[220:223], v[204:207]
v_mov_b64 v[224:225], 0
v_add_u32 v243, 1600, v243
v_mfma_f32_16x16x32_bf16 v[204:207], a[72:75], v[236:239], v[204:207]
v_exp_f32 v233, v233
v_exp_f32 v235, v235
v_exp_f32 v232, v232
v_cvt_pk_bf16_f32 v123, v234, v235
v_cvt_pk_bf16_f32 v122, v232, v233
s_waitcnt lgkmcnt(0)
v_mfma_f32_16x16x32_bf16 v[204:207], a[76:79], v[200:203], v[204:207]
buffer_load_dwordx4 v241, s[16:19], s98 offen offset:0 nt lds
v_mfma_f32_16x16x32_bf16 v[228:231], a[92:95], v[200:203], 0
buffer_load_dwordx4 v241, s[16:19], s99 offen offset:1056 nt lds
v_mfma_f32_16x16x32_bf16 v[228:231], a[88:91], v[236:239], v[228:231]
s_add_u32 s98, s98, s48
v_exp_f32 v213, v213
v_mfma_f32_16x16x32_bf16 v[228:231], a[84:87], v[220:223], v[228:231]
s_add_u32 s99, s98, s51
v_exp_f32 v214, v214
v_mfma_f32_16x16x32_bf16 v[228:231], a[80:83], v[196:199], v[228:231]
v_exp_f32 v215, v215
v_smfmac_f32_16x16x64_bf16 v[224:227], v[192:195], v[112:119], v250
v_cvt_pk_bf16_f32 v131, v214, v215
v_smfmac_f32_16x16x64_bf16 v[224:227], v[192:195], v[120:127], v250 abid:1
v_cvt_pk_bf16_f32 v1, v206, v207
v_mfma_f32_16x16x32_bf16 v[232:235], a[96:99], v[196:199], 0
v_exp_f32 v212, v212
v_mfma_f32_16x16x32_bf16 v[232:235], a[100:103], v[220:223], v[232:235]
v_cvt_pk_bf16_f32 v130, v212, v213
v_cvt_pk_bf16_f32 v0, v204, v205
v_mfma_f32_16x16x32_bf16 v[232:235], a[104:107], v[236:239], v[232:235]
ds_read_b128 v[204:207], v240 offset:4224
v_add_f32 v224, v224, v225
v_mfma_f32_16x16x32_bf16 v[232:235], a[108:111], v[200:203], v[232:235]
v_exp_f32 v210, v210
v_mfma_f32_16x16x32_bf16 v[212:215], a[124:127], v[200:203], 0
ds_read_b128 v[200:203], v240 offset:4736
v_cvt_pk_bf16_f32 v2, v228, v229
v_mfma_f32_16x16x32_bf16 v[212:215], a[120:123], v[236:239], v[212:215]
v_exp_f32 v211, v211
v_mfma_f32_16x16x32_bf16 v[212:215], a[116:119], v[220:223], v[212:215]
v_exp_f32 v208, v208
v_mfma_f32_16x16x32_bf16 v[212:215], a[112:115], v[196:199], v[212:215]
v_exp_f32 v209, v209
v_mfma_f32_16x16x32_bf16 v[176:179], v[48:51], v[112:115], v[176:179]
v_cvt_pk_bf16_f32 v128, v208, v209
v_cvt_pk_bf16_f32 v129, v210, v211
v_mfma_f32_16x16x32_bf16 v[176:179], v[64:67], v[116:119], v[176:179]
v_exp_f32 v218, v218
v_mfma_f32_16x16x32_bf16 v[176:179], v[80:83], v[120:123], v[176:179]
v_exp_f32 v216, v216
v_mfma_f32_16x16x32_bf16 v[180:183], v[84:87], v[120:123], v[180:183]
v_perm_b32 v141, v218, v216, v252
v_perm_b32 v140, v218, v216, v251
v_mfma_f32_16x16x32_bf16 v[180:183], v[52:55], v[112:115], v[180:183]
ds_read_b128 v[216:219], v240 offset:4992
v_cvt_pk_bf16_f32 v7, v214, v215
v_mfma_f32_16x16x32_bf16 v[180:183], v[68:71], v[116:119], v[180:183]
v_cvt_pk_bf16_f32 v6, v212, v213
v_cvt_pk_bf16_f32 v3, v230, v231
v_mfma_f32_16x16x32_bf16 v[184:187], v[72:75], v[116:119], v[184:187]
ds_read_b128 v[228:231], v240 offset:4480
v_cvt_pk_bf16_f32 v5, v234, v235
v_mfma_f32_16x16x32_bf16 v[184:187], v[88:91], v[120:123], v[184:187]
s_waitcnt lgkmcnt(3)
v_cvt_pk_bf16_f32 v4, v232, v233
v_mfma_f32_16x16x32_bf16 v[184:187], v[56:59], v[112:115], v[184:187]
v_rcp_f32 v253, v224
v_mfma_f32_16x16x32_bf16 v[188:191], v[60:63], v[112:115], v[188:191]
s_waitcnt lgkmcnt(2)
v_fmac_f32 v149, v181, v253
v_fmac_f32 v150, v182, v253
v_mfma_f32_16x16x32_bf16 v[188:191], v[76:79], v[116:119], v[188:191]
v_fmac_f32 v146, v178, v253
v_fmac_f32 v144, v176, v253
v_mfma_f32_16x16x32_bf16 v[188:191], v[92:95], v[120:123], v[188:191]
v_fmac_f32 v155, v187, v253
v_fmac_f32 v152, v184, v253
v_mfma_f32_16x16x32_bf16 v[196:199], v[16:19], v[104:107], 0
v_fmac_f32 v153, v185, v253
v_cvt_pk_bf16_f32 v152, v152, v153
v_mfma_f32_16x16x32_bf16 v[196:199], v[20:23], v[108:111], v[196:199]
v_max3_f32 v254, v254, v224, v253
v_fmac_f32 v145, v177, v253
v_mfma_f32_16x16x32_bf16 v[208:211], v[28:31], v[108:111], 0
s_waitcnt lgkmcnt(1)
v_fmac_f32 v156, v188, v253
v_fmac_f32 v159, v191, v253
v_mfma_f32_16x16x32_bf16 v[208:211], v[24:27], v[104:107], v[208:211]
v_fmac_f32 v148, v180, v253
v_fmac_f32 v151, v183, v253
v_mfma_f32_16x16x32_bf16 v[212:215], a[124:127], v[216:219], 0
s_waitcnt lgkmcnt(0)
v_exp_f32 v199, v199
v_mfma_f32_16x16x32_bf16 v[212:215], a[120:123], v[200:203], v[212:215]
v_exp_f32 v196, v196
v_mfma_f32_16x16x32_bf16 v[212:215], a[116:119], v[228:231], v[212:215]
v_exp_f32 v208, v208
v_mfma_f32_16x16x32_bf16 v[212:215], a[112:115], v[204:207], v[212:215]
ds_read_b128 v[220:223], v240 offset:8704
ds_read_b128 v[224:227], v240 offset:8448
v_mfma_f32_16x16x32_bf16 v[232:235], a[96:99], v[204:207], 0
v_exp_f32 v211, v211
v_mfma_f32_16x16x32_bf16 v[232:235], a[100:103], v[228:231], v[232:235]
v_exp_f32 v209, v209
v_mfma_f32_16x16x32_bf16 v[232:235], a[104:107], v[200:203], v[232:235]
v_cvt_pk_bf16_f32 v134, v208, v209
v_cvt_pk_bf16_f32 v15, v214, v215
v_mfma_f32_16x16x32_bf16 v[232:235], a[108:111], v[216:219], v[232:235]
v_exp_f32 v210, v210
v_mfma_f32_16x16x32_bf16 v[236:239], a[92:95], v[216:219], 0
v_cvt_pk_bf16_f32 v135, v210, v211
v_cvt_pk_bf16_f32 v14, v212, v213
v_mfma_f32_16x16x32_bf16 v[236:239], a[88:91], v[200:203], v[236:239]
ds_read_b128 v[212:215], v240 offset:8960
v_cvt_pk_bf16_f32 v144, v144, v145
v_mfma_f32_16x16x32_bf16 v[236:239], a[84:87], v[228:231], v[236:239]
v_cvt_pk_bf16_f32 v12, v232, v233
v_cvt_pk_bf16_f32 v13, v234, v235
v_mfma_f32_16x16x32_bf16 v[236:239], a[80:83], v[204:207], v[236:239]
ds_read_b128 v[232:235], v240 offset:9216
v_fmac_f32 v154, v186, v253
v_mfma_f32_16x16x32_bf16 v[208:211], a[64:67], v[204:207], 0
v_exp_f32 v198, v198
v_mfma_f32_16x16x32_bf16 v[208:211], a[72:75], v[200:203], v[208:211]
v_exp_f32 v197, v197
v_mfma_f32_16x16x32_bf16 v[208:211], a[76:79], v[216:219], v[208:211]
s_waitcnt lgkmcnt(3)
v_cvt_pk_bf16_f32 v133, v198, v199
v_cvt_pk_bf16_f32 v132, v196, v197
v_mfma_f32_16x16x32_bf16 v[208:211], a[68:71], v[228:231], v[208:211]
s_waitcnt lgkmcnt(2)
v_fmac_f32 v147, v179, v253
v_cvt_pk_bf16_f32 v145, v146, v147
v_mfma_f32_16x16x32_bf16 v[200:203], a[68:71], v[220:223], 0
s_waitcnt lgkmcnt(1)
v_cvt_pk_bf16_f32 v146, v148, v149
v_fmac_f32 v157, v189, v253
v_mfma_f32_16x16x32_bf16 v[200:203], a[64:67], v[224:227], v[200:203]
s_waitcnt lgkmcnt(0)
v_cvt_pk_bf16_f32 v147, v150, v151
v_pk_max_i16 v147, v147, 0
v_mfma_f32_16x16x32_bf16 v[200:203], a[72:75], v[212:215], v[200:203]
v_fmac_f32 v158, v190, v253
v_pk_max_i16 v146, v146, 0
v_mfma_f32_16x16x32_bf16 v[200:203], a[76:79], v[232:235], v[200:203]
v_cvt_pk_bf16_f32 v153, v154, v155
v_cvt_pk_bf16_f32 v154, v156, v157
v_mfma_f32_16x16x32_bf16 v[196:199], a[92:95], v[232:235], 0
ds_read_b128 v[204:207], v240 offset:13440
v_pk_max_i16 v154, v154, 0
v_mfma_f32_16x16x32_bf16 v[196:199], a[88:91], v[212:215], v[196:199]
ds_read_b128 v[216:219], v240 offset:12928
v_pk_max_i16 v153, v153, 0
v_mfma_f32_16x16x32_bf16 v[196:199], a[84:87], v[220:223], v[196:199]
ds_read_b128 v[228:231], v240 offset:12672
v_cvt_pk_bf16_f32 v16, v200, v201
v_mfma_f32_16x16x32_bf16 v[196:199], a[80:83], v[224:227], v[196:199]
v_cvt_pk_bf16_f32 v17, v202, v203
v_cvt_pk_bf16_f32 v155, v158, v159
v_mfma_f32_16x16x32_bf16 v[200:203], a[96:99], v[224:227], 0
v_pk_max_i16 v155, v155, 0
v_pk_max_i16 v145, v145, 0
v_mfma_f32_16x16x32_bf16 v[200:203], a[100:103], v[220:223], v[200:203]
v_pk_max_i16 v152, v152, 0
v_pk_max_i16 v144, v144, 0
v_mfma_f32_16x16x32_bf16 v[200:203], a[104:107], v[212:215], v[200:203]
v_cvt_pk_bf16_f32 v19, v198, v199
v_cvt_pk_bf16_f32 v18, v196, v197
v_mfma_f32_16x16x32_bf16 v[200:203], a[108:111], v[232:235], v[200:203]
v_cvt_pk_bf16_f32 v8, v208, v209
v_cvt_pk_bf16_f32 v9, v210, v211
v_mfma_f32_32x32x16_bf16 v[176:191], v[100:103], v[140:143], 0
buffer_store_dwordx4 v[144:147], v242, s[20:23], s52 offen offset:0 nt
buffer_store_dwordx4 v[152:155], v242, s[20:23], s52 offen offset:64 nt
buffer_load_dwordx4 v241, s[16:19], s100 offen offset:2112 nt lds
buffer_load_dwordx4 v241, s[16:19], s101 offen offset:3168 nt lds
ds_read_b128 v[208:211], v240 offset:13184
v_cvt_pk_bf16_f32 v21, v202, v203
v_mfma_f32_16x16x32_bf16 v[196:199], a[124:127], v[232:235], 0
s_add_u32 s100, s99, s51
ds_read2_b32 v[100:101], v244 offset0:0 offset1:8
v_cvt_pk_bf16_f32 v20, v200, v201
v_mfma_f32_16x16x32_bf16 v[196:199], a[120:123], v[212:215], v[196:199]
s_add_u32 s101, s100, s51
v_cvt_pk_bf16_f32 v11, v238, v239
v_cvt_pk_bf16_f32 v10, v236, v237
v_mfma_f32_16x16x32_bf16 v[196:199], a[116:119], v[220:223], v[196:199]
s_add_u32 m0, s49, 8448
v_add_u32 v244, 1600, v244
s_add_u32 s52, s46, 20480
v_mfma_f32_16x16x32_bf16 v[196:199], a[112:115], v[224:227], v[196:199]
s_waitcnt lgkmcnt(3)
s_nop 1
v_mfma_f32_16x16x32_bf16 v[200:203], v[36:39], v[108:111], 0
s_waitcnt lgkmcnt(2)
s_nop 1
v_mfma_f32_16x16x32_bf16 v[200:203], v[32:35], v[104:107], v[200:203]
v_cvt_pk_bf16_f32 v22, v196, v197
v_cvt_pk_bf16_f32 v23, v198, v199
v_mfma_f32_16x16x32_bf16 v[196:199], v[40:43], v[104:107], 0
s_nop 2
v_mfma_f32_16x16x32_bf16 v[196:199], v[44:47], v[108:111], v[196:199]
s_waitcnt lgkmcnt(1)
v_exp_f32 v203, v203
v_mfma_f32_16x16x32_bf16 v[212:215], a[124:127], v[204:207], 0
v_exp_f32 v202, v202
v_mfma_f32_16x16x32_bf16 v[212:215], a[120:123], v[208:211], v[212:215]
v_exp_f32 v200, v200
v_mfma_f32_16x16x32_bf16 v[212:215], a[116:119], v[216:219], v[212:215]
s_nop 0
v_exp_f32 v198, v198
v_mfma_f32_16x16x32_bf16 v[212:215], a[112:115], v[228:231], v[212:215]
ds_read_b128 v[220:223], v240 offset:17152
ds_read_b128 v[224:227], v240 offset:16896
v_mfma_f32_16x16x32_bf16 v[232:235], a[96:99], v[228:231], 0
ds_read_b128 v[236:239], v240 offset:17408
v_cvt_pk_bf16_f32 v137, v202, v203
v_mfma_f32_16x16x32_bf16 v[232:235], a[100:103], v[216:219], v[232:235]
s_waitcnt lgkmcnt(3)
v_exp_f32 v196, v196
v_mfma_f32_16x16x32_bf16 v[232:235], a[104:107], v[208:211], v[232:235]
v_cvt_pk_bf16_f32 v31, v214, v215
v_cvt_pk_bf16_f32 v30, v212, v213
v_mfma_f32_16x16x32_bf16 v[232:235], a[108:111], v[204:207], v[232:235]
buffer_load_dwordx4 v241, s[16:19], s98 offen offset:0 nt lds
v_mfma_f32_16x16x32_bf16 v[212:215], a[92:95], v[204:207], 0
buffer_load_dwordx4 v241, s[16:19], s99 offen offset:1056 nt lds
v_mfma_f32_16x16x32_bf16 v[212:215], a[88:91], v[208:211], v[212:215]
s_add_u32 s98, s98, s48
v_exp_f32 v197, v197
v_mfma_f32_16x16x32_bf16 v[212:215], a[84:87], v[216:219], v[212:215]
s_add_u32 s99, s98, s51
v_exp_f32 v199, v199
v_mfma_f32_16x16x32_bf16 v[212:215], a[80:83], v[228:231], v[212:215]
v_cvt_pk_bf16_f32 v138, v196, v197
v_cvt_pk_bf16_f32 v139, v198, v199
v_mfma_f32_16x16x32_bf16 v[196:199], a[64:67], v[228:231], 0
v_exp_f32 v201, v201
v_mfma_f32_16x16x32_bf16 v[196:199], a[72:75], v[208:211], v[196:199]
v_cvt_pk_bf16_f32 v136, v200, v201
v_cvt_pk_bf16_f32 v29, v234, v235
v_mfma_f32_16x16x32_bf16 v[196:199], a[76:79], v[204:207], v[196:199]
s_waitcnt lgkmcnt(2)
ds_read_b128 v[200:203], v240 offset:17664
v_cvt_pk_bf16_f32 v26, v212, v213
v_mfma_f32_16x16x32_bf16 v[196:199], a[68:71], v[216:219], v[196:199]
s_waitcnt lgkmcnt(2)
v_cvt_pk_bf16_f32 v27, v214, v215
v_cvt_pk_bf16_f32 v28, v232, v233
v_mfma_f32_16x16x32_bf16 v[204:207], a[68:71], v[220:223], 0
s_waitcnt lgkmcnt(1)
s_nop 1
v_mfma_f32_16x16x32_bf16 v[204:207], a[64:67], v[224:227], v[204:207]
v_cvt_pk_bf16_f32 v24, v196, v197
v_cvt_pk_bf16_f32 v25, v198, v199
v_mfma_f32_16x16x32_bf16 v[204:207], a[72:75], v[236:239], v[204:207]
s_waitcnt lgkmcnt(0)
v_mfma_f32_16x16x32_bf16 v[204:207], a[76:79], v[200:203], v[204:207]
ds_read_b128 v[228:231], v240 offset:21120
ds_read_b128 v[216:219], v240 offset:21376
v_mfma_f32_16x16x32_bf16 v[212:215], a[92:95], v[200:203], 0
ds_read_b128 v[208:211], v240 offset:21632
ds_read_b128 v[196:199], v240 offset:21888
v_mfma_f32_16x16x32_bf16 v[212:215], a[88:91], v[236:239], v[212:215]
s_nop 1
v_cvt_pk_bf16_f32 v32, v204, v205
v_mfma_f32_16x16x32_bf16 v[212:215], a[84:87], v[220:223], v[212:215]
v_mov_b64 v[204:205], 0
v_cvt_pk_bf16_f32 v33, v206, v207
v_mfma_f32_16x16x32_bf16 v[212:215], a[80:83], v[224:227], v[212:215]
s_nop 2
v_mfma_f32_16x16x32_bf16 v[232:235], a[96:99], v[224:227], 0
s_nop 2
v_mfma_f32_16x16x32_bf16 v[232:235], a[100:103], v[220:223], v[232:235]
v_cvt_pk_bf16_f32 v35, v214, v215
v_cvt_pk_bf16_f32 v34, v212, v213
v_mfma_f32_16x16x32_bf16 v[232:235], a[104:107], v[236:239], v[232:235]
s_waitcnt lgkmcnt(0)
v_mfma_f32_16x16x32_bf16 v[232:235], a[108:111], v[200:203], v[232:235]
s_nop 2
v_smfmac_f32_16x16x64_bf16 v[204:207], v[192:195], v[128:135], v250
s_nop 2
v_smfmac_f32_16x16x64_bf16 v[204:207], v[192:195], v[136:143], v250 abid:1
v_cvt_pk_bf16_f32 v37, v234, v235
v_mfma_f32_16x16x32_bf16 v[212:215], a[124:127], v[200:203], 0
v_cvt_pk_bf16_f32 v36, v232, v233
s_nop 0
v_mfma_f32_16x16x32_bf16 v[212:215], a[120:123], v[236:239], v[212:215]
s_nop 1
v_mfma_f32_16x16x32_bf16 v[212:215], a[116:119], v[220:223], v[212:215]
v_add_f32 v204, v204, v205
v_mfma_f32_16x16x32_bf16 v[212:215], a[112:115], v[224:227], v[212:215]
v_rcp_f32 v253, v204
v_mfma_f32_16x16x32_bf16 v[176:179], v[48:51], v[128:131], v[176:179]
v_max3_f32 v254, v254, v204, v253
s_nop 0
v_mfma_f32_16x16x32_bf16 v[176:179], v[64:67], v[132:135], v[176:179]
s_nop 1
v_mfma_f32_16x16x32_bf16 v[176:179], v[80:83], v[136:139], v[176:179]
v_cvt_pk_bf16_f32 v38, v212, v213
v_cvt_pk_bf16_f32 v39, v214, v215
v_mfma_f32_16x16x32_bf16 v[180:183], v[84:87], v[136:139], v[180:183]
s_nop 2
v_mfma_f32_16x16x32_bf16 v[180:183], v[52:55], v[128:131], v[180:183]
s_nop 0
v_fmac_f32 v162, v178, v253
v_fmac_f32 v163, v179, v253
v_mfma_f32_16x16x32_bf16 v[180:183], v[68:71], v[132:135], v[180:183]
v_fmac_f32 v160, v176, v253
v_fmac_f32 v161, v177, v253
v_mfma_f32_16x16x32_bf16 v[184:187], v[72:75], v[132:135], v[184:187]
v_cvt_pk_bf16_f32 v160, v160, v161
v_pk_max_i16 v160, v160, 0
v_mfma_f32_16x16x32_bf16 v[184:187], v[88:91], v[136:139], v[184:187]
v_cvt_pk_bf16_f32 v161, v162, v163
v_pk_max_i16 v161, v161, 0
v_mfma_f32_16x16x32_bf16 v[184:187], v[56:59], v[128:131], v[184:187]
v_fmac_f32 v166, v182, v253
v_fmac_f32 v167, v183, v253
v_mfma_f32_16x16x32_bf16 v[188:191], v[60:63], v[128:131], v[188:191]
v_fmac_f32 v164, v180, v253
v_fmac_f32 v165, v181, v253
v_mfma_f32_16x16x32_bf16 v[188:191], v[76:79], v[132:135], v[188:191]
v_cvt_pk_bf16_f32 v162, v164, v165
v_pk_max_i16 v162, v162, 0
v_mfma_f32_16x16x32_bf16 v[188:191], v[92:95], v[136:139], v[188:191]
v_fmac_f32 v168, v184, v253
v_fmac_f32 v169, v185, v253
v_mfma_f32_16x16x32_bf16 v[200:203], a[124:127], v[196:199], 0
v_fmac_f32 v170, v186, v253
v_fmac_f32 v171, v187, v253
v_mfma_f32_16x16x32_bf16 v[200:203], a[120:123], v[208:211], v[200:203]
v_cvt_pk_bf16_f32 v168, v168, v169
v_cvt_pk_bf16_f32 v169, v170, v171
v_mfma_f32_16x16x32_bf16 v[200:203], a[116:119], v[216:219], v[200:203]
v_fmac_f32 v173, v189, v253
v_fmac_f32 v172, v188, v253
v_mfma_f32_16x16x32_bf16 v[200:203], a[112:115], v[228:231], v[200:203]
v_fmac_f32 v175, v191, v253
v_cvt_pk_bf16_f32 v170, v172, v173
v_mfma_f32_16x16x32_bf16 v[204:207], a[96:99], v[228:231], 0
v_fmac_f32 v174, v190, v253
v_cvt_pk_bf16_f32 v163, v166, v167
v_mfma_f32_16x16x32_bf16 v[204:207], a[100:103], v[216:219], v[204:207]
v_pk_max_i16 v163, v163, 0
v_cvt_pk_bf16_f32 v171, v174, v175
v_mfma_f32_16x16x32_bf16 v[204:207], a[104:107], v[208:211], v[204:207]
v_cvt_pk_bf16_f32 v47, v202, v203
v_cvt_pk_bf16_f32 v46, v200, v201
v_mfma_f32_16x16x32_bf16 v[204:207], a[108:111], v[196:199], v[204:207]
v_pk_max_i16 v171, v171, 0
v_pk_max_i16 v168, v168, 0
v_mfma_f32_16x16x32_bf16 v[200:203], a[92:95], v[196:199], 0
v_pk_max_i16 v169, v169, 0
v_pk_max_i16 v170, v170, 0
v_mfma_f32_16x16x32_bf16 v[200:203], a[88:91], v[208:211], v[200:203]
s_nop 1
v_cvt_pk_bf16_f32 v44, v204, v205
v_mfma_f32_16x16x32_bf16 v[200:203], a[84:87], v[216:219], v[200:203]
v_cvt_pk_bf16_f32 v45, v206, v207
v_mfma_f32_16x16x32_bf16 v[200:203], a[80:83], v[228:231], v[200:203]
s_nop 2
v_mfma_f32_16x16x32_bf16 v[204:207], a[64:67], v[228:231], 0
s_nop 2
v_mfma_f32_16x16x32_bf16 v[204:207], a[72:75], v[208:211], v[204:207]
v_cvt_pk_bf16_f32 v42, v200, v201
v_cvt_pk_bf16_f32 v43, v202, v203
v_mfma_f32_16x16x32_bf16 v[204:207], a[76:79], v[196:199], v[204:207]
v_mfma_f32_16x16x32_bf16 v[204:207], a[68:71], v[216:219], v[204:207]
ds_read_b128 v[200:203], v245 offset:0
v_add_u32 v245, 1600, v245
v_mfma_f32_16x16x32_bf16 v[212:215], a[4:7], v[216:219], 0
s_nop 2
v_mfma_f32_16x16x32_bf16 v[212:215], a[0:3], v[228:231], v[212:215]
s_nop 0
v_cvt_pk_bf16_f32 v41, v206, v207
v_cvt_pk_bf16_f32 v40, v204, v205
v_mfma_f32_16x16x32_bf16 v[212:215], a[8:11], v[208:211], v[212:215]
v_mfma_f32_16x16x32_bf16 v[212:215], a[12:15], v[196:199], v[212:215]
s_nop 2
v_mfma_f32_16x16x32_bf16 v[204:207], a[28:31], v[196:199], 0
s_nop 2
v_mfma_f32_16x16x32_bf16 v[204:207], a[24:27], v[208:211], v[204:207]
v_cvt_pk_bf16_f32 v104, v212, v213
v_cvt_pk_bf16_f32 v105, v214, v215
v_mfma_f32_16x16x32_bf16 v[204:207], a[20:23], v[216:219], v[204:207]
v_mfma_f32_16x16x32_bf16 v[204:207], a[16:19], v[228:231], v[204:207]
buffer_load_dwordx4 v241, s[16:19], s100 offen offset:2112 nt lds
v_mfma_f32_16x16x32_bf16 v[212:215], a[32:35], v[228:231], 0
buffer_load_dwordx4 v241, s[16:19], s101 offen offset:3168 nt lds
v_mfma_f32_16x16x32_bf16 v[212:215], a[36:39], v[216:219], v[212:215]
s_add_u32 s100, s99, s51
v_mov_b64 v[178:179], 0
v_mov_b64 v[176:177], 0
v_mfma_f32_16x16x32_bf16 v[212:215], a[40:43], v[208:211], v[212:215]
s_add_u32 m0, s49, 16896
v_mov_b64 v[182:183], 0
v_mov_b64 v[180:181], 0
v_mfma_f32_16x16x32_bf16 v[212:215], a[44:47], v[196:199], v[212:215]
s_add_u32 s101, s100, s51
v_mov_b64 v[186:187], 0
v_mov_b64 v[184:185], 0
v_mfma_f32_16x16x32_bf16 v[220:223], a[60:63], v[196:199], 0
s_waitcnt lgkmcnt(0)
v_cvt_pk_bf16_f32 v107, v206, v207
v_cvt_pk_bf16_f32 v106, v204, v205
v_mfma_f32_16x16x32_bf16 v[220:223], a[56:59], v[208:211], v[220:223]
s_and_b32 s51, s57, 13106176
v_cvt_pk_bf16_f32 v108, v212, v213
v_cvt_pk_bf16_f32 v109, v214, v215
v_mfma_f32_16x16x32_bf16 v[220:223], a[52:55], v[216:219], v[220:223]
s_lshl3_add_u32 s48, s51, 8192
s_sub_u32 s49, s49, s56
s_sub_u32 s51, s51, 32
v_mfma_f32_16x16x32_bf16 v[220:223], a[48:51], v[228:231], v[220:223]
s_nop 2
v_smfmac_f32_16x16x64_bf16 v[176:179], v[200:203], v[0:7], v250
s_nop 2
v_smfmac_f32_16x16x64_bf16 v[180:183], v[200:203], v[16:23], v250
v_cvt_pk_bf16_f32 v111, v222, v223
v_smfmac_f32_16x16x64_bf16 v[184:187], v[200:203], v[32:39], v250
v_cvt_pk_bf16_f32 v110, v220, v221
v_mfma_f32_16x16x32_bf16 v[144:147], a[192:195], v[228:231], 0
v_add_f32 v176, v176, v177
v_mfma_f32_16x16x32_bf16 v[144:147], a[196:199], v[216:219], v[144:147]
v_exp_f32 v176, v176
v_mfma_f32_16x16x32_bf16 v[144:147], a[200:203], v[208:211], v[144:147]
v_mfma_f32_16x16x32_bf16 v[144:147], a[204:207], v[196:199], v[144:147]
v_smfmac_f32_16x16x64_bf16 v[178:181], v[200:203], v[8:15], v250
s_nop 2
v_smfmac_f32_16x16x64_bf16 v[182:185], v[200:203], v[24:31], v250
s_nop 2
v_smfmac_f32_16x16x64_bf16 v[186:189], v[200:203], v[40:47], v250
v_add_f32 v178, v178, v179
v_mfma_f32_16x16x32_bf16 v[148:151], a[220:223], v[196:199], 0
v_add_f32 v180, v180, v181
s_nop 0
v_mfma_f32_16x16x32_bf16 v[148:151], a[216:219], v[208:211], v[148:151]
v_exp_f32 v180, v180
v_mfma_f32_16x16x32_bf16 v[148:151], a[212:215], v[216:219], v[148:151]
v_add_f32 v182, v182, v183
v_add_f32 v184, v184, v185
v_mfma_f32_16x16x32_bf16 v[148:151], a[208:211], v[228:231], v[148:151]
v_exp_f32 v184, v184
v_mfma_f32_16x16x32_bf16 v[152:155], a[224:227], v[228:231], 0
v_add_f32 v186, v186, v187
v_mfma_f32_16x16x32_bf16 v[152:155], a[228:231], v[216:219], v[152:155]
v_mov_b64 v[200:201], s[96:97]
v_mov_b64 v[202:203], s[96:97]
v_mfma_f32_16x16x32_bf16 v[152:155], a[232:235], v[208:211], v[152:155]
v_exp_f32 v178, v178
v_mfma_f32_16x16x32_bf16 v[152:155], a[236:239], v[196:199], v[152:155]
v_cvt_pk_bf16_f32 v177, v176, v178
v_add_f32 v188, v176, v178
v_mfma_f32_16x16x32_bf16 v[156:159], a[252:255], v[196:199], 0
ds_write_b16 v246, v177 offset:0
v_mfma_f32_16x16x32_bf16 v[156:159], a[248:251], v[208:211], v[156:159]
ds_write_b16_d16_hi v246, v177 offset:4
v_mfma_f32_16x16x32_bf16 v[156:159], a[244:247], v[216:219], v[156:159]
v_exp_f32 v182, v182
v_mfma_f32_16x16x32_bf16 v[156:159], a[240:243], v[228:231], v[156:159]
v_add_f32 v188, v188, v180
v_add_f32 v188, v188, v182
v_smfmac_f32_16x16x64_bf16 v[200:203], v[96:99], v[104:111], v250
v_add_f32 v188, v188, v184
v_mfma_f32_16x16x32_bf16 v[204:207], v[0:3], v[104:107], 0
v_exp_f32 v186, v186
v_mfma_f32_16x16x32_bf16 v[204:207], v[4:7], v[108:111], v[204:207]
v_add_f32 v188, v188, v186
v_cvt_pk_bf16_f32 v181, v180, v182
v_mfma_f32_16x16x32_bf16 v[212:215], v[228:231], a[128:131], 0
ds_write_b16 v246, v181 offset:272
v_mfma_f32_16x16x32_bf16 v[212:215], v[216:219], a[132:135], v[212:215]
ds_write_b16_d16_hi v246, v181 offset:276
v_mfma_f32_16x16x32_bf16 v[212:215], v[208:211], a[136:139], v[212:215]
v_add_f32 v202, v202, v203
v_add_f32 v200, v200, v201
v_mfma_f32_16x16x32_bf16 v[212:215], v[196:199], a[140:143], v[212:215]
ds_read_b128 v[232:235], v240 offset:4224
v_cvt_pk_bf16_f32 v185, v184, v186
v_mfma_f32_16x16x32_bf16 v[220:223], v[196:199], a[156:159], 0
ds_read_b128 v[224:227], v240 offset:4480
v_add_f32_dpp v188, v188, v188 row_ror:8 row_mask:0xf bank_mask:0xf
v_mfma_f32_16x16x32_bf16 v[220:223], v[208:211], a[152:155], v[220:223]
ds_write_b16 v246, v185 offset:544
v_mfma_f32_16x16x32_bf16 v[220:223], v[216:219], a[148:151], v[220:223]
ds_write_b16_d16_hi v246, v185 offset:548
v_mfma_f32_16x16x32_bf16 v[220:223], v[228:231], a[144:147], v[220:223]
v_exp_f32 v200, v200
v_mfma_f32_16x16x32_bf16 v[236:239], v[228:231], a[160:163], 0
v_exp_f32 v202, v202
v_mfma_f32_16x16x32_bf16 v[236:239], v[216:219], a[164:167], v[236:239]
v_perm_b32 v125, v202, v200, v252
v_perm_b32 v124, v202, v200, v251
v_mfma_f32_16x16x32_bf16 v[236:239], v[208:211], a[168:171], v[236:239]
v_exp_f32 v207, v207
v_mfma_f32_16x16x32_bf16 v[236:239], v[196:199], a[172:175], v[236:239]
v_exp_f32 v206, v206
v_mfma_f32_16x16x32_bf16 v[200:203], v[196:199], a[188:191], 0
v_cvt_pk_bf16_f32 v113, v206, v207
v_cvt_pk_bf16_f32 v87, v222, v223
v_mfma_f32_16x16x32_bf16 v[200:203], v[208:211], a[184:187], v[200:203]
v_exp_f32 v204, v204
v_mfma_f32_16x16x32_bf16 v[200:203], v[216:219], a[180:183], v[200:203]
v_exp_f32 v205, v205
v_mfma_f32_16x16x32_bf16 v[200:203], v[228:231], a[176:179], v[200:203]
v_cvt_pk_bf16_f32 v112, v204, v205
v_cvt_pk_bf16_f32 v86, v220, v221
v_mfma_f32_16x16x32_bf16 v[196:199], v[8:11], v[104:107], 0
s_waitcnt lgkmcnt(3)
ds_read_b128 v[220:223], v240 offset:4992
v_cvt_pk_bf16_f32 v83, v214, v215
v_mfma_f32_16x16x32_bf16 v[196:199], v[12:15], v[108:111], v[196:199]
s_waitcnt lgkmcnt(3)
v_cvt_pk_bf16_f32 v95, v202, v203
v_cvt_pk_bf16_f32 v94, v200, v201
v_mfma_f32_16x16x32_bf16 v[200:203], v[20:23], v[108:111], 0
v_cvt_pk_bf16_f32 v82, v212, v213
v_add_f32_dpp v188, v188, v188 row_ror:4 row_mask:0xf bank_mask:0xf
v_mfma_f32_16x16x32_bf16 v[200:203], v[16:19], v[104:107], v[200:203]
ds_read_b128 v[212:215], v240 offset:4736
v_cvt_pk_bf16_f32 v91, v238, v239
v_mfma_f32_16x16x32_bf16 v[204:207], v[24:27], v[104:107], 0
ds_write_b32 v249, v188 offset:0
v_mfma_f32_16x16x32_bf16 v[204:207], v[28:31], v[108:111], v[204:207]
v_cvt_pk_bf16_f32 v90, v236, v237
s_waitcnt lgkmcnt(2)
v_mfma_f32_16x16x32_bf16 v[208:211], v[220:223], a[188:191], 0
v_exp_f32 v202, v202
v_exp_f32 v200, v200
v_exp_f32 v203, v203
v_exp_f32 v201, v201
v_cvt_pk_bf16_f32 v117, v202, v203
s_waitcnt lgkmcnt(1)
v_mfma_f32_16x16x32_bf16 v[208:211], v[212:215], a[184:187], v[208:211]
v_exp_f32 v207, v207
v_mfma_f32_16x16x32_bf16 v[208:211], v[224:227], a[180:183], v[208:211]
v_exp_f32 v205, v205
v_mfma_f32_16x16x32_bf16 v[208:211], v[232:235], a[176:179], v[208:211]
ds_read_b128 v[216:219], v240 offset:0
v_cvt_pk_bf16_f32 v116, v200, v201
v_mfma_f32_16x16x32_bf16 v[228:231], v[232:235], a[160:163], 0
ds_read_b128 v[236:239], v240 offset:512
v_add_u32 v249, 1600, v249
v_mfma_f32_16x16x32_bf16 v[228:231], v[224:227], a[164:167], v[228:231]
v_exp_f32 v204, v204
v_mfma_f32_16x16x32_bf16 v[228:231], v[212:215], a[168:171], v[228:231]
v_cvt_pk_bf16_f32 v63, v210, v211
v_cvt_pk_bf16_f32 v62, v208, v209
v_mfma_f32_16x16x32_bf16 v[228:231], v[220:223], a[172:175], v[228:231]
v_exp_f32 v206, v206
v_mfma_f32_16x16x32_bf16 v[208:211], v[220:223], a[156:159], 0
v_cvt_pk_bf16_f32 v119, v206, v207
v_cvt_pk_bf16_f32 v118, v204, v205
v_mfma_f32_16x16x32_bf16 v[208:211], v[212:215], a[152:155], v[208:211]
v_exp_f32 v196, v196
v_mfma_f32_16x16x32_bf16 v[208:211], v[224:227], a[148:151], v[208:211]
v_exp_f32 v197, v197
v_mfma_f32_16x16x32_bf16 v[208:211], v[232:235], a[144:147], v[208:211]
v_exp_f32 v198, v198
v_mfma_f32_16x16x32_bf16 v[204:207], v[232:235], a[128:131], 0
v_exp_f32 v199, v199
v_mfma_f32_16x16x32_bf16 v[204:207], v[224:227], a[132:135], v[204:207]
v_cvt_pk_bf16_f32 v114, v196, v197
v_cvt_pk_bf16_f32 v115, v198, v199
v_mfma_f32_16x16x32_bf16 v[204:207], v[212:215], a[136:139], v[204:207]
ds_read_b128 v[196:199], v240 offset:256
v_cvt_pk_bf16_f32 v54, v208, v209
v_mfma_f32_16x16x32_bf16 v[204:207], v[220:223], a[140:143], v[204:207]
v_cvt_pk_bf16_f32 v55, v210, v211
v_cvt_pk_bf16_f32 v58, v228, v229
v_mfma_f32_32x32x16_bf16 v[176:191], v[100:103], v[124:127], 0
buffer_store_dwordx4 v[160:163], v242, s[20:23], s53 offen offset:0 nt
buffer_store_dwordx4 v[168:171], v242, s[20:23], s53 offen offset:64 nt
buffer_load_dwordx4 v241, s[16:19], s98 offen offset:0 nt lds
buffer_load_dwordx4 v241, s[16:19], s99 offen offset:1056 nt lds
buffer_load_dwordx4 v241, s[16:19], s100 offen offset:2112 nt lds
buffer_load_dwordx4 v241, s[16:19], s101 offen offset:3168 nt lds
v_mfma_f32_16x16x32_bf16 v[200:203], v[36:39], v[108:111], 0
s_waitcnt lgkmcnt(1)
v_cvt_pk_bf16_f32 v50, v204, v205
v_cvt_pk_bf16_f32 v51, v206, v207
v_mfma_f32_16x16x32_bf16 v[200:203], v[32:35], v[104:107], v[200:203]
s_waitcnt lgkmcnt(0)
v_cvt_pk_bf16_f32 v59, v230, v231
s_add_u32 s53, s46, 0
v_mfma_f32_16x16x32_bf16 v[204:207], v[40:43], v[104:107], 0
ds_read_b128 v[228:231], v240 offset:768
s_nop 0
v_mfma_f32_16x16x32_bf16 v[204:207], v[44:47], v[108:111], v[204:207]
s_nop 0
v_exp_f32 v201, v201
v_mfma_f32_16x16x32_bf16 v[208:211], v[216:219], a[128:131], 0
v_exp_f32 v200, v200
v_mfma_f32_16x16x32_bf16 v[208:211], v[196:199], a[132:135], v[208:211]
v_exp_f32 v203, v203
v_mfma_f32_16x16x32_bf16 v[208:211], v[236:239], a[136:139], v[208:211]
v_exp_f32 v202, v202
v_cvt_pk_bf16_f32 v120, v200, v201
v_cvt_pk_bf16_f32 v121, v202, v203
s_waitcnt lgkmcnt(0)
v_mfma_f32_16x16x32_bf16 v[208:211], v[228:231], a[140:143], v[208:211]
v_exp_f32 v205, v205
v_mfma_f32_16x16x32_bf16 v[212:215], v[228:231], a[156:159], 0
v_exp_f32 v207, v207
v_mfma_f32_16x16x32_bf16 v[212:215], v[236:239], a[152:155], v[212:215]
v_exp_f32 v204, v204
v_mfma_f32_16x16x32_bf16 v[212:215], v[196:199], a[148:151], v[212:215]
v_exp_f32 v206, v206
v_mfma_f32_16x16x32_bf16 v[212:215], v[216:219], a[144:147], v[212:215]
v_cvt_pk_bf16_f32 v123, v206, v207
v_cvt_pk_bf16_f32 v122, v204, v205
v_mfma_f32_16x16x32_bf16 v[220:223], v[216:219], a[160:163], 0
v_cvt_pk_bf16_f32 v48, v208, v209
v_cvt_pk_bf16_f32 v49, v210, v211
v_mfma_f32_16x16x32_bf16 v[220:223], v[196:199], a[164:167], v[220:223]
s_nop 1
v_cvt_pk_bf16_f32 v52, v212, v213
v_mfma_f32_16x16x32_bf16 v[220:223], v[236:239], a[168:171], v[220:223]
v_cvt_pk_bf16_f32 v53, v214, v215
v_mfma_f32_16x16x32_bf16 v[220:223], v[228:231], a[172:175], v[220:223]
s_nop 2
v_mfma_f32_16x16x32_bf16 v[200:203], v[228:231], a[188:191], 0
s_nop 2
v_mfma_f32_16x16x32_bf16 v[200:203], v[236:239], a[184:187], v[200:203]
v_cvt_pk_bf16_f32 v57, v222, v223
v_cvt_pk_bf16_f32 v56, v220, v221
v_mfma_f32_16x16x32_bf16 v[200:203], v[196:199], a[180:183], v[200:203]
v_mfma_f32_16x16x32_bf16 v[200:203], v[216:219], a[176:179], v[200:203]
s_nop 2
v_mfma_f32_16x16x32_bf16 v[204:207], a[0:3], v[216:219], 0
s_nop 2
v_mfma_f32_16x16x32_bf16 v[204:207], a[4:7], v[196:199], v[204:207]
v_cvt_pk_bf16_f32 v60, v200, v201
v_cvt_pk_bf16_f32 v61, v202, v203
v_mfma_f32_16x16x32_bf16 v[204:207], a[8:11], v[236:239], v[204:207]
v_mfma_f32_16x16x32_bf16 v[204:207], a[12:15], v[228:231], v[204:207]
s_nop 2
v_mfma_f32_16x16x32_bf16 v[200:203], a[28:31], v[228:231], 0
s_nop 2
v_mfma_f32_16x16x32_bf16 v[200:203], a[24:27], v[236:239], v[200:203]
v_cvt_pk_bf16_f32 v104, v204, v205
v_cvt_pk_bf16_f32 v105, v206, v207
v_mfma_f32_16x16x32_bf16 v[200:203], a[20:23], v[196:199], v[200:203]
v_mfma_f32_16x16x32_bf16 v[200:203], a[16:19], v[216:219], v[200:203]
s_nop 2
v_mfma_f32_16x16x32_bf16 v[204:207], a[32:35], v[216:219], 0
s_nop 2
v_mfma_f32_16x16x32_bf16 v[204:207], a[36:39], v[196:199], v[204:207]
v_cvt_pk_bf16_f32 v107, v202, v203
v_cvt_pk_bf16_f32 v106, v200, v201
v_mfma_f32_16x16x32_bf16 v[204:207], a[40:43], v[236:239], v[204:207]
v_mov_b64 v[208:209], 0
v_mfma_f32_16x16x32_bf16 v[204:207], a[44:47], v[228:231], v[204:207]
s_nop 2
v_mfma_f32_16x16x32_bf16 v[200:203], a[60:63], v[228:231], 0
s_nop 2
v_mfma_f32_16x16x32_bf16 v[200:203], a[56:59], v[236:239], v[200:203]
v_cvt_pk_bf16_f32 v108, v204, v205
v_cvt_pk_bf16_f32 v109, v206, v207
v_mfma_f32_16x16x32_bf16 v[200:203], a[52:55], v[196:199], v[200:203]
v_mfma_f32_16x16x32_bf16 v[200:203], a[48:51], v[216:219], v[200:203]
s_nop 2
v_smfmac_f32_16x16x64_bf16 v[208:211], v[192:195], v[112:119], v250
s_nop 2
v_smfmac_f32_16x16x64_bf16 v[208:211], v[192:195], v[120:127], v250 abid:1
ds_read_b128 v[204:207], v240 offset:8448
v_cvt_pk_bf16_f32 v110, v200, v201
v_mfma_f32_16x16x32_bf16 v[160:163], a[192:195], v[216:219], 0
ds_read_b128 v[212:215], v240 offset:8704
v_cvt_pk_bf16_f32 v111, v202, v203
v_mfma_f32_16x16x32_bf16 v[160:163], a[196:199], v[196:199], v[160:163]
ds_read_b128 v[224:227], v240 offset:9216
ds_read_b128 v[220:223], v240 offset:8960
v_mfma_f32_16x16x32_bf16 v[160:163], a[200:203], v[236:239], v[160:163]
v_add_f32 v208, v208, v209
v_mfma_f32_16x16x32_bf16 v[160:163], a[204:207], v[228:231], v[160:163]
v_rcp_f32 v253, v208
v_mfma_f32_16x16x32_bf16 v[164:167], a[220:223], v[228:231], 0
v_max3_f32 v254, v254, v208, v253
v_mfma_f32_16x16x32_bf16 v[164:167], a[216:219], v[236:239], v[164:167]
v_mfma_f32_16x16x32_bf16 v[164:167], a[212:215], v[196:199], v[164:167]
v_mfma_f32_16x16x32_bf16 v[164:167], a[208:211], v[216:219], v[164:167]
v_mfma_f32_16x16x32_bf16 v[168:171], a[224:227], v[216:219], 0
v_mfma_f32_16x16x32_bf16 v[168:171], a[228:231], v[196:199], v[168:171]
v_mov_b64 v[202:203], s[96:97]
v_mov_b64 v[200:201], s[96:97]
v_mfma_f32_16x16x32_bf16 v[168:171], a[232:235], v[236:239], v[168:171]
v_mfma_f32_16x16x32_bf16 v[168:171], a[236:239], v[228:231], v[168:171]
v_mfma_f32_16x16x32_bf16 v[172:175], a[252:255], v[228:231], 0
s_waitcnt lgkmcnt(3)
v_mfma_f32_16x16x32_bf16 v[172:175], a[248:251], v[236:239], v[172:175]
s_waitcnt lgkmcnt(2)
v_mfma_f32_16x16x32_bf16 v[172:175], a[244:247], v[196:199], v[172:175]
s_waitcnt lgkmcnt(0)
v_mfma_f32_16x16x32_bf16 v[172:175], a[240:243], v[216:219], v[172:175]
v_smfmac_f32_16x16x64_bf16 v[200:203], v[96:99], v[104:111], v250
s_nop 2
v_mfma_f32_16x16x32_bf16 v[196:199], v[0:3], v[104:107], 0
s_nop 2
v_mfma_f32_16x16x32_bf16 v[196:199], v[4:7], v[108:111], v[196:199]
v_add_f32 v200, v200, v201
v_add_f32 v202, v202, v203
v_mfma_f32_16x16x32_bf16 v[208:211], v[12:15], v[108:111], 0
v_exp_f32 v200, v200
v_mfma_f32_16x16x32_bf16 v[208:211], v[8:11], v[104:107], v[208:211]
v_exp_f32 v202, v202
v_mfma_f32_16x16x32_bf16 v[216:219], v[204:207], a[128:131], 0
s_nop 0
v_exp_f32 v198, v198
v_mfma_f32_16x16x32_bf16 v[216:219], v[212:215], a[132:135], v[216:219]
v_exp_f32 v199, v199
v_mfma_f32_16x16x32_bf16 v[216:219], v[220:223], a[136:139], v[216:219]
s_nop 0
v_exp_f32 v211, v211
v_mfma_f32_16x16x32_bf16 v[216:219], v[224:227], a[140:143], v[216:219]
ds_read_b128 v[228:231], v240 offset:12672
v_cvt_pk_bf16_f32 v129, v198, v199
v_mfma_f32_16x16x32_bf16 v[232:235], v[224:227], a[156:159], 0
v_exp_f32 v210, v210
v_mfma_f32_16x16x32_bf16 v[232:235], v[220:223], a[152:155], v[232:235]
v_exp_f32 v208, v208
v_mfma_f32_16x16x32_bf16 v[232:235], v[212:215], a[148:151], v[232:235]
v_exp_f32 v209, v209
v_mfma_f32_16x16x32_bf16 v[232:235], v[204:207], a[144:147], v[232:235]
v_cvt_pk_bf16_f32 v131, v210, v211
v_cvt_pk_bf16_f32 v130, v208, v209
v_mfma_f32_16x16x32_bf16 v[236:239], v[204:207], a[160:163], 0
v_exp_f32 v197, v197
v_mfma_f32_16x16x32_bf16 v[236:239], v[212:215], a[164:167], v[236:239]
v_exp_f32 v196, v196
v_mfma_f32_16x16x32_bf16 v[236:239], v[220:223], a[168:171], v[236:239]
s_nop 0
v_cvt_pk_bf16_f32 v68, v232, v233
v_cvt_pk_bf16_f32 v69, v234, v235
v_mfma_f32_16x16x32_bf16 v[236:239], v[224:227], a[172:175], v[236:239]
v_cvt_pk_bf16_f32 v128, v196, v197
v_cvt_pk_bf16_f32 v64, v216, v217
v_mfma_f32_16x16x32_bf16 v[232:235], v[224:227], a[188:191], 0
ds_read_b128 v[196:199], v240 offset:13440
v_cvt_pk_bf16_f32 v65, v218, v219
v_mfma_f32_16x16x32_bf16 v[232:235], v[220:223], a[184:187], v[232:235]
ds_read_b128 v[216:219], v240 offset:13184
v_perm_b32 v140, v202, v200, v251
v_mfma_f32_16x16x32_bf16 v[232:235], v[212:215], a[180:183], v[232:235]
v_perm_b32 v141, v202, v200, v252
v_cvt_pk_bf16_f32 v73, v238, v239
v_mfma_f32_16x16x32_bf16 v[232:235], v[204:207], a[176:179], v[232:235]
ds_read_b128 v[200:203], v240 offset:12928
v_cvt_pk_bf16_f32 v72, v236, v237
v_mfma_f32_16x16x32_bf16 v[204:207], v[20:23], v[108:111], 0
s_waitcnt lgkmcnt(3)
s_nop 1
v_mfma_f32_16x16x32_bf16 v[204:207], v[16:19], v[104:107], v[204:207]
s_nop 0
v_cvt_pk_bf16_f32 v76, v232, v233
v_cvt_pk_bf16_f32 v77, v234, v235
v_mfma_f32_16x16x32_bf16 v[208:211], v[24:27], v[104:107], 0
s_waitcnt lgkmcnt(2)
s_nop 1
v_mfma_f32_16x16x32_bf16 v[208:211], v[28:31], v[108:111], v[208:211]
s_waitcnt lgkmcnt(1)
v_exp_f32 v204, v204
v_mfma_f32_16x16x32_bf16 v[212:215], v[196:199], a[188:191], 0
v_exp_f32 v205, v205
v_mfma_f32_16x16x32_bf16 v[212:215], v[216:219], a[184:187], v[212:215]
s_waitcnt lgkmcnt(0)
v_exp_f32 v207, v207
v_mfma_f32_16x16x32_bf16 v[212:215], v[200:203], a[180:183], v[212:215]
v_exp_f32 v206, v206
v_mfma_f32_16x16x32_bf16 v[212:215], v[228:231], a[176:179], v[212:215]
ds_read_b128 v[220:223], v240 offset:17152
ds_read_b128 v[224:227], v240 offset:16896
v_mfma_f32_16x16x32_bf16 v[232:235], v[228:231], a[160:163], 0
v_cvt_pk_bf16_f32 v133, v206, v207
v_cvt_pk_bf16_f32 v132, v204, v205
v_mfma_f32_16x16x32_bf16 v[232:235], v[200:203], a[164:167], v[232:235]
ds_read_b128 v[204:207], v240 offset:17408
v_mfma_f32_16x16x32_bf16 v[232:235], v[216:219], a[168:171], v[232:235]
v_cvt_pk_bf16_f32 v78, v212, v213
v_cvt_pk_bf16_f32 v79, v214, v215
v_mfma_f32_16x16x32_bf16 v[232:235], v[196:199], a[172:175], v[232:235]
ds_read_b128 v[212:215], v240 offset:17664
s_nop 0
v_mfma_f32_16x16x32_bf16 v[236:239], v[196:199], a[156:159], 0
v_exp_f32 v208, v208
v_mfma_f32_16x16x32_bf16 v[236:239], v[216:219], a[152:155], v[236:239]
v_exp_f32 v210, v210
v_mfma_f32_16x16x32_bf16 v[236:239], v[200:203], a[148:151], v[236:239]
s_nop 0
v_cvt_pk_bf16_f32 v74, v232, v233
v_cvt_pk_bf16_f32 v75, v234, v235
v_mfma_f32_16x16x32_bf16 v[236:239], v[228:231], a[144:147], v[236:239]
v_exp_f32 v211, v211
v_mfma_f32_16x16x32_bf16 v[232:235], v[228:231], a[128:131], 0
v_exp_f32 v209, v209
v_mfma_f32_16x16x32_bf16 v[232:235], v[216:219], a[136:139], v[232:235]
v_cvt_pk_bf16_f32 v134, v208, v209
v_cvt_pk_bf16_f32 v135, v210, v211
v_mfma_f32_16x16x32_bf16 v[232:235], v[196:199], a[140:143], v[232:235]
s_waitcnt lgkmcnt(3)
v_cvt_pk_bf16_f32 v71, v238, v239
v_cvt_pk_bf16_f32 v70, v236, v237
v_mfma_f32_16x16x32_bf16 v[232:235], v[200:203], a[132:135], v[232:235]
s_waitcnt lgkmcnt(2)
s_nop 1
v_mfma_f32_16x16x32_bf16 v[196:199], v[220:223], a[132:135], 0
s_waitcnt lgkmcnt(1)
s_nop 1
v_mfma_f32_16x16x32_bf16 v[196:199], v[224:227], a[128:131], v[196:199]
s_waitcnt lgkmcnt(0)
v_cvt_pk_bf16_f32 v67, v234, v235
v_cvt_pk_bf16_f32 v66, v232, v233
v_mfma_f32_16x16x32_bf16 v[196:199], v[204:207], a[136:139], v[196:199]
v_mfma_f32_16x16x32_bf16 v[196:199], v[212:215], a[140:143], v[196:199]
s_nop 2
v_mfma_f32_16x16x32_bf16 v[200:203], v[212:215], a[156:159], 0
s_nop 2
v_mfma_f32_16x16x32_bf16 v[200:203], v[204:207], a[152:155], v[200:203]
v_cvt_pk_bf16_f32 v81, v198, v199
v_cvt_pk_bf16_f32 v80, v196, v197
v_mfma_f32_16x16x32_bf16 v[200:203], v[220:223], a[148:151], v[200:203]
v_mfma_f32_16x16x32_bf16 v[200:203], v[224:227], a[144:147], v[200:203]
s_nop 2
v_mfma_f32_16x16x32_bf16 v[196:199], v[224:227], a[160:163], 0
s_nop 2
v_mfma_f32_16x16x32_bf16 v[196:199], v[220:223], a[164:167], v[196:199]
v_cvt_pk_bf16_f32 v84, v200, v201
v_cvt_pk_bf16_f32 v85, v202, v203
v_mfma_f32_16x16x32_bf16 v[196:199], v[204:207], a[168:171], v[196:199]
v_mfma_f32_16x16x32_bf16 v[196:199], v[212:215], a[172:175], v[196:199]
s_nop 2
v_mfma_f32_16x16x32_bf16 v[200:203], v[212:215], a[188:191], 0
s_nop 2
v_mfma_f32_16x16x32_bf16 v[200:203], v[204:207], a[184:187], v[200:203]
v_cvt_pk_bf16_f32 v89, v198, v199
v_cvt_pk_bf16_f32 v88, v196, v197
v_mfma_f32_16x16x32_bf16 v[200:203], v[220:223], a[180:183], v[200:203]
v_mfma_f32_16x16x32_bf16 v[200:203], v[224:227], a[176:179], v[200:203]
s_nop 2
v_mfma_f32_16x16x32_bf16 v[196:199], v[36:39], v[108:111], 0
s_nop 2
v_mfma_f32_16x16x32_bf16 v[196:199], v[32:35], v[104:107], v[196:199]
v_cvt_pk_bf16_f32 v92, v200, v201
v_cvt_pk_bf16_f32 v93, v202, v203
v_mfma_f32_16x16x32_bf16 v[200:203], v[40:43], v[104:107], 0
s_nop 2
v_mfma_f32_16x16x32_bf16 v[200:203], v[44:47], v[108:111], v[200:203]
s_nop 0
v_exp_f32 v199, v199
v_mfma_f32_16x16x32_bf16 v[176:179], v[48:51], v[112:115], v[176:179]
v_exp_f32 v196, v196
v_mfma_f32_16x16x32_bf16 v[176:179], v[64:67], v[116:119], v[176:179]
v_exp_f32 v197, v197
v_mfma_f32_16x16x32_bf16 v[176:179], v[80:83], v[120:123], v[176:179]
v_exp_f32 v198, v198
v_mfma_f32_16x16x32_bf16 v[180:183], v[84:87], v[120:123], v[180:183]
v_cvt_pk_bf16_f32 v136, v196, v197
v_cvt_pk_bf16_f32 v137, v198, v199
v_mfma_f32_16x16x32_bf16 v[180:183], v[52:55], v[112:115], v[180:183]
v_exp_f32 v200, v200
v_mfma_f32_16x16x32_bf16 v[180:183], v[68:71], v[116:119], v[180:183]
s_nop 0
v_fmac_f32 v144, v176, v253
v_fmac_f32 v145, v177, v253
v_mfma_f32_16x16x32_bf16 v[184:187], v[72:75], v[116:119], v[184:187]
v_cvt_pk_bf16_f32 v144, v144, v145
v_fmac_f32 v146, v178, v253
v_mfma_f32_16x16x32_bf16 v[184:187], v[88:91], v[120:123], v[184:187]
s_nop 0
v_fmac_f32 v149, v181, v253
v_fmac_f32 v147, v179, v253
v_mfma_f32_16x16x32_bf16 v[184:187], v[56:59], v[112:115], v[184:187]
v_cvt_pk_bf16_f32 v145, v146, v147
v_fmac_f32 v151, v183, v253
v_mfma_f32_16x16x32_bf16 v[188:191], v[60:63], v[112:115], v[188:191]
v_fmac_f32 v150, v182, v253
v_cvt_pk_bf16_f32 v147, v150, v151
v_mfma_f32_16x16x32_bf16 v[188:191], v[76:79], v[116:119], v[188:191]
v_fmac_f32 v148, v180, v253
v_cvt_pk_bf16_f32 v146, v148, v149
v_mfma_f32_16x16x32_bf16 v[188:191], v[92:95], v[120:123], v[188:191]
v_fmac_f32 v152, v184, v253
v_fmac_f32 v155, v187, v253
v_mfma_f32_16x16x32_bf16 v[208:211], a[0:3], v[224:227], 0
v_fmac_f32 v154, v186, v253
v_fmac_f32 v153, v185, v253
v_mfma_f32_16x16x32_bf16 v[208:211], a[4:7], v[220:223], v[208:211]
v_cvt_pk_bf16_f32 v152, v152, v153
v_cvt_pk_bf16_f32 v153, v154, v155
v_mfma_f32_16x16x32_bf16 v[208:211], a[8:11], v[204:207], v[208:211]
v_fmac_f32 v157, v189, v253
v_fmac_f32 v156, v188, v253
v_mfma_f32_16x16x32_bf16 v[208:211], a[12:15], v[212:215], v[208:211]
v_cvt_pk_bf16_f32 v154, v156, v157
v_fmac_f32 v158, v190, v253
v_mfma_f32_16x16x32_bf16 v[216:219], a[28:31], v[212:215], 0
v_fmac_f32 v159, v191, v253
v_cvt_pk_bf16_f32 v155, v158, v159
v_mfma_f32_16x16x32_bf16 v[216:219], a[24:27], v[204:207], v[216:219]
v_pk_max_i16 v155, v155, 0
v_pk_max_i16 v152, v152, 0
v_mfma_f32_16x16x32_bf16 v[216:219], a[20:23], v[220:223], v[216:219]
v_cvt_pk_bf16_f32 v105, v210, v211
v_cvt_pk_bf16_f32 v104, v208, v209
v_mfma_f32_16x16x32_bf16 v[216:219], a[16:19], v[224:227], v[216:219]
ds_read_b128 v[208:211], v247 offset:0
ds_read_b128 v[228:231], v247 offset:272
v_mfma_f32_16x16x32_bf16 v[232:235], a[32:35], v[224:227], 0
ds_read_b128 v[236:239], v247 offset:544
v_pk_max_i16 v153, v153, 0
v_mfma_f32_16x16x32_bf16 v[232:235], a[36:39], v[220:223], v[232:235]
v_mov_b64 v[196:197], 0
v_mov_b64 v[198:199], 0
v_mfma_f32_16x16x32_bf16 v[232:235], a[40:43], v[204:207], v[232:235]
v_cvt_pk_bf16_f32 v106, v216, v217
v_cvt_pk_bf16_f32 v107, v218, v219
v_mfma_f32_16x16x32_bf16 v[232:235], a[44:47], v[212:215], v[232:235]
v_exp_f32 v201, v201
v_mfma_f32_16x16x32_bf16 v[216:219], a[60:63], v[212:215], 0
v_exp_f32 v203, v203
v_mfma_f32_16x16x32_bf16 v[216:219], a[56:59], v[204:207], v[216:219]
v_exp_f32 v202, v202
v_mfma_f32_16x16x32_bf16 v[216:219], a[52:55], v[220:223], v[216:219]
s_waitcnt lgkmcnt(2)
v_cvt_pk_bf16_f32 v138, v200, v201
v_cvt_pk_bf16_f32 v108, v232, v233
v_mfma_f32_16x16x32_bf16 v[216:219], a[48:51], v[224:227], v[216:219]
s_waitcnt lgkmcnt(1)
v_mov_b64 v[232:233], 0
v_cvt_pk_bf16_f32 v109, v234, v235
v_smfmac_f32_16x16x64_bf16 v[196:199], v[208:211], v[48:55], v250
s_waitcnt lgkmcnt(0)
v_mov_b64 v[234:235], 0
v_smfmac_f32_16x16x64_bf16 v[196:199], v[228:231], v[64:71], v250
s_nop 0
v_cvt_pk_bf16_f32 v110, v216, v217
v_smfmac_f32_16x16x64_bf16 v[196:199], v[236:239], v[80:87], v250
v_cvt_pk_bf16_f32 v111, v218, v219
v_smfmac_f32_16x16x64_bf16 v[232:235], v[236:239], v[88:95], v250
v_mov_b64 v[218:219], s[96:97]
v_smfmac_f32_16x16x64_bf16 v[232:235], v[228:231], v[72:79], v250
v_mov_b64 v[216:217], s[96:97]
v_smfmac_f32_16x16x64_bf16 v[232:235], v[208:211], v[56:63], v250
s_nop 1
v_add_f32 v196, v196, v197
v_smfmac_f32_16x16x64_bf16 v[216:219], v[96:99], v[104:111], v250
v_add_f32 v198, v198, v199
v_mfma_f32_16x16x32_bf16 v[208:211], v[0:3], v[104:107], 0
ds_write2_b32 v248, v196, v198 offset0:0 offset1:16
v_mfma_f32_16x16x32_bf16 v[208:211], v[4:7], v[108:111], v[208:211]
v_cvt_pk_bf16_f32 v139, v202, v203
L_entryf:
v_pk_max_i16 v146, v146, 0
v_mfma_f32_16x16x32_bf16 v[196:199], v[12:15], v[108:111], 0
v_pk_max_i16 v145, v145, 0
v_pk_max_i16 v147, v147, 0
v_mfma_f32_16x16x32_bf16 v[196:199], v[8:11], v[104:107], v[196:199]
v_pk_max_i16 v144, v144, 0
v_pk_max_i16 v154, v154, 0
v_mfma_f32_16x16x32_bf16 v[200:203], v[16:19], v[104:107], 0
v_exp_f32 v210, v210
v_mfma_f32_16x16x32_bf16 v[200:203], v[20:23], v[108:111], v[200:203]
v_exp_f32 v209, v209
v_mfma_f32_32x32x16_bf16 v[176:191], v[100:103], v[140:143], 0
buffer_store_dwordx4 v[144:147], v242, s[20:23], s52 offen offset:0 nt
buffer_store_dwordx4 v[152:155], v242, s[20:23], s52 offen offset:64 nt
v_exp_f32 v198, v198
v_exp_f32 v197, v197
v_mfma_f32_16x16x32_bf16 v[144:147], a[192:195], v[224:227], 0
s_add_u32 s52, s46, 16384
v_exp_f32 v196, v196
v_mfma_f32_16x16x32_bf16 v[144:147], a[196:199], v[220:223], v[144:147]
v_mov_b64 v[228:229], 0
v_cvt_pk_bf16_f32 v114, v196, v197
v_mfma_f32_16x16x32_bf16 v[144:147], a[200:203], v[204:207], v[144:147]
v_exp_f32 v199, v199
v_mfma_f32_16x16x32_bf16 v[144:147], a[204:207], v[212:215], v[144:147]
v_cvt_pk_bf16_f32 v115, v198, v199
v_add_f32 v218, v218, v219
v_mfma_f32_16x16x32_bf16 v[148:151], a[220:223], v[212:215], 0
v_exp_f32 v211, v211
v_mfma_f32_16x16x32_bf16 v[148:151], a[216:219], v[204:207], v[148:151]
v_cvt_pk_bf16_f32 v113, v210, v211
v_add_f32 v216, v216, v217
v_mfma_f32_16x16x32_bf16 v[148:151], a[212:215], v[220:223], v[148:151]
v_exp_f32 v208, v208
v_mfma_f32_16x16x32_bf16 v[148:151], a[208:211], v[224:227], v[148:151]
v_cvt_pk_bf16_f32 v112, v208, v209
v_add_f32 v232, v232, v233
v_smfmac_f32_16x16x64_bf16 v[228:231], v[192:195], v[128:135], v250
v_add_f32 v234, v234, v235
v_smfmac_f32_16x16x64_bf16 v[228:231], v[192:195], v[136:143], v250 abid:1
ds_write2_b32 v248, v232, v234 offset0:32 offset1:48
v_mfma_f32_16x16x32_bf16 v[152:155], a[224:227], v[224:227], 0
v_exp_f32 v203, v203
v_mfma_f32_16x16x32_bf16 v[152:155], a[228:231], v[220:223], v[152:155]
v_exp_f32 v216, v216
v_mfma_f32_16x16x32_bf16 v[152:155], a[232:235], v[204:207], v[152:155]
v_exp_f32 v201, v201
v_mfma_f32_16x16x32_bf16 v[152:155], a[236:239], v[212:215], v[152:155]
v_exp_f32 v200, v200
v_mfma_f32_16x16x32_bf16 v[156:159], a[252:255], v[212:215], 0
v_exp_f32 v202, v202
v_mfma_f32_16x16x32_bf16 v[156:159], a[248:251], v[204:207], v[156:159]
ds_read_b128 v[212:215], v240 offset:4736
v_cvt_pk_bf16_f32 v117, v202, v203
v_mfma_f32_16x16x32_bf16 v[156:159], a[244:247], v[220:223], v[156:159]
ds_read_b128 v[204:207], v240 offset:4224
v_cvt_pk_bf16_f32 v116, v200, v201
v_mfma_f32_16x16x32_bf16 v[156:159], a[240:243], v[224:227], v[156:159]
ds_read_b128 v[208:211], v240 offset:4480
ds_read_b128 v[220:223], v240 offset:4992
v_mfma_f32_16x16x32_bf16 v[176:179], v[48:51], v[128:131], v[176:179]
v_exp_f32 v218, v218
v_mfma_f32_16x16x32_bf16 v[176:179], v[64:67], v[132:135], v[176:179]
v_perm_b32 v124, v218, v216, v251
v_perm_b32 v125, v218, v216, v252
v_mfma_f32_16x16x32_bf16 v[176:179], v[80:83], v[136:139], v[176:179]
v_add_f32 v228, v228, v229
v_add_u32 v248, 1600, v248
v_mfma_f32_16x16x32_bf16 v[180:183], v[84:87], v[136:139], v[180:183]
v_rcp_f32 v253, v228
v_mfma_f32_16x16x32_bf16 v[180:183], v[52:55], v[128:131], v[180:183]
v_max3_f32 v254, v254, v228, v253
s_nop 0
v_mfma_f32_16x16x32_bf16 v[180:183], v[68:71], v[132:135], v[180:183]
v_fmac_f32 v161, v177, v253
v_fmac_f32 v160, v176, v253
v_mfma_f32_16x16x32_bf16 v[184:187], v[72:75], v[132:135], v[184:187]
v_fmac_f32 v162, v178, v253
v_cvt_pk_bf16_f32 v160, v160, v161
v_mfma_f32_16x16x32_bf16 v[184:187], v[88:91], v[136:139], v[184:187]
v_fmac_f32 v163, v179, v253
v_cvt_pk_bf16_f32 v161, v162, v163
v_mfma_f32_16x16x32_bf16 v[184:187], v[56:59], v[128:131], v[184:187]
v_fmac_f32 v165, v181, v253
v_fmac_f32 v164, v180, v253
v_mfma_f32_16x16x32_bf16 v[188:191], v[60:63], v[128:131], v[188:191]
v_fmac_f32 v167, v183, v253
v_fmac_f32 v166, v182, v253
v_mfma_f32_16x16x32_bf16 v[188:191], v[76:79], v[132:135], v[188:191]
s_waitcnt lgkmcnt(3)
v_cvt_pk_bf16_f32 v162, v164, v165
v_cvt_pk_bf16_f32 v163, v166, v167
v_mfma_f32_16x16x32_bf16 v[188:191], v[92:95], v[136:139], v[188:191]
s_waitcnt lgkmcnt(2)
v_fmac_f32 v171, v187, v253
v_fmac_f32 v169, v185, v253
v_mfma_f32_16x16x32_bf16 v[196:199], v[24:27], v[104:107], 0
s_waitcnt lgkmcnt(0)
v_fmac_f32 v168, v184, v253
v_fmac_f32 v170, v186, v253
v_mfma_f32_16x16x32_bf16 v[196:199], v[28:31], v[108:111], v[196:199]
v_fmac_f32 v174, v190, v253
v_fmac_f32 v172, v188, v253
v_mfma_f32_16x16x32_bf16 v[200:203], v[36:39], v[108:111], 0
v_fmac_f32 v173, v189, v253
v_fmac_f32 v175, v191, v253
v_mfma_f32_16x16x32_bf16 v[200:203], v[32:35], v[104:107], v[200:203]
v_cvt_pk_bf16_f32 v168, v168, v169
v_cvt_pk_bf16_f32 v169, v170, v171
v_mfma_f32_16x16x32_bf16 v[216:219], v[40:43], v[104:107], 0
v_cvt_pk_bf16_f32 v171, v174, v175
v_pk_max_i16 v161, v161, 0
v_mfma_f32_16x16x32_bf16 v[216:219], v[44:47], v[108:111], v[216:219]
v_pk_max_i16 v162, v162, 0
v_pk_max_i16 v163, v163, 0
v_mfma_f32_16x16x32_bf16 v[224:227], a[0:3], v[204:207], 0
v_cvt_pk_bf16_f32 v170, v172, v173
v_pk_max_i16 v169, v169, 0
v_mfma_f32_16x16x32_bf16 v[224:227], a[4:7], v[208:211], v[224:227]
v_pk_max_i16 v171, v171, 0
v_pk_max_i16 v160, v160, 0
v_mfma_f32_16x16x32_bf16 v[224:227], a[8:11], v[212:215], v[224:227]
v_pk_max_i16 v168, v168, 0
v_pk_max_i16 v170, v170, 0
v_mfma_f32_16x16x32_bf16 v[224:227], a[12:15], v[220:223], v[224:227]
v_exp_f32 v196, v196
v_mfma_f32_16x16x32_bf16 v[228:231], a[28:31], v[220:223], 0
v_exp_f32 v198, v198
v_mfma_f32_16x16x32_bf16 v[228:231], a[24:27], v[212:215], v[228:231]
v_exp_f32 v199, v199
v_mfma_f32_16x16x32_bf16 v[228:231], a[20:23], v[208:211], v[228:231]
v_exp_f32 v197, v197
v_mfma_f32_16x16x32_bf16 v[228:231], a[16:19], v[204:207], v[228:231]
v_cvt_pk_bf16_f32 v118, v196, v197
v_cvt_pk_bf16_f32 v119, v198, v199
v_mfma_f32_16x16x32_bf16 v[232:235], a[32:35], v[204:207], 0
v_exp_f32 v219, v219
v_mfma_f32_16x16x32_bf16 v[232:235], a[36:39], v[208:211], v[232:235]
v_exp_f32 v201, v201
v_mfma_f32_16x16x32_bf16 v[232:235], a[40:43], v[212:215], v[232:235]
v_exp_f32 v216, v216
v_mfma_f32_16x16x32_bf16 v[232:235], a[44:47], v[220:223], v[232:235]
v_exp_f32 v217, v217
v_mfma_f32_32x32x16_bf16 v[176:191], v[100:103], v[124:127], 0
buffer_store_dwordx4 v[160:163], v242, s[20:23], s53 offen offset:0 nt
buffer_store_dwordx4 v[168:171], v242, s[20:23], s53 offen offset:64 nt
v_exp_f32 v218, v218
v_exp_f32 v203, v203
v_mfma_f32_16x16x32_bf16 v[196:199], a[60:63], v[220:223], 0
s_add_u32 s53, s46, 4096
v_exp_f32 v202, v202
v_mfma_f32_16x16x32_bf16 v[196:199], a[56:59], v[212:215], v[196:199]
s_add_u32 s46, s46, 13107200
v_exp_f32 v200, v200
v_mfma_f32_16x16x32_bf16 v[196:199], a[52:55], v[208:211], v[196:199]
v_cvt_pk_bf16_f32 v121, v202, v203
v_cvt_pk_bf16_f32 v122, v216, v217
v_mfma_f32_16x16x32_bf16 v[196:199], a[48:51], v[204:207], v[196:199]
v_cvt_pk_bf16_f32 v123, v218, v219
v_cvt_pk_bf16_f32 v120, v200, v201
v_mfma_f32_16x16x32_bf16 v[160:163], a[192:195], v[204:207], 0
v_cvt_pk_bf16_f32 v109, v234, v235
v_cvt_pk_bf16_f32 v108, v232, v233
v_mfma_f32_16x16x32_bf16 v[160:163], a[196:199], v[208:211], v[160:163]
v_cvt_pk_bf16_f32 v106, v228, v229
v_cvt_pk_bf16_f32 v105, v226, v227
v_mfma_f32_16x16x32_bf16 v[160:163], a[200:203], v[212:215], v[160:163]
v_cvt_pk_bf16_f32 v110, v196, v197
v_cvt_pk_bf16_f32 v111, v198, v199
v_mfma_f32_16x16x32_bf16 v[160:163], a[204:207], v[220:223], v[160:163]
v_cvt_pk_bf16_f32 v104, v224, v225
v_cvt_pk_bf16_f32 v107, v230, v231
v_mfma_f32_16x16x32_bf16 v[164:167], a[220:223], v[220:223], 0
v_mfma_f32_16x16x32_bf16 v[164:167], a[216:219], v[212:215], v[164:167]
v_mov_b64 v[196:197], 0
v_mfma_f32_16x16x32_bf16 v[164:167], a[212:215], v[208:211], v[164:167]
v_mfma_f32_16x16x32_bf16 v[164:167], a[208:211], v[204:207], v[164:167]
v_mfma_f32_16x16x32_bf16 v[168:171], a[224:227], v[204:207], 0
v_mfma_f32_16x16x32_bf16 v[168:171], a[228:231], v[208:211], v[168:171]
v_mfma_f32_16x16x32_bf16 v[168:171], a[232:235], v[212:215], v[168:171]
v_mfma_f32_16x16x32_bf16 v[168:171], a[236:239], v[220:223], v[168:171]
v_mov_b64 v[200:201], s[96:97]
v_mov_b64 v[202:203], s[96:97]
v_smfmac_f32_16x16x64_bf16 v[196:199], v[192:195], v[112:119], v250
v_smfmac_f32_16x16x64_bf16 v[196:199], v[192:195], v[120:127], v250 abid:1
s_nop 2
v_mfma_f32_16x16x32_bf16 v[172:175], a[252:255], v[220:223], 0
s_nop 2
v_mfma_f32_16x16x32_bf16 v[172:175], a[248:251], v[212:215], v[172:175]
v_add_f32 v196, v196, v197
v_mfma_f32_16x16x32_bf16 v[172:175], a[244:247], v[208:211], v[172:175]
v_rcp_f32 v253, v196
v_mfma_f32_16x16x32_bf16 v[172:175], a[240:243], v[204:207], v[172:175]
v_max3_f32 v254, v254, v196, v253
v_smfmac_f32_16x16x64_bf16 v[200:203], v[96:99], v[104:111], v250
s_nop 2
v_mfma_f32_16x16x32_bf16 v[196:199], v[0:3], v[104:107], 0
s_nop 2
v_mfma_f32_16x16x32_bf16 v[196:199], v[4:7], v[108:111], v[196:199]
v_add_f32 v202, v202, v203
v_add_f32 v200, v200, v201
v_mfma_f32_16x16x32_bf16 v[204:207], v[12:15], v[108:111], 0
v_exp_f32 v200, v200
v_mfma_f32_16x16x32_bf16 v[204:207], v[8:11], v[104:107], v[204:207]
ds_read_b128 v[212:215], v240 offset:9216
ds_read_b128 v[224:227], v240 offset:8960
v_mfma_f32_16x16x32_bf16 v[216:219], v[16:19], v[104:107], 0
ds_read_b128 v[208:211], v240 offset:8448
ds_read_b128 v[220:223], v240 offset:8704
v_mfma_f32_16x16x32_bf16 v[216:219], v[20:23], v[108:111], v[216:219]
v_exp_f32 v202, v202
v_mfma_f32_16x16x32_bf16 v[176:179], v[48:51], v[112:115], v[176:179]
v_perm_b32 v141, v202, v200, v252
v_perm_b32 v140, v202, v200, v251
v_mfma_f32_16x16x32_bf16 v[176:179], v[64:67], v[116:119], v[176:179]
v_exp_f32 v198, v198
v_mfma_f32_16x16x32_bf16 v[176:179], v[80:83], v[120:123], v[176:179]
v_exp_f32 v199, v199
v_mfma_f32_16x16x32_bf16 v[180:183], v[84:87], v[120:123], v[180:183]
v_exp_f32 v196, v196
v_mfma_f32_16x16x32_bf16 v[180:183], v[52:55], v[112:115], v[180:183]
v_exp_f32 v197, v197
v_mfma_f32_16x16x32_bf16 v[180:183], v[68:71], v[116:119], v[180:183]
v_cvt_pk_bf16_f32 v129, v198, v199
v_cvt_pk_bf16_f32 v128, v196, v197
v_mfma_f32_16x16x32_bf16 v[184:187], v[72:75], v[116:119], v[184:187]
v_exp_f32 v204, v204
v_mfma_f32_16x16x32_bf16 v[184:187], v[88:91], v[120:123], v[184:187]
v_exp_f32 v205, v205
v_mfma_f32_16x16x32_bf16 v[184:187], v[56:59], v[112:115], v[184:187]
v_exp_f32 v206, v206
v_mfma_f32_16x16x32_bf16 v[188:191], v[60:63], v[112:115], v[188:191]
v_exp_f32 v207, v207
v_mfma_f32_16x16x32_bf16 v[188:191], v[76:79], v[116:119], v[188:191]
s_waitcnt lgkmcnt(2)
v_cvt_pk_bf16_f32 v131, v206, v207
v_cvt_pk_bf16_f32 v130, v204, v205
v_mfma_f32_16x16x32_bf16 v[188:191], v[92:95], v[120:123], v[188:191]
s_waitcnt lgkmcnt(0)
v_fmac_f32 v155, v187, v253
v_fmac_f32 v144, v176, v253
v_mfma_f32_16x16x32_bf16 v[200:203], v[24:27], v[104:107], 0
v_fmac_f32 v153, v185, v253
v_fmac_f32 v152, v184, v253
v_mfma_f32_16x16x32_bf16 v[200:203], v[28:31], v[108:111], v[200:203]
s_nop 0
v_fmac_f32 v158, v190, v253
v_fmac_f32 v157, v189, v253
v_mfma_f32_16x16x32_bf16 v[228:231], v[36:39], v[108:111], 0
v_fmac_f32 v145, v177, v253
v_fmac_f32 v148, v180, v253
v_mfma_f32_16x16x32_bf16 v[228:231], v[32:35], v[104:107], v[228:231]
v_fmac_f32 v159, v191, v253
v_cvt_pk_bf16_f32 v152, v152, v153
v_mfma_f32_16x16x32_bf16 v[232:235], v[40:43], v[104:107], 0
v_fmac_f32 v146, v178, v253
v_cvt_pk_bf16_f32 v144, v144, v145
v_mfma_f32_16x16x32_bf16 v[232:235], v[44:47], v[108:111], v[232:235]
v_fmac_f32 v147, v179, v253
v_cvt_pk_bf16_f32 v145, v146, v147
v_mfma_f32_16x16x32_bf16 v[236:239], a[0:3], v[208:211], 0
v_fmac_f32 v151, v183, v253
v_pk_max_i16 v145, v145, 0
v_mfma_f32_16x16x32_bf16 v[236:239], a[4:7], v[220:223], v[236:239]
v_fmac_f32 v154, v186, v253
v_fmac_f32 v150, v182, v253
v_mfma_f32_16x16x32_bf16 v[236:239], a[8:11], v[224:227], v[236:239]
v_fmac_f32 v156, v188, v253
v_cvt_pk_bf16_f32 v153, v154, v155
v_mfma_f32_16x16x32_bf16 v[236:239], a[12:15], v[212:215], v[236:239]
v_cvt_pk_bf16_f32 v154, v156, v157
v_pk_max_i16 v154, v154, 0
v_mfma_f32_16x16x32_bf16 v[196:199], a[28:31], v[212:215], 0
v_cvt_pk_bf16_f32 v147, v150, v151
v_pk_max_i16 v153, v153, 0
v_mfma_f32_16x16x32_bf16 v[196:199], a[24:27], v[224:227], v[196:199]
v_fmac_f32 v149, v181, v253
v_cvt_pk_bf16_f32 v146, v148, v149
v_mfma_f32_16x16x32_bf16 v[196:199], a[20:23], v[220:223], v[196:199]
v_cvt_pk_bf16_f32 v155, v158, v159
v_pk_max_i16 v155, v155, 0
v_mfma_f32_16x16x32_bf16 v[196:199], a[16:19], v[208:211], v[196:199]
v_pk_max_i16 v147, v147, 0
v_pk_max_i16 v144, v144, 0
v_mfma_f32_16x16x32_bf16 v[204:207], a[32:35], v[208:211], 0
v_pk_max_i16 v152, v152, 0
v_pk_max_i16 v146, v146, 0
v_mfma_f32_16x16x32_bf16 v[204:207], a[36:39], v[220:223], v[204:207]
v_cvt_pk_bf16_f32 v105, v238, v239
v_cvt_pk_bf16_f32 v104, v236, v237
v_mfma_f32_16x16x32_bf16 v[204:207], a[40:43], v[224:227], v[204:207]
v_cvt_pk_bf16_f32 v107, v198, v199
v_cvt_pk_bf16_f32 v106, v196, v197
v_mfma_f32_16x16x32_bf16 v[204:207], a[44:47], v[212:215], v[204:207]
v_exp_f32 v217, v217
v_mfma_f32_32x32x16_bf16 v[176:191], v[100:103], v[140:143], 0
buffer_store_dwordx4 v[144:147], v242, s[20:23], s52 offen offset:0 nt
buffer_store_dwordx4 v[152:155], v242, s[20:23], s52 offen offset:64 nt
v_exp_f32 v216, v216
v_exp_f32 v230, v230
v_mfma_f32_16x16x32_bf16 v[196:199], a[60:63], v[212:215], 0
v_exp_f32 v219, v219
v_mfma_f32_16x16x32_bf16 v[196:199], a[56:59], v[224:227], v[196:199]
v_cvt_pk_bf16_f32 v132, v216, v217
v_cvt_pk_bf16_f32 v109, v206, v207
v_mfma_f32_16x16x32_bf16 v[196:199], a[52:55], v[220:223], v[196:199]
v_exp_f32 v218, v218
v_mfma_f32_16x16x32_bf16 v[196:199], a[48:51], v[208:211], v[196:199]
v_cvt_pk_bf16_f32 v133, v218, v219
v_cvt_pk_bf16_f32 v108, v204, v205
v_mfma_f32_16x16x32_bf16 v[144:147], a[192:195], v[208:211], 0
v_exp_f32 v201, v201
v_mfma_f32_16x16x32_bf16 v[144:147], a[196:199], v[220:223], v[144:147]
v_exp_f32 v203, v203
v_mfma_f32_16x16x32_bf16 v[144:147], a[200:203], v[224:227], v[144:147]
v_exp_f32 v202, v202
v_mfma_f32_16x16x32_bf16 v[144:147], a[204:207], v[212:215], v[144:147]
v_exp_f32 v200, v200
v_mfma_f32_16x16x32_bf16 v[148:151], a[220:223], v[212:215], 0
v_cvt_pk_bf16_f32 v135, v202, v203
v_cvt_pk_bf16_f32 v134, v200, v201
v_mfma_f32_16x16x32_bf16 v[148:151], a[216:219], v[224:227], v[148:151]
v_exp_f32 v229, v229
v_mfma_f32_16x16x32_bf16 v[148:151], a[212:215], v[220:223], v[148:151]
v_exp_f32 v228, v228
v_mfma_f32_16x16x32_bf16 v[148:151], a[208:211], v[208:211], v[148:151]
v_exp_f32 v231, v231
v_mfma_f32_16x16x32_bf16 v[152:155], a[224:227], v[208:211], 0
v_cvt_pk_bf16_f32 v136, v228, v229
v_cvt_pk_bf16_f32 v137, v230, v231
v_mfma_f32_16x16x32_bf16 v[152:155], a[228:231], v[220:223], v[152:155]
v_mov_b64 v[200:201], 0
v_cvt_pk_bf16_f32 v110, v196, v197
v_mfma_f32_16x16x32_bf16 v[152:155], a[232:235], v[224:227], v[152:155]
v_exp_f32 v235, v235
v_mfma_f32_16x16x32_bf16 v[152:155], a[236:239], v[212:215], v[152:155]
v_exp_f32 v232, v232
v_mfma_f32_16x16x32_bf16 v[156:159], a[252:255], v[212:215], 0
v_exp_f32 v234, v234
v_mfma_f32_16x16x32_bf16 v[156:159], a[248:251], v[224:227], v[156:159]
v_cvt_pk_bf16_f32 v139, v234, v235
v_cvt_pk_bf16_f32 v111, v198, v199
v_mfma_f32_16x16x32_bf16 v[156:159], a[244:247], v[220:223], v[156:159]
v_exp_f32 v233, v233
v_mfma_f32_16x16x32_bf16 v[156:159], a[240:243], v[208:211], v[156:159]
v_cvt_pk_bf16_f32 v138, v232, v233
v_mov_b64 v[198:199], s[96:97]
v_smfmac_f32_16x16x64_bf16 v[200:203], v[192:195], v[128:135], v250
v_mov_b64 v[196:197], s[96:97]
v_smfmac_f32_16x16x64_bf16 v[200:203], v[192:195], v[136:143], v250 abid:1
s_nop 2
v_smfmac_f32_16x16x64_bf16 v[196:199], v[96:99], v[104:111], v250
s_nop 2
v_mfma_f32_16x16x32_bf16 v[204:207], v[0:3], v[104:107], 0
v_add_f32 v200, v200, v201
s_nop 0
v_mfma_f32_16x16x32_bf16 v[204:207], v[4:7], v[108:111], v[204:207]
v_rcp_f32 v253, v200
v_mfma_f32_16x16x32_bf16 v[208:211], v[12:15], v[108:111], 0
v_max3_f32 v254, v254, v200, v253
v_add_f32 v198, v198, v199
v_mfma_f32_16x16x32_bf16 v[208:211], v[8:11], v[104:107], v[208:211]
ds_read_b128 v[224:227], v240 offset:12672
v_add_f32 v196, v196, v197
v_mfma_f32_16x16x32_bf16 v[220:223], v[16:19], v[104:107], 0
ds_read_b128 v[216:219], v240 offset:13440
ds_read_b128 v[228:231], v240 offset:13184
v_mfma_f32_16x16x32_bf16 v[220:223], v[20:23], v[108:111], v[220:223]
ds_read_b128 v[212:215], v240 offset:12928
v_add_u32 v240, s56, v240
v_mfma_f32_16x16x32_bf16 v[176:179], v[48:51], v[128:131], v[176:179]
s_sub_u32 s56, 0, s56
v_exp_f32 v196, v196
v_mfma_f32_16x16x32_bf16 v[176:179], v[64:67], v[132:135], v[176:179]
v_exp_f32 v198, v198
v_mfma_f32_16x16x32_bf16 v[176:179], v[80:83], v[136:139], v[176:179]
v_perm_b32 v125, v198, v196, v252
v_perm_b32 v124, v198, v196, v251
v_mfma_f32_16x16x32_bf16 v[180:183], v[84:87], v[136:139], v[180:183]
v_exp_f32 v220, v220
v_mfma_f32_16x16x32_bf16 v[180:183], v[52:55], v[128:131], v[180:183]
v_exp_f32 v222, v222
v_mfma_f32_16x16x32_bf16 v[180:183], v[68:71], v[132:135], v[180:183]
v_exp_f32 v223, v223
v_mfma_f32_16x16x32_bf16 v[184:187], v[72:75], v[132:135], v[184:187]
v_exp_f32 v221, v221
v_mfma_f32_16x16x32_bf16 v[184:187], v[88:91], v[136:139], v[184:187]
v_cvt_pk_bf16_f32 v116, v220, v221
v_cvt_pk_bf16_f32 v117, v222, v223
v_mfma_f32_16x16x32_bf16 v[184:187], v[56:59], v[128:131], v[184:187]
s_nop 0
v_fmac_f32 v167, v183, v253
v_fmac_f32 v160, v176, v253
v_mfma_f32_16x16x32_bf16 v[188:191], v[60:63], v[128:131], v[188:191]
v_mov_b32 v196, s45
v_fmac_f32 v161, v177, v253
v_mfma_f32_16x16x32_bf16 v[188:191], v[76:79], v[132:135], v[188:191]
s_waitcnt lgkmcnt(3)
v_fmac_f32 v170, v186, v253
v_cvt_pk_bf16_f32 v160, v160, v161
v_mfma_f32_16x16x32_bf16 v[188:191], v[92:95], v[136:139], v[188:191]
s_waitcnt lgkmcnt(1)
v_fmac_f32 v168, v184, v253
v_fmac_f32 v171, v187, v253
v_mfma_f32_16x16x32_bf16 v[200:203], v[24:27], v[104:107], 0
s_waitcnt lgkmcnt(0)
v_fmac_f32 v169, v185, v253
v_cvt_pk_bf16_f32 v168, v168, v169
v_mfma_f32_16x16x32_bf16 v[200:203], v[28:31], v[108:111], v[200:203]
s_waitcnt vmcnt(6)
ds_write_b16 v246, v196 offset:816
v_cvt_pk_bf16_f32 v169, v170, v171
v_fmac_f32 v175, v191, v253
v_mfma_f32_16x16x32_bf16 v[196:199], v[36:39], v[108:111], 0
v_fmac_f32 v173, v189, v253
v_fmac_f32 v174, v190, v253
v_mfma_f32_16x16x32_bf16 v[196:199], v[32:35], v[104:107], v[196:199]
v_fmac_f32 v166, v182, v253
v_cvt_pk_bf16_f32 v171, v174, v175
v_mfma_f32_16x16x32_bf16 v[232:235], v[40:43], v[104:107], 0
v_pk_max_i16 v169, v169, 0
v_fmac_f32 v163, v179, v253
v_mfma_f32_16x16x32_bf16 v[232:235], v[44:47], v[108:111], v[232:235]
v_fmac_f32 v172, v188, v253
v_cvt_pk_bf16_f32 v170, v172, v173
v_mfma_f32_16x16x32_bf16 v[236:239], a[0:3], v[224:227], 0
v_pk_max_i16 v170, v170, 0
v_fmac_f32 v164, v180, v253
v_mfma_f32_16x16x32_bf16 v[236:239], a[4:7], v[212:215], v[236:239]
v_fmac_f32 v162, v178, v253
v_cvt_pk_bf16_f32 v161, v162, v163
v_mfma_f32_16x16x32_bf16 v[236:239], a[8:11], v[228:231], v[236:239]
v_cvt_pk_bf16_f32 v163, v166, v167
v_pk_max_i16 v163, v163, 0
v_mfma_f32_16x16x32_bf16 v[236:239], a[12:15], v[216:219], v[236:239]
v_fmac_f32 v165, v181, v253
v_cvt_pk_bf16_f32 v162, v164, v165
v_mfma_f32_16x16x32_bf16 v[220:223], a[28:31], v[216:219], 0
v_pk_max_i16 v162, v162, 0
v_pk_max_i16 v161, v161, 0
v_mfma_f32_16x16x32_bf16 v[220:223], a[24:27], v[228:231], v[220:223]
v_pk_max_i16 v168, v168, 0
v_pk_max_i16 v160, v160, 0
v_mfma_f32_16x16x32_bf16 v[220:223], a[20:23], v[212:215], v[220:223]
v_cvt_pk_bf16_f32 v104, v236, v237
v_cvt_pk_bf16_f32 v105, v238, v239
v_mfma_f32_16x16x32_bf16 v[220:223], a[16:19], v[224:227], v[220:223]
v_pk_max_i16 v171, v171, 0
s_nop 0
v_mfma_f32_16x16x32_bf16 v[236:239], a[32:35], v[224:227], 0
v_exp_f32 v196, v196
v_mfma_f32_16x16x32_bf16 v[236:239], a[36:39], v[212:215], v[236:239]
v_exp_f32 v197, v197
v_mfma_f32_16x16x32_bf16 v[236:239], a[40:43], v[228:231], v[236:239]
s_nop 0
v_cvt_pk_bf16_f32 v106, v220, v221
v_cvt_pk_bf16_f32 v107, v222, v223
v_mfma_f32_16x16x32_bf16 v[236:239], a[44:47], v[216:219], v[236:239]
v_cvt_pk_bf16_f32 v120, v196, v197
s_nop 0
v_mfma_f32_32x32x16_bf16 v[176:191], v[100:103], v[124:127], 0
s_cmp_lg_u32 s45, 0
buffer_store_dwordx4 v[160:163], v242, s[20:23], s53 offen offset:0 nt
s_cbranch_scc1 L_loopf
buffer_store_dwordx4 v[168:171], v242, s[20:23], s53 offen offset:64 nt
v_mfma_f32_16x16x32_bf16 v[220:223], a[60:63], v[216:219], 0
s_barrier
v_mfma_f32_16x16x32_bf16 v[220:223], a[56:59], v[228:231], v[220:223]
s_add_u32 s52, s47, 8192
v_exp_f32 v199, v199
v_mfma_f32_16x16x32_bf16 v[220:223], a[52:55], v[212:215], v[220:223]
s_lshl_b32 s55, s41, 9
v_exp_f32 v198, v198
v_mfma_f32_16x16x32_bf16 v[220:223], a[48:51], v[224:227], v[220:223]
s_add_u32 s53, s47, 12288
v_cvt_pk_bf16_f32 v109, v238, v239
v_cvt_pk_bf16_f32 v121, v198, v199
v_mfma_f32_16x16x32_bf16 v[160:163], a[192:195], v[224:227], 0
v_mov_b64 v[196:197], s[96:97]
v_mov_b64 v[198:199], s[96:97]
v_mfma_f32_16x16x32_bf16 v[160:163], a[196:199], v[212:215], v[160:163]
s_nop 0
v_cvt_pk_bf16_f32 v110, v220, v221
v_cvt_pk_bf16_f32 v111, v222, v223
v_mfma_f32_16x16x32_bf16 v[160:163], a[200:203], v[228:231], v[160:163]
v_cvt_pk_bf16_f32 v108, v236, v237
v_mbcnt_lo_u32_b32 v243, -1, 0
v_mfma_f32_16x16x32_bf16 v[160:163], a[204:207], v[216:219], v[160:163]
v_exp_f32 v203, v203
v_mfma_f32_16x16x32_bf16 v[164:167], a[220:223], v[216:219], 0
v_exp_f32 v202, v202
v_mfma_f32_16x16x32_bf16 v[164:167], a[216:219], v[228:231], v[164:167]
v_exp_f32 v200, v200
v_mfma_f32_16x16x32_bf16 v[164:167], a[212:215], v[212:215], v[164:167]
v_exp_f32 v201, v201
v_mfma_f32_16x16x32_bf16 v[164:167], a[208:211], v[224:227], v[164:167]
v_cvt_pk_bf16_f32 v119, v202, v203
v_cvt_pk_bf16_f32 v118, v200, v201
v_mfma_f32_16x16x32_bf16 v[168:171], a[224:227], v[224:227], 0
v_exp_f32 v209, v209
v_mfma_f32_16x16x32_bf16 v[168:171], a[228:231], v[212:215], v[168:171]
v_exp_f32 v205, v205
v_mfma_f32_16x16x32_bf16 v[168:171], a[232:235], v[228:231], v[168:171]
v_exp_f32 v210, v210
v_mfma_f32_16x16x32_bf16 v[168:171], a[236:239], v[216:219], v[168:171]
v_exp_f32 v208, v208
v_mfma_f32_16x16x32_bf16 v[172:175], a[252:255], v[216:219], 0
ds_read_b128 v[216:219], v240 offset:768
v_cvt_pk_bf16_f32 v114, v208, v209
v_mfma_f32_16x16x32_bf16 v[172:175], a[248:251], v[228:231], v[172:175]
v_exp_f32 v204, v204
v_mfma_f32_16x16x32_bf16 v[172:175], a[244:247], v[212:215], v[172:175]
ds_read_b128 v[212:215], v240 offset:512
v_cvt_pk_bf16_f32 v112, v204, v205
v_mfma_f32_16x16x32_bf16 v[172:175], a[240:243], v[224:227], v[172:175]
v_exp_f32 v207, v207
v_smfmac_f32_16x16x64_bf16 v[196:199], v[96:99], v[104:111], v250
s_mul_i32 s54, s41, 12800
s_add_u32 s54, s54, 101376
v_mov_b64 v[224:225], 0
v_mfma_f32_16x16x32_bf16 v[200:203], v[0:3], v[104:107], 0
v_exp_f32 v211, v211
v_mfma_f32_16x16x32_bf16 v[200:203], v[4:7], v[108:111], v[200:203]
v_exp_f32 v206, v206
v_mfma_f32_16x16x32_bf16 v[220:223], v[12:15], v[108:111], 0
v_cvt_pk_bf16_f32 v113, v206, v207
v_cvt_pk_bf16_f32 v115, v210, v211
v_mfma_f32_16x16x32_bf16 v[220:223], v[8:11], v[104:107], v[220:223]
ds_read_b128 v[204:207], v240 offset:0
v_add_f32 v196, v196, v197
v_mfma_f32_16x16x32_bf16 v[228:231], v[16:19], v[104:107], 0
ds_read_b128 v[208:211], v240 offset:256
v_add_f32 v198, v198, v199
v_mfma_f32_16x16x32_bf16 v[228:231], v[20:23], v[108:111], v[228:231]
v_exp_f32 v234, v234
v_smfmac_f32_16x16x64_bf16 v[224:227], v[192:195], v[112:119], v250
s_mov_b32 vcc_lo, 0xf0000f
s_mov_b32 vcc_hi, 0xf0000f00
v_exp_f32 v233, v233
v_exp_f32 v235, v235
v_exp_f32 v232, v232
v_cvt_pk_bf16_f32 v123, v234, v235
v_cvt_pk_bf16_f32 v122, v232, v233
v_exp_f32 v196, v196
v_mbcnt_hi_u32_b32 v243, -1, v243
v_smfmac_f32_16x16x64_bf16 v[224:227], v[192:195], v[120:127], v250 abid:1
s_waitcnt lgkmcnt(3)
s_lshl_b32 s48, s43, 7
s_add_u32 s48, s48, s44
s_add_u32 s48, s48, 0
v_mfma_f32_16x16x32_bf16 v[176:179], v[80:83], v[120:123], v[176:179]
s_waitcnt lgkmcnt(2)
v_exp_f32 v198, v198
v_mfma_f32_16x16x32_bf16 v[176:179], v[64:67], v[116:119], v[176:179]
v_perm_b32 v140, v198, v196, v251
v_perm_b32 v141, v198, v196, v252
v_mfma_f32_16x16x32_bf16 v[176:179], v[48:51], v[112:115], v[176:179]
v_add_f32 v224, v224, v225
v_bfe_u32 v244, v243, 2, 2
v_mfma_f32_16x16x32_bf16 v[196:199], v[24:27], v[104:107], 0
v_rcp_f32 v253, v224
v_mfma_f32_16x16x32_bf16 v[196:199], v[28:31], v[108:111], v[196:199]
v_max3_f32 v254, v254, v224, v253
v_mov_b32 v245, s54
v_mfma_f32_16x16x32_bf16 v[180:183], v[52:55], v[112:115], v[180:183]
s_waitcnt lgkmcnt(1)
v_fmac_f32 v144, v176, v253
v_fmac_f32 v145, v177, v253
v_mfma_f32_16x16x32_bf16 v[180:183], v[68:71], v[116:119], v[180:183]
s_waitcnt lgkmcnt(0)
v_fmac_f32 v146, v178, v253
v_fmac_f32 v147, v179, v253
v_mfma_f32_16x16x32_bf16 v[180:183], v[84:87], v[120:123], v[180:183]
v_cvt_pk_bf16_f32 v144, v144, v145
v_cvt_pk_bf16_f32 v145, v146, v147
v_mfma_f32_16x16x32_bf16 v[232:235], v[32:35], v[104:107], 0
v_pk_max_i16 v144, v144, 0
v_pk_max_i16 v145, v145, 0
v_mfma_f32_16x16x32_bf16 v[232:235], v[36:39], v[108:111], v[232:235]
v_mul_u32_u24 v244, 1600, v244
v_add_u32 v245, v244, v245
v_mfma_f32_16x16x32_bf16 v[184:187], v[56:59], v[112:115], v[184:187]
v_fmac_f32 v148, v180, v253
v_fmac_f32 v149, v181, v253
v_mfma_f32_16x16x32_bf16 v[184:187], v[72:75], v[116:119], v[184:187]
v_fmac_f32 v150, v182, v253
v_fmac_f32 v151, v183, v253
v_mfma_f32_16x16x32_bf16 v[184:187], v[88:91], v[120:123], v[184:187]
v_cvt_pk_bf16_f32 v146, v148, v149
v_cvt_pk_bf16_f32 v147, v150, v151
v_mfma_f32_16x16x32_bf16 v[224:227], v[40:43], v[104:107], 0
v_pk_max_i16 v146, v146, 0
v_pk_max_i16 v147, v147, 0
v_mfma_f32_16x16x32_bf16 v[224:227], v[44:47], v[108:111], v[224:227]
v_bfe_u32 v244, v243, 0, 2
v_mul_u32_u24 v244, 272, v244
v_mfma_f32_16x16x32_bf16 v[188:191], v[60:63], v[112:115], v[188:191]
v_fmac_f32 v152, v184, v253
v_fmac_f32 v153, v185, v253
v_mfma_f32_16x16x32_bf16 v[188:191], v[76:79], v[116:119], v[188:191]
v_fmac_f32 v154, v186, v253
v_fmac_f32 v155, v187, v253
v_mfma_f32_16x16x32_bf16 v[188:191], v[92:95], v[120:123], v[188:191]
v_cvt_pk_bf16_f32 v152, v152, v153
v_cvt_pk_bf16_f32 v153, v154, v155
v_mfma_f32_16x16x32_bf16 v[0:3], a[192:195], v[204:207], 0
v_pk_max_i16 v152, v152, 0
v_pk_max_i16 v153, v153, 0
v_mfma_f32_16x16x32_bf16 v[0:3], a[196:199], v[208:211], v[0:3]
v_add_u32 v245, v244, v245
v_bfe_u32 v244, v243, 4, 2
v_mfma_f32_16x16x32_bf16 v[0:3], a[200:203], v[212:215], v[0:3]
v_fmac_f32 v156, v188, v253
v_fmac_f32 v157, v189, v253
v_mfma_f32_16x16x32_bf16 v[0:3], a[204:207], v[216:219], v[0:3]
v_fmac_f32 v158, v190, v253
v_fmac_f32 v159, v191, v253
v_mfma_f32_16x16x32_bf16 v[4:7], a[220:223], v[216:219], 0
v_cvt_pk_bf16_f32 v154, v156, v157
v_cvt_pk_bf16_f32 v155, v158, v159
v_mfma_f32_16x16x32_bf16 v[4:7], a[216:219], v[212:215], v[4:7]
v_pk_max_i16 v154, v154, 0
v_pk_max_i16 v155, v155, 0
v_mfma_f32_16x16x32_bf16 v[4:7], a[212:215], v[208:211], v[4:7]
v_lshl_add_u32 v245, v244, 4, v245
v_mov_b32 v249, s54
v_mfma_f32_16x16x32_bf16 v[4:7], a[208:211], v[204:207], v[4:7]
v_bfe_u32 v244, v243, 2, 2
v_add_u32 v249, 256, v249
v_mfma_f32_16x16x32_bf16 v[8:11], a[224:227], v[204:207], 0
ds_read_b128 v[236:239], v240 offset:4480
v_mul_u32_u24 v244, 1600, v244
v_mfma_f32_16x16x32_bf16 v[8:11], a[228:231], v[208:211], v[8:11]
v_add_u32 v249, v244, v249
v_bfe_u32 v244, v243, 0, 2
v_mfma_f32_16x16x32_bf16 v[8:11], a[232:235], v[212:215], v[8:11]
v_mul_u32_u24 v244, 272, v244
v_add_u32 v249, v244, v249
v_mfma_f32_16x16x32_bf16 v[8:11], a[236:239], v[216:219], v[8:11]
v_mov_b32 v247, s54
v_bfe_u32 v244, v243, 4, 2
v_mfma_f32_16x16x32_bf16 v[12:15], a[252:255], v[216:219], 0
ds_read_b128 v[216:219], v240 offset:4736
v_add_u32 v247, 1088, v247
v_mfma_f32_16x16x32_bf16 v[12:15], a[248:251], v[212:215], v[12:15]
ds_read_b128 v[212:215], v240 offset:4992
v_mul_u32_u24 v244, 1600, v244
v_mfma_f32_16x16x32_bf16 v[12:15], a[244:247], v[208:211], v[12:15]
ds_read_b128 v[208:211], v245 offset:0
v_add_u32 v247, v244, v247
v_mfma_f32_16x16x32_bf16 v[12:15], a[240:243], v[204:207], v[12:15]
ds_read_b128 v[204:207], v245 offset:64
v_bfe_u32 v244, v243, 0, 4
v_mfma_f32_32x32x16_bf16 v[176:191], v[100:103], v[140:143], 0
buffer_store_dwordx4 v[144:147], v242, s[20:23], s52 offen offset:0 nt
buffer_store_dwordx4 v[152:155], v242, s[20:23], s52 offen offset:64 nt
v_lshl_add_u32 v247, v244, 3, v247
ds_read_b64 v[32:33], v247 offset:0
ds_read_b64 v[34:35], v247 offset:6400
ds_read_b64 v[36:37], v247 offset:128
ds_read_b64 v[38:39], v247 offset:6528
ds_read_b64 v[40:41], v247 offset:256
ds_read_b64 v[42:43], v247 offset:6656
ds_read_b64 v[44:45], v247 offset:384
ds_read_b64 v[46:47], v247 offset:6784
v_mov_b32 v248, s55
v_add_u32 v248, 156928, v248
v_bfe_u32 v244, v243, 0, 4
v_lshl_add_u32 v248, v244, 4, v248
ds_read_b64 v[104:105], v248 offset:0
ds_read_b32 v110, v248 offset:8
ds_read_b64 v[108:109], v248 offset:256
ds_read_b32 v111, v248 offset:264
v_mov_b64 v[106:107], 0
v_exp_f32 v200, v200
v_exp_f32 v201, v201
v_exp_f32 v202, v202
v_exp_f32 v203, v203
v_cvt_pk_bf16_f32 v128, v200, v201
v_cvt_pk_bf16_f32 v129, v202, v203
ds_read_b128 v[200:203], v245 offset:128
v_exp_f32 v220, v220
s_waitcnt lgkmcnt(4)
v_cndmask_b32 v104, 0, v104, vcc
v_cndmask_b32 v105, 0, v105, vcc
v_exp_f32 v221, v221
v_mov_b32 v246, 24576
v_mfma_f32_16x16x32_bf16 v[208:211], v[32:35], v[104:107], v[208:211]
s_waitcnt lgkmcnt(1)
v_exp_f32 v222, v222
v_mfma_f32_16x16x32_bf16 v[204:207], v[36:39], v[104:107], v[204:207]
v_exp_f32 v223, v223
v_cvt_pk_bf16_f32 v130, v220, v221
v_cvt_pk_bf16_f32 v131, v222, v223
v_bfe_u32 v244, v243, 0, 2
s_waitcnt lgkmcnt(0)
v_mfma_f32_16x16x32_bf16 v[200:203], v[40:43], v[104:107], v[200:203]
ds_read_b128 v[220:223], v245 offset:192
v_exp_f32 v228, v228
v_exp_f32 v229, v229
v_exp_f32 v230, v230
v_exp_f32 v231, v231
v_cvt_pk_bf16_f32 v132, v228, v229
v_cvt_pk_bf16_f32 v133, v230, v231
ds_read_b128 v[228:231], v249 offset:0
v_exp_f32 v232, v232
v_exp_f32 v233, v233
v_exp_f32 v196, v196
v_cvt_pk_bf16_f32 v136, v232, v233
s_waitcnt lgkmcnt(1)
v_mfma_f32_16x16x32_bf16 v[220:223], v[44:47], v[104:107], v[220:223]
v_exp_f32 v197, v197
v_exp_f32 v198, v198
v_exp_f32 v199, v199
v_exp_f32 v234, v234
v_exp_f32 v235, v235
v_cvt_pk_bf16_f32 v134, v196, v197
v_cvt_pk_bf16_f32 v135, v198, v199
v_mov_b64 v[232:233], 0
v_cvt_pk_bf16_f32 v137, v234, v235
v_lshl_add_u32 v246, v244, 8, v246
v_smfmac_f32_16x16x64_bf16 v[232:235], v[192:195], v[128:135], v250
s_waitcnt lgkmcnt(0)
ds_read_b128 v[196:199], v240 offset:4224
v_exp_f32 v224, v224
v_exp_f32 v225, v225
v_exp_f32 v226, v226
v_exp_f32 v227, v227
v_cvt_pk_bf16_f32 v138, v224, v225
v_cvt_pk_bf16_f32 v139, v226, v227
v_add_f32 v228, v228, v229
v_add_f32 v230, v230, v231
v_smfmac_f32_16x16x64_bf16 v[232:235], v[192:195], v[136:143], v250 abid:1
ds_read_b128 v[224:227], v245 offset:6400
v_add_f32 v228, v228, v110
v_add_f32 v228, v228, v230
v_rcp_f32 v229, v228
v_bfe_u32 v244, v243, 2, 2
s_waitcnt lgkmcnt(1)
v_mfma_f32_16x16x32_bf16 v[16:19], a[192:195], v[196:199], 0
v_fmac_f32 v8, v200, v229
v_fmac_f32 v9, v201, v229
v_mfma_f32_16x16x32_bf16 v[16:19], a[196:199], v[236:239], v[16:19]
v_fmac_f32 v0, v208, v229
v_fmac_f32 v1, v209, v229
v_mfma_f32_16x16x32_bf16 v[16:19], a[200:203], v[216:219], v[16:19]
v_fmac_f32 v10, v202, v229
v_fmac_f32 v11, v203, v229
v_mfma_f32_16x16x32_bf16 v[16:19], a[204:207], v[212:215], v[16:19]
ds_read_b128 v[200:203], v245 offset:6528
v_fmac_f32 v2, v210, v229
v_mfma_f32_16x16x32_bf16 v[20:23], a[220:223], v[212:215], 0
v_mul_u32_u24 v244, 13107200, v244
v_fmac_f32 v3, v211, v229
v_mfma_f32_16x16x32_bf16 v[20:23], a[216:219], v[216:219], v[20:23]
v_cvt_pk_bf16_f32 v0, v0, v1
v_cvt_pk_bf16_f32 v8, v8, v9
v_mfma_f32_16x16x32_bf16 v[20:23], a[212:215], v[236:239], v[20:23]
v_fmac_f32 v4, v204, v229
v_fmac_f32 v5, v205, v229
v_mfma_f32_16x16x32_bf16 v[20:23], a[208:211], v[196:199], v[20:23]
v_fmac_f32 v6, v206, v229
v_fmac_f32 v7, v207, v229
v_mfma_f32_16x16x32_bf16 v[24:27], a[224:227], v[196:199], 0
ds_read_b128 v[204:207], v245 offset:6592
v_cndmask_b32 v108, 0, v108, vcc
v_mfma_f32_16x16x32_bf16 v[24:27], a[228:231], v[236:239], v[24:27]
v_cndmask_b32 v109, 0, v109, vcc
v_add_f32 v232, v232, v233
v_mfma_f32_16x16x32_bf16 v[24:27], a[232:235], v[216:219], v[24:27]
v_rcp_f32 v253, v232
v_mfma_f32_16x16x32_bf16 v[24:27], a[236:239], v[212:215], v[24:27]
s_waitcnt lgkmcnt(2)
v_max3_f32 v254, v254, v228, v229
v_max3_f32 v254, v254, v232, v253
v_mfma_f32_16x16x32_bf16 v[28:31], a[252:255], v[212:215], 0
ds_read_b128 v[232:235], v245 offset:6464
ds_read_b128 v[212:215], v249 offset:6400
v_mfma_f32_16x16x32_bf16 v[28:31], a[248:251], v[216:219], v[28:31]
v_add_u32 v246, v244, v246
v_cvt_pk_bf16_f32 v1, v2, v3
v_mfma_f32_16x16x32_bf16 v[28:31], a[244:247], v[236:239], v[28:31]
v_fmac_f32 v12, v220, v229
v_fmac_f32 v13, v221, v229
v_mfma_f32_16x16x32_bf16 v[28:31], a[240:243], v[196:199], v[28:31]
v_fmac_f32 v14, v222, v229
v_fmac_f32 v15, v223, v229
v_mfma_f32_16x16x32_bf16 v[176:179], v[48:51], v[128:131], v[176:179]
s_waitcnt lgkmcnt(3)
v_cvt_pk_bf16_f32 v9, v10, v11
v_bfe_u32 v244, v243, 4, 2
v_mfma_f32_16x16x32_bf16 v[176:179], v[64:67], v[132:135], v[176:179]
v_cvt_pk_bf16_f32 v2, v4, v5
v_cvt_pk_bf16_f32 v3, v6, v7
v_mfma_f32_16x16x32_bf16 v[176:179], v[80:83], v[136:139], v[176:179]
s_waitcnt lgkmcnt(0)
v_cvt_pk_bf16_f32 v10, v12, v13
v_cvt_pk_bf16_f32 v11, v14, v15
v_mfma_f32_16x16x32_bf16 v[180:183], v[84:87], v[136:139], v[180:183]
v_lshl_add_u32 v246, v244, 4, v246
v_pk_max_i16 v0, v0, 0
v_mfma_f32_16x16x32_bf16 v[180:183], v[52:55], v[128:131], v[180:183]
v_pk_max_i16 v1, v1, 0
v_pk_max_i16 v2, v2, 0
v_mfma_f32_16x16x32_bf16 v[180:183], v[68:71], v[132:135], v[180:183]
v_pk_max_i16 v3, v3, 0
v_pk_max_i16 v8, v8, 0
v_mfma_f32_16x16x32_bf16 v[184:187], v[72:75], v[132:135], v[184:187]
v_pk_max_i16 v9, v9, 0
v_pk_max_i16 v10, v10, 0
v_mfma_f32_16x16x32_bf16 v[184:187], v[88:91], v[136:139], v[184:187]
v_pk_max_i16 v11, v11, 0
v_fmac_f32 v160, v176, v253
v_mfma_f32_16x16x32_bf16 v[184:187], v[56:59], v[128:131], v[184:187]
buffer_store_dwordx4 v[0:3], v246, s[20:23], s48 offen offset:0 nt
buffer_store_dwordx4 v[8:11], v246, s[20:23], s48 offen offset:64 nt
v_fmac_f32 v161, v177, v253
v_fmac_f32 v162, v178, v253
v_fmac_f32 v163, v179, v253
v_cvt_pk_bf16_f32 v160, v160, v161
v_mfma_f32_16x16x32_bf16 v[188:191], v[60:63], v[128:131], v[188:191]
s_nop 0
v_fmac_f32 v168, v184, v253
v_fmac_f32 v169, v185, v253
v_mfma_f32_16x16x32_bf16 v[188:191], v[76:79], v[132:135], v[188:191]
v_fmac_f32 v170, v186, v253
v_fmac_f32 v171, v187, v253
v_mfma_f32_16x16x32_bf16 v[188:191], v[92:95], v[136:139], v[188:191]
v_cvt_pk_bf16_f32 v168, v168, v169
v_fmac_f32 v164, v180, v253
v_mfma_f32_16x16x32_bf16 v[224:227], v[32:35], v[106:109], v[224:227]
v_fmac_f32 v165, v181, v253
v_fmac_f32 v166, v182, v253
v_mfma_f32_16x16x32_bf16 v[232:235], v[36:39], v[106:109], v[232:235]
v_fmac_f32 v167, v183, v253
v_cvt_pk_bf16_f32 v161, v162, v163
v_mfma_f32_16x16x32_bf16 v[200:203], v[40:43], v[106:109], v[200:203]
v_fmac_f32 v172, v188, v253
v_fmac_f32 v173, v189, v253
v_mfma_f32_16x16x32_bf16 v[204:207], v[44:47], v[106:109], v[204:207]
v_fmac_f32 v174, v190, v253
v_fmac_f32 v175, v191, v253
v_cvt_pk_bf16_f32 v169, v170, v171
v_cvt_pk_bf16_f32 v162, v164, v165
v_cvt_pk_bf16_f32 v163, v166, v167
v_cvt_pk_bf16_f32 v170, v172, v173
v_cvt_pk_bf16_f32 v171, v174, v175
v_pk_max_i16 v160, v160, 0
v_pk_max_i16 v161, v161, 0
v_pk_max_i16 v162, v162, 0
v_pk_max_i16 v163, v163, 0
v_pk_max_i16 v168, v168, 0
v_pk_max_i16 v169, v169, 0
v_pk_max_i16 v170, v170, 0
v_pk_max_i16 v171, v171, 0
buffer_store_dwordx4 v[160:163], v242, s[20:23], s53 offen offset:0 nt
buffer_store_dwordx4 v[168:171], v242, s[20:23], s53 offen offset:64 nt
v_add_f32 v212, v212, v213
v_add_f32 v214, v214, v215
v_add_f32 v212, v212, v111
v_add_f32 v212, v212, v214
v_rcp_f32 v213, v212
s_lshl_b32 s51, s43, 7
s_add_u32 s51, s51, s44
s_add_u32 s51, s51, 52428800
v_fmac_f32 v16, v224, v213
v_fmac_f32 v17, v225, v213
v_fmac_f32 v24, v200, v213
v_fmac_f32 v25, v201, v213
v_fmac_f32 v18, v226, v213
v_fmac_f32 v19, v227, v213
v_cvt_pk_bf16_f32 v16, v16, v17
v_fmac_f32 v26, v202, v213
v_fmac_f32 v27, v203, v213
v_cvt_pk_bf16_f32 v24, v24, v25
v_fmac_f32 v20, v232, v213
v_fmac_f32 v21, v233, v213
v_fmac_f32 v22, v234, v213
v_fmac_f32 v23, v235, v213
v_cvt_pk_bf16_f32 v17, v18, v19
v_fmac_f32 v28, v204, v213
v_fmac_f32 v29, v205, v213
v_fmac_f32 v30, v206, v213
v_fmac_f32 v31, v207, v213
v_cvt_pk_bf16_f32 v25, v26, v27
v_cvt_pk_bf16_f32 v18, v20, v21
v_cvt_pk_bf16_f32 v19, v22, v23
v_cvt_pk_bf16_f32 v26, v28, v29
v_cvt_pk_bf16_f32 v27, v30, v31
v_pk_max_i16 v16, v16, 0
v_pk_max_i16 v17, v17, 0
v_pk_max_i16 v18, v18, 0
v_pk_max_i16 v19, v19, 0
v_pk_max_i16 v24, v24, 0
v_pk_max_i16 v25, v25, 0
v_pk_max_i16 v26, v26, 0
v_pk_max_i16 v27, v27, 0
buffer_store_dwordx4 v[16:19], v246, s[20:23], s51 offen offset:0 nt
buffer_store_dwordx4 v[24:27], v246, s[20:23], s51 offen offset:64 nt
v_max3_f32 v254, v254, v212, v213
v_mov_b32 v1, 0x53800000
v_cmp_nle_f32 vcc, v254, v1
s_lshl_b32 s52, s41, 2
s_add_u32 s52, s52, 158976
s_or_b32 s3, vcc_lo, vcc_hi
v_mov_b32 v2, s52
v_mov_b32 v3, s3
ds_write_b32 v2, v3
v_mov_b32 v2, 158976
s_waitcnt lgkmcnt(0)
s_barrier
ds_read_b128 v[4:7], v2
s_waitcnt lgkmcnt(0)
v_or_b32 v4, v4, v5
v_or3_b32 v4, v4, v6, v7
s_nop 0
v_readfirstlane_b32 s3, v4
s_nop 3
s_cmp_eq_u32 s3, 0
s_cbranch_scc1 L_end
L_fast_end:
s_waitcnt vmcnt(0)
s_barrier
s_mov_b32 s45, 8
s_mov_b32 s3, 64
s_mov_b32 s46, s44
s_mov_b32 s47, 0x7ff00000
s_mov_b32 s56, 50688
v_mbcnt_lo_u32_b32 v48, -1, 0
v_mbcnt_hi_u32_b32 v48, -1, v48
v_lshlrev_b32 v53, 4, v48
s_lshl_b32 s54, s41, 13
s_add_u32 s57, s54, 4096
v_and_b32 v49, 16, v48
v_lshlrev_b32 v52, 2, v49
v_lshlrev_b32 v49, 1, v49
v_xor_b32 v50, v53, v49
s_mul_i32 s49, s42, 25344
s_mul_i32 s53, s43, 1056
s_add_u32 s49, s49, s53
s_add_u32 m0, s49, 0
s_lshl_b32 s55, s43, 10
s_add_u32 s55, s55, s44
s_add_u32 s48, s55, 0
v_mov_b32 v237, 0
v_bfe_u32 v49, v48, 0, 2
v_lshl_add_u32 v237, v49, 4, v237
v_bfe_u32 v49, v48, 4, 2
v_lshl_add_u32 v237, v49, 6, v237
v_bfe_u32 v49, v48, 2, 2
v_lshl_add_u32 v237, v49, 8, v237
v_xor_b32 v51, 64, v50
s_lshl_b32 s53, s43, 14
v_mov_b32 v248, s53
v_add_u32 v248, 50688, v248
v_bfe_u32 v49, v48, 4, 2
v_lshl_add_u32 v248, v49, 10, v248
v_bfe_u32 v49, v48, 2, 2
v_lshl_add_u32 v248, v49, 7, v248
v_bfe_u32 v49, v48, 3, 1
v_lshl_add_u32 v248, v49, 5, v248
v_bfe_u32 v49, v48, 4, 1
v_lshl_add_u32 v248, v49, 6, v248
v_bfe_u32 v49, v48, 0, 2
v_lshl_add_u32 v248, v49, 3, v248
v_mov_b32 v252, s53
v_add_u32 v252, 116224, v252
v_bfe_u32 v49, v48, 4, 2
v_lshl_add_u32 v252, v49, 10, v252
v_bfe_u32 v49, v48, 2, 2
v_lshl_add_u32 v252, v49, 7, v252
v_bfe_u32 v49, v48, 3, 1
v_lshl_add_u32 v252, v49, 6, v252
v_bfe_u32 v49, v48, 0, 2
v_lshl_add_u32 v252, v49, 4, v252
s_mul_i32 s53, s42, 25344
v_bfe_u32 v49, v48, 2, 2
v_mov_b32 v236, s53
v_mul_u32_u24 v49, 1056, v49
v_add_u32 v236, v49, v236
v_bfe_u32 v49, v48, 0, 2
s_add_u32 s53, s54, 83456
v_lshl_add_u32 v236, v49, 6, v236
v_add_u32 v104, s53, v50
v_add_u32 v105, s53, v51
v_bfe_u32 v49, v48, 4, 2
s_lshl_b32 s53, s41, 12
v_lshl_add_u32 v236, v49, 4, v236
v_mov_b32 v54, s53
v_add_u32 v54, 50688, v54
v_bfe_u32 v49, v48, 3, 1
v_lshl_add_u32 v54, v49, 14, v54
v_bfe_u32 v49, v48, 4, 2
v_lshl_add_u32 v54, v49, 7, v54
v_bfe_u32 v49, v48, 2, 1
v_lshl_add_u32 v54, v49, 6, v54
v_bfe_u32 v49, v48, 5, 1
v_lshl_add_u32 v54, v49, 5, v54
v_bfe_u32 v49, v48, 0, 2
v_lshl_add_u32 v54, v49, 3, v54
s_lshl_b32 s53, s43, 7
v_mov_b32 v239, s53
v_bfe_u32 v49, v48, 0, 4
v_lshl_add_u32 v239, v49, 8, v239
s_mul_i32 s52, s41, 12288
s_add_u32 s52, s52, 101376
v_bfe_u32 v49, v48, 4, 2
v_lshl_add_u32 v239, v49, 4, v239
v_mov_b32 v241, s52
v_add_u32 v241, 8192, v241
v_bfe_u32 v49, v48, 4, 2
v_lshl_add_u32 v241, v49, 1, v241
v_bfe_u32 v49, v48, 0, 4
v_lshl_add_u32 v241, v49, 3, v241
buffer_load_dwordx4 v[152:155], v53, s[24:27], s54 offen offset:0
v_mov_b32 v240, s52
v_bfe_u32 v49, v48, 2, 2
v_lshl_add_u32 v240, v49, 7, v240
buffer_load_dwordx4 v[156:159], v53, s[24:27], s54 offen offset:1024
v_lshlrev_b32 v49, 2, v48
v_xor_b32 v49, v49, v48
v_and_b32 v49, 48, v49
buffer_load_dwordx4 v[160:163], v53, s[24:27], s54 offen offset:2048
s_lshl_b32 s53, s41, 10
v_add_u32 v240, v49, v240
v_mov_b32 v254, s53
v_add_u32 v254, 150528, v254
buffer_load_dwordx4 v[164:167], v53, s[24:27], s54 offen offset:3072
v_bfe_u32 v49, v48, 0, 6
v_mov_b32 v40, 0
v_mov_b32 v41, 0
buffer_load_dwordx4 v[168:171], v53, s[24:27], s57 offen offset:0
v_mov_b32 v42, 0
v_mov_b32 v43, 0
v_lshl_add_u32 v254, v49, 4, v254
buffer_load_dwordx4 v[172:175], v53, s[24:27], s57 offen offset:1024
ds_write_b128 v254, v[40:43] offset:0
buffer_load_dwordx4 v[176:179], v53, s[24:27], s57 offen offset:2048
ds_write_b128 v254, v[40:43] offset:256
buffer_load_dwordx4 v[180:183], v53, s[24:27], s57 offen offset:3072
buffer_load_dwordx4 v237, s[16:19], s48 offen nt lds
s_add_u32 m0, s49, 2112
s_add_u32 s48, s55, 2048
v_mov_b32 v245, s52
v_add_u32 v245, 4096, v245
buffer_load_dwordx4 v237, s[16:19], s48 offen nt lds
s_add_u32 m0, s49, 4224
s_add_u32 s48, s55, 4096
v_bfe_u32 v49, v48, 0, 2
buffer_load_dwordx4 v237, s[16:19], s48 offen nt lds
s_add_u32 m0, s49, 6336
s_add_u32 s48, s55, 6144
s_mov_b32 vcc_lo, 0x11111111
s_mov_b32 vcc_hi, 0x11111111
buffer_load_dwordx4 v237, s[16:19], s48 offen nt lds
s_add_u32 m0, s54, 50688
v_lshl_add_u32 v245, v49, 7, v245
v_mov_b32 v254, 150528
v_lshlrev_b32 v49, 4, v48
buffer_load_dwordx4 v50, s[28:31], s54 offen offset:0 lds
v_cndmask_b32 v240, v254, v240, vcc
v_xor_b32 v49, v49, v48
v_and_b32 v49, 48, v49
buffer_load_dwordx4 v51, s[28:31], s54 offen offset:1024 lds
s_mov_b32 vcc_lo, 0xf000f
s_mov_b32 vcc_hi, 0xf000f
v_add_u32 v245, v49, v245
buffer_load_dwordx4 v50, s[28:31], s54 offen offset:2048 lds
v_cndmask_b32 v242, v254, v245, vcc
s_mov_b32 vcc_lo, 0xf000f0
s_mov_b32 vcc_hi, 0xf000f0
buffer_load_dwordx4 v51, s[28:31], s54 offen offset:3072 lds
s_add_u32 m0, s57, 50688
v_cndmask_b32 v243, v254, v245, vcc
s_mov_b32 vcc_lo, 0xf000f00
s_mov_b32 vcc_hi, 0xf000f00
buffer_load_dwordx4 v50, s[28:31], s57 offen offset:0 lds
v_cndmask_b32 v244, v254, v245, vcc
s_mov_b32 vcc_lo, 0xf000f000
s_mov_b32 vcc_hi, 0xf000f000
v_mov_b32 v246, s52
buffer_load_dwordx4 v51, s[28:31], s57 offen offset:1024 lds
v_add_u32 v246, 4096, v246
v_bfe_u32 v49, v48, 0, 2
v_cndmask_b32 v245, v254, v245, vcc
buffer_load_dwordx4 v50, s[28:31], s57 offen offset:2048 lds
v_lshl_add_u32 v246, v49, 7, v246
v_mov_b32 v254, 154880
v_bfe_u32 v49, v48, 2, 2
buffer_load_dwordx4 v51, s[28:31], s57 offen offset:3072 lds
s_add_u32 m0, s49, 16896
s_mov_b32 vcc_lo, 0xf000f
s_mov_b32 vcc_hi, 0xf000f
v_lshl_add_u32 v254, v49, 3, v254
v_cndmask_b32 v246, v254, v246, vcc
v_xor_b32 v249, 32, v248
v_xor_b32 v250, 64, v248
v_xor_b32 v251, 96, v248
s_mul_i32 s4, s43, 13107200
s_add_u32 s4, s4, s44
s_add_u32 s4, s4, 24576
s_add_u32 s5, s55, 104857600
s_sub_u32 s5, s5, s4
s_add_u32 s48, s4, 0
v_xor_b32 v52, v53, v52
v_xor_b32 v55, 96, v54
v_xor_b32 v253, 64, v252
v_lshlrev_b32 v49, 4, v48
v_xor_b32 v49, v49, v48
v_and_b32 v49, 48, v49
v_add_u32 v246, v49, v246
v_add_u32 v246, v49, v246
v_mov_b32 v50, s52
v_bfe_u32 v49, v48, 0, 4
v_lshl_add_u32 v50, v49, 7, v50
v_lshlrev_b32 v49, 4, v48
v_xor_b32 v49, v49, v48
v_and_b32 v49, 48, v49
v_add_u32 v50, v49, v50
v_mov_b32 v51, s52
v_add_u32 v51, 8192, v51
v_bfe_u32 v49, v48, 4, 2
v_lshl_add_u32 v51, v49, 9, v51
v_bfe_u32 v49, v48, 0, 4
v_lshl_add_u32 v51, v49, 3, v51
s_add_u32 s50, s55, 13107200
s_mov_b32 s51, 2048
v_xor_b32 v247, 32, v48
s_mov_b32 s52, 0x7ff00000
v_lshlrev_b32 v247, 2, v247
s_waitcnt vmcnt(19)
v_and_b32 v254, 0xffff0000, v152
buffer_load_dwordx4 v237, s[16:19], s48 offen nt lds
s_add_u32 m0, s49, 19008
s_add_u32 s48, s4, 26214400
v_and_b32 v255, 0xffff0000, v153
v_lshlrev_b32 v152, 16, v152
v_lshlrev_b32 v153, 16, v153
v_mul_f32 v254, s40, v254
v_mul_f32 v152, s40, v152
v_mul_f32 v255, s40, v255
v_mul_f32 v153, s40, v153
v_cvt_pk_bf16_f32 v152, v152, v254
v_cvt_pk_bf16_f32 v153, v153, v255
v_and_b32 v254, 0xffff0000, v154
v_and_b32 v255, 0xffff0000, v155
v_lshlrev_b32 v154, 16, v154
v_lshlrev_b32 v155, 16, v155
v_mul_f32 v254, s40, v254
v_mul_f32 v154, s40, v154
v_mul_f32 v255, s40, v255
v_mul_f32 v155, s40, v155
v_cvt_pk_bf16_f32 v154, v154, v254
v_cvt_pk_bf16_f32 v155, v155, v255
s_waitcnt vmcnt(19)
v_and_b32 v254, 0xffff0000, v156
v_and_b32 v255, 0xffff0000, v157
v_lshlrev_b32 v156, 16, v156
v_lshlrev_b32 v157, 16, v157
v_mul_f32 v254, s40, v254
v_mul_f32 v156, s40, v156
v_mul_f32 v255, s40, v255
v_mul_f32 v157, s40, v157
v_cvt_pk_bf16_f32 v156, v156, v254
buffer_load_dwordx4 v237, s[16:19], s48 offen nt lds
s_add_u32 m0, s49, 21120
s_add_u32 s48, s4, 52428800
v_cvt_pk_bf16_f32 v157, v157, v255
v_and_b32 v254, 0xffff0000, v158
v_and_b32 v255, 0xffff0000, v159
v_lshlrev_b32 v158, 16, v158
v_lshlrev_b32 v159, 16, v159
v_mul_f32 v254, s40, v254
v_mul_f32 v158, s40, v158
v_mul_f32 v255, s40, v255
v_mul_f32 v159, s40, v159
v_cvt_pk_bf16_f32 v158, v158, v254
v_cvt_pk_bf16_f32 v159, v159, v255
s_waitcnt vmcnt(19)
v_and_b32 v254, 0xffff0000, v160
v_and_b32 v255, 0xffff0000, v161
v_lshlrev_b32 v160, 16, v160
v_lshlrev_b32 v161, 16, v161
v_mul_f32 v254, s40, v254
v_mul_f32 v160, s40, v160
v_mul_f32 v255, s40, v255
v_mul_f32 v161, s40, v161
v_cvt_pk_bf16_f32 v160, v160, v254
v_cvt_pk_bf16_f32 v161, v161, v255
v_and_b32 v254, 0xffff0000, v162
v_and_b32 v255, 0xffff0000, v163
v_lshlrev_b32 v162, 16, v162
v_lshlrev_b32 v163, 16, v163
v_mul_f32 v254, s40, v254
v_mul_f32 v162, s40, v162
v_mul_f32 v255, s40, v255
v_mul_f32 v163, s40, v163
v_cvt_pk_bf16_f32 v162, v162, v254
buffer_load_dwordx4 v237, s[16:19], s48 offen nt lds
s_add_u32 m0, s49, 23232
s_add_u32 s48, s4, 78643200
ds_write_b128 v104, v[152:155] offset:0
ds_write_b128 v105, v[156:159] offset:1024
v_cvt_pk_bf16_f32 v163, v163, v255
s_waitcnt vmcnt(19)
v_and_b32 v254, 0xffff0000, v164
v_and_b32 v255, 0xffff0000, v165
v_lshlrev_b32 v164, 16, v164
v_lshlrev_b32 v165, 16, v165
v_mul_f32 v254, s40, v254
v_mul_f32 v164, s40, v164
v_mul_f32 v255, s40, v255
v_mul_f32 v165, s40, v165
v_cvt_pk_bf16_f32 v164, v164, v254
v_cvt_pk_bf16_f32 v165, v165, v255
v_and_b32 v254, 0xffff0000, v166
v_and_b32 v255, 0xffff0000, v167
v_lshlrev_b32 v166, 16, v166
v_lshlrev_b32 v167, 16, v167
v_mul_f32 v254, s40, v254
buffer_load_dwordx4 v237, s[16:19], s48 offen nt lds
s_add_u32 m0, s54, 116224
s_add_u32 s48, s55, 8192
ds_write_b128 v104, v[160:163] offset:2048
v_mul_f32 v166, s40, v166
v_mul_f32 v255, s40, v255
v_mul_f32 v167, s40, v167
v_cvt_pk_bf16_f32 v166, v166, v254
v_cvt_pk_bf16_f32 v167, v167, v255
s_waitcnt vmcnt(19)
v_and_b32 v254, 0xffff0000, v168
v_and_b32 v255, 0xffff0000, v169
v_lshlrev_b32 v168, 16, v168
v_lshlrev_b32 v169, 16, v169
v_mul_f32 v254, s40, v254
v_mul_f32 v168, s40, v168
v_mul_f32 v255, s40, v255
v_mul_f32 v169, s40, v169
v_cvt_pk_bf16_f32 v168, v168, v254
v_cvt_pk_bf16_f32 v169, v169, v255
v_and_b32 v254, 0xffff0000, v170
v_and_b32 v255, 0xffff0000, v171
v_lshlrev_b32 v170, 16, v170
v_lshlrev_b32 v171, 16, v171
v_mul_f32 v254, s40, v254
v_mul_f32 v170, s40, v170
v_mul_f32 v255, s40, v255
v_mul_f32 v171, s40, v171
buffer_load_dwordx4 v52, s[32:35], s54 offen offset:0 lds
ds_write_b128 v105, v[164:167] offset:3072
v_cvt_pk_bf16_f32 v170, v170, v254
v_cvt_pk_bf16_f32 v171, v171, v255
s_waitcnt vmcnt(19)
v_and_b32 v254, 0xffff0000, v172
v_and_b32 v255, 0xffff0000, v173
v_lshlrev_b32 v172, 16, v172
v_lshlrev_b32 v173, 16, v173
v_mul_f32 v254, s40, v254
v_mul_f32 v172, s40, v172
v_mul_f32 v255, s40, v255
v_mul_f32 v173, s40, v173
v_cvt_pk_bf16_f32 v172, v172, v254
v_cvt_pk_bf16_f32 v173, v173, v255
v_and_b32 v254, 0xffff0000, v174
v_and_b32 v255, 0xffff0000, v175
v_lshlrev_b32 v174, 16, v174
v_lshlrev_b32 v175, 16, v175
v_mul_f32 v254, s40, v254
v_mul_f32 v174, s40, v174
v_mul_f32 v255, s40, v255
v_mul_f32 v175, s40, v175
v_cvt_pk_bf16_f32 v174, v174, v254
v_cvt_pk_bf16_f32 v175, v175, v255
s_waitcnt vmcnt(18)
v_and_b32 v254, 0xffff0000, v176
v_and_b32 v255, 0xffff0000, v177
v_lshlrev_b32 v176, 16, v176
buffer_load_dwordx4 v52, s[32:35], s54 offen offset:1024 lds
ds_write_b128 v104, v[168:171] offset:4096
v_lshlrev_b32 v177, 16, v177
v_mul_f32 v254, s40, v254
v_mul_f32 v176, s40, v176
v_mul_f32 v255, s40, v255
v_mul_f32 v177, s40, v177
v_cvt_pk_bf16_f32 v176, v176, v254
v_cvt_pk_bf16_f32 v177, v177, v255
v_and_b32 v254, 0xffff0000, v178
v_and_b32 v255, 0xffff0000, v179
v_lshlrev_b32 v178, 16, v178
v_lshlrev_b32 v179, 16, v179
v_mul_f32 v254, s40, v254
v_mul_f32 v178, s40, v178
v_mul_f32 v255, s40, v255
v_mul_f32 v179, s40, v179
v_cvt_pk_bf16_f32 v178, v178, v254
v_cvt_pk_bf16_f32 v179, v179, v255
s_waitcnt vmcnt(18)
v_and_b32 v254, 0xffff0000, v180
v_and_b32 v255, 0xffff0000, v181
v_lshlrev_b32 v180, 16, v180
v_lshlrev_b32 v181, 16, v181
v_mul_f32 v254, s40, v254
v_mul_f32 v180, s40, v180
v_mul_f32 v255, s40, v255
v_mul_f32 v181, s40, v181
buffer_load_dwordx4 v52, s[32:35], s54 offen offset:2048 lds
ds_write_b128 v105, v[172:175] offset:5120
ds_write_b128 v104, v[176:179] offset:6144
v_cvt_pk_bf16_f32 v180, v180, v254
v_cvt_pk_bf16_f32 v181, v181, v255
v_and_b32 v254, 0xffff0000, v182
v_and_b32 v255, 0xffff0000, v183
v_lshlrev_b32 v182, 16, v182
v_lshlrev_b32 v183, 16, v183
v_mul_f32 v254, s40, v254
v_mul_f32 v182, s40, v182
v_mul_f32 v255, s40, v255
v_mul_f32 v183, s40, v183
v_cvt_pk_bf16_f32 v182, v182, v254
v_cvt_pk_bf16_f32 v183, v183, v255
ds_write_b128 v105, v[180:183] offset:7168
buffer_load_dwordx4 v52, s[32:35], s54 offen offset:3072 lds
s_add_u32 m0, s57, 116224
v_xor_b32 v254, 32, v54
v_xor_b32 v255, 64, v54
s_mov_b32 s53, 0x7ff00000
buffer_load_dwordx4 v52, s[32:35], s57 offen offset:0 lds
buffer_load_dwordx4 v52, s[32:35], s57 offen offset:1024 lds
s_waitcnt vmcnt(10) lgkmcnt(0)
s_barrier
ds_read_b64_tr_b16 a[64:65], v248 offset:0
ds_read_b64_tr_b16 a[66:67], v248 offset:512
ds_read_b128 v[188:191], v236 offset:0
ds_read_b64_tr_b16 a[68:69], v248 offset:4096
ds_read_b64_tr_b16 a[70:71], v248 offset:4608
buffer_load_dwordx4 v52, s[32:35], s57 offen offset:2048 lds
ds_read_b128 v[196:199], v236 offset:256
ds_read_b64_tr_b16 a[72:73], v248 offset:8192
ds_read_b64_tr_b16 a[74:75], v248 offset:8704
ds_read_b128 v[200:203], v236 offset:512
ds_read_b64_tr_b16 a[76:77], v248 offset:12288
ds_read_b64_tr_b16 a[78:79], v248 offset:12800
ds_read_b128 v[204:207], v236 offset:768
ds_read_b64_tr_b16 a[92:93], v249 offset:12288
ds_read_b64_tr_b16 a[94:95], v249 offset:12800
ds_read_b64_tr_b16 a[88:89], v249 offset:8192
ds_read_b64_tr_b16 a[90:91], v249 offset:8704
ds_read_b64_tr_b16 a[84:85], v249 offset:4096
ds_read_b64_tr_b16 a[86:87], v249 offset:4608
ds_read_b64_tr_b16 a[80:81], v249 offset:0
ds_read_b64_tr_b16 a[82:83], v249 offset:512
s_waitcnt lgkmcnt(15)
v_mfma_f32_16x16x32_bf16 v[192:195], a[64:67], v[188:191], 0
ds_read_b64_tr_b16 a[96:97], v250 offset:0
ds_read_b64_tr_b16 a[98:99], v250 offset:512
s_waitcnt lgkmcnt(15)
v_mfma_f32_16x16x32_bf16 v[192:195], a[68:71], v[196:199], v[192:195]
s_waitcnt lgkmcnt(14)
ds_read_b64_tr_b16 a[100:101], v250 offset:4096
s_waitcnt lgkmcnt(14)
v_mfma_f32_16x16x32_bf16 v[192:195], a[72:75], v[200:203], v[192:195]
s_waitcnt lgkmcnt(11)
ds_read_b64_tr_b16 a[102:103], v250 offset:4608
ds_read_b64_tr_b16 a[104:105], v250 offset:8192
v_mfma_f32_16x16x32_bf16 v[192:195], a[76:79], v[204:207], v[192:195]
s_waitcnt lgkmcnt(9)
ds_read_b64_tr_b16 a[106:107], v250 offset:8704
ds_read_b64_tr_b16 a[108:109], v250 offset:12288
v_mfma_f32_16x16x32_bf16 v[208:211], a[92:95], v[204:207], 0
s_waitcnt lgkmcnt(7)
buffer_load_dwordx4 v52, s[32:35], s57 offen offset:3072 lds
s_add_u32 m0, s49, 8448
v_mfma_f32_16x16x32_bf16 v[208:211], a[88:91], v[200:203], v[208:211]
ds_read_b64_tr_b16 a[110:111], v250 offset:12800
v_cvt_pk_bf16_f32 v0, v192, v193
v_mfma_f32_16x16x32_bf16 v[208:211], a[84:87], v[196:199], v[208:211]
s_waitcnt lgkmcnt(6)
ds_read_b64_tr_b16 a[124:125], v251 offset:12288
v_cvt_pk_bf16_f32 v1, v194, v195
v_mfma_f32_16x16x32_bf16 v[208:211], a[80:83], v[188:191], v[208:211]
s_waitcnt lgkmcnt(6)
ds_read_b64_tr_b16 a[126:127], v251 offset:12800
ds_read_b64_tr_b16 a[120:121], v251 offset:8192
v_mfma_f32_16x16x32_bf16 v[192:195], a[96:99], v[188:191], 0
s_waitcnt lgkmcnt(6)
ds_read_b64_tr_b16 a[122:123], v251 offset:8704
ds_read_b64_tr_b16 a[116:117], v251 offset:4096
v_mfma_f32_16x16x32_bf16 v[192:195], a[100:103], v[196:199], v[192:195]
s_waitcnt lgkmcnt(6)
ds_read_b64_tr_b16 a[118:119], v251 offset:4608
v_cvt_pk_bf16_f32 v2, v208, v209
v_mfma_f32_16x16x32_bf16 v[192:195], a[104:107], v[200:203], v[192:195]
ds_read_b64_tr_b16 a[112:113], v251 offset:0
s_waitcnt lgkmcnt(7)
v_mfma_f32_16x16x32_bf16 v[192:195], a[108:111], v[204:207], v[192:195]
ds_read_b64_tr_b16 a[114:115], v251 offset:512
v_cvt_pk_bf16_f32 v3, v210, v211
ds_read_b128 v[184:187], v236 offset:4992
s_waitcnt lgkmcnt(7)
v_mfma_f32_16x16x32_bf16 v[208:211], a[124:127], v[204:207], 0
s_waitcnt lgkmcnt(6)
buffer_load_dwordx4 v[120:123], v53, s[36:39], s54 offen offset:0
s_waitcnt lgkmcnt(5)
v_mfma_f32_16x16x32_bf16 v[208:211], a[120:123], v[200:203], v[208:211]
s_waitcnt lgkmcnt(4)
ds_read_b128 v[216:219], v236 offset:4736
s_waitcnt lgkmcnt(4)
v_mfma_f32_16x16x32_bf16 v[208:211], a[116:119], v[196:199], v[208:211]
ds_read_b128 v[204:207], v236 offset:4480
v_cvt_pk_bf16_f32 v5, v194, v195
v_cvt_pk_bf16_f32 v4, v192, v193
s_waitcnt lgkmcnt(3)
v_mfma_f32_16x16x32_bf16 v[208:211], a[112:115], v[188:191], v[208:211]
ds_read_b128 v[192:195], v236 offset:4224
s_waitcnt lgkmcnt(3)
v_mfma_f32_16x16x32_bf16 v[200:203], a[124:127], v[184:187], 0
ds_read_b64_tr_b16 a[0:1], v248 offset:32768
ds_read_b64_tr_b16 a[2:3], v248 offset:33280
v_mfma_f32_16x16x32_bf16 v[220:223], a[92:95], v[184:187], 0
ds_read_b64_tr_b16 a[4:5], v248 offset:36864
s_waitcnt lgkmcnt(5)
v_mfma_f32_16x16x32_bf16 v[200:203], a[120:123], v[216:219], v[200:203]
ds_read_b64_tr_b16 a[6:7], v248 offset:37376
s_waitcnt lgkmcnt(5)
v_mfma_f32_16x16x32_bf16 v[200:203], a[116:119], v[204:207], v[200:203]
ds_read_b64_tr_b16 a[8:9], v248 offset:40960
v_cvt_pk_bf16_f32 v6, v208, v209
v_mfma_f32_16x16x32_bf16 v[220:223], a[88:91], v[216:219], v[220:223]
buffer_load_dwordx4 v[124:127], v53, s[36:39], s54 offen offset:1024
s_waitcnt lgkmcnt(5)
v_mfma_f32_16x16x32_bf16 v[200:203], a[112:115], v[192:195], v[200:203]
ds_read_b64_tr_b16 a[10:11], v248 offset:41472
v_cvt_pk_bf16_f32 v7, v210, v211
v_mfma_f32_16x16x32_bf16 v[208:211], a[96:99], v[192:195], 0
s_waitcnt lgkmcnt(4)
ds_read_b64_tr_b16 a[12:13], v248 offset:45056
ds_read_b64_tr_b16 a[14:15], v248 offset:45568
v_mfma_f32_16x16x32_bf16 v[208:211], a[100:103], v[204:207], v[208:211]
s_waitcnt lgkmcnt(5)
ds_read_b64_tr_b16 a[16:17], v249 offset:32768
ds_read_b64_tr_b16 a[18:19], v249 offset:33280
v_mfma_f32_16x16x32_bf16 v[208:211], a[104:107], v[216:219], v[208:211]
s_waitcnt lgkmcnt(6)
ds_read_b64_tr_b16 a[20:21], v249 offset:36864
ds_read_b64_tr_b16 a[22:23], v249 offset:37376
v_mfma_f32_16x16x32_bf16 v[208:211], a[108:111], v[184:187], v[208:211]
s_waitcnt lgkmcnt(7)
ds_read_b64_tr_b16 a[24:25], v249 offset:40960
ds_read_b64_tr_b16 a[26:27], v249 offset:41472
v_mfma_f32_16x16x32_bf16 v[220:223], a[84:87], v[204:207], v[220:223]
ds_read_b64_tr_b16 a[28:29], v249 offset:45056
ds_read_b64_tr_b16 a[30:31], v249 offset:45568
v_mfma_f32_16x16x32_bf16 v[220:223], a[80:83], v[192:195], v[220:223]
s_waitcnt lgkmcnt(10)
ds_read_b64_tr_b16 a[32:33], v250 offset:32768
ds_read_b64_tr_b16 a[34:35], v250 offset:33280
v_mfma_f32_16x16x32_bf16 v[188:191], a[64:67], v[192:195], 0
s_waitcnt lgkmcnt(10)
ds_read_b64_tr_b16 a[36:37], v250 offset:36864
ds_read_b64_tr_b16 a[38:39], v250 offset:37376
v_mfma_f32_16x16x32_bf16 v[188:191], a[72:75], v[216:219], v[188:191]
s_waitcnt lgkmcnt(10)
buffer_load_dwordx4 v[128:131], v53, s[36:39], s54 offen offset:2048
ds_read_b64_tr_b16 a[40:41], v250 offset:40960
v_mfma_f32_16x16x32_bf16 v[188:191], a[76:79], v[184:187], v[188:191]
s_waitcnt lgkmcnt(9)
ds_read_b64_tr_b16 a[42:43], v250 offset:41472
ds_read_b64_tr_b16 a[44:45], v250 offset:45056
v_mfma_f32_16x16x32_bf16 v[188:191], a[68:71], v[204:207], v[188:191]
s_waitcnt lgkmcnt(9)
ds_read_b64_tr_b16 a[46:47], v250 offset:45568
ds_read_b64_tr_b16 a[48:49], v251 offset:32768
ds_read_b64_tr_b16 a[50:51], v251 offset:33280
ds_read_b64_tr_b16 a[52:53], v251 offset:36864
ds_read_b64_tr_b16 a[54:55], v251 offset:37376
ds_read_b64_tr_b16 a[56:57], v251 offset:40960
ds_read_b64_tr_b16 a[58:59], v251 offset:41472
s_waitcnt vmcnt(11)
s_barrier
ds_read_b128 v[56:59], v236 offset:16896
ds_read_b128 v[60:63], v236 offset:17152
ds_read_b128 v[64:67], v236 offset:17408
ds_read_b128 v[68:71], v236 offset:17664
ds_read_b128 v[72:75], v236 offset:21120
ds_read_b128 v[76:79], v236 offset:21376
ds_read_b128 v[80:83], v236 offset:21632
ds_read_b128 v[84:87], v236 offset:21888
ds_read_b64_tr_b16 a[60:61], v251 offset:45056
ds_read_b64_tr_b16 a[62:63], v251 offset:45568
v_cvt_pk_bf16_f32 v14, v200, v201
buffer_load_dwordx4 v[132:135], v53, s[36:39], s54 offen offset:3072
v_cvt_pk_bf16_f32 v15, v202, v203
v_cvt_pk_bf16_f32 v9, v190, v191
v_cvt_pk_bf16_f32 v8, v188, v189
v_cvt_pk_bf16_f32 v13, v210, v211
v_cvt_pk_bf16_f32 v12, v208, v209
v_cvt_pk_bf16_f32 v10, v220, v221
v_cvt_pk_bf16_f32 v11, v222, v223
s_waitcnt lgkmcnt(9)
v_mfma_f32_16x16x32_bf16 v[156:159], a[64:67], v[56:59], 0
s_waitcnt lgkmcnt(7)
v_mfma_f32_16x16x32_bf16 v[156:159], a[68:71], v[60:63], v[156:159]
s_waitcnt lgkmcnt(3)
v_mfma_f32_16x16x32_bf16 v[156:159], a[72:75], v[64:67], v[156:159]
s_waitcnt lgkmcnt(0)
v_mfma_f32_16x16x32_bf16 v[156:159], a[76:79], v[68:71], v[156:159]
s_nop 2
v_mfma_f32_16x16x32_bf16 v[160:163], a[92:95], v[68:71], 0
s_nop 2
v_mfma_f32_16x16x32_bf16 v[160:163], a[88:91], v[64:67], v[160:163]
s_waitcnt vmcnt(4)
s_barrier
v_mfma_f32_16x16x32_bf16 v[160:163], a[84:87], v[60:63], v[160:163]
buffer_load_dwordx4 v[136:139], v53, s[36:39], s57 offen offset:0
ds_read_b64_tr_b16 a[128:129], v252 offset:0
v_mfma_f32_16x16x32_bf16 v[160:163], a[80:83], v[56:59], v[160:163]
ds_read_b64_tr_b16 a[130:131], v252 offset:512
ds_read_b64_tr_b16 a[132:133], v252 offset:4096
v_mfma_f32_16x16x32_bf16 v[164:167], a[96:99], v[56:59], 0
ds_read_b64_tr_b16 a[134:135], v252 offset:4608
ds_read_b64_tr_b16 a[136:137], v252 offset:8192
v_mfma_f32_16x16x32_bf16 v[164:167], a[100:103], v[60:63], v[164:167]
ds_read_b64_tr_b16 a[138:139], v252 offset:8704
ds_read_b64_tr_b16 a[140:141], v252 offset:12288
v_mfma_f32_16x16x32_bf16 v[164:167], a[104:107], v[64:67], v[164:167]
ds_read_b64_tr_b16 a[142:143], v252 offset:12800
ds_read_b64_tr_b16 a[144:145], v252 offset:8
v_mfma_f32_16x16x32_bf16 v[164:167], a[108:111], v[68:71], v[164:167]
ds_read_b64_tr_b16 a[146:147], v252 offset:520
ds_read_b64_tr_b16 a[148:149], v252 offset:4104
v_mfma_f32_16x16x32_bf16 v[168:171], a[124:127], v[68:71], 0
s_waitcnt lgkmcnt(10)
ds_read_b64_tr_b16 a[150:151], v252 offset:4616
v_cvt_pk_bf16_f32 v88, v156, v157
v_mfma_f32_16x16x32_bf16 v[168:171], a[120:123], v[64:67], v[168:171]
s_waitcnt lgkmcnt(9)
ds_read_b64_tr_b16 a[152:153], v252 offset:8200
v_cvt_pk_bf16_f32 v89, v158, v159
v_mfma_f32_16x16x32_bf16 v[168:171], a[116:119], v[60:63], v[168:171]
s_waitcnt lgkmcnt(8)
ds_read_b64_tr_b16 a[154:155], v252 offset:8712
ds_read_b64_tr_b16 a[156:157], v252 offset:12296
v_mfma_f32_16x16x32_bf16 v[168:171], a[112:115], v[56:59], v[168:171]
s_waitcnt lgkmcnt(8)
buffer_load_dwordx4 v[140:143], v53, s[36:39], s57 offen offset:1024
ds_read_b64_tr_b16 a[158:159], v252 offset:12808
v_mfma_f32_16x16x32_bf16 v[172:175], a[64:67], v[72:75], 0
s_waitcnt lgkmcnt(7)
ds_read_b64_tr_b16 a[160:161], v253 offset:0
v_cvt_pk_bf16_f32 v90, v160, v161
v_mfma_f32_16x16x32_bf16 v[172:175], a[68:71], v[76:79], v[172:175]
s_waitcnt lgkmcnt(6)
ds_read_b64_tr_b16 a[162:163], v253 offset:512
v_cvt_pk_bf16_f32 v91, v162, v163
v_mfma_f32_16x16x32_bf16 v[172:175], a[72:75], v[80:83], v[172:175]
s_waitcnt lgkmcnt(6)
ds_read_b64_tr_b16 a[164:165], v253 offset:4096
ds_read_b64_tr_b16 a[166:167], v253 offset:4608
v_mfma_f32_16x16x32_bf16 v[172:175], a[76:79], v[84:87], v[172:175]
s_waitcnt lgkmcnt(7)
ds_read_b64_tr_b16 a[168:169], v253 offset:8192
ds_read_b64_tr_b16 a[170:171], v253 offset:8704
v_mfma_f32_16x16x32_bf16 v[176:179], a[92:95], v[84:87], 0
s_waitcnt lgkmcnt(7)
ds_read_b64_tr_b16 a[172:173], v253 offset:12288
v_cvt_pk_bf16_f32 v92, v164, v165
v_mfma_f32_16x16x32_bf16 v[176:179], a[88:91], v[80:83], v[176:179]
s_waitcnt lgkmcnt(7)
ds_read_b64_tr_b16 a[174:175], v253 offset:12800
v_cvt_pk_bf16_f32 v93, v166, v167
v_mfma_f32_16x16x32_bf16 v[176:179], a[84:87], v[76:79], v[176:179]
s_waitcnt lgkmcnt(7)
ds_read_b64_tr_b16 a[176:177], v253 offset:8
ds_read_b64_tr_b16 a[178:179], v253 offset:520
v_mfma_f32_16x16x32_bf16 v[176:179], a[80:83], v[72:75], v[176:179]
s_waitcnt lgkmcnt(8)
ds_read_b64_tr_b16 a[180:181], v253 offset:4104
ds_read_b64_tr_b16 a[182:183], v253 offset:4616
v_mfma_f32_16x16x32_bf16 v[180:183], a[96:99], v[72:75], 0
s_waitcnt lgkmcnt(8)
buffer_load_dwordx4 v[144:147], v53, s[36:39], s57 offen offset:2048
v_cvt_pk_bf16_f32 v94, v168, v169
v_mfma_f32_16x16x32_bf16 v[180:183], a[100:103], v[76:79], v[180:183]
s_waitcnt lgkmcnt(6)
ds_read_b64_tr_b16 a[184:185], v253 offset:8200
v_cvt_pk_bf16_f32 v95, v170, v171
v_mfma_f32_16x16x32_bf16 v[180:183], a[104:107], v[80:83], v[180:183]
s_waitcnt lgkmcnt(6)
ds_read_b64_tr_b16 a[186:187], v253 offset:8712
ds_read_b64_tr_b16 a[188:189], v253 offset:12296
v_mfma_f32_16x16x32_bf16 v[180:183], a[108:111], v[84:87], v[180:183]
s_waitcnt lgkmcnt(7)
ds_read_b64_tr_b16 a[190:191], v253 offset:12808
v_cvt_pk_bf16_f32 v96, v172, v173
v_mfma_f32_16x16x32_bf16 v[152:155], a[124:127], v[84:87], 0
s_waitcnt lgkmcnt(6)
v_cvt_pk_bf16_f32 v97, v174, v175
v_cvt_pk_bf16_f32 v98, v176, v177
v_mfma_f32_16x16x32_bf16 v[152:155], a[120:123], v[80:83], v[152:155]
s_waitcnt lgkmcnt(4)
v_cvt_pk_bf16_f32 v99, v178, v179
v_cvt_pk_bf16_f32 v100, v180, v181
v_mfma_f32_16x16x32_bf16 v[152:155], a[116:119], v[76:79], v[152:155]
v_cvt_pk_bf16_f32 v101, v182, v183
v_mov_b32 v253, 0
v_mfma_f32_16x16x32_bf16 v[152:155], a[112:115], v[72:75], v[152:155]
s_waitcnt lgkmcnt(3)
v_mov_b32 v252, 1.0
s_nop 0
v_mfma_f32_16x16x32_bf16 v[156:159], a[0:3], v[56:59], 0
s_waitcnt lgkmcnt(1)
s_nop 1
v_mfma_f32_16x16x32_bf16 v[156:159], a[4:7], v[60:63], v[156:159]
s_waitcnt lgkmcnt(0)
buffer_load_dwordx4 v[148:151], v53, s[36:39], s57 offen offset:3072
v_cvt_pk_bf16_f32 v102, v152, v153
v_mfma_f32_16x16x32_bf16 v[156:159], a[8:11], v[64:67], v[156:159]
v_cvt_pk_bf16_f32 v103, v154, v155
v_mfma_f32_16x16x32_bf16 v[156:159], a[12:15], v[68:71], v[156:159]
s_nop 2
v_mfma_f32_16x16x32_bf16 v[160:163], a[28:31], v[68:71], 0
s_nop 2
v_mfma_f32_16x16x32_bf16 v[160:163], a[24:27], v[64:67], v[160:163]
v_cvt_pk_bf16_f32 v104, v156, v157
v_cvt_pk_bf16_f32 v105, v158, v159
v_mfma_f32_16x16x32_bf16 v[160:163], a[20:23], v[60:63], v[160:163]
v_mfma_f32_16x16x32_bf16 v[160:163], a[16:19], v[56:59], v[160:163]
s_nop 2
v_mfma_f32_16x16x32_bf16 v[164:167], a[32:35], v[56:59], 0
s_nop 2
v_mfma_f32_16x16x32_bf16 v[164:167], a[36:39], v[60:63], v[164:167]
v_cvt_pk_bf16_f32 v106, v160, v161
v_cvt_pk_bf16_f32 v107, v162, v163
v_mfma_f32_16x16x32_bf16 v[164:167], a[40:43], v[64:67], v[164:167]
buffer_load_dwordx4 v237, s[16:19], s48 offen nt lds
s_add_u32 m0, s49, 10560
v_mfma_f32_16x16x32_bf16 v[164:167], a[44:47], v[68:71], v[164:167]
s_add_u32 s48, s55, 10240
s_nop 1
v_mfma_f32_16x16x32_bf16 v[168:171], a[60:63], v[68:71], 0
s_nop 2
v_mfma_f32_16x16x32_bf16 v[168:171], a[56:59], v[64:67], v[168:171]
v_cvt_pk_bf16_f32 v108, v164, v165
v_cvt_pk_bf16_f32 v109, v166, v167
v_mfma_f32_16x16x32_bf16 v[168:171], a[52:55], v[60:63], v[168:171]
v_mfma_f32_16x16x32_bf16 v[168:171], a[48:51], v[56:59], v[168:171]
s_nop 2
v_mfma_f32_16x16x32_bf16 v[172:175], a[0:3], v[72:75], 0
s_waitcnt vmcnt(8)
ds_write_b64 v54, v[120:121] offset:0
v_mfma_f32_16x16x32_bf16 v[172:175], a[4:7], v[76:79], v[172:175]
ds_write_b64 v254, v[122:123] offset:0
v_mfma_f32_16x16x32_bf16 v[172:175], a[8:11], v[80:83], v[172:175]
buffer_load_dwordx4 v237, s[16:19], s48 offen nt lds
v_mfma_f32_16x16x32_bf16 v[172:175], a[12:15], v[84:87], v[172:175]
s_add_u32 m0, s49, 12672
s_add_u32 s48, s55, 12288
v_cvt_pk_bf16_f32 v110, v168, v169
v_mfma_f32_16x16x32_bf16 v[176:179], a[28:31], v[84:87], 0
s_waitcnt vmcnt(8)
ds_write_b64 v54, v[124:125] offset:512
v_mfma_f32_16x16x32_bf16 v[176:179], a[24:27], v[80:83], v[176:179]
ds_write_b64 v254, v[126:127] offset:512
v_mfma_f32_16x16x32_bf16 v[176:179], a[20:23], v[76:79], v[176:179]
s_waitcnt vmcnt(7)
ds_write_b64 v255, v[128:129] offset:1024
v_mfma_f32_16x16x32_bf16 v[176:179], a[16:19], v[72:75], v[176:179]
ds_write_b64 v55, v[130:131] offset:1024
v_mfma_f32_16x16x32_bf16 v[180:183], a[32:35], v[72:75], 0
s_waitcnt vmcnt(6)
ds_write_b64 v255, v[132:133] offset:1536
v_mfma_f32_16x16x32_bf16 v[180:183], a[36:39], v[76:79], v[180:183]
ds_write_b64 v55, v[134:135] offset:1536
v_mfma_f32_16x16x32_bf16 v[180:183], a[40:43], v[80:83], v[180:183]
buffer_load_dwordx4 v237, s[16:19], s48 offen nt lds
s_add_u32 m0, s49, 14784
v_mfma_f32_16x16x32_bf16 v[180:183], a[44:47], v[84:87], v[180:183]
s_add_u32 s48, s55, 14336
v_cvt_pk_bf16_f32 v111, v170, v171
v_cvt_pk_bf16_f32 v112, v172, v173
v_mfma_f32_16x16x32_bf16 v[152:155], a[60:63], v[84:87], 0
s_waitcnt vmcnt(6)
ds_write_b64 v54, v[136:137] offset:2048
v_mfma_f32_16x16x32_bf16 v[152:155], a[56:59], v[80:83], v[152:155]
ds_write_b64 v254, v[138:139] offset:2048
v_mfma_f32_16x16x32_bf16 v[152:155], a[52:55], v[76:79], v[152:155]
s_waitcnt vmcnt(5)
ds_write_b64 v54, v[140:141] offset:2560
v_mfma_f32_16x16x32_bf16 v[152:155], a[48:51], v[72:75], v[152:155]
ds_write_b64 v254, v[142:143] offset:2560
v_mfma_f32_16x16x32_bf16 v[156:159], v[56:59], a[128:131], 0
s_waitcnt vmcnt(4)
ds_write_b64 v255, v[144:145] offset:3072
v_mfma_f32_16x16x32_bf16 v[156:159], v[60:63], a[132:135], v[156:159]
ds_write_b64 v55, v[146:147] offset:3072
v_mfma_f32_16x16x32_bf16 v[156:159], v[64:67], a[136:139], v[156:159]
buffer_load_dwordx4 v237, s[16:19], s48 offen nt lds
s_add_u32 m0, s49, 16896
v_mfma_f32_16x16x32_bf16 v[156:159], v[68:71], a[140:143], v[156:159]
s_add_u32 s48, s55, 16384
buffer_load_dwordx4 v237, s[16:19], s48 offen nt lds
s_add_u32 m0, s49, 19008
v_mfma_f32_16x16x32_bf16 v[160:163], v[68:71], a[156:159], 0
s_add_u32 s48, s55, 18432
buffer_load_dwordx4 v237, s[16:19], s48 offen nt lds
s_add_u32 m0, s49, 21120
v_mfma_f32_16x16x32_bf16 v[160:163], v[64:67], a[152:155], v[160:163]
s_add_u32 s48, s55, 20480
buffer_load_dwordx4 v237, s[16:19], s48 offen nt lds
s_add_u32 m0, s49, 23232
v_mfma_f32_16x16x32_bf16 v[160:163], v[60:63], a[148:151], v[160:163]
s_add_u32 s48, s55, 22528
buffer_load_dwordx4 v237, s[16:19], s48 offen nt lds
v_cvt_pk_bf16_f32 v113, v174, v175
v_mfma_f32_16x16x32_bf16 v[160:163], v[56:59], a[144:147], v[160:163]
s_add_u32 s49, s49, 50688
v_cvt_pk_bf16_f32 v114, v176, v177
v_cvt_pk_bf16_f32 v115, v178, v179
v_mfma_f32_16x16x32_bf16 v[164:167], v[56:59], a[160:163], 0
s_waitcnt vmcnt(8)
ds_write_b64 v255, v[148:149] offset:3584
v_mfma_f32_16x16x32_bf16 v[164:167], v[60:63], a[164:167], v[164:167]
ds_write_b64 v55, v[150:151] offset:3584
v_mfma_f32_16x16x32_bf16 v[164:167], v[64:67], a[168:171], v[164:167]
v_cvt_pk_bf16_f32 v116, v180, v181
v_cvt_pk_bf16_f32 v117, v182, v183
v_mfma_f32_16x16x32_bf16 v[164:167], v[68:71], a[172:175], v[164:167]
v_cvt_pk_bf16_f32 v118, v152, v153
v_cvt_pk_bf16_f32 v119, v154, v155
v_mfma_f32_16x16x32_bf16 v[168:171], v[68:71], a[188:191], 0
v_cvt_pk_bf16_f32 v156, v156, v157
v_cvt_pk_bf16_f32 v157, v158, v159
v_mfma_f32_16x16x32_bf16 v[168:171], v[64:67], a[184:187], v[168:171]
v_cvt_pk_bf16_f32 v160, v160, v161
v_cvt_pk_bf16_f32 v161, v162, v163
v_mfma_f32_16x16x32_bf16 v[168:171], v[60:63], a[180:183], v[168:171]
s_waitcnt lgkmcnt(0)
s_barrier
v_mfma_f32_16x16x32_bf16 v[168:171], v[56:59], a[176:179], v[168:171]
ds_read_b64_tr_b16 a[192:193], v248 offset:0
ds_read_b64_tr_b16 a[194:195], v248 offset:512
v_mfma_f32_16x16x32_bf16 v[172:175], v[72:75], a[128:131], 0
ds_read_b64_tr_b16 a[196:197], v248 offset:4096
ds_read_b64_tr_b16 a[198:199], v248 offset:4608
v_mfma_f32_16x16x32_bf16 v[172:175], v[76:79], a[132:135], v[172:175]
ds_read_b64_tr_b16 a[200:201], v248 offset:8192
ds_read_b64_tr_b16 a[202:203], v248 offset:8704
v_mfma_f32_16x16x32_bf16 v[172:175], v[80:83], a[136:139], v[172:175]
ds_read_b64_tr_b16 a[204:205], v248 offset:12288
ds_read_b64_tr_b16 a[206:207], v248 offset:12800
v_mfma_f32_16x16x32_bf16 v[172:175], v[84:87], a[140:143], v[172:175]
ds_read_b64_tr_b16 a[208:209], v249 offset:0
ds_read_b64_tr_b16 a[210:211], v249 offset:512
v_mfma_f32_16x16x32_bf16 v[176:179], v[84:87], a[156:159], 0
ds_read_b64_tr_b16 a[212:213], v249 offset:4096
ds_read_b64_tr_b16 a[214:215], v249 offset:4608
v_mfma_f32_16x16x32_bf16 v[176:179], v[80:83], a[152:155], v[176:179]
s_waitcnt lgkmcnt(10)
ds_read_b64_tr_b16 a[216:217], v249 offset:8192
ds_read_b64_tr_b16 a[218:219], v249 offset:8704
v_mfma_f32_16x16x32_bf16 v[176:179], v[76:79], a[148:151], v[176:179]
s_waitcnt lgkmcnt(10)
ds_read_b64_tr_b16 a[220:221], v249 offset:12288
ds_read_b64_tr_b16 a[222:223], v249 offset:12800
v_mfma_f32_16x16x32_bf16 v[176:179], v[72:75], a[144:147], v[176:179]
s_waitcnt lgkmcnt(10)
ds_read_b64_tr_b16 a[224:225], v250 offset:0
ds_read_b64_tr_b16 a[226:227], v250 offset:512
v_mfma_f32_16x16x32_bf16 v[180:183], v[72:75], a[160:163], 0
s_waitcnt lgkmcnt(10)
ds_read_b64_tr_b16 a[228:229], v250 offset:4096
ds_read_b64_tr_b16 a[230:231], v250 offset:4608
v_mfma_f32_16x16x32_bf16 v[180:183], v[76:79], a[164:167], v[180:183]
s_waitcnt lgkmcnt(10)
ds_read_b64_tr_b16 a[232:233], v250 offset:8192
ds_read_b64_tr_b16 a[234:235], v250 offset:8704
v_mfma_f32_16x16x32_bf16 v[180:183], v[80:83], a[168:171], v[180:183]
s_waitcnt lgkmcnt(10)
ds_read_b64_tr_b16 a[236:237], v250 offset:12288
ds_read_b64_tr_b16 a[238:239], v250 offset:12800
v_mfma_f32_16x16x32_bf16 v[180:183], v[84:87], a[172:175], v[180:183]
s_waitcnt lgkmcnt(10)
ds_read_b64_tr_b16 a[240:241], v251 offset:0
ds_read_b64_tr_b16 a[242:243], v251 offset:512
v_mfma_f32_16x16x32_bf16 v[152:155], v[84:87], a[188:191], 0
s_waitcnt lgkmcnt(10)
ds_read_b64_tr_b16 a[244:245], v251 offset:4096
ds_read_b64_tr_b16 a[246:247], v251 offset:4608
v_mfma_f32_16x16x32_bf16 v[152:155], v[80:83], a[184:187], v[152:155]
s_waitcnt lgkmcnt(10)
ds_read_b64_tr_b16 a[248:249], v251 offset:8192
ds_read_b64_tr_b16 a[250:251], v251 offset:8704
v_mfma_f32_16x16x32_bf16 v[152:155], v[76:79], a[180:183], v[152:155]
s_waitcnt lgkmcnt(10)
ds_read_b64_tr_b16 a[252:253], v251 offset:12288
ds_read_b64_tr_b16 a[254:255], v251 offset:12800
v_mfma_f32_16x16x32_bf16 v[152:155], v[72:75], a[176:179], v[152:155]
s_waitcnt lgkmcnt(10)
ds_write_b128 v50, v[88:91] offset:0
ds_write_b128 v50, v[104:107] offset:4096
ds_write_b64 v51, v[156:157] offset:0
ds_write_b128 v50, v[92:95] offset:64
ds_write_b128 v50, v[108:111] offset:4160
ds_write_b64 v51, v[160:161] offset:128
v_cvt_pk_bf16_f32 v164, v164, v165
v_cvt_pk_bf16_f32 v165, v166, v167
v_cvt_pk_bf16_f32 v168, v168, v169
v_cvt_pk_bf16_f32 v169, v170, v171
v_cvt_pk_bf16_f32 v172, v172, v173
v_cvt_pk_bf16_f32 v173, v174, v175
v_cvt_pk_bf16_f32 v176, v176, v177
v_cvt_pk_bf16_f32 v177, v178, v179
v_cvt_pk_bf16_f32 v180, v180, v181
v_cvt_pk_bf16_f32 v181, v182, v183
v_cvt_pk_bf16_f32 v152, v152, v153
v_cvt_pk_bf16_f32 v153, v154, v155
v_mov_b32 v105, 0
v_mov_b32 v107, 0
v_mov_b32 v109, 0
v_mov_b32 v111, 0
v_mov_b32 v133, 0
v_mov_b32 v134, 0
v_mov_b32 v135, 0
v_mov_b32 v149, 0
v_mov_b32 v150, 0
v_mov_b32 v151, 0
v_mov_b32 v248, 1.0
v_mov_b32 v249, 1.0
v_mov_b32 v251, 1.0
ds_write_b64 v51, v[164:165] offset:256
ds_write_b64 v51, v[168:169] offset:384
ds_write_b128 v50, v[96:99] offset:2048
ds_write_b128 v50, v[112:115] offset:6144
ds_write_b64 v51, v[172:173] offset:2048
ds_write_b64 v51, v[176:177] offset:2176
s_waitcnt vmcnt(4)
s_barrier
ds_read_b128 v[200:203], v236 offset:8704
ds_read_b128 v[212:215], v236 offset:8448
ds_read_b128 v[224:227], v236 offset:8960
ds_read_b128 v[228:231], v236 offset:9216
ds_read_b128 v[192:195], v236 offset:13440
ds_read_b128 v[204:207], v236 offset:12928
ds_read_b128 v[208:211], v236 offset:12672
ds_write_b128 v50, v[100:103] offset:2112
ds_write_b128 v50, v[116:119] offset:6208
s_waitcnt lgkmcnt(8)
v_mfma_f32_16x16x32_bf16 v[184:187], a[68:71], v[200:203], 0
s_waitcnt lgkmcnt(6)
ds_write_b64 v51, v[180:181] offset:2304
v_mfma_f32_16x16x32_bf16 v[184:187], a[64:67], v[212:215], v[184:187]
s_waitcnt lgkmcnt(2)
ds_write_b64 v51, v[152:153] offset:2432
v_mfma_f32_16x16x32_bf16 v[184:187], a[72:75], v[224:227], v[184:187]
v_mfma_f32_16x16x32_bf16 v[184:187], a[76:79], v[228:231], v[184:187]
s_nop 2
v_mfma_f32_16x16x32_bf16 v[188:191], a[92:95], v[228:231], 0
s_nop 2
v_mfma_f32_16x16x32_bf16 v[188:191], a[88:91], v[224:227], v[188:191]
v_cvt_pk_bf16_f32 v16, v184, v185
v_cvt_pk_bf16_f32 v17, v186, v187
v_mfma_f32_16x16x32_bf16 v[188:191], a[84:87], v[200:203], v[188:191]
ds_read_b128 v[184:187], v236 offset:13184
v_mfma_f32_16x16x32_bf16 v[188:191], a[80:83], v[212:215], v[188:191]
s_nop 2
v_mfma_f32_16x16x32_bf16 v[196:199], a[96:99], v[212:215], 0
s_nop 2
v_mfma_f32_16x16x32_bf16 v[196:199], a[100:103], v[200:203], v[196:199]
v_cvt_pk_bf16_f32 v18, v188, v189
v_cvt_pk_bf16_f32 v19, v190, v191
v_mfma_f32_16x16x32_bf16 v[196:199], a[104:107], v[224:227], v[196:199]
v_mfma_f32_16x16x32_bf16 v[196:199], a[108:111], v[228:231], v[196:199]
s_nop 2
v_mfma_f32_16x16x32_bf16 v[188:191], a[124:127], v[228:231], 0
s_waitcnt lgkmcnt(0)
s_nop 1
v_mfma_f32_16x16x32_bf16 v[188:191], a[116:119], v[200:203], v[188:191]
v_cvt_pk_bf16_f32 v21, v198, v199
v_cvt_pk_bf16_f32 v20, v196, v197
v_mfma_f32_16x16x32_bf16 v[188:191], a[112:115], v[212:215], v[188:191]
v_mfma_f32_16x16x32_bf16 v[188:191], a[120:123], v[224:227], v[188:191]
s_nop 2
v_mfma_f32_16x16x32_bf16 v[196:199], a[120:123], v[184:187], 0
s_nop 2
v_mfma_f32_16x16x32_bf16 v[196:199], a[124:127], v[192:195], v[196:199]
v_cvt_pk_bf16_f32 v23, v190, v191
v_cvt_pk_bf16_f32 v22, v188, v189
v_mfma_f32_16x16x32_bf16 v[196:199], a[116:119], v[204:207], v[196:199]
v_mfma_f32_16x16x32_bf16 v[196:199], a[112:115], v[208:211], v[196:199]
s_nop 2
v_mfma_f32_16x16x32_bf16 v[188:191], a[96:99], v[208:211], 0
s_nop 2
v_mfma_f32_16x16x32_bf16 v[188:191], a[100:103], v[204:207], v[188:191]
v_cvt_pk_bf16_f32 v30, v196, v197
v_cvt_pk_bf16_f32 v31, v198, v199
v_mfma_f32_16x16x32_bf16 v[188:191], a[104:107], v[184:187], v[188:191]
v_mfma_f32_16x16x32_bf16 v[188:191], a[108:111], v[192:195], v[188:191]
s_nop 2
v_mfma_f32_16x16x32_bf16 v[212:215], a[92:95], v[192:195], 0
s_nop 2
v_mfma_f32_16x16x32_bf16 v[212:215], a[88:91], v[184:187], v[212:215]
v_cvt_pk_bf16_f32 v29, v190, v191
v_cvt_pk_bf16_f32 v28, v188, v189
v_mfma_f32_16x16x32_bf16 v[212:215], a[84:87], v[204:207], v[212:215]
v_mfma_f32_16x16x32_bf16 v[212:215], a[80:83], v[208:211], v[212:215]
s_nop 2
v_mfma_f32_16x16x32_bf16 v[188:191], a[64:67], v[208:211], 0
s_nop 2
v_mfma_f32_16x16x32_bf16 v[188:191], a[72:75], v[184:187], v[188:191]
v_cvt_pk_bf16_f32 v27, v214, v215
v_cvt_pk_bf16_f32 v26, v212, v213
v_mfma_f32_16x16x32_bf16 v[188:191], a[76:79], v[192:195], v[188:191]
s_waitcnt vmcnt(0)
s_barrier
v_mfma_f32_16x16x32_bf16 v[188:191], a[68:71], v[204:207], v[188:191]
s_mov_b32 s48, s50
ds_read_b128 v[196:199], v236 offset:17152
ds_read_b128 v[200:203], v236 offset:16896
ds_read_b128 v[216:219], v236 offset:17408
ds_read_b128 v[220:223], v236 offset:17664
ds_read_u16 v108, v241 offset:256
ds_read_b128 v[204:207], v236 offset:21376
ds_read_b128 v[208:211], v236 offset:21120
ds_read_b128 v[52:55], v240 offset:64
v_cvt_pk_bf16_f32 v24, v188, v189
v_cvt_pk_bf16_f32 v25, v190, v191
s_add_u32 m0, s49, 0
s_add_u32 s50, s50, 13107200
buffer_load_dwordx4 v237, s[16:19], s48 offen nt lds
ds_read_b128 v[192:195], v236 offset:21888
ds_read_b128 v[48:51], v240 offset:0
ds_read_u16 v110, v241 offset:384
v_add_u32 v240, 0x200, v240
s_add_u32 s48, s48, s51
s_add_u32 m0, s49, 2112
ds_read_u16 v106, v241 offset:128
buffer_load_dwordx4 v237, s[16:19], s48 offen nt lds
s_waitcnt lgkmcnt(11)
v_mfma_f32_16x16x32_bf16 v[184:187], a[68:71], v[196:199], 0
s_waitcnt lgkmcnt(9)
ds_read_u16 v104, v241 offset:0
s_add_u32 m0, s49, 4224
v_mfma_f32_16x16x32_bf16 v[184:187], a[64:67], v[200:203], v[184:187]
s_waitcnt lgkmcnt(6)
s_add_u32 s48, s48, s51
buffer_load_dwordx4 v237, s[16:19], s48 offen nt lds
v_mfma_f32_16x16x32_bf16 v[184:187], a[72:75], v[216:219], v[184:187]
s_add_u32 m0, s49, 6336
s_add_u32 s48, s48, s51
buffer_load_dwordx4 v237, s[16:19], s48 offen nt lds
v_mfma_f32_16x16x32_bf16 v[184:187], a[76:79], v[220:223], v[184:187]
s_add_u32 m0, s49, 8448
s_add_u32 s48, s48, s51
buffer_load_dwordx4 v237, s[16:19], s48 offen nt lds
v_mfma_f32_16x16x32_bf16 v[188:191], a[92:95], v[220:223], 0
s_add_u32 m0, s49, 10560
s_mov_b32 s47, s46
s_add_u32 s48, s48, s51
v_mfma_f32_16x16x32_bf16 v[188:191], a[88:91], v[216:219], v[188:191]
s_bfe_i32 s57, s3, 0x10000
buffer_load_dwordx4 v237, s[16:19], s48 offen nt lds
v_cvt_pk_bf16_f32 v32, v184, v185
v_mfma_f32_16x16x32_bf16 v[188:191], a[84:87], v[196:199], v[188:191]
s_and_b32 s54, s57, s5
v_cvt_pk_bf16_f32 v33, v186, v187
s_sub_u32 s45, s45, 1
v_mfma_f32_16x16x32_bf16 v[188:191], a[80:83], v[200:203], v[188:191]
s_sub_u32 s50, s50, s54
s_add_u32 s52, s46, 20480
s_lshr_b32 s3, s3, 1
v_mfma_f32_16x16x32_bf16 v[184:187], a[96:99], v[200:203], 0
s_waitcnt lgkmcnt(0)
s_nop 1
v_mfma_f32_16x16x32_bf16 v[184:187], a[100:103], v[196:199], v[184:187]
v_cvt_pk_bf16_f32 v35, v190, v191
v_cvt_pk_bf16_f32 v34, v188, v189
v_mfma_f32_16x16x32_bf16 v[184:187], a[104:107], v[216:219], v[184:187]
v_mfma_f32_16x16x32_bf16 v[184:187], a[108:111], v[220:223], v[184:187]
s_nop 2
v_mfma_f32_16x16x32_bf16 v[188:191], a[124:127], v[220:223], 0
s_nop 2
v_mfma_f32_16x16x32_bf16 v[188:191], a[120:123], v[216:219], v[188:191]
v_cvt_pk_bf16_f32 v37, v186, v187
v_cvt_pk_bf16_f32 v36, v184, v185
v_mfma_f32_16x16x32_bf16 v[188:191], a[116:119], v[196:199], v[188:191]
ds_read_b128 v[196:199], v236 offset:21632
v_mfma_f32_16x16x32_bf16 v[188:191], a[112:115], v[200:203], v[188:191]
s_nop 7
v_cvt_pk_bf16_f32 v39, v190, v191
v_cvt_pk_bf16_f32 v38, v188, v189
s_nop 7
s_waitcnt lgkmcnt(0)
s_branch L_entrys
.p2align 6
L_loops:
s_waitcnt vmcnt(8)
s_barrier
v_mfma_f32_16x16x32_bf16 v[176:179], a[224:227], v[220:223], 0
s_add_u32 s52, s47, 8192
v_exp_f32 v187, v187
v_mfma_f32_16x16x32_bf16 v[176:179], a[228:231], v[224:227], v[176:179]
s_add_u32 s53, s47, 12288
v_add_f32 v248, v184, v185
v_add_f32 v248, v248, v186
v_mfma_f32_16x16x32_bf16 v[176:179], a[232:235], v[212:215], v[176:179]
s_mov_b32 s47, s46
v_add_f32 v248, v248, v187
v_cvt_pk_bf16_f32 v120, v184, v185
v_mfma_f32_16x16x32_bf16 v[176:179], a[236:239], v[216:219], v[176:179]
s_bfe_i32 s57, s3, 0x10000
v_cvt_pk_bf16_f32 v121, v186, v187
v_sub_f32 v193, v193, v254
v_mfma_f32_16x16x32_bf16 v[180:183], a[252:255], v[216:219], 0
s_and_b32 s54, s57, s5
v_exp_f32 v188, v188
v_mfma_f32_16x16x32_bf16 v[180:183], a[248:251], v[212:215], v[180:183]
s_sub_u32 s45, s45, 1
v_exp_f32 v190, v190
v_mfma_f32_16x16x32_bf16 v[180:183], a[244:247], v[224:227], v[180:183]
s_lshr_b32 s3, s3, 1
v_sub_f32 v194, v194, v254
v_add_f32 v248, v248, v188
v_mfma_f32_16x16x32_bf16 v[180:183], a[240:243], v[220:223], v[180:183]
v_exp_f32 v189, v189
v_mfma_f32_16x16x32_bf16 v[212:215], v[0:3], v[112:115], 0
v_add_f32 v248, v248, v189
v_sub_f32 v191, v191, v254
v_mfma_f32_16x16x32_bf16 v[212:215], v[4:7], v[116:119], v[212:215]
v_exp_f32 v191, v191
v_mfma_f32_16x16x32_bf16 v[216:219], v[12:15], v[116:119], 0
v_sub_f32 v195, v195, v254
v_sub_f32 v192, v192, v254
v_mfma_f32_16x16x32_bf16 v[216:219], v[8:11], v[112:115], v[216:219]
v_exp_f32 v192, v192
v_mfma_f32_16x16x32_bf16 v[220:223], v[16:19], v[112:115], 0
v_exp_f32 v194, v194
v_mfma_f32_16x16x32_bf16 v[220:223], v[20:23], v[116:119], v[220:223]
v_exp_f32 v193, v193
v_mfma_f32_16x16x32_bf16 v[224:227], v[28:31], v[116:119], 0
v_add_f32 v248, v248, v190
v_add_f32 v248, v248, v191
v_mfma_f32_16x16x32_bf16 v[224:227], v[24:27], v[112:115], v[224:227]
v_exp_f32 v195, v195
v_mfma_f32_16x16x32_bf16 v[228:231], v[32:35], v[112:115], 0
v_add_f32 v248, v248, v192
v_add_f32 v248, v248, v193
v_mfma_f32_16x16x32_bf16 v[228:231], v[36:39], v[116:119], v[228:231]
v_add_f32 v248, v248, v194
v_add_f32 v248, v248, v195
v_mfma_f32_16x16x32_bf16 v[232:235], v[44:47], v[116:119], 0
v_cvt_pk_bf16_f32 v123, v190, v191
v_cvt_pk_bf16_f32 v122, v188, v189
v_mfma_f32_16x16x32_bf16 v[232:235], v[40:43], v[112:115], v[232:235]
s_mov_b32 s48, s50
ds_read_b128 v[188:191], v236 offset:0
v_cvt_pk_bf16_f32 v125, v194, v195
v_mfma_f32_16x16x32_bf16 v[184:187], v[48:51], v[112:115], 0
s_add_u32 m0, s49, 0
ds_read_b128 v[48:51], v240 offset:0
v_cvt_pk_bf16_f32 v124, v192, v193
v_mfma_f32_16x16x32_bf16 v[184:187], v[52:55], v[116:119], v[184:187]
s_add_u32 s50, s50, 13107200
buffer_load_dwordx4 v237, s[16:19], s48 offen nt lds
v_sub_f32 v196, v196, v254
v_sub_f32 v197, v197, v254
v_sub_f32 v199, v199, v254
v_sub_f32 v198, v198, v254
v_exp_f32 v196, v196
v_exp_f32 v197, v197
v_add_f32 v248, v248, v196
v_add_f32 v248, v248, v197
v_exp_f32 v198, v198
s_waitcnt lgkmcnt(1)
v_mfma_f32_16x16x32_bf16 v[192:195], a[64:67], v[188:191], 0
s_sub_u32 s50, s50, s54
ds_read_b128 v[52:55], v240 offset:64
v_exp_f32 v199, v199
v_add_f32 v248, v248, v198
v_add_f32 v248, v248, v199
v_cvt_pk_bf16_f32 v126, v196, v197
v_cvt_pk_bf16_f32 v127, v198, v199
ds_read_b128 v[196:199], v236 offset:256
v_sub_f32 v200, v200, v254
v_sub_f32 v203, v203, v254
v_sub_f32 v201, v201, v254
v_exp_f32 v201, v201
v_sub_f32 v202, v202, v254
v_exp_f32 v202, v202
v_exp_f32 v200, v200
v_exp_f32 v203, v203
v_add_f32 v248, v248, v200
v_add_f32 v248, v248, v201
v_add_f32 v248, v248, v202
v_add_f32 v248, v248, v203
v_cvt_pk_bf16_f32 v128, v200, v201
v_cvt_pk_bf16_f32 v129, v202, v203
v_sub_f32 v204, v204, v254
v_sub_f32 v205, v205, v254
s_waitcnt lgkmcnt(0)
v_mfma_f32_16x16x32_bf16 v[192:195], a[68:71], v[196:199], v[192:195]
ds_read_b128 v[200:203], v236 offset:512
v_exp_f32 v204, v204
v_sub_f32 v206, v206, v254
v_add_f32 v248, v248, v204
v_exp_f32 v206, v206
v_sub_f32 v207, v207, v254
v_exp_f32 v205, v205
v_exp_f32 v207, v207
v_add_f32 v248, v248, v205
v_cvt_pk_bf16_f32 v130, v204, v205
v_add_f32 v248, v248, v206
v_add_f32 v248, v248, v207
v_cvt_pk_bf16_f32 v131, v206, v207
v_sub_f32 v208, v208, v254
v_exp_f32 v208, v208
v_max3_f32 v254, v212, v213, v214
s_waitcnt lgkmcnt(0)
v_mfma_f32_16x16x32_bf16 v[192:195], a[72:75], v[200:203], v[192:195]
ds_read_b128 v[204:207], v236 offset:768
v_add_f32 v248, v248, v208
v_cvt_pk_bf16_f32 v132, v208, 0
v_max3_f32 v254, v254, v215, v216
v_max3_f32 v254, v254, v217, v218
v_max3_f32 v254, v254, v219, v220
v_max3_f32 v254, v254, v221, v222
v_max3_f32 v254, v254, v223, v224
v_max3_f32 v254, v254, v225, v226
v_max3_f32 v254, v254, v227, v228
v_max3_f32 v254, v254, v229, v230
v_max3_f32 v254, v254, v231, v232
v_max3_f32 v254, v254, v233, v234
v_max3_f32 v254, v254, v235, v184
v_add_u32 v240, 0x200, v240
ds_swizzle_b32 v250, v248 offset:0x401F
ds_swizzle_b32 v255, v254 offset:0x401F
s_waitcnt lgkmcnt(2)
v_mfma_f32_16x16x32_bf16 v[192:195], a[76:79], v[204:207], v[192:195]
s_nop 2
v_mfma_f32_16x16x32_bf16 v[208:211], a[92:95], v[204:207], 0
s_nop 2
v_mfma_f32_16x16x32_bf16 v[208:211], a[88:91], v[200:203], v[208:211]
v_cvt_pk_bf16_f32 v0, v192, v193
v_cvt_pk_bf16_f32 v1, v194, v195
v_mfma_f32_16x16x32_bf16 v[208:211], a[84:87], v[196:199], v[208:211]
v_mfma_f32_16x16x32_bf16 v[208:211], a[80:83], v[188:191], v[208:211]
s_waitcnt lgkmcnt(0)
v_add_f32 v248, v248, v250
v_max_f32 v254, v254, v255
v_mfma_f32_16x16x32_bf16 v[192:195], a[96:99], v[188:191], 0
ds_bpermute_b32 v250, v247, v248
v_mfma_f32_16x16x32_bf16 v[192:195], a[100:103], v[196:199], v[192:195]
ds_bpermute_b32 v255, v247, v254
v_mfma_f32_16x16x32_bf16 v[192:195], a[104:107], v[200:203], v[192:195]
v_cvt_pk_bf16_f32 v2, v208, v209
v_cvt_pk_bf16_f32 v3, v210, v211
v_mfma_f32_16x16x32_bf16 v[192:195], a[108:111], v[204:207], v[192:195]
s_nop 2
v_mfma_f32_16x16x32_bf16 v[208:211], a[124:127], v[204:207], 0
s_nop 2
v_mfma_f32_16x16x32_bf16 v[208:211], a[120:123], v[200:203], v[208:211]
v_cvt_pk_bf16_f32 v5, v194, v195
v_cvt_pk_bf16_f32 v4, v192, v193
v_mfma_f32_16x16x32_bf16 v[208:211], a[116:119], v[196:199], v[208:211]
s_waitcnt lgkmcnt(1)
v_add_f32 v248, v248, v250
v_mfma_f32_16x16x32_bf16 v[208:211], a[112:115], v[188:191], v[208:211]
s_waitcnt lgkmcnt(0)
v_rcp_f32 v251, v248
v_mfma_f32_16x16x32_bf16 v[188:191], v[56:59], v[120:123], 0
v_max_f32 v254, v254, v255
v_sub_f32 v214, v214, v254
v_mfma_f32_16x16x32_bf16 v[188:191], v[104:107], v[132:135], v[188:191]
s_add_u32 s48, s48, s51
v_sub_f32 v215, v215, v254
v_cvt_pk_bf16_f32 v6, v208, v209
v_mfma_f32_16x16x32_bf16 v[188:191], v[72:75], v[124:127], v[188:191]
s_add_u32 m0, s49, 2112
v_cvt_pk_bf16_f32 v7, v210, v211
v_sub_f32 v212, v212, v254
v_mfma_f32_16x16x32_bf16 v[188:191], v[88:91], v[128:131], v[188:191]
buffer_load_dwordx4 v237, s[16:19], s48 offen nt lds
v_sub_f32 v213, v213, v254
v_mfma_f32_16x16x32_bf16 v[196:199], v[92:95], v[128:131], 0
v_exp_f32 v212, v212
v_mfma_f32_16x16x32_bf16 v[196:199], v[76:79], v[124:127], v[196:199]
v_exp_f32 v214, v214
v_mfma_f32_16x16x32_bf16 v[196:199], v[106:109], v[132:135], v[196:199]
v_exp_f32 v213, v213
v_mfma_f32_16x16x32_bf16 v[196:199], v[60:63], v[120:123], v[196:199]
ds_read_b128 v[204:207], v236 offset:4480
v_sub_f32 v216, v216, v254
v_mfma_f32_16x16x32_bf16 v[200:203], v[64:67], v[120:123], 0
ds_read_b128 v[192:195], v236 offset:4224
v_sub_f32 v217, v217, v254
v_mfma_f32_16x16x32_bf16 v[200:203], v[108:111], v[132:135], v[200:203]
v_exp_f32 v215, v215
v_mfma_f32_16x16x32_bf16 v[200:203], v[80:83], v[124:127], v[200:203]
v_exp_f32 v217, v217
v_mfma_f32_16x16x32_bf16 v[200:203], v[96:99], v[128:131], v[200:203]
v_sub_f32 v218, v218, v254
v_add_f32 v249, v212, v213
v_mfma_f32_16x16x32_bf16 v[208:211], v[100:103], v[128:131], 0
v_add_f32 v249, v249, v214
v_add_f32 v249, v249, v215
v_mfma_f32_16x16x32_bf16 v[208:211], v[84:87], v[124:127], v[208:211]
s_waitcnt lgkmcnt(1)
v_exp_f32 v216, v216
v_mfma_f32_16x16x32_bf16 v[208:211], v[110:113], v[132:135], v[208:211]
s_waitcnt lgkmcnt(0)
v_sub_f32 v219, v219, v254
v_sub_f32 v220, v220, v254
v_mfma_f32_16x16x32_bf16 v[208:211], v[68:71], v[120:123], v[208:211]
v_exp_f32 v218, v218
v_sub_f32 v223, v223, v254
v_add_f32 v249, v249, v216
v_add_f32 v249, v249, v217
v_exp_f32 v219, v219
v_add_f32 v249, v249, v218
v_add_f32 v249, v249, v219
v_exp_f32 v220, v220
v_sub_f32 v224, v224, v254
v_exp_f32 v223, v223
v_sub_f32 v221, v221, v254
v_exp_f32 v224, v224
v_exp_f32 v221, v221
v_sub_f32 v222, v222, v254
v_sub_f32 v225, v225, v254
v_add_f32 v249, v249, v220
v_add_f32 v249, v249, v221
v_exp_f32 v222, v222
v_exp_f32 v225, v225
v_add_f32 v249, v249, v222
v_add_f32 v249, v249, v223
v_add_f32 v249, v249, v224
v_sub_f32 v226, v226, v254
v_add_f32 v249, v249, v225
v_exp_f32 v226, v226
v_sub_f32 v227, v227, v254
v_exp_f32 v227, v227
v_sub_f32 v228, v228, v254
v_exp_f32 v228, v228
v_add_f32 v249, v249, v226
v_sub_f32 v232, v232, v254
v_sub_f32 v229, v229, v254
v_sub_f32 v230, v230, v254
v_exp_f32 v230, v230
v_exp_f32 v229, v229
v_add_f32 v249, v249, v227
v_add_f32 v249, v249, v228
v_add_f32 v249, v249, v229
v_exp_f32 v232, v232
v_sub_f32 v233, v233, v254
v_exp_f32 v233, v233
v_sub_f32 v231, v231, v254
v_exp_f32 v231, v231
v_sub_f32 v234, v234, v254
v_sub_f32 v235, v235, v254
v_add_f32 v249, v249, v230
v_add_f32 v249, v249, v231
v_add_f32 v249, v249, v232
v_exp_f32 v234, v234
v_exp_f32 v235, v235
v_sub_f32 v184, v184, v254
v_exp_f32 v184, v184
v_add_f32 v249, v249, v233
v_cvt_pk_bf16_f32 v148, v184, 0
v_add_f32 v249, v249, v234
v_add_f32 v249, v249, v235
v_add_f32 v249, v249, v184
v_fmac_f32 v161, v201, v251
v_fmac_f32 v163, v203, v251
v_fmac_f32 v160, v200, v251
v_fmac_f32 v162, v202, v251
ds_read_b128 v[184:187], v236 offset:4992
v_cvt_pk_bf16_f32 v138, v216, v217
v_cvt_pk_bf16_f32 v139, v218, v219
v_fmac_f32 v167, v211, v251
v_fmac_f32 v165, v209, v251
v_fmac_f32 v166, v210, v251
v_fmac_f32 v164, v208, v251
v_cvt_pk_bf16_f32 v140, v220, v221
v_cvt_pk_bf16_f32 v141, v222, v223
v_fmac_f32 v155, v191, v251
v_fmac_f32 v154, v190, v251
v_fmac_f32 v152, v188, v251
v_fmac_f32 v153, v189, v251
v_cvt_pk_bf16_f32 v137, v214, v215
v_cvt_pk_bf16_f32 v136, v212, v213
v_cvt_pk_bf16_f32 v143, v226, v227
v_cvt_pk_bf16_f32 v142, v224, v225
v_cvt_pk_bf16_f32 v145, v230, v231
v_cvt_pk_bf16_f32 v144, v228, v229
v_fmac_f32 v156, v196, v251
v_fmac_f32 v157, v197, v251
s_waitcnt lgkmcnt(0)
v_mfma_f32_16x16x32_bf16 v[200:203], a[124:127], v[184:187], 0
ds_read_b128 v[216:219], v236 offset:4736
v_fmac_f32 v158, v198, v251
v_fmac_f32 v159, v199, v251
v_cvt_pk_bf16_f32 v147, v234, v235
v_cvt_pk_bf16_f32 v146, v232, v233
v_cvt_pk_bf16_f32 v160, v160, v161
v_cvt_pk_bf16_f32 v161, v162, v163
v_cvt_pk_bf16_f32 v163, v166, v167
v_cvt_pk_bf16_f32 v162, v164, v165
v_cvt_pk_bf16_f32 v152, v152, v153
v_cvt_pk_bf16_f32 v153, v154, v155
v_pk_max_i16 v160, v160, 0
v_pk_max_i16 v162, v162, 0
v_pk_max_i16 v153, v153, 0
v_pk_max_i16 v161, v161, 0
v_pk_max_i16 v163, v163, 0
v_cvt_pk_bf16_f32 v155, v158, v159
v_pk_max_i16 v155, v155, 0
v_pk_max_i16 v152, v152, 0
v_cvt_pk_bf16_f32 v154, v156, v157
v_pk_max_i16 v154, v154, 0
s_waitcnt lgkmcnt(0)
v_mfma_f32_16x16x32_bf16 v[200:203], a[120:123], v[216:219], v[200:203]
ds_swizzle_b32 v250, v249 offset:0x401F
buffer_store_dwordx4 v[152:155], v239, s[20:23], s52 offen offset:0 nt
buffer_store_dwordx4 v[160:163], v239, s[20:23], s52 offen offset:64 nt
s_add_u32 s52, s46, 20480
v_mfma_f32_16x16x32_bf16 v[200:203], a[116:119], v[204:207], v[200:203]
v_mfma_f32_16x16x32_bf16 v[200:203], a[112:115], v[192:195], v[200:203]
s_nop 2
v_mfma_f32_16x16x32_bf16 v[208:211], a[96:99], v[192:195], 0
s_waitcnt lgkmcnt(0)
v_add_f32 v249, v249, v250
v_mfma_f32_16x16x32_bf16 v[208:211], a[100:103], v[204:207], v[208:211]
s_add_u32 m0, s49, 4224
ds_bpermute_b32 v250, v247, v249
v_mfma_f32_16x16x32_bf16 v[208:211], a[104:107], v[216:219], v[208:211]
s_add_u32 s48, s48, s51
buffer_load_dwordx4 v237, s[16:19], s48 offen nt lds
v_cvt_pk_bf16_f32 v14, v200, v201
v_mfma_f32_16x16x32_bf16 v[208:211], a[108:111], v[184:187], v[208:211]
ds_read_b128 v[212:215], v236 offset:8448
v_cvt_pk_bf16_f32 v15, v202, v203
v_mfma_f32_16x16x32_bf16 v[220:223], a[92:95], v[184:187], 0
ds_read_b128 v[200:203], v236 offset:8704
ds_read_b128 v[224:227], v236 offset:8960
v_mfma_f32_16x16x32_bf16 v[220:223], a[88:91], v[216:219], v[220:223]
ds_read_b128 v[228:231], v236 offset:9216
v_mfma_f32_16x16x32_bf16 v[220:223], a[84:87], v[204:207], v[220:223]
v_cvt_pk_bf16_f32 v13, v210, v211
v_cvt_pk_bf16_f32 v12, v208, v209
v_mfma_f32_16x16x32_bf16 v[220:223], a[80:83], v[192:195], v[220:223]
s_waitcnt lgkmcnt(4)
v_add_f32 v249, v249, v250
s_nop 0
v_mfma_f32_16x16x32_bf16 v[188:191], a[64:67], v[192:195], 0
v_rcp_f32 v252, v249
v_mfma_f32_16x16x32_bf16 v[188:191], a[72:75], v[216:219], v[188:191]
s_waitcnt lgkmcnt(3)
s_nop 0
v_cvt_pk_bf16_f32 v10, v220, v221
v_mfma_f32_16x16x32_bf16 v[188:191], a[76:79], v[184:187], v[188:191]
s_waitcnt lgkmcnt(1)
v_cvt_pk_bf16_f32 v11, v222, v223
v_mfma_f32_16x16x32_bf16 v[188:191], a[68:71], v[204:207], v[188:191]
s_waitcnt lgkmcnt(0)
s_nop 1
v_mfma_f32_16x16x32_bf16 v[184:187], a[68:71], v[200:203], 0
s_nop 2
v_mfma_f32_16x16x32_bf16 v[184:187], a[64:67], v[212:215], v[184:187]
v_cvt_pk_bf16_f32 v9, v190, v191
v_cvt_pk_bf16_f32 v8, v188, v189
v_mfma_f32_16x16x32_bf16 v[184:187], a[72:75], v[224:227], v[184:187]
v_mfma_f32_16x16x32_bf16 v[184:187], a[76:79], v[228:231], v[184:187]
s_nop 2
v_mfma_f32_16x16x32_bf16 v[188:191], a[92:95], v[228:231], 0
s_nop 2
v_mfma_f32_16x16x32_bf16 v[188:191], a[88:91], v[224:227], v[188:191]
v_cvt_pk_bf16_f32 v16, v184, v185
v_cvt_pk_bf16_f32 v17, v186, v187
v_mfma_f32_16x16x32_bf16 v[188:191], a[84:87], v[200:203], v[188:191]
v_mfma_f32_16x16x32_bf16 v[188:191], a[80:83], v[212:215], v[188:191]
ds_read_b128 v[184:187], v236 offset:13184
ds_read_b128 v[192:195], v236 offset:13440
v_mfma_f32_16x16x32_bf16 v[196:199], a[96:99], v[212:215], 0
ds_read_b128 v[204:207], v236 offset:12928
ds_read_b128 v[208:211], v236 offset:12672
v_mfma_f32_16x16x32_bf16 v[196:199], a[100:103], v[200:203], v[196:199]
s_add_u32 m0, s49, 6336
s_add_u32 s48, s48, s51
v_cvt_pk_bf16_f32 v18, v188, v189
v_mfma_f32_16x16x32_bf16 v[196:199], a[104:107], v[224:227], v[196:199]
buffer_load_dwordx4 v237, s[16:19], s48 offen nt lds
v_cvt_pk_bf16_f32 v19, v190, v191
v_mfma_f32_16x16x32_bf16 v[196:199], a[108:111], v[228:231], v[196:199]
s_nop 2
v_mfma_f32_16x16x32_bf16 v[188:191], a[124:127], v[228:231], 0
s_nop 2
v_mfma_f32_16x16x32_bf16 v[188:191], a[116:119], v[200:203], v[188:191]
s_waitcnt lgkmcnt(2)
v_cvt_pk_bf16_f32 v21, v198, v199
v_cvt_pk_bf16_f32 v20, v196, v197
v_mfma_f32_16x16x32_bf16 v[188:191], a[112:115], v[212:215], v[188:191]
s_waitcnt lgkmcnt(0)
v_mfma_f32_16x16x32_bf16 v[188:191], a[120:123], v[224:227], v[188:191]
s_nop 2
v_mfma_f32_16x16x32_bf16 v[196:199], a[120:123], v[184:187], 0
s_nop 2
v_mfma_f32_16x16x32_bf16 v[196:199], a[124:127], v[192:195], v[196:199]
v_cvt_pk_bf16_f32 v23, v190, v191
v_cvt_pk_bf16_f32 v22, v188, v189
v_mfma_f32_16x16x32_bf16 v[196:199], a[116:119], v[204:207], v[196:199]
v_mfma_f32_16x16x32_bf16 v[196:199], a[112:115], v[208:211], v[196:199]
s_nop 2
v_mfma_f32_16x16x32_bf16 v[188:191], a[96:99], v[208:211], 0
s_nop 2
v_mfma_f32_16x16x32_bf16 v[188:191], a[100:103], v[204:207], v[188:191]
v_cvt_pk_bf16_f32 v30, v196, v197
v_cvt_pk_bf16_f32 v31, v198, v199
v_mfma_f32_16x16x32_bf16 v[188:191], a[104:107], v[184:187], v[188:191]
v_mfma_f32_16x16x32_bf16 v[188:191], a[108:111], v[192:195], v[188:191]
ds_read_b128 v[196:199], v236 offset:17152
ds_read_b128 v[200:203], v236 offset:16896
v_mfma_f32_16x16x32_bf16 v[212:215], a[92:95], v[192:195], 0
ds_read_b128 v[216:219], v236 offset:17408
ds_read_b128 v[220:223], v236 offset:17664
v_mfma_f32_16x16x32_bf16 v[212:215], a[88:91], v[184:187], v[212:215]
s_nop 1
v_cvt_pk_bf16_f32 v29, v190, v191
v_mfma_f32_16x16x32_bf16 v[212:215], a[84:87], v[204:207], v[212:215]
v_cvt_pk_bf16_f32 v28, v188, v189
v_mfma_f32_16x16x32_bf16 v[212:215], a[80:83], v[208:211], v[212:215]
s_nop 2
v_mfma_f32_16x16x32_bf16 v[188:191], a[64:67], v[208:211], 0
s_nop 2
v_mfma_f32_16x16x32_bf16 v[188:191], a[72:75], v[184:187], v[188:191]
s_add_u32 m0, s49, 8448
v_cvt_pk_bf16_f32 v27, v214, v215
v_cvt_pk_bf16_f32 v26, v212, v213
v_mfma_f32_16x16x32_bf16 v[188:191], a[76:79], v[192:195], v[188:191]
s_add_u32 s48, s48, s51
buffer_load_dwordx4 v237, s[16:19], s48 offen nt lds
v_mfma_f32_16x16x32_bf16 v[188:191], a[68:71], v[204:207], v[188:191]
s_waitcnt lgkmcnt(0)
s_nop 1
v_mfma_f32_16x16x32_bf16 v[184:187], a[68:71], v[196:199], 0
s_nop 2
v_mfma_f32_16x16x32_bf16 v[184:187], a[64:67], v[200:203], v[184:187]
v_cvt_pk_bf16_f32 v24, v188, v189
v_cvt_pk_bf16_f32 v25, v190, v191
v_mfma_f32_16x16x32_bf16 v[184:187], a[72:75], v[216:219], v[184:187]
v_mfma_f32_16x16x32_bf16 v[184:187], a[76:79], v[220:223], v[184:187]
s_nop 2
v_mfma_f32_16x16x32_bf16 v[188:191], a[92:95], v[220:223], 0
s_nop 2
v_mfma_f32_16x16x32_bf16 v[188:191], a[88:91], v[216:219], v[188:191]
v_cvt_pk_bf16_f32 v32, v184, v185
v_cvt_pk_bf16_f32 v33, v186, v187
v_mfma_f32_16x16x32_bf16 v[188:191], a[84:87], v[196:199], v[188:191]
v_mfma_f32_16x16x32_bf16 v[188:191], a[80:83], v[200:203], v[188:191]
s_nop 2
v_mfma_f32_16x16x32_bf16 v[184:187], a[96:99], v[200:203], 0
s_nop 2
v_mfma_f32_16x16x32_bf16 v[184:187], a[100:103], v[196:199], v[184:187]
v_cvt_pk_bf16_f32 v35, v190, v191
v_cvt_pk_bf16_f32 v34, v188, v189
v_mfma_f32_16x16x32_bf16 v[184:187], a[104:107], v[216:219], v[184:187]
v_mfma_f32_16x16x32_bf16 v[184:187], a[108:111], v[220:223], v[184:187]
s_nop 2
v_mfma_f32_16x16x32_bf16 v[188:191], a[124:127], v[220:223], 0
s_nop 2
v_mfma_f32_16x16x32_bf16 v[188:191], a[120:123], v[216:219], v[188:191]
v_cvt_pk_bf16_f32 v37, v186, v187
v_cvt_pk_bf16_f32 v36, v184, v185
v_mfma_f32_16x16x32_bf16 v[188:191], a[116:119], v[196:199], v[188:191]
v_mfma_f32_16x16x32_bf16 v[188:191], a[112:115], v[200:203], v[188:191]
s_nop 2
v_mfma_f32_16x16x32_bf16 v[184:187], v[56:59], v[136:139], 0
s_nop 2
v_mfma_f32_16x16x32_bf16 v[184:187], v[104:107], v[148:151], v[184:187]
s_add_u32 m0, s49, 10560
ds_read_u16 v104, v241 offset:0
v_cvt_pk_bf16_f32 v39, v190, v191
v_mfma_f32_16x16x32_bf16 v[184:187], v[72:75], v[140:143], v[184:187]
s_add_u32 s48, s48, s51
buffer_load_dwordx4 v237, s[16:19], s48 offen nt lds
v_cvt_pk_bf16_f32 v38, v188, v189
v_mfma_f32_16x16x32_bf16 v[184:187], v[88:91], v[144:147], v[184:187]
s_nop 2
v_mfma_f32_16x16x32_bf16 v[188:191], v[92:95], v[144:147], 0
s_nop 2
v_mfma_f32_16x16x32_bf16 v[188:191], v[76:79], v[140:143], v[188:191]
v_fmac_f32 v170, v186, v252
v_fmac_f32 v168, v184, v252
v_mfma_f32_16x16x32_bf16 v[188:191], v[106:109], v[148:151], v[188:191]
ds_read_u16 v106, v241 offset:128
v_fmac_f32 v171, v187, v252
v_mfma_f32_16x16x32_bf16 v[188:191], v[60:63], v[136:139], v[188:191]
s_waitcnt lgkmcnt(1)
ds_read_b128 v[192:195], v236 offset:21888
v_fmac_f32 v169, v185, v252
v_mfma_f32_16x16x32_bf16 v[200:203], v[64:67], v[136:139], 0
ds_read_b128 v[196:199], v236 offset:21632
ds_read_b128 v[204:207], v236 offset:21376
v_mfma_f32_16x16x32_bf16 v[200:203], v[108:111], v[148:151], v[200:203]
ds_read_b128 v[208:211], v236 offset:21120
v_fmac_f32 v174, v190, v252
v_mfma_f32_16x16x32_bf16 v[200:203], v[80:83], v[140:143], v[200:203]
ds_read_u16 v108, v241 offset:256
v_fmac_f32 v175, v191, v252
v_mfma_f32_16x16x32_bf16 v[200:203], v[96:99], v[144:147], v[200:203]
v_fmac_f32 v172, v188, v252
v_fmac_f32 v173, v189, v252
v_mfma_f32_16x16x32_bf16 v[184:187], v[100:103], v[144:147], 0
s_waitcnt lgkmcnt(5)
v_cvt_pk_bf16_f32 v168, v168, v169
v_cvt_pk_bf16_f32 v169, v170, v171
v_mfma_f32_16x16x32_bf16 v[184:187], v[84:87], v[140:143], v[184:187]
s_waitcnt lgkmcnt(4)
v_fmac_f32 v178, v202, v252
v_fmac_f32 v176, v200, v252
v_mfma_f32_16x16x32_bf16 v[184:187], v[110:113], v[148:151], v[184:187]
s_waitcnt lgkmcnt(2)
ds_read_u16 v110, v241 offset:384
v_fmac_f32 v177, v201, v252
v_mfma_f32_16x16x32_bf16 v[184:187], v[68:71], v[136:139], v[184:187]
L_entrys:
s_waitcnt lgkmcnt(2)
v_fmac_f32 v179, v203, v252
v_cvt_pk_bf16_f32 v176, v176, v177
v_mfma_f32_16x16x32_bf16 v[188:191], a[124:127], v[192:195], 0
s_waitcnt lgkmcnt(1)
v_cvt_pk_bf16_f32 v177, v178, v179
v_cvt_pk_bf16_f32 v171, v174, v175
v_mfma_f32_16x16x32_bf16 v[188:191], a[120:123], v[196:199], v[188:191]
v_fmac_f32 v180, v184, v252
v_fmac_f32 v181, v185, v252
v_mfma_f32_16x16x32_bf16 v[188:191], a[116:119], v[204:207], v[188:191]
v_fmac_f32 v183, v187, v252
v_fmac_f32 v182, v186, v252
v_mfma_f32_16x16x32_bf16 v[188:191], a[112:115], v[208:211], v[188:191]
v_cvt_pk_bf16_f32 v178, v180, v181
v_cvt_pk_bf16_f32 v170, v172, v173
v_mfma_f32_16x16x32_bf16 v[184:187], a[96:99], v[208:211], 0
s_waitcnt lgkmcnt(0)
v_cvt_pk_bf16_f32 v179, v182, v183
v_pk_max_i16 v168, v168, 0
v_mfma_f32_16x16x32_bf16 v[184:187], a[100:103], v[204:207], v[184:187]
s_add_u32 s48, s48, s51
v_cvt_pk_bf16_f32 v46, v188, v189
v_cvt_pk_bf16_f32 v47, v190, v191
v_mfma_f32_16x16x32_bf16 v[184:187], a[104:107], v[196:199], v[184:187]
s_add_u32 m0, s49, 12672
v_pk_max_i16 v176, v176, 0
v_pk_max_i16 v170, v170, 0
v_mfma_f32_16x16x32_bf16 v[184:187], a[108:111], v[192:195], v[184:187]
buffer_load_dwordx4 v237, s[16:19], s48 offen nt lds
v_pk_max_i16 v179, v179, 0
v_mfma_f32_16x16x32_bf16 v[188:191], a[92:95], v[192:195], 0
v_pk_max_i16 v178, v178, 0
v_pk_max_i16 v169, v169, 0
v_mfma_f32_16x16x32_bf16 v[188:191], a[88:91], v[196:199], v[188:191]
v_pk_max_i16 v177, v177, 0
v_pk_max_i16 v171, v171, 0
v_mfma_f32_16x16x32_bf16 v[188:191], a[84:87], v[204:207], v[188:191]
buffer_store_dwordx4 v[168:171], v239, s[20:23], s53 offen offset:0 nt
buffer_store_dwordx4 v[176:179], v239, s[20:23], s53 offen offset:64 nt
v_cvt_pk_bf16_f32 v44, v184, v185
v_cvt_pk_bf16_f32 v45, v186, v187
v_add_u32 v241, 0x200, v241
s_add_u32 s53, s46, 0
v_mfma_f32_16x16x32_bf16 v[188:191], a[80:83], v[208:211], v[188:191]
s_nop 2
v_mfma_f32_16x16x32_bf16 v[184:187], a[64:67], v[208:211], 0
s_nop 2
v_mfma_f32_16x16x32_bf16 v[184:187], a[72:75], v[196:199], v[184:187]
v_cvt_pk_bf16_f32 v42, v188, v189
v_cvt_pk_bf16_f32 v43, v190, v191
v_mfma_f32_16x16x32_bf16 v[184:187], a[76:79], v[192:195], v[184:187]
v_mfma_f32_16x16x32_bf16 v[184:187], a[68:71], v[204:207], v[184:187]
s_nop 2
v_mfma_f32_16x16x32_bf16 v[188:191], a[4:7], v[204:207], 0
s_nop 2
v_mfma_f32_16x16x32_bf16 v[188:191], a[0:3], v[208:211], v[188:191]
v_cvt_pk_bf16_f32 v41, v186, v187
v_cvt_pk_bf16_f32 v40, v184, v185
v_mfma_f32_16x16x32_bf16 v[188:191], a[8:11], v[196:199], v[188:191]
v_mfma_f32_16x16x32_bf16 v[188:191], a[12:15], v[192:195], v[188:191]
s_nop 2
v_mfma_f32_16x16x32_bf16 v[184:187], a[28:31], v[192:195], 0
s_nop 2
v_mfma_f32_16x16x32_bf16 v[184:187], a[24:27], v[196:199], v[184:187]
v_cvt_pk_bf16_f32 v112, v188, v189
v_cvt_pk_bf16_f32 v113, v190, v191
v_mfma_f32_16x16x32_bf16 v[184:187], a[20:23], v[204:207], v[184:187]
v_mfma_f32_16x16x32_bf16 v[184:187], a[16:19], v[208:211], v[184:187]
s_nop 2
v_mfma_f32_16x16x32_bf16 v[188:191], a[32:35], v[208:211], 0
s_nop 2
v_mfma_f32_16x16x32_bf16 v[188:191], a[36:39], v[204:207], v[188:191]
s_add_u32 m0, s49, 14784
v_cvt_pk_bf16_f32 v114, v184, v185
v_cvt_pk_bf16_f32 v115, v186, v187
v_mfma_f32_16x16x32_bf16 v[188:191], a[40:43], v[196:199], v[188:191]
s_add_u32 s48, s48, s51
buffer_load_dwordx4 v237, s[16:19], s48 offen nt lds
v_mfma_f32_16x16x32_bf16 v[188:191], a[44:47], v[192:195], v[188:191]
s_nop 2
v_mfma_f32_16x16x32_bf16 v[184:187], a[60:63], v[192:195], 0
s_nop 2
v_mfma_f32_16x16x32_bf16 v[184:187], a[56:59], v[196:199], v[184:187]
v_cvt_pk_bf16_f32 v116, v188, v189
v_cvt_pk_bf16_f32 v117, v190, v191
v_mfma_f32_16x16x32_bf16 v[184:187], a[52:55], v[204:207], v[184:187]
v_mfma_f32_16x16x32_bf16 v[184:187], a[48:51], v[208:211], v[184:187]
s_nop 2
v_mfma_f32_16x16x32_bf16 v[152:155], a[192:195], v[208:211], 0
s_nop 2
v_mfma_f32_16x16x32_bf16 v[152:155], a[196:199], v[204:207], v[152:155]
v_cvt_pk_bf16_f32 v118, v184, v185
v_cvt_pk_bf16_f32 v119, v186, v187
v_mfma_f32_16x16x32_bf16 v[152:155], a[200:203], v[196:199], v[152:155]
v_mfma_f32_16x16x32_bf16 v[152:155], a[204:207], v[192:195], v[152:155]
v_mfma_f32_16x16x32_bf16 v[156:159], a[220:223], v[192:195], 0
v_mfma_f32_16x16x32_bf16 v[156:159], a[216:219], v[196:199], v[156:159]
v_mfma_f32_16x16x32_bf16 v[156:159], a[212:215], v[204:207], v[156:159]
v_mfma_f32_16x16x32_bf16 v[156:159], a[208:211], v[208:211], v[156:159]
v_mfma_f32_16x16x32_bf16 v[160:163], a[224:227], v[208:211], 0
v_mfma_f32_16x16x32_bf16 v[160:163], a[228:231], v[204:207], v[160:163]
v_mfma_f32_16x16x32_bf16 v[160:163], a[232:235], v[196:199], v[160:163]
v_mfma_f32_16x16x32_bf16 v[160:163], a[236:239], v[192:195], v[160:163]
v_mfma_f32_16x16x32_bf16 v[164:167], a[252:255], v[192:195], 0
v_mfma_f32_16x16x32_bf16 v[164:167], a[248:251], v[196:199], v[164:167]
s_add_u32 s48, s48, s51
s_add_u32 m0, s49, 16896
v_mfma_f32_16x16x32_bf16 v[164:167], a[244:247], v[204:207], v[164:167]
buffer_load_dwordx4 v237, s[16:19], s48 offen nt lds
v_mfma_f32_16x16x32_bf16 v[164:167], a[240:243], v[208:211], v[164:167]
v_mfma_f32_16x16x32_bf16 v[184:187], v[0:3], v[112:115], 0
v_mfma_f32_16x16x32_bf16 v[184:187], v[4:7], v[116:119], v[184:187]
s_nop 2
v_mfma_f32_16x16x32_bf16 v[188:191], v[12:15], v[116:119], 0
s_nop 2
v_mfma_f32_16x16x32_bf16 v[188:191], v[8:11], v[112:115], v[188:191]
v_max3_f32 v254, v184, v185, v186
s_nop 0
v_mfma_f32_16x16x32_bf16 v[200:203], v[16:19], v[112:115], 0
s_nop 2
v_mfma_f32_16x16x32_bf16 v[200:203], v[20:23], v[116:119], v[200:203]
s_nop 0
v_max3_f32 v254, v254, v187, v188
v_max3_f32 v254, v254, v189, v190
v_mfma_f32_16x16x32_bf16 v[212:215], v[28:31], v[116:119], 0
s_nop 2
v_mfma_f32_16x16x32_bf16 v[212:215], v[24:27], v[112:115], v[212:215]
v_max3_f32 v254, v254, v191, v200
v_max3_f32 v254, v254, v201, v202
v_mfma_f32_16x16x32_bf16 v[216:219], v[32:35], v[112:115], 0
s_nop 2
v_mfma_f32_16x16x32_bf16 v[216:219], v[36:39], v[116:119], v[216:219]
s_nop 0
v_max3_f32 v254, v254, v203, v212
v_max3_f32 v254, v254, v213, v214
v_mfma_f32_16x16x32_bf16 v[220:223], v[44:47], v[116:119], 0
s_nop 2
v_mfma_f32_16x16x32_bf16 v[220:223], v[40:43], v[112:115], v[220:223]
v_max3_f32 v254, v254, v215, v216
v_max3_f32 v254, v254, v217, v218
v_mfma_f32_16x16x32_bf16 v[224:227], v[48:51], v[112:115], 0
s_nop 2
v_mfma_f32_16x16x32_bf16 v[224:227], v[52:55], v[116:119], v[224:227]
s_nop 0
v_max3_f32 v254, v254, v219, v220
v_max3_f32 v254, v254, v221, v222
v_mfma_f32_16x16x32_bf16 v[228:231], v[208:211], a[128:131], 0
s_nop 2
v_mfma_f32_16x16x32_bf16 v[228:231], v[204:207], a[132:135], v[228:231]
v_max3_f32 v254, v254, v223, v224
v_mfma_f32_16x16x32_bf16 v[228:231], v[196:199], a[136:139], v[228:231]
ds_swizzle_b32 v255, v254 offset:0x401F
v_mfma_f32_16x16x32_bf16 v[228:231], v[192:195], a[140:143], v[228:231]
s_add_u32 m0, s49, 19008
s_add_u32 s48, s48, s51
buffer_load_dwordx4 v237, s[16:19], s48 offen nt lds
v_mfma_f32_16x16x32_bf16 v[232:235], v[192:195], a[156:159], 0
s_nop 2
v_mfma_f32_16x16x32_bf16 v[232:235], v[196:199], a[152:155], v[232:235]
v_cvt_pk_bf16_f32 v91, v230, v231
v_cvt_pk_bf16_f32 v90, v228, v229
v_mfma_f32_16x16x32_bf16 v[232:235], v[204:207], a[148:151], v[232:235]
v_mfma_f32_16x16x32_bf16 v[232:235], v[208:211], a[144:147], v[232:235]
s_nop 2
v_mfma_f32_16x16x32_bf16 v[228:231], v[208:211], a[160:163], 0
s_waitcnt lgkmcnt(0)
v_max_f32 v254, v254, v255
s_nop 0
v_mfma_f32_16x16x32_bf16 v[228:231], v[204:207], a[164:167], v[228:231]
ds_bpermute_b32 v255, v247, v254
v_mfma_f32_16x16x32_bf16 v[228:231], v[196:199], a[168:171], v[228:231]
v_cvt_pk_bf16_f32 v95, v234, v235
v_cvt_pk_bf16_f32 v94, v232, v233
v_mfma_f32_16x16x32_bf16 v[228:231], v[192:195], a[172:175], v[228:231]
s_nop 2
v_mfma_f32_16x16x32_bf16 v[232:235], v[192:195], a[188:191], 0
ds_read_b128 v[192:195], v236 offset:4224
s_nop 0
v_mfma_f32_16x16x32_bf16 v[232:235], v[204:207], a[180:183], v[232:235]
ds_read_b128 v[204:207], v236 offset:4480
v_cvt_pk_bf16_f32 v99, v230, v231
v_mfma_f32_16x16x32_bf16 v[232:235], v[208:211], a[176:179], v[232:235]
ds_read_b128 v[208:211], v236 offset:4736
v_cvt_pk_bf16_f32 v98, v228, v229
v_mfma_f32_16x16x32_bf16 v[232:235], v[196:199], a[184:187], v[232:235]
s_waitcnt lgkmcnt(3)
ds_read_b128 v[196:199], v236 offset:4992
v_max_f32 v254, v254, v255
v_sub_f32 v184, v184, v254
v_sub_f32 v185, v185, v254
v_exp_f32 v184, v184
v_exp_f32 v185, v185
v_sub_f32 v187, v187, v254
v_cvt_pk_bf16_f32 v103, v234, v235
v_cvt_pk_bf16_f32 v102, v232, v233
v_add_f32 v248, v184, v185
v_sub_f32 v186, v186, v254
v_exp_f32 v186, v186
v_cvt_pk_bf16_f32 v120, v184, v185
v_add_f32 v248, v248, v186
s_waitcnt lgkmcnt(1)
v_mfma_f32_16x16x32_bf16 v[228:231], v[208:211], a[184:187], 0
v_sub_f32 v188, v188, v254
s_waitcnt lgkmcnt(0)
v_mfma_f32_16x16x32_bf16 v[228:231], v[196:199], a[188:191], v[228:231]
v_exp_f32 v187, v187
v_mfma_f32_16x16x32_bf16 v[228:231], v[204:207], a[180:183], v[228:231]
v_cvt_pk_bf16_f32 v121, v186, v187
v_add_f32 v248, v248, v187
v_mfma_f32_16x16x32_bf16 v[228:231], v[192:195], a[176:179], v[228:231]
v_sub_f32 v189, v189, v254
v_sub_f32 v190, v190, v254
v_mfma_f32_16x16x32_bf16 v[232:235], v[192:195], a[160:163], 0
v_exp_f32 v189, v189
v_mfma_f32_16x16x32_bf16 v[232:235], v[204:207], a[164:167], v[232:235]
v_exp_f32 v190, v190
v_mfma_f32_16x16x32_bf16 v[232:235], v[208:211], a[168:171], v[232:235]
s_nop 0
v_cvt_pk_bf16_f32 v71, v230, v231
v_cvt_pk_bf16_f32 v70, v228, v229
v_mfma_f32_16x16x32_bf16 v[232:235], v[196:199], a[172:175], v[232:235]
s_add_u32 s48, s48, s51
v_exp_f32 v188, v188
v_mfma_f32_16x16x32_bf16 v[228:231], v[196:199], a[156:159], 0
s_add_u32 m0, s49, 21120
v_add_f32 v248, v248, v188
v_sub_f32 v191, v191, v254
v_mfma_f32_16x16x32_bf16 v[228:231], v[208:211], a[152:155], v[228:231]
buffer_load_dwordx4 v237, s[16:19], s48 offen nt lds
v_cvt_pk_bf16_f32 v66, v232, v233
v_mfma_f32_16x16x32_bf16 v[228:231], v[204:207], a[148:151], v[228:231]
v_cvt_pk_bf16_f32 v67, v234, v235
v_add_f32 v248, v248, v189
v_mfma_f32_16x16x32_bf16 v[228:231], v[192:195], a[144:147], v[228:231]
v_exp_f32 v191, v191
v_mfma_f32_16x16x32_bf16 v[232:235], v[192:195], a[128:131], 0
ds_read_b128 v[192:195], v236 offset:0
v_cvt_pk_bf16_f32 v122, v188, v189
v_mfma_f32_16x16x32_bf16 v[232:235], v[208:211], a[136:139], v[232:235]
ds_read_b128 v[208:211], v236 offset:256
v_add_f32 v248, v248, v190
v_mfma_f32_16x16x32_bf16 v[232:235], v[196:199], a[140:143], v[232:235]
ds_read_b128 v[196:199], v236 offset:512
v_cvt_pk_bf16_f32 v62, v228, v229
v_mfma_f32_16x16x32_bf16 v[232:235], v[204:207], a[132:135], v[232:235]
ds_read_b128 v[204:207], v236 offset:768
v_cvt_pk_bf16_f32 v63, v230, v231
v_add_f32 v248, v248, v191
v_cvt_pk_bf16_f32 v123, v190, v191
v_sub_f32 v200, v200, v254
v_exp_f32 v200, v200
v_sub_f32 v201, v201, v254
v_exp_f32 v201, v201
v_cvt_pk_bf16_f32 v59, v234, v235
v_cvt_pk_bf16_f32 v58, v232, v233
v_sub_f32 v203, v203, v254
s_waitcnt lgkmcnt(2)
v_mfma_f32_16x16x32_bf16 v[228:231], v[208:211], a[132:135], 0
ds_read_b128 v[188:191], v242 offset:64
v_sub_f32 v202, v202, v254
v_mfma_f32_16x16x32_bf16 v[228:231], v[192:195], a[128:131], v[228:231]
s_waitcnt lgkmcnt(2)
v_exp_f32 v203, v203
v_mfma_f32_16x16x32_bf16 v[228:231], v[196:199], a[136:139], v[228:231]
s_waitcnt lgkmcnt(1)
v_exp_f32 v202, v202
v_mfma_f32_16x16x32_bf16 v[228:231], v[204:207], a[140:143], v[228:231]
v_add_f32 v248, v248, v200
v_add_f32 v248, v248, v201
v_mfma_f32_16x16x32_bf16 v[184:187], v[204:207], a[156:159], 0
v_add_f32 v248, v248, v202
v_add_f32 v248, v248, v203
v_mfma_f32_16x16x32_bf16 v[184:187], v[196:199], a[152:155], v[184:187]
v_cvt_pk_bf16_f32 v124, v200, v201
v_cvt_pk_bf16_f32 v125, v202, v203
v_mfma_f32_16x16x32_bf16 v[184:187], v[208:211], a[148:151], v[184:187]
s_waitcnt lgkmcnt(0)
v_cvt_pk_bf16_f32 v56, v228, v229
v_cvt_pk_bf16_f32 v57, v230, v231
v_mfma_f32_16x16x32_bf16 v[184:187], v[192:195], a[144:147], v[184:187]
v_sub_f32 v212, v212, v254
v_sub_f32 v213, v213, v254
v_mfma_f32_16x16x32_bf16 v[228:231], v[192:195], a[160:163], 0
v_exp_f32 v212, v212
v_mfma_f32_16x16x32_bf16 v[228:231], v[208:211], a[164:167], v[228:231]
v_sub_f32 v214, v214, v254
v_add_f32 v248, v248, v212
v_mfma_f32_16x16x32_bf16 v[228:231], v[196:199], a[168:171], v[228:231]
v_cvt_pk_bf16_f32 v60, v184, v185
v_cvt_pk_bf16_f32 v61, v186, v187
v_mfma_f32_16x16x32_bf16 v[228:231], v[204:207], a[172:175], v[228:231]
s_add_u32 m0, s49, 23232
ds_read_b128 v[184:187], v242 offset:0
v_sub_f32 v215, v215, v254
v_mfma_f32_16x16x32_bf16 v[232:235], v[204:207], a[188:191], 0
s_add_u32 s48, s48, s51
buffer_load_dwordx4 v237, s[16:19], s48 offen nt lds
v_sub_f32 v216, v216, v254
v_mfma_f32_16x16x32_bf16 v[232:235], v[196:199], a[184:187], v[232:235]
s_sub_u32 s49, s49, s56
v_exp_f32 v213, v213
v_mfma_f32_16x16x32_bf16 v[232:235], v[208:211], a[180:183], v[232:235]
s_and_b32 s51, s57, 26212352
v_exp_f32 v214, v214
v_mfma_f32_16x16x32_bf16 v[232:235], v[192:195], a[176:179], v[232:235]
s_add_u32 s51, s51, 2048
v_cvt_pk_bf16_f32 v126, v212, v213
v_add_f32 v248, v248, v213
v_mfma_f32_16x16x32_bf16 v[200:203], v[4:7], v[188:191], 0
v_add_f32 v248, v248, v214
s_waitcnt lgkmcnt(0)
v_mfma_f32_16x16x32_bf16 v[200:203], v[0:3], v[184:187], v[200:203]
s_nop 0
v_cvt_pk_bf16_f32 v69, v234, v235
v_cvt_pk_bf16_f32 v68, v232, v233
v_mfma_f32_16x16x32_bf16 v[232:235], v[32:35], v[184:187], 0
ds_read_b128 v[184:187], v245 offset:64
v_sub_f32 v218, v218, v254
v_mfma_f32_16x16x32_bf16 v[232:235], v[36:39], v[188:191], v[232:235]
ds_read_b128 v[188:191], v243 offset:0
v_exp_f32 v215, v215
s_nop 0
v_add_f32 v248, v248, v215
v_cvt_pk_bf16_f32 v127, v214, v215
ds_read_b128 v[212:215], v243 offset:64
v_exp_f32 v216, v216
v_sub_f32 v217, v217, v254
v_add_f32 v248, v248, v216
v_exp_f32 v218, v218
v_sub_f32 v219, v219, v254
v_exp_f32 v217, v217
v_exp_f32 v219, v219
v_cvt_pk_bf16_f32 v128, v216, v217
v_cvt_pk_bf16_f32 v129, v218, v219
v_add_f32 v248, v248, v217
v_add_f32 v248, v248, v218
v_add_f32 v248, v248, v219
v_cvt_pk_bf16_f32 v64, v228, v229
v_cvt_pk_bf16_f32 v65, v230, v231
v_sub_f32 v220, v220, v254
v_sub_f32 v221, v221, v254
s_waitcnt lgkmcnt(0)
v_mfma_f32_16x16x32_bf16 v[200:203], v[12:15], v[212:215], v[200:203]
ds_read_b128 v[216:219], v244 offset:0
ds_read_b128 v[228:231], v245 offset:0
v_mfma_f32_16x16x32_bf16 v[200:203], v[8:11], v[188:191], v[200:203]
v_exp_f32 v220, v220
v_mfma_f32_16x16x32_bf16 v[232:235], v[40:43], v[188:191], v[232:235]
ds_read_b128 v[188:191], v244 offset:64
v_add_f32 v248, v248, v220
v_mfma_f32_16x16x32_bf16 v[232:235], v[44:47], v[212:215], v[232:235]
v_exp_f32 v221, v221
v_sub_f32 v223, v223, v254
v_add_f32 v248, v248, v221
v_exp_f32 v223, v223
v_sub_f32 v222, v222, v254
v_exp_f32 v222, v222
v_cvt_pk_bf16_f32 v130, v220, v221
v_mov_b32 v221, 0xff800000
v_add_f32 v248, v248, v222
v_cvt_pk_bf16_f32 v131, v222, v223
v_add_f32 v248, v248, v223
v_sub_f32 v224, v224, v254
v_exp_f32 v224, v224
s_waitcnt lgkmcnt(0)
v_mfma_f32_16x16x32_bf16 v[200:203], v[20:23], v[188:191], v[200:203]
v_cvt_pk_bf16_f32 v132, v224, 0
v_add_f32 v248, v248, v224
v_mfma_f32_16x16x32_bf16 v[200:203], v[16:19], v[216:219], v[200:203]
ds_swizzle_b32 v250, v248 offset:0x401F
v_add_u32 v245, 0x200, v245
v_mfma_f32_16x16x32_bf16 v[232:235], v[48:51], v[216:219], v[232:235]
v_add_u32 v244, 0x200, v244
v_add_u32 v243, 0x200, v243
v_mfma_f32_16x16x32_bf16 v[232:235], v[52:55], v[188:191], v[232:235]
v_add_u32 v242, 0x200, v242
s_nop 0
v_mfma_f32_16x16x32_bf16 v[200:203], v[24:27], v[228:231], v[200:203]
s_nop 2
v_mfma_f32_16x16x32_bf16 v[200:203], v[28:31], v[184:187], v[200:203]
s_nop 0
v_mov_b32_dpp v233, v221 quad_perm:[0,1,2,3] row_mask:0xf bank_mask:0xc
v_mov_b32_dpp v232, v221 quad_perm:[0,1,2,3] row_mask:0xf bank_mask:0x8
v_mfma_f32_16x16x32_bf16 v[184:187], a[0:3], v[192:195], 0
v_mov_b32_dpp v234, v221 quad_perm:[0,1,2,3] row_mask:0xf bank_mask:0xc
v_mov_b32_dpp v235, v221 quad_perm:[0,1,2,3] row_mask:0xf bank_mask:0xc
v_mfma_f32_16x16x32_bf16 v[184:187], a[4:7], v[208:211], v[184:187]
s_waitcnt lgkmcnt(0)
v_max3_f32 v223, v200, v201, v202
v_max3_f32 v223, v223, v203, v232
v_mfma_f32_16x16x32_bf16 v[184:187], a[8:11], v[196:199], v[184:187]
v_max3_f32 v223, v223, v233, v234
v_max_f32 v223, v223, v235
v_mfma_f32_16x16x32_bf16 v[184:187], a[12:15], v[204:207], v[184:187]
s_nop 0
v_max_f32_dpp v223, v223, v223 row_ror:8 row_mask:0xf bank_mask:0xf
v_add_f32 v248, v248, v250
v_mfma_f32_16x16x32_bf16 v[188:191], a[28:31], v[204:207], 0
ds_bpermute_b32 v250, v247, v248
v_mfma_f32_16x16x32_bf16 v[188:191], a[24:27], v[196:199], v[188:191]
v_max_f32_dpp v223, v223, v223 row_ror:4 row_mask:0xf bank_mask:0xf
v_mfma_f32_16x16x32_bf16 v[188:191], a[20:23], v[208:211], v[188:191]
ds_swizzle_b32 v221, v223 offset:0x401F
v_cvt_pk_bf16_f32 v113, v186, v187
v_mfma_f32_16x16x32_bf16 v[188:191], a[16:19], v[192:195], v[188:191]
v_cvt_pk_bf16_f32 v112, v184, v185
s_nop 0
v_mfma_f32_16x16x32_bf16 v[184:187], a[32:35], v[192:195], 0
s_nop 2
v_mfma_f32_16x16x32_bf16 v[184:187], a[36:39], v[208:211], v[184:187]
s_nop 0
v_cvt_pk_bf16_f32 v115, v190, v191
v_cvt_pk_bf16_f32 v114, v188, v189
v_mfma_f32_16x16x32_bf16 v[184:187], a[40:43], v[196:199], v[184:187]
s_waitcnt lgkmcnt(1)
v_add_f32 v248, v248, v250
v_mfma_f32_16x16x32_bf16 v[184:187], a[44:47], v[204:207], v[184:187]
v_rcp_f32 v251, v248
v_mfma_f32_16x16x32_bf16 v[188:191], a[60:63], v[204:207], 0
s_waitcnt lgkmcnt(0)
v_max_f32 v223, v223, v221
s_nop 0
v_mfma_f32_16x16x32_bf16 v[188:191], a[56:59], v[196:199], v[188:191]
ds_bpermute_b32 v221, v247, v223
v_mfma_f32_16x16x32_bf16 v[188:191], a[52:55], v[208:211], v[188:191]
v_cvt_pk_bf16_f32 v117, v186, v187
v_cvt_pk_bf16_f32 v116, v184, v185
v_mfma_f32_16x16x32_bf16 v[188:191], a[48:51], v[192:195], v[188:191]
s_nop 2
v_mfma_f32_16x16x32_bf16 v[168:171], a[192:195], v[192:195], 0
s_nop 2
v_mfma_f32_16x16x32_bf16 v[168:171], a[196:199], v[208:211], v[168:171]
v_cvt_pk_bf16_f32 v119, v190, v191
v_cvt_pk_bf16_f32 v118, v188, v189
v_mfma_f32_16x16x32_bf16 v[168:171], a[200:203], v[196:199], v[168:171]
v_mfma_f32_16x16x32_bf16 v[168:171], a[204:207], v[204:207], v[168:171]
s_waitcnt lgkmcnt(0)
v_max_f32 v223, v223, v221
v_sub_f32 v200, v200, v223
v_mfma_f32_16x16x32_bf16 v[172:175], a[220:223], v[204:207], 0
v_exp_f32 v200, v200
v_mfma_f32_16x16x32_bf16 v[172:175], a[216:219], v[196:199], v[172:175]
v_sub_f32 v201, v201, v223
v_sub_f32 v202, v202, v223
v_mfma_f32_16x16x32_bf16 v[172:175], a[212:215], v[208:211], v[172:175]
v_exp_f32 v202, v202
v_mfma_f32_16x16x32_bf16 v[172:175], a[208:211], v[192:195], v[172:175]
v_exp_f32 v201, v201
v_mfma_f32_16x16x32_bf16 v[176:179], a[224:227], v[192:195], 0
v_add_f32 v220, v200, v201
v_add_f32 v220, v220, v202
v_mfma_f32_16x16x32_bf16 v[176:179], a[228:231], v[208:211], v[176:179]
v_sub_f32 v203, v203, v223
v_sub_f32 v233, v233, v223
v_mfma_f32_16x16x32_bf16 v[176:179], a[232:235], v[196:199], v[176:179]
v_exp_f32 v233, v233
v_mfma_f32_16x16x32_bf16 v[176:179], a[236:239], v[204:207], v[176:179]
v_exp_f32 v203, v203
v_mfma_f32_16x16x32_bf16 v[180:183], a[252:255], v[204:207], 0
v_sub_f32 v232, v232, v223
v_sub_f32 v234, v234, v223
v_mfma_f32_16x16x32_bf16 v[180:183], a[248:251], v[196:199], v[180:183]
v_exp_f32 v232, v232
v_mfma_f32_16x16x32_bf16 v[180:183], a[244:247], v[208:211], v[180:183]
v_exp_f32 v234, v234
v_mfma_f32_16x16x32_bf16 v[180:183], a[240:243], v[192:195], v[180:183]
v_add_f32 v220, v220, v203
v_add_f32 v220, v220, v232
v_mfma_f32_16x16x32_bf16 v[184:187], v[0:3], v[112:115], 0
v_add_f32 v220, v220, v233
v_add_f32 v220, v220, v234
v_mfma_f32_16x16x32_bf16 v[184:187], v[4:7], v[116:119], v[184:187]
v_sub_f32 v235, v235, v223
v_cvt_pk_bf16_f32 v200, v200, v201
v_mfma_f32_16x16x32_bf16 v[188:191], v[12:15], v[116:119], 0
v_exp_f32 v235, v235
v_mfma_f32_16x16x32_bf16 v[188:191], v[8:11], v[112:115], v[188:191]
v_add_f32 v220, v220, v235
v_cvt_pk_bf16_f32 v201, v202, v203
v_mfma_f32_16x16x32_bf16 v[192:195], v[16:19], v[112:115], 0
v_cvt_pk_bf16_f32 v202, v232, v233
v_cvt_pk_bf16_f32 v203, v234, v235
v_mfma_f32_16x16x32_bf16 v[192:195], v[20:23], v[116:119], v[192:195]
ds_read_b128 v[196:199], v236 offset:8448
v_add_f32_dpp v220, v220, v220 row_ror:8 row_mask:0xf bank_mask:0xf
v_mfma_f32_16x16x32_bf16 v[208:211], v[28:31], v[116:119], 0
ds_read_b128 v[204:207], v236 offset:8704
v_add_f32_dpp v220, v220, v220 row_ror:4 row_mask:0xf bank_mask:0xf
v_mfma_f32_16x16x32_bf16 v[208:211], v[24:27], v[112:115], v[208:211]
ds_write_b32 v246, v220 offset:4096
ds_read_b128 v[212:215], v236 offset:8960
v_mfma_f32_16x16x32_bf16 v[216:219], v[32:35], v[112:115], 0
ds_read_b128 v[224:227], v236 offset:9216
v_max3_f32 v254, v184, v185, v186
v_mfma_f32_16x16x32_bf16 v[216:219], v[36:39], v[116:119], v[216:219]
v_max3_f32 v254, v254, v187, v188
v_max3_f32 v254, v254, v189, v190
v_mfma_f32_16x16x32_bf16 v[228:231], v[44:47], v[116:119], 0
v_max3_f32 v254, v254, v191, v192
v_max3_f32 v254, v254, v193, v194
v_mfma_f32_16x16x32_bf16 v[228:231], v[40:43], v[112:115], v[228:231]
s_waitcnt lgkmcnt(4)
v_max3_f32 v254, v254, v195, v208
v_max3_f32 v254, v254, v209, v210
v_mfma_f32_16x16x32_bf16 v[232:235], v[48:51], v[112:115], 0
s_waitcnt lgkmcnt(3)
v_max3_f32 v254, v254, v211, v216
v_max3_f32 v254, v254, v217, v218
v_mfma_f32_16x16x32_bf16 v[232:235], v[52:55], v[116:119], v[232:235]
s_waitcnt lgkmcnt(1)
v_max3_f32 v254, v254, v219, v228
v_max3_f32 v254, v254, v229, v230
v_mfma_f32_16x16x32_bf16 v[220:223], v[196:199], a[128:131], 0
s_waitcnt lgkmcnt(0)
s_nop 1
v_mfma_f32_16x16x32_bf16 v[220:223], v[204:207], a[132:135], v[220:223]
v_max3_f32 v254, v254, v231, v232
v_mfma_f32_16x16x32_bf16 v[220:223], v[212:215], a[136:139], v[220:223]
ds_swizzle_b32 v255, v254 offset:0x401F
v_mfma_f32_16x16x32_bf16 v[220:223], v[224:227], a[140:143], v[220:223]
s_nop 7
v_cvt_pk_bf16_f32 v73, v222, v223
v_cvt_pk_bf16_f32 v72, v220, v221
v_mfma_f32_16x16x32_bf16 v[220:223], v[224:227], a[156:159], 0
v_mfma_f32_16x16x32_bf16 v[220:223], v[212:215], a[152:155], v[220:223]
v_mfma_f32_16x16x32_bf16 v[220:223], v[204:207], a[148:151], v[220:223]
s_waitcnt lgkmcnt(0)
v_max_f32 v254, v254, v255
v_mfma_f32_16x16x32_bf16 v[220:223], v[196:199], a[144:147], v[220:223]
ds_bpermute_b32 v255, v247, v254
s_nop 6
v_cvt_pk_bf16_f32 v76, v220, v221
v_cvt_pk_bf16_f32 v77, v222, v223
v_mfma_f32_16x16x32_bf16 v[220:223], v[196:199], a[160:163], 0
v_mfma_f32_16x16x32_bf16 v[220:223], v[204:207], a[164:167], v[220:223]
v_mfma_f32_16x16x32_bf16 v[220:223], v[212:215], a[168:171], v[220:223]
s_waitcnt lgkmcnt(0)
v_max_f32 v254, v254, v255
v_mfma_f32_16x16x32_bf16 v[220:223], v[224:227], a[172:175], v[220:223]
v_sub_f32 v184, v184, v254
v_exp_f32 v184, v184
v_sub_f32 v185, v185, v254
v_sub_f32 v187, v187, v254
v_exp_f32 v185, v185
s_nop 2
v_cvt_pk_bf16_f32 v81, v222, v223
v_cvt_pk_bf16_f32 v80, v220, v221
v_mfma_f32_16x16x32_bf16 v[220:223], v[224:227], a[188:191], 0
ds_read_b128 v[224:227], v236 offset:12672
v_add_f32 v249, v184, v185
v_mfma_f32_16x16x32_bf16 v[220:223], v[204:207], a[180:183], v[220:223]
ds_read_b128 v[204:207], v236 offset:12928
v_sub_f32 v186, v186, v254
v_mfma_f32_16x16x32_bf16 v[220:223], v[196:199], a[176:179], v[220:223]
ds_read_b128 v[196:199], v236 offset:13184
v_cvt_pk_bf16_f32 v136, v184, v185
v_mfma_f32_16x16x32_bf16 v[220:223], v[212:215], a[184:187], v[220:223]
ds_read_b128 v[212:215], v236 offset:13440
v_exp_f32 v186, v186
v_exp_f32 v187, v187
v_add_f32 v249, v249, v186
v_add_f32 v249, v249, v187
v_cvt_pk_bf16_f32 v137, v186, v187
v_sub_f32 v189, v189, v254
v_sub_f32 v188, v188, v254
v_cvt_pk_bf16_f32 v84, v220, v221
v_cvt_pk_bf16_f32 v85, v222, v223
v_exp_f32 v188, v188
v_exp_f32 v189, v189
v_sub_f32 v191, v191, v254
s_waitcnt lgkmcnt(1)
v_mfma_f32_16x16x32_bf16 v[184:187], v[196:199], a[184:187], 0
v_sub_f32 v190, v190, v254
s_waitcnt lgkmcnt(0)
v_mfma_f32_16x16x32_bf16 v[184:187], v[212:215], a[188:191], v[184:187]
v_exp_f32 v190, v190
v_mfma_f32_16x16x32_bf16 v[184:187], v[204:207], a[180:183], v[184:187]
v_exp_f32 v191, v191
v_mfma_f32_16x16x32_bf16 v[184:187], v[224:227], a[176:179], v[184:187]
v_add_f32 v249, v249, v188
v_add_f32 v249, v249, v189
v_mfma_f32_16x16x32_bf16 v[220:223], v[224:227], a[160:163], 0
v_add_f32 v249, v249, v190
v_cvt_pk_bf16_f32 v139, v190, v191
v_mfma_f32_16x16x32_bf16 v[220:223], v[204:207], a[164:167], v[220:223]
v_cvt_pk_bf16_f32 v138, v188, v189
v_add_f32 v249, v249, v191
v_mfma_f32_16x16x32_bf16 v[220:223], v[196:199], a[168:171], v[220:223]
v_cvt_pk_bf16_f32 v86, v184, v185
v_cvt_pk_bf16_f32 v87, v186, v187
v_mfma_f32_16x16x32_bf16 v[220:223], v[212:215], a[172:175], v[220:223]
v_sub_f32 v192, v192, v254
v_sub_f32 v194, v194, v254
v_mfma_f32_16x16x32_bf16 v[184:187], v[212:215], a[156:159], 0
v_exp_f32 v192, v192
v_mfma_f32_16x16x32_bf16 v[184:187], v[196:199], a[152:155], v[184:187]
v_add_f32 v249, v249, v192
v_sub_f32 v193, v193, v254
v_mfma_f32_16x16x32_bf16 v[184:187], v[204:207], a[148:151], v[184:187]
v_cvt_pk_bf16_f32 v83, v222, v223
v_cvt_pk_bf16_f32 v82, v220, v221
v_mfma_f32_16x16x32_bf16 v[184:187], v[224:227], a[144:147], v[184:187]
v_exp_f32 v193, v193
v_mfma_f32_16x16x32_bf16 v[220:223], v[224:227], a[128:131], 0
ds_read_b128 v[224:227], v236 offset:16896
v_sub_f32 v209, v209, v254
v_mfma_f32_16x16x32_bf16 v[220:223], v[196:199], a[136:139], v[220:223]
ds_read_b128 v[196:199], v236 offset:17152
v_sub_f32 v208, v208, v254
v_mfma_f32_16x16x32_bf16 v[220:223], v[212:215], a[140:143], v[220:223]
ds_read_b128 v[212:215], v236 offset:17408
v_cvt_pk_bf16_f32 v79, v186, v187
v_mfma_f32_16x16x32_bf16 v[220:223], v[204:207], a[132:135], v[220:223]
ds_read_b128 v[204:207], v236 offset:17664
v_cvt_pk_bf16_f32 v78, v184, v185
v_exp_f32 v208, v208
v_exp_f32 v209, v209
v_exp_f32 v194, v194
v_add_f32 v249, v249, v193
v_add_f32 v249, v249, v194
v_sub_f32 v195, v195, v254
v_cvt_pk_bf16_f32 v74, v220, v221
v_cvt_pk_bf16_f32 v75, v222, v223
s_waitcnt lgkmcnt(2)
v_mfma_f32_16x16x32_bf16 v[184:187], v[196:199], a[132:135], 0
v_exp_f32 v195, v195
v_mfma_f32_16x16x32_bf16 v[184:187], v[224:227], a[128:131], v[184:187]
s_waitcnt lgkmcnt(1)
v_sub_f32 v216, v216, v254
v_sub_f32 v211, v211, v254
v_mfma_f32_16x16x32_bf16 v[184:187], v[212:215], a[136:139], v[184:187]
s_waitcnt lgkmcnt(0)
v_sub_f32 v210, v210, v254
v_add_f32 v249, v249, v195
v_mfma_f32_16x16x32_bf16 v[184:187], v[204:207], a[140:143], v[184:187]
v_exp_f32 v211, v211
v_mfma_f32_16x16x32_bf16 v[220:223], v[204:207], a[156:159], 0
v_exp_f32 v210, v210
v_mfma_f32_16x16x32_bf16 v[220:223], v[212:215], a[152:155], v[220:223]
v_add_f32 v249, v249, v208
v_sub_f32 v219, v219, v254
v_mfma_f32_16x16x32_bf16 v[220:223], v[196:199], a[148:151], v[220:223]
s_nop 0
v_cvt_pk_bf16_f32 v89, v186, v187
v_cvt_pk_bf16_f32 v88, v184, v185
v_mfma_f32_16x16x32_bf16 v[220:223], v[224:227], a[144:147], v[220:223]
v_exp_f32 v216, v216
v_mfma_f32_16x16x32_bf16 v[184:187], v[224:227], a[160:163], 0
v_sub_f32 v217, v217, v254
v_add_f32 v249, v249, v209
v_mfma_f32_16x16x32_bf16 v[184:187], v[196:199], a[164:167], v[184:187]
v_sub_f32 v228, v228, v254
v_add_f32 v249, v249, v210
v_mfma_f32_16x16x32_bf16 v[184:187], v[212:215], a[168:171], v[184:187]
v_exp_f32 v217, v217
v_mfma_f32_16x16x32_bf16 v[184:187], v[204:207], a[172:175], v[184:187]
v_sub_f32 v229, v229, v254
v_sub_f32 v218, v218, v254
v_mfma_f32_16x16x32_bf16 v[188:191], v[204:207], a[188:191], 0
v_exp_f32 v218, v218
v_mfma_f32_16x16x32_bf16 v[188:191], v[212:215], a[184:187], v[188:191]
v_add_f32 v249, v249, v211
v_add_f32 v249, v249, v216
v_mfma_f32_16x16x32_bf16 v[188:191], v[196:199], a[180:183], v[188:191]
v_cvt_pk_bf16_f32 v96, v184, v185
v_cvt_pk_bf16_f32 v97, v186, v187
v_mfma_f32_16x16x32_bf16 v[188:191], v[224:227], a[176:179], v[188:191]
v_exp_f32 v219, v219
v_mfma_f32_16x16x32_bf16 v[184:187], a[0:3], v[224:227], 0
v_add_f32 v249, v249, v217
v_add_f32 v249, v249, v218
v_mfma_f32_16x16x32_bf16 v[184:187], a[4:7], v[196:199], v[184:187]
v_add_f32 v249, v249, v219
v_cvt_pk_bf16_f32 v144, v216, v217
v_mfma_f32_16x16x32_bf16 v[184:187], a[8:11], v[212:215], v[184:187]
v_cvt_pk_bf16_f32 v100, v188, v189
v_cvt_pk_bf16_f32 v101, v190, v191
v_mfma_f32_16x16x32_bf16 v[184:187], a[12:15], v[204:207], v[184:187]
v_cvt_pk_bf16_f32 v145, v218, v219
v_cvt_pk_bf16_f32 v92, v220, v221
v_mfma_f32_16x16x32_bf16 v[188:191], a[28:31], v[204:207], 0
v_cvt_pk_bf16_f32 v93, v222, v223
v_sub_f32 v232, v232, v254
v_mfma_f32_16x16x32_bf16 v[188:191], a[24:27], v[212:215], v[188:191]
v_exp_f32 v228, v228
v_mfma_f32_16x16x32_bf16 v[188:191], a[20:23], v[196:199], v[188:191]
v_cvt_pk_bf16_f32 v112, v184, v185
v_cvt_pk_bf16_f32 v113, v186, v187
v_mfma_f32_16x16x32_bf16 v[188:191], a[16:19], v[224:227], v[188:191]
v_exp_f32 v229, v229
v_mfma_f32_16x16x32_bf16 v[184:187], a[32:35], v[224:227], 0
v_add_f32 v249, v249, v228
v_sub_f32 v231, v231, v254
v_mfma_f32_16x16x32_bf16 v[184:187], a[36:39], v[196:199], v[184:187]
v_exp_f32 v232, v232
v_mfma_f32_16x16x32_bf16 v[184:187], a[40:43], v[212:215], v[184:187]
s_nop 0
v_cvt_pk_bf16_f32 v115, v190, v191
v_cvt_pk_bf16_f32 v114, v188, v189
v_mfma_f32_16x16x32_bf16 v[184:187], a[44:47], v[204:207], v[184:187]
v_sub_f32 v230, v230, v254
v_add_f32 v249, v249, v229
v_mfma_f32_16x16x32_bf16 v[188:191], a[60:63], v[204:207], 0
v_cvt_pk_bf16_f32 v140, v192, v193
v_mov_b32 v192, v202
v_mfma_f32_16x16x32_bf16 v[188:191], a[56:59], v[212:215], v[188:191]
v_cvt_pk_bf16_f32 v142, v208, v209
v_mov_b32_dpp v209, v201 row_ror:8 row_mask:0xf bank_mask:0xf
v_mfma_f32_16x16x32_bf16 v[188:191], a[52:55], v[196:199], v[188:191]
v_cvt_pk_bf16_f32 v116, v184, v185
v_cvt_pk_bf16_f32 v117, v186, v187
v_mfma_f32_16x16x32_bf16 v[188:191], a[48:51], v[224:227], v[188:191]
v_mov_b32_dpp v208, v200 row_ror:8 row_mask:0xf bank_mask:0xf
v_cvt_pk_bf16_f32 v143, v210, v211
v_mfma_f32_16x16x32_bf16 v[216:219], v[56:59], v[120:123], 0
v_mov_b32_dpp v211, v201 row_ror:4 row_mask:0xf bank_mask:0xf
v_mov_b32_dpp v210, v200 row_ror:4 row_mask:0xf bank_mask:0xf
v_mfma_f32_16x16x32_bf16 v[216:219], v[104:107], v[132:135], v[216:219]
v_cvt_pk_bf16_f32 v141, v194, v195
v_mov_b32_dpp v194, v202 row_ror:12 row_mask:0xf bank_mask:0xf
v_mfma_f32_16x16x32_bf16 v[216:219], v[72:75], v[124:127], v[216:219]
v_cvt_pk_bf16_f32 v118, v188, v189
v_cvt_pk_bf16_f32 v119, v190, v191
v_mfma_f32_16x16x32_bf16 v[216:219], v[88:91], v[128:131], v[216:219]
v_mov_b32_dpp v195, v203 row_ror:12 row_mask:0xf bank_mask:0xf
v_mov_b32 v193, v203
v_mfma_f32_16x16x32_bf16 v[220:223], v[92:95], v[128:131], 0
v_mov_b32_dpp v203, v201 row_ror:12 row_mask:0xf bank_mask:0xf
v_mov_b32_dpp v202, v200 row_ror:12 row_mask:0xf bank_mask:0xf
v_mfma_f32_16x16x32_bf16 v[220:223], v[76:79], v[124:127], v[220:223]
v_exp_f32 v230, v230
v_mfma_f32_16x16x32_bf16 v[220:223], v[106:109], v[132:135], v[220:223]
v_fmac_f32 v154, v218, v251
v_fmac_f32 v152, v216, v251
v_mfma_f32_16x16x32_bf16 v[220:223], v[60:63], v[120:123], v[220:223]
v_fmac_f32 v155, v219, v251
v_fmac_f32 v153, v217, v251
v_mfma_f32_16x16x32_bf16 v[188:191], v[64:67], v[120:123], 0
v_exp_f32 v231, v231
v_mfma_f32_16x16x32_bf16 v[188:191], v[108:111], v[132:135], v[188:191]
v_add_f32 v249, v249, v230
v_add_f32 v249, v249, v231
v_mfma_f32_16x16x32_bf16 v[188:191], v[80:83], v[124:127], v[188:191]
v_cvt_pk_bf16_f32 v146, v228, v229
v_cvt_pk_bf16_f32 v147, v230, v231
v_mfma_f32_16x16x32_bf16 v[188:191], v[96:99], v[128:131], v[188:191]
v_add_f32 v249, v249, v232
v_fmac_f32 v156, v220, v251
v_mfma_f32_16x16x32_bf16 v[184:187], v[100:103], v[128:131], 0
ds_swizzle_b32 v250, v249 offset:0x401F
v_fmac_f32 v158, v222, v251
v_mfma_f32_16x16x32_bf16 v[184:187], v[84:87], v[124:127], v[184:187]
v_fmac_f32 v157, v221, v251
v_fmac_f32 v159, v223, v251
v_mfma_f32_16x16x32_bf16 v[184:187], v[68:71], v[120:123], v[184:187]
v_fmac_f32 v161, v189, v251
v_fmac_f32 v160, v188, v251
v_mfma_f32_16x16x32_bf16 v[184:187], v[110:113], v[132:135], v[184:187]
v_mov_b32_dpp v132, v192 row_ror:8 row_mask:0xf bank_mask:0xf
v_fmac_f32 v163, v191, v251
v_fmac_f32 v162, v190, v251
v_mfma_f32_16x16x32_bf16 v[216:219], v[110:113], v[132:135], 0
v_cvt_pk_bf16_f32 v152, v152, v153
v_cvt_pk_bf16_f32 v153, v154, v155
v_mfma_f32_16x16x32_bf16 v[216:219], v[84:87], v[208:211], v[216:219]
s_nop 0
v_fmac_f32 v167, v187, v251
v_fmac_f32 v164, v184, v251
v_mfma_f32_16x16x32_bf16 v[216:219], v[100:103], v[192:195], v[216:219]
s_waitcnt lgkmcnt(0)
v_fmac_f32 v165, v185, v251
v_fmac_f32 v166, v186, v251
v_mfma_f32_16x16x32_bf16 v[216:219], v[68:71], v[200:203], v[216:219]
v_add_f32 v249, v249, v250
v_pk_max_i16 v153, v153, 0
v_mfma_f32_16x16x32_bf16 v[188:191], v[64:67], v[200:203], 0
ds_bpermute_b32 v250, v247, v249
v_mfma_f32_16x16x32_bf16 v[188:191], v[80:83], v[208:211], v[188:191]
v_cvt_pk_bf16_f32 v160, v160, v161
v_cvt_pk_bf16_f32 v161, v162, v163
v_mfma_f32_16x16x32_bf16 v[188:191], v[96:99], v[192:195], v[188:191]
v_cvt_pk_bf16_f32 v216, v216, v217
v_cvt_pk_bf16_f32 v217, v218, v219
v_mfma_f32_16x16x32_bf16 v[188:191], v[108:111], v[132:135], v[188:191]
ds_write_b64 v246, v[216:217] offset:24
v_mfma_f32_16x16x32_bf16 v[228:231], v[106:109], v[132:135], 0
v_cvt_pk_bf16_f32 v162, v164, v165
v_pk_max_i16 v160, v160, 0
v_mfma_f32_16x16x32_bf16 v[228:231], v[76:79], v[208:211], v[228:231]
v_pk_max_i16 v161, v161, 0
v_cvt_pk_bf16_f32 v163, v166, v167
v_mfma_f32_16x16x32_bf16 v[228:231], v[92:95], v[192:195], v[228:231]
s_waitcnt lgkmcnt(1)
v_cvt_pk_bf16_f32 v188, v188, v189
v_cvt_pk_bf16_f32 v189, v190, v191
v_mfma_f32_16x16x32_bf16 v[228:231], v[60:63], v[200:203], v[228:231]
ds_write_b64 v246, v[188:189] offset:16
v_mfma_f32_16x16x32_bf16 v[184:187], v[56:59], v[200:203], 0
v_pk_max_i16 v163, v163, 0
v_cvt_pk_bf16_f32 v155, v158, v159
v_mfma_f32_16x16x32_bf16 v[184:187], v[72:75], v[208:211], v[184:187]
v_pk_max_i16 v162, v162, 0
v_cvt_pk_bf16_f32 v154, v156, v157
v_mfma_f32_16x16x32_bf16 v[184:187], v[88:91], v[192:195], v[184:187]
v_cvt_pk_bf16_f32 v228, v228, v229
v_cvt_pk_bf16_f32 v229, v230, v231
v_mfma_f32_16x16x32_bf16 v[184:187], v[104:107], v[132:135], v[184:187]
ds_write_b64 v246, v[228:229] offset:8
v_mfma_f32_16x16x32_bf16 v[188:191], v[0:3], v[112:115], 0
v_pk_max_i16 v154, v154, 0
v_pk_max_i16 v152, v152, 0
v_mfma_f32_16x16x32_bf16 v[188:191], v[4:7], v[116:119], v[188:191]
v_pk_max_i16 v155, v155, 0
v_add_f32 v249, v249, v250
v_mfma_f32_16x16x32_bf16 v[192:195], v[12:15], v[116:119], 0
buffer_store_dwordx4 v[152:155], v239, s[20:23], s52 offen offset:0 nt
buffer_store_dwordx4 v[160:163], v239, s[20:23], s52 offen offset:64 nt
v_cvt_pk_bf16_f32 v184, v184, v185
v_cvt_pk_bf16_f32 v185, v186, v187
v_rcp_f32 v252, v249
v_max3_f32 v254, v188, v189, v190
v_cvt_pk_bf16_f32 v148, v232, 0
s_add_u32 s52, s46, 16384
v_mfma_f32_16x16x32_bf16 v[192:195], v[8:11], v[112:115], v[192:195]
ds_write_b64 v246, v[184:185] offset:0
v_mfma_f32_16x16x32_bf16 v[200:203], v[16:19], v[112:115], 0
s_nop 0
v_add_u32 v246, 0x200, v246
s_nop 0
v_mfma_f32_16x16x32_bf16 v[200:203], v[20:23], v[116:119], v[200:203]
s_nop 1
v_max3_f32 v254, v254, v191, v192
v_mfma_f32_16x16x32_bf16 v[184:187], v[28:31], v[116:119], 0
v_max3_f32 v254, v254, v193, v194
s_nop 0
v_mfma_f32_16x16x32_bf16 v[184:187], v[24:27], v[112:115], v[184:187]
s_nop 0
v_max3_f32 v254, v254, v195, v200
v_max3_f32 v254, v254, v201, v202
v_mfma_f32_16x16x32_bf16 v[208:211], v[32:35], v[112:115], 0
s_nop 2
v_mfma_f32_16x16x32_bf16 v[208:211], v[36:39], v[116:119], v[208:211]
v_max3_f32 v254, v254, v203, v184
v_max3_f32 v254, v254, v185, v186
v_mfma_f32_16x16x32_bf16 v[216:219], v[44:47], v[116:119], 0
s_nop 2
v_mfma_f32_16x16x32_bf16 v[216:219], v[40:43], v[112:115], v[216:219]
s_nop 0
v_max3_f32 v254, v254, v187, v208
v_max3_f32 v254, v254, v209, v210
v_mfma_f32_16x16x32_bf16 v[220:223], v[48:51], v[112:115], 0
s_nop 2
v_mfma_f32_16x16x32_bf16 v[220:223], v[52:55], v[116:119], v[220:223]
v_max3_f32 v254, v254, v211, v216
v_max3_f32 v254, v254, v217, v218
v_mfma_f32_16x16x32_bf16 v[152:155], a[192:195], v[224:227], 0
s_nop 2
v_mfma_f32_16x16x32_bf16 v[152:155], a[196:199], v[196:199], v[152:155]
s_nop 0
v_max3_f32 v254, v254, v219, v220
v_mfma_f32_16x16x32_bf16 v[152:155], a[200:203], v[212:215], v[152:155]
ds_swizzle_b32 v255, v254 offset:0x401F
v_mfma_f32_16x16x32_bf16 v[152:155], a[204:207], v[204:207], v[152:155]
v_mfma_f32_16x16x32_bf16 v[156:159], a[220:223], v[204:207], 0
v_mfma_f32_16x16x32_bf16 v[156:159], a[216:219], v[212:215], v[156:159]
v_mfma_f32_16x16x32_bf16 v[156:159], a[212:215], v[196:199], v[156:159]
v_mfma_f32_16x16x32_bf16 v[156:159], a[208:211], v[224:227], v[156:159]
v_mfma_f32_16x16x32_bf16 v[160:163], a[224:227], v[224:227], 0
s_waitcnt lgkmcnt(0)
v_max_f32 v254, v254, v255
v_mfma_f32_16x16x32_bf16 v[160:163], a[228:231], v[196:199], v[160:163]
ds_bpermute_b32 v255, v247, v254
v_mfma_f32_16x16x32_bf16 v[160:163], a[232:235], v[212:215], v[160:163]
v_mfma_f32_16x16x32_bf16 v[160:163], a[236:239], v[204:207], v[160:163]
v_mfma_f32_16x16x32_bf16 v[164:167], a[252:255], v[204:207], 0
v_mfma_f32_16x16x32_bf16 v[164:167], a[248:251], v[212:215], v[164:167]
v_mfma_f32_16x16x32_bf16 v[164:167], a[244:247], v[196:199], v[164:167]
v_mfma_f32_16x16x32_bf16 v[164:167], a[240:243], v[224:227], v[164:167]
s_waitcnt lgkmcnt(0)
v_max_f32 v254, v254, v255
v_sub_f32 v188, v188, v254
v_mfma_f32_16x16x32_bf16 v[196:199], v[56:59], v[136:139], 0
v_sub_f32 v190, v190, v254
v_sub_f32 v189, v189, v254
v_mfma_f32_16x16x32_bf16 v[196:199], v[104:107], v[148:151], v[196:199]
v_exp_f32 v189, v189
v_mfma_f32_16x16x32_bf16 v[196:199], v[72:75], v[140:143], v[196:199]
v_exp_f32 v188, v188
v_mfma_f32_16x16x32_bf16 v[196:199], v[88:91], v[144:147], v[196:199]
v_add_f32 v248, v188, v189
v_sub_f32 v191, v191, v254
v_mfma_f32_16x16x32_bf16 v[204:207], v[92:95], v[144:147], 0
v_exp_f32 v191, v191
v_mfma_f32_16x16x32_bf16 v[204:207], v[76:79], v[140:143], v[204:207]
v_exp_f32 v190, v190
v_mfma_f32_16x16x32_bf16 v[204:207], v[106:109], v[148:151], v[204:207]
v_cvt_pk_bf16_f32 v120, v188, v189
v_add_f32 v248, v248, v190
v_mfma_f32_16x16x32_bf16 v[204:207], v[60:63], v[136:139], v[204:207]
ds_read_b128 v[212:215], v236 offset:4224
v_add_f32 v248, v248, v191
v_mfma_f32_16x16x32_bf16 v[228:231], v[64:67], v[136:139], 0
ds_read_b128 v[224:227], v236 offset:4480
v_cvt_pk_bf16_f32 v121, v190, v191
v_mfma_f32_16x16x32_bf16 v[228:231], v[108:111], v[148:151], v[228:231]
v_fmac_f32 v170, v198, v252
v_fmac_f32 v171, v199, v252
v_mfma_f32_16x16x32_bf16 v[228:231], v[80:83], v[140:143], v[228:231]
v_fmac_f32 v168, v196, v252
v_fmac_f32 v169, v197, v252
v_mfma_f32_16x16x32_bf16 v[228:231], v[96:99], v[144:147], v[228:231]
ds_read_b128 v[196:199], v236 offset:4736
v_fmac_f32 v175, v207, v252
v_mfma_f32_16x16x32_bf16 v[232:235], v[100:103], v[144:147], 0
v_fmac_f32 v172, v204, v252
v_fmac_f32 v174, v206, v252
v_mfma_f32_16x16x32_bf16 v[232:235], v[84:87], v[140:143], v[232:235]
s_waitcnt lgkmcnt(2)
v_fmac_f32 v173, v205, v252
v_fmac_f32 v177, v229, v252
v_mfma_f32_16x16x32_bf16 v[232:235], v[110:113], v[148:151], v[232:235]
s_waitcnt lgkmcnt(1)
ds_read_b128 v[204:207], v236 offset:4992
v_fmac_f32 v176, v228, v252
v_mfma_f32_16x16x32_bf16 v[232:235], v[68:71], v[136:139], v[232:235]
v_fmac_f32 v178, v230, v252
v_fmac_f32 v179, v231, v252
v_mfma_f32_16x16x32_bf16 v[188:191], a[0:3], v[212:215], 0
v_cvt_pk_bf16_f32 v176, v176, v177
v_cvt_pk_bf16_f32 v168, v168, v169
v_mfma_f32_16x16x32_bf16 v[188:191], a[4:7], v[224:227], v[188:191]
s_waitcnt lgkmcnt(1)
v_cvt_pk_bf16_f32 v169, v170, v171
v_fmac_f32 v181, v233, v252
v_mfma_f32_16x16x32_bf16 v[188:191], a[8:11], v[196:199], v[188:191]
v_fmac_f32 v182, v234, v252
v_fmac_f32 v180, v232, v252
v_fmac_f32 v183, v235, v252
v_cvt_pk_bf16_f32 v170, v172, v173
v_pk_max_i16 v170, v170, 0
s_waitcnt lgkmcnt(0)
v_mfma_f32_16x16x32_bf16 v[188:191], a[12:15], v[204:207], v[188:191]
v_cvt_pk_bf16_f32 v171, v174, v175
v_pk_max_i16 v176, v176, 0
v_mfma_f32_16x16x32_bf16 v[232:235], a[28:31], v[204:207], 0
v_pk_max_i16 v171, v171, 0
v_cvt_pk_bf16_f32 v177, v178, v179
v_mfma_f32_16x16x32_bf16 v[232:235], a[24:27], v[196:199], v[232:235]
v_cvt_pk_bf16_f32 v178, v180, v181
v_pk_max_i16 v177, v177, 0
v_mfma_f32_16x16x32_bf16 v[232:235], a[20:23], v[224:227], v[232:235]
v_cvt_pk_bf16_f32 v112, v188, v189
v_cvt_pk_bf16_f32 v113, v190, v191
v_mfma_f32_16x16x32_bf16 v[232:235], a[16:19], v[212:215], v[232:235]
v_pk_max_i16 v168, v168, 0
v_cvt_pk_bf16_f32 v179, v182, v183
v_mfma_f32_16x16x32_bf16 v[188:191], a[32:35], v[212:215], 0
v_pk_max_i16 v179, v179, 0
v_pk_max_i16 v169, v169, 0
v_mfma_f32_16x16x32_bf16 v[188:191], a[36:39], v[224:227], v[188:191]
v_pk_max_i16 v178, v178, 0
v_sub_f32 v192, v192, v254
v_mfma_f32_16x16x32_bf16 v[188:191], a[40:43], v[196:199], v[188:191]
buffer_store_dwordx4 v[168:171], v239, s[20:23], s53 offen offset:0 nt
buffer_store_dwordx4 v[176:179], v239, s[20:23], s53 offen offset:64 nt
v_sub_f32 v193, v193, v254
v_exp_f32 v192, v192
v_exp_f32 v193, v193
v_sub_f32 v195, v195, v254
v_exp_f32 v195, v195
v_mfma_f32_16x16x32_bf16 v[188:191], a[44:47], v[204:207], v[188:191]
s_add_u32 s53, s46, 4096
v_add_f32 v248, v248, v192
v_sub_f32 v194, v194, v254
v_mfma_f32_16x16x32_bf16 v[228:231], a[60:63], v[204:207], 0
s_add_u32 s46, s46, 13107200
v_cvt_pk_bf16_f32 v114, v232, v233
v_cvt_pk_bf16_f32 v115, v234, v235
v_mfma_f32_16x16x32_bf16 v[228:231], a[56:59], v[196:199], v[228:231]
v_cvt_pk_bf16_f32 v117, v190, v191
v_cvt_pk_bf16_f32 v116, v188, v189
v_mfma_f32_16x16x32_bf16 v[228:231], a[52:55], v[224:227], v[228:231]
v_exp_f32 v194, v194
v_mfma_f32_16x16x32_bf16 v[228:231], a[48:51], v[212:215], v[228:231]
v_add_f32 v248, v248, v193
v_add_f32 v248, v248, v194
v_mfma_f32_16x16x32_bf16 v[168:171], a[192:195], v[212:215], 0
v_add_f32 v248, v248, v195
v_cvt_pk_bf16_f32 v122, v192, v193
v_mfma_f32_16x16x32_bf16 v[168:171], a[196:199], v[224:227], v[168:171]
v_cvt_pk_bf16_f32 v123, v194, v195
v_sub_f32 v201, v201, v254
v_mfma_f32_16x16x32_bf16 v[168:171], a[200:203], v[196:199], v[168:171]
v_cvt_pk_bf16_f32 v119, v230, v231
v_cvt_pk_bf16_f32 v118, v228, v229
v_mfma_f32_16x16x32_bf16 v[168:171], a[204:207], v[204:207], v[168:171]
v_sub_f32 v202, v202, v254
v_sub_f32 v200, v200, v254
v_mfma_f32_16x16x32_bf16 v[172:175], a[220:223], v[204:207], 0
v_exp_f32 v200, v200
v_mfma_f32_16x16x32_bf16 v[172:175], a[216:219], v[196:199], v[172:175]
v_exp_f32 v202, v202
v_mfma_f32_16x16x32_bf16 v[172:175], a[212:215], v[224:227], v[172:175]
v_exp_f32 v201, v201
v_mfma_f32_16x16x32_bf16 v[172:175], a[208:211], v[212:215], v[172:175]
v_sub_f32 v203, v203, v254
v_add_f32 v248, v248, v200
v_mfma_f32_16x16x32_bf16 v[176:179], a[224:227], v[212:215], 0
v_exp_f32 v203, v203
v_mfma_f32_16x16x32_bf16 v[176:179], a[228:231], v[224:227], v[176:179]
v_cvt_pk_bf16_f32 v125, v202, v203
v_add_f32 v248, v248, v201
v_mfma_f32_16x16x32_bf16 v[176:179], a[232:235], v[196:199], v[176:179]
v_add_f32 v248, v248, v202
v_cvt_pk_bf16_f32 v124, v200, v201
v_mfma_f32_16x16x32_bf16 v[176:179], a[236:239], v[204:207], v[176:179]
v_add_f32 v248, v248, v203
v_sub_f32 v184, v184, v254
v_mfma_f32_16x16x32_bf16 v[180:183], a[252:255], v[204:207], 0
v_sub_f32 v185, v185, v254
v_sub_f32 v187, v187, v254
v_mfma_f32_16x16x32_bf16 v[180:183], a[248:251], v[196:199], v[180:183]
v_sub_f32 v186, v186, v254
v_sub_f32 v220, v220, v254
v_mfma_f32_16x16x32_bf16 v[180:183], a[244:247], v[224:227], v[180:183]
v_exp_f32 v184, v184
v_mfma_f32_16x16x32_bf16 v[180:183], a[240:243], v[212:215], v[180:183]
v_add_f32 v248, v248, v184
v_sub_f32 v216, v216, v254
v_mfma_f32_16x16x32_bf16 v[188:191], v[0:3], v[112:115], 0
v_exp_f32 v187, v187
v_mfma_f32_16x16x32_bf16 v[188:191], v[4:7], v[116:119], v[188:191]
v_exp_f32 v186, v186
v_mfma_f32_16x16x32_bf16 v[192:195], v[12:15], v[116:119], 0
v_exp_f32 v185, v185
v_mfma_f32_16x16x32_bf16 v[192:195], v[8:11], v[112:115], v[192:195]
v_add_f32 v248, v248, v185
v_add_f32 v248, v248, v186
v_mfma_f32_16x16x32_bf16 v[196:199], v[16:19], v[112:115], 0
v_add_f32 v248, v248, v187
v_cvt_pk_bf16_f32 v127, v186, v187
v_mfma_f32_16x16x32_bf16 v[196:199], v[20:23], v[116:119], v[196:199]
v_cvt_pk_bf16_f32 v126, v184, v185
v_sub_f32 v218, v218, v254
v_mfma_f32_16x16x32_bf16 v[200:203], v[28:31], v[116:119], 0
v_exp_f32 v220, v220
v_mfma_f32_16x16x32_bf16 v[200:203], v[24:27], v[112:115], v[200:203]
v_cvt_pk_bf16_f32 v132, v220, 0
v_sub_f32 v217, v217, v254
v_mfma_f32_16x16x32_bf16 v[204:207], v[32:35], v[112:115], 0
v_sub_f32 v211, v211, v254
v_sub_f32 v210, v210, v254
v_mfma_f32_16x16x32_bf16 v[204:207], v[36:39], v[116:119], v[204:207]
v_sub_f32 v219, v219, v254
v_sub_f32 v208, v208, v254
v_mfma_f32_16x16x32_bf16 v[212:215], v[44:47], v[116:119], 0
v_sub_f32 v209, v209, v254
v_max3_f32 v254, v188, v189, v190
v_mfma_f32_16x16x32_bf16 v[212:215], v[40:43], v[112:115], v[212:215]
v_exp_f32 v209, v209
v_mfma_f32_16x16x32_bf16 v[224:227], v[48:51], v[112:115], 0
v_exp_f32 v208, v208
v_mfma_f32_16x16x32_bf16 v[224:227], v[52:55], v[116:119], v[224:227]
v_exp_f32 v217, v217
v_mfma_f32_16x16x32_bf16 v[184:187], v[56:59], v[120:123], 0
v_exp_f32 v210, v210
v_mfma_f32_16x16x32_bf16 v[184:187], v[104:107], v[132:135], v[184:187]
v_exp_f32 v218, v218
v_mfma_f32_16x16x32_bf16 v[184:187], v[72:75], v[124:127], v[184:187]
v_exp_f32 v211, v211
v_exp_f32 v216, v216
v_exp_f32 v219, v219
v_cvt_pk_bf16_f32 v129, v210, v211
v_cvt_pk_bf16_f32 v131, v218, v219
v_cvt_pk_bf16_f32 v130, v216, v217
v_cvt_pk_bf16_f32 v128, v208, v209
v_add_f32 v248, v248, v208
v_add_f32 v248, v248, v209
v_mfma_f32_16x16x32_bf16 v[184:187], v[88:91], v[128:131], v[184:187]
v_add_f32 v248, v248, v210
v_add_f32 v248, v248, v211
v_mfma_f32_16x16x32_bf16 v[208:211], v[92:95], v[128:131], 0
v_max3_f32 v254, v254, v191, v192
v_max3_f32 v254, v254, v193, v194
v_mfma_f32_16x16x32_bf16 v[208:211], v[76:79], v[124:127], v[208:211]
v_max3_f32 v254, v254, v195, v196
v_max3_f32 v254, v254, v197, v198
v_mfma_f32_16x16x32_bf16 v[208:211], v[106:109], v[132:135], v[208:211]
v_max3_f32 v254, v254, v199, v200
v_max3_f32 v254, v254, v201, v202
v_mfma_f32_16x16x32_bf16 v[208:211], v[60:63], v[120:123], v[208:211]
v_max3_f32 v254, v254, v203, v204
v_max3_f32 v254, v254, v205, v206
v_mfma_f32_16x16x32_bf16 v[228:231], v[64:67], v[120:123], 0
v_max3_f32 v254, v254, v207, v212
v_max3_f32 v254, v254, v213, v214
v_mfma_f32_16x16x32_bf16 v[228:231], v[108:111], v[132:135], v[228:231]
v_max3_f32 v254, v254, v215, v224
v_add_f32 v248, v248, v216
v_mfma_f32_16x16x32_bf16 v[228:231], v[80:83], v[124:127], v[228:231]
ds_swizzle_b32 v255, v254 offset:0x401F
v_add_f32 v248, v248, v217
v_mfma_f32_16x16x32_bf16 v[228:231], v[96:99], v[128:131], v[228:231]
v_add_f32 v248, v248, v218
v_add_f32 v248, v248, v219
v_mfma_f32_16x16x32_bf16 v[232:235], v[100:103], v[128:131], 0
ds_read_b128 v[216:219], v236 offset:8448
v_add_f32 v248, v248, v220
v_mfma_f32_16x16x32_bf16 v[232:235], v[84:87], v[124:127], v[232:235]
ds_read_b128 v[220:223], v236 offset:8704
ds_swizzle_b32 v250, v248 offset:0x401F
v_mfma_f32_16x16x32_bf16 v[232:235], v[110:113], v[132:135], v[232:235]
v_mfma_f32_16x16x32_bf16 v[232:235], v[68:71], v[120:123], v[232:235]
s_waitcnt lgkmcnt(3)
v_max_f32 v254, v254, v255
ds_bpermute_b32 v255, v247, v254
s_waitcnt lgkmcnt(1)
v_add_f32 v248, v248, v250
ds_bpermute_b32 v250, v247, v248
s_waitcnt lgkmcnt(1)
v_max_f32 v254, v254, v255
v_sub_f32 v188, v188, v254
v_exp_f32 v188, v188
v_sub_f32 v189, v189, v254
v_sub_f32 v190, v190, v254
v_sub_f32 v191, v191, v254
v_exp_f32 v189, v189
v_exp_f32 v191, v191
v_exp_f32 v190, v190
v_add_f32 v249, v188, v189
v_add_f32 v249, v249, v190
v_add_f32 v249, v249, v191
v_cvt_pk_bf16_f32 v137, v190, v191
v_cvt_pk_bf16_f32 v136, v188, v189
v_mfma_f32_16x16x32_bf16 v[188:191], a[0:3], v[216:219], 0
s_waitcnt lgkmcnt(0)
v_sub_f32 v192, v192, v254
v_sub_f32 v195, v195, v254
v_mfma_f32_16x16x32_bf16 v[188:191], a[4:7], v[220:223], v[188:191]
v_exp_f32 v192, v192
v_sub_f32 v193, v193, v254
v_sub_f32 v194, v194, v254
v_exp_f32 v195, v195
v_exp_f32 v193, v193
v_exp_f32 v194, v194
v_add_f32 v249, v249, v192
v_add_f32 v249, v249, v193
v_add_f32 v249, v249, v194
v_add_f32 v249, v249, v195
v_cvt_pk_bf16_f32 v139, v194, v195
v_cvt_pk_bf16_f32 v138, v192, v193
ds_read_b128 v[192:195], v236 offset:8960
v_sub_f32 v198, v198, v254
v_sub_f32 v197, v197, v254
v_sub_f32 v196, v196, v254
v_exp_f32 v196, v196
v_exp_f32 v198, v198
v_sub_f32 v202, v202, v254
v_sub_f32 v200, v200, v254
v_exp_f32 v197, v197
v_sub_f32 v201, v201, v254
v_sub_f32 v199, v199, v254
v_exp_f32 v199, v199
v_exp_f32 v200, v200
v_add_f32 v249, v249, v196
v_add_f32 v249, v249, v197
v_add_f32 v249, v249, v198
s_waitcnt lgkmcnt(0)
v_mfma_f32_16x16x32_bf16 v[188:191], a[8:11], v[192:195], v[188:191]
v_sub_f32 v203, v203, v254
v_add_f32 v249, v249, v199
v_add_f32 v249, v249, v200
v_exp_f32 v201, v201
v_exp_f32 v202, v202
v_exp_f32 v203, v203
v_sub_f32 v204, v204, v254
v_exp_f32 v204, v204
v_add_f32 v249, v249, v201
v_add_f32 v249, v249, v202
v_add_f32 v249, v249, v203
v_sub_f32 v205, v205, v254
v_sub_f32 v206, v206, v254
v_exp_f32 v205, v205
v_exp_f32 v206, v206
v_add_f32 v249, v249, v204
v_add_f32 v249, v249, v205
v_sub_f32 v207, v207, v254
v_exp_f32 v207, v207
v_add_f32 v249, v249, v206
v_add_f32 v249, v249, v207
v_cvt_pk_bf16_f32 v145, v206, v207
v_cvt_pk_bf16_f32 v144, v204, v205
ds_read_b128 v[204:207], v236 offset:9216
v_add_f32 v248, v248, v250
v_rcp_f32 v251, v248
v_sub_f32 v212, v212, v254
v_fmac_f32 v152, v184, v251
v_fmac_f32 v153, v185, v251
v_fmac_f32 v155, v187, v251
v_fmac_f32 v154, v186, v251
v_fmac_f32 v157, v209, v251
v_fmac_f32 v159, v211, v251
v_fmac_f32 v158, v210, v251
v_fmac_f32 v156, v208, v251
v_exp_f32 v212, v212
v_sub_f32 v213, v213, v254
v_exp_f32 v213, v213
v_sub_f32 v214, v214, v254
v_exp_f32 v214, v214
s_waitcnt lgkmcnt(0)
v_mfma_f32_16x16x32_bf16 v[188:191], a[12:15], v[204:207], v[188:191]
v_sub_f32 v215, v215, v254
v_add_f32 v249, v249, v212
v_mfma_f32_16x16x32_bf16 v[184:187], a[28:31], v[204:207], 0
v_exp_f32 v215, v215
v_mfma_f32_16x16x32_bf16 v[184:187], a[24:27], v[192:195], v[184:187]
v_add_f32 v249, v249, v213
v_add_f32 v249, v249, v214
v_mfma_f32_16x16x32_bf16 v[184:187], a[20:23], v[220:223], v[184:187]
v_add_f32 v249, v249, v215
v_cvt_pk_bf16_f32 v147, v214, v215
v_mfma_f32_16x16x32_bf16 v[184:187], a[16:19], v[216:219], v[184:187]
v_cvt_pk_bf16_f32 v146, v212, v213
v_fmac_f32 v163, v231, v251
v_mfma_f32_16x16x32_bf16 v[208:211], a[32:35], v[216:219], 0
v_fmac_f32 v161, v229, v251
v_cvt_pk_bf16_f32 v152, v152, v153
v_mfma_f32_16x16x32_bf16 v[208:211], a[36:39], v[220:223], v[208:211]
v_fmac_f32 v167, v235, v251
v_fmac_f32 v160, v228, v251
v_mfma_f32_16x16x32_bf16 v[208:211], a[40:43], v[192:195], v[208:211]
v_fmac_f32 v164, v232, v251
v_cvt_pk_bf16_f32 v160, v160, v161
v_mfma_f32_16x16x32_bf16 v[208:211], a[44:47], v[204:207], v[208:211]
v_cvt_pk_bf16_f32 v153, v154, v155
v_cvt_pk_bf16_f32 v154, v156, v157
v_mfma_f32_16x16x32_bf16 v[212:215], a[60:63], v[204:207], 0
v_fmac_f32 v166, v234, v251
v_fmac_f32 v162, v230, v251
v_mfma_f32_16x16x32_bf16 v[212:215], a[56:59], v[192:195], v[212:215]
v_fmac_f32 v165, v233, v251
v_cvt_pk_bf16_f32 v155, v158, v159
v_mfma_f32_16x16x32_bf16 v[212:215], a[52:55], v[220:223], v[212:215]
v_cvt_pk_bf16_f32 v161, v162, v163
v_cvt_pk_bf16_f32 v162, v164, v165
v_mfma_f32_16x16x32_bf16 v[212:215], a[48:51], v[216:219], v[212:215]
v_cvt_pk_bf16_f32 v163, v166, v167
v_pk_max_i16 v162, v162, 0
v_pk_max_i16 v161, v161, 0
v_pk_max_i16 v163, v163, 0
v_pk_max_i16 v153, v153, 0
v_pk_max_i16 v155, v155, 0
v_pk_max_i16 v152, v152, 0
v_pk_max_i16 v160, v160, 0
v_pk_max_i16 v154, v154, 0
buffer_store_dwordx4 v[152:155], v239, s[20:23], s52 offen offset:0 nt
buffer_store_dwordx4 v[160:163], v239, s[20:23], s52 offen offset:64 nt
v_cvt_pk_bf16_f32 v112, v188, v189
v_cvt_pk_bf16_f32 v113, v190, v191
v_cvt_pk_bf16_f32 v114, v184, v185
v_cvt_pk_bf16_f32 v115, v186, v187
v_cvt_pk_bf16_f32 v118, v212, v213
v_cvt_pk_bf16_f32 v119, v214, v215
v_cvt_pk_bf16_f32 v116, v208, v209
v_cvt_pk_bf16_f32 v117, v210, v211
v_mfma_f32_16x16x32_bf16 v[152:155], a[192:195], v[216:219], 0
v_sub_f32 v224, v224, v254
v_cvt_pk_bf16_f32 v142, v200, v201
v_mfma_f32_16x16x32_bf16 v[152:155], a[196:199], v[220:223], v[152:155]
v_exp_f32 v224, v224
v_mfma_f32_16x16x32_bf16 v[152:155], a[200:203], v[192:195], v[152:155]
v_cvt_pk_bf16_f32 v141, v198, v199
v_cvt_pk_bf16_f32 v140, v196, v197
v_mfma_f32_16x16x32_bf16 v[152:155], a[204:207], v[204:207], v[152:155]
v_add_f32 v249, v249, v224
v_cvt_pk_bf16_f32 v143, v202, v203
v_mfma_f32_16x16x32_bf16 v[156:159], a[220:223], v[204:207], 0
ds_swizzle_b32 v250, v249 offset:0x401F
v_cvt_pk_bf16_f32 v148, v224, 0
v_mfma_f32_16x16x32_bf16 v[156:159], a[216:219], v[192:195], v[156:159]
v_mfma_f32_16x16x32_bf16 v[156:159], a[212:215], v[220:223], v[156:159]
v_mfma_f32_16x16x32_bf16 v[156:159], a[208:211], v[216:219], v[156:159]
v_mfma_f32_16x16x32_bf16 v[160:163], a[224:227], v[216:219], 0
v_mfma_f32_16x16x32_bf16 v[160:163], a[228:231], v[220:223], v[160:163]
v_mfma_f32_16x16x32_bf16 v[160:163], a[232:235], v[192:195], v[160:163]
s_waitcnt lgkmcnt(0)
v_add_f32 v249, v249, v250
v_mfma_f32_16x16x32_bf16 v[160:163], a[236:239], v[204:207], v[160:163]
ds_bpermute_b32 v250, v247, v249
v_mfma_f32_16x16x32_bf16 v[164:167], a[252:255], v[204:207], 0
v_mfma_f32_16x16x32_bf16 v[164:167], a[248:251], v[192:195], v[164:167]
v_mfma_f32_16x16x32_bf16 v[164:167], a[244:247], v[220:223], v[164:167]
v_mfma_f32_16x16x32_bf16 v[164:167], a[240:243], v[216:219], v[164:167]
v_mfma_f32_16x16x32_bf16 v[184:187], v[0:3], v[112:115], 0
v_mfma_f32_16x16x32_bf16 v[184:187], v[4:7], v[116:119], v[184:187]
s_waitcnt lgkmcnt(0)
v_add_f32 v249, v249, v250
s_nop 0
v_mfma_f32_16x16x32_bf16 v[188:191], v[12:15], v[116:119], 0
v_rcp_f32 v252, v249
v_mfma_f32_16x16x32_bf16 v[188:191], v[8:11], v[112:115], v[188:191]
s_nop 1
v_max3_f32 v254, v184, v185, v186
v_mfma_f32_16x16x32_bf16 v[192:195], v[16:19], v[112:115], 0
s_nop 2
v_mfma_f32_16x16x32_bf16 v[192:195], v[20:23], v[116:119], v[192:195]
v_max3_f32 v254, v254, v187, v188
v_max3_f32 v254, v254, v189, v190
v_mfma_f32_16x16x32_bf16 v[196:199], v[28:31], v[116:119], 0
s_nop 2
v_mfma_f32_16x16x32_bf16 v[196:199], v[24:27], v[112:115], v[196:199]
s_nop 0
v_max3_f32 v254, v254, v191, v192
v_max3_f32 v254, v254, v193, v194
v_mfma_f32_16x16x32_bf16 v[200:203], v[32:35], v[112:115], 0
s_nop 2
v_mfma_f32_16x16x32_bf16 v[200:203], v[36:39], v[116:119], v[200:203]
v_max3_f32 v254, v254, v195, v196
v_max3_f32 v254, v254, v197, v198
v_mfma_f32_16x16x32_bf16 v[204:207], v[44:47], v[116:119], 0
s_nop 2
v_mfma_f32_16x16x32_bf16 v[204:207], v[40:43], v[112:115], v[204:207]
s_nop 0
v_max3_f32 v254, v254, v199, v200
v_max3_f32 v254, v254, v201, v202
v_mfma_f32_16x16x32_bf16 v[208:211], v[48:51], v[112:115], 0
s_nop 2
v_mfma_f32_16x16x32_bf16 v[208:211], v[52:55], v[116:119], v[208:211]
v_max3_f32 v254, v254, v203, v204
v_max3_f32 v254, v254, v205, v206
v_mfma_f32_16x16x32_bf16 v[212:215], v[56:59], v[136:139], 0
s_nop 2
v_mfma_f32_16x16x32_bf16 v[212:215], v[104:107], v[148:151], v[212:215]
s_nop 0
v_max3_f32 v254, v254, v207, v208
v_mfma_f32_16x16x32_bf16 v[212:215], v[72:75], v[140:143], v[212:215]
ds_swizzle_b32 v255, v254 offset:0x401F
v_mfma_f32_16x16x32_bf16 v[212:215], v[88:91], v[144:147], v[212:215]
s_nop 2
v_mfma_f32_16x16x32_bf16 v[216:219], v[92:95], v[144:147], 0
s_nop 2
v_mfma_f32_16x16x32_bf16 v[216:219], v[76:79], v[140:143], v[216:219]
v_fmac_f32 v169, v213, v252
v_fmac_f32 v168, v212, v252
v_mfma_f32_16x16x32_bf16 v[216:219], v[106:109], v[148:151], v[216:219]
v_fmac_f32 v171, v215, v252
v_fmac_f32 v170, v214, v252
v_mfma_f32_16x16x32_bf16 v[216:219], v[60:63], v[136:139], v[216:219]
ds_read_b128 v[220:223], v236 offset:12672
ds_read_b128 v[224:227], v236 offset:12928
v_mfma_f32_16x16x32_bf16 v[228:231], v[64:67], v[136:139], 0
s_waitcnt lgkmcnt(2)
ds_read_b128 v[212:215], v236 offset:13184
v_cvt_pk_bf16_f32 v168, v168, v169
v_mfma_f32_16x16x32_bf16 v[228:231], v[108:111], v[148:151], v[228:231]
s_nop 0
v_fmac_f32 v172, v216, v252
v_fmac_f32 v174, v218, v252
v_mfma_f32_16x16x32_bf16 v[228:231], v[80:83], v[140:143], v[228:231]
v_fmac_f32 v173, v217, v252
v_fmac_f32 v175, v219, v252
v_mfma_f32_16x16x32_bf16 v[228:231], v[96:99], v[144:147], v[228:231]
ds_read_b128 v[216:219], v236 offset:13440
v_cvt_pk_bf16_f32 v169, v170, v171
v_mfma_f32_16x16x32_bf16 v[232:235], v[100:103], v[144:147], 0
v_cvt_pk_bf16_f32 v170, v172, v173
v_cvt_pk_bf16_f32 v171, v174, v175
v_mfma_f32_16x16x32_bf16 v[232:235], v[84:87], v[140:143], v[232:235]
s_waitcnt lgkmcnt(2)
v_pk_max_i16 v170, v170, 0
v_fmac_f32 v178, v230, v252
v_mfma_f32_16x16x32_bf16 v[232:235], v[110:113], v[148:151], v[232:235]
s_waitcnt lgkmcnt(1)
v_fmac_f32 v179, v231, v252
v_fmac_f32 v176, v228, v252
v_mfma_f32_16x16x32_bf16 v[232:235], v[68:71], v[136:139], v[232:235]
v_fmac_f32 v177, v229, v252
v_cvt_pk_bf16_f32 v176, v176, v177
v_mfma_f32_16x16x32_bf16 v[228:231], a[0:3], v[220:223], 0
v_cvt_pk_bf16_f32 v177, v178, v179
v_pk_max_i16 v169, v169, 0
v_mfma_f32_16x16x32_bf16 v[228:231], a[4:7], v[224:227], v[228:231]
s_waitcnt lgkmcnt(0)
v_pk_max_i16 v171, v171, 0
v_fmac_f32 v182, v234, v252
v_mfma_f32_16x16x32_bf16 v[228:231], a[8:11], v[212:215], v[228:231]
v_fmac_f32 v181, v233, v252
v_fmac_f32 v183, v235, v252
v_mfma_f32_16x16x32_bf16 v[228:231], a[12:15], v[216:219], v[228:231]
v_fmac_f32 v180, v232, v252
v_cvt_pk_bf16_f32 v179, v182, v183
v_mfma_f32_16x16x32_bf16 v[232:235], a[28:31], v[216:219], 0
v_cvt_pk_bf16_f32 v178, v180, v181
v_pk_max_i16 v178, v178, 0
v_mfma_f32_16x16x32_bf16 v[232:235], a[24:27], v[212:215], v[232:235]
v_pk_max_i16 v179, v179, 0
v_pk_max_i16 v176, v176, 0
v_mfma_f32_16x16x32_bf16 v[232:235], a[20:23], v[224:227], v[232:235]
v_cvt_pk_bf16_f32 v113, v230, v231
v_cvt_pk_bf16_f32 v112, v228, v229
v_mfma_f32_16x16x32_bf16 v[232:235], a[16:19], v[220:223], v[232:235]
v_pk_max_i16 v168, v168, 0
v_pk_max_i16 v177, v177, 0
v_mfma_f32_16x16x32_bf16 v[228:231], a[32:35], v[220:223], 0
buffer_store_dwordx4 v[168:171], v239, s[20:23], s53 offen offset:0 nt
buffer_store_dwordx4 v[176:179], v239, s[20:23], s53 offen offset:64 nt
v_add_u32 v236, s56, v236
v_max_f32 v254, v254, v255
s_sub_u32 s56, 0, s56
v_cvt_pk_bf16_f32 v115, v234, v235
v_cvt_pk_bf16_f32 v114, v232, v233
v_mfma_f32_16x16x32_bf16 v[228:231], a[36:39], v[224:227], v[228:231]
ds_bpermute_b32 v255, v247, v254
v_mfma_f32_16x16x32_bf16 v[228:231], a[40:43], v[212:215], v[228:231]
v_mfma_f32_16x16x32_bf16 v[228:231], a[44:47], v[216:219], v[228:231]
s_nop 2
v_mfma_f32_16x16x32_bf16 v[232:235], a[60:63], v[216:219], 0
s_nop 2
v_mfma_f32_16x16x32_bf16 v[232:235], a[56:59], v[212:215], v[232:235]
v_cvt_pk_bf16_f32 v116, v228, v229
v_cvt_pk_bf16_f32 v117, v230, v231
v_mfma_f32_16x16x32_bf16 v[232:235], a[52:55], v[224:227], v[232:235]
v_mfma_f32_16x16x32_bf16 v[232:235], a[48:51], v[220:223], v[232:235]
s_waitcnt lgkmcnt(0)
v_max_f32 v254, v254, v255
v_sub_f32 v184, v184, v254
v_mfma_f32_16x16x32_bf16 v[168:171], a[192:195], v[220:223], 0
v_exp_f32 v184, v184
v_mfma_f32_16x16x32_bf16 v[168:171], a[196:199], v[224:227], v[168:171]
v_sub_f32 v185, v185, v254
v_sub_f32 v186, v186, v254
v_mfma_f32_16x16x32_bf16 v[168:171], a[200:203], v[212:215], v[168:171]
v_cvt_pk_bf16_f32 v119, v234, v235
v_cvt_pk_bf16_f32 v118, v232, v233
v_mfma_f32_16x16x32_bf16 v[168:171], a[204:207], v[216:219], v[168:171]
v_exp_f32 v186, v186
v_mfma_f32_16x16x32_bf16 v[172:175], a[220:223], v[216:219], 0
v_exp_f32 v185, v185
v_mfma_f32_16x16x32_bf16 v[172:175], a[216:219], v[212:215], v[172:175]
v_sub_f32 v189, v189, v254
v_sub_f32 v187, v187, v254
v_mfma_f32_16x16x32_bf16 v[172:175], a[212:215], v[224:227], v[172:175]
v_sub_f32 v188, v188, v254
v_sub_f32 v190, v190, v254
v_mfma_f32_16x16x32_bf16 v[172:175], a[208:211], v[220:223], v[172:175]
s_cmp_lg_u32 s45, 0
s_cbranch_scc1 L_loops
v_mfma_f32_16x16x32_bf16 v[176:179], a[224:227], v[220:223], 0
s_waitcnt vmcnt(8)
s_barrier
v_mfma_f32_16x16x32_bf16 v[176:179], a[228:231], v[224:227], v[176:179]
s_add_u32 s52, s47, 8192
ds_read_b128 v[232:235], v236 offset:0
v_add_f32 v248, v184, v185
v_mfma_f32_16x16x32_bf16 v[176:179], a[232:235], v[212:215], v[176:179]
s_add_u32 s53, s47, 12288
v_exp_f32 v188, v188
v_mfma_f32_16x16x32_bf16 v[176:179], a[236:239], v[216:219], v[176:179]
v_add_f32 v248, v248, v186
v_sub_f32 v191, v191, v254
v_mfma_f32_16x16x32_bf16 v[180:183], a[252:255], v[216:219], 0
v_exp_f32 v187, v187
v_mfma_f32_16x16x32_bf16 v[180:183], a[248:251], v[212:215], v[180:183]
v_exp_f32 v190, v190
v_mfma_f32_16x16x32_bf16 v[180:183], a[244:247], v[224:227], v[180:183]
v_add_f32 v248, v248, v187
v_add_f32 v248, v248, v188
v_mfma_f32_16x16x32_bf16 v[180:183], a[240:243], v[220:223], v[180:183]
s_waitcnt lgkmcnt(0)
v_exp_f32 v189, v189
v_mfma_f32_16x16x32_bf16 v[228:231], v[0:3], v[112:115], 0
v_add_f32 v248, v248, v189
v_add_f32 v248, v248, v190
v_mfma_f32_16x16x32_bf16 v[228:231], v[4:7], v[116:119], v[228:231]
v_exp_f32 v191, v191
v_cvt_pk_bf16_f32 v122, v188, v189
v_add_f32 v248, v248, v191
v_cvt_pk_bf16_f32 v123, v190, v191
v_mfma_f32_16x16x32_bf16 v[188:191], v[12:15], v[116:119], 0
v_sub_f32 v193, v193, v254
v_sub_f32 v194, v194, v254
v_mfma_f32_16x16x32_bf16 v[188:191], v[8:11], v[112:115], v[188:191]
v_sub_f32 v195, v195, v254
v_exp_f32 v194, v194
v_sub_f32 v192, v192, v254
v_exp_f32 v192, v192
v_sub_f32 v196, v196, v254
v_exp_f32 v193, v193
v_sub_f32 v197, v197, v254
v_sub_f32 v199, v199, v254
v_sub_f32 v198, v198, v254
v_exp_f32 v195, v195
v_add_f32 v248, v248, v192
v_add_f32 v248, v248, v193
v_exp_f32 v196, v196
v_exp_f32 v197, v197
v_add_f32 v248, v248, v194
v_add_f32 v248, v248, v195
v_add_f32 v248, v248, v196
v_add_f32 v248, v248, v197
v_exp_f32 v198, v198
v_sub_f32 v200, v200, v254
v_sub_f32 v203, v203, v254
v_exp_f32 v199, v199
v_sub_f32 v201, v201, v254
v_exp_f32 v201, v201
v_sub_f32 v202, v202, v254
v_exp_f32 v202, v202
v_add_f32 v248, v248, v198
v_exp_f32 v200, v200
v_add_f32 v248, v248, v199
v_add_f32 v248, v248, v200
v_add_f32 v248, v248, v201
v_exp_f32 v203, v203
v_add_f32 v248, v248, v202
v_add_f32 v248, v248, v203
v_cvt_pk_bf16_f32 v128, v200, v201
v_cvt_pk_bf16_f32 v129, v202, v203
v_mfma_f32_16x16x32_bf16 v[200:203], v[16:19], v[112:115], 0
v_sub_f32 v204, v204, v254
v_sub_f32 v205, v205, v254
v_mfma_f32_16x16x32_bf16 v[200:203], v[20:23], v[116:119], v[200:203]
v_exp_f32 v204, v204
v_sub_f32 v206, v206, v254
v_add_f32 v248, v248, v204
v_exp_f32 v206, v206
v_sub_f32 v207, v207, v254
v_exp_f32 v205, v205
v_exp_f32 v207, v207
v_add_f32 v248, v248, v205
v_add_f32 v248, v248, v206
v_add_f32 v248, v248, v207
v_cvt_pk_bf16_f32 v130, v204, v205
v_cvt_pk_bf16_f32 v131, v206, v207
v_mfma_f32_16x16x32_bf16 v[204:207], v[28:31], v[116:119], 0
v_sub_f32 v208, v208, v254
v_cvt_pk_bf16_f32 v120, v184, v185
v_mfma_f32_16x16x32_bf16 v[204:207], v[24:27], v[112:115], v[204:207]
v_exp_f32 v208, v208
s_nop 0
v_add_f32 v248, v248, v208
v_cvt_pk_bf16_f32 v132, v208, 0
v_mfma_f32_16x16x32_bf16 v[208:211], v[32:35], v[112:115], 0
ds_swizzle_b32 v250, v248 offset:0x401F
v_cvt_pk_bf16_f32 v121, v186, v187
v_mfma_f32_16x16x32_bf16 v[208:211], v[36:39], v[116:119], v[208:211]
ds_read_b128 v[184:187], v236 offset:256
v_cvt_pk_bf16_f32 v126, v196, v197
v_mfma_f32_16x16x32_bf16 v[212:215], v[44:47], v[116:119], 0
v_cvt_pk_bf16_f32 v125, v194, v195
v_cvt_pk_bf16_f32 v127, v198, v199
v_mfma_f32_16x16x32_bf16 v[212:215], v[40:43], v[112:115], v[212:215]
ds_read_b128 v[196:199], v236 offset:768
v_cvt_pk_bf16_f32 v124, v192, v193
v_mfma_f32_16x16x32_bf16 v[216:219], v[48:51], v[112:115], 0
ds_read_b128 v[192:195], v236 offset:512
v_max3_f32 v254, v228, v229, v230
v_mfma_f32_16x16x32_bf16 v[216:219], v[52:55], v[116:119], v[216:219]
v_max3_f32 v254, v254, v231, v188
v_max3_f32 v254, v254, v189, v190
v_mfma_f32_16x16x32_bf16 v[220:223], v[56:59], v[120:123], 0
s_waitcnt lgkmcnt(3)
v_add_f32 v248, v248, v250
v_max3_f32 v254, v254, v191, v200
v_mfma_f32_16x16x32_bf16 v[220:223], v[104:107], v[132:135], v[220:223]
s_waitcnt lgkmcnt(2)
ds_bpermute_b32 v250, v247, v248
v_mfma_f32_16x16x32_bf16 v[220:223], v[72:75], v[124:127], v[220:223]
v_max3_f32 v254, v254, v201, v202
v_max3_f32 v254, v254, v203, v204
v_mfma_f32_16x16x32_bf16 v[220:223], v[88:91], v[128:131], v[220:223]
s_waitcnt lgkmcnt(2)
v_max3_f32 v254, v254, v205, v206
v_max3_f32 v254, v254, v207, v208
v_mfma_f32_16x16x32_bf16 v[224:227], v[92:95], v[128:131], 0
s_waitcnt lgkmcnt(1)
v_max3_f32 v254, v254, v209, v210
v_max3_f32 v254, v254, v211, v212
v_mfma_f32_16x16x32_bf16 v[224:227], v[76:79], v[124:127], v[224:227]
v_max3_f32 v254, v254, v213, v214
v_max3_f32 v254, v254, v215, v216
v_mfma_f32_16x16x32_bf16 v[224:227], v[106:109], v[132:135], v[224:227]
ds_swizzle_b32 v255, v254 offset:0x401F
v_mbcnt_lo_u32_b32 v242, -1, 0
v_mfma_f32_16x16x32_bf16 v[224:227], v[60:63], v[120:123], v[224:227]
s_waitcnt lgkmcnt(1)
v_add_f32 v248, v248, v250
v_rcp_f32 v251, v248
s_nop 0
v_fmac_f32 v152, v220, v251
v_fmac_f32 v153, v221, v251
v_fmac_f32 v154, v222, v251
v_fmac_f32 v155, v223, v251
v_mfma_f32_16x16x32_bf16 v[220:223], v[64:67], v[120:123], 0
v_fmac_f32 v156, v224, v251
v_fmac_f32 v157, v225, v251
v_mfma_f32_16x16x32_bf16 v[220:223], v[108:111], v[132:135], v[220:223]
v_fmac_f32 v158, v226, v251
v_fmac_f32 v159, v227, v251
v_mfma_f32_16x16x32_bf16 v[220:223], v[80:83], v[124:127], v[220:223]
s_waitcnt lgkmcnt(0)
v_cvt_pk_bf16_f32 v152, v152, v153
v_cvt_pk_bf16_f32 v153, v154, v155
v_mfma_f32_16x16x32_bf16 v[220:223], v[96:99], v[128:131], v[220:223]
v_cvt_pk_bf16_f32 v154, v156, v157
v_cvt_pk_bf16_f32 v155, v158, v159
v_mfma_f32_16x16x32_bf16 v[224:227], v[100:103], v[128:131], 0
v_pk_max_i16 v152, v152, 0
v_pk_max_i16 v153, v153, 0
v_mfma_f32_16x16x32_bf16 v[224:227], v[84:87], v[124:127], v[224:227]
v_max_f32 v254, v254, v255
v_pk_max_i16 v154, v154, 0
v_mfma_f32_16x16x32_bf16 v[224:227], v[110:113], v[132:135], v[224:227]
ds_bpermute_b32 v255, v247, v254
v_mfma_f32_16x16x32_bf16 v[224:227], v[68:71], v[120:123], v[224:227]
v_fmac_f32 v160, v220, v251
v_fmac_f32 v161, v221, v251
v_mfma_f32_16x16x32_bf16 v[0:3], a[192:195], v[232:235], 0
v_fmac_f32 v162, v222, v251
v_fmac_f32 v163, v223, v251
v_mfma_f32_16x16x32_bf16 v[0:3], a[196:199], v[184:187], v[0:3]
v_cvt_pk_bf16_f32 v160, v160, v161
v_cvt_pk_bf16_f32 v161, v162, v163
v_mfma_f32_16x16x32_bf16 v[0:3], a[200:203], v[192:195], v[0:3]
v_fmac_f32 v164, v224, v251
v_fmac_f32 v165, v225, v251
v_mfma_f32_16x16x32_bf16 v[0:3], a[204:207], v[196:199], v[0:3]
v_fmac_f32 v166, v226, v251
v_fmac_f32 v167, v227, v251
v_mfma_f32_16x16x32_bf16 v[4:7], a[220:223], v[196:199], 0
s_waitcnt lgkmcnt(0)
v_max_f32 v254, v254, v255
v_sub_f32 v228, v228, v254
v_mfma_f32_16x16x32_bf16 v[4:7], a[216:219], v[192:195], v[4:7]
v_sub_f32 v229, v229, v254
v_sub_f32 v230, v230, v254
v_mfma_f32_16x16x32_bf16 v[4:7], a[212:215], v[184:187], v[4:7]
v_exp_f32 v228, v228
v_mfma_f32_16x16x32_bf16 v[4:7], a[208:211], v[232:235], v[4:7]
ds_read_b128 v[220:223], v236 offset:4224
v_sub_f32 v231, v231, v254
v_mfma_f32_16x16x32_bf16 v[8:11], a[224:227], v[232:235], 0
v_exp_f32 v229, v229
v_mfma_f32_16x16x32_bf16 v[8:11], a[228:231], v[184:187], v[8:11]
v_exp_f32 v230, v230
v_mfma_f32_16x16x32_bf16 v[8:11], a[232:235], v[192:195], v[8:11]
v_exp_f32 v231, v231
v_mfma_f32_16x16x32_bf16 v[8:11], a[236:239], v[196:199], v[8:11]
v_add_f32 v249, v228, v229
v_add_f32 v249, v249, v230
v_mfma_f32_16x16x32_bf16 v[12:15], a[252:255], v[196:199], 0
ds_read_b128 v[196:199], v236 offset:4736
v_add_f32 v249, v249, v231
v_mfma_f32_16x16x32_bf16 v[12:15], a[248:251], v[192:195], v[12:15]
s_waitcnt lgkmcnt(1)
ds_read_b128 v[192:195], v236 offset:4992
v_cvt_pk_bf16_f32 v136, v228, v229
v_mfma_f32_16x16x32_bf16 v[12:15], a[244:247], v[184:187], v[12:15]
v_cvt_pk_bf16_f32 v137, v230, v231
v_sub_f32 v188, v188, v254
v_mfma_f32_16x16x32_bf16 v[12:15], a[240:243], v[232:235], v[12:15]
ds_read_b128 v[228:231], v236 offset:4480
v_sub_f32 v189, v189, v254
v_mfma_f32_16x16x32_bf16 v[16:19], a[192:195], v[220:223], 0
v_exp_f32 v188, v188
v_exp_f32 v189, v189
v_sub_f32 v190, v190, v254
v_cvt_pk_bf16_f32 v138, v188, v189
v_sub_f32 v191, v191, v254
v_exp_f32 v190, v190
v_exp_f32 v191, v191
v_sub_f32 v216, v216, v254
v_cvt_pk_bf16_f32 v139, v190, v191
v_exp_f32 v216, v216
v_sub_f32 v200, v200, v254
v_cvt_pk_bf16_f32 v148, v216, 0
s_waitcnt lgkmcnt(0)
v_mfma_f32_16x16x32_bf16 v[16:19], a[196:199], v[228:231], v[16:19]
v_sub_f32 v201, v201, v254
v_sub_f32 v202, v202, v254
v_mfma_f32_16x16x32_bf16 v[16:19], a[200:203], v[196:199], v[16:19]
v_exp_f32 v200, v200
v_mfma_f32_16x16x32_bf16 v[16:19], a[204:207], v[192:195], v[16:19]
v_exp_f32 v201, v201
v_mfma_f32_16x16x32_bf16 v[20:23], a[220:223], v[192:195], 0
v_exp_f32 v202, v202
v_mfma_f32_16x16x32_bf16 v[20:23], a[216:219], v[196:199], v[20:23]
v_sub_f32 v203, v203, v254
v_sub_f32 v204, v204, v254
v_mfma_f32_16x16x32_bf16 v[20:23], a[212:215], v[228:231], v[20:23]
v_exp_f32 v203, v203
v_mfma_f32_16x16x32_bf16 v[20:23], a[208:211], v[220:223], v[20:23]
v_exp_f32 v204, v204
v_mfma_f32_16x16x32_bf16 v[24:27], a[224:227], v[220:223], 0
v_sub_f32 v205, v205, v254
v_sub_f32 v206, v206, v254
v_mfma_f32_16x16x32_bf16 v[24:27], a[228:231], v[228:231], v[24:27]
v_exp_f32 v205, v205
v_mfma_f32_16x16x32_bf16 v[24:27], a[232:235], v[196:199], v[24:27]
v_exp_f32 v206, v206
v_mfma_f32_16x16x32_bf16 v[24:27], a[236:239], v[192:195], v[24:27]
v_sub_f32 v207, v207, v254
v_cvt_pk_bf16_f32 v140, v200, v201
v_mfma_f32_16x16x32_bf16 v[28:31], a[252:255], v[192:195], 0
v_exp_f32 v207, v207
v_mfma_f32_16x16x32_bf16 v[28:31], a[248:251], v[196:199], v[28:31]
v_cvt_pk_bf16_f32 v141, v202, v203
v_cvt_pk_bf16_f32 v142, v204, v205
v_mfma_f32_16x16x32_bf16 v[28:31], a[244:247], v[228:231], v[28:31]
v_cvt_pk_bf16_f32 v143, v206, v207
v_sub_f32 v208, v208, v254
v_mfma_f32_16x16x32_bf16 v[28:31], a[240:243], v[220:223], v[28:31]
v_sub_f32 v209, v209, v254
v_sub_f32 v210, v210, v254
v_mfma_f32_16x16x32_bf16 v[228:231], v[56:59], v[136:139], 0
v_exp_f32 v208, v208
v_mfma_f32_16x16x32_bf16 v[228:231], v[104:107], v[148:151], v[228:231]
v_exp_f32 v209, v209
v_mfma_f32_16x16x32_bf16 v[228:231], v[72:75], v[140:143], v[228:231]
v_exp_f32 v210, v210
v_sub_f32 v211, v211, v254
v_exp_f32 v211, v211
v_sub_f32 v212, v212, v254
v_exp_f32 v212, v212
v_sub_f32 v213, v213, v254
v_exp_f32 v213, v213
v_sub_f32 v214, v214, v254
v_exp_f32 v214, v214
v_sub_f32 v215, v215, v254
v_exp_f32 v215, v215
v_cvt_pk_bf16_f32 v144, v208, v209
v_cvt_pk_bf16_f32 v145, v210, v211
v_cvt_pk_bf16_f32 v146, v212, v213
v_cvt_pk_bf16_f32 v147, v214, v215
v_cvt_pk_bf16_f32 v162, v164, v165
v_cvt_pk_bf16_f32 v163, v166, v167
v_mfma_f32_16x16x32_bf16 v[228:231], v[88:91], v[144:147], v[228:231]
v_pk_max_i16 v155, v155, 0
v_pk_max_i16 v160, v160, 0
v_mfma_f32_16x16x32_bf16 v[192:195], v[92:95], v[144:147], 0
v_pk_max_i16 v161, v161, 0
v_pk_max_i16 v162, v162, 0
v_mfma_f32_16x16x32_bf16 v[192:195], v[76:79], v[140:143], v[192:195]
v_pk_max_i16 v163, v163, 0
v_mbcnt_hi_u32_b32 v242, -1, v242
v_mfma_f32_16x16x32_bf16 v[192:195], v[106:109], v[148:151], v[192:195]
buffer_store_dwordx4 v[152:155], v239, s[20:23], s52 offen offset:0 nt
buffer_store_dwordx4 v[160:163], v239, s[20:23], s52 offen offset:64 nt
s_mul_i32 s54, s41, 12288
s_add_u32 s54, s54, 105472
v_mov_b32 v244, s54
v_bfe_u32 v243, v242, 0, 4
v_lshl_add_u32 v244, v243, 7, v244
v_lshlrev_b32 v243, 4, v242
v_xor_b32 v243, v243, v242
v_and_b32 v243, 48, v243
v_mfma_f32_16x16x32_bf16 v[192:195], v[60:63], v[136:139], v[192:195]
v_add_u32 v244, v243, v244
v_add_u32 v244, v243, v244
v_mfma_f32_16x16x32_bf16 v[220:223], v[64:67], v[136:139], 0
ds_read_b128 v[184:187], v244 offset:0
ds_read_b128 v[232:235], v244 offset:16
v_mfma_f32_16x16x32_bf16 v[220:223], v[108:111], v[148:151], v[220:223]
ds_read_b128 v[196:199], v244 offset:2048
v_add_f32 v249, v249, v188
v_mfma_f32_16x16x32_bf16 v[220:223], v[80:83], v[140:143], v[220:223]
ds_read_b32 v188, v244 offset:4096
v_add_f32 v249, v249, v189
v_mfma_f32_16x16x32_bf16 v[220:223], v[96:99], v[144:147], v[220:223]
v_add_f32 v249, v249, v190
v_add_f32 v249, v249, v191
v_mfma_f32_16x16x32_bf16 v[224:227], v[100:103], v[144:147], 0
v_mov_b32 v245, 24576
v_bfe_u32 v243, v242, 0, 2
v_mfma_f32_16x16x32_bf16 v[224:227], v[84:87], v[140:143], v[224:227]
v_lshl_add_u32 v245, v243, 8, v245
v_bfe_u32 v243, v242, 2, 2
v_mfma_f32_16x16x32_bf16 v[224:227], v[110:113], v[148:151], v[224:227]
s_waitcnt lgkmcnt(2)
v_lshlrev_b32 v190, 16, v184
v_lshlrev_b32 v191, 16, v185
v_mfma_f32_16x16x32_bf16 v[224:227], v[68:71], v[136:139], v[224:227]
s_waitcnt lgkmcnt(1)
s_waitcnt lgkmcnt(0)
ds_swizzle_b32 v189, v188 offset:0x401F
v_and_b32 v184, 0xffff0000, v184
v_and_b32 v185, 0xffff0000, v185
v_mul_u32_u24 v243, 13107200, v243
v_add_u32 v245, v243, v245
s_lshl_b32 s48, s43, 7
s_add_u32 s48, s48, s44
s_add_u32 s48, s48, 0
v_bfe_u32 v243, v242, 4, 2
v_lshl_add_u32 v245, v243, 4, v245
v_add_f32 v249, v249, v200
v_add_f32 v249, v249, v201
v_add_f32 v249, v249, v202
v_add_f32 v249, v249, v203
ds_read_b128 v[200:203], v244 offset:2064
v_add_f32 v249, v249, v204
ds_read_b32 v204, v244 offset:6144
v_add_f32 v249, v249, v205
v_add_f32 v249, v249, v206
v_add_f32 v249, v249, v207
v_add_f32 v249, v249, v208
v_add_f32 v249, v249, v209
v_add_f32 v249, v249, v210
v_add_f32 v249, v249, v211
v_add_f32 v249, v249, v212
v_add_f32 v249, v249, v213
v_add_f32 v249, v249, v214
v_add_f32 v249, v249, v215
v_add_f32 v249, v249, v216
ds_swizzle_b32 v250, v249 offset:0x401F
v_lshlrev_b32 v206, 16, v196
v_lshlrev_b32 v207, 16, v197
v_and_b32 v196, 0xffff0000, v196
v_and_b32 v197, 0xffff0000, v197
s_waitcnt lgkmcnt(1)
ds_swizzle_b32 v205, v204 offset:0x401F
v_add_f32 v188, v188, v189
ds_bpermute_b32 v189, v247, v188
s_lshl_b32 s51, s43, 7
s_add_u32 s51, s51, s44
s_add_u32 s51, s51, 52428800
s_waitcnt lgkmcnt(2)
v_add_f32 v249, v249, v250
ds_bpermute_b32 v250, v247, v249
s_waitcnt lgkmcnt(2)
v_add_f32 v204, v204, v205
ds_bpermute_b32 v205, v247, v204
s_waitcnt lgkmcnt(2)
v_add_f32 v188, v188, v189
v_rcp_f32 v189, v188
s_nop 0
v_fmac_f32 v0, v190, v189
v_fmac_f32 v2, v191, v189
v_lshlrev_b32 v190, 16, v186
v_lshlrev_b32 v191, 16, v187
v_fmac_f32 v4, v190, v189
v_fmac_f32 v6, v191, v189
v_lshlrev_b32 v190, 16, v232
v_lshlrev_b32 v191, 16, v233
v_and_b32 v232, 0xffff0000, v232
v_fmac_f32 v8, v190, v189
v_fmac_f32 v10, v191, v189
v_fmac_f32 v1, v184, v189
v_fmac_f32 v9, v232, v189
v_and_b32 v233, 0xffff0000, v233
v_lshlrev_b32 v190, 16, v234
v_lshlrev_b32 v191, 16, v235
v_fmac_f32 v3, v185, v189
v_and_b32 v186, 0xffff0000, v186
v_and_b32 v187, 0xffff0000, v187
v_fmac_f32 v11, v233, v189
v_and_b32 v234, 0xffff0000, v234
v_and_b32 v235, 0xffff0000, v235
v_cvt_pk_bf16_f32 v0, v0, v1
v_cvt_pk_bf16_f32 v8, v8, v9
v_fmac_f32 v5, v186, v189
v_fmac_f32 v7, v187, v189
v_fmac_f32 v12, v190, v189
v_fmac_f32 v13, v234, v189
v_fmac_f32 v14, v191, v189
v_fmac_f32 v15, v235, v189
v_cvt_pk_bf16_f32 v1, v2, v3
v_cvt_pk_bf16_f32 v9, v10, v11
v_cvt_pk_bf16_f32 v2, v4, v5
v_cvt_pk_bf16_f32 v3, v6, v7
v_cvt_pk_bf16_f32 v10, v12, v13
v_cvt_pk_bf16_f32 v11, v14, v15
v_pk_max_i16 v0, v0, 0
v_pk_max_i16 v1, v1, 0
v_pk_max_i16 v2, v2, 0
v_pk_max_i16 v3, v3, 0
v_pk_max_i16 v8, v8, 0
v_pk_max_i16 v9, v9, 0
v_pk_max_i16 v10, v10, 0
v_pk_max_i16 v11, v11, 0
buffer_store_dwordx4 v[0:3], v245, s[20:23], s48 offen offset:0 nt
buffer_store_dwordx4 v[8:11], v245, s[20:23], s48 offen offset:64 nt
s_waitcnt lgkmcnt(1)
v_add_f32 v249, v249, v250
v_rcp_f32 v252, v249
s_nop 0
v_fmac_f32 v168, v228, v252
v_fmac_f32 v169, v229, v252
v_fmac_f32 v176, v220, v252
v_fmac_f32 v177, v221, v252
v_fmac_f32 v170, v230, v252
v_fmac_f32 v171, v231, v252
v_cvt_pk_bf16_f32 v168, v168, v169
v_fmac_f32 v178, v222, v252
v_fmac_f32 v179, v223, v252
v_cvt_pk_bf16_f32 v176, v176, v177
v_fmac_f32 v172, v192, v252
v_fmac_f32 v173, v193, v252
v_fmac_f32 v174, v194, v252
v_fmac_f32 v175, v195, v252
v_cvt_pk_bf16_f32 v169, v170, v171
v_fmac_f32 v180, v224, v252
v_fmac_f32 v181, v225, v252
v_fmac_f32 v182, v226, v252
v_fmac_f32 v183, v227, v252
v_cvt_pk_bf16_f32 v177, v178, v179
v_cvt_pk_bf16_f32 v170, v172, v173
v_cvt_pk_bf16_f32 v171, v174, v175
v_cvt_pk_bf16_f32 v178, v180, v181
v_cvt_pk_bf16_f32 v179, v182, v183
v_pk_max_i16 v168, v168, 0
v_pk_max_i16 v169, v169, 0
v_pk_max_i16 v170, v170, 0
v_pk_max_i16 v171, v171, 0
v_pk_max_i16 v176, v176, 0
v_pk_max_i16 v177, v177, 0
v_pk_max_i16 v178, v178, 0
v_pk_max_i16 v179, v179, 0
buffer_store_dwordx4 v[168:171], v239, s[20:23], s53 offen offset:0 nt
buffer_store_dwordx4 v[176:179], v239, s[20:23], s53 offen offset:64 nt
s_waitcnt lgkmcnt(0)
v_add_f32 v204, v204, v205
v_rcp_f32 v205, v204
s_nop 0
v_fmac_f32 v16, v206, v205
v_fmac_f32 v18, v207, v205
v_lshlrev_b32 v206, 16, v198
v_lshlrev_b32 v207, 16, v199
v_fmac_f32 v20, v206, v205
v_fmac_f32 v22, v207, v205
v_lshlrev_b32 v206, 16, v200
v_lshlrev_b32 v207, 16, v201
v_and_b32 v200, 0xffff0000, v200
v_fmac_f32 v24, v206, v205
v_fmac_f32 v26, v207, v205
v_fmac_f32 v17, v196, v205
v_fmac_f32 v25, v200, v205
v_and_b32 v201, 0xffff0000, v201
v_lshlrev_b32 v206, 16, v202
v_lshlrev_b32 v207, 16, v203
v_fmac_f32 v19, v197, v205
v_and_b32 v198, 0xffff0000, v198
v_and_b32 v199, 0xffff0000, v199
v_fmac_f32 v27, v201, v205
v_and_b32 v202, 0xffff0000, v202
v_and_b32 v203, 0xffff0000, v203
v_cvt_pk_bf16_f32 v16, v16, v17
v_cvt_pk_bf16_f32 v24, v24, v25
v_fmac_f32 v21, v198, v205
v_fmac_f32 v23, v199, v205
v_fmac_f32 v28, v206, v205
v_fmac_f32 v29, v202, v205
v_fmac_f32 v30, v207, v205
v_fmac_f32 v31, v203, v205
v_cvt_pk_bf16_f32 v17, v18, v19
v_cvt_pk_bf16_f32 v25, v26, v27
v_cvt_pk_bf16_f32 v18, v20, v21
v_cvt_pk_bf16_f32 v19, v22, v23
v_cvt_pk_bf16_f32 v26, v28, v29
v_cvt_pk_bf16_f32 v27, v30, v31
v_pk_max_i16 v16, v16, 0
v_pk_max_i16 v17, v17, 0
v_pk_max_i16 v18, v18, 0
v_pk_max_i16 v19, v19, 0
v_pk_max_i16 v24, v24, 0
v_pk_max_i16 v25, v25, 0
v_pk_max_i16 v26, v26, 0
v_pk_max_i16 v27, v27, 0
buffer_store_dwordx4 v[16:19], v245, s[20:23], s51 offen offset:0 nt
buffer_store_dwordx4 v[24:27], v245, s[20:23], s51 offen offset:64 nt
L_end:
s_endpgm
.section .rodata,"a"
.p2align 6
.amdhsa_kernel standalone__attention_interact_autoint__recsys_kernel
  .amdhsa_next_free_vgpr 512
  .amdhsa_next_free_sgpr 102
  .amdhsa_accum_offset 256
  .amdhsa_group_segment_fixed_size 0
  .amdhsa_kernarg_size 64
  .amdhsa_user_sgpr_count 2
  .amdhsa_user_sgpr_kernarg_segment_ptr 1
  .amdhsa_system_sgpr_workgroup_id_x 1
.end_amdhsa_kernel
```

```asm
; @launch grid=(256,1,1) block=(256,1,1) lds=163840
.amdgcn_target "amdgcn-amd-amdhsa--gfx950"
.text
.globl standalone__attention_interact_autoint__recsys_kernel
.p2align 8
.type standalone__attention_interact_autoint__recsys_kernel,@function
standalone__attention_interact_autoint__recsys_kernel:
s_cmp_ge_u32 s2, 256
s_cbranch_scc1 L_end
s_load_dwordx2 s[24:25], s[0:1], 8
s_load_dwordx2 s[16:17], s[0:1], 0
s_load_dwordx2 s[28:29], s[0:1], 16
s_load_dwordx2 s[32:33], s[0:1], 24
s_load_dwordx2 s[36:37], s[0:1], 32
s_load_dwordx2 s[20:21], s[0:1], 40
s_getpc_b64 s[58:59]
L_pc:
s_lshl_b32 s3, s2, 8
s_and_b32 s3, s3, 0x7800
v_lshrrev_b32 v2, 4, v0
v_lshl_add_u32 v2, v2, 7, s3
v_min_u32 v2, L_fast_end-L_pc-4, v2
global_load_dword v104, v2, s[58:59]
v_lshrrev_b32 v1, 6, v0
s_mov_b32 s19, 0x20000
v_readfirstlane_b32 s41, v1
s_mov_b32 s18, 104857600
s_mov_b32 s26, 32768
s_mov_b32 s27, s19
s_lshr_b32 s42, s41, 1
s_and_b32 s43, s41, 1
s_lshl1_add_u32 s44, s2, s42
s_mul_i32 s44, s44, 25600
s_mov_b64 s[30:31], s[26:27]
s_mov_b64 s[34:35], s[26:27]
s_mov_b64 s[38:39], s[26:27]
s_lshl_b32 s54, s41, 13
s_mul_i32 s49, s42, 25344
s_mul_i32 s53, s43, 1056
s_add_u32 s49, s49, s53
s_lshl_b32 s55, s43, 10
s_add_u32 s55, s55, s44
s_lshl_b32 s6, s2, 7
s_and_b32 s6, s6, 0x7c00
s_add_u32 s57, s54, 4096
s_add_u32 m0, s49, 21120
s_add_u32 s48, s55, 20480
v_and_b32 v176, 63, v0
v_lshlrev_b32 v183, 4, v176
v_and_b32 v241, 48, v183
v_and_b32 v177, 48, v176
v_lshl_add_u32 v241, v177, 2, v241
v_and_b32 v177, 12, v176
v_lshl_add_u32 v241, v177, 6, v241
v_lshrrev_b32 v177, 5, v0
v_lshlrev_b32 v177, 7, v177
s_waitcnt lgkmcnt(0)
buffer_load_dword v105, v177, s[24:27], s6 offen
buffer_load_dword v106, v177, s[28:31], s6 offen
buffer_load_dword v107, v177, s[32:35], s6 offen
buffer_load_dword v108, v177, s[36:39], s6 offen
buffer_load_dwordx4 v[112:115], v183, s[24:27], s54 offen offset:0
buffer_load_dwordx4 v[116:119], v183, s[24:27], s54 offen offset:1024
buffer_load_dwordx4 v[120:123], v183, s[24:27], s54 offen offset:2048
buffer_load_dwordx4 v[124:127], v183, s[24:27], s54 offen offset:3072
buffer_load_dwordx4 v[128:131], v183, s[24:27], s57 offen offset:0
buffer_load_dwordx4 v[132:135], v183, s[24:27], s57 offen offset:1024
buffer_load_dwordx4 v[136:139], v183, s[24:27], s57 offen offset:2048
buffer_load_dwordx4 v[140:143], v183, s[24:27], s57 offen offset:3072
buffer_load_dwordx4 v241, s[16:19], s48 offen nt lds
s_add_u32 m0, s49, 23232
s_add_u32 s48, s55, 22528
buffer_load_dwordx4 v241, s[16:19], s48 offen nt lds
s_add_u32 m0, s49, 0
s_add_u32 s48, s55, 0
buffer_load_dwordx4 v241, s[16:19], s48 offen nt lds
s_add_u32 m0, s49, 2112
s_add_u32 s48, s55, 2048
buffer_load_dwordx4 v241, s[16:19], s48 offen nt lds
s_mov_b32 s40, 0x3e38aa3b
s_mov_b32 s22, s18
s_mov_b32 s23, s19
s_mov_b32 s45, 8
s_mov_b32 s3, 64
s_mov_b32 s46, s44
s_mov_b32 s47, 0x7ff00000
s_mov_b32 s56, 50688
s_mov_b32 s96, 0x3b8265d9
s_mov_b32 s97, 0
s_mul_i32 s98, s42, 25344
s_lshl_b32 s53, s43, 13
s_add_u32 s98, s98, s53
s_add_u32 s53, s98, 4224
s_add_u32 m0, s98, 101376
v_and_b32 v177, 16, v176
v_lshlrev_b32 v188, 2, v177
v_lshlrev_b32 v177, 1, v177
v_xor_b32 v178, v183, v177
v_add_u32 v180, s53, v178
v_xor_b32 v179, 64, v178
v_add_u32 v181, s53, v179
s_mul_i32 s4, s43, 13107200
s_add_u32 s4, s4, s44
s_add_u32 s4, s4, 24576
s_mul_i32 s5, s43, -52424704
s_add_u32 s5, s5, 104833024
s_add_u32 s99, s4, 0
s_add_u32 s100, s4, 26212288
s_mul_i32 s53, s43, 25344
s_add_u32 s7, s53, 4224
v_lshrrev_b32 v82, 4, v176
v_lshl_add_u32 v184, v82, 10, s7
v_bfe_u32 v83, v176, 2, 2
v_lshl_add_u32 v184, v83, 7, v184
v_bfe_u32 v84, v176, 3, 1
v_lshl_add_u32 v184, v84, 5, v184
v_bfe_u32 v85, v176, 4, 1
v_lshl_add_u32 v184, v85, 6, v184
v_and_b32 v86, 3, v176
v_lshl_add_u32 v184, v86, 3, v184
v_xor_b32 v185, 32, v184
v_xor_b32 v186, 64, v184
s_mul_i32 s53, s42, 25344
v_lshl_add_u32 v240, v86, 6, s53
v_lshl_add_u32 v240, v82, 4, v240
s_mov_b32 s6, 1056
v_mad_u32_u24 v240, v83, s6, v240
s_waitcnt vmcnt(11)
v_and_b32 v168, 0xffff0000, v112
v_and_b32 v169, 0xffff0000, v113
v_and_b32 v170, 0xffff0000, v114
v_and_b32 v171, 0xffff0000, v115
v_lshlrev_b32 v112, 16, v112
v_lshlrev_b32 v113, 16, v113
v_lshlrev_b32 v114, 16, v114
v_lshlrev_b32 v115, 16, v115
v_mul_f32 v168, s40, v168
v_mul_f32 v112, s40, v112
v_mul_f32 v169, s40, v169
v_mul_f32 v113, s40, v113
v_mul_f32 v170, s40, v170
v_mul_f32 v114, s40, v114
v_mul_f32 v171, s40, v171
v_mul_f32 v115, s40, v115
v_cvt_pk_bf16_f32 v112, v112, v168
v_cvt_pk_bf16_f32 v113, v113, v169
v_cvt_pk_bf16_f32 v114, v114, v170
v_cvt_pk_bf16_f32 v115, v115, v171
ds_write_b128 v180, v[112:115] offset:0
buffer_load_dwordx4 v178, s[28:31], s54 offen offset:0 lds
buffer_load_dwordx4 v179, s[28:31], s54 offen offset:1024 lds
buffer_load_dwordx4 v178, s[28:31], s54 offen offset:2048 lds
buffer_load_dwordx4 v179, s[28:31], s54 offen offset:3072 lds
s_add_u32 m0, s98, 105472
s_waitcnt vmcnt(14)
v_and_b32 v168, 0xffff0000, v116
v_and_b32 v169, 0xffff0000, v117
v_and_b32 v170, 0xffff0000, v118
v_and_b32 v171, 0xffff0000, v119
v_lshlrev_b32 v116, 16, v116
v_lshlrev_b32 v117, 16, v117
v_lshlrev_b32 v118, 16, v118
v_lshlrev_b32 v119, 16, v119
v_mul_f32 v168, s40, v168
v_mul_f32 v116, s40, v116
v_mul_f32 v169, s40, v169
v_mul_f32 v117, s40, v117
v_mul_f32 v170, s40, v170
v_mul_f32 v118, s40, v118
v_mul_f32 v171, s40, v171
v_mul_f32 v119, s40, v119
v_cvt_pk_bf16_f32 v116, v116, v168
v_cvt_pk_bf16_f32 v117, v117, v169
v_cvt_pk_bf16_f32 v118, v118, v170
v_cvt_pk_bf16_f32 v119, v119, v171
ds_write_b128 v181, v[116:119] offset:1024
buffer_load_dwordx4 v178, s[28:31], s57 offen offset:0 lds
buffer_load_dwordx4 v179, s[28:31], s57 offen offset:1024 lds
buffer_load_dwordx4 v178, s[28:31], s57 offen offset:2048 lds
buffer_load_dwordx4 v179, s[28:31], s57 offen offset:3072 lds
s_add_u32 m0, s49, 50688
s_waitcnt vmcnt(17)
v_and_b32 v168, 0xffff0000, v120
v_and_b32 v169, 0xffff0000, v121
v_and_b32 v170, 0xffff0000, v122
v_and_b32 v171, 0xffff0000, v123
v_lshlrev_b32 v120, 16, v120
v_lshlrev_b32 v121, 16, v121
v_lshlrev_b32 v122, 16, v122
v_lshlrev_b32 v123, 16, v123
v_mul_f32 v168, s40, v168
v_mul_f32 v120, s40, v120
v_mul_f32 v169, s40, v169
v_mul_f32 v121, s40, v121
v_mul_f32 v170, s40, v170
v_mul_f32 v122, s40, v122
v_mul_f32 v171, s40, v171
v_mul_f32 v123, s40, v123
v_cvt_pk_bf16_f32 v120, v120, v168
v_cvt_pk_bf16_f32 v121, v121, v169
v_cvt_pk_bf16_f32 v122, v122, v170
v_cvt_pk_bf16_f32 v123, v123, v171
ds_write_b128 v180, v[120:123] offset:2048
s_waitcnt vmcnt(16)
v_and_b32 v168, 0xffff0000, v124
v_and_b32 v169, 0xffff0000, v125
v_and_b32 v170, 0xffff0000, v126
v_and_b32 v171, 0xffff0000, v127
v_lshlrev_b32 v124, 16, v124
v_lshlrev_b32 v125, 16, v125
v_lshlrev_b32 v126, 16, v126
v_lshlrev_b32 v127, 16, v127
v_mul_f32 v168, s40, v168
v_mul_f32 v124, s40, v124
v_mul_f32 v169, s40, v169
v_mul_f32 v125, s40, v125
v_mul_f32 v170, s40, v170
v_mul_f32 v126, s40, v126
v_mul_f32 v171, s40, v171
v_mul_f32 v127, s40, v127
v_cvt_pk_bf16_f32 v124, v124, v168
v_cvt_pk_bf16_f32 v125, v125, v169
v_cvt_pk_bf16_f32 v126, v126, v170
v_cvt_pk_bf16_f32 v127, v127, v171
ds_write_b128 v181, v[124:127] offset:3072
s_waitcnt vmcnt(15)
v_and_b32 v168, 0xffff0000, v128
v_and_b32 v169, 0xffff0000, v129
v_and_b32 v170, 0xffff0000, v130
v_and_b32 v171, 0xffff0000, v131
v_lshlrev_b32 v128, 16, v128
v_lshlrev_b32 v129, 16, v129
v_lshlrev_b32 v130, 16, v130
v_lshlrev_b32 v131, 16, v131
v_mul_f32 v168, s40, v168
v_mul_f32 v128, s40, v128
v_mul_f32 v169, s40, v169
v_mul_f32 v129, s40, v129
v_mul_f32 v170, s40, v170
v_mul_f32 v130, s40, v130
v_mul_f32 v171, s40, v171
v_mul_f32 v131, s40, v131
v_cvt_pk_bf16_f32 v128, v128, v168
v_cvt_pk_bf16_f32 v129, v129, v169
v_cvt_pk_bf16_f32 v130, v130, v170
v_cvt_pk_bf16_f32 v131, v131, v171
ds_write_b128 v180, v[128:131] offset:4096
s_waitcnt vmcnt(14)
v_and_b32 v168, 0xffff0000, v132
v_and_b32 v169, 0xffff0000, v133
v_and_b32 v170, 0xffff0000, v134
v_and_b32 v171, 0xffff0000, v135
v_lshlrev_b32 v132, 16, v132
v_lshlrev_b32 v133, 16, v133
v_lshlrev_b32 v134, 16, v134
v_lshlrev_b32 v135, 16, v135
v_mul_f32 v168, s40, v168
v_mul_f32 v132, s40, v132
v_mul_f32 v169, s40, v169
v_mul_f32 v133, s40, v133
v_mul_f32 v170, s40, v170
v_mul_f32 v134, s40, v134
v_mul_f32 v171, s40, v171
v_mul_f32 v135, s40, v135
v_cvt_pk_bf16_f32 v132, v132, v168
v_cvt_pk_bf16_f32 v133, v133, v169
v_cvt_pk_bf16_f32 v134, v134, v170
v_cvt_pk_bf16_f32 v135, v135, v171
ds_write_b128 v181, v[132:135] offset:5120
s_waitcnt vmcnt(13)
v_and_b32 v168, 0xffff0000, v136
v_and_b32 v169, 0xffff0000, v137
v_and_b32 v170, 0xffff0000, v138
v_and_b32 v171, 0xffff0000, v139
v_lshlrev_b32 v136, 16, v136
v_lshlrev_b32 v137, 16, v137
v_lshlrev_b32 v138, 16, v138
v_lshlrev_b32 v139, 16, v139
v_mul_f32 v168, s40, v168
v_mul_f32 v136, s40, v136
v_mul_f32 v169, s40, v169
v_mul_f32 v137, s40, v137
v_mul_f32 v170, s40, v170
v_mul_f32 v138, s40, v138
v_mul_f32 v171, s40, v171
v_mul_f32 v139, s40, v139
v_cvt_pk_bf16_f32 v136, v136, v168
v_cvt_pk_bf16_f32 v137, v137, v169
v_cvt_pk_bf16_f32 v138, v138, v170
v_cvt_pk_bf16_f32 v139, v139, v171
ds_write_b128 v180, v[136:139] offset:6144
s_waitcnt vmcnt(12)
v_and_b32 v168, 0xffff0000, v140
v_and_b32 v169, 0xffff0000, v141
v_and_b32 v170, 0xffff0000, v142
v_and_b32 v171, 0xffff0000, v143
v_lshlrev_b32 v140, 16, v140
v_lshlrev_b32 v141, 16, v141
v_lshlrev_b32 v142, 16, v142
v_lshlrev_b32 v143, 16, v143
v_mul_f32 v168, s40, v168
v_mul_f32 v140, s40, v140
v_mul_f32 v169, s40, v169
v_mul_f32 v141, s40, v141
v_mul_f32 v170, s40, v170
v_mul_f32 v142, s40, v142
v_mul_f32 v171, s40, v171
v_mul_f32 v143, s40, v143
v_cvt_pk_bf16_f32 v140, v140, v168
v_cvt_pk_bf16_f32 v141, v141, v169
v_cvt_pk_bf16_f32 v142, v142, v170
v_cvt_pk_bf16_f32 v143, v143, v171
ds_write_b128 v181, v[140:143] offset:7168
buffer_load_dwordx4 v241, s[16:19], s99 offen offset:0 nt lds
buffer_load_dwordx4 v241, s[16:19], s100 offen offset:2112 nt lds
s_add_u32 m0, s49, 54912
s_add_u32 s99, s4, 52428800
buffer_load_dwordx4 v241, s[16:19], s99 offen offset:0 nt lds
s_add_u32 s100, s4, 78641088
buffer_load_dwordx4 v241, s[16:19], s100 offen offset:2112 nt lds
s_add_u32 m0, s98, 59648
s_add_u32 s99, s55, 4096
s_add_u32 s100, s55, 4032
s_waitcnt vmcnt(12) lgkmcnt(0)
s_barrier
ds_read_b64_tr_b16 a[4:5], v184 offset:4096
ds_read_b128 v[200:203], v240 offset:21376
ds_read_b64_tr_b16 a[6:7], v184 offset:4608
ds_read_b128 v[208:211], v240 offset:21632
ds_read_b64_tr_b16 a[8:9], v184 offset:8192
ds_read_b128 v[216:219], v240 offset:21888
ds_read_b64_tr_b16 a[10:11], v184 offset:8704
ds_read_b128 v[196:199], v240 offset:21120
ds_read_b64_tr_b16 a[12:13], v184 offset:12288
ds_read_b128 v[204:207], v240 offset:0
ds_read_b64_tr_b16 a[14:15], v184 offset:12800
ds_read_b128 v[212:215], v240 offset:256
ds_read_b64_tr_b16 a[0:1], v184 offset:0
ds_read_b128 v[220:223], v240 offset:512
ds_read_b64_tr_b16 a[2:3], v184 offset:512
ds_read_b128 v[224:227], v240 offset:768
ds_read_b64_tr_b16 a[16:17], v185 offset:0
ds_read_b64_tr_b16 a[18:19], v185 offset:512
ds_read_b64_tr_b16 a[20:21], v185 offset:4096
ds_read_b64_tr_b16 a[22:23], v185 offset:4608
ds_read_b64_tr_b16 a[24:25], v185 offset:8192
ds_read_b64_tr_b16 a[26:27], v185 offset:8704
ds_read_b64_tr_b16 a[28:29], v185 offset:12288
ds_read_b64_tr_b16 a[30:31], v185 offset:12800
ds_read_b64_tr_b16 a[32:33], v186 offset:0
ds_read_b64_tr_b16 a[34:35], v186 offset:512
ds_read_b64_tr_b16 a[36:37], v186 offset:4096
ds_read_b64_tr_b16 a[38:39], v186 offset:4608
s_waitcnt lgkmcnt(15)
v_mfma_f32_16x16x32_bf16 v[228:231], a[4:7], v[200:203], 0
s_mov_b32 s51, -32
ds_read_b64_tr_b16 a[40:41], v186 offset:8192
v_xor_b32 v187, 96, v184
v_mfma_f32_16x16x32_bf16 v[228:231], a[8:11], v[208:211], v[228:231]
s_waitcnt lgkmcnt(14)
ds_read_b64_tr_b16 a[42:43], v186 offset:8704
v_add_u32 v184, 97152, v184
v_mfma_f32_16x16x32_bf16 v[228:231], a[12:15], v[216:219], v[228:231]
ds_read_b64_tr_b16 a[44:45], v186 offset:12288
v_lshrrev_b32 v80, 3, v176
v_mfma_f32_16x16x32_bf16 v[228:231], a[0:3], v[196:199], v[228:231]
ds_read_b64_tr_b16 a[46:47], v186 offset:12800
v_lshlrev_b32 v182, 8, v80
v_mfma_f32_16x16x32_bf16 v[232:235], a[0:3], v[204:207], 0
ds_read_b64_tr_b16 a[48:49], v187 offset:0
v_and_b32 v81, 7, v176
v_mfma_f32_16x16x32_bf16 v[232:235], a[4:7], v[212:215], v[232:235]
s_waitcnt lgkmcnt(15)
ds_read_b64_tr_b16 a[50:51], v187 offset:512
v_cvt_pk_bf16_f32 v160, v228, v229
v_mfma_f32_16x16x32_bf16 v[232:235], a[8:11], v[220:223], v[232:235]
s_waitcnt lgkmcnt(10)
ds_read_b64_tr_b16 a[52:53], v187 offset:4096
v_cvt_pk_bf16_f32 v161, v230, v231
v_mfma_f32_16x16x32_bf16 v[232:235], a[12:15], v[224:227], v[232:235]
ds_read_b64_tr_b16 a[54:55], v187 offset:4608
v_lshl_add_u32 v182, v81, 4, v182
v_mfma_f32_16x16x32_bf16 v[228:231], a[28:31], v[224:227], 0
ds_read_b64_tr_b16 a[56:57], v187 offset:8192
v_xor_b32 v182, v182, v188
v_mfma_f32_16x16x32_bf16 v[228:231], a[24:27], v[220:223], v[228:231]
ds_read_b64_tr_b16 a[58:59], v187 offset:8704
v_xor_b32 v188, v183, v188
v_mfma_f32_16x16x32_bf16 v[228:231], a[20:23], v[212:215], v[228:231]
ds_read_b64_tr_b16 a[60:61], v187 offset:12288
v_cvt_pk_bf16_f32 v104, v232, v233
v_mfma_f32_16x16x32_bf16 v[228:231], a[16:19], v[204:207], v[228:231]
s_waitcnt lgkmcnt(13)
ds_read_b64_tr_b16 a[62:63], v187 offset:12800
v_cvt_pk_bf16_f32 v105, v234, v235
v_mfma_f32_16x16x32_bf16 v[232:235], a[16:19], v[196:199], 0
s_waitcnt vmcnt(4)
s_barrier
v_mfma_f32_16x16x32_bf16 v[232:235], a[28:31], v[216:219], v[232:235]
s_waitcnt lgkmcnt(10)
ds_read_b64_tr_b16 a[64:65], v184 offset:0
v_cvt_pk_bf16_f32 v106, v228, v229
v_mfma_f32_16x16x32_bf16 v[232:235], a[24:27], v[208:211], v[232:235]
s_waitcnt lgkmcnt(10)
ds_read_b64_tr_b16 a[66:67], v184 offset:512
v_cvt_pk_bf16_f32 v107, v230, v231
v_mfma_f32_16x16x32_bf16 v[232:235], a[20:23], v[200:203], v[232:235]
s_waitcnt lgkmcnt(10)
ds_read_b64_tr_b16 a[68:69], v184 offset:4096
v_add_u32 v185, 97152, v185
v_mfma_f32_16x16x32_bf16 v[228:231], a[36:39], v[200:203], 0
s_waitcnt lgkmcnt(10)
ds_read_b64_tr_b16 a[70:71], v184 offset:4608
v_add_u32 v186, 97152, v186
v_mfma_f32_16x16x32_bf16 v[228:231], a[40:43], v[208:211], v[228:231]
s_waitcnt lgkmcnt(10)
ds_read_b64_tr_b16 a[72:73], v184 offset:8192
v_cvt_pk_bf16_f32 v162, v232, v233
v_mfma_f32_16x16x32_bf16 v[228:231], a[44:47], v[216:219], v[228:231]
s_waitcnt lgkmcnt(10)
ds_read_b64_tr_b16 a[74:75], v184 offset:8704
v_cvt_pk_bf16_f32 v163, v234, v235
v_mfma_f32_16x16x32_bf16 v[228:231], a[32:35], v[196:199], v[228:231]
s_waitcnt lgkmcnt(10)
ds_read_b64_tr_b16 a[76:77], v184 offset:12288
v_add_u32 v187, 97152, v187
v_mfma_f32_16x16x32_bf16 v[232:235], a[32:35], v[204:207], 0
s_waitcnt lgkmcnt(10)
ds_read_b64_tr_b16 a[78:79], v184 offset:12800
v_and_b32 v88, 1, v176
v_mfma_f32_16x16x32_bf16 v[232:235], a[36:39], v[212:215], v[232:235]
s_waitcnt lgkmcnt(10)
ds_read_b64_tr_b16 a[80:81], v185 offset:0
v_cvt_pk_bf16_f32 v164, v228, v229
v_mfma_f32_16x16x32_bf16 v[232:235], a[40:43], v[220:223], v[232:235]
s_waitcnt lgkmcnt(9)
ds_read_b64_tr_b16 a[82:83], v185 offset:512
v_cvt_pk_bf16_f32 v165, v230, v231
v_mfma_f32_16x16x32_bf16 v[232:235], a[44:47], v[224:227], v[232:235]
buffer_load_dwordx4 v188, s[32:35], s54 offen offset:0 lds
v_mfma_f32_16x16x32_bf16 v[228:231], a[60:63], v[224:227], 0
buffer_load_dwordx4 v188, s[32:35], s54 offen offset:1024 lds
v_mfma_f32_16x16x32_bf16 v[228:231], a[52:55], v[212:215], v[228:231]
ds_read_b64_tr_b16 a[84:85], v185 offset:4096
v_bfe_u32 v87, v176, 1, 1
v_mfma_f32_16x16x32_bf16 v[228:231], a[48:51], v[204:207], v[228:231]
s_waitcnt lgkmcnt(10)
ds_read_b64_tr_b16 a[86:87], v185 offset:4608
v_cvt_pk_bf16_f32 v108, v232, v233
v_mfma_f32_16x16x32_bf16 v[228:231], a[56:59], v[220:223], v[228:231]
s_waitcnt lgkmcnt(10)
ds_read_b64_tr_b16 a[88:89], v185 offset:8192
v_cvt_pk_bf16_f32 v109, v234, v235
v_mfma_f32_16x16x32_bf16 v[232:235], a[56:59], v[208:211], 0
s_waitcnt lgkmcnt(10)
ds_read_b64_tr_b16 a[90:91], v185 offset:8704
v_mov_b32 v100, 0
v_mfma_f32_16x16x32_bf16 v[232:235], a[60:63], v[216:219], v[232:235]
s_waitcnt lgkmcnt(10)
ds_read_b64_tr_b16 a[92:93], v185 offset:12288
v_cvt_pk_bf16_f32 v110, v228, v229
v_mfma_f32_16x16x32_bf16 v[232:235], a[52:55], v[200:203], v[232:235]
s_waitcnt lgkmcnt(10)
ds_read_b64_tr_b16 a[94:95], v185 offset:12800
v_cvt_pk_bf16_f32 v111, v230, v231
v_mfma_f32_16x16x32_bf16 v[232:235], a[48:51], v[196:199], v[232:235]
s_waitcnt lgkmcnt(10)
ds_read_b64_tr_b16 a[96:97], v186 offset:0
v_lshrrev_b32 v92, 5, v176
v_mfma_f32_16x16x32_bf16 v[228:231], a[64:67], v[196:199], 0
s_waitcnt lgkmcnt(10)
ds_read_b64_tr_b16 a[98:99], v186 offset:512
v_lshlrev_b32 v16, 4, v86
v_mfma_f32_16x16x32_bf16 v[228:231], a[68:71], v[200:203], v[228:231]
s_waitcnt lgkmcnt(10)
ds_read_b64_tr_b16 a[100:101], v186 offset:4096
v_cvt_pk_bf16_f32 v166, v232, v233
v_mfma_f32_16x16x32_bf16 v[228:231], a[72:75], v[208:211], v[228:231]
s_waitcnt lgkmcnt(10)
ds_read_b64_tr_b16 a[102:103], v186 offset:4608
v_cvt_pk_bf16_f32 v167, v234, v235
v_mfma_f32_16x16x32_bf16 v[228:231], a[76:79], v[216:219], v[228:231]
s_waitcnt lgkmcnt(10)
ds_read_b64_tr_b16 a[104:105], v186 offset:8192
v_lshlrev_b32 v93, 5, v84
v_mfma_f32_16x16x32_bf16 v[232:235], a[76:79], v[224:227], 0
buffer_load_dwordx4 v188, s[32:35], s54 offen offset:2048 lds
v_mfma_f32_16x16x32_bf16 v[232:235], a[64:67], v[204:207], v[232:235]
buffer_load_dwordx4 v188, s[32:35], s54 offen offset:3072 lds
v_mfma_f32_16x16x32_bf16 v[232:235], a[68:71], v[212:215], v[232:235]
s_waitcnt lgkmcnt(7)
ds_read_b64_tr_b16 a[106:107], v186 offset:8704
s_add_u32 m0, s98, 63744
v_mfma_f32_16x16x32_bf16 v[232:235], a[72:75], v[220:223], v[232:235]
ds_read_b64_tr_b16 a[108:109], v186 offset:12288
v_cvt_pk_bf16_f32 v40, v228, v229
v_cvt_pk_bf16_f32 v41, v230, v231
v_mfma_f32_16x16x32_bf16 v[228:231], a[88:91], v[220:223], 0
ds_read_b64_tr_b16 a[110:111], v186 offset:12800
v_lshlrev_b32 v94, 4, v87
v_mfma_f32_16x16x32_bf16 v[228:231], a[84:87], v[212:215], v[228:231]
s_waitcnt lgkmcnt(8)
ds_read_b64_tr_b16 a[112:113], v187 offset:0
v_cvt_pk_bf16_f32 v0, v232, v233
v_mfma_f32_16x16x32_bf16 v[228:231], a[80:83], v[204:207], v[228:231]
ds_read_b64_tr_b16 a[114:115], v187 offset:512
v_cvt_pk_bf16_f32 v1, v234, v235
v_mfma_f32_16x16x32_bf16 v[228:231], a[92:95], v[224:227], v[228:231]
ds_read_b64_tr_b16 a[116:117], v187 offset:4096
v_and_b32 v89, 15, v176
v_mfma_f32_16x16x32_bf16 v[232:235], a[92:95], v[216:219], 0
s_waitcnt lgkmcnt(10)
ds_read_b64_tr_b16 a[118:119], v187 offset:4608
v_lshlrev_b32 v95, 4, v83
v_mfma_f32_16x16x32_bf16 v[232:235], a[88:91], v[208:211], v[232:235]
s_waitcnt lgkmcnt(10)
ds_read_b64_tr_b16 a[120:121], v187 offset:8192
v_cvt_pk_bf16_f32 v2, v228, v229
v_mfma_f32_16x16x32_bf16 v[232:235], a[84:87], v[200:203], v[232:235]
s_waitcnt lgkmcnt(10)
ds_read_b64_tr_b16 a[122:123], v187 offset:8704
v_cvt_pk_bf16_f32 v3, v230, v231
v_mfma_f32_16x16x32_bf16 v[232:235], a[80:83], v[196:199], v[232:235]
s_waitcnt lgkmcnt(10)
ds_read_b64_tr_b16 a[124:125], v187 offset:12288
v_mov_b32 v177, 159056
v_mfma_f32_16x16x32_bf16 v[228:231], a[96:99], v[196:199], 0
s_waitcnt lgkmcnt(9)
ds_read_b64_tr_b16 a[126:127], v187 offset:12800
v_mov_b32 v192, 0
v_mfma_f32_16x16x32_bf16 v[228:231], a[100:103], v[200:203], v[228:231]
s_waitcnt lgkmcnt(8)
buffer_load_dwordx4 v188, s[32:35], s57 offen offset:0 lds
v_mfma_f32_16x16x32_bf16 v[228:231], a[104:107], v[208:211], v[228:231]
buffer_load_dwordx4 v188, s[32:35], s57 offen offset:1024 lds
v_mfma_f32_16x16x32_bf16 v[228:231], a[108:111], v[216:219], v[228:231]
v_cvt_pk_bf16_f32 v42, v232, v233
v_cvt_pk_bf16_f32 v43, v234, v235
v_mfma_f32_16x16x32_bf16 v[232:235], a[108:111], v[224:227], 0
s_mul_i32 s53, s41, 1104
s_add_u32 s53, s53, 152576
v_lshl_add_u32 v247, v83, 6, s53
v_mfma_f32_16x16x32_bf16 v[232:235], a[96:99], v[204:207], v[232:235]
s_add_u32 s8, s53, 256
v_cvt_pk_bf16_f32 v44, v228, v229
v_cvt_pk_bf16_f32 v45, v230, v231
v_mfma_f32_16x16x32_bf16 v[232:235], a[100:103], v[212:215], v[232:235]
s_waitcnt lgkmcnt(2)
v_lshl_add_u32 v247, v88, 5, v247
v_lshl_add_u32 v247, v85, 4, v247
v_mfma_f32_16x16x32_bf16 v[232:235], a[104:107], v[220:223], v[232:235]
s_add_u32 s9, s53, 256
s_mov_b32 vcc_lo, 0x33333333
s_mov_b32 vcc_hi, 0xcccccccc
v_mfma_f32_16x16x32_bf16 v[228:231], a[120:123], v[220:223], 0
v_mov_b32 v174, s8
v_cndmask_b32 v247, v174, v247, vcc
v_mfma_f32_16x16x32_bf16 v[228:231], a[116:119], v[212:215], v[228:231]
s_waitcnt lgkmcnt(0)
v_cvt_pk_bf16_f32 v4, v232, v233
v_cvt_pk_bf16_f32 v5, v234, v235
v_mfma_f32_16x16x32_bf16 v[228:231], a[112:115], v[204:207], v[228:231]
s_mov_b32 s8, 272
v_lshl_add_u32 v174, v83, 2, s9
v_lshl_add_u32 v246, v82, 6, s53
v_mfma_f32_16x16x32_bf16 v[228:231], a[124:127], v[224:227], v[228:231]
s_mul_i32 s53, s43, 25344
v_mad_u32_u24 v174, v86, s8, v174
v_lshl_add_u32 v246, v87, 5, v246
v_mfma_f32_16x16x32_bf16 v[204:207], a[124:127], v[216:219], 0
s_add_u32 s10, s53, 59648
ds_write_b32 v174, v100 offset:0
v_mfma_f32_16x16x32_bf16 v[204:207], a[120:123], v[208:211], v[204:207]
s_lshl_b32 s53, s43, 7
v_cvt_pk_bf16_f32 v6, v228, v229
v_cvt_pk_bf16_f32 v7, v230, v231
v_mfma_f32_16x16x32_bf16 v[204:207], a[116:119], v[200:203], v[204:207]
buffer_load_dwordx4 v188, s[32:35], s57 offen offset:2048 lds
v_mfma_f32_16x16x32_bf16 v[204:207], a[112:115], v[196:199], v[204:207]
buffer_load_dwordx4 v188, s[32:35], s57 offen offset:3072 lds
v_mfma_f32_16x16x32_bf16 v[212:215], v[4:7], v[164:167], 0
s_add_u32 m0, s49, 4224
v_lshl_add_u32 v246, v83, 3, v246
v_lshl_add_u32 v246, v88, 1, v246
v_mfma_f32_16x16x32_bf16 v[212:215], v[0:3], v[160:163], v[212:215]
v_mov_b32 v174, 64
v_lshl_add_u32 v242, v89, 8, s53
v_mfma_f32_16x16x32_bf16 v[220:223], v[40:43], v[160:163], 0
ds_write_b16 v246, v174 offset:816
v_cvt_pk_bf16_f32 v46, v204, v205
v_cvt_pk_bf16_f32 v47, v206, v207
s_mul_i32 s52, s41, 12800
s_add_u32 s52, s52, 101376
v_mfma_f32_16x16x32_bf16 v[220:223], v[44:47], v[164:167], v[220:223]
s_add_u32 s14, s52, 256
v_lshl_add_u32 v172, v86, 7, s52
v_lshl_add_u32 v249, v86, 2, s14
v_mfma_f32_16x16x32_bf16 v[204:207], v[0:3], v[104:107], 0
s_mov_b32 s14, 1600
v_lshl_add_u32 v172, v92, 4, v172
v_lshl_add_u32 v172, v85, 3, v172
v_mfma_f32_16x16x32_bf16 v[204:207], v[4:7], v[108:111], v[204:207]
s_add_u32 s12, s52, 512
v_mad_u32_u24 v172, v83, s14, v172
v_xor_b32 v172, v16, v172
v_xor_b32 v173, 32, v172
s_waitcnt vmcnt(8) lgkmcnt(0)
s_barrier
ds_read_b128 v[48:51], v240 offset:50688
ds_read_b128 v[52:55], v240 offset:50944
ds_read_b128 v[56:59], v240 offset:51200
ds_read_b128 v[60:63], v240 offset:51456
ds_read_b128 v[64:67], v240 offset:54912
ds_read_b128 v[68:71], v240 offset:55168
ds_read_b128 v[72:75], v240 offset:55424
ds_read_b128 v[76:79], v240 offset:55680
v_exp_f32 v204, v204
v_exp_f32 v205, v205
v_exp_f32 v206, v206
v_exp_f32 v207, v207
v_lshl_add_u32 v243, v84, 8, s52
v_lshl_add_u32 v243, v87, 7, v243
v_lshl_add_u32 v243, v88, 6, v243
v_cvt_pk_bf16_f32 v128, v204, v205
v_cvt_pk_bf16_f32 v129, v206, v207
s_waitcnt lgkmcnt(7)
v_mfma_f32_16x16x32_bf16 v[224:227], a[64:67], v[48:51], 0
s_waitcnt lgkmcnt(5)
buffer_load_dwordx4 v241, s[16:19], s99 offen offset:0 nt lds
v_mfma_f32_16x16x32_bf16 v[224:227], a[68:71], v[52:55], v[224:227]
s_waitcnt lgkmcnt(4)
buffer_load_dwordx4 v241, s[16:19], s100 offen offset:2112 nt lds
v_mfma_f32_16x16x32_bf16 v[224:227], a[72:75], v[56:59], v[224:227]
s_add_u32 m0, s49, 8448
s_add_u32 s99, s55, 8192
s_add_u32 s100, s55, 8128
v_mfma_f32_16x16x32_bf16 v[224:227], a[76:79], v[60:63], v[224:227]
s_add_u32 s13, s52, 1072
v_lshl_add_u32 v243, v82, 4, v243
v_xor_b32 v243, v93, v243
v_mfma_f32_16x16x32_bf16 v[228:231], a[92:95], v[60:63], 0
s_add_u32 s11, s52, 1088
v_xor_b32 v243, v94, v243
v_lshl_add_u32 v245, v83, 7, s12
v_mfma_f32_16x16x32_bf16 v[228:231], a[88:91], v[56:59], v[228:231]
s_add_u32 s15, s52, 1072
v_cvt_pk_bf16_f32 v144, v224, v225
v_cvt_pk_bf16_f32 v146, v226, v227
v_mfma_f32_16x16x32_bf16 v[228:231], a[84:87], v[52:55], v[228:231]
s_add_u32 s7, s52, 1088
v_lshl_add_u32 v245, v88, 6, v245
v_lshl_add_u32 v245, v82, 4, v245
v_mfma_f32_16x16x32_bf16 v[228:231], a[80:83], v[48:51], v[228:231]
buffer_load_dwordx4 v241, s[16:19], s99 offen offset:0 nt lds
v_mfma_f32_16x16x32_bf16 v[224:227], a[96:99], v[48:51], 0
s_add_u32 s99, s55, 12288
buffer_load_dwordx4 v241, s[16:19], s100 offen offset:2112 nt lds
v_mfma_f32_16x16x32_bf16 v[224:227], a[100:103], v[52:55], v[224:227]
s_add_u32 m0, s49, 12672
s_add_u32 s100, s55, 12224
v_xor_b32 v245, v95, v245
v_mfma_f32_16x16x32_bf16 v[224:227], a[104:107], v[56:59], v[224:227]
s_waitcnt lgkmcnt(0)
v_cvt_pk_bf16_f32 v145, v228, v229
v_cvt_pk_bf16_f32 v147, v230, v231
v_mfma_f32_16x16x32_bf16 v[224:227], a[108:111], v[60:63], v[224:227]
s_xor_b32 s53, s41, 1
s_mul_i32 s53, s53, 1104
v_mov_b32 v174, s13
v_mfma_f32_16x16x32_bf16 v[228:231], a[124:127], v[60:63], 0
s_add_u32 s9, s53, 153392
s_mov_b32 vcc_lo, 0x33333333
s_mov_b32 vcc_hi, 0x33333333
v_mfma_f32_16x16x32_bf16 v[228:231], a[116:119], v[52:55], v[228:231]
s_lshl_b32 s53, s41, 9
v_cvt_pk_bf16_f32 v148, v224, v225
v_cvt_pk_bf16_f32 v150, v226, v227
v_mfma_f32_16x16x32_bf16 v[228:231], a[112:115], v[48:51], v[228:231]
buffer_load_dwordx4 v241, s[16:19], s99 offen offset:0 nt lds
v_mfma_f32_16x16x32_bf16 v[228:231], a[120:123], v[56:59], v[228:231]
s_add_u32 s99, s55, 16384
buffer_load_dwordx4 v241, s[16:19], s100 offen offset:2112 nt lds
v_mfma_f32_16x16x32_bf16 v[224:227], a[56:59], v[56:59], 0
s_add_u32 m0, s49, 16896
s_add_u32 s100, s55, 16320
v_lshl_add_u32 v190, v82, 10, s10
v_mfma_f32_16x16x32_bf16 v[224:227], a[60:63], v[60:63], v[224:227]
s_add_u32 s10, s53, 156992
s_lshl_b32 s57, s43, 14
s_lshl_b32 s53, s42, 7
s_add_u32 s57, s57, s53
v_mfma_f32_16x16x32_bf16 v[224:227], a[52:55], v[52:55], v[224:227]
ds_write_b32 v172, v144 offset:0
v_mfma_f32_16x16x32_bf16 v[224:227], a[48:51], v[48:51], v[224:227]
ds_write_b32 v172, v145 offset:4
v_mfma_f32_16x16x32_bf16 v[232:235], a[32:35], v[48:51], 0
ds_write_b32 v172, v146 offset:64
v_mfma_f32_16x16x32_bf16 v[232:235], a[36:39], v[52:55], v[232:235]
buffer_load_dwordx4 v241, s[16:19], s99 offen offset:0 nt lds
v_mfma_f32_16x16x32_bf16 v[232:235], a[40:43], v[56:59], v[232:235]
s_add_u32 s99, s57, 0
buffer_load_dwordx4 v241, s[16:19], s100 offen offset:2112 nt lds
v_mfma_f32_16x16x32_bf16 v[232:235], a[44:47], v[60:63], v[232:235]
s_add_u32 m0, s98, 59648
s_add_u32 s100, s57, 1024
v_cvt_pk_bf16_f32 v157, v224, v225
v_mfma_f32_16x16x32_bf16 v[236:239], a[28:31], v[60:63], 0
ds_write_b32 v172, v147 offset:68
v_mfma_f32_16x16x32_bf16 v[236:239], a[24:27], v[56:59], v[236:239]
s_waitcnt vmcnt(8)
s_barrier
v_mfma_f32_16x16x32_bf16 v[236:239], a[20:23], v[52:55], v[236:239]
ds_write_b32 v173, v148 offset:0
v_mfma_f32_16x16x32_bf16 v[236:239], a[16:19], v[48:51], v[236:239]
v_cvt_pk_bf16_f32 v159, v226, v227
v_cvt_pk_bf16_f32 v149, v228, v229
v_mfma_f32_16x16x32_bf16 v[224:227], a[0:3], v[48:51], 0
ds_write_b32 v173, v149 offset:4
v_mfma_f32_16x16x32_bf16 v[224:227], a[8:11], v[56:59], v[224:227]
ds_write_b32 v173, v150 offset:64
v_mfma_f32_16x16x32_bf16 v[224:227], a[12:15], v[60:63], v[224:227]
v_cvt_pk_bf16_f32 v151, v230, v231
v_cvt_pk_bf16_f32 v153, v236, v237
v_mfma_f32_16x16x32_bf16 v[224:227], a[4:7], v[52:55], v[224:227]
ds_write_b32 v173, v151 offset:68
v_mfma_f32_16x16x32_bf16 v[228:231], a[4:7], v[68:71], 0
ds_read_b128 v[96:99], v243 offset:0
v_cvt_pk_bf16_f32 v155, v238, v239
v_mfma_f32_16x16x32_bf16 v[228:231], a[0:3], v[64:67], v[228:231]
v_cvt_pk_bf16_f32 v156, v232, v233
v_cvt_pk_bf16_f32 v158, v234, v235
v_mfma_f32_16x16x32_bf16 v[228:231], a[8:11], v[72:75], v[228:231]
v_cvt_pk_bf16_f32 v152, v224, v225
v_cvt_pk_bf16_f32 v154, v226, v227
v_mfma_f32_16x16x32_bf16 v[228:231], a[12:15], v[76:79], v[228:231]
v_cndmask_b32 v245, v174, v245, vcc
v_lshl_add_u32 v175, v89, 4, s10
v_mfma_f32_16x16x32_bf16 v[224:227], v[144:147], v[152:155], 0
s_mov_b32 vcc_lo, 0xf0000f
s_mov_b32 vcc_hi, 0xf0000f00
v_cndmask_b32 v175, v177, v175, vcc
v_mfma_f32_16x16x32_bf16 v[224:227], v[148:151], v[156:159], v[224:227]
s_mov_b32 vcc_lo, 0x33333333
s_mov_b32 vcc_hi, 0x33333333
v_mov_b32 v177, 0x3f803f80
v_cndmask_b32 v192, v192, v177, vcc
s_mov_b32 vcc_lo, 0xaaaaaaaa
s_mov_b32 vcc_hi, 0xaaaaaaaa
v_mov_b32 v250, 0x44444444
v_mov_b32 v177, 0xeeeeeeee
v_cndmask_b32 v250, v250, v177, vcc
s_mov_b32 vcc_lo, 0x0
s_mov_b32 vcc_hi, 0xaaaaaaaa
v_mov_b32 v177, 0xe4eeeeee
v_cndmask_b32 v250, v250, v177, vcc
v_mov_b64 v[232:233], s[96:97]
v_mov_b64 v[234:235], s[96:97]
v_mov_b64 v[236:237], s[96:97]
s_waitcnt lgkmcnt(0)
v_smfmac_f32_16x16x64_bf16 v[232:235], v[96:99], v[160:167], v250
s_mov_b32 vcc_lo, 0xffff
s_mov_b32 vcc_hi, 0xffff
v_mov_b64 v[238:239], s[96:97]
v_cvt_pk_bf16_f32 v32, v228, v229
v_cvt_pk_bf16_f32 v34, v230, v231
v_smfmac_f32_16x16x64_bf16 v[236:239], v[96:99], v[104:111], v250
s_lshl_b32 s50, s43, 12
s_add_u32 s50, s50, s44
s_add_u32 s50, s50, 13107200
v_mfma_f32_16x16x32_bf16 v[228:231], a[28:31], v[76:79], 0
v_lshl_add_u32 v190, v83, 7, v190
v_lshl_add_u32 v190, v84, 6, v190
v_mfma_f32_16x16x32_bf16 v[228:231], a[24:27], v[72:75], v[228:231]
v_lshl_add_u32 v190, v86, 4, v190
v_xor_b32 v191, 64, v190
v_mfma_f32_16x16x32_bf16 v[228:231], a[20:23], v[68:71], v[228:231]
ds_read_b64_tr_b16 a[176:177], v191 offset:8
v_mov_b32 v251, 0x0c0c0c0c
v_mfma_f32_16x16x32_bf16 v[228:231], a[16:19], v[64:67], v[228:231]
ds_read_b64_tr_b16 a[178:179], v191 offset:520
v_exp_f32 v224, v224
v_exp_f32 v225, v225
v_exp_f32 v226, v226
v_add_f32 v168, v224, v225
s_nop 2
v_cvt_pk_bf16_f32 v33, v228, v229
v_cvt_pk_bf16_f32 v35, v230, v231
v_mfma_f32_16x16x32_bf16 v[228:231], a[32:35], v[64:67], 0
ds_read_b64_tr_b16 a[180:181], v191 offset:4104
v_cvt_pk_bf16_f32 v224, v224, v225
v_mfma_f32_16x16x32_bf16 v[228:231], a[36:39], v[68:71], v[228:231]
ds_read_b64_tr_b16 a[182:183], v191 offset:4616
v_mov_b32 v177, 0x07060302
v_mfma_f32_16x16x32_bf16 v[228:231], a[40:43], v[72:75], v[228:231]
ds_read_b64_tr_b16 a[184:185], v191 offset:8200
v_cndmask_b32 v251, v251, v177, vcc
v_mfma_f32_16x16x32_bf16 v[228:231], a[44:47], v[76:79], v[228:231]
ds_read_b64_tr_b16 a[186:187], v191 offset:8712
v_add_f32 v236, v236, v237
v_mfma_f32_16x16x32_bf16 v[204:207], a[60:63], v[76:79], 0
ds_read_b64_tr_b16 a[188:189], v191 offset:12296
v_add_f32 v238, v238, v239
v_mfma_f32_16x16x32_bf16 v[204:207], a[52:55], v[68:71], v[204:207]
ds_read_b64_tr_b16 a[190:191], v191 offset:12808
v_bfe_u32 v90, v176, 3, 2
v_mfma_f32_16x16x32_bf16 v[204:207], a[48:51], v[64:67], v[204:207]
ds_read_b64_tr_b16 a[160:161], v191 offset:0
v_cvt_pk_bf16_f32 v36, v228, v229
v_mfma_f32_16x16x32_bf16 v[204:207], a[56:59], v[72:75], v[204:207]
ds_read_b64_tr_b16 a[162:163], v191 offset:512
v_cvt_pk_bf16_f32 v38, v230, v231
v_mfma_f32_16x16x32_bf16 v[228:231], a[120:123], v[72:75], 0
s_waitcnt lgkmcnt(9)
ds_read_b64_tr_b16 a[164:165], v191 offset:4096
v_mov_b32 v252, 0x0c0c0c0c
v_mfma_f32_16x16x32_bf16 v[228:231], a[124:127], v[76:79], v[228:231]
s_waitcnt lgkmcnt(9)
ds_read_b64_tr_b16 a[166:167], v191 offset:4608
v_cvt_pk_bf16_f32 v37, v204, v205
v_mfma_f32_16x16x32_bf16 v[228:231], a[116:119], v[68:71], v[228:231]
ds_read_b64_tr_b16 a[168:169], v191 offset:8192
v_cvt_pk_bf16_f32 v39, v206, v207
v_mfma_f32_16x16x32_bf16 v[228:231], a[112:115], v[64:67], v[228:231]
ds_read_b64_tr_b16 a[170:171], v191 offset:8704
v_mov_b32 v177, 0x07060302
v_mfma_f32_16x16x32_bf16 v[204:207], a[96:99], v[64:67], 0
ds_read_b64_tr_b16 a[172:173], v191 offset:12288
v_bfe_u32 v91, v176, 2, 1
v_mfma_f32_16x16x32_bf16 v[204:207], a[100:103], v[68:71], v[204:207]
s_waitcnt lgkmcnt(12)
ds_read_b64_tr_b16 a[174:175], v191 offset:12800
v_cvt_pk_bf16_f32 v29, v228, v229
v_mfma_f32_16x16x32_bf16 v[204:207], a[104:107], v[72:75], v[204:207]
s_waitcnt lgkmcnt(12)
ds_read_b64_tr_b16 a[144:145], v190 offset:8
v_cvt_pk_bf16_f32 v31, v230, v231
v_mfma_f32_16x16x32_bf16 v[204:207], a[108:111], v[76:79], v[204:207]
s_waitcnt lgkmcnt(12)
ds_read_b64_tr_b16 a[146:147], v190 offset:520
v_lshl_add_u32 v244, v90, 7, s11
v_mfma_f32_16x16x32_bf16 v[228:231], a[92:95], v[76:79], 0
s_waitcnt lgkmcnt(12)
ds_read_b64_tr_b16 a[148:149], v190 offset:4104
v_lshl_add_u32 v174, v90, 2, s15
v_mfma_f32_16x16x32_bf16 v[228:231], a[88:91], v[72:75], v[228:231]
s_waitcnt lgkmcnt(12)
ds_read_b64_tr_b16 a[150:151], v190 offset:4616
v_cvt_pk_bf16_f32 v28, v204, v205
v_mfma_f32_16x16x32_bf16 v[228:231], a[84:87], v[68:71], v[228:231]
s_waitcnt lgkmcnt(12)
ds_read_b64_tr_b16 a[152:153], v190 offset:8200
v_cvt_pk_bf16_f32 v30, v206, v207
v_mfma_f32_16x16x32_bf16 v[228:231], a[80:83], v[64:67], v[228:231]
s_waitcnt lgkmcnt(12)
ds_read_b64_tr_b16 a[154:155], v190 offset:8712
v_lshl_add_u32 v244, v91, 6, v244
v_mfma_f32_16x16x32_bf16 v[204:207], a[64:67], v[64:67], 0
s_waitcnt lgkmcnt(12)
ds_read_b64_tr_b16 a[156:157], v190 offset:12296
v_lshl_add_u32 v189, v89, 3, s7
v_mfma_f32_16x16x32_bf16 v[204:207], a[68:71], v[68:71], v[204:207]
s_waitcnt lgkmcnt(12)
ds_read_b64_tr_b16 a[158:159], v190 offset:12808
v_cvt_pk_bf16_f32 v25, v228, v229
v_mfma_f32_16x16x32_bf16 v[204:207], a[72:75], v[72:75], v[204:207]
s_waitcnt lgkmcnt(12)
ds_read_b64_tr_b16 a[128:129], v190 offset:0
v_cvt_pk_bf16_f32 v27, v230, v231
v_mfma_f32_16x16x32_bf16 v[204:207], a[76:79], v[76:79], v[204:207]
s_waitcnt lgkmcnt(12)
ds_read_b64_tr_b16 a[130:131], v190 offset:512
v_lshl_add_u32 v248, v89, 2, s52
v_mfma_f32_16x16x32_bf16 v[228:231], v[76:79], a[188:191], 0
s_waitcnt lgkmcnt(12)
ds_read_b64_tr_b16 a[132:133], v190 offset:4096
v_mad_u32_u24 v189, v82, s14, v189
v_mfma_f32_16x16x32_bf16 v[228:231], v[72:75], a[184:187], v[228:231]
s_waitcnt lgkmcnt(12)
ds_read_b64_tr_b16 a[134:135], v190 offset:4608
v_cvt_pk_bf16_f32 v24, v204, v205
v_mfma_f32_16x16x32_bf16 v[228:231], v[68:71], a[180:183], v[228:231]
s_waitcnt lgkmcnt(12)
ds_read_b64_tr_b16 a[136:137], v190 offset:8192
v_cvt_pk_bf16_f32 v26, v206, v207
v_mfma_f32_16x16x32_bf16 v[228:231], v[64:67], a[176:179], v[228:231]
s_waitcnt lgkmcnt(12)
ds_read_b64_tr_b16 a[138:139], v190 offset:8704
v_mad_u32_u24 v249, v82, s8, v249
v_mfma_f32_16x16x32_bf16 v[204:207], v[24:27], v[32:35], 0
s_waitcnt lgkmcnt(12)
ds_read_b64_tr_b16 a[140:141], v190 offset:12288
v_lshl_add_u32 v242, v82, 4, v242
v_mfma_f32_16x16x32_bf16 v[204:207], v[28:31], v[36:39], v[204:207]
s_waitcnt lgkmcnt(12)
ds_read_b64_tr_b16 a[142:143], v190 offset:12800
v_cvt_pk_bf16_f32 v14, v228, v229
v_cvt_pk_bf16_f32 v15, v230, v231
v_mfma_f32_16x16x32_bf16 v[228:231], v[64:67], a[160:163], 0
s_waitcnt lgkmcnt(12)
ds_write_b32 v175, v224 offset:0
v_mfma_f32_16x16x32_bf16 v[228:231], v[68:71], a[164:167], v[228:231]
s_waitcnt lgkmcnt(12)
v_exp_f32 v212, v212
v_mfma_f32_16x16x32_bf16 v[228:231], v[72:75], a[168:171], v[228:231]
s_waitcnt lgkmcnt(9)
v_exp_f32 v213, v213
v_mfma_f32_16x16x32_bf16 v[228:231], v[76:79], a[172:175], v[228:231]
v_exp_f32 v214, v214
v_exp_f32 v215, v215
v_cvt_pk_bf16_f32 v112, v212, v213
v_cvt_pk_bf16_f32 v113, v214, v215
v_mfma_f32_16x16x32_bf16 v[212:215], v[76:79], a[156:159], 0
s_waitcnt lgkmcnt(8)
v_exp_f32 v220, v220
v_mfma_f32_16x16x32_bf16 v[212:215], v[72:75], a[152:155], v[212:215]
s_waitcnt lgkmcnt(7)
v_cvt_pk_bf16_f32 v12, v228, v229
v_cvt_pk_bf16_f32 v13, v230, v231
v_mfma_f32_16x16x32_bf16 v[212:215], v[68:71], a[148:151], v[212:215]
s_waitcnt lgkmcnt(6)
v_exp_f32 v221, v221
v_mfma_f32_16x16x32_bf16 v[212:215], v[64:67], a[144:147], v[212:215]
s_waitcnt lgkmcnt(3)
v_exp_f32 v222, v222
v_mfma_f32_16x16x32_bf16 v[228:231], v[64:67], a[128:131], 0
s_waitcnt lgkmcnt(1)
v_exp_f32 v223, v223
v_mfma_f32_16x16x32_bf16 v[228:231], v[72:75], a[136:139], v[228:231]
v_cvt_pk_bf16_f32 v122, v220, v221
v_cvt_pk_bf16_f32 v123, v222, v223
v_mfma_f32_16x16x32_bf16 v[228:231], v[76:79], a[140:143], v[228:231]
v_cvt_pk_bf16_f32 v10, v212, v213
v_cvt_pk_bf16_f32 v11, v214, v215
v_mfma_f32_16x16x32_bf16 v[228:231], v[68:71], a[132:135], v[228:231]
s_mov_b32 vcc_lo, 0xffff0000
s_mov_b32 vcc_hi, 0xffff0000
v_cndmask_b32 v252, v252, v177, vcc
v_mfma_f32_16x16x32_bf16 v[212:215], v[52:55], a[132:135], 0
v_add_f32 v232, v232, v233
v_add_f32 v234, v234, v235
v_mfma_f32_16x16x32_bf16 v[212:215], v[48:51], a[128:131], v[212:215]
v_exp_f32 v232, v232
v_mfma_f32_16x16x32_bf16 v[212:215], v[56:59], a[136:139], v[212:215]
s_waitcnt vmcnt(4)
s_barrier
v_mfma_f32_16x16x32_bf16 v[212:215], v[60:63], a[140:143], v[212:215]
v_exp_f32 v234, v234
v_mfma_f32_16x16x32_bf16 v[220:223], v[60:63], a[156:159], 0
v_perm_b32 v124, v234, v232, v251
v_perm_b32 v125, v234, v232, v252
v_mfma_f32_16x16x32_bf16 v[220:223], v[56:59], a[152:155], v[220:223]
v_exp_f32 v227, v227
v_mfma_f32_16x16x32_bf16 v[220:223], v[52:55], a[148:151], v[220:223]
s_nop 0
v_cvt_pk_bf16_f32 v16, v212, v213
v_cvt_pk_bf16_f32 v17, v214, v215
v_mfma_f32_16x16x32_bf16 v[220:223], v[48:51], a[144:147], v[220:223]
v_cvt_pk_bf16_f32 v225, v226, v227
v_add_f32 v169, v226, v227
v_mfma_f32_16x16x32_bf16 v[212:215], v[48:51], a[160:163], 0
ds_write_b32 v175, v225 offset:4
v_mfma_f32_16x16x32_bf16 v[212:215], v[52:55], a[164:167], v[212:215]
v_add_f32 v226, v168, v169
v_lshl_add_u32 v244, v86, 3, v244
v_mfma_f32_16x16x32_bf16 v[212:215], v[56:59], a[168:171], v[212:215]
ds_write_b32 v175, v226 offset:8
v_mfma_f32_16x16x32_bf16 v[212:215], v[60:63], a[172:175], v[212:215]
v_exp_f32 v204, v204
v_mfma_f32_16x16x32_bf16 v[232:235], v[60:63], a[188:191], 0
v_exp_f32 v205, v205
v_mfma_f32_16x16x32_bf16 v[232:235], v[52:55], a[180:183], v[232:235]
v_add_f32 v168, v204, v205
v_cvt_pk_bf16_f32 v204, v204, v205
v_mfma_f32_16x16x32_bf16 v[232:235], v[48:51], a[176:179], v[232:235]
ds_write_b32 v175, v204 offset:256
v_mfma_f32_16x16x32_bf16 v[232:235], v[56:59], a[184:187], v[232:235]
v_exp_f32 v206, v206
v_exp_f32 v207, v207
v_cvt_pk_bf16_f32 v18, v220, v221
v_cvt_pk_bf16_f32 v205, v206, v207
v_add_f32 v169, v206, v207
s_nop 2
v_cvt_pk_bf16_f32 v22, v232, v233
v_cvt_pk_bf16_f32 v23, v234, v235
v_mfma_f32_16x16x32_bf16 v[232:235], v[208:211], a[184:187], 0
ds_write_b32 v175, v205 offset:260
v_mfma_f32_16x16x32_bf16 v[232:235], v[216:219], a[188:191], v[232:235]
v_add_f32 v206, v168, v169
v_cvt_pk_bf16_f32 v19, v222, v223
v_mfma_f32_16x16x32_bf16 v[232:235], v[200:203], a[180:183], v[232:235]
ds_write_b32 v175, v206 offset:264
v_mfma_f32_16x16x32_bf16 v[232:235], v[196:199], a[176:179], v[232:235]
ds_read_b128 v[220:223], v240 offset:256
v_cvt_pk_bf16_f32 v8, v228, v229
v_mfma_f32_16x16x32_bf16 v[224:227], v[196:199], a[160:163], 0
v_cvt_pk_bf16_f32 v9, v230, v231
v_cvt_pk_bf16_f32 v20, v212, v213
v_mfma_f32_16x16x32_bf16 v[224:227], v[200:203], a[164:167], v[224:227]
ds_read_b128 v[228:231], v240 offset:0
v_cvt_pk_bf16_f32 v21, v214, v215
v_mfma_f32_16x16x32_bf16 v[224:227], v[208:211], a[168:171], v[224:227]
ds_read_b128 v[212:215], v240 offset:512
v_mad_u32_u24 v248, v82, s8, v248
v_mfma_f32_16x16x32_bf16 v[224:227], v[216:219], a[172:175], v[224:227]
v_exp_f32 v236, v236
v_mfma_f32_16x16x32_bf16 v[204:207], v[216:219], a[156:159], 0
v_exp_f32 v238, v238
v_mfma_f32_16x16x32_bf16 v[204:207], v[208:211], a[152:155], v[204:207]
v_perm_b32 v140, v238, v236, v251
v_perm_b32 v141, v238, v236, v252
v_mfma_f32_16x16x32_bf16 v[204:207], v[200:203], a[148:151], v[204:207]
ds_read_b128 v[236:239], v240 offset:768
v_cvt_pk_bf16_f32 v90, v224, v225
v_mfma_f32_16x16x32_bf16 v[204:207], v[196:199], a[144:147], v[204:207]
v_cvt_pk_bf16_f32 v91, v226, v227
v_cvt_pk_bf16_f32 v94, v232, v233
v_mfma_f32_16x16x32_bf16 v[224:227], v[196:199], a[128:131], 0
s_mul_i32 s48, s43, 3168
s_add_u32 s49, s49, s48
s_add_u32 s49, s49, 50688
s_mov_b32 s48, 8192
v_mfma_f32_16x16x32_bf16 v[224:227], v[208:211], a[136:139], v[224:227]
v_cvt_pk_bf16_f32 v86, v204, v205
v_cvt_pk_bf16_f32 v87, v206, v207
v_mfma_f32_16x16x32_bf16 v[224:227], v[216:219], a[140:143], v[224:227]
s_waitcnt lgkmcnt(3)
v_cvt_pk_bf16_f32 v95, v234, v235
v_mad_u32_u24 v174, v81, s14, v174
v_mfma_f32_16x16x32_bf16 v[224:227], v[200:203], a[132:135], v[224:227]
s_waitcnt lgkmcnt(2)
ds_write_b32 v174, v100 offset:0
v_mfma_f32_16x16x32_bf16 v[204:207], v[220:223], a[132:135], 0
s_waitcnt lgkmcnt(2)
ds_read_b128 v[196:199], v240 offset:4224
ds_read_b128 v[200:203], v240 offset:4480
v_mfma_f32_16x16x32_bf16 v[204:207], v[228:231], a[128:131], v[204:207]
s_waitcnt lgkmcnt(3)
ds_read_b128 v[208:211], v240 offset:4736
v_cvt_pk_bf16_f32 v82, v224, v225
v_mfma_f32_16x16x32_bf16 v[204:207], v[212:215], a[136:139], v[204:207]
ds_read_b128 v[216:219], v240 offset:4992
v_cvt_pk_bf16_f32 v83, v226, v227
v_mfma_f32_16x16x32_bf16 v[204:207], v[236:239], a[140:143], v[204:207]
ds_write_b32 v189, v14 offset:6784
v_mfma_f32_16x16x32_bf16 v[224:227], v[236:239], a[156:159], 0
ds_write_b32 v189, v15 offset:6788
v_mfma_f32_16x16x32_bf16 v[224:227], v[212:215], a[152:155], v[224:227]
ds_write_b32 v189, v12 offset:6656
v_mfma_f32_16x16x32_bf16 v[224:227], v[220:223], a[148:151], v[224:227]
ds_write_b32 v189, v13 offset:6660
v_mfma_f32_16x16x32_bf16 v[224:227], v[228:231], a[144:147], v[224:227]
ds_write_b32 v189, v10 offset:6528
v_cvt_pk_bf16_f32 v48, v204, v205
v_cvt_pk_bf16_f32 v49, v206, v207
v_mfma_f32_16x16x32_bf16 v[204:207], v[228:231], a[160:163], 0
ds_write_b32 v189, v11 offset:6532
v_mfma_f32_16x16x32_bf16 v[204:207], v[220:223], a[164:167], v[204:207]
ds_write_b32 v189, v8 offset:6400
v_mfma_f32_16x16x32_bf16 v[204:207], v[212:215], a[168:171], v[204:207]
ds_write_b32 v189, v9 offset:6404
v_mfma_f32_16x16x32_bf16 v[204:207], v[236:239], a[172:175], v[204:207]
v_cvt_pk_bf16_f32 v52, v224, v225
v_cvt_pk_bf16_f32 v53, v226, v227
v_mfma_f32_16x16x32_bf16 v[224:227], v[236:239], a[188:191], 0
buffer_load_dwordx4 v182, s[36:39], s99 offen offset:0 lds
v_mfma_f32_16x16x32_bf16 v[224:227], v[212:215], a[184:187], v[224:227]
s_add_u32 s99, s57, 2048
buffer_load_dwordx4 v182, s[36:39], s100 offen offset:1024 lds
v_mfma_f32_16x16x32_bf16 v[224:227], v[220:223], a[180:183], v[224:227]
s_add_u32 s100, s57, 3072
v_cvt_pk_bf16_f32 v56, v204, v205
v_cvt_pk_bf16_f32 v57, v206, v207
v_mfma_f32_16x16x32_bf16 v[224:227], v[228:231], a[176:179], v[224:227]
s_waitcnt lgkmcnt(8)
v_lshl_add_u32 v244, v92, 2, v244
v_mov_b32 v193, v192
v_mfma_f32_16x16x32_bf16 v[204:207], a[64:67], v[196:199], 0
v_mov_b32 v194, v192
v_mov_b32 v195, v192
v_mfma_f32_16x16x32_bf16 v[204:207], a[68:71], v[200:203], v[204:207]
s_nop 0
v_cvt_pk_bf16_f32 v60, v224, v225
v_cvt_pk_bf16_f32 v61, v226, v227
v_mfma_f32_16x16x32_bf16 v[204:207], a[72:75], v[208:211], v[204:207]
v_mov_b32 v126, 0
v_mov_b32 v127, 0
v_mfma_f32_16x16x32_bf16 v[204:207], a[76:79], v[216:219], v[204:207]
v_mov_b32 v101, 0
v_mov_b32 v102, 0
v_mfma_f32_16x16x32_bf16 v[212:215], a[92:95], v[216:219], 0
buffer_load_dwordx4 v182, s[36:39], s99 offen offset:2048 lds
v_mfma_f32_16x16x32_bf16 v[212:215], a[88:91], v[208:211], v[212:215]
s_add_u32 s99, s57, 8192
buffer_load_dwordx4 v182, s[36:39], s100 offen offset:3072 lds
v_mfma_f32_16x16x32_bf16 v[212:215], a[84:87], v[200:203], v[212:215]
s_add_u32 m0, s98, 63744
s_add_u32 s100, s57, 9216
v_cvt_pk_bf16_f32 v8, v204, v205
v_mfma_f32_16x16x32_bf16 v[212:215], a[80:83], v[196:199], v[212:215]
v_cvt_pk_bf16_f32 v9, v206, v207
v_mov_b32 v103, 0
v_mfma_f32_16x16x32_bf16 v[204:207], a[96:99], v[196:199], 0
v_mov_b32 v254, 0
v_mov_b32 v142, 0
v_mfma_f32_16x16x32_bf16 v[204:207], a[100:103], v[200:203], v[204:207]
v_mov_b32 v143, 0
v_mov_b32 v255, s9
v_mfma_f32_16x16x32_bf16 v[204:207], a[104:107], v[208:211], v[204:207]
v_cvt_pk_bf16_f32 v10, v212, v213
v_cvt_pk_bf16_f32 v11, v214, v215
v_mfma_f32_16x16x32_bf16 v[204:207], a[108:111], v[216:219], v[204:207]
ds_write_b32 v189, v16 offset:0
v_mfma_f32_16x16x32_bf16 v[212:215], a[124:127], v[216:219], 0
buffer_load_dwordx4 v182, s[36:39], s99 offen offset:0 lds
v_mfma_f32_16x16x32_bf16 v[212:215], a[120:123], v[208:211], v[212:215]
s_add_u32 s99, s57, 10240
buffer_load_dwordx4 v182, s[36:39], s100 offen offset:1024 lds
v_mfma_f32_16x16x32_bf16 v[212:215], a[116:119], v[200:203], v[212:215]
s_add_u32 s100, s57, 11264
v_cvt_pk_bf16_f32 v12, v204, v205
v_cvt_pk_bf16_f32 v13, v206, v207
v_mfma_f32_16x16x32_bf16 v[212:215], a[112:115], v[196:199], v[212:215]
ds_write_b32 v189, v17 offset:4
v_mfma_f32_16x16x32_bf16 v[204:207], v[196:199], a[128:131], 0
ds_write_b32 v189, v18 offset:128
v_mfma_f32_16x16x32_bf16 v[204:207], v[200:203], a[132:135], v[204:207]
ds_write_b32 v189, v19 offset:132
v_mfma_f32_16x16x32_bf16 v[204:207], v[208:211], a[136:139], v[204:207]
s_waitcnt vmcnt(6)
s_barrier
v_mfma_f32_16x16x32_bf16 v[204:207], v[216:219], a[140:143], v[204:207]
s_mov_b32 s98, s50
v_cvt_pk_bf16_f32 v14, v212, v213
v_cvt_pk_bf16_f32 v15, v214, v215
s_nop 1
v_mfma_f32_16x16x32_bf16 v[212:215], v[12:15], v[164:167], 0
buffer_load_dwordx4 v182, s[36:39], s99 offen offset:2048 lds
v_mfma_f32_16x16x32_bf16 v[212:215], v[8:11], v[160:163], v[212:215]
s_add_u32 s99, s98, s51
buffer_load_dwordx4 v182, s[36:39], s100 offen offset:3072 lds
v_mfma_f32_16x16x32_bf16 v[220:223], v[8:11], v[104:107], 0
s_add_u32 s100, s99, s51
v_cvt_pk_bf16_f32 v50, v204, v205
v_cvt_pk_bf16_f32 v51, v206, v207
v_mfma_f32_16x16x32_bf16 v[220:223], v[12:15], v[108:111], v[220:223]
s_add_u32 m0, s49, 0
v_exp_f32 v212, v212
v_mfma_f32_16x16x32_bf16 v[204:207], v[216:219], a[156:159], 0
s_add_u32 s101, s100, s51
ds_read_b128 v[224:227], v240 offset:8448
ds_read_b128 v[228:231], v240 offset:8704
v_mfma_f32_16x16x32_bf16 v[204:207], v[208:211], a[152:155], v[204:207]
ds_read_b128 v[232:235], v240 offset:8960
v_mfma_f32_16x16x32_bf16 v[204:207], v[200:203], a[148:151], v[204:207]
v_exp_f32 v213, v213
v_mfma_f32_16x16x32_bf16 v[204:207], v[196:199], a[144:147], v[204:207]
v_exp_f32 v214, v214
v_mfma_f32_16x16x32_bf16 v[236:239], v[196:199], a[160:163], 0
ds_write_b32 v189, v20 offset:256
v_mfma_f32_16x16x32_bf16 v[236:239], v[200:203], a[164:167], v[236:239]
ds_write_b32 v189, v21 offset:260
v_mfma_f32_16x16x32_bf16 v[236:239], v[208:211], a[168:171], v[236:239]
v_exp_f32 v215, v215
v_mfma_f32_16x16x32_bf16 v[236:239], v[216:219], a[172:175], v[236:239]
v_cvt_pk_bf16_f32 v54, v204, v205
v_cvt_pk_bf16_f32 v55, v206, v207
v_mfma_f32_16x16x32_bf16 v[204:207], v[216:219], a[188:191], 0
ds_write_b32 v189, v22 offset:384
v_mfma_f32_16x16x32_bf16 v[204:207], v[208:211], a[184:187], v[204:207]
ds_write_b32 v189, v23 offset:388
v_mfma_f32_16x16x32_bf16 v[204:207], v[200:203], a[180:183], v[204:207]
s_waitcnt lgkmcnt(6)
ds_read2_b32 v[100:101], v244 offset0:0 offset1:8
v_cvt_pk_bf16_f32 v58, v236, v237
v_mfma_f32_16x16x32_bf16 v[204:207], v[196:199], a[176:179], v[204:207]
s_waitcnt lgkmcnt(6)
v_cvt_pk_bf16_f32 v59, v238, v239
v_cvt_pk_bf16_f32 v114, v212, v213
v_mfma_f32_16x16x32_bf16 v[236:239], a[64:67], v[224:227], 0
s_waitcnt lgkmcnt(5)
v_cvt_pk_bf16_f32 v115, v214, v215
s_nop 0
v_mfma_f32_16x16x32_bf16 v[236:239], a[68:71], v[228:231], v[236:239]
ds_read_b128 v[212:215], v240 offset:9216
v_cvt_pk_bf16_f32 v62, v204, v205
v_mfma_f32_16x16x32_bf16 v[236:239], a[72:75], v[232:235], v[236:239]
v_cvt_pk_bf16_f32 v63, v206, v207
v_exp_f32 v220, v220
v_exp_f32 v221, v221
v_exp_f32 v222, v222
v_exp_f32 v223, v223
v_cvt_pk_bf16_f32 v130, v220, v221
v_cvt_pk_bf16_f32 v131, v222, v223
ds_write_b32 v172, v152 offset:512
ds_write_b32 v172, v153 offset:516
s_waitcnt lgkmcnt(2)
v_mfma_f32_16x16x32_bf16 v[236:239], a[76:79], v[212:215], v[236:239]
ds_write_b32 v172, v154 offset:576
v_mfma_f32_16x16x32_bf16 v[204:207], a[92:95], v[212:215], 0
ds_write_b32 v172, v155 offset:580
v_mfma_f32_16x16x32_bf16 v[204:207], a[88:91], v[232:235], v[204:207]
ds_write_b32 v173, v156 offset:512
v_mfma_f32_16x16x32_bf16 v[204:207], a[84:87], v[228:231], v[204:207]
s_nop 1
v_cvt_pk_bf16_f32 v16, v236, v237
v_mfma_f32_16x16x32_bf16 v[204:207], a[80:83], v[224:227], v[204:207]
v_cvt_pk_bf16_f32 v17, v238, v239
s_nop 0
v_mfma_f32_16x16x32_bf16 v[220:223], a[96:99], v[224:227], 0
ds_write_b32 v173, v157 offset:516
v_mfma_f32_16x16x32_bf16 v[220:223], a[100:103], v[228:231], v[220:223]
ds_write_b32 v173, v158 offset:576
v_mfma_f32_16x16x32_bf16 v[220:223], a[104:107], v[232:235], v[220:223]
s_nop 0
v_cvt_pk_bf16_f32 v18, v204, v205
v_cvt_pk_bf16_f32 v19, v206, v207
v_mfma_f32_16x16x32_bf16 v[220:223], a[108:111], v[212:215], v[220:223]
ds_write_b32 v173, v159 offset:580
v_mfma_f32_16x16x32_bf16 v[204:207], a[124:127], v[212:215], 0
ds_write_b32 v172, v32 offset:6912
v_mfma_f32_16x16x32_bf16 v[204:207], a[120:123], v[232:235], v[204:207]
ds_write_b32 v172, v33 offset:6916
v_mfma_f32_16x16x32_bf16 v[204:207], a[116:119], v[228:231], v[204:207]
s_nop 1
v_cvt_pk_bf16_f32 v20, v220, v221
v_mfma_f32_16x16x32_bf16 v[204:207], a[112:115], v[224:227], v[204:207]
v_cvt_pk_bf16_f32 v21, v222, v223
s_nop 0
v_mfma_f32_16x16x32_bf16 v[220:223], v[224:227], a[128:131], 0
ds_write_b32 v172, v34 offset:6976
v_mfma_f32_16x16x32_bf16 v[220:223], v[228:231], a[132:135], v[220:223]
ds_write_b32 v172, v35 offset:6980
v_mfma_f32_16x16x32_bf16 v[220:223], v[232:235], a[136:139], v[220:223]
s_nop 0
v_cvt_pk_bf16_f32 v22, v204, v205
v_cvt_pk_bf16_f32 v23, v206, v207
v_mfma_f32_16x16x32_bf16 v[220:223], v[212:215], a[140:143], v[220:223]
ds_write_b32 v173, v36 offset:6912
v_mfma_f32_16x16x32_bf16 v[204:207], v[20:23], v[164:167], 0
ds_read_b128 v[196:199], v240 offset:16896
ds_read_b128 v[200:203], v240 offset:17152
v_mfma_f32_16x16x32_bf16 v[204:207], v[16:19], v[160:163], v[204:207]
ds_read_b128 v[208:211], v240 offset:17408
ds_read_b128 v[216:219], v240 offset:17664
v_mfma_f32_16x16x32_bf16 v[236:239], v[16:19], v[104:107], 0
v_cvt_pk_bf16_f32 v64, v220, v221
v_cvt_pk_bf16_f32 v65, v222, v223
v_mfma_f32_16x16x32_bf16 v[236:239], v[20:23], v[108:111], v[236:239]
ds_write_b32 v173, v37 offset:6916
v_mfma_f32_16x16x32_bf16 v[220:223], v[212:215], a[156:159], 0
v_exp_f32 v204, v204
v_mfma_f32_16x16x32_bf16 v[220:223], v[232:235], a[152:155], v[220:223]
v_exp_f32 v205, v205
v_mfma_f32_16x16x32_bf16 v[220:223], v[228:231], a[148:151], v[220:223]
v_exp_f32 v206, v206
v_mfma_f32_16x16x32_bf16 v[220:223], v[224:227], a[144:147], v[220:223]
v_exp_f32 v207, v207
v_cvt_pk_bf16_f32 v116, v204, v205
v_cvt_pk_bf16_f32 v117, v206, v207
v_mfma_f32_16x16x32_bf16 v[204:207], v[224:227], a[160:163], 0
v_exp_f32 v236, v236
v_mfma_f32_16x16x32_bf16 v[204:207], v[228:231], a[164:167], v[204:207]
v_exp_f32 v237, v237
v_mfma_f32_16x16x32_bf16 v[204:207], v[232:235], a[168:171], v[204:207]
v_cvt_pk_bf16_f32 v68, v220, v221
v_cvt_pk_bf16_f32 v69, v222, v223
v_mfma_f32_16x16x32_bf16 v[204:207], v[212:215], a[172:175], v[204:207]
v_exp_f32 v238, v238
v_mfma_f32_16x16x32_bf16 v[220:223], v[212:215], a[188:191], 0
ds_write_b32 v173, v38 offset:6976
v_mfma_f32_16x16x32_bf16 v[220:223], v[232:235], a[184:187], v[220:223]
s_waitcnt lgkmcnt(4)
ds_write_b32 v173, v39 offset:6980
v_mfma_f32_16x16x32_bf16 v[220:223], v[228:231], a[180:183], v[220:223]
s_waitcnt lgkmcnt(3)
v_cvt_pk_bf16_f32 v72, v204, v205
v_cvt_pk_bf16_f32 v73, v206, v207
v_mfma_f32_16x16x32_bf16 v[220:223], v[224:227], a[176:179], v[220:223]
v_exp_f32 v239, v239
v_mfma_f32_16x16x32_bf16 v[204:207], a[64:67], v[196:199], 0
v_cvt_pk_bf16_f32 v132, v236, v237
v_cvt_pk_bf16_f32 v133, v238, v239
v_mfma_f32_16x16x32_bf16 v[204:207], a[68:71], v[200:203], v[204:207]
ds_write_b32 v172, v24 offset:6400
v_mfma_f32_16x16x32_bf16 v[204:207], a[72:75], v[208:211], v[204:207]
s_nop 0
v_cvt_pk_bf16_f32 v76, v220, v221
v_cvt_pk_bf16_f32 v77, v222, v223
v_mfma_f32_16x16x32_bf16 v[204:207], a[76:79], v[216:219], v[204:207]
buffer_load_dwordx4 v241, s[16:19], s98 offen offset:0 nt lds
v_mfma_f32_16x16x32_bf16 v[212:215], a[92:95], v[216:219], 0
buffer_load_dwordx4 v241, s[16:19], s99 offen offset:1056 nt lds
v_mfma_f32_16x16x32_bf16 v[212:215], a[88:91], v[208:211], v[212:215]
ds_write_b32 v172, v25 offset:6404
v_mfma_f32_16x16x32_bf16 v[212:215], a[84:87], v[200:203], v[212:215]
s_nop 1
v_cvt_pk_bf16_f32 v32, v204, v205
v_mfma_f32_16x16x32_bf16 v[212:215], a[80:83], v[196:199], v[212:215]
v_cvt_pk_bf16_f32 v33, v206, v207
s_nop 0
v_mfma_f32_16x16x32_bf16 v[204:207], a[96:99], v[196:199], 0
ds_write_b32 v172, v26 offset:6464
v_mfma_f32_16x16x32_bf16 v[204:207], a[100:103], v[200:203], v[204:207]
ds_write_b32 v172, v27 offset:6468
v_mfma_f32_16x16x32_bf16 v[204:207], a[104:107], v[208:211], v[204:207]
s_nop 0
v_cvt_pk_bf16_f32 v34, v212, v213
v_cvt_pk_bf16_f32 v35, v214, v215
v_mfma_f32_16x16x32_bf16 v[204:207], a[108:111], v[216:219], v[204:207]
buffer_load_dwordx4 v241, s[16:19], s100 offen offset:2112 nt lds
v_mfma_f32_16x16x32_bf16 v[212:215], a[124:127], v[216:219], 0
buffer_load_dwordx4 v241, s[16:19], s101 offen offset:3168 nt lds
v_mfma_f32_16x16x32_bf16 v[212:215], a[120:123], v[208:211], v[212:215]
ds_write_b32 v173, v28 offset:6400
v_mfma_f32_16x16x32_bf16 v[212:215], a[116:119], v[200:203], v[212:215]
s_nop 1
v_cvt_pk_bf16_f32 v36, v204, v205
v_mfma_f32_16x16x32_bf16 v[212:215], a[112:115], v[196:199], v[212:215]
v_cvt_pk_bf16_f32 v37, v206, v207
s_nop 0
v_mfma_f32_16x16x32_bf16 v[204:207], v[196:199], a[128:131], 0
ds_write_b32 v173, v29 offset:6404
v_mfma_f32_16x16x32_bf16 v[204:207], v[200:203], a[132:135], v[204:207]
ds_write_b32 v173, v30 offset:6464
v_mfma_f32_16x16x32_bf16 v[204:207], v[208:211], a[136:139], v[204:207]
s_nop 0
v_cvt_pk_bf16_f32 v38, v212, v213
v_cvt_pk_bf16_f32 v39, v214, v215
v_mfma_f32_16x16x32_bf16 v[204:207], v[216:219], a[140:143], v[204:207]
ds_write_b32 v173, v31 offset:6468
v_mfma_f32_16x16x32_bf16 v[212:215], v[32:35], v[160:163], 0
s_nop 2
v_mfma_f32_16x16x32_bf16 v[212:215], v[36:39], v[164:167], v[212:215]
s_nop 1
v_cvt_pk_bf16_f32 v80, v204, v205
v_cvt_pk_bf16_f32 v81, v206, v207
v_mfma_f32_16x16x32_bf16 v[204:207], v[216:219], a[156:159], 0
ds_read_b128 v[220:223], v240 offset:12672
ds_read_b128 v[224:227], v240 offset:12928
v_mfma_f32_16x16x32_bf16 v[204:207], v[208:211], a[152:155], v[204:207]
ds_read_b128 v[228:231], v240 offset:13184
ds_read_b128 v[232:235], v240 offset:13440
v_mfma_f32_16x16x32_bf16 v[204:207], v[200:203], a[148:151], v[204:207]
v_exp_f32 v212, v212
v_mfma_f32_16x16x32_bf16 v[204:207], v[196:199], a[144:147], v[204:207]
v_exp_f32 v213, v213
v_mfma_f32_16x16x32_bf16 v[236:239], v[196:199], a[160:163], 0
v_exp_f32 v214, v214
v_mfma_f32_16x16x32_bf16 v[236:239], v[200:203], a[164:167], v[236:239]
v_exp_f32 v215, v215
v_mfma_f32_16x16x32_bf16 v[236:239], v[208:211], a[168:171], v[236:239]
v_cvt_pk_bf16_f32 v120, v212, v213
v_cvt_pk_bf16_f32 v121, v214, v215
v_mfma_f32_16x16x32_bf16 v[236:239], v[216:219], a[172:175], v[236:239]
v_cvt_pk_bf16_f32 v84, v204, v205
v_cvt_pk_bf16_f32 v85, v206, v207
v_mfma_f32_16x16x32_bf16 v[204:207], v[216:219], a[188:191], 0
s_nop 2
v_mfma_f32_16x16x32_bf16 v[204:207], v[208:211], a[184:187], v[204:207]
s_nop 0
v_cvt_pk_bf16_f32 v88, v236, v237
v_cvt_pk_bf16_f32 v89, v238, v239
v_mfma_f32_16x16x32_bf16 v[204:207], v[200:203], a[180:183], v[204:207]
s_waitcnt lgkmcnt(3)
v_mfma_f32_16x16x32_bf16 v[204:207], v[196:199], a[176:179], v[204:207]
s_waitcnt lgkmcnt(2)
s_nop 1
v_mfma_f32_16x16x32_bf16 v[212:215], a[64:67], v[220:223], 0
s_waitcnt vmcnt(4)
s_barrier
v_mfma_f32_16x16x32_bf16 v[212:215], a[68:71], v[224:227], v[212:215]
s_waitcnt lgkmcnt(0)
ds_read_b64_tr_b16 a[192:193], v190 offset:0
v_cvt_pk_bf16_f32 v92, v204, v205
v_mfma_f32_16x16x32_bf16 v[212:215], a[72:75], v[228:231], v[212:215]
ds_read_b64_tr_b16 a[194:195], v190 offset:512
v_cvt_pk_bf16_f32 v93, v206, v207
v_mfma_f32_16x16x32_bf16 v[212:215], a[76:79], v[232:235], v[212:215]
ds_read_b64_tr_b16 a[196:197], v190 offset:4096
s_nop 0
v_mfma_f32_16x16x32_bf16 v[204:207], a[92:95], v[232:235], 0
ds_read_b64_tr_b16 a[198:199], v190 offset:4608
s_nop 0
v_mfma_f32_16x16x32_bf16 v[204:207], a[88:91], v[228:231], v[204:207]
ds_read_b64_tr_b16 a[200:201], v190 offset:8192
v_mfma_f32_16x16x32_bf16 v[204:207], a[84:87], v[224:227], v[204:207]
ds_read_b64_tr_b16 a[202:203], v190 offset:8704
v_cvt_pk_bf16_f32 v24, v212, v213
v_mfma_f32_16x16x32_bf16 v[204:207], a[80:83], v[220:223], v[204:207]
ds_read_b64_tr_b16 a[204:205], v190 offset:12288
v_cvt_pk_bf16_f32 v25, v214, v215
v_mfma_f32_16x16x32_bf16 v[212:215], a[96:99], v[220:223], 0
ds_read_b64_tr_b16 a[206:207], v190 offset:12800
ds_read_b128 v[236:239], v245 offset:0
v_mfma_f32_16x16x32_bf16 v[212:215], a[100:103], v[224:227], v[212:215]
ds_read_b64_tr_b16 a[208:209], v190 offset:8
v_mfma_f32_16x16x32_bf16 v[212:215], a[104:107], v[228:231], v[212:215]
ds_read_b64_tr_b16 a[210:211], v190 offset:520
v_cvt_pk_bf16_f32 v26, v204, v205
v_mfma_f32_16x16x32_bf16 v[212:215], a[108:111], v[232:235], v[212:215]
ds_read_b64_tr_b16 a[212:213], v190 offset:4104
v_cvt_pk_bf16_f32 v27, v206, v207
v_mfma_f32_16x16x32_bf16 v[204:207], a[124:127], v[232:235], 0
ds_read_b64_tr_b16 a[214:215], v190 offset:4616
s_nop 0
v_mfma_f32_16x16x32_bf16 v[204:207], a[120:123], v[228:231], v[204:207]
ds_read_b64_tr_b16 a[216:217], v190 offset:8200
v_mfma_f32_16x16x32_bf16 v[204:207], a[116:119], v[224:227], v[204:207]
s_waitcnt lgkmcnt(13)
ds_read_b64_tr_b16 a[218:219], v190 offset:8712
v_cvt_pk_bf16_f32 v28, v212, v213
v_mfma_f32_16x16x32_bf16 v[204:207], a[112:115], v[220:223], v[204:207]
s_waitcnt lgkmcnt(13)
ds_read_b64_tr_b16 a[220:221], v190 offset:12296
v_cvt_pk_bf16_f32 v29, v214, v215
v_mfma_f32_16x16x32_bf16 v[212:215], v[220:223], a[128:131], 0
s_waitcnt lgkmcnt(13)
ds_read_b64_tr_b16 a[222:223], v190 offset:12808
s_nop 0
v_mfma_f32_16x16x32_bf16 v[212:215], v[224:227], a[132:135], v[212:215]
s_waitcnt lgkmcnt(13)
ds_read_b64_tr_b16 a[224:225], v191 offset:0
v_cvt_pk_bf16_f32 v30, v204, v205
v_mfma_f32_16x16x32_bf16 v[212:215], v[228:231], a[136:139], v[212:215]
s_waitcnt lgkmcnt(13)
ds_read_b64_tr_b16 a[226:227], v191 offset:512
v_cvt_pk_bf16_f32 v31, v206, v207
v_mfma_f32_16x16x32_bf16 v[212:215], v[232:235], a[140:143], v[212:215]
s_waitcnt lgkmcnt(13)
v_mov_b64 v[176:177], 0
v_mov_b64 v[178:179], 0
v_mfma_f32_16x16x32_bf16 v[204:207], v[24:27], v[160:163], 0
s_waitcnt lgkmcnt(12)
v_mov_b64 v[180:181], 0
v_mov_b64 v[182:183], 0
v_mfma_f32_16x16x32_bf16 v[204:207], v[28:31], v[164:167], v[204:207]
s_waitcnt lgkmcnt(10)
v_cvt_pk_bf16_f32 v66, v212, v213
v_cvt_pk_bf16_f32 v67, v214, v215
v_mfma_f32_16x16x32_bf16 v[212:215], v[232:235], a[156:159], 0
s_waitcnt lgkmcnt(9)
v_mov_b64 v[184:185], 0
v_mov_b64 v[186:187], 0
v_mfma_f32_16x16x32_bf16 v[212:215], v[228:231], a[152:155], v[212:215]
s_waitcnt lgkmcnt(8)
v_exp_f32 v204, v204
v_mfma_f32_16x16x32_bf16 v[212:215], v[224:227], a[148:151], v[212:215]
s_waitcnt lgkmcnt(7)
v_exp_f32 v205, v205
v_mfma_f32_16x16x32_bf16 v[212:215], v[220:223], a[144:147], v[212:215]
s_waitcnt lgkmcnt(6)
ds_read_b128 v[160:163], v240 offset:21120
v_cvt_pk_bf16_f32 v118, v204, v205
v_smfmac_f32_16x16x64_bf16 v[176:179], v[236:239], v[0:7], v250
s_waitcnt lgkmcnt(6)
ds_read_b128 v[164:167], v240 offset:21376
ds_read_b128 v[168:171], v240 offset:21632
v_smfmac_f32_16x16x64_bf16 v[180:183], v[236:239], v[16:23], v250
s_waitcnt lgkmcnt(7)
ds_read_b128 v[172:175], v240 offset:21888
v_cvt_pk_bf16_f32 v70, v212, v213
v_smfmac_f32_16x16x64_bf16 v[184:187], v[236:239], v[32:39], v250
s_waitcnt lgkmcnt(7)
v_cvt_pk_bf16_f32 v71, v214, v215
v_mfma_f32_16x16x32_bf16 v[212:215], v[220:223], a[160:163], 0
s_waitcnt lgkmcnt(6)
ds_read_b64_tr_b16 a[228:229], v191 offset:4096
v_add_f32 v176, v176, v177
v_mfma_f32_16x16x32_bf16 v[212:215], v[224:227], a[164:167], v[212:215]
s_waitcnt lgkmcnt(6)
ds_read_b64_tr_b16 a[230:231], v191 offset:4608
v_mfma_f32_16x16x32_bf16 v[212:215], v[228:231], a[168:171], v[212:215]
s_waitcnt lgkmcnt(6)
ds_read_b64_tr_b16 a[232:233], v191 offset:8192
v_mfma_f32_16x16x32_bf16 v[212:215], v[232:235], a[172:175], v[212:215]
ds_read_b64_tr_b16 a[234:235], v191 offset:8704
s_nop 0
v_smfmac_f32_16x16x64_bf16 v[178:181], v[236:239], v[8:15], v250
ds_read_b64_tr_b16 a[236:237], v191 offset:12288
s_nop 0
v_smfmac_f32_16x16x64_bf16 v[182:185], v[236:239], v[24:31], v250
ds_read_b64_tr_b16 a[238:239], v191 offset:12800
s_nop 0
v_smfmac_f32_16x16x64_bf16 v[186:189], v[236:239], v[40:47], v250
ds_read_b64_tr_b16 a[240:241], v191 offset:8
v_cvt_pk_bf16_f32 v74, v212, v213
v_mfma_f32_16x16x32_bf16 v[236:239], v[232:235], a[188:191], 0
ds_read_b64_tr_b16 a[242:243], v191 offset:520
v_mov_b64 v[212:213], 0
v_mfma_f32_16x16x32_bf16 v[236:239], v[228:231], a[184:187], v[236:239]
ds_read_b64_tr_b16 a[244:245], v191 offset:4104
v_cvt_pk_bf16_f32 v75, v214, v215
v_mfma_f32_16x16x32_bf16 v[236:239], v[224:227], a[180:183], v[236:239]
s_waitcnt lgkmcnt(12)
ds_read_b64_tr_b16 a[246:247], v191 offset:4616
ds_read_b128 v[224:227], v240 offset:512
v_mfma_f32_16x16x32_bf16 v[236:239], v[220:223], a[176:179], v[236:239]
s_waitcnt lgkmcnt(12)
ds_read_b64_tr_b16 a[248:249], v191 offset:8200
v_exp_f32 v206, v206
v_exp_f32 v207, v207
s_nop 0
v_cvt_pk_bf16_f32 v119, v206, v207
v_add_f32 v178, v178, v179
v_add_f32 v180, v180, v181
v_smfmac_f32_16x16x64_bf16 v[212:215], v[192:195], v[112:119], v250
s_waitcnt lgkmcnt(11)
ds_read_b64_tr_b16 a[250:251], v191 offset:8712
ds_read_b128 v[204:207], v240 offset:768
v_smfmac_f32_16x16x64_bf16 v[212:215], v[192:195], v[120:127], v250 abid:1
s_waitcnt lgkmcnt(12)
ds_read_b64_tr_b16 a[252:253], v191 offset:12296
ds_read_b128 v[220:223], v240 offset:256
v_mfma_f32_16x16x32_bf16 v[144:147], a[192:195], v[160:163], 0
s_waitcnt lgkmcnt(13)
ds_read_b64_tr_b16 a[254:255], v191 offset:12808
ds_read_b128 v[228:231], v240 offset:0
v_mfma_f32_16x16x32_bf16 v[144:147], a[196:199], v[164:167], v[144:147]
s_waitcnt lgkmcnt(14)
v_exp_f32 v176, v176
v_mfma_f32_16x16x32_bf16 v[144:147], a[200:203], v[168:171], v[144:147]
s_waitcnt lgkmcnt(13)
v_exp_f32 v178, v178
v_mfma_f32_16x16x32_bf16 v[144:147], a[204:207], v[172:175], v[144:147]
s_waitcnt lgkmcnt(12)
v_exp_f32 v180, v180
v_mfma_f32_16x16x32_bf16 v[148:151], a[220:223], v[172:175], 0
s_waitcnt lgkmcnt(11)
v_add_f32 v182, v182, v183
v_add_f32 v184, v184, v185
v_mfma_f32_16x16x32_bf16 v[148:151], a[216:219], v[168:171], v[148:151]
s_waitcnt lgkmcnt(10)
v_exp_f32 v182, v182
v_mfma_f32_16x16x32_bf16 v[148:151], a[212:215], v[164:167], v[148:151]
s_waitcnt lgkmcnt(1)
s_barrier
v_mfma_f32_16x16x32_bf16 v[148:151], a[208:211], v[160:163], v[148:151]
s_add_u32 s98, s98, s48
v_exp_f32 v184, v184
v_mfma_f32_16x16x32_bf16 v[152:155], a[224:227], v[160:163], 0
s_add_u32 s99, s98, s51
v_add_f32 v186, v186, v187
v_add_f32 v188, v176, v178
v_mfma_f32_16x16x32_bf16 v[152:155], a[228:231], v[164:167], v[152:155]
s_add_u32 s100, s99, s51
v_cvt_pk_bf16_f32 v177, v176, v178
v_add_f32 v188, v188, v180
v_mfma_f32_16x16x32_bf16 v[152:155], a[232:235], v[168:171], v[152:155]
s_add_u32 m0, s49, 8448
ds_write_b16 v246, v177 offset:0
s_add_u32 s101, s100, s51
v_mfma_f32_16x16x32_bf16 v[152:155], a[236:239], v[172:175], v[152:155]
buffer_load_dwordx4 v241, s[16:19], s98 offen offset:0 nt lds
v_mfma_f32_16x16x32_bf16 v[156:159], a[252:255], v[172:175], 0
buffer_load_dwordx4 v241, s[16:19], s99 offen offset:1056 nt lds
v_mfma_f32_16x16x32_bf16 v[156:159], a[244:247], v[164:167], v[156:159]
s_add_u32 s98, s98, s48
ds_write_b16_d16_hi v246, v177 offset:4
v_mfma_f32_16x16x32_bf16 v[156:159], a[240:243], v[160:163], v[156:159]
s_add_u32 s99, s98, s51
v_exp_f32 v186, v186
v_mfma_f32_16x16x32_bf16 v[156:159], a[248:251], v[168:171], v[156:159]
buffer_load_dwordx4 v241, s[16:19], s100 offen offset:2112 nt lds
v_mfma_f32_16x16x32_bf16 v[172:175], a[248:251], v[224:227], 0
buffer_load_dwordx4 v241, s[16:19], s101 offen offset:3168 nt lds
v_mfma_f32_16x16x32_bf16 v[172:175], a[252:255], v[204:207], v[172:175]
s_add_u32 s100, s99, s51
v_add_f32 v188, v188, v182
v_add_f32 v188, v188, v184
v_mfma_f32_16x16x32_bf16 v[172:175], a[244:247], v[220:223], v[172:175]
s_add_u32 m0, s49, 16896
v_add_f32 v188, v188, v186
s_waitcnt lgkmcnt(2)
v_mfma_f32_16x16x32_bf16 v[172:175], a[240:243], v[228:231], v[172:175]
s_add_u32 s101, s100, s51
v_cvt_pk_bf16_f32 v181, v180, v182
v_add_f32_dpp v188, v188, v188 row_ror:8 row_mask:0xf bank_mask:0xf
v_cvt_pk_bf16_f32 v185, v184, v186
s_nop 0
v_add_f32_dpp v188, v188, v188 row_ror:4 row_mask:0xf bank_mask:0xf
ds_write_b16 v246, v181 offset:272
ds_write_b16_d16_hi v246, v181 offset:276
ds_write_b16 v246, v185 offset:544
ds_write_b32 v249, v188 offset:0
ds_write_b16_d16_hi v246, v185 offset:548
v_cvt_pk_bf16_f32 v78, v236, v237
v_cvt_pk_bf16_f32 v79, v238, v239
v_mfma_f32_32x32x16_bf16 v[176:191], v[100:103], v[124:127], 0
s_bfe_i32 s57, s3, 0x10000
v_add_f32 v212, v212, v213
v_rcp_f32 v253, v212
v_add_u32 v243, 1600, v243
v_max3_f32 v254, v254, v212, v253
v_add_u32 v244, 1600, v244
v_mfma_f32_16x16x32_bf16 v[168:171], a[224:227], v[228:231], 0
s_and_b32 s51, s57, 13106176
v_add_u32 v245, 1600, v245
v_add_u32 v249, 1600, v249
v_mfma_f32_16x16x32_bf16 v[168:171], a[228:231], v[220:223], v[168:171]
s_and_b32 s54, s57, s5
s_add_u32 s50, s50, 13107200
s_add_u32 s52, s46, 20480
v_mfma_f32_16x16x32_bf16 v[168:171], a[232:235], v[224:227], v[168:171]
s_lshl3_add_u32 s48, s51, 8192
s_mov_b32 s47, s46
s_lshr_b32 s3, s3, 1
v_mfma_f32_16x16x32_bf16 v[168:171], a[236:239], v[204:207], v[168:171]
buffer_load_dwordx4 v241, s[16:19], s98 offen offset:0 nt lds
v_mfma_f32_16x16x32_bf16 v[164:167], a[220:223], v[204:207], 0
buffer_load_dwordx4 v241, s[16:19], s99 offen offset:1056 nt lds
v_mfma_f32_16x16x32_bf16 v[164:167], a[216:219], v[224:227], v[164:167]
s_sub_u32 s45, s45, 1
buffer_load_dwordx4 v241, s[16:19], s100 offen offset:2112 nt lds
v_mfma_f32_16x16x32_bf16 v[164:167], a[212:215], v[220:223], v[164:167]
s_sub_u32 s50, s50, s54
s_sub_u32 s49, s49, s56
s_sub_u32 s51, s51, 32
v_mfma_f32_16x16x32_bf16 v[164:167], a[208:211], v[228:231], v[164:167]
s_add_u32 s53, s46, 0
v_mfma_f32_16x16x32_bf16 v[160:163], a[192:195], v[228:231], 0
v_mfma_f32_16x16x32_bf16 v[160:163], a[196:199], v[220:223], v[160:163]
v_mfma_f32_16x16x32_bf16 v[160:163], a[200:203], v[224:227], v[160:163]
v_mfma_f32_16x16x32_bf16 v[160:163], a[204:207], v[204:207], v[160:163]
v_mfma_f32_16x16x32_bf16 v[176:179], v[48:51], v[112:115], v[176:179]
v_mfma_f32_16x16x32_bf16 v[176:179], v[64:67], v[116:119], v[176:179]
v_mfma_f32_16x16x32_bf16 v[176:179], v[80:83], v[120:123], v[176:179]
s_nop 2
v_mfma_f32_16x16x32_bf16 v[180:183], v[84:87], v[120:123], v[180:183]
s_nop 2
v_mfma_f32_16x16x32_bf16 v[180:183], v[52:55], v[112:115], v[180:183]
v_fmac_f32 v144, v176, v253
v_fmac_f32 v145, v177, v253
v_mfma_f32_16x16x32_bf16 v[180:183], v[68:71], v[116:119], v[180:183]
v_fmac_f32 v146, v178, v253
v_fmac_f32 v147, v179, v253
v_mfma_f32_16x16x32_bf16 v[184:187], v[72:75], v[116:119], v[184:187]
v_cvt_pk_bf16_f32 v144, v144, v145
v_cvt_pk_bf16_f32 v145, v146, v147
v_mfma_f32_16x16x32_bf16 v[184:187], v[88:91], v[120:123], v[184:187]
v_pk_max_i16 v144, v144, 0
v_pk_max_i16 v145, v145, 0
v_mfma_f32_16x16x32_bf16 v[184:187], v[56:59], v[112:115], v[184:187]
v_fmac_f32 v148, v180, v253
v_fmac_f32 v149, v181, v253
v_mfma_f32_16x16x32_bf16 v[188:191], v[60:63], v[112:115], v[188:191]
v_fmac_f32 v150, v182, v253
v_fmac_f32 v151, v183, v253
v_mfma_f32_16x16x32_bf16 v[188:191], v[76:79], v[116:119], v[188:191]
v_cvt_pk_bf16_f32 v146, v148, v149
v_cvt_pk_bf16_f32 v147, v150, v151
v_mfma_f32_16x16x32_bf16 v[188:191], v[92:95], v[120:123], v[188:191]
v_fmac_f32 v152, v184, v253
v_fmac_f32 v153, v185, v253
v_mfma_f32_16x16x32_bf16 v[212:215], v[24:27], v[104:107], 0
v_fmac_f32 v154, v186, v253
v_fmac_f32 v155, v187, v253
v_mfma_f32_16x16x32_bf16 v[212:215], v[28:31], v[108:111], v[212:215]
v_cvt_pk_bf16_f32 v152, v152, v153
v_cvt_pk_bf16_f32 v153, v154, v155
v_mfma_f32_16x16x32_bf16 v[220:223], v[36:39], v[108:111], 0
v_fmac_f32 v156, v188, v253
v_fmac_f32 v157, v189, v253
v_mfma_f32_16x16x32_bf16 v[220:223], v[32:35], v[104:107], v[220:223]
v_fmac_f32 v158, v190, v253
v_fmac_f32 v159, v191, v253
v_mfma_f32_16x16x32_bf16 v[224:227], v[40:43], v[104:107], 0
v_cvt_pk_bf16_f32 v154, v156, v157
v_cvt_pk_bf16_f32 v155, v158, v159
v_mfma_f32_16x16x32_bf16 v[224:227], v[44:47], v[108:111], v[224:227]
v_pk_max_i16 v146, v146, 0
v_pk_max_i16 v147, v147, 0
v_mfma_f32_16x16x32_bf16 v[228:231], a[0:3], v[196:199], 0
buffer_store_dwordx4 v[144:147], v242, s[20:23], s52 offen offset:0 nt
v_mfma_f32_16x16x32_bf16 v[228:231], a[4:7], v[200:203], v[228:231]
v_exp_f32 v220, v220
v_mfma_f32_16x16x32_bf16 v[228:231], a[8:11], v[208:211], v[228:231]
v_exp_f32 v221, v221
v_mfma_f32_16x16x32_bf16 v[228:231], a[12:15], v[216:219], v[228:231]
v_exp_f32 v222, v222
v_mfma_f32_16x16x32_bf16 v[232:235], a[28:31], v[216:219], 0
v_exp_f32 v223, v223
v_mfma_f32_16x16x32_bf16 v[232:235], a[24:27], v[208:211], v[232:235]
v_cvt_pk_bf16_f32 v136, v220, v221
v_cvt_pk_bf16_f32 v137, v222, v223
v_mfma_f32_16x16x32_bf16 v[232:235], a[20:23], v[200:203], v[232:235]
s_nop 0
v_cvt_pk_bf16_f32 v104, v228, v229
v_cvt_pk_bf16_f32 v105, v230, v231
v_mfma_f32_16x16x32_bf16 v[232:235], a[16:19], v[196:199], v[232:235]
v_exp_f32 v224, v224
v_mfma_f32_16x16x32_bf16 v[228:231], a[32:35], v[196:199], 0
v_exp_f32 v225, v225
v_mfma_f32_16x16x32_bf16 v[228:231], a[36:39], v[200:203], v[228:231]
v_exp_f32 v226, v226
v_mfma_f32_16x16x32_bf16 v[228:231], a[40:43], v[208:211], v[228:231]
v_exp_f32 v227, v227
v_mfma_f32_16x16x32_bf16 v[228:231], a[44:47], v[216:219], v[228:231]
v_pk_max_i16 v152, v152, 0
v_pk_max_i16 v153, v153, 0
v_mfma_f32_16x16x32_bf16 v[220:223], a[60:63], v[216:219], 0
v_pk_max_i16 v154, v154, 0
v_pk_max_i16 v155, v155, 0
v_mfma_f32_16x16x32_bf16 v[220:223], a[56:59], v[208:211], v[220:223]
buffer_store_dwordx4 v[152:155], v242, s[20:23], s52 offen offset:64 nt
v_cvt_pk_bf16_f32 v138, v224, v225
v_cvt_pk_bf16_f32 v139, v226, v227
v_mfma_f32_16x16x32_bf16 v[220:223], a[52:55], v[200:203], v[220:223]
v_mfma_f32_16x16x32_bf16 v[220:223], a[48:51], v[196:199], v[220:223]
v_mfma_f32_32x32x16_bf16 v[176:191], v[100:103], v[140:143], 0
s_nop 7
s_waitcnt lgkmcnt(0)
s_branch L_entryf
L_spin:
ds_read_u16 v236, v255 offset:0
s_waitcnt lgkmcnt(0)
v_cmp_lt_u32 vcc, s45, v236
s_nop 1
s_cbranch_vccnz L_spin
s_branch L_back
.p2align 6
L_loopf:
buffer_store_dwordx4 v[168:171], v242, s[20:23], s53 offen offset:64 nt
v_exp_f32 v204, v204
v_exp_f32 v205, v205
v_mfma_f32_16x16x32_bf16 v[196:199], a[60:63], v[228:231], 0
s_add_u32 s52, s47, 8192
v_cvt_pk_bf16_f32 v108, v236, v237
v_cvt_pk_bf16_f32 v109, v238, v239
v_mfma_f32_16x16x32_bf16 v[196:199], a[56:59], v[224:227], v[196:199]
s_add_u32 s53, s47, 12288
v_exp_f32 v200, v200
v_mfma_f32_16x16x32_bf16 v[196:199], a[52:55], v[220:223], v[196:199]
s_bfe_i32 s57, s3, 0x10000
v_exp_f32 v201, v201
v_mfma_f32_16x16x32_bf16 v[196:199], a[48:51], v[216:219], v[196:199]
s_mov_b32 s47, s46
v_exp_f32 v202, v202
v_mfma_f32_16x16x32_bf16 v[160:163], a[192:195], v[216:219], 0
s_and_b32 s54, s57, s5
ds_read_u16 v236, v255 offset:0
v_cvt_pk_bf16_f32 v120, v200, v201
v_mfma_f32_16x16x32_bf16 v[160:163], a[196:199], v[220:223], v[160:163]
s_lshr_b32 s3, s3, 1
v_cvt_pk_bf16_f32 v110, v196, v197
v_cvt_pk_bf16_f32 v111, v198, v199
v_mfma_f32_16x16x32_bf16 v[160:163], a[200:203], v[224:227], v[160:163]
v_exp_f32 v203, v203
v_mfma_f32_16x16x32_bf16 v[160:163], a[204:207], v[228:231], v[160:163]
v_cvt_pk_bf16_f32 v121, v202, v203
v_cvt_pk_bf16_f32 v112, v204, v205
v_mfma_f32_16x16x32_bf16 v[164:167], a[220:223], v[228:231], 0
v_exp_f32 v206, v206
v_mfma_f32_16x16x32_bf16 v[164:167], a[216:219], v[224:227], v[164:167]
v_exp_f32 v207, v207
v_mfma_f32_16x16x32_bf16 v[164:167], a[212:215], v[220:223], v[164:167]
s_waitcnt lgkmcnt(0)
v_cmp_lt_u32 vcc, s45, v236
v_cvt_pk_bf16_f32 v113, v206, v207
v_mfma_f32_16x16x32_bf16 v[164:167], a[208:211], v[216:219], v[164:167]
s_cbranch_vccnz L_spin
L_back:
ds_read_b128 v[196:199], v240 offset:0
ds_read_b128 v[204:207], v240 offset:256
v_mfma_f32_16x16x32_bf16 v[168:171], a[224:227], v[216:219], 0
s_mov_b32 s98, s50
ds_read_b128 v[236:239], v240 offset:512
s_add_u32 s99, s98, s51
v_mfma_f32_16x16x32_bf16 v[168:171], a[228:231], v[220:223], v[168:171]
s_add_u32 s100, s99, s51
v_exp_f32 v212, v212
v_mfma_f32_16x16x32_bf16 v[168:171], a[232:235], v[224:227], v[168:171]
s_add_u32 m0, s49, 0
v_exp_f32 v213, v213
v_mfma_f32_16x16x32_bf16 v[168:171], a[236:239], v[228:231], v[168:171]
s_add_u32 s101, s100, s51
v_exp_f32 v214, v214
v_mfma_f32_16x16x32_bf16 v[172:175], a[252:255], v[228:231], 0
s_sub_u32 s45, s45, 1
v_exp_f32 v215, v215
v_mfma_f32_16x16x32_bf16 v[172:175], a[248:251], v[224:227], v[172:175]
s_waitcnt lgkmcnt(2)
v_mov_b64 v[224:225], s[96:97]
v_mov_b64 v[226:227], s[96:97]
v_mfma_f32_16x16x32_bf16 v[172:175], a[244:247], v[220:223], v[172:175]
s_waitcnt lgkmcnt(0)
v_cvt_pk_bf16_f32 v114, v212, v213
v_cvt_pk_bf16_f32 v115, v214, v215
v_mfma_f32_16x16x32_bf16 v[172:175], a[240:243], v[216:219], v[172:175]
s_add_u32 s50, s50, 13107200
ds_read_b128 v[212:215], v240 offset:768
s_sub_u32 s50, s50, s54
v_smfmac_f32_16x16x64_bf16 v[224:227], v[96:99], v[104:111], v250
s_nop 2
v_mfma_f32_16x16x32_bf16 v[216:219], v[0:3], v[104:107], 0
v_exp_f32 v208, v208
v_mfma_f32_16x16x32_bf16 v[216:219], v[4:7], v[108:111], v[216:219]
v_exp_f32 v209, v209
v_mfma_f32_16x16x32_bf16 v[220:223], v[36:39], v[108:111], 0
v_exp_f32 v210, v210
v_mfma_f32_16x16x32_bf16 v[220:223], v[32:35], v[104:107], v[220:223]
v_exp_f32 v211, v211
v_mfma_f32_16x16x32_bf16 v[200:203], a[64:67], v[196:199], 0
v_cvt_pk_bf16_f32 v116, v208, v209
v_cvt_pk_bf16_f32 v117, v210, v211
v_mfma_f32_16x16x32_bf16 v[200:203], a[68:71], v[204:207], v[200:203]
s_waitcnt lgkmcnt(0)
v_add_f32 v224, v224, v225
v_add_f32 v226, v226, v227
v_mfma_f32_16x16x32_bf16 v[200:203], a[72:75], v[236:239], v[200:203]
v_exp_f32 v224, v224
v_mfma_f32_16x16x32_bf16 v[200:203], a[76:79], v[212:215], v[200:203]
buffer_load_dwordx4 v241, s[16:19], s98 offen offset:0 nt lds
v_mfma_f32_16x16x32_bf16 v[208:211], a[92:95], v[212:215], 0
s_add_u32 s98, s98, s48
v_exp_f32 v226, v226
v_mfma_f32_16x16x32_bf16 v[208:211], a[88:91], v[236:239], v[208:211]
v_perm_b32 v140, v226, v224, v251
v_perm_b32 v141, v226, v224, v252
v_mfma_f32_16x16x32_bf16 v[208:211], a[84:87], v[204:207], v[208:211]
v_exp_f32 v232, v232
v_mfma_f32_16x16x32_bf16 v[208:211], a[80:83], v[196:199], v[208:211]
v_exp_f32 v233, v233
v_mfma_f32_16x16x32_bf16 v[228:231], a[96:99], v[196:199], 0
v_exp_f32 v234, v234
v_mfma_f32_16x16x32_bf16 v[228:231], a[100:103], v[204:207], v[228:231]
v_mov_b64 v[224:225], 0
v_cvt_pk_bf16_f32 v122, v232, v233
v_mfma_f32_16x16x32_bf16 v[228:231], a[104:107], v[236:239], v[228:231]
s_nop 0
v_cvt_pk_bf16_f32 v2, v208, v209
v_cvt_pk_bf16_f32 v3, v210, v211
v_mfma_f32_16x16x32_bf16 v[228:231], a[108:111], v[212:215], v[228:231]
v_exp_f32 v235, v235
v_mfma_f32_16x16x32_bf16 v[208:211], a[124:127], v[212:215], 0
ds_read_b128 v[212:215], v240 offset:17408
v_cvt_pk_bf16_f32 v123, v234, v235
v_mfma_f32_16x16x32_bf16 v[208:211], a[120:123], v[236:239], v[208:211]
ds_read_b128 v[232:235], v240 offset:17152
v_cvt_pk_bf16_f32 v0, v200, v201
v_mfma_f32_16x16x32_bf16 v[208:211], a[116:119], v[204:207], v[208:211]
v_exp_f32 v220, v220
v_mfma_f32_16x16x32_bf16 v[208:211], a[112:115], v[196:199], v[208:211]
v_exp_f32 v221, v221
v_smfmac_f32_16x16x64_bf16 v[224:227], v[192:195], v[112:119], v250
v_cvt_pk_bf16_f32 v136, v220, v221
v_smfmac_f32_16x16x64_bf16 v[224:227], v[192:195], v[120:127], v250 abid:1
v_cvt_pk_bf16_f32 v4, v228, v229
v_mfma_f32_16x16x32_bf16 v[176:179], v[80:83], v[120:123], v[176:179]
v_exp_f32 v222, v222
v_mfma_f32_16x16x32_bf16 v[176:179], v[64:67], v[116:119], v[176:179]
v_exp_f32 v223, v223
v_mfma_f32_16x16x32_bf16 v[176:179], v[48:51], v[112:115], v[176:179]
v_cvt_pk_bf16_f32 v137, v222, v223
v_cvt_pk_bf16_f32 v5, v230, v231
v_mfma_f32_16x16x32_bf16 v[180:183], v[52:55], v[112:115], v[180:183]
v_add_f32 v224, v224, v225
v_cvt_pk_bf16_f32 v1, v202, v203
v_mfma_f32_16x16x32_bf16 v[180:183], v[68:71], v[116:119], v[180:183]
ds_read_b128 v[200:203], v240 offset:16896
v_cvt_pk_bf16_f32 v6, v208, v209
v_mfma_f32_16x16x32_bf16 v[180:183], v[84:87], v[120:123], v[180:183]
buffer_load_dwordx4 v241, s[16:19], s99 offen offset:1056 nt lds
v_mfma_f32_16x16x32_bf16 v[184:187], v[88:91], v[120:123], v[184:187]
s_add_u32 s99, s98, s51
v_rcp_f32 v253, v224
v_mfma_f32_16x16x32_bf16 v[184:187], v[72:75], v[116:119], v[184:187]
s_waitcnt lgkmcnt(2)
v_max3_f32 v254, v254, v224, v253
v_cvt_pk_bf16_f32 v7, v210, v211
v_mfma_f32_16x16x32_bf16 v[184:187], v[56:59], v[112:115], v[184:187]
s_waitcnt lgkmcnt(1)
v_exp_f32 v216, v216
v_mfma_f32_16x16x32_bf16 v[188:191], v[60:63], v[112:115], v[188:191]
v_exp_f32 v217, v217
v_mfma_f32_16x16x32_bf16 v[188:191], v[76:79], v[116:119], v[188:191]
v_exp_f32 v218, v218
v_mfma_f32_16x16x32_bf16 v[188:191], v[92:95], v[120:123], v[188:191]
v_exp_f32 v219, v219
v_mfma_f32_16x16x32_bf16 v[196:199], v[12:15], v[108:111], 0
v_cvt_pk_bf16_f32 v128, v216, v217
v_cvt_pk_bf16_f32 v129, v218, v219
v_mfma_f32_16x16x32_bf16 v[196:199], v[8:11], v[104:107], v[196:199]
ds_read_b128 v[216:219], v240 offset:17664
v_fmac_f32 v144, v176, v253
v_mfma_f32_16x16x32_bf16 v[204:207], v[16:19], v[104:107], 0
v_fmac_f32 v145, v177, v253
v_fmac_f32 v146, v178, v253
v_mfma_f32_16x16x32_bf16 v[204:207], v[20:23], v[108:111], v[204:207]
v_fmac_f32 v147, v179, v253
v_fmac_f32 v148, v180, v253
v_mfma_f32_16x16x32_bf16 v[220:223], v[28:31], v[108:111], 0
v_exp_f32 v196, v196
v_mfma_f32_16x16x32_bf16 v[220:223], v[24:27], v[104:107], v[220:223]
s_waitcnt lgkmcnt(1)
v_exp_f32 v197, v197
v_mfma_f32_16x16x32_bf16 v[224:227], v[40:43], v[104:107], 0
v_exp_f32 v204, v204
v_mfma_f32_16x16x32_bf16 v[224:227], v[44:47], v[108:111], v[224:227]
s_waitcnt lgkmcnt(0)
v_exp_f32 v205, v205
v_mfma_f32_16x16x32_bf16 v[228:231], a[124:127], v[216:219], 0
v_exp_f32 v206, v206
v_mfma_f32_16x16x32_bf16 v[228:231], a[120:123], v[212:215], v[228:231]
v_exp_f32 v207, v207
v_mfma_f32_16x16x32_bf16 v[228:231], a[116:119], v[232:235], v[228:231]
v_cvt_pk_bf16_f32 v132, v204, v205
v_cvt_pk_bf16_f32 v133, v206, v207
v_mfma_f32_16x16x32_bf16 v[228:231], a[112:115], v[200:203], v[228:231]
v_exp_f32 v198, v198
v_mfma_f32_16x16x32_bf16 v[208:211], a[96:99], v[200:203], 0
v_exp_f32 v199, v199
v_mfma_f32_16x16x32_bf16 v[208:211], a[100:103], v[232:235], v[208:211]
v_cvt_pk_bf16_f32 v130, v196, v197
v_cvt_pk_bf16_f32 v131, v198, v199
v_mfma_f32_16x16x32_bf16 v[208:211], a[104:107], v[212:215], v[208:211]
ds_read_b128 v[196:199], v240 offset:4224
v_cvt_pk_bf16_f32 v38, v228, v229
v_mfma_f32_16x16x32_bf16 v[208:211], a[108:111], v[216:219], v[208:211]
buffer_load_dwordx4 v241, s[16:19], s100 offen offset:2112 nt lds
v_mfma_f32_16x16x32_bf16 v[236:239], a[92:95], v[216:219], 0
s_add_u32 s100, s99, s51
v_cvt_pk_bf16_f32 v39, v230, v231
v_fmac_f32 v149, v181, v253
v_mfma_f32_16x16x32_bf16 v[236:239], a[88:91], v[212:215], v[236:239]
ds_read_b128 v[228:231], v240 offset:4480
v_fmac_f32 v150, v182, v253
v_mfma_f32_16x16x32_bf16 v[236:239], a[84:87], v[232:235], v[236:239]
v_cvt_pk_bf16_f32 v36, v208, v209
v_cvt_pk_bf16_f32 v37, v210, v211
v_mfma_f32_16x16x32_bf16 v[236:239], a[80:83], v[200:203], v[236:239]
ds_read_b128 v[208:211], v240 offset:4992
v_fmac_f32 v151, v183, v253
v_mfma_f32_16x16x32_bf16 v[204:207], a[64:67], v[200:203], 0
s_waitcnt lgkmcnt(2)
ds_read_b128 v[200:203], v240 offset:4736
v_fmac_f32 v152, v184, v253
v_mfma_f32_16x16x32_bf16 v[204:207], a[72:75], v[212:215], v[204:207]
v_fmac_f32 v153, v185, v253
v_fmac_f32 v154, v186, v253
v_mfma_f32_16x16x32_bf16 v[204:207], a[76:79], v[216:219], v[204:207]
v_fmac_f32 v155, v187, v253
v_fmac_f32 v156, v188, v253
v_mfma_f32_16x16x32_bf16 v[204:207], a[68:71], v[232:235], v[204:207]
s_waitcnt lgkmcnt(2)
v_fmac_f32 v157, v189, v253
v_fmac_f32 v158, v190, v253
v_mfma_f32_16x16x32_bf16 v[212:215], a[68:71], v[228:231], 0
v_fmac_f32 v159, v191, v253
v_cvt_pk_bf16_f32 v144, v144, v145
v_mfma_f32_16x16x32_bf16 v[212:215], a[64:67], v[196:199], v[212:215]
s_waitcnt lgkmcnt(1)
v_cvt_pk_bf16_f32 v32, v204, v205
s_waitcnt lgkmcnt(0)
v_mfma_f32_16x16x32_bf16 v[212:215], a[72:75], v[200:203], v[212:215]
v_cvt_pk_bf16_f32 v33, v206, v207
v_cvt_pk_bf16_f32 v152, v152, v153
v_mfma_f32_16x16x32_bf16 v[212:215], a[76:79], v[208:211], v[212:215]
v_cvt_pk_bf16_f32 v145, v146, v147
v_cvt_pk_bf16_f32 v153, v154, v155
v_mfma_f32_16x16x32_bf16 v[216:219], a[92:95], v[208:211], 0
v_cvt_pk_bf16_f32 v146, v148, v149
v_cvt_pk_bf16_f32 v147, v150, v151
v_mfma_f32_16x16x32_bf16 v[216:219], a[88:91], v[200:203], v[216:219]
v_cvt_pk_bf16_f32 v154, v156, v157
v_cvt_pk_bf16_f32 v155, v158, v159
v_mfma_f32_16x16x32_bf16 v[216:219], a[84:87], v[228:231], v[216:219]
v_pk_max_i16 v144, v144, 0
v_pk_max_i16 v145, v145, 0
v_mfma_f32_16x16x32_bf16 v[216:219], a[80:83], v[196:199], v[216:219]
v_pk_max_i16 v146, v146, 0
v_pk_max_i16 v147, v147, 0
v_mfma_f32_16x16x32_bf16 v[204:207], a[96:99], v[196:199], 0
v_pk_max_i16 v152, v152, 0
v_pk_max_i16 v153, v153, 0
v_mfma_f32_16x16x32_bf16 v[204:207], a[100:103], v[228:231], v[204:207]
v_pk_max_i16 v154, v154, 0
v_pk_max_i16 v155, v155, 0
v_mfma_f32_16x16x32_bf16 v[204:207], a[104:107], v[200:203], v[204:207]
v_exp_f32 v220, v220
v_mfma_f32_16x16x32_bf16 v[204:207], a[108:111], v[208:211], v[204:207]
v_exp_f32 v221, v221
v_mfma_f32_32x32x16_bf16 v[176:191], v[100:103], v[140:143], 0
buffer_store_dwordx4 v[144:147], v242, s[20:23], s52 offen offset:0 nt
buffer_store_dwordx4 v[152:155], v242, s[20:23], s52 offen offset:64 nt
v_exp_f32 v222, v222
v_exp_f32 v223, v223
s_nop 1
v_cvt_pk_bf16_f32 v12, v204, v205
v_cvt_pk_bf16_f32 v13, v206, v207
v_mfma_f32_16x16x32_bf16 v[204:207], a[124:127], v[208:211], 0
s_add_u32 s52, s46, 20480
v_cvt_pk_bf16_f32 v8, v212, v213
v_cvt_pk_bf16_f32 v134, v220, v221
v_mfma_f32_16x16x32_bf16 v[204:207], a[120:123], v[200:203], v[204:207]
v_cvt_pk_bf16_f32 v135, v222, v223
v_mov_b64 v[212:213], 0
v_mfma_f32_16x16x32_bf16 v[204:207], a[116:119], v[228:231], v[204:207]
v_cvt_pk_bf16_f32 v9, v214, v215
v_cvt_pk_bf16_f32 v10, v216, v217
v_mfma_f32_16x16x32_bf16 v[204:207], a[112:115], v[196:199], v[204:207]
v_exp_f32 v224, v224
v_smfmac_f32_16x16x64_bf16 v[212:215], v[192:195], v[128:135], v250
v_exp_f32 v225, v225
v_exp_f32 v226, v226
v_exp_f32 v227, v227
v_cvt_pk_bf16_f32 v138, v224, v225
v_cvt_pk_bf16_f32 v139, v226, v227
v_cvt_pk_bf16_f32 v11, v218, v219
v_cvt_pk_bf16_f32 v14, v204, v205
v_smfmac_f32_16x16x64_bf16 v[212:215], v[192:195], v[136:143], v250 abid:1
v_cvt_pk_bf16_f32 v15, v206, v207
v_mfma_f32_16x16x32_bf16 v[176:179], v[80:83], v[136:139], v[176:179]
v_cvt_pk_bf16_f32 v34, v236, v237
v_cvt_pk_bf16_f32 v35, v238, v239
v_mfma_f32_16x16x32_bf16 v[176:179], v[64:67], v[132:135], v[176:179]
s_nop 1
v_mfma_f32_16x16x32_bf16 v[176:179], v[48:51], v[128:131], v[176:179]
v_add_f32 v212, v212, v213
v_mfma_f32_16x16x32_bf16 v[180:183], v[52:55], v[128:131], v[180:183]
v_rcp_f32 v253, v212
v_mfma_f32_16x16x32_bf16 v[180:183], v[68:71], v[132:135], v[180:183]
v_max3_f32 v254, v254, v212, v253
s_nop 0
v_mfma_f32_16x16x32_bf16 v[180:183], v[84:87], v[136:139], v[180:183]
s_nop 0
v_fmac_f32 v160, v176, v253
v_fmac_f32 v161, v177, v253
v_mfma_f32_16x16x32_bf16 v[184:187], v[88:91], v[136:139], v[184:187]
v_fmac_f32 v162, v178, v253
v_fmac_f32 v163, v179, v253
v_mfma_f32_16x16x32_bf16 v[184:187], v[72:75], v[132:135], v[184:187]
s_nop 0
v_fmac_f32 v164, v180, v253
v_fmac_f32 v165, v181, v253
v_mfma_f32_16x16x32_bf16 v[184:187], v[56:59], v[128:131], v[184:187]
v_fmac_f32 v166, v182, v253
v_fmac_f32 v167, v183, v253
v_mfma_f32_16x16x32_bf16 v[188:191], v[60:63], v[128:131], v[188:191]
v_cvt_pk_bf16_f32 v160, v160, v161
v_cvt_pk_bf16_f32 v161, v162, v163
v_mfma_f32_16x16x32_bf16 v[188:191], v[76:79], v[132:135], v[188:191]
v_cvt_pk_bf16_f32 v162, v164, v165
v_cvt_pk_bf16_f32 v163, v166, v167
v_mfma_f32_16x16x32_bf16 v[188:191], v[92:95], v[136:139], v[188:191]
v_fmac_f32 v168, v184, v253
v_fmac_f32 v169, v185, v253
v_mfma_f32_16x16x32_bf16 v[204:207], v[196:199], a[128:131], 0
v_fmac_f32 v170, v186, v253
v_fmac_f32 v171, v187, v253
v_mfma_f32_16x16x32_bf16 v[204:207], v[228:231], a[132:135], v[204:207]
v_cvt_pk_bf16_f32 v168, v168, v169
v_cvt_pk_bf16_f32 v169, v170, v171
v_mfma_f32_16x16x32_bf16 v[204:207], v[200:203], a[136:139], v[204:207]
v_fmac_f32 v172, v188, v253
v_fmac_f32 v173, v189, v253
v_mfma_f32_16x16x32_bf16 v[204:207], v[208:211], a[140:143], v[204:207]
v_fmac_f32 v174, v190, v253
v_fmac_f32 v175, v191, v253
v_mfma_f32_16x16x32_bf16 v[212:215], v[208:211], a[156:159], 0
ds_read_b128 v[216:219], v240 offset:8960
ds_read_b128 v[220:223], v240 offset:9216
v_mfma_f32_16x16x32_bf16 v[212:215], v[200:203], a[152:155], v[212:215]
ds_read_b128 v[224:227], v240 offset:8704
ds_read_b128 v[232:235], v240 offset:8448
v_mfma_f32_16x16x32_bf16 v[212:215], v[228:231], a[148:151], v[212:215]
v_cvt_pk_bf16_f32 v50, v204, v205
v_cvt_pk_bf16_f32 v51, v206, v207
v_mfma_f32_16x16x32_bf16 v[212:215], v[196:199], a[144:147], v[212:215]
v_cvt_pk_bf16_f32 v170, v172, v173
v_cvt_pk_bf16_f32 v171, v174, v175
v_mfma_f32_16x16x32_bf16 v[204:207], v[196:199], a[160:163], 0
v_pk_max_i16 v160, v160, 0
v_pk_max_i16 v161, v161, 0
v_mfma_f32_16x16x32_bf16 v[204:207], v[228:231], a[164:167], v[204:207]
v_pk_max_i16 v162, v162, 0
v_pk_max_i16 v163, v163, 0
v_mfma_f32_16x16x32_bf16 v[204:207], v[200:203], a[168:171], v[204:207]
v_cvt_pk_bf16_f32 v54, v212, v213
v_cvt_pk_bf16_f32 v55, v214, v215
v_mfma_f32_16x16x32_bf16 v[204:207], v[208:211], a[172:175], v[204:207]
v_pk_max_i16 v168, v168, 0
v_pk_max_i16 v169, v169, 0
v_mfma_f32_16x16x32_bf16 v[212:215], v[208:211], a[188:191], 0
v_pk_max_i16 v170, v170, 0
v_pk_max_i16 v171, v171, 0
v_mfma_f32_16x16x32_bf16 v[212:215], v[228:231], a[180:183], v[212:215]
s_nop 1
v_cvt_pk_bf16_f32 v58, v204, v205
v_mfma_f32_16x16x32_bf16 v[212:215], v[196:199], a[176:179], v[212:215]
s_waitcnt lgkmcnt(3)
v_cvt_pk_bf16_f32 v59, v206, v207
v_mfma_f32_16x16x32_bf16 v[212:215], v[200:203], a[184:187], v[212:215]
buffer_load_dwordx4 v241, s[16:19], s101 offen offset:3168 nt lds
v_mfma_f32_16x16x32_bf16 v[196:199], v[216:219], a[184:187], 0
s_add_u32 m0, s49, 8448
s_add_u32 s101, s100, s51
s_waitcnt lgkmcnt(2)
v_mfma_f32_16x16x32_bf16 v[196:199], v[220:223], a[188:191], v[196:199]
s_waitcnt lgkmcnt(0)
s_nop 0
v_cvt_pk_bf16_f32 v62, v212, v213
v_mfma_f32_16x16x32_bf16 v[196:199], v[224:227], a[180:183], v[196:199]
v_cvt_pk_bf16_f32 v63, v214, v215
v_mfma_f32_16x16x32_bf16 v[196:199], v[232:235], a[176:179], v[196:199]
s_nop 2
v_mfma_f32_16x16x32_bf16 v[200:203], v[232:235], a[160:163], 0
s_nop 2
v_mfma_f32_16x16x32_bf16 v[200:203], v[224:227], a[164:167], v[200:203]
v_cvt_pk_bf16_f32 v76, v196, v197
v_cvt_pk_bf16_f32 v77, v198, v199
v_mfma_f32_16x16x32_bf16 v[200:203], v[216:219], a[168:171], v[200:203]
v_mfma_f32_16x16x32_bf16 v[200:203], v[220:223], a[172:175], v[200:203]
s_nop 2
v_mfma_f32_16x16x32_bf16 v[196:199], v[220:223], a[156:159], 0
s_nop 2
v_mfma_f32_16x16x32_bf16 v[196:199], v[216:219], a[152:155], v[196:199]
v_cvt_pk_bf16_f32 v72, v200, v201
v_cvt_pk_bf16_f32 v73, v202, v203
v_mfma_f32_16x16x32_bf16 v[196:199], v[224:227], a[148:151], v[196:199]
v_mfma_f32_16x16x32_bf16 v[196:199], v[232:235], a[144:147], v[196:199]
s_nop 2
v_mfma_f32_16x16x32_bf16 v[200:203], v[232:235], a[128:131], 0
s_nop 2
v_mfma_f32_16x16x32_bf16 v[200:203], v[224:227], a[132:135], v[200:203]
v_cvt_pk_bf16_f32 v68, v196, v197
v_cvt_pk_bf16_f32 v69, v198, v199
v_mfma_f32_16x16x32_bf16 v[200:203], v[216:219], a[136:139], v[200:203]
v_mfma_f32_16x16x32_bf16 v[200:203], v[220:223], a[140:143], v[200:203]
s_nop 2
v_mfma_f32_16x16x32_bf16 v[196:199], a[64:67], v[232:235], 0
s_nop 2
v_mfma_f32_16x16x32_bf16 v[196:199], a[68:71], v[224:227], v[196:199]
v_cvt_pk_bf16_f32 v64, v200, v201
v_cvt_pk_bf16_f32 v65, v202, v203
v_mfma_f32_16x16x32_bf16 v[196:199], a[72:75], v[216:219], v[196:199]
v_mfma_f32_16x16x32_bf16 v[196:199], a[76:79], v[220:223], v[196:199]
s_nop 2
v_mfma_f32_16x16x32_bf16 v[200:203], a[92:95], v[220:223], 0
ds_read_b128 v[204:207], v240 offset:13184
ds_read_b128 v[208:211], v240 offset:13440
v_mfma_f32_16x16x32_bf16 v[200:203], a[88:91], v[216:219], v[200:203]
ds_read_b128 v[212:215], v240 offset:12928
v_cvt_pk_bf16_f32 v16, v196, v197
v_mfma_f32_16x16x32_bf16 v[200:203], a[84:87], v[224:227], v[200:203]
ds_read_b128 v[228:231], v240 offset:12672
v_cvt_pk_bf16_f32 v17, v198, v199
v_mfma_f32_16x16x32_bf16 v[200:203], a[80:83], v[232:235], v[200:203]
buffer_load_dwordx4 v241, s[16:19], s98 offen offset:0 nt lds
v_mfma_f32_16x16x32_bf16 v[196:199], a[96:99], v[232:235], 0
s_add_u32 s98, s98, s48
s_nop 1
v_mfma_f32_16x16x32_bf16 v[196:199], a[100:103], v[224:227], v[196:199]
s_nop 1
v_cvt_pk_bf16_f32 v18, v200, v201
v_mfma_f32_16x16x32_bf16 v[196:199], a[104:107], v[216:219], v[196:199]
v_cvt_pk_bf16_f32 v19, v202, v203
v_mfma_f32_16x16x32_bf16 v[196:199], a[108:111], v[220:223], v[196:199]
s_nop 2
v_mfma_f32_16x16x32_bf16 v[200:203], a[124:127], v[220:223], 0
s_nop 2
v_mfma_f32_16x16x32_bf16 v[200:203], a[116:119], v[224:227], v[200:203]
v_cvt_pk_bf16_f32 v20, v196, v197
v_cvt_pk_bf16_f32 v21, v198, v199
v_mfma_f32_16x16x32_bf16 v[200:203], a[112:115], v[232:235], v[200:203]
s_waitcnt lgkmcnt(3)
v_mfma_f32_16x16x32_bf16 v[200:203], a[120:123], v[216:219], v[200:203]
s_waitcnt lgkmcnt(2)
s_nop 1
v_mfma_f32_16x16x32_bf16 v[196:199], a[120:123], v[204:207], 0
s_waitcnt lgkmcnt(1)
s_nop 1
v_mfma_f32_16x16x32_bf16 v[196:199], a[124:127], v[208:211], v[196:199]
s_waitcnt lgkmcnt(0)
v_cvt_pk_bf16_f32 v22, v200, v201
v_cvt_pk_bf16_f32 v23, v202, v203
v_mfma_f32_16x16x32_bf16 v[196:199], a[116:119], v[212:215], v[196:199]
v_mfma_f32_16x16x32_bf16 v[196:199], a[112:115], v[228:231], v[196:199]
s_nop 2
v_mfma_f32_16x16x32_bf16 v[200:203], a[96:99], v[228:231], 0
s_nop 2
v_mfma_f32_16x16x32_bf16 v[200:203], a[100:103], v[212:215], v[200:203]
v_cvt_pk_bf16_f32 v30, v196, v197
v_cvt_pk_bf16_f32 v31, v198, v199
v_mfma_f32_16x16x32_bf16 v[200:203], a[104:107], v[204:207], v[200:203]
v_mfma_f32_16x16x32_bf16 v[200:203], a[108:111], v[208:211], v[200:203]
s_nop 2
v_mfma_f32_16x16x32_bf16 v[196:199], a[92:95], v[208:211], 0
s_nop 2
v_mfma_f32_16x16x32_bf16 v[196:199], a[88:91], v[204:207], v[196:199]
v_cvt_pk_bf16_f32 v28, v200, v201
v_cvt_pk_bf16_f32 v29, v202, v203
v_mfma_f32_16x16x32_bf16 v[196:199], a[84:87], v[212:215], v[196:199]
v_mfma_f32_16x16x32_bf16 v[196:199], a[80:83], v[228:231], v[196:199]
s_nop 2
v_mfma_f32_16x16x32_bf16 v[200:203], a[64:67], v[228:231], 0
s_nop 2
v_mfma_f32_16x16x32_bf16 v[200:203], a[68:71], v[212:215], v[200:203]
v_cvt_pk_bf16_f32 v26, v196, v197
v_cvt_pk_bf16_f32 v27, v198, v199
v_mfma_f32_16x16x32_bf16 v[200:203], a[72:75], v[204:207], v[200:203]
v_mfma_f32_16x16x32_bf16 v[200:203], a[76:79], v[208:211], v[200:203]
s_nop 2
v_mfma_f32_16x16x32_bf16 v[196:199], v[228:231], a[128:131], 0
s_nop 2
v_mfma_f32_16x16x32_bf16 v[196:199], v[212:215], a[132:135], v[196:199]
v_cvt_pk_bf16_f32 v24, v200, v201
v_cvt_pk_bf16_f32 v25, v202, v203
v_mfma_f32_16x16x32_bf16 v[196:199], v[204:207], a[136:139], v[196:199]
v_mfma_f32_16x16x32_bf16 v[196:199], v[208:211], a[140:143], v[196:199]
buffer_load_dwordx4 v241, s[16:19], s99 offen offset:1056 nt lds
v_mfma_f32_16x16x32_bf16 v[200:203], v[208:211], a[156:159], 0
s_add_u32 s99, s98, s51
ds_read_b128 v[216:219], v240 offset:21120
ds_read_b128 v[220:223], v240 offset:21376
v_mfma_f32_16x16x32_bf16 v[200:203], v[204:207], a[152:155], v[200:203]
ds_read_b128 v[224:227], v240 offset:21632
ds_read_b128 v[232:235], v240 offset:21888
v_mfma_f32_16x16x32_bf16 v[200:203], v[212:215], a[148:151], v[200:203]
v_cvt_pk_bf16_f32 v66, v196, v197
v_cvt_pk_bf16_f32 v67, v198, v199
v_mfma_f32_16x16x32_bf16 v[200:203], v[228:231], a[144:147], v[200:203]
s_nop 2
v_mfma_f32_16x16x32_bf16 v[196:199], v[228:231], a[160:163], 0
s_nop 2
v_mfma_f32_16x16x32_bf16 v[196:199], v[212:215], a[164:167], v[196:199]
v_cvt_pk_bf16_f32 v70, v200, v201
v_cvt_pk_bf16_f32 v71, v202, v203
v_mfma_f32_16x16x32_bf16 v[196:199], v[204:207], a[168:171], v[196:199]
v_mfma_f32_16x16x32_bf16 v[196:199], v[208:211], a[172:175], v[196:199]
s_nop 2
v_mfma_f32_16x16x32_bf16 v[200:203], v[208:211], a[188:191], 0
s_nop 2
v_mfma_f32_16x16x32_bf16 v[200:203], v[204:207], a[184:187], v[200:203]
v_cvt_pk_bf16_f32 v74, v196, v197
v_cvt_pk_bf16_f32 v75, v198, v199
v_mfma_f32_16x16x32_bf16 v[200:203], v[212:215], a[180:183], v[200:203]
s_waitcnt lgkmcnt(3)
v_mfma_f32_16x16x32_bf16 v[200:203], v[228:231], a[176:179], v[200:203]
s_waitcnt lgkmcnt(2)
s_nop 1
v_mfma_f32_16x16x32_bf16 v[196:199], a[64:67], v[216:219], 0
s_waitcnt lgkmcnt(1)
s_nop 1
v_mfma_f32_16x16x32_bf16 v[196:199], a[68:71], v[220:223], v[196:199]
s_waitcnt lgkmcnt(0)
v_cvt_pk_bf16_f32 v78, v200, v201
v_cvt_pk_bf16_f32 v79, v202, v203
v_mfma_f32_16x16x32_bf16 v[196:199], a[72:75], v[224:227], v[196:199]
v_mfma_f32_16x16x32_bf16 v[196:199], a[76:79], v[232:235], v[196:199]
ds_read_b128 v[96:99], v243 offset:0
ds_read2_b32 v[100:101], v244 offset0:0 offset1:8
v_mfma_f32_16x16x32_bf16 v[200:203], a[92:95], v[232:235], 0
v_add_u32 v243, 1600, v243
v_add_u32 v244, 1600, v244
v_mfma_f32_16x16x32_bf16 v[200:203], a[88:91], v[224:227], v[200:203]
s_nop 1
v_cvt_pk_bf16_f32 v40, v196, v197
v_mfma_f32_16x16x32_bf16 v[200:203], a[84:87], v[220:223], v[200:203]
v_cvt_pk_bf16_f32 v41, v198, v199
v_mfma_f32_16x16x32_bf16 v[200:203], a[80:83], v[216:219], v[200:203]
s_nop 2
v_mfma_f32_16x16x32_bf16 v[196:199], a[96:99], v[216:219], 0
s_nop 2
v_mfma_f32_16x16x32_bf16 v[196:199], a[100:103], v[220:223], v[196:199]
v_cvt_pk_bf16_f32 v42, v200, v201
v_cvt_pk_bf16_f32 v43, v202, v203
v_mfma_f32_16x16x32_bf16 v[196:199], a[104:107], v[224:227], v[196:199]
v_mfma_f32_16x16x32_bf16 v[196:199], a[108:111], v[232:235], v[196:199]
ds_read_b128 v[200:203], v245 offset:0
v_add_u32 v245, 1600, v245
v_mfma_f32_16x16x32_bf16 v[204:207], a[124:127], v[232:235], 0
s_nop 2
v_mfma_f32_16x16x32_bf16 v[204:207], a[120:123], v[224:227], v[204:207]
s_nop 0
v_cvt_pk_bf16_f32 v44, v196, v197
v_cvt_pk_bf16_f32 v45, v198, v199
v_mfma_f32_16x16x32_bf16 v[204:207], a[116:119], v[220:223], v[204:207]
v_mfma_f32_16x16x32_bf16 v[204:207], a[112:115], v[216:219], v[204:207]
s_nop 2
v_mfma_f32_16x16x32_bf16 v[196:199], a[0:3], v[216:219], 0
s_waitcnt lgkmcnt(1)
s_nop 1
v_mfma_f32_16x16x32_bf16 v[196:199], a[4:7], v[220:223], v[196:199]
v_cvt_pk_bf16_f32 v46, v204, v205
v_cvt_pk_bf16_f32 v47, v206, v207
v_mfma_f32_16x16x32_bf16 v[196:199], a[8:11], v[224:227], v[196:199]
v_mfma_f32_16x16x32_bf16 v[196:199], a[12:15], v[232:235], v[196:199]
s_nop 2
v_mfma_f32_16x16x32_bf16 v[204:207], a[28:31], v[232:235], 0
s_nop 2
v_mfma_f32_16x16x32_bf16 v[204:207], a[24:27], v[224:227], v[204:207]
v_mov_b64 v[176:177], 0
v_mov_b64 v[178:179], 0
v_mfma_f32_16x16x32_bf16 v[204:207], a[20:23], v[220:223], v[204:207]
v_mov_b64 v[180:181], 0
v_mov_b64 v[182:183], 0
v_mfma_f32_16x16x32_bf16 v[204:207], a[16:19], v[216:219], v[204:207]
buffer_load_dwordx4 v241, s[16:19], s100 offen offset:2112 nt lds
v_mfma_f32_16x16x32_bf16 v[208:211], a[32:35], v[216:219], 0
s_add_u32 s100, s99, s51
v_mov_b64 v[184:185], 0
v_mov_b64 v[186:187], 0
v_mfma_f32_16x16x32_bf16 v[208:211], a[36:39], v[220:223], v[208:211]
s_waitcnt lgkmcnt(0)
v_cvt_pk_bf16_f32 v104, v196, v197
v_cvt_pk_bf16_f32 v105, v198, v199
v_mfma_f32_16x16x32_bf16 v[208:211], a[40:43], v[224:227], v[208:211]
v_cvt_pk_bf16_f32 v106, v204, v205
v_cvt_pk_bf16_f32 v107, v206, v207
v_mfma_f32_16x16x32_bf16 v[208:211], a[44:47], v[232:235], v[208:211]
s_nop 2
v_smfmac_f32_16x16x64_bf16 v[176:179], v[200:203], v[0:7], v250
s_nop 2
v_smfmac_f32_16x16x64_bf16 v[180:183], v[200:203], v[16:23], v250
v_cvt_pk_bf16_f32 v108, v208, v209
v_smfmac_f32_16x16x64_bf16 v[184:187], v[200:203], v[32:39], v250
v_cvt_pk_bf16_f32 v109, v210, v211
v_mfma_f32_16x16x32_bf16 v[196:199], a[60:63], v[232:235], 0
v_add_f32 v176, v176, v177
v_mfma_f32_16x16x32_bf16 v[196:199], a[56:59], v[224:227], v[196:199]
v_exp_f32 v176, v176
v_mfma_f32_16x16x32_bf16 v[196:199], a[52:55], v[220:223], v[196:199]
v_mfma_f32_16x16x32_bf16 v[196:199], a[48:51], v[216:219], v[196:199]
s_nop 2
v_smfmac_f32_16x16x64_bf16 v[178:181], v[200:203], v[8:15], v250
s_nop 2
v_smfmac_f32_16x16x64_bf16 v[182:185], v[200:203], v[24:31], v250
v_cvt_pk_bf16_f32 v110, v196, v197
v_smfmac_f32_16x16x64_bf16 v[186:189], v[200:203], v[40:47], v250
v_cvt_pk_bf16_f32 v111, v198, v199
v_mfma_f32_16x16x32_bf16 v[144:147], a[192:195], v[216:219], 0
v_add_f32 v178, v178, v179
v_add_f32 v180, v180, v181
v_mfma_f32_16x16x32_bf16 v[144:147], a[196:199], v[220:223], v[144:147]
v_exp_f32 v178, v178
v_mfma_f32_16x16x32_bf16 v[144:147], a[200:203], v[224:227], v[144:147]
v_exp_f32 v180, v180
v_mfma_f32_16x16x32_bf16 v[144:147], a[204:207], v[232:235], v[144:147]
buffer_load_dwordx4 v241, s[16:19], s101 offen offset:3168 nt lds
v_mfma_f32_16x16x32_bf16 v[148:151], a[220:223], v[232:235], 0
s_add_u32 m0, s49, 16896
v_add_f32 v182, v182, v183
v_add_f32 v184, v184, v185
v_mfma_f32_16x16x32_bf16 v[148:151], a[216:219], v[224:227], v[148:151]
s_add_u32 s101, s100, s51
v_exp_f32 v182, v182
v_mfma_f32_16x16x32_bf16 v[148:151], a[212:215], v[220:223], v[148:151]
s_and_b32 s51, s57, 13106176
v_exp_f32 v184, v184
v_mfma_f32_16x16x32_bf16 v[148:151], a[208:211], v[216:219], v[148:151]
s_sub_u32 s49, s49, s56
v_add_f32 v186, v186, v187
v_add_f32 v188, v176, v178
v_mfma_f32_16x16x32_bf16 v[152:155], a[224:227], v[216:219], 0
s_lshl3_add_u32 s48, s51, 8192
v_cvt_pk_bf16_f32 v177, v176, v178
v_add_f32 v188, v188, v180
v_mfma_f32_16x16x32_bf16 v[152:155], a[228:231], v[220:223], v[152:155]
s_sub_u32 s51, s51, 32
ds_write_b16 v246, v177 offset:0
v_mfma_f32_16x16x32_bf16 v[152:155], a[232:235], v[224:227], v[152:155]
ds_write_b16_d16_hi v246, v177 offset:4
v_mfma_f32_16x16x32_bf16 v[152:155], a[236:239], v[232:235], v[152:155]
v_mov_b64 v[196:197], s[96:97]
v_mov_b64 v[198:199], s[96:97]
v_mfma_f32_16x16x32_bf16 v[156:159], a[252:255], v[232:235], 0
v_exp_f32 v186, v186
v_mfma_f32_16x16x32_bf16 v[156:159], a[248:251], v[224:227], v[156:159]
v_add_f32 v188, v188, v182
v_add_f32 v188, v188, v184
v_mfma_f32_16x16x32_bf16 v[156:159], a[244:247], v[220:223], v[156:159]
v_add_f32 v188, v188, v186
v_cvt_pk_bf16_f32 v181, v180, v182
v_mfma_f32_16x16x32_bf16 v[156:159], a[240:243], v[216:219], v[156:159]
ds_write_b16 v246, v181 offset:272
v_smfmac_f32_16x16x64_bf16 v[196:199], v[96:99], v[104:111], v250
ds_write_b16_d16_hi v246, v181 offset:276
v_mfma_f32_16x16x32_bf16 v[200:203], v[0:3], v[104:107], 0
v_add_f32_dpp v188, v188, v188 row_ror:8 row_mask:0xf bank_mask:0xf
v_cvt_pk_bf16_f32 v185, v184, v186
v_mfma_f32_16x16x32_bf16 v[200:203], v[4:7], v[108:111], v[200:203]
ds_write_b16 v246, v185 offset:544
v_mfma_f32_16x16x32_bf16 v[204:207], v[216:219], a[128:131], 0
ds_write_b16_d16_hi v246, v185 offset:548
v_mfma_f32_16x16x32_bf16 v[204:207], v[220:223], a[132:135], v[204:207]
v_add_f32 v196, v196, v197
v_add_f32 v198, v198, v199
v_mfma_f32_16x16x32_bf16 v[204:207], v[224:227], a[136:139], v[204:207]
v_exp_f32 v196, v196
v_mfma_f32_16x16x32_bf16 v[204:207], v[232:235], a[140:143], v[204:207]
v_exp_f32 v198, v198
v_mfma_f32_16x16x32_bf16 v[208:211], v[232:235], a[156:159], 0
ds_read_b128 v[236:239], v240 offset:512
v_perm_b32 v124, v198, v196, v251
v_mfma_f32_16x16x32_bf16 v[208:211], v[224:227], a[152:155], v[208:211]
ds_read_b128 v[212:215], v240 offset:256
v_perm_b32 v125, v198, v196, v252
v_mfma_f32_16x16x32_bf16 v[208:211], v[220:223], a[148:151], v[208:211]
ds_read_b128 v[228:231], v240 offset:0
v_add_f32_dpp v188, v188, v188 row_ror:4 row_mask:0xf bank_mask:0xf
v_mfma_f32_16x16x32_bf16 v[208:211], v[216:219], a[144:147], v[208:211]
ds_write_b32 v249, v188 offset:0
v_mfma_f32_16x16x32_bf16 v[196:199], v[216:219], a[160:163], 0
v_exp_f32 v200, v200
v_mfma_f32_16x16x32_bf16 v[196:199], v[220:223], a[164:167], v[196:199]
v_exp_f32 v201, v201
v_mfma_f32_16x16x32_bf16 v[196:199], v[224:227], a[168:171], v[196:199]
s_waitcnt lgkmcnt(3)
v_exp_f32 v202, v202
v_mfma_f32_16x16x32_bf16 v[196:199], v[232:235], a[172:175], v[196:199]
v_cvt_pk_bf16_f32 v86, v208, v209
v_cvt_pk_bf16_f32 v87, v210, v211
v_mfma_f32_16x16x32_bf16 v[208:211], v[232:235], a[188:191], 0
v_exp_f32 v203, v203
v_mfma_f32_16x16x32_bf16 v[208:211], v[224:227], a[184:187], v[208:211]
v_cvt_pk_bf16_f32 v112, v200, v201
v_cvt_pk_bf16_f32 v113, v202, v203
v_mfma_f32_16x16x32_bf16 v[208:211], v[220:223], a[180:183], v[208:211]
v_cvt_pk_bf16_f32 v90, v196, v197
v_cvt_pk_bf16_f32 v91, v198, v199
v_mfma_f32_16x16x32_bf16 v[208:211], v[216:219], a[176:179], v[208:211]
v_cvt_pk_bf16_f32 v82, v204, v205
v_cvt_pk_bf16_f32 v83, v206, v207
v_mfma_f32_16x16x32_bf16 v[200:203], v[12:15], v[108:111], 0
ds_read_b128 v[204:207], v240 offset:768
v_add_u32 v249, 1600, v249
v_mfma_f32_16x16x32_bf16 v[200:203], v[8:11], v[104:107], v[200:203]
s_nop 1
v_cvt_pk_bf16_f32 v94, v208, v209
v_mfma_f32_16x16x32_bf16 v[196:199], v[16:19], v[104:107], 0
s_waitcnt lgkmcnt(1)
v_cvt_pk_bf16_f32 v95, v210, v211
s_nop 0
v_mfma_f32_16x16x32_bf16 v[196:199], v[20:23], v[108:111], v[196:199]
v_exp_f32 v200, v200
v_mfma_f32_32x32x16_bf16 v[176:191], v[100:103], v[124:127], 0
buffer_store_dwordx4 v[160:163], v242, s[20:23], s53 offen offset:0 nt
buffer_store_dwordx4 v[168:171], v242, s[20:23], s53 offen offset:64 nt
v_exp_f32 v201, v201
s_add_u32 s53, s46, 0
s_waitcnt lgkmcnt(0)
v_mfma_f32_16x16x32_bf16 v[208:211], v[204:207], a[188:191], 0
v_exp_f32 v202, v202
v_mfma_f32_16x16x32_bf16 v[208:211], v[236:239], a[184:187], v[208:211]
v_exp_f32 v203, v203
v_mfma_f32_16x16x32_bf16 v[208:211], v[212:215], a[180:183], v[208:211]
v_cvt_pk_bf16_f32 v114, v200, v201
v_cvt_pk_bf16_f32 v115, v202, v203
v_mfma_f32_16x16x32_bf16 v[208:211], v[228:231], a[176:179], v[208:211]
v_exp_f32 v196, v196
v_mfma_f32_16x16x32_bf16 v[200:203], v[228:231], a[160:163], 0
v_exp_f32 v197, v197
v_mfma_f32_16x16x32_bf16 v[200:203], v[212:215], a[164:167], v[200:203]
v_exp_f32 v198, v198
v_mfma_f32_16x16x32_bf16 v[200:203], v[236:239], a[168:171], v[200:203]
v_exp_f32 v199, v199
v_mfma_f32_16x16x32_bf16 v[200:203], v[204:207], a[172:175], v[200:203]
v_cvt_pk_bf16_f32 v116, v196, v197
v_cvt_pk_bf16_f32 v117, v198, v199
v_mfma_f32_16x16x32_bf16 v[196:199], v[204:207], a[156:159], 0
v_cvt_pk_bf16_f32 v60, v208, v209
v_cvt_pk_bf16_f32 v61, v210, v211
v_mfma_f32_16x16x32_bf16 v[196:199], v[236:239], a[152:155], v[196:199]
s_nop 1
v_cvt_pk_bf16_f32 v56, v200, v201
v_mfma_f32_16x16x32_bf16 v[196:199], v[212:215], a[148:151], v[196:199]
v_cvt_pk_bf16_f32 v57, v202, v203
v_mfma_f32_16x16x32_bf16 v[196:199], v[228:231], a[144:147], v[196:199]
s_nop 2
v_mfma_f32_16x16x32_bf16 v[200:203], v[228:231], a[128:131], 0
s_nop 2
v_mfma_f32_16x16x32_bf16 v[200:203], v[212:215], a[132:135], v[200:203]
v_cvt_pk_bf16_f32 v52, v196, v197
v_cvt_pk_bf16_f32 v53, v198, v199
v_mfma_f32_16x16x32_bf16 v[200:203], v[236:239], a[136:139], v[200:203]
v_mfma_f32_16x16x32_bf16 v[200:203], v[204:207], a[140:143], v[200:203]
s_nop 2
v_mfma_f32_16x16x32_bf16 v[196:199], v[24:27], v[104:107], 0
s_nop 2
v_mfma_f32_16x16x32_bf16 v[196:199], v[28:31], v[108:111], v[196:199]
v_cvt_pk_bf16_f32 v48, v200, v201
v_cvt_pk_bf16_f32 v49, v202, v203
v_mfma_f32_16x16x32_bf16 v[200:203], v[36:39], v[108:111], 0
s_nop 2
v_mfma_f32_16x16x32_bf16 v[200:203], v[32:35], v[104:107], v[200:203]
s_nop 0
v_exp_f32 v196, v196
v_mfma_f32_16x16x32_bf16 v[208:211], v[40:43], v[104:107], 0
v_exp_f32 v197, v197
v_mfma_f32_16x16x32_bf16 v[208:211], v[44:47], v[108:111], v[208:211]
v_exp_f32 v198, v198
v_mfma_f32_16x16x32_bf16 v[216:219], a[0:3], v[228:231], 0
v_exp_f32 v199, v199
v_mfma_f32_16x16x32_bf16 v[216:219], a[4:7], v[212:215], v[216:219]
v_cvt_pk_bf16_f32 v118, v196, v197
v_cvt_pk_bf16_f32 v119, v198, v199
v_mfma_f32_16x16x32_bf16 v[216:219], a[8:11], v[236:239], v[216:219]
v_exp_f32 v200, v200
v_mfma_f32_16x16x32_bf16 v[216:219], a[12:15], v[204:207], v[216:219]
buffer_load_dwordx4 v241, s[16:19], s98 offen offset:0 nt lds
v_mfma_f32_16x16x32_bf16 v[196:199], a[28:31], v[204:207], 0
v_exp_f32 v201, v201
v_mfma_f32_16x16x32_bf16 v[196:199], a[24:27], v[236:239], v[196:199]
v_exp_f32 v202, v202
v_mfma_f32_16x16x32_bf16 v[196:199], a[20:23], v[212:215], v[196:199]
v_exp_f32 v203, v203
v_mfma_f32_16x16x32_bf16 v[196:199], a[16:19], v[228:231], v[196:199]
v_cvt_pk_bf16_f32 v120, v200, v201
v_cvt_pk_bf16_f32 v121, v202, v203
v_mfma_f32_16x16x32_bf16 v[220:223], a[32:35], v[228:231], 0
v_cvt_pk_bf16_f32 v104, v216, v217
v_cvt_pk_bf16_f32 v105, v218, v219
v_mfma_f32_16x16x32_bf16 v[220:223], a[36:39], v[212:215], v[220:223]
v_exp_f32 v208, v208
v_mfma_f32_16x16x32_bf16 v[220:223], a[40:43], v[236:239], v[220:223]
v_cvt_pk_bf16_f32 v106, v196, v197
v_cvt_pk_bf16_f32 v107, v198, v199
v_mfma_f32_16x16x32_bf16 v[220:223], a[44:47], v[204:207], v[220:223]
v_exp_f32 v209, v209
v_mfma_f32_16x16x32_bf16 v[196:199], a[60:63], v[204:207], 0
v_exp_f32 v210, v210
v_mfma_f32_16x16x32_bf16 v[196:199], a[56:59], v[236:239], v[196:199]
v_exp_f32 v211, v211
v_mfma_f32_16x16x32_bf16 v[196:199], a[52:55], v[212:215], v[196:199]
v_cvt_pk_bf16_f32 v122, v208, v209
v_cvt_pk_bf16_f32 v123, v210, v211
v_mfma_f32_16x16x32_bf16 v[196:199], a[48:51], v[228:231], v[196:199]
v_cvt_pk_bf16_f32 v108, v220, v221
v_cvt_pk_bf16_f32 v109, v222, v223
v_mfma_f32_16x16x32_bf16 v[160:163], a[192:195], v[228:231], 0
s_nop 2
v_mfma_f32_16x16x32_bf16 v[160:163], a[196:199], v[212:215], v[160:163]
s_nop 0
v_cvt_pk_bf16_f32 v110, v196, v197
v_cvt_pk_bf16_f32 v111, v198, v199
v_mfma_f32_16x16x32_bf16 v[160:163], a[200:203], v[236:239], v[160:163]
v_mfma_f32_16x16x32_bf16 v[160:163], a[204:207], v[204:207], v[160:163]
v_mfma_f32_16x16x32_bf16 v[164:167], a[220:223], v[204:207], 0
ds_read_b128 v[196:199], v240 offset:16896
ds_read_b128 v[200:203], v240 offset:17152
v_mfma_f32_16x16x32_bf16 v[164:167], a[216:219], v[236:239], v[164:167]
ds_read_b128 v[208:211], v240 offset:17408
ds_read_b128 v[216:219], v240 offset:17664
v_mfma_f32_16x16x32_bf16 v[164:167], a[212:215], v[212:215], v[164:167]
v_mfma_f32_16x16x32_bf16 v[164:167], a[208:211], v[228:231], v[164:167]
v_mfma_f32_16x16x32_bf16 v[168:171], a[224:227], v[228:231], 0
v_mfma_f32_16x16x32_bf16 v[168:171], a[228:231], v[212:215], v[168:171]
v_mov_b64 v[220:221], s[96:97]
v_mov_b64 v[222:223], s[96:97]
v_mfma_f32_16x16x32_bf16 v[168:171], a[232:235], v[236:239], v[168:171]
s_waitcnt lgkmcnt(3)
v_mfma_f32_16x16x32_bf16 v[168:171], a[236:239], v[204:207], v[168:171]
v_mfma_f32_16x16x32_bf16 v[172:175], a[252:255], v[204:207], 0
v_mfma_f32_16x16x32_bf16 v[172:175], a[248:251], v[236:239], v[172:175]
v_mfma_f32_16x16x32_bf16 v[172:175], a[244:247], v[212:215], v[172:175]
v_mfma_f32_16x16x32_bf16 v[172:175], a[240:243], v[228:231], v[172:175]
v_smfmac_f32_16x16x64_bf16 v[220:223], v[96:99], v[104:111], v250
s_nop 2
v_mfma_f32_16x16x32_bf16 v[204:207], v[0:3], v[104:107], 0
s_waitcnt lgkmcnt(2)
s_nop 1
v_mfma_f32_16x16x32_bf16 v[204:207], v[4:7], v[108:111], v[204:207]
s_waitcnt lgkmcnt(0)
v_add_f32 v220, v220, v221
v_add_f32 v222, v222, v223
v_mfma_f32_16x16x32_bf16 v[212:215], v[12:15], v[108:111], 0
v_exp_f32 v220, v220
v_mfma_f32_16x16x32_bf16 v[212:215], v[8:11], v[104:107], v[212:215]
v_exp_f32 v222, v222
v_mfma_f32_16x16x32_bf16 v[224:227], v[196:199], a[128:131], 0
v_perm_b32 v140, v222, v220, v251
v_perm_b32 v141, v222, v220, v252
v_mfma_f32_16x16x32_bf16 v[224:227], v[200:203], a[132:135], v[224:227]
v_exp_f32 v204, v204
v_mfma_f32_16x16x32_bf16 v[224:227], v[208:211], a[136:139], v[224:227]
v_exp_f32 v205, v205
v_mfma_f32_16x16x32_bf16 v[224:227], v[216:219], a[140:143], v[224:227]
buffer_load_dwordx4 v241, s[16:19], s99 offen offset:1056 nt lds
v_mfma_f32_16x16x32_bf16 v[220:223], v[216:219], a[156:159], 0
v_exp_f32 v206, v206
v_mfma_f32_16x16x32_bf16 v[220:223], v[208:211], a[152:155], v[220:223]
v_exp_f32 v207, v207
v_mfma_f32_16x16x32_bf16 v[220:223], v[200:203], a[148:151], v[220:223]
v_cvt_pk_bf16_f32 v128, v204, v205
v_cvt_pk_bf16_f32 v129, v206, v207
v_mfma_f32_16x16x32_bf16 v[220:223], v[196:199], a[144:147], v[220:223]
v_cvt_pk_bf16_f32 v80, v224, v225
v_cvt_pk_bf16_f32 v81, v226, v227
v_mfma_f32_16x16x32_bf16 v[224:227], v[196:199], a[160:163], 0
v_exp_f32 v212, v212
v_mfma_f32_16x16x32_bf16 v[224:227], v[200:203], a[164:167], v[224:227]
v_mov_b64 v[228:229], 0
s_nop 0
v_mfma_f32_16x16x32_bf16 v[224:227], v[208:211], a[168:171], v[224:227]
v_cvt_pk_bf16_f32 v84, v220, v221
v_cvt_pk_bf16_f32 v85, v222, v223
v_mfma_f32_16x16x32_bf16 v[224:227], v[216:219], a[172:175], v[224:227]
v_exp_f32 v213, v213
v_mfma_f32_16x16x32_bf16 v[220:223], v[216:219], a[188:191], 0
v_exp_f32 v214, v214
v_mfma_f32_16x16x32_bf16 v[220:223], v[208:211], a[184:187], v[220:223]
v_exp_f32 v215, v215
v_mfma_f32_16x16x32_bf16 v[220:223], v[200:203], a[180:183], v[220:223]
v_cvt_pk_bf16_f32 v130, v212, v213
v_cvt_pk_bf16_f32 v131, v214, v215
v_mfma_f32_16x16x32_bf16 v[220:223], v[196:199], a[176:179], v[220:223]
v_cvt_pk_bf16_f32 v88, v224, v225
v_cvt_pk_bf16_f32 v89, v226, v227
v_smfmac_f32_16x16x64_bf16 v[228:231], v[192:195], v[112:119], v250
s_nop 2
v_smfmac_f32_16x16x64_bf16 v[228:231], v[192:195], v[120:127], v250 abid:1
s_nop 0
v_cvt_pk_bf16_f32 v92, v220, v221
v_mfma_f32_16x16x32_bf16 v[204:207], v[16:19], v[104:107], 0
v_cvt_pk_bf16_f32 v93, v222, v223
s_nop 0
v_mfma_f32_16x16x32_bf16 v[204:207], v[20:23], v[108:111], v[204:207]
s_nop 1
v_add_f32 v228, v228, v229
v_mfma_f32_16x16x32_bf16 v[176:179], v[48:51], v[112:115], v[176:179]
v_rcp_f32 v253, v228
v_mfma_f32_16x16x32_bf16 v[176:179], v[64:67], v[116:119], v[176:179]
v_max3_f32 v254, v254, v228, v253
v_mfma_f32_16x16x32_bf16 v[176:179], v[80:83], v[120:123], v[176:179]
buffer_load_dwordx4 v241, s[16:19], s100 offen offset:2112 nt lds
v_mfma_f32_16x16x32_bf16 v[180:183], v[84:87], v[120:123], v[180:183]
v_exp_f32 v204, v204
v_mfma_f32_16x16x32_bf16 v[180:183], v[52:55], v[112:115], v[180:183]
v_exp_f32 v205, v205
v_mfma_f32_16x16x32_bf16 v[180:183], v[68:71], v[116:119], v[180:183]
v_exp_f32 v206, v206
v_mfma_f32_16x16x32_bf16 v[184:187], v[72:75], v[116:119], v[184:187]
v_fmac_f32 v144, v176, v253
v_fmac_f32 v145, v177, v253
v_mfma_f32_16x16x32_bf16 v[184:187], v[88:91], v[120:123], v[184:187]
v_fmac_f32 v146, v178, v253
v_fmac_f32 v147, v179, v253
v_mfma_f32_16x16x32_bf16 v[184:187], v[56:59], v[112:115], v[184:187]
v_cvt_pk_bf16_f32 v144, v144, v145
v_fmac_f32 v148, v180, v253
v_mfma_f32_16x16x32_bf16 v[188:191], v[60:63], v[112:115], v[188:191]
v_fmac_f32 v149, v181, v253
v_fmac_f32 v150, v182, v253
v_mfma_f32_16x16x32_bf16 v[188:191], v[76:79], v[116:119], v[188:191]
v_fmac_f32 v151, v183, v253
v_cvt_pk_bf16_f32 v145, v146, v147
v_mfma_f32_16x16x32_bf16 v[188:191], v[92:95], v[120:123], v[188:191]
v_fmac_f32 v152, v184, v253
v_fmac_f32 v153, v185, v253
v_mfma_f32_16x16x32_bf16 v[212:215], v[24:27], v[104:107], 0
v_fmac_f32 v154, v186, v253
v_fmac_f32 v155, v187, v253
v_mfma_f32_16x16x32_bf16 v[212:215], v[28:31], v[108:111], v[212:215]
v_cvt_pk_bf16_f32 v152, v152, v153
v_cvt_pk_bf16_f32 v153, v154, v155
v_mfma_f32_16x16x32_bf16 v[220:223], v[36:39], v[108:111], 0
v_fmac_f32 v156, v188, v253
v_fmac_f32 v157, v189, v253
v_mfma_f32_16x16x32_bf16 v[220:223], v[32:35], v[104:107], v[220:223]
v_fmac_f32 v158, v190, v253
v_fmac_f32 v159, v191, v253
v_mfma_f32_16x16x32_bf16 v[224:227], v[40:43], v[104:107], 0
v_cvt_pk_bf16_f32 v146, v148, v149
v_cvt_pk_bf16_f32 v147, v150, v151
v_mfma_f32_16x16x32_bf16 v[224:227], v[44:47], v[108:111], v[224:227]
v_cvt_pk_bf16_f32 v154, v156, v157
v_cvt_pk_bf16_f32 v155, v158, v159
v_mfma_f32_16x16x32_bf16 v[228:231], a[0:3], v[196:199], 0
v_exp_f32 v220, v220
v_mfma_f32_16x16x32_bf16 v[228:231], a[4:7], v[200:203], v[228:231]
v_exp_f32 v221, v221
v_mfma_f32_16x16x32_bf16 v[228:231], a[8:11], v[208:211], v[228:231]
v_exp_f32 v222, v222
v_mfma_f32_16x16x32_bf16 v[228:231], a[12:15], v[216:219], v[228:231]
v_exp_f32 v223, v223
v_mfma_f32_16x16x32_bf16 v[232:235], a[28:31], v[216:219], 0
v_cvt_pk_bf16_f32 v136, v220, v221
v_cvt_pk_bf16_f32 v137, v222, v223
v_mfma_f32_16x16x32_bf16 v[232:235], a[24:27], v[208:211], v[232:235]
v_pk_max_i16 v144, v144, 0
v_pk_max_i16 v145, v145, 0
v_mfma_f32_16x16x32_bf16 v[232:235], a[20:23], v[200:203], v[232:235]
v_cvt_pk_bf16_f32 v104, v228, v229
v_cvt_pk_bf16_f32 v105, v230, v231
v_mfma_f32_16x16x32_bf16 v[232:235], a[16:19], v[196:199], v[232:235]
v_pk_max_i16 v146, v146, 0
v_pk_max_i16 v147, v147, 0
v_mfma_f32_16x16x32_bf16 v[228:231], a[32:35], v[196:199], 0
v_pk_max_i16 v152, v152, 0
v_pk_max_i16 v153, v153, 0
v_mfma_f32_16x16x32_bf16 v[228:231], a[36:39], v[200:203], v[228:231]
v_pk_max_i16 v154, v154, 0
v_pk_max_i16 v155, v155, 0
v_mfma_f32_16x16x32_bf16 v[228:231], a[40:43], v[208:211], v[228:231]
v_exp_f32 v224, v224
v_mfma_f32_16x16x32_bf16 v[228:231], a[44:47], v[216:219], v[228:231]
v_exp_f32 v225, v225
v_mfma_f32_16x16x32_bf16 v[220:223], a[60:63], v[216:219], 0
v_exp_f32 v226, v226
v_mfma_f32_16x16x32_bf16 v[220:223], a[56:59], v[208:211], v[220:223]
v_exp_f32 v227, v227
v_mfma_f32_16x16x32_bf16 v[220:223], a[52:55], v[200:203], v[220:223]
v_cvt_pk_bf16_f32 v138, v224, v225
v_cvt_pk_bf16_f32 v139, v226, v227
v_mfma_f32_16x16x32_bf16 v[220:223], a[48:51], v[196:199], v[220:223]
v_exp_f32 v207, v207
v_mfma_f32_32x32x16_bf16 v[176:191], v[100:103], v[140:143], 0
buffer_store_dwordx4 v[144:147], v242, s[20:23], s52 offen offset:0 nt
buffer_store_dwordx4 v[152:155], v242, s[20:23], s52 offen offset:64 nt
v_cvt_pk_bf16_f32 v132, v204, v205
v_cvt_pk_bf16_f32 v133, v206, v207
L_entryf:
v_cvt_pk_bf16_f32 v106, v232, v233
v_cvt_pk_bf16_f32 v107, v234, v235
v_mfma_f32_16x16x32_bf16 v[144:147], a[192:195], v[196:199], 0
s_add_u32 s52, s46, 16384
ds_read_b128 v[224:227], v247 offset:0
ds_read_b128 v[232:235], v247 offset:272
v_mfma_f32_16x16x32_bf16 v[144:147], a[196:199], v[200:203], v[144:147]
ds_read_b128 v[236:239], v247 offset:544
v_cvt_pk_bf16_f32 v110, v220, v221
v_mfma_f32_16x16x32_bf16 v[144:147], a[200:203], v[208:211], v[144:147]
v_exp_f32 v212, v212
v_mfma_f32_16x16x32_bf16 v[144:147], a[204:207], v[216:219], v[144:147]
v_exp_f32 v213, v213
v_mfma_f32_16x16x32_bf16 v[148:151], a[220:223], v[216:219], 0
v_exp_f32 v214, v214
v_mfma_f32_16x16x32_bf16 v[148:151], a[216:219], v[208:211], v[148:151]
v_exp_f32 v215, v215
v_mfma_f32_16x16x32_bf16 v[148:151], a[212:215], v[200:203], v[148:151]
v_cvt_pk_bf16_f32 v134, v212, v213
v_cvt_pk_bf16_f32 v135, v214, v215
v_mfma_f32_16x16x32_bf16 v[148:151], a[208:211], v[196:199], v[148:151]
v_cvt_pk_bf16_f32 v111, v222, v223
v_cvt_pk_bf16_f32 v108, v228, v229
v_mfma_f32_16x16x32_bf16 v[152:155], a[224:227], v[196:199], 0
v_cvt_pk_bf16_f32 v109, v230, v231
v_mfma_f32_16x16x32_bf16 v[152:155], a[228:231], v[200:203], v[152:155]
v_mov_b64 v[204:205], 0
v_mov_b64 v[206:207], 0
v_mfma_f32_16x16x32_bf16 v[152:155], a[232:235], v[208:211], v[152:155]
v_mfma_f32_16x16x32_bf16 v[152:155], a[236:239], v[216:219], v[152:155]
v_mfma_f32_16x16x32_bf16 v[156:159], a[252:255], v[216:219], 0
v_mov_b64 v[212:213], 0
v_mov_b64 v[214:215], 0
v_mfma_f32_16x16x32_bf16 v[156:159], a[248:251], v[208:211], v[156:159]
s_waitcnt lgkmcnt(1)
v_mfma_f32_16x16x32_bf16 v[156:159], a[244:247], v[200:203], v[156:159]
s_waitcnt lgkmcnt(0)
v_mfma_f32_16x16x32_bf16 v[156:159], a[240:243], v[196:199], v[156:159]
v_mov_b64 v[196:197], s[96:97]
v_mov_b64 v[198:199], s[96:97]
v_smfmac_f32_16x16x64_bf16 v[204:207], v[224:227], v[48:55], v250
v_smfmac_f32_16x16x64_bf16 v[204:207], v[232:235], v[64:71], v250
v_smfmac_f32_16x16x64_bf16 v[204:207], v[236:239], v[80:87], v250
s_nop 2
v_smfmac_f32_16x16x64_bf16 v[212:215], v[236:239], v[88:95], v250
s_nop 2
v_smfmac_f32_16x16x64_bf16 v[212:215], v[232:235], v[72:79], v250
v_add_f32 v204, v204, v205
v_smfmac_f32_16x16x64_bf16 v[212:215], v[224:227], v[56:63], v250
ds_write_b32 v248, v204 offset:0
v_smfmac_f32_16x16x64_bf16 v[196:199], v[96:99], v[104:111], v250
v_add_f32 v206, v206, v207
v_mfma_f32_16x16x32_bf16 v[208:211], v[0:3], v[104:107], 0
ds_write_b32 v248, v206 offset:64
v_mfma_f32_16x16x32_bf16 v[208:211], v[4:7], v[108:111], v[208:211]
v_mov_b64 v[200:201], 0
s_nop 0
v_mfma_f32_16x16x32_bf16 v[216:219], v[12:15], v[108:111], 0
s_nop 0
v_add_f32 v196, v196, v197
v_add_f32 v198, v198, v199
v_mfma_f32_16x16x32_bf16 v[216:219], v[8:11], v[104:107], v[216:219]
v_exp_f32 v196, v196
v_mfma_f32_16x16x32_bf16 v[204:207], v[16:19], v[104:107], 0
v_exp_f32 v198, v198
v_mfma_f32_16x16x32_bf16 v[204:207], v[20:23], v[108:111], v[204:207]
v_perm_b32 v124, v198, v196, v251
v_perm_b32 v125, v198, v196, v252
v_smfmac_f32_16x16x64_bf16 v[200:203], v[192:195], v[128:135], v250
ds_read_b128 v[196:199], v240 offset:4224
ds_read_b128 v[220:223], v240 offset:4480
v_smfmac_f32_16x16x64_bf16 v[200:203], v[192:195], v[136:143], v250 abid:1
ds_read_b128 v[224:227], v240 offset:4736
ds_read_b128 v[228:231], v240 offset:4992
v_mfma_f32_16x16x32_bf16 v[176:179], v[80:83], v[136:139], v[176:179]
v_exp_f32 v208, v208
v_mfma_f32_16x16x32_bf16 v[176:179], v[64:67], v[132:135], v[176:179]
v_exp_f32 v209, v209
v_mfma_f32_16x16x32_bf16 v[176:179], v[48:51], v[128:131], v[176:179]
buffer_load_dwordx4 v241, s[16:19], s101 offen offset:3168 nt lds
v_mfma_f32_16x16x32_bf16 v[180:183], v[52:55], v[128:131], v[180:183]
v_add_f32 v200, v200, v201
v_cvt_pk_bf16_f32 v112, v208, v209
v_mfma_f32_16x16x32_bf16 v[180:183], v[68:71], v[132:135], v[180:183]
s_waitcnt lgkmcnt(3)
v_rcp_f32 v253, v200
v_mfma_f32_16x16x32_bf16 v[180:183], v[84:87], v[136:139], v[180:183]
v_max3_f32 v254, v254, v200, v253
v_add_f32 v212, v212, v213
v_mfma_f32_16x16x32_bf16 v[184:187], v[88:91], v[136:139], v[184:187]
ds_write_b32 v248, v212 offset:128
v_mfma_f32_16x16x32_bf16 v[184:187], v[72:75], v[132:135], v[184:187]
v_exp_f32 v210, v210
v_mfma_f32_16x16x32_bf16 v[184:187], v[56:59], v[128:131], v[184:187]
v_exp_f32 v211, v211
v_mfma_f32_16x16x32_bf16 v[188:191], v[60:63], v[128:131], v[188:191]
v_cvt_pk_bf16_f32 v113, v210, v211
v_add_f32 v214, v214, v215
v_mfma_f32_16x16x32_bf16 v[188:191], v[76:79], v[132:135], v[188:191]
ds_write_b32 v248, v214 offset:192
v_mfma_f32_16x16x32_bf16 v[188:191], v[92:95], v[136:139], v[188:191]
s_waitcnt lgkmcnt(4)
v_fmac_f32 v160, v176, v253
v_fmac_f32 v161, v177, v253
v_mfma_f32_16x16x32_bf16 v[232:235], v[24:27], v[104:107], 0
s_waitcnt lgkmcnt(2)
v_fmac_f32 v168, v184, v253
v_fmac_f32 v169, v185, v253
v_mfma_f32_16x16x32_bf16 v[232:235], v[28:31], v[108:111], v[232:235]
v_fmac_f32 v162, v178, v253
v_fmac_f32 v163, v179, v253
v_mfma_f32_16x16x32_bf16 v[200:203], v[36:39], v[108:111], 0
v_cvt_pk_bf16_f32 v160, v160, v161
v_fmac_f32 v170, v186, v253
v_mfma_f32_16x16x32_bf16 v[200:203], v[32:35], v[104:107], v[200:203]
v_fmac_f32 v171, v187, v253
v_cvt_pk_bf16_f32 v168, v168, v169
v_mfma_f32_16x16x32_bf16 v[236:239], v[40:43], v[104:107], 0
v_fmac_f32 v164, v180, v253
v_fmac_f32 v165, v181, v253
v_mfma_f32_16x16x32_bf16 v[236:239], v[44:47], v[108:111], v[236:239]
v_fmac_f32 v166, v182, v253
v_fmac_f32 v167, v183, v253
v_mfma_f32_16x16x32_bf16 v[208:211], a[0:3], v[196:199], 0
v_cvt_pk_bf16_f32 v161, v162, v163
v_fmac_f32 v172, v188, v253
v_mfma_f32_16x16x32_bf16 v[208:211], a[4:7], v[220:223], v[208:211]
v_fmac_f32 v173, v189, v253
v_fmac_f32 v174, v190, v253
v_mfma_f32_16x16x32_bf16 v[208:211], a[8:11], v[224:227], v[208:211]
v_fmac_f32 v175, v191, v253
v_cvt_pk_bf16_f32 v169, v170, v171
v_mfma_f32_16x16x32_bf16 v[208:211], a[12:15], v[228:231], v[208:211]
v_cvt_pk_bf16_f32 v162, v164, v165
v_cvt_pk_bf16_f32 v163, v166, v167
v_mfma_f32_16x16x32_bf16 v[212:215], a[28:31], v[228:231], 0
v_cvt_pk_bf16_f32 v170, v172, v173
v_cvt_pk_bf16_f32 v171, v174, v175
v_mfma_f32_16x16x32_bf16 v[212:215], a[24:27], v[224:227], v[212:215]
v_pk_max_i16 v160, v160, 0
v_pk_max_i16 v161, v161, 0
v_mfma_f32_16x16x32_bf16 v[212:215], a[20:23], v[220:223], v[212:215]
v_cvt_pk_bf16_f32 v104, v208, v209
v_cvt_pk_bf16_f32 v105, v210, v211
v_mfma_f32_16x16x32_bf16 v[212:215], a[16:19], v[196:199], v[212:215]
v_pk_max_i16 v162, v162, 0
v_pk_max_i16 v163, v163, 0
v_mfma_f32_16x16x32_bf16 v[208:211], a[32:35], v[196:199], 0
v_pk_max_i16 v168, v168, 0
v_pk_max_i16 v169, v169, 0
v_mfma_f32_16x16x32_bf16 v[208:211], a[36:39], v[220:223], v[208:211]
v_pk_max_i16 v170, v170, 0
v_pk_max_i16 v171, v171, 0
v_mfma_f32_16x16x32_bf16 v[208:211], a[40:43], v[224:227], v[208:211]
v_cvt_pk_bf16_f32 v106, v212, v213
v_cvt_pk_bf16_f32 v107, v214, v215
v_mfma_f32_16x16x32_bf16 v[208:211], a[44:47], v[228:231], v[208:211]
v_exp_f32 v204, v204
v_mfma_f32_16x16x32_bf16 v[212:215], a[60:63], v[228:231], 0
v_exp_f32 v205, v205
v_mfma_f32_16x16x32_bf16 v[212:215], a[56:59], v[224:227], v[212:215]
v_exp_f32 v206, v206
v_mfma_f32_16x16x32_bf16 v[212:215], a[52:55], v[220:223], v[212:215]
v_exp_f32 v207, v207
v_mfma_f32_16x16x32_bf16 v[212:215], a[48:51], v[196:199], v[212:215]
v_cvt_pk_bf16_f32 v108, v208, v209
v_cvt_pk_bf16_f32 v109, v210, v211
v_mfma_f32_32x32x16_bf16 v[176:191], v[100:103], v[124:127], 0
buffer_store_dwordx4 v[160:163], v242, s[20:23], s53 offen offset:0 nt
buffer_store_dwordx4 v[168:171], v242, s[20:23], s53 offen offset:64 nt
v_cvt_pk_bf16_f32 v116, v204, v205
v_cvt_pk_bf16_f32 v117, v206, v207
v_exp_f32 v200, v200
v_mfma_f32_16x16x32_bf16 v[160:163], a[192:195], v[196:199], 0
s_add_u32 s53, s46, 4096
v_cvt_pk_bf16_f32 v110, v212, v213
v_cvt_pk_bf16_f32 v111, v214, v215
v_mfma_f32_16x16x32_bf16 v[160:163], a[196:199], v[220:223], v[160:163]
s_add_u32 s46, s46, 13107200
v_exp_f32 v201, v201
v_mfma_f32_16x16x32_bf16 v[160:163], a[200:203], v[224:227], v[160:163]
v_exp_f32 v202, v202
v_mfma_f32_16x16x32_bf16 v[160:163], a[204:207], v[228:231], v[160:163]
v_exp_f32 v203, v203
v_mfma_f32_16x16x32_bf16 v[164:167], a[220:223], v[228:231], 0
v_cvt_pk_bf16_f32 v120, v200, v201
v_cvt_pk_bf16_f32 v121, v202, v203
v_mfma_f32_16x16x32_bf16 v[164:167], a[216:219], v[224:227], v[164:167]
v_exp_f32 v216, v216
v_mfma_f32_16x16x32_bf16 v[164:167], a[212:215], v[220:223], v[164:167]
v_exp_f32 v217, v217
v_mfma_f32_16x16x32_bf16 v[164:167], a[208:211], v[196:199], v[164:167]
v_exp_f32 v218, v218
v_mfma_f32_16x16x32_bf16 v[168:171], a[224:227], v[196:199], 0
v_exp_f32 v219, v219
v_mfma_f32_16x16x32_bf16 v[168:171], a[228:231], v[220:223], v[168:171]
v_mov_b64 v[208:209], s[96:97]
v_mov_b64 v[210:211], s[96:97]
v_mfma_f32_16x16x32_bf16 v[168:171], a[232:235], v[224:227], v[168:171]
v_exp_f32 v232, v232
v_mfma_f32_16x16x32_bf16 v[168:171], a[236:239], v[228:231], v[168:171]
v_exp_f32 v233, v233
v_mfma_f32_16x16x32_bf16 v[172:175], a[252:255], v[228:231], 0
v_exp_f32 v234, v234
v_mfma_f32_16x16x32_bf16 v[172:175], a[248:251], v[224:227], v[172:175]
v_exp_f32 v235, v235
v_mfma_f32_16x16x32_bf16 v[172:175], a[244:247], v[220:223], v[172:175]
v_cvt_pk_bf16_f32 v114, v216, v217
v_cvt_pk_bf16_f32 v115, v218, v219
v_mfma_f32_16x16x32_bf16 v[172:175], a[240:243], v[196:199], v[172:175]
v_cvt_pk_bf16_f32 v118, v232, v233
v_cvt_pk_bf16_f32 v119, v234, v235
v_smfmac_f32_16x16x64_bf16 v[208:211], v[96:99], v[104:111], v250
v_mov_b64 v[196:197], 0
v_mfma_f32_16x16x32_bf16 v[204:207], v[0:3], v[104:107], 0
v_exp_f32 v236, v236
v_mfma_f32_16x16x32_bf16 v[204:207], v[4:7], v[108:111], v[204:207]
v_exp_f32 v237, v237
v_mfma_f32_16x16x32_bf16 v[212:215], v[12:15], v[108:111], 0
v_exp_f32 v238, v238
v_mfma_f32_16x16x32_bf16 v[212:215], v[8:11], v[104:107], v[212:215]
v_exp_f32 v239, v239
v_mfma_f32_16x16x32_bf16 v[200:203], v[16:19], v[104:107], 0
v_cvt_pk_bf16_f32 v122, v236, v237
v_cvt_pk_bf16_f32 v123, v238, v239
v_mfma_f32_16x16x32_bf16 v[200:203], v[20:23], v[108:111], v[200:203]
v_add_f32 v208, v208, v209
v_add_f32 v210, v210, v211
v_smfmac_f32_16x16x64_bf16 v[196:199], v[192:195], v[112:119], v250
ds_read_b128 v[216:219], v240 offset:8448
ds_read_b128 v[220:223], v240 offset:8704
v_smfmac_f32_16x16x64_bf16 v[196:199], v[192:195], v[120:127], v250 abid:1
ds_read_b128 v[224:227], v240 offset:8960
ds_read_b128 v[228:231], v240 offset:9216
v_mfma_f32_16x16x32_bf16 v[176:179], v[80:83], v[120:123], v[176:179]
v_exp_f32 v208, v208
v_mfma_f32_16x16x32_bf16 v[176:179], v[64:67], v[116:119], v[176:179]
v_exp_f32 v210, v210
v_mfma_f32_16x16x32_bf16 v[176:179], v[48:51], v[112:115], v[176:179]
s_nop 0
v_add_f32 v196, v196, v197
v_perm_b32 v140, v210, v208, v251
v_mfma_f32_16x16x32_bf16 v[180:183], v[52:55], v[112:115], v[180:183]
v_rcp_f32 v253, v196
v_mfma_f32_16x16x32_bf16 v[180:183], v[68:71], v[116:119], v[180:183]
v_max3_f32 v254, v254, v196, v253
v_perm_b32 v141, v210, v208, v252
v_mfma_f32_16x16x32_bf16 v[180:183], v[84:87], v[120:123], v[180:183]
v_fmac_f32 v144, v176, v253
v_fmac_f32 v145, v177, v253
v_mfma_f32_16x16x32_bf16 v[184:187], v[88:91], v[120:123], v[184:187]
v_fmac_f32 v146, v178, v253
v_fmac_f32 v147, v179, v253
v_mfma_f32_16x16x32_bf16 v[184:187], v[72:75], v[116:119], v[184:187]
v_cvt_pk_bf16_f32 v144, v144, v145
v_cvt_pk_bf16_f32 v145, v146, v147
v_mfma_f32_16x16x32_bf16 v[184:187], v[56:59], v[112:115], v[184:187]
v_fmac_f32 v148, v180, v253
v_fmac_f32 v149, v181, v253
v_mfma_f32_16x16x32_bf16 v[188:191], v[60:63], v[112:115], v[188:191]
v_fmac_f32 v150, v182, v253
v_fmac_f32 v151, v183, v253
v_mfma_f32_16x16x32_bf16 v[188:191], v[76:79], v[116:119], v[188:191]
v_cvt_pk_bf16_f32 v146, v148, v149
v_cvt_pk_bf16_f32 v147, v150, v151
v_mfma_f32_16x16x32_bf16 v[188:191], v[92:95], v[120:123], v[188:191]
s_waitcnt lgkmcnt(2)
v_fmac_f32 v152, v184, v253
v_fmac_f32 v153, v185, v253
v_mfma_f32_16x16x32_bf16 v[196:199], v[24:27], v[104:107], 0
s_waitcnt lgkmcnt(0)
v_fmac_f32 v154, v186, v253
v_fmac_f32 v155, v187, v253
v_mfma_f32_16x16x32_bf16 v[196:199], v[28:31], v[108:111], v[196:199]
v_cvt_pk_bf16_f32 v152, v152, v153
v_fmac_f32 v156, v188, v253
v_mfma_f32_16x16x32_bf16 v[208:211], v[36:39], v[108:111], 0
v_fmac_f32 v157, v189, v253
v_fmac_f32 v158, v190, v253
v_mfma_f32_16x16x32_bf16 v[208:211], v[32:35], v[104:107], v[208:211]
v_fmac_f32 v159, v191, v253
v_cvt_pk_bf16_f32 v153, v154, v155
v_mfma_f32_16x16x32_bf16 v[232:235], v[40:43], v[104:107], 0
v_exp_f32 v196, v196
v_mfma_f32_16x16x32_bf16 v[232:235], v[44:47], v[108:111], v[232:235]
v_exp_f32 v197, v197
v_mfma_f32_16x16x32_bf16 v[236:239], a[0:3], v[216:219], 0
v_exp_f32 v198, v198
v_mfma_f32_16x16x32_bf16 v[236:239], a[4:7], v[220:223], v[236:239]
v_exp_f32 v199, v199
v_mfma_f32_16x16x32_bf16 v[236:239], a[8:11], v[224:227], v[236:239]
v_cvt_pk_bf16_f32 v134, v196, v197
v_cvt_pk_bf16_f32 v135, v198, v199
v_mfma_f32_16x16x32_bf16 v[236:239], a[12:15], v[228:231], v[236:239]
v_cvt_pk_bf16_f32 v154, v156, v157
v_cvt_pk_bf16_f32 v155, v158, v159
v_mfma_f32_16x16x32_bf16 v[196:199], a[28:31], v[228:231], 0
v_pk_max_i16 v144, v144, 0
v_pk_max_i16 v145, v145, 0
v_mfma_f32_16x16x32_bf16 v[196:199], a[24:27], v[224:227], v[196:199]
v_pk_max_i16 v146, v146, 0
v_pk_max_i16 v147, v147, 0
v_mfma_f32_16x16x32_bf16 v[196:199], a[20:23], v[220:223], v[196:199]
v_cvt_pk_bf16_f32 v104, v236, v237
v_cvt_pk_bf16_f32 v105, v238, v239
v_mfma_f32_16x16x32_bf16 v[196:199], a[16:19], v[216:219], v[196:199]
v_pk_max_i16 v152, v152, 0
v_pk_max_i16 v153, v153, 0
v_mfma_f32_16x16x32_bf16 v[236:239], a[32:35], v[216:219], 0
v_pk_max_i16 v154, v154, 0
v_pk_max_i16 v155, v155, 0
v_mfma_f32_16x16x32_bf16 v[236:239], a[36:39], v[220:223], v[236:239]
v_exp_f32 v200, v200
v_mfma_f32_16x16x32_bf16 v[236:239], a[40:43], v[224:227], v[236:239]
v_cvt_pk_bf16_f32 v106, v196, v197
v_cvt_pk_bf16_f32 v107, v198, v199
v_mfma_f32_16x16x32_bf16 v[236:239], a[44:47], v[228:231], v[236:239]
v_exp_f32 v204, v204
v_mfma_f32_16x16x32_bf16 v[196:199], a[60:63], v[228:231], 0
v_exp_f32 v205, v205
v_mfma_f32_16x16x32_bf16 v[196:199], a[56:59], v[224:227], v[196:199]
v_exp_f32 v206, v206
v_mfma_f32_16x16x32_bf16 v[196:199], a[52:55], v[220:223], v[196:199]
v_exp_f32 v207, v207
v_mfma_f32_16x16x32_bf16 v[196:199], a[48:51], v[216:219], v[196:199]
v_cvt_pk_bf16_f32 v108, v236, v237
v_cvt_pk_bf16_f32 v109, v238, v239
v_mfma_f32_32x32x16_bf16 v[176:191], v[100:103], v[140:143], 0
buffer_store_dwordx4 v[144:147], v242, s[20:23], s52 offen offset:0 nt
buffer_store_dwordx4 v[152:155], v242, s[20:23], s52 offen offset:64 nt
v_cvt_pk_bf16_f32 v128, v204, v205
v_cvt_pk_bf16_f32 v129, v206, v207
v_exp_f32 v212, v212
v_mfma_f32_16x16x32_bf16 v[144:147], a[192:195], v[216:219], 0
v_cvt_pk_bf16_f32 v110, v196, v197
v_cvt_pk_bf16_f32 v111, v198, v199
v_mfma_f32_16x16x32_bf16 v[144:147], a[196:199], v[220:223], v[144:147]
v_exp_f32 v213, v213
v_mfma_f32_16x16x32_bf16 v[144:147], a[200:203], v[224:227], v[144:147]
v_exp_f32 v214, v214
v_mfma_f32_16x16x32_bf16 v[144:147], a[204:207], v[228:231], v[144:147]
v_exp_f32 v215, v215
v_mfma_f32_16x16x32_bf16 v[148:151], a[220:223], v[228:231], 0
v_cvt_pk_bf16_f32 v130, v212, v213
v_cvt_pk_bf16_f32 v131, v214, v215
v_mfma_f32_16x16x32_bf16 v[148:151], a[216:219], v[224:227], v[148:151]
v_exp_f32 v208, v208
v_mfma_f32_16x16x32_bf16 v[148:151], a[212:215], v[220:223], v[148:151]
v_exp_f32 v209, v209
v_mfma_f32_16x16x32_bf16 v[148:151], a[208:211], v[216:219], v[148:151]
v_exp_f32 v210, v210
v_mfma_f32_16x16x32_bf16 v[152:155], a[224:227], v[216:219], 0
v_exp_f32 v211, v211
v_mfma_f32_16x16x32_bf16 v[152:155], a[228:231], v[220:223], v[152:155]
v_mov_b64 v[196:197], s[96:97]
v_mov_b64 v[198:199], s[96:97]
v_mfma_f32_16x16x32_bf16 v[152:155], a[232:235], v[224:227], v[152:155]
v_cvt_pk_bf16_f32 v136, v208, v209
v_cvt_pk_bf16_f32 v137, v210, v211
v_mfma_f32_16x16x32_bf16 v[152:155], a[236:239], v[228:231], v[152:155]
v_exp_f32 v201, v201
v_mfma_f32_16x16x32_bf16 v[156:159], a[252:255], v[228:231], 0
v_exp_f32 v202, v202
v_mfma_f32_16x16x32_bf16 v[156:159], a[248:251], v[224:227], v[156:159]
v_exp_f32 v203, v203
v_mfma_f32_16x16x32_bf16 v[156:159], a[244:247], v[220:223], v[156:159]
v_cvt_pk_bf16_f32 v132, v200, v201
v_cvt_pk_bf16_f32 v133, v202, v203
v_mfma_f32_16x16x32_bf16 v[156:159], a[240:243], v[216:219], v[156:159]
v_exp_f32 v232, v232
v_smfmac_f32_16x16x64_bf16 v[196:199], v[96:99], v[104:111], v250
v_mov_b64 v[200:201], 0
v_mfma_f32_16x16x32_bf16 v[204:207], v[0:3], v[104:107], 0
v_exp_f32 v233, v233
v_mfma_f32_16x16x32_bf16 v[204:207], v[4:7], v[108:111], v[204:207]
v_exp_f32 v234, v234
v_mfma_f32_16x16x32_bf16 v[212:215], v[12:15], v[108:111], 0
v_exp_f32 v235, v235
v_mfma_f32_16x16x32_bf16 v[212:215], v[8:11], v[104:107], v[212:215]
v_cvt_pk_bf16_f32 v138, v232, v233
v_cvt_pk_bf16_f32 v139, v234, v235
v_mfma_f32_16x16x32_bf16 v[208:211], v[16:19], v[104:107], 0
v_add_f32 v196, v196, v197
v_add_f32 v198, v198, v199
v_mfma_f32_16x16x32_bf16 v[208:211], v[20:23], v[108:111], v[208:211]
v_exp_f32 v196, v196
v_smfmac_f32_16x16x64_bf16 v[200:203], v[192:195], v[128:135], v250
ds_read_b128 v[216:219], v240 offset:12672
ds_read_b128 v[220:223], v240 offset:12928
v_smfmac_f32_16x16x64_bf16 v[200:203], v[192:195], v[136:143], v250 abid:1
ds_read_b128 v[224:227], v240 offset:13184
ds_read_b128 v[228:231], v240 offset:13440
v_mfma_f32_16x16x32_bf16 v[176:179], v[80:83], v[136:139], v[176:179]
v_exp_f32 v198, v198
v_mfma_f32_16x16x32_bf16 v[176:179], v[64:67], v[132:135], v[176:179]
v_perm_b32 v124, v198, v196, v251
v_perm_b32 v125, v198, v196, v252
v_mfma_f32_16x16x32_bf16 v[176:179], v[48:51], v[128:131], v[176:179]
v_add_f32 v200, v200, v201
v_add_u32 v240, s56, v240
v_mfma_f32_16x16x32_bf16 v[180:183], v[52:55], v[128:131], v[180:183]
s_sub_u32 s56, 0, s56
v_rcp_f32 v253, v200
v_mfma_f32_16x16x32_bf16 v[180:183], v[68:71], v[132:135], v[180:183]
v_max3_f32 v254, v254, v200, v253
v_add_u32 v248, 1600, v248
v_mfma_f32_16x16x32_bf16 v[180:183], v[84:87], v[136:139], v[180:183]
v_fmac_f32 v160, v176, v253
v_fmac_f32 v161, v177, v253
v_mfma_f32_16x16x32_bf16 v[184:187], v[88:91], v[136:139], v[184:187]
v_fmac_f32 v162, v178, v253
v_fmac_f32 v163, v179, v253
v_mfma_f32_16x16x32_bf16 v[184:187], v[72:75], v[132:135], v[184:187]
v_cvt_pk_bf16_f32 v160, v160, v161
v_cvt_pk_bf16_f32 v161, v162, v163
v_mfma_f32_16x16x32_bf16 v[184:187], v[56:59], v[128:131], v[184:187]
v_fmac_f32 v164, v180, v253
v_fmac_f32 v165, v181, v253
v_mfma_f32_16x16x32_bf16 v[188:191], v[60:63], v[128:131], v[188:191]
v_mov_b32 v196, s45
v_fmac_f32 v166, v182, v253
v_mfma_f32_16x16x32_bf16 v[188:191], v[76:79], v[132:135], v[188:191]
s_waitcnt vmcnt(4)
ds_write_b16 v246, v196 offset:816
v_mfma_f32_16x16x32_bf16 v[188:191], v[92:95], v[136:139], v[188:191]
s_waitcnt lgkmcnt(3)
v_fmac_f32 v168, v184, v253
v_fmac_f32 v169, v185, v253
v_mfma_f32_16x16x32_bf16 v[196:199], v[24:27], v[104:107], 0
s_waitcnt lgkmcnt(1)
v_fmac_f32 v170, v186, v253
v_fmac_f32 v171, v187, v253
v_mfma_f32_16x16x32_bf16 v[196:199], v[28:31], v[108:111], v[196:199]
v_cvt_pk_bf16_f32 v168, v168, v169
v_fmac_f32 v167, v183, v253
v_mfma_f32_16x16x32_bf16 v[200:203], v[36:39], v[108:111], 0
v_fmac_f32 v172, v188, v253
v_fmac_f32 v173, v189, v253
v_mfma_f32_16x16x32_bf16 v[200:203], v[32:35], v[104:107], v[200:203]
v_fmac_f32 v174, v190, v253
v_fmac_f32 v175, v191, v253
v_mfma_f32_16x16x32_bf16 v[232:235], v[40:43], v[104:107], 0
v_exp_f32 v196, v196
v_mfma_f32_16x16x32_bf16 v[232:235], v[44:47], v[108:111], v[232:235]
v_exp_f32 v197, v197
v_mfma_f32_16x16x32_bf16 v[236:239], a[0:3], v[216:219], 0
v_exp_f32 v198, v198
v_mfma_f32_16x16x32_bf16 v[236:239], a[4:7], v[220:223], v[236:239]
v_exp_f32 v199, v199
v_mfma_f32_16x16x32_bf16 v[236:239], a[8:11], v[224:227], v[236:239]
v_cvt_pk_bf16_f32 v118, v196, v197
v_cvt_pk_bf16_f32 v119, v198, v199
v_mfma_f32_16x16x32_bf16 v[236:239], a[12:15], v[228:231], v[236:239]
v_cvt_pk_bf16_f32 v169, v170, v171
v_cvt_pk_bf16_f32 v162, v164, v165
v_mfma_f32_16x16x32_bf16 v[196:199], a[28:31], v[228:231], 0
v_cvt_pk_bf16_f32 v163, v166, v167
v_cvt_pk_bf16_f32 v170, v172, v173
v_mfma_f32_16x16x32_bf16 v[196:199], a[24:27], v[224:227], v[196:199]
v_cvt_pk_bf16_f32 v171, v174, v175
v_pk_max_i16 v160, v160, 0
v_mfma_f32_16x16x32_bf16 v[196:199], a[20:23], v[220:223], v[196:199]
v_cvt_pk_bf16_f32 v104, v236, v237
v_cvt_pk_bf16_f32 v105, v238, v239
v_mfma_f32_16x16x32_bf16 v[196:199], a[16:19], v[216:219], v[196:199]
v_pk_max_i16 v161, v161, 0
v_pk_max_i16 v162, v162, 0
v_mfma_f32_16x16x32_bf16 v[236:239], a[32:35], v[216:219], 0
v_pk_max_i16 v163, v163, 0
v_pk_max_i16 v168, v168, 0
v_mfma_f32_16x16x32_bf16 v[236:239], a[36:39], v[220:223], v[236:239]
v_pk_max_i16 v169, v169, 0
v_pk_max_i16 v170, v170, 0
v_mfma_f32_16x16x32_bf16 v[236:239], a[40:43], v[224:227], v[236:239]
v_pk_max_i16 v171, v171, 0
v_cvt_pk_bf16_f32 v106, v196, v197
v_mfma_f32_16x16x32_bf16 v[236:239], a[44:47], v[228:231], v[236:239]
v_cvt_pk_bf16_f32 v107, v198, v199
s_nop 0
v_mfma_f32_32x32x16_bf16 v[176:191], v[100:103], v[124:127], 0
s_cmp_lg_u32 s45, 0
buffer_store_dwordx4 v[160:163], v242, s[20:23], s53 offen offset:0 nt
s_cbranch_scc1 L_loopf
buffer_store_dwordx4 v[168:171], v242, s[20:23], s53 offen offset:64 nt
v_mfma_f32_16x16x32_bf16 v[196:199], a[60:63], v[228:231], 0
s_barrier
v_mfma_f32_16x16x32_bf16 v[196:199], a[56:59], v[224:227], v[196:199]
s_add_u32 s52, s47, 8192
v_cvt_pk_bf16_f32 v108, v236, v237
v_cvt_pk_bf16_f32 v109, v238, v239
v_mfma_f32_16x16x32_bf16 v[196:199], a[52:55], v[220:223], v[196:199]
s_lshl_b32 s55, s41, 9
v_exp_f32 v200, v200
v_mfma_f32_16x16x32_bf16 v[196:199], a[48:51], v[216:219], v[196:199]
s_add_u32 s53, s47, 12288
v_exp_f32 v201, v201
v_mfma_f32_16x16x32_bf16 v[160:163], a[192:195], v[216:219], 0
v_exp_f32 v202, v202
v_mfma_f32_16x16x32_bf16 v[160:163], a[196:199], v[220:223], v[160:163]
v_exp_f32 v203, v203
v_mfma_f32_16x16x32_bf16 v[160:163], a[200:203], v[224:227], v[160:163]
s_nop 0
v_cvt_pk_bf16_f32 v110, v196, v197
v_cvt_pk_bf16_f32 v111, v198, v199
v_mfma_f32_16x16x32_bf16 v[160:163], a[204:207], v[228:231], v[160:163]
v_mov_b64 v[196:197], s[96:97]
v_mov_b64 v[198:199], s[96:97]
v_mfma_f32_16x16x32_bf16 v[164:167], a[220:223], v[228:231], 0
v_cvt_pk_bf16_f32 v120, v200, v201
v_cvt_pk_bf16_f32 v121, v202, v203
v_mfma_f32_16x16x32_bf16 v[164:167], a[216:219], v[224:227], v[164:167]
v_exp_f32 v204, v204
v_mfma_f32_16x16x32_bf16 v[164:167], a[212:215], v[220:223], v[164:167]
v_exp_f32 v205, v205
v_mfma_f32_16x16x32_bf16 v[164:167], a[208:211], v[216:219], v[164:167]
v_exp_f32 v206, v206
v_mfma_f32_16x16x32_bf16 v[168:171], a[224:227], v[216:219], 0
v_exp_f32 v207, v207
v_mfma_f32_16x16x32_bf16 v[168:171], a[228:231], v[220:223], v[168:171]
v_exp_f32 v212, v212
v_mfma_f32_16x16x32_bf16 v[168:171], a[232:235], v[224:227], v[168:171]
v_exp_f32 v213, v213
v_mfma_f32_16x16x32_bf16 v[168:171], a[236:239], v[228:231], v[168:171]
v_exp_f32 v214, v214
v_mfma_f32_16x16x32_bf16 v[172:175], a[252:255], v[228:231], 0
v_exp_f32 v215, v215
v_mfma_f32_16x16x32_bf16 v[172:175], a[248:251], v[224:227], v[172:175]
v_exp_f32 v208, v208
v_mfma_f32_16x16x32_bf16 v[172:175], a[244:247], v[220:223], v[172:175]
v_exp_f32 v209, v209
v_mfma_f32_16x16x32_bf16 v[172:175], a[240:243], v[216:219], v[172:175]
ds_read_b128 v[216:219], v240 offset:768
v_cvt_pk_bf16_f32 v112, v204, v205
v_smfmac_f32_16x16x64_bf16 v[196:199], v[96:99], v[104:111], v250
s_mul_i32 s54, s41, 12800
s_add_u32 s54, s54, 101376
v_cvt_pk_bf16_f32 v113, v206, v207
v_mfma_f32_16x16x32_bf16 v[200:203], v[0:3], v[104:107], 0
ds_read_b128 v[204:207], v240 offset:0
v_cvt_pk_bf16_f32 v114, v212, v213
v_mfma_f32_16x16x32_bf16 v[200:203], v[4:7], v[108:111], v[200:203]
v_exp_f32 v210, v210
v_mfma_f32_16x16x32_bf16 v[220:223], v[12:15], v[108:111], 0
v_exp_f32 v211, v211
v_mfma_f32_16x16x32_bf16 v[220:223], v[8:11], v[104:107], v[220:223]
v_cvt_pk_bf16_f32 v115, v214, v215
v_cvt_pk_bf16_f32 v116, v208, v209
v_mfma_f32_16x16x32_bf16 v[228:231], v[16:19], v[104:107], 0
ds_read_b128 v[212:215], v240 offset:512
v_cvt_pk_bf16_f32 v117, v210, v211
v_mfma_f32_16x16x32_bf16 v[228:231], v[20:23], v[108:111], v[228:231]
ds_read_b128 v[208:211], v240 offset:256
v_mov_b64 v[224:225], 0
v_exp_f32 v232, v232
v_add_f32 v196, v196, v197
v_smfmac_f32_16x16x64_bf16 v[224:227], v[192:195], v[112:119], v250
s_mov_b32 vcc_lo, 0xf0000f
s_mov_b32 vcc_hi, 0xf0000f00
v_exp_f32 v233, v233
v_exp_f32 v234, v234
v_exp_f32 v235, v235
v_cvt_pk_bf16_f32 v122, v232, v233
v_cvt_pk_bf16_f32 v123, v234, v235
v_add_f32 v198, v198, v199
v_mbcnt_lo_u32_b32 v243, -1, 0
v_smfmac_f32_16x16x64_bf16 v[224:227], v[192:195], v[120:127], v250 abid:1
s_lshl_b32 s48, s43, 7
s_add_u32 s48, s48, s44
s_add_u32 s48, s48, 0
v_mfma_f32_16x16x32_bf16 v[176:179], v[80:83], v[120:123], v[176:179]
s_waitcnt lgkmcnt(3)
v_exp_f32 v196, v196
v_mfma_f32_16x16x32_bf16 v[176:179], v[64:67], v[116:119], v[176:179]
v_exp_f32 v198, v198
v_mfma_f32_16x16x32_bf16 v[176:179], v[48:51], v[112:115], v[176:179]
s_waitcnt lgkmcnt(2)
v_perm_b32 v140, v198, v196, v251
v_perm_b32 v141, v198, v196, v252
v_mfma_f32_16x16x32_bf16 v[196:199], v[24:27], v[104:107], 0
v_add_f32 v224, v224, v225
v_mbcnt_hi_u32_b32 v243, -1, v243
v_mfma_f32_16x16x32_bf16 v[196:199], v[28:31], v[108:111], v[196:199]
v_rcp_f32 v253, v224
v_mfma_f32_16x16x32_bf16 v[180:183], v[52:55], v[112:115], v[180:183]
v_max3_f32 v254, v254, v224, v253
v_fmac_f32 v144, v176, v253
v_mfma_f32_16x16x32_bf16 v[180:183], v[68:71], v[116:119], v[180:183]
s_waitcnt lgkmcnt(1)
v_fmac_f32 v145, v177, v253
v_fmac_f32 v146, v178, v253
v_mfma_f32_16x16x32_bf16 v[180:183], v[84:87], v[120:123], v[180:183]
s_waitcnt lgkmcnt(0)
v_fmac_f32 v147, v179, v253
v_cvt_pk_bf16_f32 v144, v144, v145
v_mfma_f32_16x16x32_bf16 v[232:235], v[32:35], v[104:107], 0
v_cvt_pk_bf16_f32 v145, v146, v147
v_pk_max_i16 v144, v144, 0
v_mfma_f32_16x16x32_bf16 v[232:235], v[36:39], v[108:111], v[232:235]
s_nop 0
v_fmac_f32 v148, v180, v253
v_fmac_f32 v149, v181, v253
v_mfma_f32_16x16x32_bf16 v[184:187], v[56:59], v[112:115], v[184:187]
v_fmac_f32 v150, v182, v253
v_fmac_f32 v151, v183, v253
v_mfma_f32_16x16x32_bf16 v[184:187], v[72:75], v[116:119], v[184:187]
v_cvt_pk_bf16_f32 v146, v148, v149
v_cvt_pk_bf16_f32 v147, v150, v151
v_mfma_f32_16x16x32_bf16 v[184:187], v[88:91], v[120:123], v[184:187]
v_pk_max_i16 v145, v145, 0
v_pk_max_i16 v146, v146, 0
v_mfma_f32_16x16x32_bf16 v[224:227], v[40:43], v[104:107], 0
v_pk_max_i16 v147, v147, 0
v_bfe_u32 v244, v243, 2, 2
v_mfma_f32_16x16x32_bf16 v[224:227], v[44:47], v[108:111], v[224:227]
v_mov_b32 v245, s54
v_mul_u32_u24 v244, 1600, v244
v_mfma_f32_16x16x32_bf16 v[188:191], v[60:63], v[112:115], v[188:191]
v_fmac_f32 v152, v184, v253
v_fmac_f32 v153, v185, v253
v_mfma_f32_16x16x32_bf16 v[188:191], v[76:79], v[116:119], v[188:191]
v_fmac_f32 v154, v186, v253
v_fmac_f32 v155, v187, v253
v_mfma_f32_16x16x32_bf16 v[188:191], v[92:95], v[120:123], v[188:191]
v_cvt_pk_bf16_f32 v152, v152, v153
v_cvt_pk_bf16_f32 v153, v154, v155
v_mfma_f32_16x16x32_bf16 v[0:3], a[192:195], v[204:207], 0
v_pk_max_i16 v152, v152, 0
v_pk_max_i16 v153, v153, 0
v_mfma_f32_16x16x32_bf16 v[0:3], a[196:199], v[208:211], v[0:3]
v_add_u32 v245, v244, v245
v_bfe_u32 v244, v243, 0, 2
v_mfma_f32_16x16x32_bf16 v[0:3], a[200:203], v[212:215], v[0:3]
v_fmac_f32 v156, v188, v253
v_fmac_f32 v157, v189, v253
v_mfma_f32_16x16x32_bf16 v[0:3], a[204:207], v[216:219], v[0:3]
v_fmac_f32 v158, v190, v253
v_fmac_f32 v159, v191, v253
v_mfma_f32_16x16x32_bf16 v[4:7], a[220:223], v[216:219], 0
v_cvt_pk_bf16_f32 v154, v156, v157
v_cvt_pk_bf16_f32 v155, v158, v159
v_mfma_f32_16x16x32_bf16 v[4:7], a[216:219], v[212:215], v[4:7]
v_pk_max_i16 v154, v154, 0
v_pk_max_i16 v155, v155, 0
v_mfma_f32_16x16x32_bf16 v[4:7], a[212:215], v[208:211], v[4:7]
v_mul_u32_u24 v244, 272, v244
v_add_u32 v245, v244, v245
v_mfma_f32_16x16x32_bf16 v[4:7], a[208:211], v[204:207], v[4:7]
v_bfe_u32 v244, v243, 4, 2
v_lshl_add_u32 v245, v244, 4, v245
v_mfma_f32_16x16x32_bf16 v[8:11], a[224:227], v[204:207], 0
v_mov_b32 v249, s54
v_bfe_u32 v244, v243, 2, 2
v_mfma_f32_16x16x32_bf16 v[8:11], a[228:231], v[208:211], v[8:11]
ds_read_b128 v[236:239], v240 offset:4480
v_add_u32 v249, 256, v249
v_mfma_f32_16x16x32_bf16 v[8:11], a[232:235], v[212:215], v[8:11]
v_mul_u32_u24 v244, 1600, v244
v_add_u32 v249, v244, v249
v_mfma_f32_16x16x32_bf16 v[8:11], a[236:239], v[216:219], v[8:11]
v_bfe_u32 v244, v243, 0, 2
v_mul_u32_u24 v244, 272, v244
v_mfma_f32_16x16x32_bf16 v[12:15], a[252:255], v[216:219], 0
ds_read_b128 v[216:219], v240 offset:4736
v_add_u32 v249, v244, v249
v_mfma_f32_16x16x32_bf16 v[12:15], a[248:251], v[212:215], v[12:15]
ds_read_b128 v[212:215], v240 offset:4992
v_mov_b32 v247, s54
v_mfma_f32_16x16x32_bf16 v[12:15], a[244:247], v[208:211], v[12:15]
ds_read_b128 v[208:211], v245 offset:0
v_bfe_u32 v244, v243, 4, 2
v_mfma_f32_16x16x32_bf16 v[12:15], a[240:243], v[204:207], v[12:15]
ds_read_b128 v[204:207], v245 offset:64
v_add_u32 v247, 1088, v247
v_mfma_f32_32x32x16_bf16 v[176:191], v[100:103], v[140:143], 0
buffer_store_dwordx4 v[144:147], v242, s[20:23], s52 offen offset:0 nt
buffer_store_dwordx4 v[152:155], v242, s[20:23], s52 offen offset:64 nt
v_mul_u32_u24 v244, 1600, v244
v_add_u32 v247, v244, v247
v_bfe_u32 v244, v243, 0, 4
v_lshl_add_u32 v247, v244, 3, v247
ds_read_b64 v[32:33], v247 offset:0
ds_read_b64 v[34:35], v247 offset:6400
ds_read_b64 v[36:37], v247 offset:128
ds_read_b64 v[38:39], v247 offset:6528
ds_read_b64 v[40:41], v247 offset:256
ds_read_b64 v[42:43], v247 offset:6656
ds_read_b64 v[44:45], v247 offset:384
ds_read_b64 v[46:47], v247 offset:6784
v_mov_b32 v248, s55
v_add_u32 v248, 156992, v248
v_bfe_u32 v244, v243, 0, 4
v_lshl_add_u32 v248, v244, 4, v248
ds_read_b64 v[104:105], v248 offset:0
ds_read_b32 v110, v248 offset:8
ds_read_b64 v[108:109], v248 offset:256
ds_read_b32 v111, v248 offset:264
v_mov_b64 v[106:107], 0
v_exp_f32 v200, v200
v_exp_f32 v201, v201
v_exp_f32 v202, v202
v_exp_f32 v203, v203
v_cvt_pk_bf16_f32 v128, v200, v201
v_cvt_pk_bf16_f32 v129, v202, v203
ds_read_b128 v[200:203], v245 offset:128
v_exp_f32 v220, v220
s_waitcnt lgkmcnt(4)
v_cndmask_b32 v104, 0, v104, vcc
v_cndmask_b32 v105, 0, v105, vcc
v_exp_f32 v221, v221
v_mov_b32 v246, 24576
v_mfma_f32_16x16x32_bf16 v[208:211], v[32:35], v[104:107], v[208:211]
s_waitcnt lgkmcnt(1)
v_exp_f32 v222, v222
v_mfma_f32_16x16x32_bf16 v[204:207], v[36:39], v[104:107], v[204:207]
v_exp_f32 v223, v223
v_cvt_pk_bf16_f32 v130, v220, v221
v_cvt_pk_bf16_f32 v131, v222, v223
v_bfe_u32 v244, v243, 0, 2
s_waitcnt lgkmcnt(0)
v_mfma_f32_16x16x32_bf16 v[200:203], v[40:43], v[104:107], v[200:203]
ds_read_b128 v[220:223], v245 offset:192
v_exp_f32 v228, v228
v_exp_f32 v229, v229
v_exp_f32 v230, v230
v_exp_f32 v231, v231
v_cvt_pk_bf16_f32 v132, v228, v229
v_cvt_pk_bf16_f32 v133, v230, v231
ds_read_b128 v[228:231], v249 offset:0
v_exp_f32 v232, v232
v_exp_f32 v233, v233
v_exp_f32 v196, v196
v_cvt_pk_bf16_f32 v136, v232, v233
s_waitcnt lgkmcnt(1)
v_mfma_f32_16x16x32_bf16 v[220:223], v[44:47], v[104:107], v[220:223]
v_exp_f32 v197, v197
v_exp_f32 v198, v198
v_exp_f32 v199, v199
v_exp_f32 v234, v234
v_exp_f32 v235, v235
v_cvt_pk_bf16_f32 v134, v196, v197
v_cvt_pk_bf16_f32 v135, v198, v199
v_mov_b64 v[232:233], 0
v_cvt_pk_bf16_f32 v137, v234, v235
v_lshl_add_u32 v246, v244, 8, v246
v_smfmac_f32_16x16x64_bf16 v[232:235], v[192:195], v[128:135], v250
s_waitcnt lgkmcnt(0)
ds_read_b128 v[196:199], v240 offset:4224
v_exp_f32 v224, v224
v_exp_f32 v225, v225
v_exp_f32 v226, v226
v_exp_f32 v227, v227
v_cvt_pk_bf16_f32 v138, v224, v225
v_cvt_pk_bf16_f32 v139, v226, v227
v_add_f32 v228, v228, v229
v_add_f32 v230, v230, v231
v_smfmac_f32_16x16x64_bf16 v[232:235], v[192:195], v[136:143], v250 abid:1
ds_read_b128 v[224:227], v245 offset:6400
v_add_f32 v228, v228, v110
v_add_f32 v228, v228, v230
v_rcp_f32 v229, v228
v_bfe_u32 v244, v243, 2, 2
s_waitcnt lgkmcnt(1)
v_mfma_f32_16x16x32_bf16 v[16:19], a[192:195], v[196:199], 0
v_fmac_f32 v8, v200, v229
v_fmac_f32 v9, v201, v229
v_mfma_f32_16x16x32_bf16 v[16:19], a[196:199], v[236:239], v[16:19]
v_fmac_f32 v0, v208, v229
v_fmac_f32 v1, v209, v229
v_mfma_f32_16x16x32_bf16 v[16:19], a[200:203], v[216:219], v[16:19]
v_fmac_f32 v10, v202, v229
v_fmac_f32 v11, v203, v229
v_mfma_f32_16x16x32_bf16 v[16:19], a[204:207], v[212:215], v[16:19]
ds_read_b128 v[200:203], v245 offset:6528
v_fmac_f32 v2, v210, v229
v_mfma_f32_16x16x32_bf16 v[20:23], a[220:223], v[212:215], 0
v_cndmask_b32 v108, 0, v108, vcc
v_cndmask_b32 v109, 0, v109, vcc
v_mfma_f32_16x16x32_bf16 v[20:23], a[216:219], v[216:219], v[20:23]
v_add_f32 v232, v232, v233
v_max3_f32 v254, v254, v228, v229
v_mfma_f32_16x16x32_bf16 v[20:23], a[212:215], v[236:239], v[20:23]
v_rcp_f32 v253, v232
v_mfma_f32_16x16x32_bf16 v[20:23], a[208:211], v[196:199], v[20:23]
v_max3_f32 v254, v254, v232, v253
v_fmac_f32 v4, v204, v229
v_mfma_f32_16x16x32_bf16 v[24:27], a[224:227], v[196:199], 0
ds_read_b128 v[232:235], v245 offset:6464
v_fmac_f32 v5, v205, v229
v_mfma_f32_16x16x32_bf16 v[24:27], a[228:231], v[236:239], v[24:27]
v_fmac_f32 v6, v206, v229
v_fmac_f32 v7, v207, v229
v_mfma_f32_16x16x32_bf16 v[24:27], a[232:235], v[216:219], v[24:27]
ds_read_b128 v[204:207], v245 offset:6592
v_mul_u32_u24 v244, 13107200, v244
v_mfma_f32_16x16x32_bf16 v[24:27], a[236:239], v[212:215], v[24:27]
s_waitcnt lgkmcnt(3)
v_fmac_f32 v3, v211, v229
v_cvt_pk_bf16_f32 v0, v0, v1
v_mfma_f32_16x16x32_bf16 v[28:31], a[252:255], v[212:215], 0
ds_read_b128 v[212:215], v249 offset:6400
v_cvt_pk_bf16_f32 v8, v8, v9
v_mfma_f32_16x16x32_bf16 v[28:31], a[248:251], v[216:219], v[28:31]
v_add_u32 v246, v244, v246
v_cvt_pk_bf16_f32 v1, v2, v3
v_mfma_f32_16x16x32_bf16 v[28:31], a[244:247], v[236:239], v[28:31]
v_fmac_f32 v12, v220, v229
v_fmac_f32 v13, v221, v229
v_mfma_f32_16x16x32_bf16 v[28:31], a[240:243], v[196:199], v[28:31]
v_fmac_f32 v14, v222, v229
v_fmac_f32 v15, v223, v229
v_mfma_f32_16x16x32_bf16 v[176:179], v[48:51], v[128:131], v[176:179]
s_waitcnt lgkmcnt(3)
v_cvt_pk_bf16_f32 v9, v10, v11
v_bfe_u32 v244, v243, 4, 2
v_mfma_f32_16x16x32_bf16 v[176:179], v[64:67], v[132:135], v[176:179]
v_cvt_pk_bf16_f32 v2, v4, v5
v_cvt_pk_bf16_f32 v3, v6, v7
v_mfma_f32_16x16x32_bf16 v[176:179], v[80:83], v[136:139], v[176:179]
s_waitcnt lgkmcnt(0)
v_cvt_pk_bf16_f32 v10, v12, v13
v_cvt_pk_bf16_f32 v11, v14, v15
v_mfma_f32_16x16x32_bf16 v[180:183], v[84:87], v[136:139], v[180:183]
v_lshl_add_u32 v246, v244, 4, v246
v_pk_max_i16 v0, v0, 0
v_mfma_f32_16x16x32_bf16 v[180:183], v[52:55], v[128:131], v[180:183]
v_pk_max_i16 v1, v1, 0
v_pk_max_i16 v2, v2, 0
v_mfma_f32_16x16x32_bf16 v[180:183], v[68:71], v[132:135], v[180:183]
v_pk_max_i16 v3, v3, 0
v_pk_max_i16 v8, v8, 0
v_mfma_f32_16x16x32_bf16 v[184:187], v[72:75], v[132:135], v[184:187]
v_pk_max_i16 v9, v9, 0
v_pk_max_i16 v10, v10, 0
v_mfma_f32_16x16x32_bf16 v[184:187], v[88:91], v[136:139], v[184:187]
v_pk_max_i16 v11, v11, 0
v_fmac_f32 v160, v176, v253
v_mfma_f32_16x16x32_bf16 v[184:187], v[56:59], v[128:131], v[184:187]
buffer_store_dwordx4 v[0:3], v246, s[20:23], s48 offen offset:0 nt
buffer_store_dwordx4 v[8:11], v246, s[20:23], s48 offen offset:64 nt
v_fmac_f32 v161, v177, v253
v_fmac_f32 v162, v178, v253
v_fmac_f32 v163, v179, v253
v_cvt_pk_bf16_f32 v160, v160, v161
v_mfma_f32_16x16x32_bf16 v[188:191], v[60:63], v[128:131], v[188:191]
s_nop 0
v_fmac_f32 v168, v184, v253
v_fmac_f32 v169, v185, v253
v_mfma_f32_16x16x32_bf16 v[188:191], v[76:79], v[132:135], v[188:191]
v_fmac_f32 v170, v186, v253
v_fmac_f32 v171, v187, v253
v_mfma_f32_16x16x32_bf16 v[188:191], v[92:95], v[136:139], v[188:191]
v_cvt_pk_bf16_f32 v168, v168, v169
v_fmac_f32 v164, v180, v253
v_mfma_f32_16x16x32_bf16 v[224:227], v[32:35], v[106:109], v[224:227]
v_fmac_f32 v165, v181, v253
v_fmac_f32 v166, v182, v253
v_mfma_f32_16x16x32_bf16 v[232:235], v[36:39], v[106:109], v[232:235]
v_fmac_f32 v167, v183, v253
v_cvt_pk_bf16_f32 v161, v162, v163
v_mfma_f32_16x16x32_bf16 v[200:203], v[40:43], v[106:109], v[200:203]
v_fmac_f32 v172, v188, v253
v_fmac_f32 v173, v189, v253
v_mfma_f32_16x16x32_bf16 v[204:207], v[44:47], v[106:109], v[204:207]
v_fmac_f32 v174, v190, v253
v_fmac_f32 v175, v191, v253
v_cvt_pk_bf16_f32 v169, v170, v171
v_cvt_pk_bf16_f32 v162, v164, v165
v_cvt_pk_bf16_f32 v163, v166, v167
v_cvt_pk_bf16_f32 v170, v172, v173
v_cvt_pk_bf16_f32 v171, v174, v175
v_pk_max_i16 v160, v160, 0
v_pk_max_i16 v161, v161, 0
v_pk_max_i16 v162, v162, 0
v_pk_max_i16 v163, v163, 0
v_pk_max_i16 v168, v168, 0
v_pk_max_i16 v169, v169, 0
v_pk_max_i16 v170, v170, 0
v_pk_max_i16 v171, v171, 0
buffer_store_dwordx4 v[160:163], v242, s[20:23], s53 offen offset:0 nt
buffer_store_dwordx4 v[168:171], v242, s[20:23], s53 offen offset:64 nt
v_add_f32 v212, v212, v213
v_add_f32 v214, v214, v215
v_add_f32 v212, v212, v111
v_add_f32 v212, v212, v214
v_rcp_f32 v213, v212
s_lshl_b32 s51, s43, 7
s_add_u32 s51, s51, s44
s_add_u32 s51, s51, 52428800
v_fmac_f32 v16, v224, v213
v_fmac_f32 v17, v225, v213
v_fmac_f32 v24, v200, v213
v_fmac_f32 v25, v201, v213
v_fmac_f32 v18, v226, v213
v_fmac_f32 v19, v227, v213
v_cvt_pk_bf16_f32 v16, v16, v17
v_fmac_f32 v26, v202, v213
v_fmac_f32 v27, v203, v213
v_cvt_pk_bf16_f32 v24, v24, v25
v_fmac_f32 v20, v232, v213
v_fmac_f32 v21, v233, v213
v_fmac_f32 v22, v234, v213
v_fmac_f32 v23, v235, v213
v_cvt_pk_bf16_f32 v17, v18, v19
v_fmac_f32 v28, v204, v213
v_fmac_f32 v29, v205, v213
v_fmac_f32 v30, v206, v213
v_fmac_f32 v31, v207, v213
v_cvt_pk_bf16_f32 v25, v26, v27
v_cvt_pk_bf16_f32 v18, v20, v21
v_cvt_pk_bf16_f32 v19, v22, v23
v_cvt_pk_bf16_f32 v26, v28, v29
v_cvt_pk_bf16_f32 v27, v30, v31
v_pk_max_i16 v16, v16, 0
v_pk_max_i16 v17, v17, 0
v_pk_max_i16 v18, v18, 0
v_pk_max_i16 v19, v19, 0
v_pk_max_i16 v24, v24, 0
v_pk_max_i16 v25, v25, 0
v_pk_max_i16 v26, v26, 0
v_pk_max_i16 v27, v27, 0
buffer_store_dwordx4 v[16:19], v246, s[20:23], s51 offen offset:0 nt
buffer_store_dwordx4 v[24:27], v246, s[20:23], s51 offen offset:64 nt
v_max3_f32 v254, v254, v212, v213
v_mov_b32 v1, 0x53800000
v_cmp_nle_f32 vcc, v254, v1
s_lshl_b32 s52, s41, 2
s_add_u32 s52, s52, 159040
s_or_b32 s3, vcc_lo, vcc_hi
v_mov_b32 v2, s52
v_mov_b32 v3, s3
ds_write_b32 v2, v3
v_mov_b32 v2, 159040
s_waitcnt lgkmcnt(0)
s_barrier
ds_read_b128 v[4:7], v2
s_waitcnt lgkmcnt(0)
v_or_b32 v4, v4, v5
v_or3_b32 v4, v4, v6, v7
s_nop 0
v_readfirstlane_b32 s3, v4
s_nop 3
s_cmp_eq_u32 s3, 0
s_cbranch_scc1 L_end
L_fast_end:
s_waitcnt vmcnt(0)
s_barrier
s_mov_b32 s45, 8
s_mov_b32 s3, 64
s_mov_b32 s46, s44
s_mov_b32 s47, 0x7ff00000
s_mov_b32 s56, 50688
v_mbcnt_lo_u32_b32 v48, -1, 0
v_mbcnt_hi_u32_b32 v48, -1, v48
v_lshlrev_b32 v53, 4, v48
s_lshl_b32 s54, s41, 13
s_add_u32 s57, s54, 4096
v_and_b32 v49, 16, v48
v_lshlrev_b32 v52, 2, v49
v_lshlrev_b32 v49, 1, v49
v_xor_b32 v50, v53, v49
s_mul_i32 s49, s42, 25344
s_mul_i32 s53, s43, 1056
s_add_u32 s49, s49, s53
s_add_u32 m0, s49, 0
s_lshl_b32 s55, s43, 10
s_add_u32 s55, s55, s44
s_add_u32 s48, s55, 0
v_mov_b32 v237, 0
v_bfe_u32 v49, v48, 0, 2
v_lshl_add_u32 v237, v49, 4, v237
v_bfe_u32 v49, v48, 4, 2
v_lshl_add_u32 v237, v49, 6, v237
v_bfe_u32 v49, v48, 2, 2
v_lshl_add_u32 v237, v49, 8, v237
v_xor_b32 v51, 64, v50
s_lshl_b32 s53, s43, 14
v_mov_b32 v248, s53
v_add_u32 v248, 50688, v248
v_bfe_u32 v49, v48, 4, 2
v_lshl_add_u32 v248, v49, 10, v248
v_bfe_u32 v49, v48, 2, 2
v_lshl_add_u32 v248, v49, 7, v248
v_bfe_u32 v49, v48, 3, 1
v_lshl_add_u32 v248, v49, 5, v248
v_bfe_u32 v49, v48, 4, 1
v_lshl_add_u32 v248, v49, 6, v248
v_bfe_u32 v49, v48, 0, 2
v_lshl_add_u32 v248, v49, 3, v248
v_mov_b32 v252, s53
v_add_u32 v252, 116224, v252
v_bfe_u32 v49, v48, 4, 2
v_lshl_add_u32 v252, v49, 10, v252
v_bfe_u32 v49, v48, 2, 2
v_lshl_add_u32 v252, v49, 7, v252
v_bfe_u32 v49, v48, 3, 1
v_lshl_add_u32 v252, v49, 6, v252
v_bfe_u32 v49, v48, 0, 2
v_lshl_add_u32 v252, v49, 4, v252
s_mul_i32 s53, s42, 25344
v_bfe_u32 v49, v48, 2, 2
v_mov_b32 v236, s53
v_mul_u32_u24 v49, 1056, v49
v_add_u32 v236, v49, v236
v_bfe_u32 v49, v48, 0, 2
s_add_u32 s53, s54, 83456
v_lshl_add_u32 v236, v49, 6, v236
v_add_u32 v104, s53, v50
v_add_u32 v105, s53, v51
v_bfe_u32 v49, v48, 4, 2
s_lshl_b32 s53, s41, 12
v_lshl_add_u32 v236, v49, 4, v236
v_mov_b32 v54, s53
v_add_u32 v54, 50688, v54
v_bfe_u32 v49, v48, 3, 1
v_lshl_add_u32 v54, v49, 14, v54
v_bfe_u32 v49, v48, 4, 2
v_lshl_add_u32 v54, v49, 7, v54
v_bfe_u32 v49, v48, 2, 1
v_lshl_add_u32 v54, v49, 6, v54
v_bfe_u32 v49, v48, 5, 1
v_lshl_add_u32 v54, v49, 5, v54
v_bfe_u32 v49, v48, 0, 2
v_lshl_add_u32 v54, v49, 3, v54
s_lshl_b32 s53, s43, 7
v_mov_b32 v239, s53
v_bfe_u32 v49, v48, 0, 4
v_lshl_add_u32 v239, v49, 8, v239
s_mul_i32 s52, s41, 12288
s_add_u32 s52, s52, 101376
v_bfe_u32 v49, v48, 4, 2
v_lshl_add_u32 v239, v49, 4, v239
v_mov_b32 v241, s52
v_add_u32 v241, 8192, v241
v_bfe_u32 v49, v48, 4, 2
v_lshl_add_u32 v241, v49, 1, v241
v_bfe_u32 v49, v48, 0, 4
v_lshl_add_u32 v241, v49, 3, v241
buffer_load_dwordx4 v[152:155], v53, s[24:27], s54 offen offset:0
v_mov_b32 v240, s52
v_bfe_u32 v49, v48, 2, 2
v_lshl_add_u32 v240, v49, 7, v240
buffer_load_dwordx4 v[156:159], v53, s[24:27], s54 offen offset:1024
v_lshlrev_b32 v49, 2, v48
v_xor_b32 v49, v49, v48
v_and_b32 v49, 48, v49
buffer_load_dwordx4 v[160:163], v53, s[24:27], s54 offen offset:2048
s_lshl_b32 s53, s41, 10
v_add_u32 v240, v49, v240
v_mov_b32 v254, s53
v_add_u32 v254, 150528, v254
buffer_load_dwordx4 v[164:167], v53, s[24:27], s54 offen offset:3072
v_bfe_u32 v49, v48, 0, 6
v_mov_b32 v40, 0
v_mov_b32 v41, 0
buffer_load_dwordx4 v[168:171], v53, s[24:27], s57 offen offset:0
v_mov_b32 v42, 0
v_mov_b32 v43, 0
v_lshl_add_u32 v254, v49, 4, v254
buffer_load_dwordx4 v[172:175], v53, s[24:27], s57 offen offset:1024
ds_write_b128 v254, v[40:43] offset:0
buffer_load_dwordx4 v[176:179], v53, s[24:27], s57 offen offset:2048
ds_write_b128 v254, v[40:43] offset:256
buffer_load_dwordx4 v[180:183], v53, s[24:27], s57 offen offset:3072
buffer_load_dwordx4 v237, s[16:19], s48 offen nt lds
s_add_u32 m0, s49, 2112
s_add_u32 s48, s55, 2048
v_mov_b32 v245, s52
v_add_u32 v245, 4096, v245
buffer_load_dwordx4 v237, s[16:19], s48 offen nt lds
s_add_u32 m0, s49, 4224
s_add_u32 s48, s55, 4096
v_bfe_u32 v49, v48, 0, 2
buffer_load_dwordx4 v237, s[16:19], s48 offen nt lds
s_add_u32 m0, s49, 6336
s_add_u32 s48, s55, 6144
s_mov_b32 vcc_lo, 0x11111111
s_mov_b32 vcc_hi, 0x11111111
buffer_load_dwordx4 v237, s[16:19], s48 offen nt lds
s_add_u32 m0, s54, 50688
v_lshl_add_u32 v245, v49, 7, v245
v_mov_b32 v254, 150528
v_lshlrev_b32 v49, 4, v48
buffer_load_dwordx4 v50, s[28:31], s54 offen offset:0 lds
v_cndmask_b32 v240, v254, v240, vcc
v_xor_b32 v49, v49, v48
v_and_b32 v49, 48, v49
buffer_load_dwordx4 v51, s[28:31], s54 offen offset:1024 lds
s_mov_b32 vcc_lo, 0xf000f
s_mov_b32 vcc_hi, 0xf000f
v_add_u32 v245, v49, v245
buffer_load_dwordx4 v50, s[28:31], s54 offen offset:2048 lds
v_cndmask_b32 v242, v254, v245, vcc
s_mov_b32 vcc_lo, 0xf000f0
s_mov_b32 vcc_hi, 0xf000f0
buffer_load_dwordx4 v51, s[28:31], s54 offen offset:3072 lds
s_add_u32 m0, s57, 50688
v_cndmask_b32 v243, v254, v245, vcc
s_mov_b32 vcc_lo, 0xf000f00
s_mov_b32 vcc_hi, 0xf000f00
buffer_load_dwordx4 v50, s[28:31], s57 offen offset:0 lds
v_cndmask_b32 v244, v254, v245, vcc
s_mov_b32 vcc_lo, 0xf000f000
s_mov_b32 vcc_hi, 0xf000f000
v_mov_b32 v246, s52
buffer_load_dwordx4 v51, s[28:31], s57 offen offset:1024 lds
v_add_u32 v246, 4096, v246
v_bfe_u32 v49, v48, 0, 2
v_cndmask_b32 v245, v254, v245, vcc
buffer_load_dwordx4 v50, s[28:31], s57 offen offset:2048 lds
v_lshl_add_u32 v246, v49, 7, v246
v_mov_b32 v254, 154880
v_bfe_u32 v49, v48, 2, 2
buffer_load_dwordx4 v51, s[28:31], s57 offen offset:3072 lds
s_add_u32 m0, s49, 16896
s_mov_b32 vcc_lo, 0xf000f
s_mov_b32 vcc_hi, 0xf000f
v_lshl_add_u32 v254, v49, 3, v254
v_cndmask_b32 v246, v254, v246, vcc
v_xor_b32 v249, 32, v248
v_xor_b32 v250, 64, v248
v_xor_b32 v251, 96, v248
s_mul_i32 s4, s43, 13107200
s_add_u32 s4, s4, s44
s_add_u32 s4, s4, 24576
s_add_u32 s5, s55, 104857600
s_sub_u32 s5, s5, s4
s_add_u32 s48, s4, 0
v_xor_b32 v52, v53, v52
v_xor_b32 v55, 96, v54
v_xor_b32 v253, 64, v252
v_lshlrev_b32 v49, 4, v48
v_xor_b32 v49, v49, v48
v_and_b32 v49, 48, v49
v_add_u32 v246, v49, v246
v_add_u32 v246, v49, v246
v_mov_b32 v50, s52
v_bfe_u32 v49, v48, 0, 4
v_lshl_add_u32 v50, v49, 7, v50
v_lshlrev_b32 v49, 4, v48
v_xor_b32 v49, v49, v48
v_and_b32 v49, 48, v49
v_add_u32 v50, v49, v50
v_mov_b32 v51, s52
v_add_u32 v51, 8192, v51
v_bfe_u32 v49, v48, 4, 2
v_lshl_add_u32 v51, v49, 9, v51
v_bfe_u32 v49, v48, 0, 4
v_lshl_add_u32 v51, v49, 3, v51
s_add_u32 s50, s55, 13107200
s_mov_b32 s51, 2048
v_xor_b32 v247, 32, v48
s_mov_b32 s52, 0x7ff00000
v_lshlrev_b32 v247, 2, v247
s_waitcnt vmcnt(19)
v_and_b32 v254, 0xffff0000, v152
buffer_load_dwordx4 v237, s[16:19], s48 offen nt lds
s_add_u32 m0, s49, 19008
s_add_u32 s48, s4, 26214400
v_and_b32 v255, 0xffff0000, v153
v_lshlrev_b32 v152, 16, v152
v_lshlrev_b32 v153, 16, v153
v_mul_f32 v254, s40, v254
v_mul_f32 v152, s40, v152
v_mul_f32 v255, s40, v255
v_mul_f32 v153, s40, v153
v_cvt_pk_bf16_f32 v152, v152, v254
v_cvt_pk_bf16_f32 v153, v153, v255
v_and_b32 v254, 0xffff0000, v154
v_and_b32 v255, 0xffff0000, v155
v_lshlrev_b32 v154, 16, v154
v_lshlrev_b32 v155, 16, v155
v_mul_f32 v254, s40, v254
v_mul_f32 v154, s40, v154
v_mul_f32 v255, s40, v255
v_mul_f32 v155, s40, v155
v_cvt_pk_bf16_f32 v154, v154, v254
v_cvt_pk_bf16_f32 v155, v155, v255
s_waitcnt vmcnt(19)
v_and_b32 v254, 0xffff0000, v156
v_and_b32 v255, 0xffff0000, v157
v_lshlrev_b32 v156, 16, v156
v_lshlrev_b32 v157, 16, v157
v_mul_f32 v254, s40, v254
v_mul_f32 v156, s40, v156
v_mul_f32 v255, s40, v255
v_mul_f32 v157, s40, v157
v_cvt_pk_bf16_f32 v156, v156, v254
buffer_load_dwordx4 v237, s[16:19], s48 offen nt lds
s_add_u32 m0, s49, 21120
s_add_u32 s48, s4, 52428800
v_cvt_pk_bf16_f32 v157, v157, v255
v_and_b32 v254, 0xffff0000, v158
v_and_b32 v255, 0xffff0000, v159
v_lshlrev_b32 v158, 16, v158
v_lshlrev_b32 v159, 16, v159
v_mul_f32 v254, s40, v254
v_mul_f32 v158, s40, v158
v_mul_f32 v255, s40, v255
v_mul_f32 v159, s40, v159
v_cvt_pk_bf16_f32 v158, v158, v254
v_cvt_pk_bf16_f32 v159, v159, v255
s_waitcnt vmcnt(19)
v_and_b32 v254, 0xffff0000, v160
v_and_b32 v255, 0xffff0000, v161
v_lshlrev_b32 v160, 16, v160
v_lshlrev_b32 v161, 16, v161
v_mul_f32 v254, s40, v254
v_mul_f32 v160, s40, v160
v_mul_f32 v255, s40, v255
v_mul_f32 v161, s40, v161
v_cvt_pk_bf16_f32 v160, v160, v254
v_cvt_pk_bf16_f32 v161, v161, v255
v_and_b32 v254, 0xffff0000, v162
v_and_b32 v255, 0xffff0000, v163
v_lshlrev_b32 v162, 16, v162
v_lshlrev_b32 v163, 16, v163
v_mul_f32 v254, s40, v254
v_mul_f32 v162, s40, v162
v_mul_f32 v255, s40, v255
v_mul_f32 v163, s40, v163
v_cvt_pk_bf16_f32 v162, v162, v254
buffer_load_dwordx4 v237, s[16:19], s48 offen nt lds
s_add_u32 m0, s49, 23232
s_add_u32 s48, s4, 78643200
ds_write_b128 v104, v[152:155] offset:0
ds_write_b128 v105, v[156:159] offset:1024
v_cvt_pk_bf16_f32 v163, v163, v255
s_waitcnt vmcnt(19)
v_and_b32 v254, 0xffff0000, v164
v_and_b32 v255, 0xffff0000, v165
v_lshlrev_b32 v164, 16, v164
v_lshlrev_b32 v165, 16, v165
v_mul_f32 v254, s40, v254
v_mul_f32 v164, s40, v164
v_mul_f32 v255, s40, v255
v_mul_f32 v165, s40, v165
v_cvt_pk_bf16_f32 v164, v164, v254
v_cvt_pk_bf16_f32 v165, v165, v255
v_and_b32 v254, 0xffff0000, v166
v_and_b32 v255, 0xffff0000, v167
v_lshlrev_b32 v166, 16, v166
v_lshlrev_b32 v167, 16, v167
v_mul_f32 v254, s40, v254
buffer_load_dwordx4 v237, s[16:19], s48 offen nt lds
s_add_u32 m0, s54, 116224
s_add_u32 s48, s55, 8192
ds_write_b128 v104, v[160:163] offset:2048
v_mul_f32 v166, s40, v166
v_mul_f32 v255, s40, v255
v_mul_f32 v167, s40, v167
v_cvt_pk_bf16_f32 v166, v166, v254
v_cvt_pk_bf16_f32 v167, v167, v255
s_waitcnt vmcnt(19)
v_and_b32 v254, 0xffff0000, v168
v_and_b32 v255, 0xffff0000, v169
v_lshlrev_b32 v168, 16, v168
v_lshlrev_b32 v169, 16, v169
v_mul_f32 v254, s40, v254
v_mul_f32 v168, s40, v168
v_mul_f32 v255, s40, v255
v_mul_f32 v169, s40, v169
v_cvt_pk_bf16_f32 v168, v168, v254
v_cvt_pk_bf16_f32 v169, v169, v255
v_and_b32 v254, 0xffff0000, v170
v_and_b32 v255, 0xffff0000, v171
v_lshlrev_b32 v170, 16, v170
v_lshlrev_b32 v171, 16, v171
v_mul_f32 v254, s40, v254
v_mul_f32 v170, s40, v170
v_mul_f32 v255, s40, v255
v_mul_f32 v171, s40, v171
buffer_load_dwordx4 v52, s[32:35], s54 offen offset:0 lds
ds_write_b128 v105, v[164:167] offset:3072
v_cvt_pk_bf16_f32 v170, v170, v254
v_cvt_pk_bf16_f32 v171, v171, v255
s_waitcnt vmcnt(19)
v_and_b32 v254, 0xffff0000, v172
v_and_b32 v255, 0xffff0000, v173
v_lshlrev_b32 v172, 16, v172
v_lshlrev_b32 v173, 16, v173
v_mul_f32 v254, s40, v254
v_mul_f32 v172, s40, v172
v_mul_f32 v255, s40, v255
v_mul_f32 v173, s40, v173
v_cvt_pk_bf16_f32 v172, v172, v254
v_cvt_pk_bf16_f32 v173, v173, v255
v_and_b32 v254, 0xffff0000, v174
v_and_b32 v255, 0xffff0000, v175
v_lshlrev_b32 v174, 16, v174
v_lshlrev_b32 v175, 16, v175
v_mul_f32 v254, s40, v254
v_mul_f32 v174, s40, v174
v_mul_f32 v255, s40, v255
v_mul_f32 v175, s40, v175
v_cvt_pk_bf16_f32 v174, v174, v254
v_cvt_pk_bf16_f32 v175, v175, v255
s_waitcnt vmcnt(18)
v_and_b32 v254, 0xffff0000, v176
v_and_b32 v255, 0xffff0000, v177
v_lshlrev_b32 v176, 16, v176
buffer_load_dwordx4 v52, s[32:35], s54 offen offset:1024 lds
ds_write_b128 v104, v[168:171] offset:4096
v_lshlrev_b32 v177, 16, v177
v_mul_f32 v254, s40, v254
v_mul_f32 v176, s40, v176
v_mul_f32 v255, s40, v255
v_mul_f32 v177, s40, v177
v_cvt_pk_bf16_f32 v176, v176, v254
v_cvt_pk_bf16_f32 v177, v177, v255
v_and_b32 v254, 0xffff0000, v178
v_and_b32 v255, 0xffff0000, v179
v_lshlrev_b32 v178, 16, v178
v_lshlrev_b32 v179, 16, v179
v_mul_f32 v254, s40, v254
v_mul_f32 v178, s40, v178
v_mul_f32 v255, s40, v255
v_mul_f32 v179, s40, v179
v_cvt_pk_bf16_f32 v178, v178, v254
v_cvt_pk_bf16_f32 v179, v179, v255
s_waitcnt vmcnt(18)
v_and_b32 v254, 0xffff0000, v180
v_and_b32 v255, 0xffff0000, v181
v_lshlrev_b32 v180, 16, v180
v_lshlrev_b32 v181, 16, v181
v_mul_f32 v254, s40, v254
v_mul_f32 v180, s40, v180
v_mul_f32 v255, s40, v255
v_mul_f32 v181, s40, v181
buffer_load_dwordx4 v52, s[32:35], s54 offen offset:2048 lds
ds_write_b128 v105, v[172:175] offset:5120
ds_write_b128 v104, v[176:179] offset:6144
v_cvt_pk_bf16_f32 v180, v180, v254
v_cvt_pk_bf16_f32 v181, v181, v255
v_and_b32 v254, 0xffff0000, v182
v_and_b32 v255, 0xffff0000, v183
v_lshlrev_b32 v182, 16, v182
v_lshlrev_b32 v183, 16, v183
v_mul_f32 v254, s40, v254
v_mul_f32 v182, s40, v182
v_mul_f32 v255, s40, v255
v_mul_f32 v183, s40, v183
v_cvt_pk_bf16_f32 v182, v182, v254
v_cvt_pk_bf16_f32 v183, v183, v255
ds_write_b128 v105, v[180:183] offset:7168
buffer_load_dwordx4 v52, s[32:35], s54 offen offset:3072 lds
s_add_u32 m0, s57, 116224
v_xor_b32 v254, 32, v54
v_xor_b32 v255, 64, v54
s_mov_b32 s53, 0x7ff00000
buffer_load_dwordx4 v52, s[32:35], s57 offen offset:0 lds
buffer_load_dwordx4 v52, s[32:35], s57 offen offset:1024 lds
s_waitcnt vmcnt(10) lgkmcnt(0)
s_barrier
ds_read_b64_tr_b16 a[64:65], v248 offset:0
ds_read_b64_tr_b16 a[66:67], v248 offset:512
ds_read_b128 v[188:191], v236 offset:0
ds_read_b64_tr_b16 a[68:69], v248 offset:4096
ds_read_b64_tr_b16 a[70:71], v248 offset:4608
buffer_load_dwordx4 v52, s[32:35], s57 offen offset:2048 lds
ds_read_b128 v[196:199], v236 offset:256
ds_read_b64_tr_b16 a[72:73], v248 offset:8192
ds_read_b64_tr_b16 a[74:75], v248 offset:8704
ds_read_b128 v[200:203], v236 offset:512
ds_read_b64_tr_b16 a[76:77], v248 offset:12288
ds_read_b64_tr_b16 a[78:79], v248 offset:12800
ds_read_b128 v[204:207], v236 offset:768
ds_read_b64_tr_b16 a[92:93], v249 offset:12288
ds_read_b64_tr_b16 a[94:95], v249 offset:12800
ds_read_b64_tr_b16 a[88:89], v249 offset:8192
ds_read_b64_tr_b16 a[90:91], v249 offset:8704
ds_read_b64_tr_b16 a[84:85], v249 offset:4096
ds_read_b64_tr_b16 a[86:87], v249 offset:4608
ds_read_b64_tr_b16 a[80:81], v249 offset:0
ds_read_b64_tr_b16 a[82:83], v249 offset:512
s_waitcnt lgkmcnt(15)
v_mfma_f32_16x16x32_bf16 v[192:195], a[64:67], v[188:191], 0
ds_read_b64_tr_b16 a[96:97], v250 offset:0
ds_read_b64_tr_b16 a[98:99], v250 offset:512
s_waitcnt lgkmcnt(15)
v_mfma_f32_16x16x32_bf16 v[192:195], a[68:71], v[196:199], v[192:195]
s_waitcnt lgkmcnt(14)
ds_read_b64_tr_b16 a[100:101], v250 offset:4096
s_waitcnt lgkmcnt(14)
v_mfma_f32_16x16x32_bf16 v[192:195], a[72:75], v[200:203], v[192:195]
s_waitcnt lgkmcnt(11)
ds_read_b64_tr_b16 a[102:103], v250 offset:4608
ds_read_b64_tr_b16 a[104:105], v250 offset:8192
v_mfma_f32_16x16x32_bf16 v[192:195], a[76:79], v[204:207], v[192:195]
s_waitcnt lgkmcnt(9)
ds_read_b64_tr_b16 a[106:107], v250 offset:8704
ds_read_b64_tr_b16 a[108:109], v250 offset:12288
v_mfma_f32_16x16x32_bf16 v[208:211], a[92:95], v[204:207], 0
s_waitcnt lgkmcnt(7)
buffer_load_dwordx4 v52, s[32:35], s57 offen offset:3072 lds
s_add_u32 m0, s49, 8448
v_mfma_f32_16x16x32_bf16 v[208:211], a[88:91], v[200:203], v[208:211]
ds_read_b64_tr_b16 a[110:111], v250 offset:12800
v_cvt_pk_bf16_f32 v0, v192, v193
v_mfma_f32_16x16x32_bf16 v[208:211], a[84:87], v[196:199], v[208:211]
s_waitcnt lgkmcnt(6)
ds_read_b64_tr_b16 a[124:125], v251 offset:12288
v_cvt_pk_bf16_f32 v1, v194, v195
v_mfma_f32_16x16x32_bf16 v[208:211], a[80:83], v[188:191], v[208:211]
s_waitcnt lgkmcnt(6)
ds_read_b64_tr_b16 a[126:127], v251 offset:12800
ds_read_b64_tr_b16 a[120:121], v251 offset:8192
v_mfma_f32_16x16x32_bf16 v[192:195], a[96:99], v[188:191], 0
s_waitcnt lgkmcnt(6)
ds_read_b64_tr_b16 a[122:123], v251 offset:8704
ds_read_b64_tr_b16 a[116:117], v251 offset:4096
v_mfma_f32_16x16x32_bf16 v[192:195], a[100:103], v[196:199], v[192:195]
s_waitcnt lgkmcnt(6)
ds_read_b64_tr_b16 a[118:119], v251 offset:4608
v_cvt_pk_bf16_f32 v2, v208, v209
v_mfma_f32_16x16x32_bf16 v[192:195], a[104:107], v[200:203], v[192:195]
ds_read_b64_tr_b16 a[112:113], v251 offset:0
s_waitcnt lgkmcnt(7)
v_mfma_f32_16x16x32_bf16 v[192:195], a[108:111], v[204:207], v[192:195]
ds_read_b64_tr_b16 a[114:115], v251 offset:512
v_cvt_pk_bf16_f32 v3, v210, v211
ds_read_b128 v[184:187], v236 offset:4992
s_waitcnt lgkmcnt(7)
v_mfma_f32_16x16x32_bf16 v[208:211], a[124:127], v[204:207], 0
s_waitcnt lgkmcnt(6)
buffer_load_dwordx4 v[120:123], v53, s[36:39], s54 offen offset:0
s_waitcnt lgkmcnt(5)
v_mfma_f32_16x16x32_bf16 v[208:211], a[120:123], v[200:203], v[208:211]
s_waitcnt lgkmcnt(4)
ds_read_b128 v[216:219], v236 offset:4736
s_waitcnt lgkmcnt(4)
v_mfma_f32_16x16x32_bf16 v[208:211], a[116:119], v[196:199], v[208:211]
ds_read_b128 v[204:207], v236 offset:4480
v_cvt_pk_bf16_f32 v5, v194, v195
v_cvt_pk_bf16_f32 v4, v192, v193
s_waitcnt lgkmcnt(3)
v_mfma_f32_16x16x32_bf16 v[208:211], a[112:115], v[188:191], v[208:211]
ds_read_b128 v[192:195], v236 offset:4224
s_waitcnt lgkmcnt(3)
v_mfma_f32_16x16x32_bf16 v[200:203], a[124:127], v[184:187], 0
ds_read_b64_tr_b16 a[0:1], v248 offset:32768
ds_read_b64_tr_b16 a[2:3], v248 offset:33280
v_mfma_f32_16x16x32_bf16 v[220:223], a[92:95], v[184:187], 0
ds_read_b64_tr_b16 a[4:5], v248 offset:36864
s_waitcnt lgkmcnt(5)
v_mfma_f32_16x16x32_bf16 v[200:203], a[120:123], v[216:219], v[200:203]
ds_read_b64_tr_b16 a[6:7], v248 offset:37376
s_waitcnt lgkmcnt(5)
v_mfma_f32_16x16x32_bf16 v[200:203], a[116:119], v[204:207], v[200:203]
ds_read_b64_tr_b16 a[8:9], v248 offset:40960
v_cvt_pk_bf16_f32 v6, v208, v209
v_mfma_f32_16x16x32_bf16 v[220:223], a[88:91], v[216:219], v[220:223]
buffer_load_dwordx4 v[124:127], v53, s[36:39], s54 offen offset:1024
s_waitcnt lgkmcnt(5)
v_mfma_f32_16x16x32_bf16 v[200:203], a[112:115], v[192:195], v[200:203]
ds_read_b64_tr_b16 a[10:11], v248 offset:41472
v_cvt_pk_bf16_f32 v7, v210, v211
v_mfma_f32_16x16x32_bf16 v[208:211], a[96:99], v[192:195], 0
s_waitcnt lgkmcnt(4)
ds_read_b64_tr_b16 a[12:13], v248 offset:45056
ds_read_b64_tr_b16 a[14:15], v248 offset:45568
v_mfma_f32_16x16x32_bf16 v[208:211], a[100:103], v[204:207], v[208:211]
s_waitcnt lgkmcnt(5)
ds_read_b64_tr_b16 a[16:17], v249 offset:32768
ds_read_b64_tr_b16 a[18:19], v249 offset:33280
v_mfma_f32_16x16x32_bf16 v[208:211], a[104:107], v[216:219], v[208:211]
s_waitcnt lgkmcnt(6)
ds_read_b64_tr_b16 a[20:21], v249 offset:36864
ds_read_b64_tr_b16 a[22:23], v249 offset:37376
v_mfma_f32_16x16x32_bf16 v[208:211], a[108:111], v[184:187], v[208:211]
s_waitcnt lgkmcnt(7)
ds_read_b64_tr_b16 a[24:25], v249 offset:40960
ds_read_b64_tr_b16 a[26:27], v249 offset:41472
v_mfma_f32_16x16x32_bf16 v[220:223], a[84:87], v[204:207], v[220:223]
ds_read_b64_tr_b16 a[28:29], v249 offset:45056
ds_read_b64_tr_b16 a[30:31], v249 offset:45568
v_mfma_f32_16x16x32_bf16 v[220:223], a[80:83], v[192:195], v[220:223]
s_waitcnt lgkmcnt(10)
ds_read_b64_tr_b16 a[32:33], v250 offset:32768
ds_read_b64_tr_b16 a[34:35], v250 offset:33280
v_mfma_f32_16x16x32_bf16 v[188:191], a[64:67], v[192:195], 0
s_waitcnt lgkmcnt(10)
ds_read_b64_tr_b16 a[36:37], v250 offset:36864
ds_read_b64_tr_b16 a[38:39], v250 offset:37376
v_mfma_f32_16x16x32_bf16 v[188:191], a[72:75], v[216:219], v[188:191]
s_waitcnt lgkmcnt(10)
buffer_load_dwordx4 v[128:131], v53, s[36:39], s54 offen offset:2048
ds_read_b64_tr_b16 a[40:41], v250 offset:40960
v_mfma_f32_16x16x32_bf16 v[188:191], a[76:79], v[184:187], v[188:191]
s_waitcnt lgkmcnt(9)
ds_read_b64_tr_b16 a[42:43], v250 offset:41472
ds_read_b64_tr_b16 a[44:45], v250 offset:45056
v_mfma_f32_16x16x32_bf16 v[188:191], a[68:71], v[204:207], v[188:191]
s_waitcnt lgkmcnt(9)
ds_read_b64_tr_b16 a[46:47], v250 offset:45568
ds_read_b64_tr_b16 a[48:49], v251 offset:32768
ds_read_b64_tr_b16 a[50:51], v251 offset:33280
ds_read_b64_tr_b16 a[52:53], v251 offset:36864
ds_read_b64_tr_b16 a[54:55], v251 offset:37376
ds_read_b64_tr_b16 a[56:57], v251 offset:40960
ds_read_b64_tr_b16 a[58:59], v251 offset:41472
s_waitcnt vmcnt(11)
s_barrier
ds_read_b128 v[56:59], v236 offset:16896
ds_read_b128 v[60:63], v236 offset:17152
ds_read_b128 v[64:67], v236 offset:17408
ds_read_b128 v[68:71], v236 offset:17664
ds_read_b128 v[72:75], v236 offset:21120
ds_read_b128 v[76:79], v236 offset:21376
ds_read_b128 v[80:83], v236 offset:21632
ds_read_b128 v[84:87], v236 offset:21888
ds_read_b64_tr_b16 a[60:61], v251 offset:45056
ds_read_b64_tr_b16 a[62:63], v251 offset:45568
v_cvt_pk_bf16_f32 v14, v200, v201
buffer_load_dwordx4 v[132:135], v53, s[36:39], s54 offen offset:3072
v_cvt_pk_bf16_f32 v15, v202, v203
v_cvt_pk_bf16_f32 v9, v190, v191
v_cvt_pk_bf16_f32 v8, v188, v189
v_cvt_pk_bf16_f32 v13, v210, v211
v_cvt_pk_bf16_f32 v12, v208, v209
v_cvt_pk_bf16_f32 v10, v220, v221
v_cvt_pk_bf16_f32 v11, v222, v223
s_waitcnt lgkmcnt(9)
v_mfma_f32_16x16x32_bf16 v[156:159], a[64:67], v[56:59], 0
s_waitcnt lgkmcnt(7)
v_mfma_f32_16x16x32_bf16 v[156:159], a[68:71], v[60:63], v[156:159]
s_waitcnt lgkmcnt(3)
v_mfma_f32_16x16x32_bf16 v[156:159], a[72:75], v[64:67], v[156:159]
s_waitcnt lgkmcnt(0)
v_mfma_f32_16x16x32_bf16 v[156:159], a[76:79], v[68:71], v[156:159]
s_nop 2
v_mfma_f32_16x16x32_bf16 v[160:163], a[92:95], v[68:71], 0
s_nop 2
v_mfma_f32_16x16x32_bf16 v[160:163], a[88:91], v[64:67], v[160:163]
s_waitcnt vmcnt(4)
s_barrier
v_mfma_f32_16x16x32_bf16 v[160:163], a[84:87], v[60:63], v[160:163]
buffer_load_dwordx4 v[136:139], v53, s[36:39], s57 offen offset:0
ds_read_b64_tr_b16 a[128:129], v252 offset:0
v_mfma_f32_16x16x32_bf16 v[160:163], a[80:83], v[56:59], v[160:163]
ds_read_b64_tr_b16 a[130:131], v252 offset:512
ds_read_b64_tr_b16 a[132:133], v252 offset:4096
v_mfma_f32_16x16x32_bf16 v[164:167], a[96:99], v[56:59], 0
ds_read_b64_tr_b16 a[134:135], v252 offset:4608
ds_read_b64_tr_b16 a[136:137], v252 offset:8192
v_mfma_f32_16x16x32_bf16 v[164:167], a[100:103], v[60:63], v[164:167]
ds_read_b64_tr_b16 a[138:139], v252 offset:8704
ds_read_b64_tr_b16 a[140:141], v252 offset:12288
v_mfma_f32_16x16x32_bf16 v[164:167], a[104:107], v[64:67], v[164:167]
ds_read_b64_tr_b16 a[142:143], v252 offset:12800
ds_read_b64_tr_b16 a[144:145], v252 offset:8
v_mfma_f32_16x16x32_bf16 v[164:167], a[108:111], v[68:71], v[164:167]
ds_read_b64_tr_b16 a[146:147], v252 offset:520
ds_read_b64_tr_b16 a[148:149], v252 offset:4104
v_mfma_f32_16x16x32_bf16 v[168:171], a[124:127], v[68:71], 0
s_waitcnt lgkmcnt(10)
ds_read_b64_tr_b16 a[150:151], v252 offset:4616
v_cvt_pk_bf16_f32 v88, v156, v157
v_mfma_f32_16x16x32_bf16 v[168:171], a[120:123], v[64:67], v[168:171]
s_waitcnt lgkmcnt(9)
ds_read_b64_tr_b16 a[152:153], v252 offset:8200
v_cvt_pk_bf16_f32 v89, v158, v159
v_mfma_f32_16x16x32_bf16 v[168:171], a[116:119], v[60:63], v[168:171]
s_waitcnt lgkmcnt(8)
ds_read_b64_tr_b16 a[154:155], v252 offset:8712
ds_read_b64_tr_b16 a[156:157], v252 offset:12296
v_mfma_f32_16x16x32_bf16 v[168:171], a[112:115], v[56:59], v[168:171]
s_waitcnt lgkmcnt(8)
buffer_load_dwordx4 v[140:143], v53, s[36:39], s57 offen offset:1024
ds_read_b64_tr_b16 a[158:159], v252 offset:12808
v_mfma_f32_16x16x32_bf16 v[172:175], a[64:67], v[72:75], 0
s_waitcnt lgkmcnt(7)
ds_read_b64_tr_b16 a[160:161], v253 offset:0
v_cvt_pk_bf16_f32 v90, v160, v161
v_mfma_f32_16x16x32_bf16 v[172:175], a[68:71], v[76:79], v[172:175]
s_waitcnt lgkmcnt(6)
ds_read_b64_tr_b16 a[162:163], v253 offset:512
v_cvt_pk_bf16_f32 v91, v162, v163
v_mfma_f32_16x16x32_bf16 v[172:175], a[72:75], v[80:83], v[172:175]
s_waitcnt lgkmcnt(6)
ds_read_b64_tr_b16 a[164:165], v253 offset:4096
ds_read_b64_tr_b16 a[166:167], v253 offset:4608
v_mfma_f32_16x16x32_bf16 v[172:175], a[76:79], v[84:87], v[172:175]
s_waitcnt lgkmcnt(7)
ds_read_b64_tr_b16 a[168:169], v253 offset:8192
ds_read_b64_tr_b16 a[170:171], v253 offset:8704
v_mfma_f32_16x16x32_bf16 v[176:179], a[92:95], v[84:87], 0
s_waitcnt lgkmcnt(7)
ds_read_b64_tr_b16 a[172:173], v253 offset:12288
v_cvt_pk_bf16_f32 v92, v164, v165
v_mfma_f32_16x16x32_bf16 v[176:179], a[88:91], v[80:83], v[176:179]
s_waitcnt lgkmcnt(7)
ds_read_b64_tr_b16 a[174:175], v253 offset:12800
v_cvt_pk_bf16_f32 v93, v166, v167
v_mfma_f32_16x16x32_bf16 v[176:179], a[84:87], v[76:79], v[176:179]
s_waitcnt lgkmcnt(7)
ds_read_b64_tr_b16 a[176:177], v253 offset:8
ds_read_b64_tr_b16 a[178:179], v253 offset:520
v_mfma_f32_16x16x32_bf16 v[176:179], a[80:83], v[72:75], v[176:179]
s_waitcnt lgkmcnt(8)
ds_read_b64_tr_b16 a[180:181], v253 offset:4104
ds_read_b64_tr_b16 a[182:183], v253 offset:4616
v_mfma_f32_16x16x32_bf16 v[180:183], a[96:99], v[72:75], 0
s_waitcnt lgkmcnt(8)
buffer_load_dwordx4 v[144:147], v53, s[36:39], s57 offen offset:2048
v_cvt_pk_bf16_f32 v94, v168, v169
v_mfma_f32_16x16x32_bf16 v[180:183], a[100:103], v[76:79], v[180:183]
s_waitcnt lgkmcnt(6)
ds_read_b64_tr_b16 a[184:185], v253 offset:8200
v_cvt_pk_bf16_f32 v95, v170, v171
v_mfma_f32_16x16x32_bf16 v[180:183], a[104:107], v[80:83], v[180:183]
s_waitcnt lgkmcnt(6)
ds_read_b64_tr_b16 a[186:187], v253 offset:8712
ds_read_b64_tr_b16 a[188:189], v253 offset:12296
v_mfma_f32_16x16x32_bf16 v[180:183], a[108:111], v[84:87], v[180:183]
s_waitcnt lgkmcnt(7)
ds_read_b64_tr_b16 a[190:191], v253 offset:12808
v_cvt_pk_bf16_f32 v96, v172, v173
v_mfma_f32_16x16x32_bf16 v[152:155], a[124:127], v[84:87], 0
s_waitcnt lgkmcnt(6)
v_cvt_pk_bf16_f32 v97, v174, v175
v_cvt_pk_bf16_f32 v98, v176, v177
v_mfma_f32_16x16x32_bf16 v[152:155], a[120:123], v[80:83], v[152:155]
s_waitcnt lgkmcnt(4)
v_cvt_pk_bf16_f32 v99, v178, v179
v_cvt_pk_bf16_f32 v100, v180, v181
v_mfma_f32_16x16x32_bf16 v[152:155], a[116:119], v[76:79], v[152:155]
v_cvt_pk_bf16_f32 v101, v182, v183
v_mov_b32 v253, 0
v_mfma_f32_16x16x32_bf16 v[152:155], a[112:115], v[72:75], v[152:155]
s_waitcnt lgkmcnt(3)
v_mov_b32 v252, 1.0
s_nop 0
v_mfma_f32_16x16x32_bf16 v[156:159], a[0:3], v[56:59], 0
s_waitcnt lgkmcnt(1)
s_nop 1
v_mfma_f32_16x16x32_bf16 v[156:159], a[4:7], v[60:63], v[156:159]
s_waitcnt lgkmcnt(0)
buffer_load_dwordx4 v[148:151], v53, s[36:39], s57 offen offset:3072
v_cvt_pk_bf16_f32 v102, v152, v153
v_mfma_f32_16x16x32_bf16 v[156:159], a[8:11], v[64:67], v[156:159]
v_cvt_pk_bf16_f32 v103, v154, v155
v_mfma_f32_16x16x32_bf16 v[156:159], a[12:15], v[68:71], v[156:159]
s_nop 2
v_mfma_f32_16x16x32_bf16 v[160:163], a[28:31], v[68:71], 0
s_nop 2
v_mfma_f32_16x16x32_bf16 v[160:163], a[24:27], v[64:67], v[160:163]
v_cvt_pk_bf16_f32 v104, v156, v157
v_cvt_pk_bf16_f32 v105, v158, v159
v_mfma_f32_16x16x32_bf16 v[160:163], a[20:23], v[60:63], v[160:163]
v_mfma_f32_16x16x32_bf16 v[160:163], a[16:19], v[56:59], v[160:163]
s_nop 2
v_mfma_f32_16x16x32_bf16 v[164:167], a[32:35], v[56:59], 0
s_nop 2
v_mfma_f32_16x16x32_bf16 v[164:167], a[36:39], v[60:63], v[164:167]
v_cvt_pk_bf16_f32 v106, v160, v161
v_cvt_pk_bf16_f32 v107, v162, v163
v_mfma_f32_16x16x32_bf16 v[164:167], a[40:43], v[64:67], v[164:167]
buffer_load_dwordx4 v237, s[16:19], s48 offen nt lds
s_add_u32 m0, s49, 10560
v_mfma_f32_16x16x32_bf16 v[164:167], a[44:47], v[68:71], v[164:167]
s_add_u32 s48, s55, 10240
s_nop 1
v_mfma_f32_16x16x32_bf16 v[168:171], a[60:63], v[68:71], 0
s_nop 2
v_mfma_f32_16x16x32_bf16 v[168:171], a[56:59], v[64:67], v[168:171]
v_cvt_pk_bf16_f32 v108, v164, v165
v_cvt_pk_bf16_f32 v109, v166, v167
v_mfma_f32_16x16x32_bf16 v[168:171], a[52:55], v[60:63], v[168:171]
v_mfma_f32_16x16x32_bf16 v[168:171], a[48:51], v[56:59], v[168:171]
s_nop 2
v_mfma_f32_16x16x32_bf16 v[172:175], a[0:3], v[72:75], 0
s_waitcnt vmcnt(8)
ds_write_b64 v54, v[120:121] offset:0
v_mfma_f32_16x16x32_bf16 v[172:175], a[4:7], v[76:79], v[172:175]
ds_write_b64 v254, v[122:123] offset:0
v_mfma_f32_16x16x32_bf16 v[172:175], a[8:11], v[80:83], v[172:175]
buffer_load_dwordx4 v237, s[16:19], s48 offen nt lds
v_mfma_f32_16x16x32_bf16 v[172:175], a[12:15], v[84:87], v[172:175]
s_add_u32 m0, s49, 12672
s_add_u32 s48, s55, 12288
v_cvt_pk_bf16_f32 v110, v168, v169
v_mfma_f32_16x16x32_bf16 v[176:179], a[28:31], v[84:87], 0
s_waitcnt vmcnt(8)
ds_write_b64 v54, v[124:125] offset:512
v_mfma_f32_16x16x32_bf16 v[176:179], a[24:27], v[80:83], v[176:179]
ds_write_b64 v254, v[126:127] offset:512
v_mfma_f32_16x16x32_bf16 v[176:179], a[20:23], v[76:79], v[176:179]
s_waitcnt vmcnt(7)
ds_write_b64 v255, v[128:129] offset:1024
v_mfma_f32_16x16x32_bf16 v[176:179], a[16:19], v[72:75], v[176:179]
ds_write_b64 v55, v[130:131] offset:1024
v_mfma_f32_16x16x32_bf16 v[180:183], a[32:35], v[72:75], 0
s_waitcnt vmcnt(6)
ds_write_b64 v255, v[132:133] offset:1536
v_mfma_f32_16x16x32_bf16 v[180:183], a[36:39], v[76:79], v[180:183]
ds_write_b64 v55, v[134:135] offset:1536
v_mfma_f32_16x16x32_bf16 v[180:183], a[40:43], v[80:83], v[180:183]
buffer_load_dwordx4 v237, s[16:19], s48 offen nt lds
s_add_u32 m0, s49, 14784
v_mfma_f32_16x16x32_bf16 v[180:183], a[44:47], v[84:87], v[180:183]
s_add_u32 s48, s55, 14336
v_cvt_pk_bf16_f32 v111, v170, v171
v_cvt_pk_bf16_f32 v112, v172, v173
v_mfma_f32_16x16x32_bf16 v[152:155], a[60:63], v[84:87], 0
s_waitcnt vmcnt(6)
ds_write_b64 v54, v[136:137] offset:2048
v_mfma_f32_16x16x32_bf16 v[152:155], a[56:59], v[80:83], v[152:155]
ds_write_b64 v254, v[138:139] offset:2048
v_mfma_f32_16x16x32_bf16 v[152:155], a[52:55], v[76:79], v[152:155]
s_waitcnt vmcnt(5)
ds_write_b64 v54, v[140:141] offset:2560
v_mfma_f32_16x16x32_bf16 v[152:155], a[48:51], v[72:75], v[152:155]
ds_write_b64 v254, v[142:143] offset:2560
v_mfma_f32_16x16x32_bf16 v[156:159], v[56:59], a[128:131], 0
s_waitcnt vmcnt(4)
ds_write_b64 v255, v[144:145] offset:3072
v_mfma_f32_16x16x32_bf16 v[156:159], v[60:63], a[132:135], v[156:159]
ds_write_b64 v55, v[146:147] offset:3072
v_mfma_f32_16x16x32_bf16 v[156:159], v[64:67], a[136:139], v[156:159]
buffer_load_dwordx4 v237, s[16:19], s48 offen nt lds
s_add_u32 m0, s49, 16896
v_mfma_f32_16x16x32_bf16 v[156:159], v[68:71], a[140:143], v[156:159]
s_add_u32 s48, s55, 16384
buffer_load_dwordx4 v237, s[16:19], s48 offen nt lds
s_add_u32 m0, s49, 19008
v_mfma_f32_16x16x32_bf16 v[160:163], v[68:71], a[156:159], 0
s_add_u32 s48, s55, 18432
buffer_load_dwordx4 v237, s[16:19], s48 offen nt lds
s_add_u32 m0, s49, 21120
v_mfma_f32_16x16x32_bf16 v[160:163], v[64:67], a[152:155], v[160:163]
s_add_u32 s48, s55, 20480
buffer_load_dwordx4 v237, s[16:19], s48 offen nt lds
s_add_u32 m0, s49, 23232
v_mfma_f32_16x16x32_bf16 v[160:163], v[60:63], a[148:151], v[160:163]
s_add_u32 s48, s55, 22528
buffer_load_dwordx4 v237, s[16:19], s48 offen nt lds
v_cvt_pk_bf16_f32 v113, v174, v175
v_mfma_f32_16x16x32_bf16 v[160:163], v[56:59], a[144:147], v[160:163]
s_add_u32 s49, s49, 50688
v_cvt_pk_bf16_f32 v114, v176, v177
v_cvt_pk_bf16_f32 v115, v178, v179
v_mfma_f32_16x16x32_bf16 v[164:167], v[56:59], a[160:163], 0
s_waitcnt vmcnt(8)
ds_write_b64 v255, v[148:149] offset:3584
v_mfma_f32_16x16x32_bf16 v[164:167], v[60:63], a[164:167], v[164:167]
ds_write_b64 v55, v[150:151] offset:3584
v_mfma_f32_16x16x32_bf16 v[164:167], v[64:67], a[168:171], v[164:167]
v_cvt_pk_bf16_f32 v116, v180, v181
v_cvt_pk_bf16_f32 v117, v182, v183
v_mfma_f32_16x16x32_bf16 v[164:167], v[68:71], a[172:175], v[164:167]
v_cvt_pk_bf16_f32 v118, v152, v153
v_cvt_pk_bf16_f32 v119, v154, v155
v_mfma_f32_16x16x32_bf16 v[168:171], v[68:71], a[188:191], 0
v_cvt_pk_bf16_f32 v156, v156, v157
v_cvt_pk_bf16_f32 v157, v158, v159
v_mfma_f32_16x16x32_bf16 v[168:171], v[64:67], a[184:187], v[168:171]
v_cvt_pk_bf16_f32 v160, v160, v161
v_cvt_pk_bf16_f32 v161, v162, v163
v_mfma_f32_16x16x32_bf16 v[168:171], v[60:63], a[180:183], v[168:171]
s_waitcnt lgkmcnt(0)
s_barrier
v_mfma_f32_16x16x32_bf16 v[168:171], v[56:59], a[176:179], v[168:171]
ds_read_b64_tr_b16 a[192:193], v248 offset:0
ds_read_b64_tr_b16 a[194:195], v248 offset:512
v_mfma_f32_16x16x32_bf16 v[172:175], v[72:75], a[128:131], 0
ds_read_b64_tr_b16 a[196:197], v248 offset:4096
ds_read_b64_tr_b16 a[198:199], v248 offset:4608
v_mfma_f32_16x16x32_bf16 v[172:175], v[76:79], a[132:135], v[172:175]
ds_read_b64_tr_b16 a[200:201], v248 offset:8192
ds_read_b64_tr_b16 a[202:203], v248 offset:8704
v_mfma_f32_16x16x32_bf16 v[172:175], v[80:83], a[136:139], v[172:175]
ds_read_b64_tr_b16 a[204:205], v248 offset:12288
ds_read_b64_tr_b16 a[206:207], v248 offset:12800
v_mfma_f32_16x16x32_bf16 v[172:175], v[84:87], a[140:143], v[172:175]
ds_read_b64_tr_b16 a[208:209], v249 offset:0
ds_read_b64_tr_b16 a[210:211], v249 offset:512
v_mfma_f32_16x16x32_bf16 v[176:179], v[84:87], a[156:159], 0
ds_read_b64_tr_b16 a[212:213], v249 offset:4096
ds_read_b64_tr_b16 a[214:215], v249 offset:4608
v_mfma_f32_16x16x32_bf16 v[176:179], v[80:83], a[152:155], v[176:179]
s_waitcnt lgkmcnt(10)
ds_read_b64_tr_b16 a[216:217], v249 offset:8192
ds_read_b64_tr_b16 a[218:219], v249 offset:8704
v_mfma_f32_16x16x32_bf16 v[176:179], v[76:79], a[148:151], v[176:179]
s_waitcnt lgkmcnt(10)
ds_read_b64_tr_b16 a[220:221], v249 offset:12288
ds_read_b64_tr_b16 a[222:223], v249 offset:12800
v_mfma_f32_16x16x32_bf16 v[176:179], v[72:75], a[144:147], v[176:179]
s_waitcnt lgkmcnt(10)
ds_read_b64_tr_b16 a[224:225], v250 offset:0
ds_read_b64_tr_b16 a[226:227], v250 offset:512
v_mfma_f32_16x16x32_bf16 v[180:183], v[72:75], a[160:163], 0
s_waitcnt lgkmcnt(10)
ds_read_b64_tr_b16 a[228:229], v250 offset:4096
ds_read_b64_tr_b16 a[230:231], v250 offset:4608
v_mfma_f32_16x16x32_bf16 v[180:183], v[76:79], a[164:167], v[180:183]
s_waitcnt lgkmcnt(10)
ds_read_b64_tr_b16 a[232:233], v250 offset:8192
ds_read_b64_tr_b16 a[234:235], v250 offset:8704
v_mfma_f32_16x16x32_bf16 v[180:183], v[80:83], a[168:171], v[180:183]
s_waitcnt lgkmcnt(10)
ds_read_b64_tr_b16 a[236:237], v250 offset:12288
ds_read_b64_tr_b16 a[238:239], v250 offset:12800
v_mfma_f32_16x16x32_bf16 v[180:183], v[84:87], a[172:175], v[180:183]
s_waitcnt lgkmcnt(10)
ds_read_b64_tr_b16 a[240:241], v251 offset:0
ds_read_b64_tr_b16 a[242:243], v251 offset:512
v_mfma_f32_16x16x32_bf16 v[152:155], v[84:87], a[188:191], 0
s_waitcnt lgkmcnt(10)
ds_read_b64_tr_b16 a[244:245], v251 offset:4096
ds_read_b64_tr_b16 a[246:247], v251 offset:4608
v_mfma_f32_16x16x32_bf16 v[152:155], v[80:83], a[184:187], v[152:155]
s_waitcnt lgkmcnt(10)
ds_read_b64_tr_b16 a[248:249], v251 offset:8192
ds_read_b64_tr_b16 a[250:251], v251 offset:8704
v_mfma_f32_16x16x32_bf16 v[152:155], v[76:79], a[180:183], v[152:155]
s_waitcnt lgkmcnt(10)
ds_read_b64_tr_b16 a[252:253], v251 offset:12288
ds_read_b64_tr_b16 a[254:255], v251 offset:12800
v_mfma_f32_16x16x32_bf16 v[152:155], v[72:75], a[176:179], v[152:155]
s_waitcnt lgkmcnt(10)
ds_write_b128 v50, v[88:91] offset:0
ds_write_b128 v50, v[104:107] offset:4096
ds_write_b64 v51, v[156:157] offset:0
ds_write_b128 v50, v[92:95] offset:64
ds_write_b128 v50, v[108:111] offset:4160
ds_write_b64 v51, v[160:161] offset:128
v_cvt_pk_bf16_f32 v164, v164, v165
v_cvt_pk_bf16_f32 v165, v166, v167
v_cvt_pk_bf16_f32 v168, v168, v169
v_cvt_pk_bf16_f32 v169, v170, v171
v_cvt_pk_bf16_f32 v172, v172, v173
v_cvt_pk_bf16_f32 v173, v174, v175
v_cvt_pk_bf16_f32 v176, v176, v177
v_cvt_pk_bf16_f32 v177, v178, v179
v_cvt_pk_bf16_f32 v180, v180, v181
v_cvt_pk_bf16_f32 v181, v182, v183
v_cvt_pk_bf16_f32 v152, v152, v153
v_cvt_pk_bf16_f32 v153, v154, v155
v_mov_b32 v105, 0
v_mov_b32 v107, 0
v_mov_b32 v109, 0
v_mov_b32 v111, 0
v_mov_b32 v133, 0
v_mov_b32 v134, 0
v_mov_b32 v135, 0
v_mov_b32 v149, 0
v_mov_b32 v150, 0
v_mov_b32 v151, 0
v_mov_b32 v248, 1.0
v_mov_b32 v249, 1.0
v_mov_b32 v251, 1.0
ds_write_b64 v51, v[164:165] offset:256
ds_write_b64 v51, v[168:169] offset:384
ds_write_b128 v50, v[96:99] offset:2048
ds_write_b128 v50, v[112:115] offset:6144
ds_write_b64 v51, v[172:173] offset:2048
ds_write_b64 v51, v[176:177] offset:2176
s_waitcnt vmcnt(4)
s_barrier
ds_read_b128 v[200:203], v236 offset:8704
ds_read_b128 v[212:215], v236 offset:8448
ds_read_b128 v[224:227], v236 offset:8960
ds_read_b128 v[228:231], v236 offset:9216
ds_read_b128 v[192:195], v236 offset:13440
ds_read_b128 v[204:207], v236 offset:12928
ds_read_b128 v[208:211], v236 offset:12672
ds_write_b128 v50, v[100:103] offset:2112
ds_write_b128 v50, v[116:119] offset:6208
s_waitcnt lgkmcnt(8)
v_mfma_f32_16x16x32_bf16 v[184:187], a[68:71], v[200:203], 0
s_waitcnt lgkmcnt(6)
ds_write_b64 v51, v[180:181] offset:2304
v_mfma_f32_16x16x32_bf16 v[184:187], a[64:67], v[212:215], v[184:187]
s_waitcnt lgkmcnt(2)
ds_write_b64 v51, v[152:153] offset:2432
v_mfma_f32_16x16x32_bf16 v[184:187], a[72:75], v[224:227], v[184:187]
v_mfma_f32_16x16x32_bf16 v[184:187], a[76:79], v[228:231], v[184:187]
s_nop 2
v_mfma_f32_16x16x32_bf16 v[188:191], a[92:95], v[228:231], 0
s_nop 2
v_mfma_f32_16x16x32_bf16 v[188:191], a[88:91], v[224:227], v[188:191]
v_cvt_pk_bf16_f32 v16, v184, v185
v_cvt_pk_bf16_f32 v17, v186, v187
v_mfma_f32_16x16x32_bf16 v[188:191], a[84:87], v[200:203], v[188:191]
ds_read_b128 v[184:187], v236 offset:13184
v_mfma_f32_16x16x32_bf16 v[188:191], a[80:83], v[212:215], v[188:191]
s_nop 2
v_mfma_f32_16x16x32_bf16 v[196:199], a[96:99], v[212:215], 0
s_nop 2
v_mfma_f32_16x16x32_bf16 v[196:199], a[100:103], v[200:203], v[196:199]
v_cvt_pk_bf16_f32 v18, v188, v189
v_cvt_pk_bf16_f32 v19, v190, v191
v_mfma_f32_16x16x32_bf16 v[196:199], a[104:107], v[224:227], v[196:199]
v_mfma_f32_16x16x32_bf16 v[196:199], a[108:111], v[228:231], v[196:199]
s_nop 2
v_mfma_f32_16x16x32_bf16 v[188:191], a[124:127], v[228:231], 0
s_waitcnt lgkmcnt(0)
s_nop 1
v_mfma_f32_16x16x32_bf16 v[188:191], a[116:119], v[200:203], v[188:191]
v_cvt_pk_bf16_f32 v21, v198, v199
v_cvt_pk_bf16_f32 v20, v196, v197
v_mfma_f32_16x16x32_bf16 v[188:191], a[112:115], v[212:215], v[188:191]
v_mfma_f32_16x16x32_bf16 v[188:191], a[120:123], v[224:227], v[188:191]
s_nop 2
v_mfma_f32_16x16x32_bf16 v[196:199], a[120:123], v[184:187], 0
s_nop 2
v_mfma_f32_16x16x32_bf16 v[196:199], a[124:127], v[192:195], v[196:199]
v_cvt_pk_bf16_f32 v23, v190, v191
v_cvt_pk_bf16_f32 v22, v188, v189
v_mfma_f32_16x16x32_bf16 v[196:199], a[116:119], v[204:207], v[196:199]
v_mfma_f32_16x16x32_bf16 v[196:199], a[112:115], v[208:211], v[196:199]
s_nop 2
v_mfma_f32_16x16x32_bf16 v[188:191], a[96:99], v[208:211], 0
s_nop 2
v_mfma_f32_16x16x32_bf16 v[188:191], a[100:103], v[204:207], v[188:191]
v_cvt_pk_bf16_f32 v30, v196, v197
v_cvt_pk_bf16_f32 v31, v198, v199
v_mfma_f32_16x16x32_bf16 v[188:191], a[104:107], v[184:187], v[188:191]
v_mfma_f32_16x16x32_bf16 v[188:191], a[108:111], v[192:195], v[188:191]
s_nop 2
v_mfma_f32_16x16x32_bf16 v[212:215], a[92:95], v[192:195], 0
s_nop 2
v_mfma_f32_16x16x32_bf16 v[212:215], a[88:91], v[184:187], v[212:215]
v_cvt_pk_bf16_f32 v29, v190, v191
v_cvt_pk_bf16_f32 v28, v188, v189
v_mfma_f32_16x16x32_bf16 v[212:215], a[84:87], v[204:207], v[212:215]
v_mfma_f32_16x16x32_bf16 v[212:215], a[80:83], v[208:211], v[212:215]
s_nop 2
v_mfma_f32_16x16x32_bf16 v[188:191], a[64:67], v[208:211], 0
s_nop 2
v_mfma_f32_16x16x32_bf16 v[188:191], a[72:75], v[184:187], v[188:191]
v_cvt_pk_bf16_f32 v27, v214, v215
v_cvt_pk_bf16_f32 v26, v212, v213
v_mfma_f32_16x16x32_bf16 v[188:191], a[76:79], v[192:195], v[188:191]
s_waitcnt vmcnt(0)
s_barrier
v_mfma_f32_16x16x32_bf16 v[188:191], a[68:71], v[204:207], v[188:191]
s_mov_b32 s48, s50
ds_read_b128 v[196:199], v236 offset:17152
ds_read_b128 v[200:203], v236 offset:16896
ds_read_b128 v[216:219], v236 offset:17408
ds_read_b128 v[220:223], v236 offset:17664
ds_read_u16 v108, v241 offset:256
ds_read_b128 v[204:207], v236 offset:21376
ds_read_b128 v[208:211], v236 offset:21120
ds_read_b128 v[52:55], v240 offset:64
v_cvt_pk_bf16_f32 v24, v188, v189
v_cvt_pk_bf16_f32 v25, v190, v191
s_add_u32 m0, s49, 0
s_add_u32 s50, s50, 13107200
buffer_load_dwordx4 v237, s[16:19], s48 offen nt lds
ds_read_b128 v[192:195], v236 offset:21888
ds_read_b128 v[48:51], v240 offset:0
ds_read_u16 v110, v241 offset:384
v_add_u32 v240, 0x200, v240
s_add_u32 s48, s48, s51
s_add_u32 m0, s49, 2112
ds_read_u16 v106, v241 offset:128
buffer_load_dwordx4 v237, s[16:19], s48 offen nt lds
s_waitcnt lgkmcnt(11)
v_mfma_f32_16x16x32_bf16 v[184:187], a[68:71], v[196:199], 0
s_waitcnt lgkmcnt(9)
ds_read_u16 v104, v241 offset:0
s_add_u32 m0, s49, 4224
v_mfma_f32_16x16x32_bf16 v[184:187], a[64:67], v[200:203], v[184:187]
s_waitcnt lgkmcnt(6)
s_add_u32 s48, s48, s51
buffer_load_dwordx4 v237, s[16:19], s48 offen nt lds
v_mfma_f32_16x16x32_bf16 v[184:187], a[72:75], v[216:219], v[184:187]
s_add_u32 m0, s49, 6336
s_add_u32 s48, s48, s51
buffer_load_dwordx4 v237, s[16:19], s48 offen nt lds
v_mfma_f32_16x16x32_bf16 v[184:187], a[76:79], v[220:223], v[184:187]
s_add_u32 m0, s49, 8448
s_add_u32 s48, s48, s51
buffer_load_dwordx4 v237, s[16:19], s48 offen nt lds
v_mfma_f32_16x16x32_bf16 v[188:191], a[92:95], v[220:223], 0
s_add_u32 m0, s49, 10560
s_mov_b32 s47, s46
s_add_u32 s48, s48, s51
v_mfma_f32_16x16x32_bf16 v[188:191], a[88:91], v[216:219], v[188:191]
s_bfe_i32 s57, s3, 0x10000
buffer_load_dwordx4 v237, s[16:19], s48 offen nt lds
v_cvt_pk_bf16_f32 v32, v184, v185
v_mfma_f32_16x16x32_bf16 v[188:191], a[84:87], v[196:199], v[188:191]
s_and_b32 s54, s57, s5
v_cvt_pk_bf16_f32 v33, v186, v187
s_sub_u32 s45, s45, 1
v_mfma_f32_16x16x32_bf16 v[188:191], a[80:83], v[200:203], v[188:191]
s_sub_u32 s50, s50, s54
s_add_u32 s52, s46, 20480
s_lshr_b32 s3, s3, 1
v_mfma_f32_16x16x32_bf16 v[184:187], a[96:99], v[200:203], 0
s_waitcnt lgkmcnt(0)
s_nop 1
v_mfma_f32_16x16x32_bf16 v[184:187], a[100:103], v[196:199], v[184:187]
v_cvt_pk_bf16_f32 v35, v190, v191
v_cvt_pk_bf16_f32 v34, v188, v189
v_mfma_f32_16x16x32_bf16 v[184:187], a[104:107], v[216:219], v[184:187]
v_mfma_f32_16x16x32_bf16 v[184:187], a[108:111], v[220:223], v[184:187]
s_nop 2
v_mfma_f32_16x16x32_bf16 v[188:191], a[124:127], v[220:223], 0
s_nop 2
v_mfma_f32_16x16x32_bf16 v[188:191], a[120:123], v[216:219], v[188:191]
v_cvt_pk_bf16_f32 v37, v186, v187
v_cvt_pk_bf16_f32 v36, v184, v185
v_mfma_f32_16x16x32_bf16 v[188:191], a[116:119], v[196:199], v[188:191]
ds_read_b128 v[196:199], v236 offset:21632
v_mfma_f32_16x16x32_bf16 v[188:191], a[112:115], v[200:203], v[188:191]
s_nop 7
v_cvt_pk_bf16_f32 v39, v190, v191
v_cvt_pk_bf16_f32 v38, v188, v189
s_nop 7
s_waitcnt lgkmcnt(0)
s_branch L_entrys
.p2align 6
L_loops:
s_waitcnt vmcnt(8)
s_barrier
v_mfma_f32_16x16x32_bf16 v[176:179], a[224:227], v[220:223], 0
s_add_u32 s52, s47, 8192
v_exp_f32 v187, v187
v_mfma_f32_16x16x32_bf16 v[176:179], a[228:231], v[224:227], v[176:179]
s_add_u32 s53, s47, 12288
v_add_f32 v248, v184, v185
v_add_f32 v248, v248, v186
v_mfma_f32_16x16x32_bf16 v[176:179], a[232:235], v[212:215], v[176:179]
s_mov_b32 s47, s46
v_add_f32 v248, v248, v187
v_cvt_pk_bf16_f32 v120, v184, v185
v_mfma_f32_16x16x32_bf16 v[176:179], a[236:239], v[216:219], v[176:179]
s_bfe_i32 s57, s3, 0x10000
v_cvt_pk_bf16_f32 v121, v186, v187
v_sub_f32 v193, v193, v254
v_mfma_f32_16x16x32_bf16 v[180:183], a[252:255], v[216:219], 0
s_and_b32 s54, s57, s5
v_exp_f32 v188, v188
v_mfma_f32_16x16x32_bf16 v[180:183], a[248:251], v[212:215], v[180:183]
s_sub_u32 s45, s45, 1
v_exp_f32 v190, v190
v_mfma_f32_16x16x32_bf16 v[180:183], a[244:247], v[224:227], v[180:183]
s_lshr_b32 s3, s3, 1
v_sub_f32 v194, v194, v254
v_add_f32 v248, v248, v188
v_mfma_f32_16x16x32_bf16 v[180:183], a[240:243], v[220:223], v[180:183]
v_exp_f32 v189, v189
v_mfma_f32_16x16x32_bf16 v[212:215], v[0:3], v[112:115], 0
v_add_f32 v248, v248, v189
v_sub_f32 v191, v191, v254
v_mfma_f32_16x16x32_bf16 v[212:215], v[4:7], v[116:119], v[212:215]
v_exp_f32 v191, v191
v_mfma_f32_16x16x32_bf16 v[216:219], v[12:15], v[116:119], 0
v_sub_f32 v195, v195, v254
v_sub_f32 v192, v192, v254
v_mfma_f32_16x16x32_bf16 v[216:219], v[8:11], v[112:115], v[216:219]
v_exp_f32 v192, v192
v_mfma_f32_16x16x32_bf16 v[220:223], v[16:19], v[112:115], 0
v_exp_f32 v194, v194
v_mfma_f32_16x16x32_bf16 v[220:223], v[20:23], v[116:119], v[220:223]
v_exp_f32 v193, v193
v_mfma_f32_16x16x32_bf16 v[224:227], v[28:31], v[116:119], 0
v_add_f32 v248, v248, v190
v_add_f32 v248, v248, v191
v_mfma_f32_16x16x32_bf16 v[224:227], v[24:27], v[112:115], v[224:227]
v_exp_f32 v195, v195
v_mfma_f32_16x16x32_bf16 v[228:231], v[32:35], v[112:115], 0
v_add_f32 v248, v248, v192
v_add_f32 v248, v248, v193
v_mfma_f32_16x16x32_bf16 v[228:231], v[36:39], v[116:119], v[228:231]
v_add_f32 v248, v248, v194
v_add_f32 v248, v248, v195
v_mfma_f32_16x16x32_bf16 v[232:235], v[44:47], v[116:119], 0
v_cvt_pk_bf16_f32 v123, v190, v191
v_cvt_pk_bf16_f32 v122, v188, v189
v_mfma_f32_16x16x32_bf16 v[232:235], v[40:43], v[112:115], v[232:235]
s_mov_b32 s48, s50
ds_read_b128 v[188:191], v236 offset:0
v_cvt_pk_bf16_f32 v125, v194, v195
v_mfma_f32_16x16x32_bf16 v[184:187], v[48:51], v[112:115], 0
s_add_u32 m0, s49, 0
ds_read_b128 v[48:51], v240 offset:0
v_cvt_pk_bf16_f32 v124, v192, v193
v_mfma_f32_16x16x32_bf16 v[184:187], v[52:55], v[116:119], v[184:187]
s_add_u32 s50, s50, 13107200
buffer_load_dwordx4 v237, s[16:19], s48 offen nt lds
v_sub_f32 v196, v196, v254
v_sub_f32 v197, v197, v254
v_sub_f32 v199, v199, v254
v_sub_f32 v198, v198, v254
v_exp_f32 v196, v196
v_exp_f32 v197, v197
v_add_f32 v248, v248, v196
v_add_f32 v248, v248, v197
v_exp_f32 v198, v198
s_waitcnt lgkmcnt(1)
v_mfma_f32_16x16x32_bf16 v[192:195], a[64:67], v[188:191], 0
s_sub_u32 s50, s50, s54
ds_read_b128 v[52:55], v240 offset:64
v_exp_f32 v199, v199
v_add_f32 v248, v248, v198
v_add_f32 v248, v248, v199
v_cvt_pk_bf16_f32 v126, v196, v197
v_cvt_pk_bf16_f32 v127, v198, v199
ds_read_b128 v[196:199], v236 offset:256
v_sub_f32 v200, v200, v254
v_sub_f32 v203, v203, v254
v_sub_f32 v201, v201, v254
v_exp_f32 v201, v201
v_sub_f32 v202, v202, v254
v_exp_f32 v202, v202
v_exp_f32 v200, v200
v_exp_f32 v203, v203
v_add_f32 v248, v248, v200
v_add_f32 v248, v248, v201
v_add_f32 v248, v248, v202
v_add_f32 v248, v248, v203
v_cvt_pk_bf16_f32 v128, v200, v201
v_cvt_pk_bf16_f32 v129, v202, v203
v_sub_f32 v204, v204, v254
v_sub_f32 v205, v205, v254
s_waitcnt lgkmcnt(0)
v_mfma_f32_16x16x32_bf16 v[192:195], a[68:71], v[196:199], v[192:195]
ds_read_b128 v[200:203], v236 offset:512
v_exp_f32 v204, v204
v_sub_f32 v206, v206, v254
v_add_f32 v248, v248, v204
v_exp_f32 v206, v206
v_sub_f32 v207, v207, v254
v_exp_f32 v205, v205
v_exp_f32 v207, v207
v_add_f32 v248, v248, v205
v_cvt_pk_bf16_f32 v130, v204, v205
v_add_f32 v248, v248, v206
v_add_f32 v248, v248, v207
v_cvt_pk_bf16_f32 v131, v206, v207
v_sub_f32 v208, v208, v254
v_exp_f32 v208, v208
v_max3_f32 v254, v212, v213, v214
s_waitcnt lgkmcnt(0)
v_mfma_f32_16x16x32_bf16 v[192:195], a[72:75], v[200:203], v[192:195]
ds_read_b128 v[204:207], v236 offset:768
v_add_f32 v248, v248, v208
v_cvt_pk_bf16_f32 v132, v208, 0
v_max3_f32 v254, v254, v215, v216
v_max3_f32 v254, v254, v217, v218
v_max3_f32 v254, v254, v219, v220
v_max3_f32 v254, v254, v221, v222
v_max3_f32 v254, v254, v223, v224
v_max3_f32 v254, v254, v225, v226
v_max3_f32 v254, v254, v227, v228
v_max3_f32 v254, v254, v229, v230
v_max3_f32 v254, v254, v231, v232
v_max3_f32 v254, v254, v233, v234
v_max3_f32 v254, v254, v235, v184
v_add_u32 v240, 0x200, v240
ds_swizzle_b32 v250, v248 offset:0x401F
ds_swizzle_b32 v255, v254 offset:0x401F
s_waitcnt lgkmcnt(2)
v_mfma_f32_16x16x32_bf16 v[192:195], a[76:79], v[204:207], v[192:195]
s_nop 2
v_mfma_f32_16x16x32_bf16 v[208:211], a[92:95], v[204:207], 0
s_nop 2
v_mfma_f32_16x16x32_bf16 v[208:211], a[88:91], v[200:203], v[208:211]
v_cvt_pk_bf16_f32 v0, v192, v193
v_cvt_pk_bf16_f32 v1, v194, v195
v_mfma_f32_16x16x32_bf16 v[208:211], a[84:87], v[196:199], v[208:211]
v_mfma_f32_16x16x32_bf16 v[208:211], a[80:83], v[188:191], v[208:211]
s_waitcnt lgkmcnt(0)
v_add_f32 v248, v248, v250
v_max_f32 v254, v254, v255
v_mfma_f32_16x16x32_bf16 v[192:195], a[96:99], v[188:191], 0
ds_bpermute_b32 v250, v247, v248
v_mfma_f32_16x16x32_bf16 v[192:195], a[100:103], v[196:199], v[192:195]
ds_bpermute_b32 v255, v247, v254
v_mfma_f32_16x16x32_bf16 v[192:195], a[104:107], v[200:203], v[192:195]
v_cvt_pk_bf16_f32 v2, v208, v209
v_cvt_pk_bf16_f32 v3, v210, v211
v_mfma_f32_16x16x32_bf16 v[192:195], a[108:111], v[204:207], v[192:195]
s_nop 2
v_mfma_f32_16x16x32_bf16 v[208:211], a[124:127], v[204:207], 0
s_nop 2
v_mfma_f32_16x16x32_bf16 v[208:211], a[120:123], v[200:203], v[208:211]
v_cvt_pk_bf16_f32 v5, v194, v195
v_cvt_pk_bf16_f32 v4, v192, v193
v_mfma_f32_16x16x32_bf16 v[208:211], a[116:119], v[196:199], v[208:211]
s_waitcnt lgkmcnt(1)
v_add_f32 v248, v248, v250
v_mfma_f32_16x16x32_bf16 v[208:211], a[112:115], v[188:191], v[208:211]
s_waitcnt lgkmcnt(0)
v_rcp_f32 v251, v248
v_mfma_f32_16x16x32_bf16 v[188:191], v[56:59], v[120:123], 0
v_max_f32 v254, v254, v255
v_sub_f32 v214, v214, v254
v_mfma_f32_16x16x32_bf16 v[188:191], v[104:107], v[132:135], v[188:191]
s_add_u32 s48, s48, s51
v_sub_f32 v215, v215, v254
v_cvt_pk_bf16_f32 v6, v208, v209
v_mfma_f32_16x16x32_bf16 v[188:191], v[72:75], v[124:127], v[188:191]
s_add_u32 m0, s49, 2112
v_cvt_pk_bf16_f32 v7, v210, v211
v_sub_f32 v212, v212, v254
v_mfma_f32_16x16x32_bf16 v[188:191], v[88:91], v[128:131], v[188:191]
buffer_load_dwordx4 v237, s[16:19], s48 offen nt lds
v_sub_f32 v213, v213, v254
v_mfma_f32_16x16x32_bf16 v[196:199], v[92:95], v[128:131], 0
v_exp_f32 v212, v212
v_mfma_f32_16x16x32_bf16 v[196:199], v[76:79], v[124:127], v[196:199]
v_exp_f32 v214, v214
v_mfma_f32_16x16x32_bf16 v[196:199], v[106:109], v[132:135], v[196:199]
v_exp_f32 v213, v213
v_mfma_f32_16x16x32_bf16 v[196:199], v[60:63], v[120:123], v[196:199]
ds_read_b128 v[204:207], v236 offset:4480
v_sub_f32 v216, v216, v254
v_mfma_f32_16x16x32_bf16 v[200:203], v[64:67], v[120:123], 0
ds_read_b128 v[192:195], v236 offset:4224
v_sub_f32 v217, v217, v254
v_mfma_f32_16x16x32_bf16 v[200:203], v[108:111], v[132:135], v[200:203]
v_exp_f32 v215, v215
v_mfma_f32_16x16x32_bf16 v[200:203], v[80:83], v[124:127], v[200:203]
v_exp_f32 v217, v217
v_mfma_f32_16x16x32_bf16 v[200:203], v[96:99], v[128:131], v[200:203]
v_sub_f32 v218, v218, v254
v_add_f32 v249, v212, v213
v_mfma_f32_16x16x32_bf16 v[208:211], v[100:103], v[128:131], 0
v_add_f32 v249, v249, v214
v_add_f32 v249, v249, v215
v_mfma_f32_16x16x32_bf16 v[208:211], v[84:87], v[124:127], v[208:211]
s_waitcnt lgkmcnt(1)
v_exp_f32 v216, v216
v_mfma_f32_16x16x32_bf16 v[208:211], v[110:113], v[132:135], v[208:211]
s_waitcnt lgkmcnt(0)
v_sub_f32 v219, v219, v254
v_sub_f32 v220, v220, v254
v_mfma_f32_16x16x32_bf16 v[208:211], v[68:71], v[120:123], v[208:211]
v_exp_f32 v218, v218
v_sub_f32 v223, v223, v254
v_add_f32 v249, v249, v216
v_add_f32 v249, v249, v217
v_exp_f32 v219, v219
v_add_f32 v249, v249, v218
v_add_f32 v249, v249, v219
v_exp_f32 v220, v220
v_sub_f32 v224, v224, v254
v_exp_f32 v223, v223
v_sub_f32 v221, v221, v254
v_exp_f32 v224, v224
v_exp_f32 v221, v221
v_sub_f32 v222, v222, v254
v_sub_f32 v225, v225, v254
v_add_f32 v249, v249, v220
v_add_f32 v249, v249, v221
v_exp_f32 v222, v222
v_exp_f32 v225, v225
v_add_f32 v249, v249, v222
v_add_f32 v249, v249, v223
v_add_f32 v249, v249, v224
v_sub_f32 v226, v226, v254
v_add_f32 v249, v249, v225
v_exp_f32 v226, v226
v_sub_f32 v227, v227, v254
v_exp_f32 v227, v227
v_sub_f32 v228, v228, v254
v_exp_f32 v228, v228
v_add_f32 v249, v249, v226
v_sub_f32 v232, v232, v254
v_sub_f32 v229, v229, v254
v_sub_f32 v230, v230, v254
v_exp_f32 v230, v230
v_exp_f32 v229, v229
v_add_f32 v249, v249, v227
v_add_f32 v249, v249, v228
v_add_f32 v249, v249, v229
v_exp_f32 v232, v232
v_sub_f32 v233, v233, v254
v_exp_f32 v233, v233
v_sub_f32 v231, v231, v254
v_exp_f32 v231, v231
v_sub_f32 v234, v234, v254
v_sub_f32 v235, v235, v254
v_add_f32 v249, v249, v230
v_add_f32 v249, v249, v231
v_add_f32 v249, v249, v232
v_exp_f32 v234, v234
v_exp_f32 v235, v235
v_sub_f32 v184, v184, v254
v_exp_f32 v184, v184
v_add_f32 v249, v249, v233
v_cvt_pk_bf16_f32 v148, v184, 0
v_add_f32 v249, v249, v234
v_add_f32 v249, v249, v235
v_add_f32 v249, v249, v184
v_fmac_f32 v161, v201, v251
v_fmac_f32 v163, v203, v251
v_fmac_f32 v160, v200, v251
v_fmac_f32 v162, v202, v251
ds_read_b128 v[184:187], v236 offset:4992
v_cvt_pk_bf16_f32 v138, v216, v217
v_cvt_pk_bf16_f32 v139, v218, v219
v_fmac_f32 v167, v211, v251
v_fmac_f32 v165, v209, v251
v_fmac_f32 v166, v210, v251
v_fmac_f32 v164, v208, v251
v_cvt_pk_bf16_f32 v140, v220, v221
v_cvt_pk_bf16_f32 v141, v222, v223
v_fmac_f32 v155, v191, v251
v_fmac_f32 v154, v190, v251
v_fmac_f32 v152, v188, v251
v_fmac_f32 v153, v189, v251
v_cvt_pk_bf16_f32 v137, v214, v215
v_cvt_pk_bf16_f32 v136, v212, v213
v_cvt_pk_bf16_f32 v143, v226, v227
v_cvt_pk_bf16_f32 v142, v224, v225
v_cvt_pk_bf16_f32 v145, v230, v231
v_cvt_pk_bf16_f32 v144, v228, v229
v_fmac_f32 v156, v196, v251
v_fmac_f32 v157, v197, v251
s_waitcnt lgkmcnt(0)
v_mfma_f32_16x16x32_bf16 v[200:203], a[124:127], v[184:187], 0
ds_read_b128 v[216:219], v236 offset:4736
v_fmac_f32 v158, v198, v251
v_fmac_f32 v159, v199, v251
v_cvt_pk_bf16_f32 v147, v234, v235
v_cvt_pk_bf16_f32 v146, v232, v233
v_cvt_pk_bf16_f32 v160, v160, v161
v_cvt_pk_bf16_f32 v161, v162, v163
v_cvt_pk_bf16_f32 v163, v166, v167
v_cvt_pk_bf16_f32 v162, v164, v165
v_cvt_pk_bf16_f32 v152, v152, v153
v_cvt_pk_bf16_f32 v153, v154, v155
v_pk_max_i16 v160, v160, 0
v_pk_max_i16 v162, v162, 0
v_pk_max_i16 v153, v153, 0
v_pk_max_i16 v161, v161, 0
v_pk_max_i16 v163, v163, 0
v_cvt_pk_bf16_f32 v155, v158, v159
v_pk_max_i16 v155, v155, 0
v_pk_max_i16 v152, v152, 0
v_cvt_pk_bf16_f32 v154, v156, v157
v_pk_max_i16 v154, v154, 0
s_waitcnt lgkmcnt(0)
v_mfma_f32_16x16x32_bf16 v[200:203], a[120:123], v[216:219], v[200:203]
ds_swizzle_b32 v250, v249 offset:0x401F
buffer_store_dwordx4 v[152:155], v239, s[20:23], s52 offen offset:0 nt
buffer_store_dwordx4 v[160:163], v239, s[20:23], s52 offen offset:64 nt
s_add_u32 s52, s46, 20480
v_mfma_f32_16x16x32_bf16 v[200:203], a[116:119], v[204:207], v[200:203]
v_mfma_f32_16x16x32_bf16 v[200:203], a[112:115], v[192:195], v[200:203]
s_nop 2
v_mfma_f32_16x16x32_bf16 v[208:211], a[96:99], v[192:195], 0
s_waitcnt lgkmcnt(0)
v_add_f32 v249, v249, v250
v_mfma_f32_16x16x32_bf16 v[208:211], a[100:103], v[204:207], v[208:211]
s_add_u32 m0, s49, 4224
ds_bpermute_b32 v250, v247, v249
v_mfma_f32_16x16x32_bf16 v[208:211], a[104:107], v[216:219], v[208:211]
s_add_u32 s48, s48, s51
buffer_load_dwordx4 v237, s[16:19], s48 offen nt lds
v_cvt_pk_bf16_f32 v14, v200, v201
v_mfma_f32_16x16x32_bf16 v[208:211], a[108:111], v[184:187], v[208:211]
ds_read_b128 v[212:215], v236 offset:8448
v_cvt_pk_bf16_f32 v15, v202, v203
v_mfma_f32_16x16x32_bf16 v[220:223], a[92:95], v[184:187], 0
ds_read_b128 v[200:203], v236 offset:8704
ds_read_b128 v[224:227], v236 offset:8960
v_mfma_f32_16x16x32_bf16 v[220:223], a[88:91], v[216:219], v[220:223]
ds_read_b128 v[228:231], v236 offset:9216
v_mfma_f32_16x16x32_bf16 v[220:223], a[84:87], v[204:207], v[220:223]
v_cvt_pk_bf16_f32 v13, v210, v211
v_cvt_pk_bf16_f32 v12, v208, v209
v_mfma_f32_16x16x32_bf16 v[220:223], a[80:83], v[192:195], v[220:223]
s_waitcnt lgkmcnt(4)
v_add_f32 v249, v249, v250
s_nop 0
v_mfma_f32_16x16x32_bf16 v[188:191], a[64:67], v[192:195], 0
v_rcp_f32 v252, v249
v_mfma_f32_16x16x32_bf16 v[188:191], a[72:75], v[216:219], v[188:191]
s_waitcnt lgkmcnt(3)
s_nop 0
v_cvt_pk_bf16_f32 v10, v220, v221
v_mfma_f32_16x16x32_bf16 v[188:191], a[76:79], v[184:187], v[188:191]
s_waitcnt lgkmcnt(1)
v_cvt_pk_bf16_f32 v11, v222, v223
v_mfma_f32_16x16x32_bf16 v[188:191], a[68:71], v[204:207], v[188:191]
s_waitcnt lgkmcnt(0)
s_nop 1
v_mfma_f32_16x16x32_bf16 v[184:187], a[68:71], v[200:203], 0
s_nop 2
v_mfma_f32_16x16x32_bf16 v[184:187], a[64:67], v[212:215], v[184:187]
v_cvt_pk_bf16_f32 v9, v190, v191
v_cvt_pk_bf16_f32 v8, v188, v189
v_mfma_f32_16x16x32_bf16 v[184:187], a[72:75], v[224:227], v[184:187]
v_mfma_f32_16x16x32_bf16 v[184:187], a[76:79], v[228:231], v[184:187]
s_nop 2
v_mfma_f32_16x16x32_bf16 v[188:191], a[92:95], v[228:231], 0
s_nop 2
v_mfma_f32_16x16x32_bf16 v[188:191], a[88:91], v[224:227], v[188:191]
v_cvt_pk_bf16_f32 v16, v184, v185
v_cvt_pk_bf16_f32 v17, v186, v187
v_mfma_f32_16x16x32_bf16 v[188:191], a[84:87], v[200:203], v[188:191]
v_mfma_f32_16x16x32_bf16 v[188:191], a[80:83], v[212:215], v[188:191]
ds_read_b128 v[184:187], v236 offset:13184
ds_read_b128 v[192:195], v236 offset:13440
v_mfma_f32_16x16x32_bf16 v[196:199], a[96:99], v[212:215], 0
ds_read_b128 v[204:207], v236 offset:12928
ds_read_b128 v[208:211], v236 offset:12672
v_mfma_f32_16x16x32_bf16 v[196:199], a[100:103], v[200:203], v[196:199]
s_add_u32 m0, s49, 6336
s_add_u32 s48, s48, s51
v_cvt_pk_bf16_f32 v18, v188, v189
v_mfma_f32_16x16x32_bf16 v[196:199], a[104:107], v[224:227], v[196:199]
buffer_load_dwordx4 v237, s[16:19], s48 offen nt lds
v_cvt_pk_bf16_f32 v19, v190, v191
v_mfma_f32_16x16x32_bf16 v[196:199], a[108:111], v[228:231], v[196:199]
s_nop 2
v_mfma_f32_16x16x32_bf16 v[188:191], a[124:127], v[228:231], 0
s_nop 2
v_mfma_f32_16x16x32_bf16 v[188:191], a[116:119], v[200:203], v[188:191]
s_waitcnt lgkmcnt(2)
v_cvt_pk_bf16_f32 v21, v198, v199
v_cvt_pk_bf16_f32 v20, v196, v197
v_mfma_f32_16x16x32_bf16 v[188:191], a[112:115], v[212:215], v[188:191]
s_waitcnt lgkmcnt(0)
v_mfma_f32_16x16x32_bf16 v[188:191], a[120:123], v[224:227], v[188:191]
s_nop 2
v_mfma_f32_16x16x32_bf16 v[196:199], a[120:123], v[184:187], 0
s_nop 2
v_mfma_f32_16x16x32_bf16 v[196:199], a[124:127], v[192:195], v[196:199]
v_cvt_pk_bf16_f32 v23, v190, v191
v_cvt_pk_bf16_f32 v22, v188, v189
v_mfma_f32_16x16x32_bf16 v[196:199], a[116:119], v[204:207], v[196:199]
v_mfma_f32_16x16x32_bf16 v[196:199], a[112:115], v[208:211], v[196:199]
s_nop 2
v_mfma_f32_16x16x32_bf16 v[188:191], a[96:99], v[208:211], 0
s_nop 2
v_mfma_f32_16x16x32_bf16 v[188:191], a[100:103], v[204:207], v[188:191]
v_cvt_pk_bf16_f32 v30, v196, v197
v_cvt_pk_bf16_f32 v31, v198, v199
v_mfma_f32_16x16x32_bf16 v[188:191], a[104:107], v[184:187], v[188:191]
v_mfma_f32_16x16x32_bf16 v[188:191], a[108:111], v[192:195], v[188:191]
ds_read_b128 v[196:199], v236 offset:17152
ds_read_b128 v[200:203], v236 offset:16896
v_mfma_f32_16x16x32_bf16 v[212:215], a[92:95], v[192:195], 0
ds_read_b128 v[216:219], v236 offset:17408
ds_read_b128 v[220:223], v236 offset:17664
v_mfma_f32_16x16x32_bf16 v[212:215], a[88:91], v[184:187], v[212:215]
s_nop 1
v_cvt_pk_bf16_f32 v29, v190, v191
v_mfma_f32_16x16x32_bf16 v[212:215], a[84:87], v[204:207], v[212:215]
v_cvt_pk_bf16_f32 v28, v188, v189
v_mfma_f32_16x16x32_bf16 v[212:215], a[80:83], v[208:211], v[212:215]
s_nop 2
v_mfma_f32_16x16x32_bf16 v[188:191], a[64:67], v[208:211], 0
s_nop 2
v_mfma_f32_16x16x32_bf16 v[188:191], a[72:75], v[184:187], v[188:191]
s_add_u32 m0, s49, 8448
v_cvt_pk_bf16_f32 v27, v214, v215
v_cvt_pk_bf16_f32 v26, v212, v213
v_mfma_f32_16x16x32_bf16 v[188:191], a[76:79], v[192:195], v[188:191]
s_add_u32 s48, s48, s51
buffer_load_dwordx4 v237, s[16:19], s48 offen nt lds
v_mfma_f32_16x16x32_bf16 v[188:191], a[68:71], v[204:207], v[188:191]
s_waitcnt lgkmcnt(0)
s_nop 1
v_mfma_f32_16x16x32_bf16 v[184:187], a[68:71], v[196:199], 0
s_nop 2
v_mfma_f32_16x16x32_bf16 v[184:187], a[64:67], v[200:203], v[184:187]
v_cvt_pk_bf16_f32 v24, v188, v189
v_cvt_pk_bf16_f32 v25, v190, v191
v_mfma_f32_16x16x32_bf16 v[184:187], a[72:75], v[216:219], v[184:187]
v_mfma_f32_16x16x32_bf16 v[184:187], a[76:79], v[220:223], v[184:187]
s_nop 2
v_mfma_f32_16x16x32_bf16 v[188:191], a[92:95], v[220:223], 0
s_nop 2
v_mfma_f32_16x16x32_bf16 v[188:191], a[88:91], v[216:219], v[188:191]
v_cvt_pk_bf16_f32 v32, v184, v185
v_cvt_pk_bf16_f32 v33, v186, v187
v_mfma_f32_16x16x32_bf16 v[188:191], a[84:87], v[196:199], v[188:191]
v_mfma_f32_16x16x32_bf16 v[188:191], a[80:83], v[200:203], v[188:191]
s_nop 2
v_mfma_f32_16x16x32_bf16 v[184:187], a[96:99], v[200:203], 0
s_nop 2
v_mfma_f32_16x16x32_bf16 v[184:187], a[100:103], v[196:199], v[184:187]
v_cvt_pk_bf16_f32 v35, v190, v191
v_cvt_pk_bf16_f32 v34, v188, v189
v_mfma_f32_16x16x32_bf16 v[184:187], a[104:107], v[216:219], v[184:187]
v_mfma_f32_16x16x32_bf16 v[184:187], a[108:111], v[220:223], v[184:187]
s_nop 2
v_mfma_f32_16x16x32_bf16 v[188:191], a[124:127], v[220:223], 0
s_nop 2
v_mfma_f32_16x16x32_bf16 v[188:191], a[120:123], v[216:219], v[188:191]
v_cvt_pk_bf16_f32 v37, v186, v187
v_cvt_pk_bf16_f32 v36, v184, v185
v_mfma_f32_16x16x32_bf16 v[188:191], a[116:119], v[196:199], v[188:191]
v_mfma_f32_16x16x32_bf16 v[188:191], a[112:115], v[200:203], v[188:191]
s_nop 2
v_mfma_f32_16x16x32_bf16 v[184:187], v[56:59], v[136:139], 0
s_nop 2
v_mfma_f32_16x16x32_bf16 v[184:187], v[104:107], v[148:151], v[184:187]
s_add_u32 m0, s49, 10560
ds_read_u16 v104, v241 offset:0
v_cvt_pk_bf16_f32 v39, v190, v191
v_mfma_f32_16x16x32_bf16 v[184:187], v[72:75], v[140:143], v[184:187]
s_add_u32 s48, s48, s51
buffer_load_dwordx4 v237, s[16:19], s48 offen nt lds
v_cvt_pk_bf16_f32 v38, v188, v189
v_mfma_f32_16x16x32_bf16 v[184:187], v[88:91], v[144:147], v[184:187]
s_nop 2
v_mfma_f32_16x16x32_bf16 v[188:191], v[92:95], v[144:147], 0
s_nop 2
v_mfma_f32_16x16x32_bf16 v[188:191], v[76:79], v[140:143], v[188:191]
v_fmac_f32 v170, v186, v252
v_fmac_f32 v168, v184, v252
v_mfma_f32_16x16x32_bf16 v[188:191], v[106:109], v[148:151], v[188:191]
ds_read_u16 v106, v241 offset:128
v_fmac_f32 v171, v187, v252
v_mfma_f32_16x16x32_bf16 v[188:191], v[60:63], v[136:139], v[188:191]
s_waitcnt lgkmcnt(1)
ds_read_b128 v[192:195], v236 offset:21888
v_fmac_f32 v169, v185, v252
v_mfma_f32_16x16x32_bf16 v[200:203], v[64:67], v[136:139], 0
ds_read_b128 v[196:199], v236 offset:21632
ds_read_b128 v[204:207], v236 offset:21376
v_mfma_f32_16x16x32_bf16 v[200:203], v[108:111], v[148:151], v[200:203]
ds_read_b128 v[208:211], v236 offset:21120
v_fmac_f32 v174, v190, v252
v_mfma_f32_16x16x32_bf16 v[200:203], v[80:83], v[140:143], v[200:203]
ds_read_u16 v108, v241 offset:256
v_fmac_f32 v175, v191, v252
v_mfma_f32_16x16x32_bf16 v[200:203], v[96:99], v[144:147], v[200:203]
v_fmac_f32 v172, v188, v252
v_fmac_f32 v173, v189, v252
v_mfma_f32_16x16x32_bf16 v[184:187], v[100:103], v[144:147], 0
s_waitcnt lgkmcnt(5)
v_cvt_pk_bf16_f32 v168, v168, v169
v_cvt_pk_bf16_f32 v169, v170, v171
v_mfma_f32_16x16x32_bf16 v[184:187], v[84:87], v[140:143], v[184:187]
s_waitcnt lgkmcnt(4)
v_fmac_f32 v178, v202, v252
v_fmac_f32 v176, v200, v252
v_mfma_f32_16x16x32_bf16 v[184:187], v[110:113], v[148:151], v[184:187]
s_waitcnt lgkmcnt(2)
ds_read_u16 v110, v241 offset:384
v_fmac_f32 v177, v201, v252
v_mfma_f32_16x16x32_bf16 v[184:187], v[68:71], v[136:139], v[184:187]
L_entrys:
s_waitcnt lgkmcnt(2)
v_fmac_f32 v179, v203, v252
v_cvt_pk_bf16_f32 v176, v176, v177
v_mfma_f32_16x16x32_bf16 v[188:191], a[124:127], v[192:195], 0
s_waitcnt lgkmcnt(1)
v_cvt_pk_bf16_f32 v177, v178, v179
v_cvt_pk_bf16_f32 v171, v174, v175
v_mfma_f32_16x16x32_bf16 v[188:191], a[120:123], v[196:199], v[188:191]
v_fmac_f32 v180, v184, v252
v_fmac_f32 v181, v185, v252
v_mfma_f32_16x16x32_bf16 v[188:191], a[116:119], v[204:207], v[188:191]
v_fmac_f32 v183, v187, v252
v_fmac_f32 v182, v186, v252
v_mfma_f32_16x16x32_bf16 v[188:191], a[112:115], v[208:211], v[188:191]
v_cvt_pk_bf16_f32 v178, v180, v181
v_cvt_pk_bf16_f32 v170, v172, v173
v_mfma_f32_16x16x32_bf16 v[184:187], a[96:99], v[208:211], 0
s_waitcnt lgkmcnt(0)
v_cvt_pk_bf16_f32 v179, v182, v183
v_pk_max_i16 v168, v168, 0
v_mfma_f32_16x16x32_bf16 v[184:187], a[100:103], v[204:207], v[184:187]
s_add_u32 s48, s48, s51
v_cvt_pk_bf16_f32 v46, v188, v189
v_cvt_pk_bf16_f32 v47, v190, v191
v_mfma_f32_16x16x32_bf16 v[184:187], a[104:107], v[196:199], v[184:187]
s_add_u32 m0, s49, 12672
v_pk_max_i16 v176, v176, 0
v_pk_max_i16 v170, v170, 0
v_mfma_f32_16x16x32_bf16 v[184:187], a[108:111], v[192:195], v[184:187]
buffer_load_dwordx4 v237, s[16:19], s48 offen nt lds
v_pk_max_i16 v179, v179, 0
v_mfma_f32_16x16x32_bf16 v[188:191], a[92:95], v[192:195], 0
v_pk_max_i16 v178, v178, 0
v_pk_max_i16 v169, v169, 0
v_mfma_f32_16x16x32_bf16 v[188:191], a[88:91], v[196:199], v[188:191]
v_pk_max_i16 v177, v177, 0
v_pk_max_i16 v171, v171, 0
v_mfma_f32_16x16x32_bf16 v[188:191], a[84:87], v[204:207], v[188:191]
buffer_store_dwordx4 v[168:171], v239, s[20:23], s53 offen offset:0 nt
buffer_store_dwordx4 v[176:179], v239, s[20:23], s53 offen offset:64 nt
v_cvt_pk_bf16_f32 v44, v184, v185
v_cvt_pk_bf16_f32 v45, v186, v187
v_add_u32 v241, 0x200, v241
s_add_u32 s53, s46, 0
v_mfma_f32_16x16x32_bf16 v[188:191], a[80:83], v[208:211], v[188:191]
s_nop 2
v_mfma_f32_16x16x32_bf16 v[184:187], a[64:67], v[208:211], 0
s_nop 2
v_mfma_f32_16x16x32_bf16 v[184:187], a[72:75], v[196:199], v[184:187]
v_cvt_pk_bf16_f32 v42, v188, v189
v_cvt_pk_bf16_f32 v43, v190, v191
v_mfma_f32_16x16x32_bf16 v[184:187], a[76:79], v[192:195], v[184:187]
v_mfma_f32_16x16x32_bf16 v[184:187], a[68:71], v[204:207], v[184:187]
s_nop 2
v_mfma_f32_16x16x32_bf16 v[188:191], a[4:7], v[204:207], 0
s_nop 2
v_mfma_f32_16x16x32_bf16 v[188:191], a[0:3], v[208:211], v[188:191]
v_cvt_pk_bf16_f32 v41, v186, v187
v_cvt_pk_bf16_f32 v40, v184, v185
v_mfma_f32_16x16x32_bf16 v[188:191], a[8:11], v[196:199], v[188:191]
v_mfma_f32_16x16x32_bf16 v[188:191], a[12:15], v[192:195], v[188:191]
s_nop 2
v_mfma_f32_16x16x32_bf16 v[184:187], a[28:31], v[192:195], 0
s_nop 2
v_mfma_f32_16x16x32_bf16 v[184:187], a[24:27], v[196:199], v[184:187]
v_cvt_pk_bf16_f32 v112, v188, v189
v_cvt_pk_bf16_f32 v113, v190, v191
v_mfma_f32_16x16x32_bf16 v[184:187], a[20:23], v[204:207], v[184:187]
v_mfma_f32_16x16x32_bf16 v[184:187], a[16:19], v[208:211], v[184:187]
s_nop 2
v_mfma_f32_16x16x32_bf16 v[188:191], a[32:35], v[208:211], 0
s_nop 2
v_mfma_f32_16x16x32_bf16 v[188:191], a[36:39], v[204:207], v[188:191]
s_add_u32 m0, s49, 14784
v_cvt_pk_bf16_f32 v114, v184, v185
v_cvt_pk_bf16_f32 v115, v186, v187
v_mfma_f32_16x16x32_bf16 v[188:191], a[40:43], v[196:199], v[188:191]
s_add_u32 s48, s48, s51
buffer_load_dwordx4 v237, s[16:19], s48 offen nt lds
v_mfma_f32_16x16x32_bf16 v[188:191], a[44:47], v[192:195], v[188:191]
s_nop 2
v_mfma_f32_16x16x32_bf16 v[184:187], a[60:63], v[192:195], 0
s_nop 2
v_mfma_f32_16x16x32_bf16 v[184:187], a[56:59], v[196:199], v[184:187]
v_cvt_pk_bf16_f32 v116, v188, v189
v_cvt_pk_bf16_f32 v117, v190, v191
v_mfma_f32_16x16x32_bf16 v[184:187], a[52:55], v[204:207], v[184:187]
v_mfma_f32_16x16x32_bf16 v[184:187], a[48:51], v[208:211], v[184:187]
s_nop 2
v_mfma_f32_16x16x32_bf16 v[152:155], a[192:195], v[208:211], 0
s_nop 2
v_mfma_f32_16x16x32_bf16 v[152:155], a[196:199], v[204:207], v[152:155]
v_cvt_pk_bf16_f32 v118, v184, v185
v_cvt_pk_bf16_f32 v119, v186, v187
v_mfma_f32_16x16x32_bf16 v[152:155], a[200:203], v[196:199], v[152:155]
v_mfma_f32_16x16x32_bf16 v[152:155], a[204:207], v[192:195], v[152:155]
v_mfma_f32_16x16x32_bf16 v[156:159], a[220:223], v[192:195], 0
v_mfma_f32_16x16x32_bf16 v[156:159], a[216:219], v[196:199], v[156:159]
v_mfma_f32_16x16x32_bf16 v[156:159], a[212:215], v[204:207], v[156:159]
v_mfma_f32_16x16x32_bf16 v[156:159], a[208:211], v[208:211], v[156:159]
v_mfma_f32_16x16x32_bf16 v[160:163], a[224:227], v[208:211], 0
v_mfma_f32_16x16x32_bf16 v[160:163], a[228:231], v[204:207], v[160:163]
v_mfma_f32_16x16x32_bf16 v[160:163], a[232:235], v[196:199], v[160:163]
v_mfma_f32_16x16x32_bf16 v[160:163], a[236:239], v[192:195], v[160:163]
v_mfma_f32_16x16x32_bf16 v[164:167], a[252:255], v[192:195], 0
v_mfma_f32_16x16x32_bf16 v[164:167], a[248:251], v[196:199], v[164:167]
s_add_u32 s48, s48, s51
s_add_u32 m0, s49, 16896
v_mfma_f32_16x16x32_bf16 v[164:167], a[244:247], v[204:207], v[164:167]
buffer_load_dwordx4 v237, s[16:19], s48 offen nt lds
v_mfma_f32_16x16x32_bf16 v[164:167], a[240:243], v[208:211], v[164:167]
v_mfma_f32_16x16x32_bf16 v[184:187], v[0:3], v[112:115], 0
v_mfma_f32_16x16x32_bf16 v[184:187], v[4:7], v[116:119], v[184:187]
s_nop 2
v_mfma_f32_16x16x32_bf16 v[188:191], v[12:15], v[116:119], 0
s_nop 2
v_mfma_f32_16x16x32_bf16 v[188:191], v[8:11], v[112:115], v[188:191]
v_max3_f32 v254, v184, v185, v186
s_nop 0
v_mfma_f32_16x16x32_bf16 v[200:203], v[16:19], v[112:115], 0
s_nop 2
v_mfma_f32_16x16x32_bf16 v[200:203], v[20:23], v[116:119], v[200:203]
s_nop 0
v_max3_f32 v254, v254, v187, v188
v_max3_f32 v254, v254, v189, v190
v_mfma_f32_16x16x32_bf16 v[212:215], v[28:31], v[116:119], 0
s_nop 2
v_mfma_f32_16x16x32_bf16 v[212:215], v[24:27], v[112:115], v[212:215]
v_max3_f32 v254, v254, v191, v200
v_max3_f32 v254, v254, v201, v202
v_mfma_f32_16x16x32_bf16 v[216:219], v[32:35], v[112:115], 0
s_nop 2
v_mfma_f32_16x16x32_bf16 v[216:219], v[36:39], v[116:119], v[216:219]
s_nop 0
v_max3_f32 v254, v254, v203, v212
v_max3_f32 v254, v254, v213, v214
v_mfma_f32_16x16x32_bf16 v[220:223], v[44:47], v[116:119], 0
s_nop 2
v_mfma_f32_16x16x32_bf16 v[220:223], v[40:43], v[112:115], v[220:223]
v_max3_f32 v254, v254, v215, v216
v_max3_f32 v254, v254, v217, v218
v_mfma_f32_16x16x32_bf16 v[224:227], v[48:51], v[112:115], 0
s_nop 2
v_mfma_f32_16x16x32_bf16 v[224:227], v[52:55], v[116:119], v[224:227]
s_nop 0
v_max3_f32 v254, v254, v219, v220
v_max3_f32 v254, v254, v221, v222
v_mfma_f32_16x16x32_bf16 v[228:231], v[208:211], a[128:131], 0
s_nop 2
v_mfma_f32_16x16x32_bf16 v[228:231], v[204:207], a[132:135], v[228:231]
v_max3_f32 v254, v254, v223, v224
v_mfma_f32_16x16x32_bf16 v[228:231], v[196:199], a[136:139], v[228:231]
ds_swizzle_b32 v255, v254 offset:0x401F
v_mfma_f32_16x16x32_bf16 v[228:231], v[192:195], a[140:143], v[228:231]
s_add_u32 m0, s49, 19008
s_add_u32 s48, s48, s51
buffer_load_dwordx4 v237, s[16:19], s48 offen nt lds
v_mfma_f32_16x16x32_bf16 v[232:235], v[192:195], a[156:159], 0
s_nop 2
v_mfma_f32_16x16x32_bf16 v[232:235], v[196:199], a[152:155], v[232:235]
v_cvt_pk_bf16_f32 v91, v230, v231
v_cvt_pk_bf16_f32 v90, v228, v229
v_mfma_f32_16x16x32_bf16 v[232:235], v[204:207], a[148:151], v[232:235]
v_mfma_f32_16x16x32_bf16 v[232:235], v[208:211], a[144:147], v[232:235]
s_nop 2
v_mfma_f32_16x16x32_bf16 v[228:231], v[208:211], a[160:163], 0
s_waitcnt lgkmcnt(0)
v_max_f32 v254, v254, v255
s_nop 0
v_mfma_f32_16x16x32_bf16 v[228:231], v[204:207], a[164:167], v[228:231]
ds_bpermute_b32 v255, v247, v254
v_mfma_f32_16x16x32_bf16 v[228:231], v[196:199], a[168:171], v[228:231]
v_cvt_pk_bf16_f32 v95, v234, v235
v_cvt_pk_bf16_f32 v94, v232, v233
v_mfma_f32_16x16x32_bf16 v[228:231], v[192:195], a[172:175], v[228:231]
s_nop 2
v_mfma_f32_16x16x32_bf16 v[232:235], v[192:195], a[188:191], 0
ds_read_b128 v[192:195], v236 offset:4224
s_nop 0
v_mfma_f32_16x16x32_bf16 v[232:235], v[204:207], a[180:183], v[232:235]
ds_read_b128 v[204:207], v236 offset:4480
v_cvt_pk_bf16_f32 v99, v230, v231
v_mfma_f32_16x16x32_bf16 v[232:235], v[208:211], a[176:179], v[232:235]
ds_read_b128 v[208:211], v236 offset:4736
v_cvt_pk_bf16_f32 v98, v228, v229
v_mfma_f32_16x16x32_bf16 v[232:235], v[196:199], a[184:187], v[232:235]
s_waitcnt lgkmcnt(3)
ds_read_b128 v[196:199], v236 offset:4992
v_max_f32 v254, v254, v255
v_sub_f32 v184, v184, v254
v_sub_f32 v185, v185, v254
v_exp_f32 v184, v184
v_exp_f32 v185, v185
v_sub_f32 v187, v187, v254
v_cvt_pk_bf16_f32 v103, v234, v235
v_cvt_pk_bf16_f32 v102, v232, v233
v_add_f32 v248, v184, v185
v_sub_f32 v186, v186, v254
v_exp_f32 v186, v186
v_cvt_pk_bf16_f32 v120, v184, v185
v_add_f32 v248, v248, v186
s_waitcnt lgkmcnt(1)
v_mfma_f32_16x16x32_bf16 v[228:231], v[208:211], a[184:187], 0
v_sub_f32 v188, v188, v254
s_waitcnt lgkmcnt(0)
v_mfma_f32_16x16x32_bf16 v[228:231], v[196:199], a[188:191], v[228:231]
v_exp_f32 v187, v187
v_mfma_f32_16x16x32_bf16 v[228:231], v[204:207], a[180:183], v[228:231]
v_cvt_pk_bf16_f32 v121, v186, v187
v_add_f32 v248, v248, v187
v_mfma_f32_16x16x32_bf16 v[228:231], v[192:195], a[176:179], v[228:231]
v_sub_f32 v189, v189, v254
v_sub_f32 v190, v190, v254
v_mfma_f32_16x16x32_bf16 v[232:235], v[192:195], a[160:163], 0
v_exp_f32 v189, v189
v_mfma_f32_16x16x32_bf16 v[232:235], v[204:207], a[164:167], v[232:235]
v_exp_f32 v190, v190
v_mfma_f32_16x16x32_bf16 v[232:235], v[208:211], a[168:171], v[232:235]
s_nop 0
v_cvt_pk_bf16_f32 v71, v230, v231
v_cvt_pk_bf16_f32 v70, v228, v229
v_mfma_f32_16x16x32_bf16 v[232:235], v[196:199], a[172:175], v[232:235]
s_add_u32 s48, s48, s51
v_exp_f32 v188, v188
v_mfma_f32_16x16x32_bf16 v[228:231], v[196:199], a[156:159], 0
s_add_u32 m0, s49, 21120
v_add_f32 v248, v248, v188
v_sub_f32 v191, v191, v254
v_mfma_f32_16x16x32_bf16 v[228:231], v[208:211], a[152:155], v[228:231]
buffer_load_dwordx4 v237, s[16:19], s48 offen nt lds
v_cvt_pk_bf16_f32 v66, v232, v233
v_mfma_f32_16x16x32_bf16 v[228:231], v[204:207], a[148:151], v[228:231]
v_cvt_pk_bf16_f32 v67, v234, v235
v_add_f32 v248, v248, v189
v_mfma_f32_16x16x32_bf16 v[228:231], v[192:195], a[144:147], v[228:231]
v_exp_f32 v191, v191
v_mfma_f32_16x16x32_bf16 v[232:235], v[192:195], a[128:131], 0
ds_read_b128 v[192:195], v236 offset:0
v_cvt_pk_bf16_f32 v122, v188, v189
v_mfma_f32_16x16x32_bf16 v[232:235], v[208:211], a[136:139], v[232:235]
ds_read_b128 v[208:211], v236 offset:256
v_add_f32 v248, v248, v190
v_mfma_f32_16x16x32_bf16 v[232:235], v[196:199], a[140:143], v[232:235]
ds_read_b128 v[196:199], v236 offset:512
v_cvt_pk_bf16_f32 v62, v228, v229
v_mfma_f32_16x16x32_bf16 v[232:235], v[204:207], a[132:135], v[232:235]
ds_read_b128 v[204:207], v236 offset:768
v_cvt_pk_bf16_f32 v63, v230, v231
v_add_f32 v248, v248, v191
v_cvt_pk_bf16_f32 v123, v190, v191
v_sub_f32 v200, v200, v254
v_exp_f32 v200, v200
v_sub_f32 v201, v201, v254
v_exp_f32 v201, v201
v_cvt_pk_bf16_f32 v59, v234, v235
v_cvt_pk_bf16_f32 v58, v232, v233
v_sub_f32 v203, v203, v254
s_waitcnt lgkmcnt(2)
v_mfma_f32_16x16x32_bf16 v[228:231], v[208:211], a[132:135], 0
ds_read_b128 v[188:191], v242 offset:64
v_sub_f32 v202, v202, v254
v_mfma_f32_16x16x32_bf16 v[228:231], v[192:195], a[128:131], v[228:231]
s_waitcnt lgkmcnt(2)
v_exp_f32 v203, v203
v_mfma_f32_16x16x32_bf16 v[228:231], v[196:199], a[136:139], v[228:231]
s_waitcnt lgkmcnt(1)
v_exp_f32 v202, v202
v_mfma_f32_16x16x32_bf16 v[228:231], v[204:207], a[140:143], v[228:231]
v_add_f32 v248, v248, v200
v_add_f32 v248, v248, v201
v_mfma_f32_16x16x32_bf16 v[184:187], v[204:207], a[156:159], 0
v_add_f32 v248, v248, v202
v_add_f32 v248, v248, v203
v_mfma_f32_16x16x32_bf16 v[184:187], v[196:199], a[152:155], v[184:187]
v_cvt_pk_bf16_f32 v124, v200, v201
v_cvt_pk_bf16_f32 v125, v202, v203
v_mfma_f32_16x16x32_bf16 v[184:187], v[208:211], a[148:151], v[184:187]
s_waitcnt lgkmcnt(0)
v_cvt_pk_bf16_f32 v56, v228, v229
v_cvt_pk_bf16_f32 v57, v230, v231
v_mfma_f32_16x16x32_bf16 v[184:187], v[192:195], a[144:147], v[184:187]
v_sub_f32 v212, v212, v254
v_sub_f32 v213, v213, v254
v_mfma_f32_16x16x32_bf16 v[228:231], v[192:195], a[160:163], 0
v_exp_f32 v212, v212
v_mfma_f32_16x16x32_bf16 v[228:231], v[208:211], a[164:167], v[228:231]
v_sub_f32 v214, v214, v254
v_add_f32 v248, v248, v212
v_mfma_f32_16x16x32_bf16 v[228:231], v[196:199], a[168:171], v[228:231]
v_cvt_pk_bf16_f32 v60, v184, v185
v_cvt_pk_bf16_f32 v61, v186, v187
v_mfma_f32_16x16x32_bf16 v[228:231], v[204:207], a[172:175], v[228:231]
s_add_u32 m0, s49, 23232
ds_read_b128 v[184:187], v242 offset:0
v_sub_f32 v215, v215, v254
v_mfma_f32_16x16x32_bf16 v[232:235], v[204:207], a[188:191], 0
s_add_u32 s48, s48, s51
buffer_load_dwordx4 v237, s[16:19], s48 offen nt lds
v_sub_f32 v216, v216, v254
v_mfma_f32_16x16x32_bf16 v[232:235], v[196:199], a[184:187], v[232:235]
s_sub_u32 s49, s49, s56
v_exp_f32 v213, v213
v_mfma_f32_16x16x32_bf16 v[232:235], v[208:211], a[180:183], v[232:235]
s_and_b32 s51, s57, 26212352
v_exp_f32 v214, v214
v_mfma_f32_16x16x32_bf16 v[232:235], v[192:195], a[176:179], v[232:235]
s_add_u32 s51, s51, 2048
v_cvt_pk_bf16_f32 v126, v212, v213
v_add_f32 v248, v248, v213
v_mfma_f32_16x16x32_bf16 v[200:203], v[4:7], v[188:191], 0
v_add_f32 v248, v248, v214
s_waitcnt lgkmcnt(0)
v_mfma_f32_16x16x32_bf16 v[200:203], v[0:3], v[184:187], v[200:203]
s_nop 0
v_cvt_pk_bf16_f32 v69, v234, v235
v_cvt_pk_bf16_f32 v68, v232, v233
v_mfma_f32_16x16x32_bf16 v[232:235], v[32:35], v[184:187], 0
ds_read_b128 v[184:187], v245 offset:64
v_sub_f32 v218, v218, v254
v_mfma_f32_16x16x32_bf16 v[232:235], v[36:39], v[188:191], v[232:235]
ds_read_b128 v[188:191], v243 offset:0
v_exp_f32 v215, v215
s_nop 0
v_add_f32 v248, v248, v215
v_cvt_pk_bf16_f32 v127, v214, v215
ds_read_b128 v[212:215], v243 offset:64
v_exp_f32 v216, v216
v_sub_f32 v217, v217, v254
v_add_f32 v248, v248, v216
v_exp_f32 v218, v218
v_sub_f32 v219, v219, v254
v_exp_f32 v217, v217
v_exp_f32 v219, v219
v_cvt_pk_bf16_f32 v128, v216, v217
v_cvt_pk_bf16_f32 v129, v218, v219
v_add_f32 v248, v248, v217
v_add_f32 v248, v248, v218
v_add_f32 v248, v248, v219
v_cvt_pk_bf16_f32 v64, v228, v229
v_cvt_pk_bf16_f32 v65, v230, v231
v_sub_f32 v220, v220, v254
v_sub_f32 v221, v221, v254
s_waitcnt lgkmcnt(0)
v_mfma_f32_16x16x32_bf16 v[200:203], v[12:15], v[212:215], v[200:203]
ds_read_b128 v[216:219], v244 offset:0
ds_read_b128 v[228:231], v245 offset:0
v_mfma_f32_16x16x32_bf16 v[200:203], v[8:11], v[188:191], v[200:203]
v_exp_f32 v220, v220
v_mfma_f32_16x16x32_bf16 v[232:235], v[40:43], v[188:191], v[232:235]
ds_read_b128 v[188:191], v244 offset:64
v_add_f32 v248, v248, v220
v_mfma_f32_16x16x32_bf16 v[232:235], v[44:47], v[212:215], v[232:235]
v_exp_f32 v221, v221
v_sub_f32 v223, v223, v254
v_add_f32 v248, v248, v221
v_exp_f32 v223, v223
v_sub_f32 v222, v222, v254
v_exp_f32 v222, v222
v_cvt_pk_bf16_f32 v130, v220, v221
v_mov_b32 v221, 0xff800000
v_add_f32 v248, v248, v222
v_cvt_pk_bf16_f32 v131, v222, v223
v_add_f32 v248, v248, v223
v_sub_f32 v224, v224, v254
v_exp_f32 v224, v224
s_waitcnt lgkmcnt(0)
v_mfma_f32_16x16x32_bf16 v[200:203], v[20:23], v[188:191], v[200:203]
v_cvt_pk_bf16_f32 v132, v224, 0
v_add_f32 v248, v248, v224
v_mfma_f32_16x16x32_bf16 v[200:203], v[16:19], v[216:219], v[200:203]
ds_swizzle_b32 v250, v248 offset:0x401F
v_add_u32 v245, 0x200, v245
v_mfma_f32_16x16x32_bf16 v[232:235], v[48:51], v[216:219], v[232:235]
v_add_u32 v244, 0x200, v244
v_add_u32 v243, 0x200, v243
v_mfma_f32_16x16x32_bf16 v[232:235], v[52:55], v[188:191], v[232:235]
v_add_u32 v242, 0x200, v242
s_nop 0
v_mfma_f32_16x16x32_bf16 v[200:203], v[24:27], v[228:231], v[200:203]
s_nop 2
v_mfma_f32_16x16x32_bf16 v[200:203], v[28:31], v[184:187], v[200:203]
s_nop 0
v_mov_b32_dpp v233, v221 quad_perm:[0,1,2,3] row_mask:0xf bank_mask:0xc
v_mov_b32_dpp v232, v221 quad_perm:[0,1,2,3] row_mask:0xf bank_mask:0x8
v_mfma_f32_16x16x32_bf16 v[184:187], a[0:3], v[192:195], 0
v_mov_b32_dpp v234, v221 quad_perm:[0,1,2,3] row_mask:0xf bank_mask:0xc
v_mov_b32_dpp v235, v221 quad_perm:[0,1,2,3] row_mask:0xf bank_mask:0xc
v_mfma_f32_16x16x32_bf16 v[184:187], a[4:7], v[208:211], v[184:187]
s_waitcnt lgkmcnt(0)
v_max3_f32 v223, v200, v201, v202
v_max3_f32 v223, v223, v203, v232
v_mfma_f32_16x16x32_bf16 v[184:187], a[8:11], v[196:199], v[184:187]
v_max3_f32 v223, v223, v233, v234
v_max_f32 v223, v223, v235
v_mfma_f32_16x16x32_bf16 v[184:187], a[12:15], v[204:207], v[184:187]
s_nop 0
v_max_f32_dpp v223, v223, v223 row_ror:8 row_mask:0xf bank_mask:0xf
v_add_f32 v248, v248, v250
v_mfma_f32_16x16x32_bf16 v[188:191], a[28:31], v[204:207], 0
ds_bpermute_b32 v250, v247, v248
v_mfma_f32_16x16x32_bf16 v[188:191], a[24:27], v[196:199], v[188:191]
v_max_f32_dpp v223, v223, v223 row_ror:4 row_mask:0xf bank_mask:0xf
v_mfma_f32_16x16x32_bf16 v[188:191], a[20:23], v[208:211], v[188:191]
ds_swizzle_b32 v221, v223 offset:0x401F
v_cvt_pk_bf16_f32 v113, v186, v187
v_mfma_f32_16x16x32_bf16 v[188:191], a[16:19], v[192:195], v[188:191]
v_cvt_pk_bf16_f32 v112, v184, v185
s_nop 0
v_mfma_f32_16x16x32_bf16 v[184:187], a[32:35], v[192:195], 0
s_nop 2
v_mfma_f32_16x16x32_bf16 v[184:187], a[36:39], v[208:211], v[184:187]
s_nop 0
v_cvt_pk_bf16_f32 v115, v190, v191
v_cvt_pk_bf16_f32 v114, v188, v189
v_mfma_f32_16x16x32_bf16 v[184:187], a[40:43], v[196:199], v[184:187]
s_waitcnt lgkmcnt(1)
v_add_f32 v248, v248, v250
v_mfma_f32_16x16x32_bf16 v[184:187], a[44:47], v[204:207], v[184:187]
v_rcp_f32 v251, v248
v_mfma_f32_16x16x32_bf16 v[188:191], a[60:63], v[204:207], 0
s_waitcnt lgkmcnt(0)
v_max_f32 v223, v223, v221
s_nop 0
v_mfma_f32_16x16x32_bf16 v[188:191], a[56:59], v[196:199], v[188:191]
ds_bpermute_b32 v221, v247, v223
v_mfma_f32_16x16x32_bf16 v[188:191], a[52:55], v[208:211], v[188:191]
v_cvt_pk_bf16_f32 v117, v186, v187
v_cvt_pk_bf16_f32 v116, v184, v185
v_mfma_f32_16x16x32_bf16 v[188:191], a[48:51], v[192:195], v[188:191]
s_nop 2
v_mfma_f32_16x16x32_bf16 v[168:171], a[192:195], v[192:195], 0
s_nop 2
v_mfma_f32_16x16x32_bf16 v[168:171], a[196:199], v[208:211], v[168:171]
v_cvt_pk_bf16_f32 v119, v190, v191
v_cvt_pk_bf16_f32 v118, v188, v189
v_mfma_f32_16x16x32_bf16 v[168:171], a[200:203], v[196:199], v[168:171]
v_mfma_f32_16x16x32_bf16 v[168:171], a[204:207], v[204:207], v[168:171]
s_waitcnt lgkmcnt(0)
v_max_f32 v223, v223, v221
v_sub_f32 v200, v200, v223
v_mfma_f32_16x16x32_bf16 v[172:175], a[220:223], v[204:207], 0
v_exp_f32 v200, v200
v_mfma_f32_16x16x32_bf16 v[172:175], a[216:219], v[196:199], v[172:175]
v_sub_f32 v201, v201, v223
v_sub_f32 v202, v202, v223
v_mfma_f32_16x16x32_bf16 v[172:175], a[212:215], v[208:211], v[172:175]
v_exp_f32 v202, v202
v_mfma_f32_16x16x32_bf16 v[172:175], a[208:211], v[192:195], v[172:175]
v_exp_f32 v201, v201
v_mfma_f32_16x16x32_bf16 v[176:179], a[224:227], v[192:195], 0
v_add_f32 v220, v200, v201
v_add_f32 v220, v220, v202
v_mfma_f32_16x16x32_bf16 v[176:179], a[228:231], v[208:211], v[176:179]
v_sub_f32 v203, v203, v223
v_sub_f32 v233, v233, v223
v_mfma_f32_16x16x32_bf16 v[176:179], a[232:235], v[196:199], v[176:179]
v_exp_f32 v233, v233
v_mfma_f32_16x16x32_bf16 v[176:179], a[236:239], v[204:207], v[176:179]
v_exp_f32 v203, v203
v_mfma_f32_16x16x32_bf16 v[180:183], a[252:255], v[204:207], 0
v_sub_f32 v232, v232, v223
v_sub_f32 v234, v234, v223
v_mfma_f32_16x16x32_bf16 v[180:183], a[248:251], v[196:199], v[180:183]
v_exp_f32 v232, v232
v_mfma_f32_16x16x32_bf16 v[180:183], a[244:247], v[208:211], v[180:183]
v_exp_f32 v234, v234
v_mfma_f32_16x16x32_bf16 v[180:183], a[240:243], v[192:195], v[180:183]
v_add_f32 v220, v220, v203
v_add_f32 v220, v220, v232
v_mfma_f32_16x16x32_bf16 v[184:187], v[0:3], v[112:115], 0
v_add_f32 v220, v220, v233
v_add_f32 v220, v220, v234
v_mfma_f32_16x16x32_bf16 v[184:187], v[4:7], v[116:119], v[184:187]
v_sub_f32 v235, v235, v223
v_cvt_pk_bf16_f32 v200, v200, v201
v_mfma_f32_16x16x32_bf16 v[188:191], v[12:15], v[116:119], 0
v_exp_f32 v235, v235
v_mfma_f32_16x16x32_bf16 v[188:191], v[8:11], v[112:115], v[188:191]
v_add_f32 v220, v220, v235
v_cvt_pk_bf16_f32 v201, v202, v203
v_mfma_f32_16x16x32_bf16 v[192:195], v[16:19], v[112:115], 0
v_cvt_pk_bf16_f32 v202, v232, v233
v_cvt_pk_bf16_f32 v203, v234, v235
v_mfma_f32_16x16x32_bf16 v[192:195], v[20:23], v[116:119], v[192:195]
ds_read_b128 v[196:199], v236 offset:8448
v_add_f32_dpp v220, v220, v220 row_ror:8 row_mask:0xf bank_mask:0xf
v_mfma_f32_16x16x32_bf16 v[208:211], v[28:31], v[116:119], 0
ds_read_b128 v[204:207], v236 offset:8704
v_add_f32_dpp v220, v220, v220 row_ror:4 row_mask:0xf bank_mask:0xf
v_mfma_f32_16x16x32_bf16 v[208:211], v[24:27], v[112:115], v[208:211]
ds_write_b32 v246, v220 offset:4096
ds_read_b128 v[212:215], v236 offset:8960
v_mfma_f32_16x16x32_bf16 v[216:219], v[32:35], v[112:115], 0
ds_read_b128 v[224:227], v236 offset:9216
v_max3_f32 v254, v184, v185, v186
v_mfma_f32_16x16x32_bf16 v[216:219], v[36:39], v[116:119], v[216:219]
v_max3_f32 v254, v254, v187, v188
v_max3_f32 v254, v254, v189, v190
v_mfma_f32_16x16x32_bf16 v[228:231], v[44:47], v[116:119], 0
v_max3_f32 v254, v254, v191, v192
v_max3_f32 v254, v254, v193, v194
v_mfma_f32_16x16x32_bf16 v[228:231], v[40:43], v[112:115], v[228:231]
s_waitcnt lgkmcnt(4)
v_max3_f32 v254, v254, v195, v208
v_max3_f32 v254, v254, v209, v210
v_mfma_f32_16x16x32_bf16 v[232:235], v[48:51], v[112:115], 0
s_waitcnt lgkmcnt(3)
v_max3_f32 v254, v254, v211, v216
v_max3_f32 v254, v254, v217, v218
v_mfma_f32_16x16x32_bf16 v[232:235], v[52:55], v[116:119], v[232:235]
s_waitcnt lgkmcnt(1)
v_max3_f32 v254, v254, v219, v228
v_max3_f32 v254, v254, v229, v230
v_mfma_f32_16x16x32_bf16 v[220:223], v[196:199], a[128:131], 0
s_waitcnt lgkmcnt(0)
s_nop 1
v_mfma_f32_16x16x32_bf16 v[220:223], v[204:207], a[132:135], v[220:223]
v_max3_f32 v254, v254, v231, v232
v_mfma_f32_16x16x32_bf16 v[220:223], v[212:215], a[136:139], v[220:223]
ds_swizzle_b32 v255, v254 offset:0x401F
v_mfma_f32_16x16x32_bf16 v[220:223], v[224:227], a[140:143], v[220:223]
s_nop 7
v_cvt_pk_bf16_f32 v73, v222, v223
v_cvt_pk_bf16_f32 v72, v220, v221
v_mfma_f32_16x16x32_bf16 v[220:223], v[224:227], a[156:159], 0
v_mfma_f32_16x16x32_bf16 v[220:223], v[212:215], a[152:155], v[220:223]
v_mfma_f32_16x16x32_bf16 v[220:223], v[204:207], a[148:151], v[220:223]
s_waitcnt lgkmcnt(0)
v_max_f32 v254, v254, v255
v_mfma_f32_16x16x32_bf16 v[220:223], v[196:199], a[144:147], v[220:223]
ds_bpermute_b32 v255, v247, v254
s_nop 6
v_cvt_pk_bf16_f32 v76, v220, v221
v_cvt_pk_bf16_f32 v77, v222, v223
v_mfma_f32_16x16x32_bf16 v[220:223], v[196:199], a[160:163], 0
v_mfma_f32_16x16x32_bf16 v[220:223], v[204:207], a[164:167], v[220:223]
v_mfma_f32_16x16x32_bf16 v[220:223], v[212:215], a[168:171], v[220:223]
s_waitcnt lgkmcnt(0)
v_max_f32 v254, v254, v255
v_mfma_f32_16x16x32_bf16 v[220:223], v[224:227], a[172:175], v[220:223]
v_sub_f32 v184, v184, v254
v_exp_f32 v184, v184
v_sub_f32 v185, v185, v254
v_sub_f32 v187, v187, v254
v_exp_f32 v185, v185
s_nop 2
v_cvt_pk_bf16_f32 v81, v222, v223
v_cvt_pk_bf16_f32 v80, v220, v221
v_mfma_f32_16x16x32_bf16 v[220:223], v[224:227], a[188:191], 0
ds_read_b128 v[224:227], v236 offset:12672
v_add_f32 v249, v184, v185
v_mfma_f32_16x16x32_bf16 v[220:223], v[204:207], a[180:183], v[220:223]
ds_read_b128 v[204:207], v236 offset:12928
v_sub_f32 v186, v186, v254
v_mfma_f32_16x16x32_bf16 v[220:223], v[196:199], a[176:179], v[220:223]
ds_read_b128 v[196:199], v236 offset:13184
v_cvt_pk_bf16_f32 v136, v184, v185
v_mfma_f32_16x16x32_bf16 v[220:223], v[212:215], a[184:187], v[220:223]
ds_read_b128 v[212:215], v236 offset:13440
v_exp_f32 v186, v186
v_exp_f32 v187, v187
v_add_f32 v249, v249, v186
v_add_f32 v249, v249, v187
v_cvt_pk_bf16_f32 v137, v186, v187
v_sub_f32 v189, v189, v254
v_sub_f32 v188, v188, v254
v_cvt_pk_bf16_f32 v84, v220, v221
v_cvt_pk_bf16_f32 v85, v222, v223
v_exp_f32 v188, v188
v_exp_f32 v189, v189
v_sub_f32 v191, v191, v254
s_waitcnt lgkmcnt(1)
v_mfma_f32_16x16x32_bf16 v[184:187], v[196:199], a[184:187], 0
v_sub_f32 v190, v190, v254
s_waitcnt lgkmcnt(0)
v_mfma_f32_16x16x32_bf16 v[184:187], v[212:215], a[188:191], v[184:187]
v_exp_f32 v190, v190
v_mfma_f32_16x16x32_bf16 v[184:187], v[204:207], a[180:183], v[184:187]
v_exp_f32 v191, v191
v_mfma_f32_16x16x32_bf16 v[184:187], v[224:227], a[176:179], v[184:187]
v_add_f32 v249, v249, v188
v_add_f32 v249, v249, v189
v_mfma_f32_16x16x32_bf16 v[220:223], v[224:227], a[160:163], 0
v_add_f32 v249, v249, v190
v_cvt_pk_bf16_f32 v139, v190, v191
v_mfma_f32_16x16x32_bf16 v[220:223], v[204:207], a[164:167], v[220:223]
v_cvt_pk_bf16_f32 v138, v188, v189
v_add_f32 v249, v249, v191
v_mfma_f32_16x16x32_bf16 v[220:223], v[196:199], a[168:171], v[220:223]
v_cvt_pk_bf16_f32 v86, v184, v185
v_cvt_pk_bf16_f32 v87, v186, v187
v_mfma_f32_16x16x32_bf16 v[220:223], v[212:215], a[172:175], v[220:223]
v_sub_f32 v192, v192, v254
v_sub_f32 v194, v194, v254
v_mfma_f32_16x16x32_bf16 v[184:187], v[212:215], a[156:159], 0
v_exp_f32 v192, v192
v_mfma_f32_16x16x32_bf16 v[184:187], v[196:199], a[152:155], v[184:187]
v_add_f32 v249, v249, v192
v_sub_f32 v193, v193, v254
v_mfma_f32_16x16x32_bf16 v[184:187], v[204:207], a[148:151], v[184:187]
v_cvt_pk_bf16_f32 v83, v222, v223
v_cvt_pk_bf16_f32 v82, v220, v221
v_mfma_f32_16x16x32_bf16 v[184:187], v[224:227], a[144:147], v[184:187]
v_exp_f32 v193, v193
v_mfma_f32_16x16x32_bf16 v[220:223], v[224:227], a[128:131], 0
ds_read_b128 v[224:227], v236 offset:16896
v_sub_f32 v209, v209, v254
v_mfma_f32_16x16x32_bf16 v[220:223], v[196:199], a[136:139], v[220:223]
ds_read_b128 v[196:199], v236 offset:17152
v_sub_f32 v208, v208, v254
v_mfma_f32_16x16x32_bf16 v[220:223], v[212:215], a[140:143], v[220:223]
ds_read_b128 v[212:215], v236 offset:17408
v_cvt_pk_bf16_f32 v79, v186, v187
v_mfma_f32_16x16x32_bf16 v[220:223], v[204:207], a[132:135], v[220:223]
ds_read_b128 v[204:207], v236 offset:17664
v_cvt_pk_bf16_f32 v78, v184, v185
v_exp_f32 v208, v208
v_exp_f32 v209, v209
v_exp_f32 v194, v194
v_add_f32 v249, v249, v193
v_add_f32 v249, v249, v194
v_sub_f32 v195, v195, v254
v_cvt_pk_bf16_f32 v74, v220, v221
v_cvt_pk_bf16_f32 v75, v222, v223
s_waitcnt lgkmcnt(2)
v_mfma_f32_16x16x32_bf16 v[184:187], v[196:199], a[132:135], 0
v_exp_f32 v195, v195
v_mfma_f32_16x16x32_bf16 v[184:187], v[224:227], a[128:131], v[184:187]
s_waitcnt lgkmcnt(1)
v_sub_f32 v216, v216, v254
v_sub_f32 v211, v211, v254
v_mfma_f32_16x16x32_bf16 v[184:187], v[212:215], a[136:139], v[184:187]
s_waitcnt lgkmcnt(0)
v_sub_f32 v210, v210, v254
v_add_f32 v249, v249, v195
v_mfma_f32_16x16x32_bf16 v[184:187], v[204:207], a[140:143], v[184:187]
v_exp_f32 v211, v211
v_mfma_f32_16x16x32_bf16 v[220:223], v[204:207], a[156:159], 0
v_exp_f32 v210, v210
v_mfma_f32_16x16x32_bf16 v[220:223], v[212:215], a[152:155], v[220:223]
v_add_f32 v249, v249, v208
v_sub_f32 v219, v219, v254
v_mfma_f32_16x16x32_bf16 v[220:223], v[196:199], a[148:151], v[220:223]
s_nop 0
v_cvt_pk_bf16_f32 v89, v186, v187
v_cvt_pk_bf16_f32 v88, v184, v185
v_mfma_f32_16x16x32_bf16 v[220:223], v[224:227], a[144:147], v[220:223]
v_exp_f32 v216, v216
v_mfma_f32_16x16x32_bf16 v[184:187], v[224:227], a[160:163], 0
v_sub_f32 v217, v217, v254
v_add_f32 v249, v249, v209
v_mfma_f32_16x16x32_bf16 v[184:187], v[196:199], a[164:167], v[184:187]
v_sub_f32 v228, v228, v254
v_add_f32 v249, v249, v210
v_mfma_f32_16x16x32_bf16 v[184:187], v[212:215], a[168:171], v[184:187]
v_exp_f32 v217, v217
v_mfma_f32_16x16x32_bf16 v[184:187], v[204:207], a[172:175], v[184:187]
v_sub_f32 v229, v229, v254
v_sub_f32 v218, v218, v254
v_mfma_f32_16x16x32_bf16 v[188:191], v[204:207], a[188:191], 0
v_exp_f32 v218, v218
v_mfma_f32_16x16x32_bf16 v[188:191], v[212:215], a[184:187], v[188:191]
v_add_f32 v249, v249, v211
v_add_f32 v249, v249, v216
v_mfma_f32_16x16x32_bf16 v[188:191], v[196:199], a[180:183], v[188:191]
v_cvt_pk_bf16_f32 v96, v184, v185
v_cvt_pk_bf16_f32 v97, v186, v187
v_mfma_f32_16x16x32_bf16 v[188:191], v[224:227], a[176:179], v[188:191]
v_exp_f32 v219, v219
v_mfma_f32_16x16x32_bf16 v[184:187], a[0:3], v[224:227], 0
v_add_f32 v249, v249, v217
v_add_f32 v249, v249, v218
v_mfma_f32_16x16x32_bf16 v[184:187], a[4:7], v[196:199], v[184:187]
v_add_f32 v249, v249, v219
v_cvt_pk_bf16_f32 v144, v216, v217
v_mfma_f32_16x16x32_bf16 v[184:187], a[8:11], v[212:215], v[184:187]
v_cvt_pk_bf16_f32 v100, v188, v189
v_cvt_pk_bf16_f32 v101, v190, v191
v_mfma_f32_16x16x32_bf16 v[184:187], a[12:15], v[204:207], v[184:187]
v_cvt_pk_bf16_f32 v145, v218, v219
v_cvt_pk_bf16_f32 v92, v220, v221
v_mfma_f32_16x16x32_bf16 v[188:191], a[28:31], v[204:207], 0
v_cvt_pk_bf16_f32 v93, v222, v223
v_sub_f32 v232, v232, v254
v_mfma_f32_16x16x32_bf16 v[188:191], a[24:27], v[212:215], v[188:191]
v_exp_f32 v228, v228
v_mfma_f32_16x16x32_bf16 v[188:191], a[20:23], v[196:199], v[188:191]
v_cvt_pk_bf16_f32 v112, v184, v185
v_cvt_pk_bf16_f32 v113, v186, v187
v_mfma_f32_16x16x32_bf16 v[188:191], a[16:19], v[224:227], v[188:191]
v_exp_f32 v229, v229
v_mfma_f32_16x16x32_bf16 v[184:187], a[32:35], v[224:227], 0
v_add_f32 v249, v249, v228
v_sub_f32 v231, v231, v254
v_mfma_f32_16x16x32_bf16 v[184:187], a[36:39], v[196:199], v[184:187]
v_exp_f32 v232, v232
v_mfma_f32_16x16x32_bf16 v[184:187], a[40:43], v[212:215], v[184:187]
s_nop 0
v_cvt_pk_bf16_f32 v115, v190, v191
v_cvt_pk_bf16_f32 v114, v188, v189
v_mfma_f32_16x16x32_bf16 v[184:187], a[44:47], v[204:207], v[184:187]
v_sub_f32 v230, v230, v254
v_add_f32 v249, v249, v229
v_mfma_f32_16x16x32_bf16 v[188:191], a[60:63], v[204:207], 0
v_cvt_pk_bf16_f32 v140, v192, v193
v_mov_b32 v192, v202
v_mfma_f32_16x16x32_bf16 v[188:191], a[56:59], v[212:215], v[188:191]
v_cvt_pk_bf16_f32 v142, v208, v209
v_mov_b32_dpp v209, v201 row_ror:8 row_mask:0xf bank_mask:0xf
v_mfma_f32_16x16x32_bf16 v[188:191], a[52:55], v[196:199], v[188:191]
v_cvt_pk_bf16_f32 v116, v184, v185
v_cvt_pk_bf16_f32 v117, v186, v187
v_mfma_f32_16x16x32_bf16 v[188:191], a[48:51], v[224:227], v[188:191]
v_mov_b32_dpp v208, v200 row_ror:8 row_mask:0xf bank_mask:0xf
v_cvt_pk_bf16_f32 v143, v210, v211
v_mfma_f32_16x16x32_bf16 v[216:219], v[56:59], v[120:123], 0
v_mov_b32_dpp v211, v201 row_ror:4 row_mask:0xf bank_mask:0xf
v_mov_b32_dpp v210, v200 row_ror:4 row_mask:0xf bank_mask:0xf
v_mfma_f32_16x16x32_bf16 v[216:219], v[104:107], v[132:135], v[216:219]
v_cvt_pk_bf16_f32 v141, v194, v195
v_mov_b32_dpp v194, v202 row_ror:12 row_mask:0xf bank_mask:0xf
v_mfma_f32_16x16x32_bf16 v[216:219], v[72:75], v[124:127], v[216:219]
v_cvt_pk_bf16_f32 v118, v188, v189
v_cvt_pk_bf16_f32 v119, v190, v191
v_mfma_f32_16x16x32_bf16 v[216:219], v[88:91], v[128:131], v[216:219]
v_mov_b32_dpp v195, v203 row_ror:12 row_mask:0xf bank_mask:0xf
v_mov_b32 v193, v203
v_mfma_f32_16x16x32_bf16 v[220:223], v[92:95], v[128:131], 0
v_mov_b32_dpp v203, v201 row_ror:12 row_mask:0xf bank_mask:0xf
v_mov_b32_dpp v202, v200 row_ror:12 row_mask:0xf bank_mask:0xf
v_mfma_f32_16x16x32_bf16 v[220:223], v[76:79], v[124:127], v[220:223]
v_exp_f32 v230, v230
v_mfma_f32_16x16x32_bf16 v[220:223], v[106:109], v[132:135], v[220:223]
v_fmac_f32 v154, v218, v251
v_fmac_f32 v152, v216, v251
v_mfma_f32_16x16x32_bf16 v[220:223], v[60:63], v[120:123], v[220:223]
v_fmac_f32 v155, v219, v251
v_fmac_f32 v153, v217, v251
v_mfma_f32_16x16x32_bf16 v[188:191], v[64:67], v[120:123], 0
v_exp_f32 v231, v231
v_mfma_f32_16x16x32_bf16 v[188:191], v[108:111], v[132:135], v[188:191]
v_add_f32 v249, v249, v230
v_add_f32 v249, v249, v231
v_mfma_f32_16x16x32_bf16 v[188:191], v[80:83], v[124:127], v[188:191]
v_cvt_pk_bf16_f32 v146, v228, v229
v_cvt_pk_bf16_f32 v147, v230, v231
v_mfma_f32_16x16x32_bf16 v[188:191], v[96:99], v[128:131], v[188:191]
v_add_f32 v249, v249, v232
v_fmac_f32 v156, v220, v251
v_mfma_f32_16x16x32_bf16 v[184:187], v[100:103], v[128:131], 0
ds_swizzle_b32 v250, v249 offset:0x401F
v_fmac_f32 v158, v222, v251
v_mfma_f32_16x16x32_bf16 v[184:187], v[84:87], v[124:127], v[184:187]
v_fmac_f32 v157, v221, v251
v_fmac_f32 v159, v223, v251
v_mfma_f32_16x16x32_bf16 v[184:187], v[68:71], v[120:123], v[184:187]
v_fmac_f32 v161, v189, v251
v_fmac_f32 v160, v188, v251
v_mfma_f32_16x16x32_bf16 v[184:187], v[110:113], v[132:135], v[184:187]
v_mov_b32_dpp v132, v192 row_ror:8 row_mask:0xf bank_mask:0xf
v_fmac_f32 v163, v191, v251
v_fmac_f32 v162, v190, v251
v_mfma_f32_16x16x32_bf16 v[216:219], v[110:113], v[132:135], 0
v_cvt_pk_bf16_f32 v152, v152, v153
v_cvt_pk_bf16_f32 v153, v154, v155
v_mfma_f32_16x16x32_bf16 v[216:219], v[84:87], v[208:211], v[216:219]
s_nop 0
v_fmac_f32 v167, v187, v251
v_fmac_f32 v164, v184, v251
v_mfma_f32_16x16x32_bf16 v[216:219], v[100:103], v[192:195], v[216:219]
s_waitcnt lgkmcnt(0)
v_fmac_f32 v165, v185, v251
v_fmac_f32 v166, v186, v251
v_mfma_f32_16x16x32_bf16 v[216:219], v[68:71], v[200:203], v[216:219]
v_add_f32 v249, v249, v250
v_pk_max_i16 v153, v153, 0
v_mfma_f32_16x16x32_bf16 v[188:191], v[64:67], v[200:203], 0
ds_bpermute_b32 v250, v247, v249
v_mfma_f32_16x16x32_bf16 v[188:191], v[80:83], v[208:211], v[188:191]
v_cvt_pk_bf16_f32 v160, v160, v161
v_cvt_pk_bf16_f32 v161, v162, v163
v_mfma_f32_16x16x32_bf16 v[188:191], v[96:99], v[192:195], v[188:191]
v_cvt_pk_bf16_f32 v216, v216, v217
v_cvt_pk_bf16_f32 v217, v218, v219
v_mfma_f32_16x16x32_bf16 v[188:191], v[108:111], v[132:135], v[188:191]
ds_write_b64 v246, v[216:217] offset:24
v_mfma_f32_16x16x32_bf16 v[228:231], v[106:109], v[132:135], 0
v_cvt_pk_bf16_f32 v162, v164, v165
v_pk_max_i16 v160, v160, 0
v_mfma_f32_16x16x32_bf16 v[228:231], v[76:79], v[208:211], v[228:231]
v_pk_max_i16 v161, v161, 0
v_cvt_pk_bf16_f32 v163, v166, v167
v_mfma_f32_16x16x32_bf16 v[228:231], v[92:95], v[192:195], v[228:231]
s_waitcnt lgkmcnt(1)
v_cvt_pk_bf16_f32 v188, v188, v189
v_cvt_pk_bf16_f32 v189, v190, v191
v_mfma_f32_16x16x32_bf16 v[228:231], v[60:63], v[200:203], v[228:231]
ds_write_b64 v246, v[188:189] offset:16
v_mfma_f32_16x16x32_bf16 v[184:187], v[56:59], v[200:203], 0
v_pk_max_i16 v163, v163, 0
v_cvt_pk_bf16_f32 v155, v158, v159
v_mfma_f32_16x16x32_bf16 v[184:187], v[72:75], v[208:211], v[184:187]
v_pk_max_i16 v162, v162, 0
v_cvt_pk_bf16_f32 v154, v156, v157
v_mfma_f32_16x16x32_bf16 v[184:187], v[88:91], v[192:195], v[184:187]
v_cvt_pk_bf16_f32 v228, v228, v229
v_cvt_pk_bf16_f32 v229, v230, v231
v_mfma_f32_16x16x32_bf16 v[184:187], v[104:107], v[132:135], v[184:187]
ds_write_b64 v246, v[228:229] offset:8
v_mfma_f32_16x16x32_bf16 v[188:191], v[0:3], v[112:115], 0
v_pk_max_i16 v154, v154, 0
v_pk_max_i16 v152, v152, 0
v_mfma_f32_16x16x32_bf16 v[188:191], v[4:7], v[116:119], v[188:191]
v_pk_max_i16 v155, v155, 0
v_add_f32 v249, v249, v250
v_mfma_f32_16x16x32_bf16 v[192:195], v[12:15], v[116:119], 0
buffer_store_dwordx4 v[152:155], v239, s[20:23], s52 offen offset:0 nt
buffer_store_dwordx4 v[160:163], v239, s[20:23], s52 offen offset:64 nt
v_cvt_pk_bf16_f32 v184, v184, v185
v_cvt_pk_bf16_f32 v185, v186, v187
v_rcp_f32 v252, v249
v_max3_f32 v254, v188, v189, v190
v_cvt_pk_bf16_f32 v148, v232, 0
s_add_u32 s52, s46, 16384
v_mfma_f32_16x16x32_bf16 v[192:195], v[8:11], v[112:115], v[192:195]
ds_write_b64 v246, v[184:185] offset:0
v_mfma_f32_16x16x32_bf16 v[200:203], v[16:19], v[112:115], 0
s_nop 0
v_add_u32 v246, 0x200, v246
s_nop 0
v_mfma_f32_16x16x32_bf16 v[200:203], v[20:23], v[116:119], v[200:203]
s_nop 1
v_max3_f32 v254, v254, v191, v192
v_mfma_f32_16x16x32_bf16 v[184:187], v[28:31], v[116:119], 0
v_max3_f32 v254, v254, v193, v194
s_nop 0
v_mfma_f32_16x16x32_bf16 v[184:187], v[24:27], v[112:115], v[184:187]
s_nop 0
v_max3_f32 v254, v254, v195, v200
v_max3_f32 v254, v254, v201, v202
v_mfma_f32_16x16x32_bf16 v[208:211], v[32:35], v[112:115], 0
s_nop 2
v_mfma_f32_16x16x32_bf16 v[208:211], v[36:39], v[116:119], v[208:211]
v_max3_f32 v254, v254, v203, v184
v_max3_f32 v254, v254, v185, v186
v_mfma_f32_16x16x32_bf16 v[216:219], v[44:47], v[116:119], 0
s_nop 2
v_mfma_f32_16x16x32_bf16 v[216:219], v[40:43], v[112:115], v[216:219]
s_nop 0
v_max3_f32 v254, v254, v187, v208
v_max3_f32 v254, v254, v209, v210
v_mfma_f32_16x16x32_bf16 v[220:223], v[48:51], v[112:115], 0
s_nop 2
v_mfma_f32_16x16x32_bf16 v[220:223], v[52:55], v[116:119], v[220:223]
v_max3_f32 v254, v254, v211, v216
v_max3_f32 v254, v254, v217, v218
v_mfma_f32_16x16x32_bf16 v[152:155], a[192:195], v[224:227], 0
s_nop 2
v_mfma_f32_16x16x32_bf16 v[152:155], a[196:199], v[196:199], v[152:155]
s_nop 0
v_max3_f32 v254, v254, v219, v220
v_mfma_f32_16x16x32_bf16 v[152:155], a[200:203], v[212:215], v[152:155]
ds_swizzle_b32 v255, v254 offset:0x401F
v_mfma_f32_16x16x32_bf16 v[152:155], a[204:207], v[204:207], v[152:155]
v_mfma_f32_16x16x32_bf16 v[156:159], a[220:223], v[204:207], 0
v_mfma_f32_16x16x32_bf16 v[156:159], a[216:219], v[212:215], v[156:159]
v_mfma_f32_16x16x32_bf16 v[156:159], a[212:215], v[196:199], v[156:159]
v_mfma_f32_16x16x32_bf16 v[156:159], a[208:211], v[224:227], v[156:159]
v_mfma_f32_16x16x32_bf16 v[160:163], a[224:227], v[224:227], 0
s_waitcnt lgkmcnt(0)
v_max_f32 v254, v254, v255
v_mfma_f32_16x16x32_bf16 v[160:163], a[228:231], v[196:199], v[160:163]
ds_bpermute_b32 v255, v247, v254
v_mfma_f32_16x16x32_bf16 v[160:163], a[232:235], v[212:215], v[160:163]
v_mfma_f32_16x16x32_bf16 v[160:163], a[236:239], v[204:207], v[160:163]
v_mfma_f32_16x16x32_bf16 v[164:167], a[252:255], v[204:207], 0
v_mfma_f32_16x16x32_bf16 v[164:167], a[248:251], v[212:215], v[164:167]
v_mfma_f32_16x16x32_bf16 v[164:167], a[244:247], v[196:199], v[164:167]
v_mfma_f32_16x16x32_bf16 v[164:167], a[240:243], v[224:227], v[164:167]
s_waitcnt lgkmcnt(0)
v_max_f32 v254, v254, v255
v_sub_f32 v188, v188, v254
v_mfma_f32_16x16x32_bf16 v[196:199], v[56:59], v[136:139], 0
v_sub_f32 v190, v190, v254
v_sub_f32 v189, v189, v254
v_mfma_f32_16x16x32_bf16 v[196:199], v[104:107], v[148:151], v[196:199]
v_exp_f32 v189, v189
v_mfma_f32_16x16x32_bf16 v[196:199], v[72:75], v[140:143], v[196:199]
v_exp_f32 v188, v188
v_mfma_f32_16x16x32_bf16 v[196:199], v[88:91], v[144:147], v[196:199]
v_add_f32 v248, v188, v189
v_sub_f32 v191, v191, v254
v_mfma_f32_16x16x32_bf16 v[204:207], v[92:95], v[144:147], 0
v_exp_f32 v191, v191
v_mfma_f32_16x16x32_bf16 v[204:207], v[76:79], v[140:143], v[204:207]
v_exp_f32 v190, v190
v_mfma_f32_16x16x32_bf16 v[204:207], v[106:109], v[148:151], v[204:207]
v_cvt_pk_bf16_f32 v120, v188, v189
v_add_f32 v248, v248, v190
v_mfma_f32_16x16x32_bf16 v[204:207], v[60:63], v[136:139], v[204:207]
ds_read_b128 v[212:215], v236 offset:4224
v_add_f32 v248, v248, v191
v_mfma_f32_16x16x32_bf16 v[228:231], v[64:67], v[136:139], 0
ds_read_b128 v[224:227], v236 offset:4480
v_cvt_pk_bf16_f32 v121, v190, v191
v_mfma_f32_16x16x32_bf16 v[228:231], v[108:111], v[148:151], v[228:231]
v_fmac_f32 v170, v198, v252
v_fmac_f32 v171, v199, v252
v_mfma_f32_16x16x32_bf16 v[228:231], v[80:83], v[140:143], v[228:231]
v_fmac_f32 v168, v196, v252
v_fmac_f32 v169, v197, v252
v_mfma_f32_16x16x32_bf16 v[228:231], v[96:99], v[144:147], v[228:231]
ds_read_b128 v[196:199], v236 offset:4736
v_fmac_f32 v175, v207, v252
v_mfma_f32_16x16x32_bf16 v[232:235], v[100:103], v[144:147], 0
v_fmac_f32 v172, v204, v252
v_fmac_f32 v174, v206, v252
v_mfma_f32_16x16x32_bf16 v[232:235], v[84:87], v[140:143], v[232:235]
s_waitcnt lgkmcnt(2)
v_fmac_f32 v173, v205, v252
v_fmac_f32 v177, v229, v252
v_mfma_f32_16x16x32_bf16 v[232:235], v[110:113], v[148:151], v[232:235]
s_waitcnt lgkmcnt(1)
ds_read_b128 v[204:207], v236 offset:4992
v_fmac_f32 v176, v228, v252
v_mfma_f32_16x16x32_bf16 v[232:235], v[68:71], v[136:139], v[232:235]
v_fmac_f32 v178, v230, v252
v_fmac_f32 v179, v231, v252
v_mfma_f32_16x16x32_bf16 v[188:191], a[0:3], v[212:215], 0
v_cvt_pk_bf16_f32 v176, v176, v177
v_cvt_pk_bf16_f32 v168, v168, v169
v_mfma_f32_16x16x32_bf16 v[188:191], a[4:7], v[224:227], v[188:191]
s_waitcnt lgkmcnt(1)
v_cvt_pk_bf16_f32 v169, v170, v171
v_fmac_f32 v181, v233, v252
v_mfma_f32_16x16x32_bf16 v[188:191], a[8:11], v[196:199], v[188:191]
v_fmac_f32 v182, v234, v252
v_fmac_f32 v180, v232, v252
v_fmac_f32 v183, v235, v252
v_cvt_pk_bf16_f32 v170, v172, v173
v_pk_max_i16 v170, v170, 0
s_waitcnt lgkmcnt(0)
v_mfma_f32_16x16x32_bf16 v[188:191], a[12:15], v[204:207], v[188:191]
v_cvt_pk_bf16_f32 v171, v174, v175
v_pk_max_i16 v176, v176, 0
v_mfma_f32_16x16x32_bf16 v[232:235], a[28:31], v[204:207], 0
v_pk_max_i16 v171, v171, 0
v_cvt_pk_bf16_f32 v177, v178, v179
v_mfma_f32_16x16x32_bf16 v[232:235], a[24:27], v[196:199], v[232:235]
v_cvt_pk_bf16_f32 v178, v180, v181
v_pk_max_i16 v177, v177, 0
v_mfma_f32_16x16x32_bf16 v[232:235], a[20:23], v[224:227], v[232:235]
v_cvt_pk_bf16_f32 v112, v188, v189
v_cvt_pk_bf16_f32 v113, v190, v191
v_mfma_f32_16x16x32_bf16 v[232:235], a[16:19], v[212:215], v[232:235]
v_pk_max_i16 v168, v168, 0
v_cvt_pk_bf16_f32 v179, v182, v183
v_mfma_f32_16x16x32_bf16 v[188:191], a[32:35], v[212:215], 0
v_pk_max_i16 v179, v179, 0
v_pk_max_i16 v169, v169, 0
v_mfma_f32_16x16x32_bf16 v[188:191], a[36:39], v[224:227], v[188:191]
v_pk_max_i16 v178, v178, 0
v_sub_f32 v192, v192, v254
v_mfma_f32_16x16x32_bf16 v[188:191], a[40:43], v[196:199], v[188:191]
buffer_store_dwordx4 v[168:171], v239, s[20:23], s53 offen offset:0 nt
buffer_store_dwordx4 v[176:179], v239, s[20:23], s53 offen offset:64 nt
v_sub_f32 v193, v193, v254
v_exp_f32 v192, v192
v_exp_f32 v193, v193
v_sub_f32 v195, v195, v254
v_exp_f32 v195, v195
v_mfma_f32_16x16x32_bf16 v[188:191], a[44:47], v[204:207], v[188:191]
s_add_u32 s53, s46, 4096
v_add_f32 v248, v248, v192
v_sub_f32 v194, v194, v254
v_mfma_f32_16x16x32_bf16 v[228:231], a[60:63], v[204:207], 0
s_add_u32 s46, s46, 13107200
v_cvt_pk_bf16_f32 v114, v232, v233
v_cvt_pk_bf16_f32 v115, v234, v235
v_mfma_f32_16x16x32_bf16 v[228:231], a[56:59], v[196:199], v[228:231]
v_cvt_pk_bf16_f32 v117, v190, v191
v_cvt_pk_bf16_f32 v116, v188, v189
v_mfma_f32_16x16x32_bf16 v[228:231], a[52:55], v[224:227], v[228:231]
v_exp_f32 v194, v194
v_mfma_f32_16x16x32_bf16 v[228:231], a[48:51], v[212:215], v[228:231]
v_add_f32 v248, v248, v193
v_add_f32 v248, v248, v194
v_mfma_f32_16x16x32_bf16 v[168:171], a[192:195], v[212:215], 0
v_add_f32 v248, v248, v195
v_cvt_pk_bf16_f32 v122, v192, v193
v_mfma_f32_16x16x32_bf16 v[168:171], a[196:199], v[224:227], v[168:171]
v_cvt_pk_bf16_f32 v123, v194, v195
v_sub_f32 v201, v201, v254
v_mfma_f32_16x16x32_bf16 v[168:171], a[200:203], v[196:199], v[168:171]
v_cvt_pk_bf16_f32 v119, v230, v231
v_cvt_pk_bf16_f32 v118, v228, v229
v_mfma_f32_16x16x32_bf16 v[168:171], a[204:207], v[204:207], v[168:171]
v_sub_f32 v202, v202, v254
v_sub_f32 v200, v200, v254
v_mfma_f32_16x16x32_bf16 v[172:175], a[220:223], v[204:207], 0
v_exp_f32 v200, v200
v_mfma_f32_16x16x32_bf16 v[172:175], a[216:219], v[196:199], v[172:175]
v_exp_f32 v202, v202
v_mfma_f32_16x16x32_bf16 v[172:175], a[212:215], v[224:227], v[172:175]
v_exp_f32 v201, v201
v_mfma_f32_16x16x32_bf16 v[172:175], a[208:211], v[212:215], v[172:175]
v_sub_f32 v203, v203, v254
v_add_f32 v248, v248, v200
v_mfma_f32_16x16x32_bf16 v[176:179], a[224:227], v[212:215], 0
v_exp_f32 v203, v203
v_mfma_f32_16x16x32_bf16 v[176:179], a[228:231], v[224:227], v[176:179]
v_cvt_pk_bf16_f32 v125, v202, v203
v_add_f32 v248, v248, v201
v_mfma_f32_16x16x32_bf16 v[176:179], a[232:235], v[196:199], v[176:179]
v_add_f32 v248, v248, v202
v_cvt_pk_bf16_f32 v124, v200, v201
v_mfma_f32_16x16x32_bf16 v[176:179], a[236:239], v[204:207], v[176:179]
v_add_f32 v248, v248, v203
v_sub_f32 v184, v184, v254
v_mfma_f32_16x16x32_bf16 v[180:183], a[252:255], v[204:207], 0
v_sub_f32 v185, v185, v254
v_sub_f32 v187, v187, v254
v_mfma_f32_16x16x32_bf16 v[180:183], a[248:251], v[196:199], v[180:183]
v_sub_f32 v186, v186, v254
v_sub_f32 v220, v220, v254
v_mfma_f32_16x16x32_bf16 v[180:183], a[244:247], v[224:227], v[180:183]
v_exp_f32 v184, v184
v_mfma_f32_16x16x32_bf16 v[180:183], a[240:243], v[212:215], v[180:183]
v_add_f32 v248, v248, v184
v_sub_f32 v216, v216, v254
v_mfma_f32_16x16x32_bf16 v[188:191], v[0:3], v[112:115], 0
v_exp_f32 v187, v187
v_mfma_f32_16x16x32_bf16 v[188:191], v[4:7], v[116:119], v[188:191]
v_exp_f32 v186, v186
v_mfma_f32_16x16x32_bf16 v[192:195], v[12:15], v[116:119], 0
v_exp_f32 v185, v185
v_mfma_f32_16x16x32_bf16 v[192:195], v[8:11], v[112:115], v[192:195]
v_add_f32 v248, v248, v185
v_add_f32 v248, v248, v186
v_mfma_f32_16x16x32_bf16 v[196:199], v[16:19], v[112:115], 0
v_add_f32 v248, v248, v187
v_cvt_pk_bf16_f32 v127, v186, v187
v_mfma_f32_16x16x32_bf16 v[196:199], v[20:23], v[116:119], v[196:199]
v_cvt_pk_bf16_f32 v126, v184, v185
v_sub_f32 v218, v218, v254
v_mfma_f32_16x16x32_bf16 v[200:203], v[28:31], v[116:119], 0
v_exp_f32 v220, v220
v_mfma_f32_16x16x32_bf16 v[200:203], v[24:27], v[112:115], v[200:203]
v_cvt_pk_bf16_f32 v132, v220, 0
v_sub_f32 v217, v217, v254
v_mfma_f32_16x16x32_bf16 v[204:207], v[32:35], v[112:115], 0
v_sub_f32 v211, v211, v254
v_sub_f32 v210, v210, v254
v_mfma_f32_16x16x32_bf16 v[204:207], v[36:39], v[116:119], v[204:207]
v_sub_f32 v219, v219, v254
v_sub_f32 v208, v208, v254
v_mfma_f32_16x16x32_bf16 v[212:215], v[44:47], v[116:119], 0
v_sub_f32 v209, v209, v254
v_max3_f32 v254, v188, v189, v190
v_mfma_f32_16x16x32_bf16 v[212:215], v[40:43], v[112:115], v[212:215]
v_exp_f32 v209, v209
v_mfma_f32_16x16x32_bf16 v[224:227], v[48:51], v[112:115], 0
v_exp_f32 v208, v208
v_mfma_f32_16x16x32_bf16 v[224:227], v[52:55], v[116:119], v[224:227]
v_exp_f32 v217, v217
v_mfma_f32_16x16x32_bf16 v[184:187], v[56:59], v[120:123], 0
v_exp_f32 v210, v210
v_mfma_f32_16x16x32_bf16 v[184:187], v[104:107], v[132:135], v[184:187]
v_exp_f32 v218, v218
v_mfma_f32_16x16x32_bf16 v[184:187], v[72:75], v[124:127], v[184:187]
v_exp_f32 v211, v211
v_exp_f32 v216, v216
v_exp_f32 v219, v219
v_cvt_pk_bf16_f32 v129, v210, v211
v_cvt_pk_bf16_f32 v131, v218, v219
v_cvt_pk_bf16_f32 v130, v216, v217
v_cvt_pk_bf16_f32 v128, v208, v209
v_add_f32 v248, v248, v208
v_add_f32 v248, v248, v209
v_mfma_f32_16x16x32_bf16 v[184:187], v[88:91], v[128:131], v[184:187]
v_add_f32 v248, v248, v210
v_add_f32 v248, v248, v211
v_mfma_f32_16x16x32_bf16 v[208:211], v[92:95], v[128:131], 0
v_max3_f32 v254, v254, v191, v192
v_max3_f32 v254, v254, v193, v194
v_mfma_f32_16x16x32_bf16 v[208:211], v[76:79], v[124:127], v[208:211]
v_max3_f32 v254, v254, v195, v196
v_max3_f32 v254, v254, v197, v198
v_mfma_f32_16x16x32_bf16 v[208:211], v[106:109], v[132:135], v[208:211]
v_max3_f32 v254, v254, v199, v200
v_max3_f32 v254, v254, v201, v202
v_mfma_f32_16x16x32_bf16 v[208:211], v[60:63], v[120:123], v[208:211]
v_max3_f32 v254, v254, v203, v204
v_max3_f32 v254, v254, v205, v206
v_mfma_f32_16x16x32_bf16 v[228:231], v[64:67], v[120:123], 0
v_max3_f32 v254, v254, v207, v212
v_max3_f32 v254, v254, v213, v214
v_mfma_f32_16x16x32_bf16 v[228:231], v[108:111], v[132:135], v[228:231]
v_max3_f32 v254, v254, v215, v224
v_add_f32 v248, v248, v216
v_mfma_f32_16x16x32_bf16 v[228:231], v[80:83], v[124:127], v[228:231]
ds_swizzle_b32 v255, v254 offset:0x401F
v_add_f32 v248, v248, v217
v_mfma_f32_16x16x32_bf16 v[228:231], v[96:99], v[128:131], v[228:231]
v_add_f32 v248, v248, v218
v_add_f32 v248, v248, v219
v_mfma_f32_16x16x32_bf16 v[232:235], v[100:103], v[128:131], 0
ds_read_b128 v[216:219], v236 offset:8448
v_add_f32 v248, v248, v220
v_mfma_f32_16x16x32_bf16 v[232:235], v[84:87], v[124:127], v[232:235]
ds_read_b128 v[220:223], v236 offset:8704
ds_swizzle_b32 v250, v248 offset:0x401F
v_mfma_f32_16x16x32_bf16 v[232:235], v[110:113], v[132:135], v[232:235]
v_mfma_f32_16x16x32_bf16 v[232:235], v[68:71], v[120:123], v[232:235]
s_waitcnt lgkmcnt(3)
v_max_f32 v254, v254, v255
ds_bpermute_b32 v255, v247, v254
s_waitcnt lgkmcnt(1)
v_add_f32 v248, v248, v250
ds_bpermute_b32 v250, v247, v248
s_waitcnt lgkmcnt(1)
v_max_f32 v254, v254, v255
v_sub_f32 v188, v188, v254
v_exp_f32 v188, v188
v_sub_f32 v189, v189, v254
v_sub_f32 v190, v190, v254
v_sub_f32 v191, v191, v254
v_exp_f32 v189, v189
v_exp_f32 v191, v191
v_exp_f32 v190, v190
v_add_f32 v249, v188, v189
v_add_f32 v249, v249, v190
v_add_f32 v249, v249, v191
v_cvt_pk_bf16_f32 v137, v190, v191
v_cvt_pk_bf16_f32 v136, v188, v189
v_mfma_f32_16x16x32_bf16 v[188:191], a[0:3], v[216:219], 0
s_waitcnt lgkmcnt(0)
v_sub_f32 v192, v192, v254
v_sub_f32 v195, v195, v254
v_mfma_f32_16x16x32_bf16 v[188:191], a[4:7], v[220:223], v[188:191]
v_exp_f32 v192, v192
v_sub_f32 v193, v193, v254
v_sub_f32 v194, v194, v254
v_exp_f32 v195, v195
v_exp_f32 v193, v193
v_exp_f32 v194, v194
v_add_f32 v249, v249, v192
v_add_f32 v249, v249, v193
v_add_f32 v249, v249, v194
v_add_f32 v249, v249, v195
v_cvt_pk_bf16_f32 v139, v194, v195
v_cvt_pk_bf16_f32 v138, v192, v193
ds_read_b128 v[192:195], v236 offset:8960
v_sub_f32 v198, v198, v254
v_sub_f32 v197, v197, v254
v_sub_f32 v196, v196, v254
v_exp_f32 v196, v196
v_exp_f32 v198, v198
v_sub_f32 v202, v202, v254
v_sub_f32 v200, v200, v254
v_exp_f32 v197, v197
v_sub_f32 v201, v201, v254
v_sub_f32 v199, v199, v254
v_exp_f32 v199, v199
v_exp_f32 v200, v200
v_add_f32 v249, v249, v196
v_add_f32 v249, v249, v197
v_add_f32 v249, v249, v198
s_waitcnt lgkmcnt(0)
v_mfma_f32_16x16x32_bf16 v[188:191], a[8:11], v[192:195], v[188:191]
v_sub_f32 v203, v203, v254
v_add_f32 v249, v249, v199
v_add_f32 v249, v249, v200
v_exp_f32 v201, v201
v_exp_f32 v202, v202
v_exp_f32 v203, v203
v_sub_f32 v204, v204, v254
v_exp_f32 v204, v204
v_add_f32 v249, v249, v201
v_add_f32 v249, v249, v202
v_add_f32 v249, v249, v203
v_sub_f32 v205, v205, v254
v_sub_f32 v206, v206, v254
v_exp_f32 v205, v205
v_exp_f32 v206, v206
v_add_f32 v249, v249, v204
v_add_f32 v249, v249, v205
v_sub_f32 v207, v207, v254
v_exp_f32 v207, v207
v_add_f32 v249, v249, v206
v_add_f32 v249, v249, v207
v_cvt_pk_bf16_f32 v145, v206, v207
v_cvt_pk_bf16_f32 v144, v204, v205
ds_read_b128 v[204:207], v236 offset:9216
v_add_f32 v248, v248, v250
v_rcp_f32 v251, v248
v_sub_f32 v212, v212, v254
v_fmac_f32 v152, v184, v251
v_fmac_f32 v153, v185, v251
v_fmac_f32 v155, v187, v251
v_fmac_f32 v154, v186, v251
v_fmac_f32 v157, v209, v251
v_fmac_f32 v159, v211, v251
v_fmac_f32 v158, v210, v251
v_fmac_f32 v156, v208, v251
v_exp_f32 v212, v212
v_sub_f32 v213, v213, v254
v_exp_f32 v213, v213
v_sub_f32 v214, v214, v254
v_exp_f32 v214, v214
s_waitcnt lgkmcnt(0)
v_mfma_f32_16x16x32_bf16 v[188:191], a[12:15], v[204:207], v[188:191]
v_sub_f32 v215, v215, v254
v_add_f32 v249, v249, v212
v_mfma_f32_16x16x32_bf16 v[184:187], a[28:31], v[204:207], 0
v_exp_f32 v215, v215
v_mfma_f32_16x16x32_bf16 v[184:187], a[24:27], v[192:195], v[184:187]
v_add_f32 v249, v249, v213
v_add_f32 v249, v249, v214
v_mfma_f32_16x16x32_bf16 v[184:187], a[20:23], v[220:223], v[184:187]
v_add_f32 v249, v249, v215
v_cvt_pk_bf16_f32 v147, v214, v215
v_mfma_f32_16x16x32_bf16 v[184:187], a[16:19], v[216:219], v[184:187]
v_cvt_pk_bf16_f32 v146, v212, v213
v_fmac_f32 v163, v231, v251
v_mfma_f32_16x16x32_bf16 v[208:211], a[32:35], v[216:219], 0
v_fmac_f32 v161, v229, v251
v_cvt_pk_bf16_f32 v152, v152, v153
v_mfma_f32_16x16x32_bf16 v[208:211], a[36:39], v[220:223], v[208:211]
v_fmac_f32 v167, v235, v251
v_fmac_f32 v160, v228, v251
v_mfma_f32_16x16x32_bf16 v[208:211], a[40:43], v[192:195], v[208:211]
v_fmac_f32 v164, v232, v251
v_cvt_pk_bf16_f32 v160, v160, v161
v_mfma_f32_16x16x32_bf16 v[208:211], a[44:47], v[204:207], v[208:211]
v_cvt_pk_bf16_f32 v153, v154, v155
v_cvt_pk_bf16_f32 v154, v156, v157
v_mfma_f32_16x16x32_bf16 v[212:215], a[60:63], v[204:207], 0
v_fmac_f32 v166, v234, v251
v_fmac_f32 v162, v230, v251
v_mfma_f32_16x16x32_bf16 v[212:215], a[56:59], v[192:195], v[212:215]
v_fmac_f32 v165, v233, v251
v_cvt_pk_bf16_f32 v155, v158, v159
v_mfma_f32_16x16x32_bf16 v[212:215], a[52:55], v[220:223], v[212:215]
v_cvt_pk_bf16_f32 v161, v162, v163
v_cvt_pk_bf16_f32 v162, v164, v165
v_mfma_f32_16x16x32_bf16 v[212:215], a[48:51], v[216:219], v[212:215]
v_cvt_pk_bf16_f32 v163, v166, v167
v_pk_max_i16 v162, v162, 0
v_pk_max_i16 v161, v161, 0
v_pk_max_i16 v163, v163, 0
v_pk_max_i16 v153, v153, 0
v_pk_max_i16 v155, v155, 0
v_pk_max_i16 v152, v152, 0
v_pk_max_i16 v160, v160, 0
v_pk_max_i16 v154, v154, 0
buffer_store_dwordx4 v[152:155], v239, s[20:23], s52 offen offset:0 nt
buffer_store_dwordx4 v[160:163], v239, s[20:23], s52 offen offset:64 nt
v_cvt_pk_bf16_f32 v112, v188, v189
v_cvt_pk_bf16_f32 v113, v190, v191
v_cvt_pk_bf16_f32 v114, v184, v185
v_cvt_pk_bf16_f32 v115, v186, v187
v_cvt_pk_bf16_f32 v118, v212, v213
v_cvt_pk_bf16_f32 v119, v214, v215
v_cvt_pk_bf16_f32 v116, v208, v209
v_cvt_pk_bf16_f32 v117, v210, v211
v_mfma_f32_16x16x32_bf16 v[152:155], a[192:195], v[216:219], 0
v_sub_f32 v224, v224, v254
v_cvt_pk_bf16_f32 v142, v200, v201
v_mfma_f32_16x16x32_bf16 v[152:155], a[196:199], v[220:223], v[152:155]
v_exp_f32 v224, v224
v_mfma_f32_16x16x32_bf16 v[152:155], a[200:203], v[192:195], v[152:155]
v_cvt_pk_bf16_f32 v141, v198, v199
v_cvt_pk_bf16_f32 v140, v196, v197
v_mfma_f32_16x16x32_bf16 v[152:155], a[204:207], v[204:207], v[152:155]
v_add_f32 v249, v249, v224
v_cvt_pk_bf16_f32 v143, v202, v203
v_mfma_f32_16x16x32_bf16 v[156:159], a[220:223], v[204:207], 0
ds_swizzle_b32 v250, v249 offset:0x401F
v_cvt_pk_bf16_f32 v148, v224, 0
v_mfma_f32_16x16x32_bf16 v[156:159], a[216:219], v[192:195], v[156:159]
v_mfma_f32_16x16x32_bf16 v[156:159], a[212:215], v[220:223], v[156:159]
v_mfma_f32_16x16x32_bf16 v[156:159], a[208:211], v[216:219], v[156:159]
v_mfma_f32_16x16x32_bf16 v[160:163], a[224:227], v[216:219], 0
v_mfma_f32_16x16x32_bf16 v[160:163], a[228:231], v[220:223], v[160:163]
v_mfma_f32_16x16x32_bf16 v[160:163], a[232:235], v[192:195], v[160:163]
s_waitcnt lgkmcnt(0)
v_add_f32 v249, v249, v250
v_mfma_f32_16x16x32_bf16 v[160:163], a[236:239], v[204:207], v[160:163]
ds_bpermute_b32 v250, v247, v249
v_mfma_f32_16x16x32_bf16 v[164:167], a[252:255], v[204:207], 0
v_mfma_f32_16x16x32_bf16 v[164:167], a[248:251], v[192:195], v[164:167]
v_mfma_f32_16x16x32_bf16 v[164:167], a[244:247], v[220:223], v[164:167]
v_mfma_f32_16x16x32_bf16 v[164:167], a[240:243], v[216:219], v[164:167]
v_mfma_f32_16x16x32_bf16 v[184:187], v[0:3], v[112:115], 0
v_mfma_f32_16x16x32_bf16 v[184:187], v[4:7], v[116:119], v[184:187]
s_waitcnt lgkmcnt(0)
v_add_f32 v249, v249, v250
s_nop 0
v_mfma_f32_16x16x32_bf16 v[188:191], v[12:15], v[116:119], 0
v_rcp_f32 v252, v249
v_mfma_f32_16x16x32_bf16 v[188:191], v[8:11], v[112:115], v[188:191]
s_nop 1
v_max3_f32 v254, v184, v185, v186
v_mfma_f32_16x16x32_bf16 v[192:195], v[16:19], v[112:115], 0
s_nop 2
v_mfma_f32_16x16x32_bf16 v[192:195], v[20:23], v[116:119], v[192:195]
v_max3_f32 v254, v254, v187, v188
v_max3_f32 v254, v254, v189, v190
v_mfma_f32_16x16x32_bf16 v[196:199], v[28:31], v[116:119], 0
s_nop 2
v_mfma_f32_16x16x32_bf16 v[196:199], v[24:27], v[112:115], v[196:199]
s_nop 0
v_max3_f32 v254, v254, v191, v192
v_max3_f32 v254, v254, v193, v194
v_mfma_f32_16x16x32_bf16 v[200:203], v[32:35], v[112:115], 0
s_nop 2
v_mfma_f32_16x16x32_bf16 v[200:203], v[36:39], v[116:119], v[200:203]
v_max3_f32 v254, v254, v195, v196
v_max3_f32 v254, v254, v197, v198
v_mfma_f32_16x16x32_bf16 v[204:207], v[44:47], v[116:119], 0
s_nop 2
v_mfma_f32_16x16x32_bf16 v[204:207], v[40:43], v[112:115], v[204:207]
s_nop 0
v_max3_f32 v254, v254, v199, v200
v_max3_f32 v254, v254, v201, v202
v_mfma_f32_16x16x32_bf16 v[208:211], v[48:51], v[112:115], 0
s_nop 2
v_mfma_f32_16x16x32_bf16 v[208:211], v[52:55], v[116:119], v[208:211]
v_max3_f32 v254, v254, v203, v204
v_max3_f32 v254, v254, v205, v206
v_mfma_f32_16x16x32_bf16 v[212:215], v[56:59], v[136:139], 0
s_nop 2
v_mfma_f32_16x16x32_bf16 v[212:215], v[104:107], v[148:151], v[212:215]
s_nop 0
v_max3_f32 v254, v254, v207, v208
v_mfma_f32_16x16x32_bf16 v[212:215], v[72:75], v[140:143], v[212:215]
ds_swizzle_b32 v255, v254 offset:0x401F
v_mfma_f32_16x16x32_bf16 v[212:215], v[88:91], v[144:147], v[212:215]
s_nop 2
v_mfma_f32_16x16x32_bf16 v[216:219], v[92:95], v[144:147], 0
s_nop 2
v_mfma_f32_16x16x32_bf16 v[216:219], v[76:79], v[140:143], v[216:219]
v_fmac_f32 v169, v213, v252
v_fmac_f32 v168, v212, v252
v_mfma_f32_16x16x32_bf16 v[216:219], v[106:109], v[148:151], v[216:219]
v_fmac_f32 v171, v215, v252
v_fmac_f32 v170, v214, v252
v_mfma_f32_16x16x32_bf16 v[216:219], v[60:63], v[136:139], v[216:219]
ds_read_b128 v[220:223], v236 offset:12672
ds_read_b128 v[224:227], v236 offset:12928
v_mfma_f32_16x16x32_bf16 v[228:231], v[64:67], v[136:139], 0
s_waitcnt lgkmcnt(2)
ds_read_b128 v[212:215], v236 offset:13184
v_cvt_pk_bf16_f32 v168, v168, v169
v_mfma_f32_16x16x32_bf16 v[228:231], v[108:111], v[148:151], v[228:231]
s_nop 0
v_fmac_f32 v172, v216, v252
v_fmac_f32 v174, v218, v252
v_mfma_f32_16x16x32_bf16 v[228:231], v[80:83], v[140:143], v[228:231]
v_fmac_f32 v173, v217, v252
v_fmac_f32 v175, v219, v252
v_mfma_f32_16x16x32_bf16 v[228:231], v[96:99], v[144:147], v[228:231]
ds_read_b128 v[216:219], v236 offset:13440
v_cvt_pk_bf16_f32 v169, v170, v171
v_mfma_f32_16x16x32_bf16 v[232:235], v[100:103], v[144:147], 0
v_cvt_pk_bf16_f32 v170, v172, v173
v_cvt_pk_bf16_f32 v171, v174, v175
v_mfma_f32_16x16x32_bf16 v[232:235], v[84:87], v[140:143], v[232:235]
s_waitcnt lgkmcnt(2)
v_pk_max_i16 v170, v170, 0
v_fmac_f32 v178, v230, v252
v_mfma_f32_16x16x32_bf16 v[232:235], v[110:113], v[148:151], v[232:235]
s_waitcnt lgkmcnt(1)
v_fmac_f32 v179, v231, v252
v_fmac_f32 v176, v228, v252
v_mfma_f32_16x16x32_bf16 v[232:235], v[68:71], v[136:139], v[232:235]
v_fmac_f32 v177, v229, v252
v_cvt_pk_bf16_f32 v176, v176, v177
v_mfma_f32_16x16x32_bf16 v[228:231], a[0:3], v[220:223], 0
v_cvt_pk_bf16_f32 v177, v178, v179
v_pk_max_i16 v169, v169, 0
v_mfma_f32_16x16x32_bf16 v[228:231], a[4:7], v[224:227], v[228:231]
s_waitcnt lgkmcnt(0)
v_pk_max_i16 v171, v171, 0
v_fmac_f32 v182, v234, v252
v_mfma_f32_16x16x32_bf16 v[228:231], a[8:11], v[212:215], v[228:231]
v_fmac_f32 v181, v233, v252
v_fmac_f32 v183, v235, v252
v_mfma_f32_16x16x32_bf16 v[228:231], a[12:15], v[216:219], v[228:231]
v_fmac_f32 v180, v232, v252
v_cvt_pk_bf16_f32 v179, v182, v183
v_mfma_f32_16x16x32_bf16 v[232:235], a[28:31], v[216:219], 0
v_cvt_pk_bf16_f32 v178, v180, v181
v_pk_max_i16 v178, v178, 0
v_mfma_f32_16x16x32_bf16 v[232:235], a[24:27], v[212:215], v[232:235]
v_pk_max_i16 v179, v179, 0
v_pk_max_i16 v176, v176, 0
v_mfma_f32_16x16x32_bf16 v[232:235], a[20:23], v[224:227], v[232:235]
v_cvt_pk_bf16_f32 v113, v230, v231
v_cvt_pk_bf16_f32 v112, v228, v229
v_mfma_f32_16x16x32_bf16 v[232:235], a[16:19], v[220:223], v[232:235]
v_pk_max_i16 v168, v168, 0
v_pk_max_i16 v177, v177, 0
v_mfma_f32_16x16x32_bf16 v[228:231], a[32:35], v[220:223], 0
buffer_store_dwordx4 v[168:171], v239, s[20:23], s53 offen offset:0 nt
buffer_store_dwordx4 v[176:179], v239, s[20:23], s53 offen offset:64 nt
v_add_u32 v236, s56, v236
v_max_f32 v254, v254, v255
s_sub_u32 s56, 0, s56
v_cvt_pk_bf16_f32 v115, v234, v235
v_cvt_pk_bf16_f32 v114, v232, v233
v_mfma_f32_16x16x32_bf16 v[228:231], a[36:39], v[224:227], v[228:231]
ds_bpermute_b32 v255, v247, v254
v_mfma_f32_16x16x32_bf16 v[228:231], a[40:43], v[212:215], v[228:231]
v_mfma_f32_16x16x32_bf16 v[228:231], a[44:47], v[216:219], v[228:231]
s_nop 2
v_mfma_f32_16x16x32_bf16 v[232:235], a[60:63], v[216:219], 0
s_nop 2
v_mfma_f32_16x16x32_bf16 v[232:235], a[56:59], v[212:215], v[232:235]
v_cvt_pk_bf16_f32 v116, v228, v229
v_cvt_pk_bf16_f32 v117, v230, v231
v_mfma_f32_16x16x32_bf16 v[232:235], a[52:55], v[224:227], v[232:235]
v_mfma_f32_16x16x32_bf16 v[232:235], a[48:51], v[220:223], v[232:235]
s_waitcnt lgkmcnt(0)
v_max_f32 v254, v254, v255
v_sub_f32 v184, v184, v254
v_mfma_f32_16x16x32_bf16 v[168:171], a[192:195], v[220:223], 0
v_exp_f32 v184, v184
v_mfma_f32_16x16x32_bf16 v[168:171], a[196:199], v[224:227], v[168:171]
v_sub_f32 v185, v185, v254
v_sub_f32 v186, v186, v254
v_mfma_f32_16x16x32_bf16 v[168:171], a[200:203], v[212:215], v[168:171]
v_cvt_pk_bf16_f32 v119, v234, v235
v_cvt_pk_bf16_f32 v118, v232, v233
v_mfma_f32_16x16x32_bf16 v[168:171], a[204:207], v[216:219], v[168:171]
v_exp_f32 v186, v186
v_mfma_f32_16x16x32_bf16 v[172:175], a[220:223], v[216:219], 0
v_exp_f32 v185, v185
v_mfma_f32_16x16x32_bf16 v[172:175], a[216:219], v[212:215], v[172:175]
v_sub_f32 v189, v189, v254
v_sub_f32 v187, v187, v254
v_mfma_f32_16x16x32_bf16 v[172:175], a[212:215], v[224:227], v[172:175]
v_sub_f32 v188, v188, v254
v_sub_f32 v190, v190, v254
v_mfma_f32_16x16x32_bf16 v[172:175], a[208:211], v[220:223], v[172:175]
s_cmp_lg_u32 s45, 0
s_cbranch_scc1 L_loops
v_mfma_f32_16x16x32_bf16 v[176:179], a[224:227], v[220:223], 0
s_waitcnt vmcnt(8)
s_barrier
v_mfma_f32_16x16x32_bf16 v[176:179], a[228:231], v[224:227], v[176:179]
s_add_u32 s52, s47, 8192
ds_read_b128 v[232:235], v236 offset:0
v_add_f32 v248, v184, v185
v_mfma_f32_16x16x32_bf16 v[176:179], a[232:235], v[212:215], v[176:179]
s_add_u32 s53, s47, 12288
v_exp_f32 v188, v188
v_mfma_f32_16x16x32_bf16 v[176:179], a[236:239], v[216:219], v[176:179]
v_add_f32 v248, v248, v186
v_sub_f32 v191, v191, v254
v_mfma_f32_16x16x32_bf16 v[180:183], a[252:255], v[216:219], 0
v_exp_f32 v187, v187
v_mfma_f32_16x16x32_bf16 v[180:183], a[248:251], v[212:215], v[180:183]
v_exp_f32 v190, v190
v_mfma_f32_16x16x32_bf16 v[180:183], a[244:247], v[224:227], v[180:183]
v_add_f32 v248, v248, v187
v_add_f32 v248, v248, v188
v_mfma_f32_16x16x32_bf16 v[180:183], a[240:243], v[220:223], v[180:183]
s_waitcnt lgkmcnt(0)
v_exp_f32 v189, v189
v_mfma_f32_16x16x32_bf16 v[228:231], v[0:3], v[112:115], 0
v_add_f32 v248, v248, v189
v_add_f32 v248, v248, v190
v_mfma_f32_16x16x32_bf16 v[228:231], v[4:7], v[116:119], v[228:231]
v_exp_f32 v191, v191
v_cvt_pk_bf16_f32 v122, v188, v189
v_add_f32 v248, v248, v191
v_cvt_pk_bf16_f32 v123, v190, v191
v_mfma_f32_16x16x32_bf16 v[188:191], v[12:15], v[116:119], 0
v_sub_f32 v193, v193, v254
v_sub_f32 v194, v194, v254
v_mfma_f32_16x16x32_bf16 v[188:191], v[8:11], v[112:115], v[188:191]
v_sub_f32 v195, v195, v254
v_exp_f32 v194, v194
v_sub_f32 v192, v192, v254
v_exp_f32 v192, v192
v_sub_f32 v196, v196, v254
v_exp_f32 v193, v193
v_sub_f32 v197, v197, v254
v_sub_f32 v199, v199, v254
v_sub_f32 v198, v198, v254
v_exp_f32 v195, v195
v_add_f32 v248, v248, v192
v_add_f32 v248, v248, v193
v_exp_f32 v196, v196
v_exp_f32 v197, v197
v_add_f32 v248, v248, v194
v_add_f32 v248, v248, v195
v_add_f32 v248, v248, v196
v_add_f32 v248, v248, v197
v_exp_f32 v198, v198
v_sub_f32 v200, v200, v254
v_sub_f32 v203, v203, v254
v_exp_f32 v199, v199
v_sub_f32 v201, v201, v254
v_exp_f32 v201, v201
v_sub_f32 v202, v202, v254
v_exp_f32 v202, v202
v_add_f32 v248, v248, v198
v_exp_f32 v200, v200
v_add_f32 v248, v248, v199
v_add_f32 v248, v248, v200
v_add_f32 v248, v248, v201
v_exp_f32 v203, v203
v_add_f32 v248, v248, v202
v_add_f32 v248, v248, v203
v_cvt_pk_bf16_f32 v128, v200, v201
v_cvt_pk_bf16_f32 v129, v202, v203
v_mfma_f32_16x16x32_bf16 v[200:203], v[16:19], v[112:115], 0
v_sub_f32 v204, v204, v254
v_sub_f32 v205, v205, v254
v_mfma_f32_16x16x32_bf16 v[200:203], v[20:23], v[116:119], v[200:203]
v_exp_f32 v204, v204
v_sub_f32 v206, v206, v254
v_add_f32 v248, v248, v204
v_exp_f32 v206, v206
v_sub_f32 v207, v207, v254
v_exp_f32 v205, v205
v_exp_f32 v207, v207
v_add_f32 v248, v248, v205
v_add_f32 v248, v248, v206
v_add_f32 v248, v248, v207
v_cvt_pk_bf16_f32 v130, v204, v205
v_cvt_pk_bf16_f32 v131, v206, v207
v_mfma_f32_16x16x32_bf16 v[204:207], v[28:31], v[116:119], 0
v_sub_f32 v208, v208, v254
v_cvt_pk_bf16_f32 v120, v184, v185
v_mfma_f32_16x16x32_bf16 v[204:207], v[24:27], v[112:115], v[204:207]
v_exp_f32 v208, v208
s_nop 0
v_add_f32 v248, v248, v208
v_cvt_pk_bf16_f32 v132, v208, 0
v_mfma_f32_16x16x32_bf16 v[208:211], v[32:35], v[112:115], 0
ds_swizzle_b32 v250, v248 offset:0x401F
v_cvt_pk_bf16_f32 v121, v186, v187
v_mfma_f32_16x16x32_bf16 v[208:211], v[36:39], v[116:119], v[208:211]
ds_read_b128 v[184:187], v236 offset:256
v_cvt_pk_bf16_f32 v126, v196, v197
v_mfma_f32_16x16x32_bf16 v[212:215], v[44:47], v[116:119], 0
v_cvt_pk_bf16_f32 v125, v194, v195
v_cvt_pk_bf16_f32 v127, v198, v199
v_mfma_f32_16x16x32_bf16 v[212:215], v[40:43], v[112:115], v[212:215]
ds_read_b128 v[196:199], v236 offset:768
v_cvt_pk_bf16_f32 v124, v192, v193
v_mfma_f32_16x16x32_bf16 v[216:219], v[48:51], v[112:115], 0
ds_read_b128 v[192:195], v236 offset:512
v_max3_f32 v254, v228, v229, v230
v_mfma_f32_16x16x32_bf16 v[216:219], v[52:55], v[116:119], v[216:219]
v_max3_f32 v254, v254, v231, v188
v_max3_f32 v254, v254, v189, v190
v_mfma_f32_16x16x32_bf16 v[220:223], v[56:59], v[120:123], 0
s_waitcnt lgkmcnt(3)
v_add_f32 v248, v248, v250
v_max3_f32 v254, v254, v191, v200
v_mfma_f32_16x16x32_bf16 v[220:223], v[104:107], v[132:135], v[220:223]
s_waitcnt lgkmcnt(2)
ds_bpermute_b32 v250, v247, v248
v_mfma_f32_16x16x32_bf16 v[220:223], v[72:75], v[124:127], v[220:223]
v_max3_f32 v254, v254, v201, v202
v_max3_f32 v254, v254, v203, v204
v_mfma_f32_16x16x32_bf16 v[220:223], v[88:91], v[128:131], v[220:223]
s_waitcnt lgkmcnt(2)
v_max3_f32 v254, v254, v205, v206
v_max3_f32 v254, v254, v207, v208
v_mfma_f32_16x16x32_bf16 v[224:227], v[92:95], v[128:131], 0
s_waitcnt lgkmcnt(1)
v_max3_f32 v254, v254, v209, v210
v_max3_f32 v254, v254, v211, v212
v_mfma_f32_16x16x32_bf16 v[224:227], v[76:79], v[124:127], v[224:227]
v_max3_f32 v254, v254, v213, v214
v_max3_f32 v254, v254, v215, v216
v_mfma_f32_16x16x32_bf16 v[224:227], v[106:109], v[132:135], v[224:227]
ds_swizzle_b32 v255, v254 offset:0x401F
v_mbcnt_lo_u32_b32 v242, -1, 0
v_mfma_f32_16x16x32_bf16 v[224:227], v[60:63], v[120:123], v[224:227]
s_waitcnt lgkmcnt(1)
v_add_f32 v248, v248, v250
v_rcp_f32 v251, v248
s_nop 0
v_fmac_f32 v152, v220, v251
v_fmac_f32 v153, v221, v251
v_fmac_f32 v154, v222, v251
v_fmac_f32 v155, v223, v251
v_mfma_f32_16x16x32_bf16 v[220:223], v[64:67], v[120:123], 0
v_fmac_f32 v156, v224, v251
v_fmac_f32 v157, v225, v251
v_mfma_f32_16x16x32_bf16 v[220:223], v[108:111], v[132:135], v[220:223]
v_fmac_f32 v158, v226, v251
v_fmac_f32 v159, v227, v251
v_mfma_f32_16x16x32_bf16 v[220:223], v[80:83], v[124:127], v[220:223]
s_waitcnt lgkmcnt(0)
v_cvt_pk_bf16_f32 v152, v152, v153
v_cvt_pk_bf16_f32 v153, v154, v155
v_mfma_f32_16x16x32_bf16 v[220:223], v[96:99], v[128:131], v[220:223]
v_cvt_pk_bf16_f32 v154, v156, v157
v_cvt_pk_bf16_f32 v155, v158, v159
v_mfma_f32_16x16x32_bf16 v[224:227], v[100:103], v[128:131], 0
v_pk_max_i16 v152, v152, 0
v_pk_max_i16 v153, v153, 0
v_mfma_f32_16x16x32_bf16 v[224:227], v[84:87], v[124:127], v[224:227]
v_max_f32 v254, v254, v255
v_pk_max_i16 v154, v154, 0
v_mfma_f32_16x16x32_bf16 v[224:227], v[110:113], v[132:135], v[224:227]
ds_bpermute_b32 v255, v247, v254
v_mfma_f32_16x16x32_bf16 v[224:227], v[68:71], v[120:123], v[224:227]
v_fmac_f32 v160, v220, v251
v_fmac_f32 v161, v221, v251
v_mfma_f32_16x16x32_bf16 v[0:3], a[192:195], v[232:235], 0
v_fmac_f32 v162, v222, v251
v_fmac_f32 v163, v223, v251
v_mfma_f32_16x16x32_bf16 v[0:3], a[196:199], v[184:187], v[0:3]
v_cvt_pk_bf16_f32 v160, v160, v161
v_cvt_pk_bf16_f32 v161, v162, v163
v_mfma_f32_16x16x32_bf16 v[0:3], a[200:203], v[192:195], v[0:3]
v_fmac_f32 v164, v224, v251
v_fmac_f32 v165, v225, v251
v_mfma_f32_16x16x32_bf16 v[0:3], a[204:207], v[196:199], v[0:3]
v_fmac_f32 v166, v226, v251
v_fmac_f32 v167, v227, v251
v_mfma_f32_16x16x32_bf16 v[4:7], a[220:223], v[196:199], 0
s_waitcnt lgkmcnt(0)
v_max_f32 v254, v254, v255
v_sub_f32 v228, v228, v254
v_mfma_f32_16x16x32_bf16 v[4:7], a[216:219], v[192:195], v[4:7]
v_sub_f32 v229, v229, v254
v_sub_f32 v230, v230, v254
v_mfma_f32_16x16x32_bf16 v[4:7], a[212:215], v[184:187], v[4:7]
v_exp_f32 v228, v228
v_mfma_f32_16x16x32_bf16 v[4:7], a[208:211], v[232:235], v[4:7]
ds_read_b128 v[220:223], v236 offset:4224
v_sub_f32 v231, v231, v254
v_mfma_f32_16x16x32_bf16 v[8:11], a[224:227], v[232:235], 0
v_exp_f32 v229, v229
v_mfma_f32_16x16x32_bf16 v[8:11], a[228:231], v[184:187], v[8:11]
v_exp_f32 v230, v230
v_mfma_f32_16x16x32_bf16 v[8:11], a[232:235], v[192:195], v[8:11]
v_exp_f32 v231, v231
v_mfma_f32_16x16x32_bf16 v[8:11], a[236:239], v[196:199], v[8:11]
v_add_f32 v249, v228, v229
v_add_f32 v249, v249, v230
v_mfma_f32_16x16x32_bf16 v[12:15], a[252:255], v[196:199], 0
ds_read_b128 v[196:199], v236 offset:4736
v_add_f32 v249, v249, v231
v_mfma_f32_16x16x32_bf16 v[12:15], a[248:251], v[192:195], v[12:15]
s_waitcnt lgkmcnt(1)
ds_read_b128 v[192:195], v236 offset:4992
v_cvt_pk_bf16_f32 v136, v228, v229
v_mfma_f32_16x16x32_bf16 v[12:15], a[244:247], v[184:187], v[12:15]
v_cvt_pk_bf16_f32 v137, v230, v231
v_sub_f32 v188, v188, v254
v_mfma_f32_16x16x32_bf16 v[12:15], a[240:243], v[232:235], v[12:15]
ds_read_b128 v[228:231], v236 offset:4480
v_sub_f32 v189, v189, v254
v_mfma_f32_16x16x32_bf16 v[16:19], a[192:195], v[220:223], 0
v_exp_f32 v188, v188
v_exp_f32 v189, v189
v_sub_f32 v190, v190, v254
v_cvt_pk_bf16_f32 v138, v188, v189
v_sub_f32 v191, v191, v254
v_exp_f32 v190, v190
v_exp_f32 v191, v191
v_sub_f32 v216, v216, v254
v_cvt_pk_bf16_f32 v139, v190, v191
v_exp_f32 v216, v216
v_sub_f32 v200, v200, v254
v_cvt_pk_bf16_f32 v148, v216, 0
s_waitcnt lgkmcnt(0)
v_mfma_f32_16x16x32_bf16 v[16:19], a[196:199], v[228:231], v[16:19]
v_sub_f32 v201, v201, v254
v_sub_f32 v202, v202, v254
v_mfma_f32_16x16x32_bf16 v[16:19], a[200:203], v[196:199], v[16:19]
v_exp_f32 v200, v200
v_mfma_f32_16x16x32_bf16 v[16:19], a[204:207], v[192:195], v[16:19]
v_exp_f32 v201, v201
v_mfma_f32_16x16x32_bf16 v[20:23], a[220:223], v[192:195], 0
v_exp_f32 v202, v202
v_mfma_f32_16x16x32_bf16 v[20:23], a[216:219], v[196:199], v[20:23]
v_sub_f32 v203, v203, v254
v_sub_f32 v204, v204, v254
v_mfma_f32_16x16x32_bf16 v[20:23], a[212:215], v[228:231], v[20:23]
v_exp_f32 v203, v203
v_mfma_f32_16x16x32_bf16 v[20:23], a[208:211], v[220:223], v[20:23]
v_exp_f32 v204, v204
v_mfma_f32_16x16x32_bf16 v[24:27], a[224:227], v[220:223], 0
v_sub_f32 v205, v205, v254
v_sub_f32 v206, v206, v254
v_mfma_f32_16x16x32_bf16 v[24:27], a[228:231], v[228:231], v[24:27]
v_exp_f32 v205, v205
v_mfma_f32_16x16x32_bf16 v[24:27], a[232:235], v[196:199], v[24:27]
v_exp_f32 v206, v206
v_mfma_f32_16x16x32_bf16 v[24:27], a[236:239], v[192:195], v[24:27]
v_sub_f32 v207, v207, v254
v_cvt_pk_bf16_f32 v140, v200, v201
v_mfma_f32_16x16x32_bf16 v[28:31], a[252:255], v[192:195], 0
v_exp_f32 v207, v207
v_mfma_f32_16x16x32_bf16 v[28:31], a[248:251], v[196:199], v[28:31]
v_cvt_pk_bf16_f32 v141, v202, v203
v_cvt_pk_bf16_f32 v142, v204, v205
v_mfma_f32_16x16x32_bf16 v[28:31], a[244:247], v[228:231], v[28:31]
v_cvt_pk_bf16_f32 v143, v206, v207
v_sub_f32 v208, v208, v254
v_mfma_f32_16x16x32_bf16 v[28:31], a[240:243], v[220:223], v[28:31]
v_sub_f32 v209, v209, v254
v_sub_f32 v210, v210, v254
v_mfma_f32_16x16x32_bf16 v[228:231], v[56:59], v[136:139], 0
v_exp_f32 v208, v208
v_mfma_f32_16x16x32_bf16 v[228:231], v[104:107], v[148:151], v[228:231]
v_exp_f32 v209, v209
v_mfma_f32_16x16x32_bf16 v[228:231], v[72:75], v[140:143], v[228:231]
v_exp_f32 v210, v210
v_sub_f32 v211, v211, v254
v_exp_f32 v211, v211
v_sub_f32 v212, v212, v254
v_exp_f32 v212, v212
v_sub_f32 v213, v213, v254
v_exp_f32 v213, v213
v_sub_f32 v214, v214, v254
v_exp_f32 v214, v214
v_sub_f32 v215, v215, v254
v_exp_f32 v215, v215
v_cvt_pk_bf16_f32 v144, v208, v209
v_cvt_pk_bf16_f32 v145, v210, v211
v_cvt_pk_bf16_f32 v146, v212, v213
v_cvt_pk_bf16_f32 v147, v214, v215
v_cvt_pk_bf16_f32 v162, v164, v165
v_cvt_pk_bf16_f32 v163, v166, v167
v_mfma_f32_16x16x32_bf16 v[228:231], v[88:91], v[144:147], v[228:231]
v_pk_max_i16 v155, v155, 0
v_pk_max_i16 v160, v160, 0
v_mfma_f32_16x16x32_bf16 v[192:195], v[92:95], v[144:147], 0
v_pk_max_i16 v161, v161, 0
v_pk_max_i16 v162, v162, 0
v_mfma_f32_16x16x32_bf16 v[192:195], v[76:79], v[140:143], v[192:195]
v_pk_max_i16 v163, v163, 0
v_mbcnt_hi_u32_b32 v242, -1, v242
v_mfma_f32_16x16x32_bf16 v[192:195], v[106:109], v[148:151], v[192:195]
buffer_store_dwordx4 v[152:155], v239, s[20:23], s52 offen offset:0 nt
buffer_store_dwordx4 v[160:163], v239, s[20:23], s52 offen offset:64 nt
s_mul_i32 s54, s41, 12288
s_add_u32 s54, s54, 105472
v_mov_b32 v244, s54
v_bfe_u32 v243, v242, 0, 4
v_lshl_add_u32 v244, v243, 7, v244
v_lshlrev_b32 v243, 4, v242
v_xor_b32 v243, v243, v242
v_and_b32 v243, 48, v243
v_mfma_f32_16x16x32_bf16 v[192:195], v[60:63], v[136:139], v[192:195]
v_add_u32 v244, v243, v244
v_add_u32 v244, v243, v244
v_mfma_f32_16x16x32_bf16 v[220:223], v[64:67], v[136:139], 0
ds_read_b128 v[184:187], v244 offset:0
ds_read_b128 v[232:235], v244 offset:16
v_mfma_f32_16x16x32_bf16 v[220:223], v[108:111], v[148:151], v[220:223]
ds_read_b128 v[196:199], v244 offset:2048
v_add_f32 v249, v249, v188
v_mfma_f32_16x16x32_bf16 v[220:223], v[80:83], v[140:143], v[220:223]
ds_read_b32 v188, v244 offset:4096
v_add_f32 v249, v249, v189
v_mfma_f32_16x16x32_bf16 v[220:223], v[96:99], v[144:147], v[220:223]
v_add_f32 v249, v249, v190
v_add_f32 v249, v249, v191
v_mfma_f32_16x16x32_bf16 v[224:227], v[100:103], v[144:147], 0
v_mov_b32 v245, 24576
v_bfe_u32 v243, v242, 0, 2
v_mfma_f32_16x16x32_bf16 v[224:227], v[84:87], v[140:143], v[224:227]
v_lshl_add_u32 v245, v243, 8, v245
v_bfe_u32 v243, v242, 2, 2
v_mfma_f32_16x16x32_bf16 v[224:227], v[110:113], v[148:151], v[224:227]
s_waitcnt lgkmcnt(2)
v_lshlrev_b32 v190, 16, v184
v_lshlrev_b32 v191, 16, v185
v_mfma_f32_16x16x32_bf16 v[224:227], v[68:71], v[136:139], v[224:227]
s_waitcnt lgkmcnt(1)
s_waitcnt lgkmcnt(0)
ds_swizzle_b32 v189, v188 offset:0x401F
v_and_b32 v184, 0xffff0000, v184
v_and_b32 v185, 0xffff0000, v185
v_mul_u32_u24 v243, 13107200, v243
v_add_u32 v245, v243, v245
s_lshl_b32 s48, s43, 7
s_add_u32 s48, s48, s44
s_add_u32 s48, s48, 0
v_bfe_u32 v243, v242, 4, 2
v_lshl_add_u32 v245, v243, 4, v245
v_add_f32 v249, v249, v200
v_add_f32 v249, v249, v201
v_add_f32 v249, v249, v202
v_add_f32 v249, v249, v203
ds_read_b128 v[200:203], v244 offset:2064
v_add_f32 v249, v249, v204
ds_read_b32 v204, v244 offset:6144
v_add_f32 v249, v249, v205
v_add_f32 v249, v249, v206
v_add_f32 v249, v249, v207
v_add_f32 v249, v249, v208
v_add_f32 v249, v249, v209
v_add_f32 v249, v249, v210
v_add_f32 v249, v249, v211
v_add_f32 v249, v249, v212
v_add_f32 v249, v249, v213
v_add_f32 v249, v249, v214
v_add_f32 v249, v249, v215
v_add_f32 v249, v249, v216
ds_swizzle_b32 v250, v249 offset:0x401F
v_lshlrev_b32 v206, 16, v196
v_lshlrev_b32 v207, 16, v197
v_and_b32 v196, 0xffff0000, v196
v_and_b32 v197, 0xffff0000, v197
s_waitcnt lgkmcnt(1)
ds_swizzle_b32 v205, v204 offset:0x401F
v_add_f32 v188, v188, v189
ds_bpermute_b32 v189, v247, v188
s_lshl_b32 s51, s43, 7
s_add_u32 s51, s51, s44
s_add_u32 s51, s51, 52428800
s_waitcnt lgkmcnt(2)
v_add_f32 v249, v249, v250
ds_bpermute_b32 v250, v247, v249
s_waitcnt lgkmcnt(2)
v_add_f32 v204, v204, v205
ds_bpermute_b32 v205, v247, v204
s_waitcnt lgkmcnt(2)
v_add_f32 v188, v188, v189
v_rcp_f32 v189, v188
s_nop 0
v_fmac_f32 v0, v190, v189
v_fmac_f32 v2, v191, v189
v_lshlrev_b32 v190, 16, v186
v_lshlrev_b32 v191, 16, v187
v_fmac_f32 v4, v190, v189
v_fmac_f32 v6, v191, v189
v_lshlrev_b32 v190, 16, v232
v_lshlrev_b32 v191, 16, v233
v_and_b32 v232, 0xffff0000, v232
v_fmac_f32 v8, v190, v189
v_fmac_f32 v10, v191, v189
v_fmac_f32 v1, v184, v189
v_fmac_f32 v9, v232, v189
v_and_b32 v233, 0xffff0000, v233
v_lshlrev_b32 v190, 16, v234
v_lshlrev_b32 v191, 16, v235
v_fmac_f32 v3, v185, v189
v_and_b32 v186, 0xffff0000, v186
v_and_b32 v187, 0xffff0000, v187
v_fmac_f32 v11, v233, v189
v_and_b32 v234, 0xffff0000, v234
v_and_b32 v235, 0xffff0000, v235
v_cvt_pk_bf16_f32 v0, v0, v1
v_cvt_pk_bf16_f32 v8, v8, v9
v_fmac_f32 v5, v186, v189
v_fmac_f32 v7, v187, v189
v_fmac_f32 v12, v190, v189
v_fmac_f32 v13, v234, v189
v_fmac_f32 v14, v191, v189
v_fmac_f32 v15, v235, v189
v_cvt_pk_bf16_f32 v1, v2, v3
v_cvt_pk_bf16_f32 v9, v10, v11
v_cvt_pk_bf16_f32 v2, v4, v5
v_cvt_pk_bf16_f32 v3, v6, v7
v_cvt_pk_bf16_f32 v10, v12, v13
v_cvt_pk_bf16_f32 v11, v14, v15
v_pk_max_i16 v0, v0, 0
v_pk_max_i16 v1, v1, 0
v_pk_max_i16 v2, v2, 0
v_pk_max_i16 v3, v3, 0
v_pk_max_i16 v8, v8, 0
v_pk_max_i16 v9, v9, 0
v_pk_max_i16 v10, v10, 0
v_pk_max_i16 v11, v11, 0
buffer_store_dwordx4 v[0:3], v245, s[20:23], s48 offen offset:0 nt
buffer_store_dwordx4 v[8:11], v245, s[20:23], s48 offen offset:64 nt
s_waitcnt lgkmcnt(1)
v_add_f32 v249, v249, v250
v_rcp_f32 v252, v249
s_nop 0
v_fmac_f32 v168, v228, v252
v_fmac_f32 v169, v229, v252
v_fmac_f32 v176, v220, v252
v_fmac_f32 v177, v221, v252
v_fmac_f32 v170, v230, v252
v_fmac_f32 v171, v231, v252
v_cvt_pk_bf16_f32 v168, v168, v169
v_fmac_f32 v178, v222, v252
v_fmac_f32 v179, v223, v252
v_cvt_pk_bf16_f32 v176, v176, v177
v_fmac_f32 v172, v192, v252
v_fmac_f32 v173, v193, v252
v_fmac_f32 v174, v194, v252
v_fmac_f32 v175, v195, v252
v_cvt_pk_bf16_f32 v169, v170, v171
v_fmac_f32 v180, v224, v252
v_fmac_f32 v181, v225, v252
v_fmac_f32 v182, v226, v252
v_fmac_f32 v183, v227, v252
v_cvt_pk_bf16_f32 v177, v178, v179
v_cvt_pk_bf16_f32 v170, v172, v173
v_cvt_pk_bf16_f32 v171, v174, v175
v_cvt_pk_bf16_f32 v178, v180, v181
v_cvt_pk_bf16_f32 v179, v182, v183
v_pk_max_i16 v168, v168, 0
v_pk_max_i16 v169, v169, 0
v_pk_max_i16 v170, v170, 0
v_pk_max_i16 v171, v171, 0
v_pk_max_i16 v176, v176, 0
v_pk_max_i16 v177, v177, 0
v_pk_max_i16 v178, v178, 0
v_pk_max_i16 v179, v179, 0
buffer_store_dwordx4 v[168:171], v239, s[20:23], s53 offen offset:0 nt
buffer_store_dwordx4 v[176:179], v239, s[20:23], s53 offen offset:64 nt
s_waitcnt lgkmcnt(0)
v_add_f32 v204, v204, v205
v_rcp_f32 v205, v204
s_nop 0
v_fmac_f32 v16, v206, v205
v_fmac_f32 v18, v207, v205
v_lshlrev_b32 v206, 16, v198
v_lshlrev_b32 v207, 16, v199
v_fmac_f32 v20, v206, v205
v_fmac_f32 v22, v207, v205
v_lshlrev_b32 v206, 16, v200
v_lshlrev_b32 v207, 16, v201
v_and_b32 v200, 0xffff0000, v200
v_fmac_f32 v24, v206, v205
v_fmac_f32 v26, v207, v205
v_fmac_f32 v17, v196, v205
v_fmac_f32 v25, v200, v205
v_and_b32 v201, 0xffff0000, v201
v_lshlrev_b32 v206, 16, v202
v_lshlrev_b32 v207, 16, v203
v_fmac_f32 v19, v197, v205
v_and_b32 v198, 0xffff0000, v198
v_and_b32 v199, 0xffff0000, v199
v_fmac_f32 v27, v201, v205
v_and_b32 v202, 0xffff0000, v202
v_and_b32 v203, 0xffff0000, v203
v_cvt_pk_bf16_f32 v16, v16, v17
v_cvt_pk_bf16_f32 v24, v24, v25
v_fmac_f32 v21, v198, v205
v_fmac_f32 v23, v199, v205
v_fmac_f32 v28, v206, v205
v_fmac_f32 v29, v202, v205
v_fmac_f32 v30, v207, v205
v_fmac_f32 v31, v203, v205
v_cvt_pk_bf16_f32 v17, v18, v19
v_cvt_pk_bf16_f32 v25, v26, v27
v_cvt_pk_bf16_f32 v18, v20, v21
v_cvt_pk_bf16_f32 v19, v22, v23
v_cvt_pk_bf16_f32 v26, v28, v29
v_cvt_pk_bf16_f32 v27, v30, v31
v_pk_max_i16 v16, v16, 0
v_pk_max_i16 v17, v17, 0
v_pk_max_i16 v18, v18, 0
v_pk_max_i16 v19, v19, 0
v_pk_max_i16 v24, v24, 0
v_pk_max_i16 v25, v25, 0
v_pk_max_i16 v26, v26, 0
v_pk_max_i16 v27, v27, 0
buffer_store_dwordx4 v[16:19], v245, s[20:23], s51 offen offset:0 nt
buffer_store_dwordx4 v[24:27], v245, s[20:23], s51 offen offset:64 nt
L_end:
s_endpgm
.section .rodata,"a"
.p2align 6
.amdhsa_kernel standalone__attention_interact_autoint__recsys_kernel
  .amdhsa_next_free_vgpr 512
  .amdhsa_next_free_sgpr 102
  .amdhsa_accum_offset 256
  .amdhsa_group_segment_fixed_size 0
  .amdhsa_kernarg_size 64
  .amdhsa_user_sgpr_count 2
  .amdhsa_user_sgpr_kernarg_segment_ptr 1
  .amdhsa_system_sgpr_workgroup_id_x 1
.end_amdhsa_kernel
```

```asm
; @launch grid=(256,1,1) block=(256,1,1) lds=163840
.amdgcn_target "amdgcn-amd-amdhsa--gfx950"
.text
.globl standalone__attention_interact_autoint__recsys_kernel
.p2align 8
.type standalone__attention_interact_autoint__recsys_kernel,@function
standalone__attention_interact_autoint__recsys_kernel:
s_cmp_ge_u32 s2, 256
s_cbranch_scc1 L_end
s_load_dwordx2 s[24:25], s[0:1], 8
s_load_dwordx2 s[16:17], s[0:1], 0
s_load_dwordx2 s[28:29], s[0:1], 16
s_load_dwordx2 s[32:33], s[0:1], 24
s_load_dwordx2 s[36:37], s[0:1], 32
s_load_dwordx2 s[20:21], s[0:1], 40
s_getpc_b64 s[58:59]
L_pc:
s_lshl_b32 s3, s2, 8
s_and_b32 s3, s3, 0x7800
v_lshrrev_b32 v2, 4, v0
v_lshl_add_u32 v2, v2, 7, s3
v_min_u32 v2, L_fast_end-L_pc-4, v2
global_load_dword v96, v2, s[58:59]
v_lshrrev_b32 v1, 6, v0
s_mov_b32 s19, 0x20000
v_readfirstlane_b32 s41, v1
s_mov_b32 s18, 104857600
s_mov_b32 s26, 32768
s_mov_b32 s27, s19
s_lshr_b32 s42, s41, 1
s_and_b32 s43, s41, 1
s_lshl1_add_u32 s44, s2, s42
s_mul_i32 s44, s44, 25600
s_mov_b64 s[30:31], s[26:27]
s_mov_b64 s[34:35], s[26:27]
s_mov_b64 s[38:39], s[26:27]
s_lshl_b32 s54, s41, 13
s_mul_i32 s49, s42, 25344
s_mul_i32 s53, s43, 1056
s_add_u32 s49, s49, s53
s_lshl_b32 s55, s43, 10
s_add_u32 s55, s55, s44
s_lshl_b32 s6, s2, 7
s_and_b32 s6, s6, 0x7c00
s_add_u32 s57, s54, 4096
s_add_u32 m0, s49, 21120
s_add_u32 s48, s55, 20480
v_and_b32 v168, 63, v0
v_lshlrev_b32 v175, 4, v168
v_and_b32 v243, 48, v175
v_and_b32 v169, 48, v168
v_lshl_add_u32 v243, v169, 2, v243
v_and_b32 v169, 12, v168
v_lshl_add_u32 v243, v169, 6, v243
v_lshrrev_b32 v169, 5, v0
v_lshlrev_b32 v169, 7, v169
s_waitcnt lgkmcnt(0)
buffer_load_dword v97, v169, s[24:27], s6 offen
buffer_load_dword v98, v169, s[28:31], s6 offen
buffer_load_dword v99, v169, s[32:35], s6 offen
buffer_load_dword v100, v169, s[36:39], s6 offen
buffer_load_dwordx4 v[104:107], v175, s[24:27], s54 offen offset:0
buffer_load_dwordx4 v[108:111], v175, s[24:27], s54 offen offset:1024
buffer_load_dwordx4 v[112:115], v175, s[24:27], s54 offen offset:2048
buffer_load_dwordx4 v[116:119], v175, s[24:27], s54 offen offset:3072
buffer_load_dwordx4 v[120:123], v175, s[24:27], s57 offen offset:0
buffer_load_dwordx4 v[124:127], v175, s[24:27], s57 offen offset:1024
buffer_load_dwordx4 v[128:131], v175, s[24:27], s57 offen offset:2048
buffer_load_dwordx4 v[132:135], v175, s[24:27], s57 offen offset:3072
buffer_load_dwordx4 v243, s[16:19], s48 offen nt lds
s_add_u32 m0, s49, 23232
s_add_u32 s48, s55, 22528
buffer_load_dwordx4 v243, s[16:19], s48 offen nt lds
s_add_u32 m0, s49, 0
s_add_u32 s48, s55, 0
buffer_load_dwordx4 v243, s[16:19], s48 offen nt lds
s_add_u32 m0, s49, 2112
s_add_u32 s48, s55, 2048
buffer_load_dwordx4 v243, s[16:19], s48 offen nt lds
s_mov_b32 s40, 0x3e38aa3b
s_mov_b32 s22, s18
s_mov_b32 s23, s19
s_mov_b32 s45, 8
s_mov_b32 s3, 64
s_mov_b32 s46, s44
s_mov_b32 s47, 0x7ff00000
s_mov_b32 s56, 50688
s_mov_b32 s96, 0x3b8265d9
s_mov_b32 s97, 0
s_mul_i32 s98, s42, 25344
s_lshl_b32 s53, s43, 13
s_add_u32 s98, s98, s53
s_add_u32 s53, s98, 4224
s_add_u32 m0, s98, 102400
v_and_b32 v169, 16, v168
v_lshlrev_b32 v180, 2, v169
v_lshlrev_b32 v169, 1, v169
v_xor_b32 v170, v175, v169
v_add_u32 v172, s53, v170
v_xor_b32 v171, 64, v170
v_add_u32 v173, s53, v171
s_mul_i32 s4, s43, 13107200
s_add_u32 s4, s4, s44
s_add_u32 s4, s4, 24576
s_mul_i32 s5, s43, -52424704
s_add_u32 s5, s5, 104833024
s_add_u32 s99, s4, 0
s_add_u32 s100, s4, 26212288
s_mul_i32 s53, s43, 25344
s_add_u32 s7, s53, 4224
v_lshrrev_b32 v82, 4, v168
v_lshl_add_u32 v176, v82, 10, s7
v_bfe_u32 v83, v168, 2, 2
v_lshl_add_u32 v176, v83, 7, v176
v_bfe_u32 v84, v168, 3, 1
v_lshl_add_u32 v176, v84, 5, v176
v_bfe_u32 v85, v168, 4, 1
v_lshl_add_u32 v176, v85, 6, v176
v_and_b32 v86, 3, v168
v_lshl_add_u32 v176, v86, 3, v176
v_xor_b32 v177, 32, v176
v_xor_b32 v178, 64, v176
s_mul_i32 s53, s42, 25344
v_lshl_add_u32 v242, v86, 6, s53
v_lshl_add_u32 v242, v82, 4, v242
s_mov_b32 s6, 1056
v_mad_u32_u24 v242, v83, s6, v242
s_waitcnt vmcnt(11)
v_and_b32 v160, 0xffff0000, v104
v_and_b32 v161, 0xffff0000, v105
v_and_b32 v162, 0xffff0000, v106
v_and_b32 v163, 0xffff0000, v107
v_lshlrev_b32 v104, 16, v104
v_lshlrev_b32 v105, 16, v105
v_lshlrev_b32 v106, 16, v106
v_lshlrev_b32 v107, 16, v107
v_mul_f32 v160, s40, v160
v_mul_f32 v104, s40, v104
v_mul_f32 v161, s40, v161
v_mul_f32 v105, s40, v105
v_mul_f32 v162, s40, v162
v_mul_f32 v106, s40, v106
v_mul_f32 v163, s40, v163
v_mul_f32 v107, s40, v107
v_cvt_pk_bf16_f32 v104, v104, v160
v_cvt_pk_bf16_f32 v105, v105, v161
v_cvt_pk_bf16_f32 v106, v106, v162
v_cvt_pk_bf16_f32 v107, v107, v163
ds_write_b128 v172, v[104:107] offset:0
buffer_load_dwordx4 v170, s[28:31], s54 offen offset:0 lds
buffer_load_dwordx4 v171, s[28:31], s54 offen offset:1024 lds
buffer_load_dwordx4 v170, s[28:31], s54 offen offset:2048 lds
buffer_load_dwordx4 v171, s[28:31], s54 offen offset:3072 lds
s_add_u32 m0, s98, 106496
s_waitcnt vmcnt(14)
v_and_b32 v160, 0xffff0000, v108
v_and_b32 v161, 0xffff0000, v109
v_and_b32 v162, 0xffff0000, v110
v_and_b32 v163, 0xffff0000, v111
v_lshlrev_b32 v108, 16, v108
v_lshlrev_b32 v109, 16, v109
v_lshlrev_b32 v110, 16, v110
v_lshlrev_b32 v111, 16, v111
v_mul_f32 v160, s40, v160
v_mul_f32 v108, s40, v108
v_mul_f32 v161, s40, v161
v_mul_f32 v109, s40, v109
v_mul_f32 v162, s40, v162
v_mul_f32 v110, s40, v110
v_mul_f32 v163, s40, v163
v_mul_f32 v111, s40, v111
v_cvt_pk_bf16_f32 v108, v108, v160
v_cvt_pk_bf16_f32 v109, v109, v161
v_cvt_pk_bf16_f32 v110, v110, v162
v_cvt_pk_bf16_f32 v111, v111, v163
ds_write_b128 v173, v[108:111] offset:1024
buffer_load_dwordx4 v170, s[28:31], s57 offen offset:0 lds
buffer_load_dwordx4 v171, s[28:31], s57 offen offset:1024 lds
buffer_load_dwordx4 v170, s[28:31], s57 offen offset:2048 lds
buffer_load_dwordx4 v171, s[28:31], s57 offen offset:3072 lds
s_add_u32 m0, s49, 50688
s_waitcnt vmcnt(17)
v_and_b32 v160, 0xffff0000, v112
v_and_b32 v161, 0xffff0000, v113
v_and_b32 v162, 0xffff0000, v114
v_and_b32 v163, 0xffff0000, v115
v_lshlrev_b32 v112, 16, v112
v_lshlrev_b32 v113, 16, v113
v_lshlrev_b32 v114, 16, v114
v_lshlrev_b32 v115, 16, v115
v_mul_f32 v160, s40, v160
v_mul_f32 v112, s40, v112
v_mul_f32 v161, s40, v161
v_mul_f32 v113, s40, v113
v_mul_f32 v162, s40, v162
v_mul_f32 v114, s40, v114
v_mul_f32 v163, s40, v163
v_mul_f32 v115, s40, v115
v_cvt_pk_bf16_f32 v112, v112, v160
v_cvt_pk_bf16_f32 v113, v113, v161
v_cvt_pk_bf16_f32 v114, v114, v162
v_cvt_pk_bf16_f32 v115, v115, v163
ds_write_b128 v172, v[112:115] offset:2048
s_waitcnt vmcnt(16)
v_and_b32 v160, 0xffff0000, v116
v_and_b32 v161, 0xffff0000, v117
v_and_b32 v162, 0xffff0000, v118
v_and_b32 v163, 0xffff0000, v119
v_lshlrev_b32 v116, 16, v116
v_lshlrev_b32 v117, 16, v117
v_lshlrev_b32 v118, 16, v118
v_lshlrev_b32 v119, 16, v119
v_mul_f32 v160, s40, v160
v_mul_f32 v116, s40, v116
v_mul_f32 v161, s40, v161
v_mul_f32 v117, s40, v117
v_mul_f32 v162, s40, v162
v_mul_f32 v118, s40, v118
v_mul_f32 v163, s40, v163
v_mul_f32 v119, s40, v119
v_cvt_pk_bf16_f32 v116, v116, v160
v_cvt_pk_bf16_f32 v117, v117, v161
v_cvt_pk_bf16_f32 v118, v118, v162
v_cvt_pk_bf16_f32 v119, v119, v163
ds_write_b128 v173, v[116:119] offset:3072
s_waitcnt vmcnt(15)
v_and_b32 v160, 0xffff0000, v120
v_and_b32 v161, 0xffff0000, v121
v_and_b32 v162, 0xffff0000, v122
v_and_b32 v163, 0xffff0000, v123
v_lshlrev_b32 v120, 16, v120
v_lshlrev_b32 v121, 16, v121
v_lshlrev_b32 v122, 16, v122
v_lshlrev_b32 v123, 16, v123
v_mul_f32 v160, s40, v160
v_mul_f32 v120, s40, v120
v_mul_f32 v161, s40, v161
v_mul_f32 v121, s40, v121
v_mul_f32 v162, s40, v162
v_mul_f32 v122, s40, v122
v_mul_f32 v163, s40, v163
v_mul_f32 v123, s40, v123
v_cvt_pk_bf16_f32 v120, v120, v160
v_cvt_pk_bf16_f32 v121, v121, v161
v_cvt_pk_bf16_f32 v122, v122, v162
v_cvt_pk_bf16_f32 v123, v123, v163
ds_write_b128 v172, v[120:123] offset:4096
s_waitcnt vmcnt(14)
v_and_b32 v160, 0xffff0000, v124
v_and_b32 v161, 0xffff0000, v125
v_and_b32 v162, 0xffff0000, v126
v_and_b32 v163, 0xffff0000, v127
v_lshlrev_b32 v124, 16, v124
v_lshlrev_b32 v125, 16, v125
v_lshlrev_b32 v126, 16, v126
v_lshlrev_b32 v127, 16, v127
v_mul_f32 v160, s40, v160
v_mul_f32 v124, s40, v124
v_mul_f32 v161, s40, v161
v_mul_f32 v125, s40, v125
v_mul_f32 v162, s40, v162
v_mul_f32 v126, s40, v126
v_mul_f32 v163, s40, v163
v_mul_f32 v127, s40, v127
v_cvt_pk_bf16_f32 v124, v124, v160
v_cvt_pk_bf16_f32 v125, v125, v161
v_cvt_pk_bf16_f32 v126, v126, v162
v_cvt_pk_bf16_f32 v127, v127, v163
ds_write_b128 v173, v[124:127] offset:5120
s_waitcnt vmcnt(13)
v_and_b32 v160, 0xffff0000, v128
v_and_b32 v161, 0xffff0000, v129
v_and_b32 v162, 0xffff0000, v130
v_and_b32 v163, 0xffff0000, v131
v_lshlrev_b32 v128, 16, v128
v_lshlrev_b32 v129, 16, v129
v_lshlrev_b32 v130, 16, v130
v_lshlrev_b32 v131, 16, v131
v_mul_f32 v160, s40, v160
v_mul_f32 v128, s40, v128
v_mul_f32 v161, s40, v161
v_mul_f32 v129, s40, v129
v_mul_f32 v162, s40, v162
v_mul_f32 v130, s40, v130
v_mul_f32 v163, s40, v163
v_mul_f32 v131, s40, v131
v_cvt_pk_bf16_f32 v128, v128, v160
v_cvt_pk_bf16_f32 v129, v129, v161
v_cvt_pk_bf16_f32 v130, v130, v162
v_cvt_pk_bf16_f32 v131, v131, v163
ds_write_b128 v172, v[128:131] offset:6144
s_waitcnt vmcnt(12)
v_and_b32 v160, 0xffff0000, v132
v_and_b32 v161, 0xffff0000, v133
v_and_b32 v162, 0xffff0000, v134
v_and_b32 v163, 0xffff0000, v135
v_lshlrev_b32 v132, 16, v132
v_lshlrev_b32 v133, 16, v133
v_lshlrev_b32 v134, 16, v134
v_lshlrev_b32 v135, 16, v135
v_mul_f32 v160, s40, v160
v_mul_f32 v132, s40, v132
v_mul_f32 v161, s40, v161
v_mul_f32 v133, s40, v133
v_mul_f32 v162, s40, v162
v_mul_f32 v134, s40, v134
v_mul_f32 v163, s40, v163
v_mul_f32 v135, s40, v135
v_cvt_pk_bf16_f32 v132, v132, v160
v_cvt_pk_bf16_f32 v133, v133, v161
v_cvt_pk_bf16_f32 v134, v134, v162
v_cvt_pk_bf16_f32 v135, v135, v163
ds_write_b128 v173, v[132:135] offset:7168
buffer_load_dwordx4 v243, s[16:19], s99 offen offset:0 nt lds
buffer_load_dwordx4 v243, s[16:19], s100 offen offset:2112 nt lds
s_add_u32 m0, s49, 54912
s_add_u32 s99, s4, 52428800
buffer_load_dwordx4 v243, s[16:19], s99 offen offset:0 nt lds
s_add_u32 s100, s4, 78641088
buffer_load_dwordx4 v243, s[16:19], s100 offen offset:2112 nt lds
s_add_u32 m0, s98, 59648
s_add_u32 s99, s55, 4096
s_add_u32 s100, s55, 4032
s_waitcnt vmcnt(12) lgkmcnt(0)
s_barrier
ds_read_b64_tr_b16 a[4:5], v176 offset:4096
ds_read_b128 v[224:227], v242 offset:21376
ds_read_b64_tr_b16 a[6:7], v176 offset:4608
ds_read_b128 v[220:223], v242 offset:21632
ds_read_b64_tr_b16 a[8:9], v176 offset:8192
ds_read_b128 v[232:235], v242 offset:21888
ds_read_b64_tr_b16 a[10:11], v176 offset:8704
ds_read_b128 v[228:231], v242 offset:21120
ds_read_b64_tr_b16 a[12:13], v176 offset:12288
ds_read_b128 v[188:191], v242 offset:0
ds_read_b64_tr_b16 a[14:15], v176 offset:12800
ds_read_b128 v[192:195], v242 offset:256
ds_read_b64_tr_b16 a[0:1], v176 offset:0
ds_read_b128 v[196:199], v242 offset:512
ds_read_b64_tr_b16 a[2:3], v176 offset:512
ds_read_b128 v[200:203], v242 offset:768
ds_read_b64_tr_b16 a[16:17], v177 offset:0
ds_read_b64_tr_b16 a[18:19], v177 offset:512
ds_read_b64_tr_b16 a[20:21], v177 offset:4096
ds_read_b64_tr_b16 a[22:23], v177 offset:4608
ds_read_b64_tr_b16 a[24:25], v177 offset:8192
ds_read_b64_tr_b16 a[26:27], v177 offset:8704
ds_read_b64_tr_b16 a[28:29], v177 offset:12288
ds_read_b64_tr_b16 a[30:31], v177 offset:12800
ds_read_b64_tr_b16 a[32:33], v178 offset:0
ds_read_b64_tr_b16 a[34:35], v178 offset:512
ds_read_b64_tr_b16 a[36:37], v178 offset:4096
ds_read_b64_tr_b16 a[38:39], v178 offset:4608
s_waitcnt lgkmcnt(15)
v_mfma_f32_16x16x32_bf16 v[204:207], a[4:7], v[224:227], 0
s_mov_b32 s51, -32
ds_read_b64_tr_b16 a[40:41], v178 offset:8192
v_xor_b32 v179, 96, v176
v_mfma_f32_16x16x32_bf16 v[204:207], a[8:11], v[220:223], v[204:207]
s_waitcnt lgkmcnt(14)
ds_read_b64_tr_b16 a[42:43], v178 offset:8704
v_add_u32 v176, 98176, v176
v_mfma_f32_16x16x32_bf16 v[204:207], a[12:15], v[232:235], v[204:207]
ds_read_b64_tr_b16 a[44:45], v178 offset:12288
v_lshrrev_b32 v80, 3, v168
v_mfma_f32_16x16x32_bf16 v[204:207], a[0:3], v[228:231], v[204:207]
ds_read_b64_tr_b16 a[46:47], v178 offset:12800
v_lshlrev_b32 v174, 8, v80
v_mfma_f32_16x16x32_bf16 v[208:211], a[0:3], v[188:191], 0
ds_read_b64_tr_b16 a[48:49], v179 offset:0
v_and_b32 v81, 7, v168
v_mfma_f32_16x16x32_bf16 v[208:211], a[4:7], v[192:195], v[208:211]
s_waitcnt lgkmcnt(15)
ds_read_b64_tr_b16 a[50:51], v179 offset:512
v_cvt_pk_bf16_f32 v152, v204, v205
v_mfma_f32_16x16x32_bf16 v[208:211], a[8:11], v[196:199], v[208:211]
s_waitcnt lgkmcnt(10)
ds_read_b64_tr_b16 a[52:53], v179 offset:4096
v_cvt_pk_bf16_f32 v153, v206, v207
v_mfma_f32_16x16x32_bf16 v[208:211], a[12:15], v[200:203], v[208:211]
ds_read_b64_tr_b16 a[54:55], v179 offset:4608
v_lshl_add_u32 v174, v81, 4, v174
v_mfma_f32_16x16x32_bf16 v[212:215], a[28:31], v[200:203], 0
ds_read_b64_tr_b16 a[56:57], v179 offset:8192
v_add_u32 v177, 98176, v177
v_mfma_f32_16x16x32_bf16 v[212:215], a[24:27], v[196:199], v[212:215]
ds_read_b64_tr_b16 a[58:59], v179 offset:8704
v_xor_b32 v174, v174, v180
v_mfma_f32_16x16x32_bf16 v[212:215], a[20:23], v[192:195], v[212:215]
ds_read_b64_tr_b16 a[60:61], v179 offset:12288
v_cvt_pk_bf16_f32 v96, v208, v209
v_mfma_f32_16x16x32_bf16 v[212:215], a[16:19], v[188:191], v[212:215]
s_waitcnt lgkmcnt(13)
ds_read_b64_tr_b16 a[62:63], v179 offset:12800
v_cvt_pk_bf16_f32 v97, v210, v211
v_mfma_f32_16x16x32_bf16 v[204:207], a[16:19], v[228:231], 0
s_waitcnt vmcnt(4)
s_barrier
v_mfma_f32_16x16x32_bf16 v[204:207], a[28:31], v[232:235], v[204:207]
s_waitcnt lgkmcnt(10)
ds_read_b64_tr_b16 a[64:65], v176 offset:0
v_xor_b32 v180, v175, v180
v_mfma_f32_16x16x32_bf16 v[204:207], a[24:27], v[220:223], v[204:207]
s_waitcnt lgkmcnt(10)
ds_read_b64_tr_b16 a[66:67], v176 offset:512
v_add_u32 v178, 98176, v178
v_mfma_f32_16x16x32_bf16 v[204:207], a[20:23], v[224:227], v[204:207]
s_waitcnt lgkmcnt(10)
ds_read_b64_tr_b16 a[68:69], v176 offset:4096
v_add_u32 v179, 98176, v179
v_mfma_f32_16x16x32_bf16 v[208:211], a[36:39], v[224:227], 0
s_waitcnt lgkmcnt(10)
ds_read_b64_tr_b16 a[70:71], v176 offset:4608
v_and_b32 v88, 1, v168
v_mfma_f32_16x16x32_bf16 v[208:211], a[40:43], v[220:223], v[208:211]
s_waitcnt lgkmcnt(10)
ds_read_b64_tr_b16 a[72:73], v176 offset:8192
v_cvt_pk_bf16_f32 v154, v204, v205
v_mfma_f32_16x16x32_bf16 v[208:211], a[44:47], v[232:235], v[208:211]
s_waitcnt lgkmcnt(10)
ds_read_b64_tr_b16 a[74:75], v176 offset:8704
v_cvt_pk_bf16_f32 v155, v206, v207
v_mfma_f32_16x16x32_bf16 v[208:211], a[32:35], v[228:231], v[208:211]
s_waitcnt lgkmcnt(10)
ds_read_b64_tr_b16 a[76:77], v176 offset:12288
v_mov_b32 v236, 0
v_mfma_f32_16x16x32_bf16 v[204:207], a[32:35], v[188:191], 0
s_waitcnt lgkmcnt(10)
ds_read_b64_tr_b16 a[78:79], v176 offset:12800
v_cvt_pk_bf16_f32 v98, v212, v213
v_mfma_f32_16x16x32_bf16 v[204:207], a[36:39], v[192:195], v[204:207]
s_waitcnt lgkmcnt(10)
ds_read_b64_tr_b16 a[80:81], v177 offset:0
v_cvt_pk_bf16_f32 v156, v208, v209
v_mfma_f32_16x16x32_bf16 v[204:207], a[40:43], v[196:199], v[204:207]
s_waitcnt lgkmcnt(9)
ds_read_b64_tr_b16 a[82:83], v177 offset:512
v_cvt_pk_bf16_f32 v157, v210, v211
v_mfma_f32_16x16x32_bf16 v[204:207], a[44:47], v[200:203], v[204:207]
buffer_load_dwordx4 v180, s[32:35], s54 offen offset:0 lds
v_mfma_f32_16x16x32_bf16 v[208:211], a[60:63], v[200:203], 0
buffer_load_dwordx4 v180, s[32:35], s54 offen offset:1024 lds
v_mfma_f32_16x16x32_bf16 v[208:211], a[52:55], v[192:195], v[208:211]
ds_read_b64_tr_b16 a[84:85], v177 offset:4096
v_cvt_pk_bf16_f32 v99, v214, v215
v_mfma_f32_16x16x32_bf16 v[208:211], a[48:51], v[188:191], v[208:211]
s_waitcnt lgkmcnt(10)
ds_read_b64_tr_b16 a[86:87], v177 offset:4608
v_cvt_pk_bf16_f32 v100, v204, v205
v_mfma_f32_16x16x32_bf16 v[208:211], a[56:59], v[196:199], v[208:211]
s_waitcnt lgkmcnt(10)
ds_read_b64_tr_b16 a[88:89], v177 offset:8192
v_cvt_pk_bf16_f32 v101, v206, v207
v_mfma_f32_16x16x32_bf16 v[204:207], a[56:59], v[220:223], 0
s_waitcnt lgkmcnt(10)
ds_read_b64_tr_b16 a[90:91], v177 offset:8704
v_lshrrev_b32 v91, 5, v168
v_mfma_f32_16x16x32_bf16 v[204:207], a[60:63], v[232:235], v[204:207]
s_waitcnt lgkmcnt(10)
ds_read_b64_tr_b16 a[92:93], v177 offset:12288
v_cvt_pk_bf16_f32 v102, v208, v209
v_mfma_f32_16x16x32_bf16 v[204:207], a[52:55], v[224:227], v[204:207]
s_waitcnt lgkmcnt(10)
ds_read_b64_tr_b16 a[94:95], v177 offset:12800
v_cvt_pk_bf16_f32 v103, v210, v211
v_mfma_f32_16x16x32_bf16 v[204:207], a[48:51], v[228:231], v[204:207]
s_waitcnt lgkmcnt(10)
ds_read_b64_tr_b16 a[96:97], v178 offset:0
v_lshlrev_b32 v16, 4, v86
v_mfma_f32_16x16x32_bf16 v[208:211], a[64:67], v[228:231], 0
s_waitcnt lgkmcnt(10)
ds_read_b64_tr_b16 a[98:99], v178 offset:512
v_bfe_u32 v87, v168, 1, 1
v_mfma_f32_16x16x32_bf16 v[208:211], a[68:71], v[224:227], v[208:211]
s_waitcnt lgkmcnt(10)
ds_read_b64_tr_b16 a[100:101], v178 offset:4096
v_cvt_pk_bf16_f32 v158, v204, v205
v_mfma_f32_16x16x32_bf16 v[208:211], a[72:75], v[220:223], v[208:211]
s_waitcnt lgkmcnt(10)
ds_read_b64_tr_b16 a[102:103], v178 offset:4608
v_cvt_pk_bf16_f32 v159, v206, v207
v_mfma_f32_16x16x32_bf16 v[208:211], a[76:79], v[232:235], v[208:211]
s_waitcnt lgkmcnt(10)
ds_read_b64_tr_b16 a[104:105], v178 offset:8192
v_lshlrev_b32 v92, 5, v84
v_mfma_f32_16x16x32_bf16 v[204:207], a[76:79], v[200:203], 0
buffer_load_dwordx4 v180, s[32:35], s54 offen offset:2048 lds
v_mfma_f32_16x16x32_bf16 v[204:207], a[64:67], v[188:191], v[204:207]
buffer_load_dwordx4 v180, s[32:35], s54 offen offset:3072 lds
v_mfma_f32_16x16x32_bf16 v[204:207], a[68:71], v[192:195], v[204:207]
s_waitcnt lgkmcnt(7)
ds_read_b64_tr_b16 a[106:107], v178 offset:8704
s_add_u32 m0, s98, 63744
v_mfma_f32_16x16x32_bf16 v[204:207], a[72:75], v[196:199], v[204:207]
ds_read_b64_tr_b16 a[108:109], v178 offset:12288
v_cvt_pk_bf16_f32 v40, v208, v209
v_cvt_pk_bf16_f32 v41, v210, v211
v_mfma_f32_16x16x32_bf16 v[208:211], a[88:91], v[196:199], 0
ds_read_b64_tr_b16 a[110:111], v178 offset:12800
v_lshlrev_b32 v93, 4, v87
v_mfma_f32_16x16x32_bf16 v[208:211], a[84:87], v[192:195], v[208:211]
s_waitcnt lgkmcnt(8)
ds_read_b64_tr_b16 a[112:113], v179 offset:0
v_cvt_pk_bf16_f32 v0, v204, v205
v_mfma_f32_16x16x32_bf16 v[208:211], a[80:83], v[188:191], v[208:211]
ds_read_b64_tr_b16 a[114:115], v179 offset:512
v_cvt_pk_bf16_f32 v1, v206, v207
v_mfma_f32_16x16x32_bf16 v[208:211], a[92:95], v[200:203], v[208:211]
ds_read_b64_tr_b16 a[116:117], v179 offset:4096
v_lshlrev_b32 v94, 4, v83
v_mfma_f32_16x16x32_bf16 v[204:207], a[92:95], v[232:235], 0
s_waitcnt lgkmcnt(10)
ds_read_b64_tr_b16 a[118:119], v179 offset:4608
v_and_b32 v95, 15, v168
v_mfma_f32_16x16x32_bf16 v[204:207], a[88:91], v[220:223], v[204:207]
s_waitcnt lgkmcnt(10)
ds_read_b64_tr_b16 a[120:121], v179 offset:8192
v_cvt_pk_bf16_f32 v2, v208, v209
v_mfma_f32_16x16x32_bf16 v[204:207], a[84:87], v[224:227], v[204:207]
s_waitcnt lgkmcnt(10)
ds_read_b64_tr_b16 a[122:123], v179 offset:8704
v_cvt_pk_bf16_f32 v3, v210, v211
v_mfma_f32_16x16x32_bf16 v[204:207], a[80:83], v[228:231], v[204:207]
s_waitcnt lgkmcnt(10)
ds_read_b64_tr_b16 a[124:125], v179 offset:12288
v_mov_b32 v169, 163024
v_mfma_f32_16x16x32_bf16 v[208:211], a[96:99], v[228:231], 0
s_waitcnt lgkmcnt(9)
ds_read_b64_tr_b16 a[126:127], v179 offset:12800
v_mov_b32 v184, 0
v_mfma_f32_16x16x32_bf16 v[208:211], a[100:103], v[224:227], v[208:211]
s_waitcnt lgkmcnt(8)
buffer_load_dwordx4 v180, s[32:35], s57 offen offset:0 lds
v_mfma_f32_16x16x32_bf16 v[208:211], a[104:107], v[220:223], v[208:211]
buffer_load_dwordx4 v180, s[32:35], s57 offen offset:1024 lds
v_mfma_f32_16x16x32_bf16 v[208:211], a[108:111], v[232:235], v[208:211]
v_cvt_pk_bf16_f32 v42, v204, v205
v_cvt_pk_bf16_f32 v43, v206, v207
v_mfma_f32_16x16x32_bf16 v[204:207], a[108:111], v[200:203], 0
s_mul_i32 s53, s41, 816
s_add_u32 s53, s53, 157696
v_lshl_add_u32 v249, v83, 6, s53
v_mfma_f32_16x16x32_bf16 v[204:207], a[96:99], v[188:191], v[204:207]
s_add_u32 s8, s53, 256
v_cvt_pk_bf16_f32 v44, v208, v209
v_cvt_pk_bf16_f32 v45, v210, v211
v_mfma_f32_16x16x32_bf16 v[204:207], a[100:103], v[192:195], v[204:207]
s_waitcnt lgkmcnt(2)
v_lshl_add_u32 v249, v88, 5, v249
v_lshl_add_u32 v249, v85, 4, v249
v_mfma_f32_16x16x32_bf16 v[204:207], a[104:107], v[196:199], v[204:207]
s_add_u32 s9, s53, 256
s_mov_b32 vcc_lo, 0x33333333
s_mov_b32 vcc_hi, 0xcccccccc
v_mfma_f32_16x16x32_bf16 v[208:211], a[120:123], v[196:199], 0
v_mov_b32 v166, s8
v_cndmask_b32 v249, v166, v249, vcc
v_mfma_f32_16x16x32_bf16 v[208:211], a[116:119], v[192:195], v[208:211]
s_waitcnt lgkmcnt(0)
v_cvt_pk_bf16_f32 v4, v204, v205
v_cvt_pk_bf16_f32 v5, v206, v207
v_mfma_f32_16x16x32_bf16 v[208:211], a[112:115], v[188:191], v[208:211]
s_mov_b32 s8, 272
v_lshl_add_u32 v166, v83, 2, s9
v_lshl_add_u32 v248, v82, 6, s53
v_mfma_f32_16x16x32_bf16 v[208:211], a[124:127], v[200:203], v[208:211]
s_lshl_b32 s53, s41, 8
v_mad_u32_u24 v166, v86, s8, v166
v_mov_b32 v251, 0x44444444
v_mfma_f32_16x16x32_bf16 v[188:191], a[124:127], v[232:235], 0
s_add_u32 s10, s53, 101376
ds_write_b32 v166, v236 offset:0
v_mfma_f32_16x16x32_bf16 v[188:191], a[120:123], v[220:223], v[188:191]
s_nop 0
v_cvt_pk_bf16_f32 v6, v208, v209
v_cvt_pk_bf16_f32 v7, v210, v211
v_mfma_f32_16x16x32_bf16 v[188:191], a[116:119], v[224:227], v[188:191]
buffer_load_dwordx4 v180, s[32:35], s57 offen offset:2048 lds
v_mfma_f32_16x16x32_bf16 v[188:191], a[112:115], v[228:231], v[188:191]
buffer_load_dwordx4 v180, s[32:35], s57 offen offset:3072 lds
v_mfma_f32_16x16x32_bf16 v[192:195], v[4:7], v[156:159], 0
s_add_u32 m0, s49, 4224
v_lshl_add_u32 v166, v168, 2, s10
v_bfe_u32 v89, v168, 3, 2
v_mfma_f32_16x16x32_bf16 v[192:195], v[0:3], v[152:155], v[192:195]
ds_write_b32 v166, v166 offset:0
v_mfma_f32_16x16x32_bf16 v[196:199], v[40:43], v[152:155], 0
v_cvt_pk_bf16_f32 v46, v188, v189
v_cvt_pk_bf16_f32 v47, v190, v191
s_mul_i32 s52, s41, 13824
s_add_u32 s52, s52, 102400
v_mfma_f32_16x16x32_bf16 v[196:199], v[44:47], v[156:159], v[196:199]
s_add_u32 s14, s52, 1072
v_lshl_add_u32 v164, v86, 7, s52
v_mov_b32 v166, s14
v_mfma_f32_16x16x32_bf16 v[188:191], v[44:47], v[100:103], 0
s_mov_b32 s14, 1728
v_lshl_add_u32 v164, v91, 4, v164
v_lshl_add_u32 v164, v85, 3, v164
v_mfma_f32_16x16x32_bf16 v[188:191], v[40:43], v[96:99], v[188:191]
s_add_u32 s13, s52, 512
v_mad_u32_u24 v164, v83, s14, v164
v_xor_b32 v164, v16, v164
v_mfma_f32_16x16x32_bf16 v[200:203], v[0:3], v[96:99], 0
s_waitcnt vmcnt(8) lgkmcnt(0)
s_barrier
v_mfma_f32_16x16x32_bf16 v[200:203], v[4:7], v[100:103], v[200:203]
s_add_u32 s12, s52, 1136
ds_read_b128 v[48:51], v242 offset:50688
ds_read_b128 v[52:55], v242 offset:50944
ds_read_b128 v[56:59], v242 offset:51200
ds_read_b128 v[60:63], v242 offset:51456
ds_read_b128 v[64:67], v242 offset:54912
ds_read_b128 v[68:71], v242 offset:55168
ds_read_b128 v[72:75], v242 offset:55424
ds_read_b128 v[76:79], v242 offset:55680
v_xor_b32 v165, 32, v164
v_exp_f32 v188, v188
v_exp_f32 v189, v189
v_exp_f32 v190, v190
v_exp_f32 v191, v191
v_lshl_add_u32 v245, v84, 8, s52
v_lshl_add_u32 v245, v87, 7, v245
v_lshl_add_u32 v245, v88, 6, v245
v_cvt_pk_bf16_f32 v130, v188, v189
s_waitcnt lgkmcnt(7)
v_mfma_f32_16x16x32_bf16 v[204:207], a[64:67], v[48:51], 0
s_waitcnt lgkmcnt(5)
buffer_load_dwordx4 v243, s[16:19], s99 offen offset:0 nt lds
v_mfma_f32_16x16x32_bf16 v[204:207], a[68:71], v[52:55], v[204:207]
s_waitcnt lgkmcnt(4)
buffer_load_dwordx4 v243, s[16:19], s100 offen offset:2112 nt lds
v_mfma_f32_16x16x32_bf16 v[204:207], a[72:75], v[56:59], v[204:207]
s_add_u32 m0, s49, 8448
s_add_u32 s99, s55, 8192
s_add_u32 s100, s55, 8128
v_mfma_f32_16x16x32_bf16 v[204:207], a[76:79], v[60:63], v[204:207]
s_add_u32 s7, s52, 1136
v_cvt_pk_bf16_f32 v131, v190, v191
v_lshl_add_u32 v245, v82, 4, v245
v_mfma_f32_16x16x32_bf16 v[208:211], a[92:95], v[60:63], 0
s_add_u32 s15, s52, 1072
v_xor_b32 v245, v92, v245
v_xor_b32 v245, v93, v245
v_mfma_f32_16x16x32_bf16 v[208:211], a[88:91], v[56:59], v[208:211]
v_cvt_pk_bf16_f32 v136, v204, v205
v_cvt_pk_bf16_f32 v138, v206, v207
v_mfma_f32_16x16x32_bf16 v[208:211], a[84:87], v[52:55], v[208:211]
ds_write_b32 v164, v136 offset:0
v_mfma_f32_16x16x32_bf16 v[208:211], a[80:83], v[48:51], v[208:211]
buffer_load_dwordx4 v243, s[16:19], s99 offen offset:0 nt lds
v_mfma_f32_16x16x32_bf16 v[204:207], a[96:99], v[48:51], 0
s_add_u32 s99, s55, 12288
buffer_load_dwordx4 v243, s[16:19], s100 offen offset:2112 nt lds
v_mfma_f32_16x16x32_bf16 v[204:207], a[100:103], v[52:55], v[204:207]
s_add_u32 m0, s49, 12672
s_add_u32 s100, s55, 12224
v_lshl_add_u32 v247, v83, 7, s13
v_mfma_f32_16x16x32_bf16 v[204:207], a[104:107], v[56:59], v[204:207]
s_waitcnt lgkmcnt(1)
v_cvt_pk_bf16_f32 v137, v208, v209
v_cvt_pk_bf16_f32 v139, v210, v211
v_mfma_f32_16x16x32_bf16 v[204:207], a[108:111], v[60:63], v[204:207]
ds_write_b32 v164, v137 offset:4
v_mfma_f32_16x16x32_bf16 v[212:215], a[124:127], v[60:63], 0
ds_write_b32 v164, v138 offset:64
v_mfma_f32_16x16x32_bf16 v[212:215], a[116:119], v[52:55], v[212:215]
ds_write_b32 v164, v139 offset:68
v_mfma_f32_16x16x32_bf16 v[212:215], a[112:115], v[48:51], v[212:215]
buffer_load_dwordx4 v243, s[16:19], s99 offen offset:0 nt lds
v_mfma_f32_16x16x32_bf16 v[212:215], a[120:123], v[56:59], v[212:215]
s_add_u32 s99, s55, 16384
buffer_load_dwordx4 v243, s[16:19], s100 offen offset:2112 nt lds
v_mfma_f32_16x16x32_bf16 v[208:211], a[56:59], v[56:59], 0
s_add_u32 m0, s49, 16896
s_add_u32 s100, s55, 16320
v_cvt_pk_bf16_f32 v140, v204, v205
v_mfma_f32_16x16x32_bf16 v[208:211], a[60:63], v[60:63], v[208:211]
ds_write_b32 v165, v140 offset:0
v_mfma_f32_16x16x32_bf16 v[208:211], a[52:55], v[52:55], v[208:211]
v_cvt_pk_bf16_f32 v142, v206, v207
v_cvt_pk_bf16_f32 v141, v212, v213
v_mfma_f32_16x16x32_bf16 v[208:211], a[48:51], v[48:51], v[208:211]
ds_write_b32 v165, v141 offset:4
v_mfma_f32_16x16x32_bf16 v[204:207], a[32:35], v[48:51], 0
ds_write_b32 v165, v142 offset:64
v_mfma_f32_16x16x32_bf16 v[204:207], a[36:39], v[52:55], v[204:207]
buffer_load_dwordx4 v243, s[16:19], s99 offen offset:0 nt lds
v_mfma_f32_16x16x32_bf16 v[204:207], a[40:43], v[56:59], v[204:207]
buffer_load_dwordx4 v243, s[16:19], s100 offen offset:2112 nt lds
v_mfma_f32_16x16x32_bf16 v[204:207], a[44:47], v[60:63], v[204:207]
s_add_u32 m0, s98, 59648
v_cvt_pk_bf16_f32 v143, v214, v215
v_cvt_pk_bf16_f32 v149, v208, v209
v_mfma_f32_16x16x32_bf16 v[212:215], a[28:31], v[60:63], 0
ds_write_b32 v165, v143 offset:68
v_mfma_f32_16x16x32_bf16 v[212:215], a[24:27], v[56:59], v[212:215]
s_waitcnt vmcnt(8)
s_barrier
v_mfma_f32_16x16x32_bf16 v[212:215], a[20:23], v[52:55], v[212:215]
ds_read_b128 v[238:241], v245 offset:0
v_cvt_pk_bf16_f32 v151, v210, v211
v_mfma_f32_16x16x32_bf16 v[212:215], a[16:19], v[48:51], v[212:215]
v_cvt_pk_bf16_f32 v148, v204, v205
v_cvt_pk_bf16_f32 v150, v206, v207
v_mfma_f32_16x16x32_bf16 v[208:211], a[0:3], v[48:51], 0
s_add_u32 s58, s53, 36096
s_xor_b32 s59, s53, 256
s_add_u32 s59, s59, 36096
v_mfma_f32_16x16x32_bf16 v[208:211], a[8:11], v[56:59], v[208:211]
s_mul_i32 s53, s43, 25344
v_cvt_pk_bf16_f32 v145, v212, v213
v_cvt_pk_bf16_f32 v147, v214, v215
v_mfma_f32_16x16x32_bf16 v[208:211], a[12:15], v[60:63], v[208:211]
s_add_u32 s11, s53, 59648
v_lshl_add_u32 v247, v88, 6, v247
v_lshl_add_u32 v247, v82, 4, v247
v_mfma_f32_16x16x32_bf16 v[208:211], a[4:7], v[52:55], v[208:211]
s_lshl_b32 s53, s43, 7
s_mov_b32 vcc_lo, 0x33333333
s_mov_b32 vcc_hi, 0x33333333
v_mfma_f32_16x16x32_bf16 v[204:207], a[4:7], v[68:71], 0
v_xor_b32 v247, v94, v247
v_lshl_add_u32 v244, v81, 8, s53
v_mfma_f32_16x16x32_bf16 v[204:207], a[0:3], v[64:67], v[204:207]
s_lshl_b32 s53, s41, 9
v_cvt_pk_bf16_f32 v144, v208, v209
v_cvt_pk_bf16_f32 v146, v210, v211
v_mfma_f32_16x16x32_bf16 v[204:207], a[8:11], v[72:75], v[204:207]
s_add_u32 s9, s53, 160960
s_lshl_b32 s57, s43, 14
s_lshl_b32 s53, s42, 7
s_add_u32 s57, s57, s53
v_mfma_f32_16x16x32_bf16 v[204:207], a[12:15], v[76:79], v[204:207]
s_add_u32 s99, s57, 0
s_add_u32 s100, s57, 1024
v_cndmask_b32 v247, v166, v247, vcc
v_mfma_f32_16x16x32_bf16 v[208:211], v[136:139], v[144:147], 0
s_waitcnt lgkmcnt(0)
s_mov_b32 vcc_lo, 0xf0000f
s_mov_b32 vcc_hi, 0xf0000f00
v_mfma_f32_16x16x32_bf16 v[208:211], v[140:143], v[148:151], v[208:211]
v_lshl_add_u32 v167, v95, 4, s9
v_cndmask_b32 v167, v169, v167, vcc
s_mov_b32 vcc_lo, 0x33333333
s_mov_b32 vcc_hi, 0x33333333
v_mov_b32 v169, 0x3f803f80
v_cndmask_b32 v184, v184, v169, vcc
s_mov_b32 vcc_lo, 0xaaaaaaaa
s_mov_b32 vcc_hi, 0xaaaaaaaa
v_mov_b32 v169, 0xeeeeeeee
v_cndmask_b32 v251, v251, v169, vcc
s_mov_b32 vcc_lo, 0x0
s_mov_b32 vcc_hi, 0xaaaaaaaa
v_mov_b32 v169, 0xe4eeeeee
v_cndmask_b32 v251, v251, v169, vcc
v_mov_b64 v[212:213], s[96:97]
v_mov_b64 v[214:215], s[96:97]
v_mov_b64 v[216:217], s[96:97]
v_mov_b64 v[218:219], s[96:97]
v_smfmac_f32_16x16x64_bf16 v[212:215], v[238:241], v[152:159], v251
s_mov_b32 vcc_lo, 0xffff
s_mov_b32 vcc_hi, 0xffff
v_cvt_pk_bf16_f32 v32, v204, v205
v_smfmac_f32_16x16x64_bf16 v[216:219], v[238:241], v[96:103], v251
s_lshl_b32 s50, s43, 12
s_add_u32 s50, s50, s44
s_add_u32 s50, s50, 13107200
v_cvt_pk_bf16_f32 v34, v206, v207
v_mfma_f32_16x16x32_bf16 v[204:207], a[28:31], v[76:79], 0
v_lshl_add_u32 v182, v82, 10, s11
v_lshl_add_u32 v182, v83, 7, v182
v_mfma_f32_16x16x32_bf16 v[204:207], a[24:27], v[72:75], v[204:207]
v_lshl_add_u32 v182, v84, 6, v182
v_lshl_add_u32 v182, v86, 4, v182
v_mfma_f32_16x16x32_bf16 v[204:207], a[20:23], v[68:71], v[204:207]
ds_read_b64_tr_b16 a[144:145], v182 offset:8
v_xor_b32 v183, 64, v182
v_mfma_f32_16x16x32_bf16 v[204:207], a[16:19], v[64:67], v[204:207]
ds_read_b64_tr_b16 a[176:177], v183 offset:8
v_exp_f32 v208, v208
v_exp_f32 v209, v209
v_exp_f32 v210, v210
v_add_f32 v160, v208, v209
s_nop 2
v_cvt_pk_bf16_f32 v33, v204, v205
v_cvt_pk_bf16_f32 v35, v206, v207
v_mfma_f32_16x16x32_bf16 v[204:207], a[32:35], v[64:67], 0
ds_read_b64_tr_b16 a[178:179], v183 offset:520
v_cvt_pk_bf16_f32 v208, v208, v209
v_mfma_f32_16x16x32_bf16 v[204:207], a[36:39], v[68:71], v[204:207]
ds_read_b64_tr_b16 a[180:181], v183 offset:4104
v_bfe_u32 v90, v168, 2, 1
v_mfma_f32_16x16x32_bf16 v[204:207], a[40:43], v[72:75], v[204:207]
ds_read_b64_tr_b16 a[182:183], v183 offset:4616
v_lshl_add_u32 v246, v89, 7, s12
v_mfma_f32_16x16x32_bf16 v[204:207], a[44:47], v[76:79], v[204:207]
ds_read_b64_tr_b16 a[184:185], v183 offset:8200
v_lshl_add_u32 v246, v90, 6, v246
v_mfma_f32_16x16x32_bf16 v[188:191], a[60:63], v[76:79], 0
ds_read_b64_tr_b16 a[186:187], v183 offset:8712
v_lshl_add_u32 v246, v86, 3, v246
v_mfma_f32_16x16x32_bf16 v[188:191], a[52:55], v[68:71], v[188:191]
ds_read_b64_tr_b16 a[188:189], v183 offset:12296
v_lshl_add_u32 v246, v91, 2, v246
v_mfma_f32_16x16x32_bf16 v[188:191], a[48:51], v[64:67], v[188:191]
ds_read_b64_tr_b16 a[190:191], v183 offset:12808
v_cvt_pk_bf16_f32 v36, v204, v205
v_mfma_f32_16x16x32_bf16 v[188:191], a[56:59], v[72:75], v[188:191]
ds_read_b64_tr_b16 a[160:161], v183 offset:0
v_cvt_pk_bf16_f32 v38, v206, v207
v_mfma_f32_16x16x32_bf16 v[204:207], a[120:123], v[72:75], 0
s_waitcnt lgkmcnt(9)
ds_read_b64_tr_b16 a[162:163], v183 offset:512
v_mov_b32 v252, 0x0c0c0c0c
v_mfma_f32_16x16x32_bf16 v[204:207], a[124:127], v[76:79], v[204:207]
s_waitcnt lgkmcnt(9)
ds_read_b64_tr_b16 a[164:165], v183 offset:4096
v_cvt_pk_bf16_f32 v37, v188, v189
v_mfma_f32_16x16x32_bf16 v[204:207], a[116:119], v[68:71], v[204:207]
ds_read_b64_tr_b16 a[166:167], v183 offset:4608
v_cvt_pk_bf16_f32 v39, v190, v191
v_mfma_f32_16x16x32_bf16 v[204:207], a[112:115], v[64:67], v[204:207]
ds_read_b64_tr_b16 a[168:169], v183 offset:8192
v_mov_b32 v169, 0x07060302
v_mfma_f32_16x16x32_bf16 v[188:191], a[96:99], v[64:67], 0
ds_read_b64_tr_b16 a[170:171], v183 offset:8704
v_cndmask_b32 v252, v252, v169, vcc
v_mfma_f32_16x16x32_bf16 v[188:191], a[100:103], v[68:71], v[188:191]
s_waitcnt lgkmcnt(12)
ds_read_b64_tr_b16 a[172:173], v183 offset:12288
v_cvt_pk_bf16_f32 v29, v204, v205
v_mfma_f32_16x16x32_bf16 v[188:191], a[104:107], v[72:75], v[188:191]
s_waitcnt lgkmcnt(12)
ds_read_b64_tr_b16 a[174:175], v183 offset:12800
v_cvt_pk_bf16_f32 v31, v206, v207
v_mfma_f32_16x16x32_bf16 v[188:191], a[108:111], v[76:79], v[188:191]
s_waitcnt lgkmcnt(12)
ds_read_b64_tr_b16 a[146:147], v182 offset:520
v_add_f32 v212, v212, v213
v_mfma_f32_16x16x32_bf16 v[204:207], a[92:95], v[76:79], 0
s_waitcnt lgkmcnt(12)
ds_read_b64_tr_b16 a[148:149], v182 offset:4104
v_add_f32 v214, v214, v215
v_mfma_f32_16x16x32_bf16 v[204:207], a[88:91], v[72:75], v[204:207]
s_waitcnt lgkmcnt(12)
ds_read_b64_tr_b16 a[150:151], v182 offset:4616
v_cvt_pk_bf16_f32 v28, v188, v189
v_mfma_f32_16x16x32_bf16 v[204:207], a[84:87], v[68:71], v[204:207]
s_waitcnt lgkmcnt(12)
ds_read_b64_tr_b16 a[152:153], v182 offset:8200
v_cvt_pk_bf16_f32 v30, v190, v191
v_mfma_f32_16x16x32_bf16 v[204:207], a[80:83], v[64:67], v[204:207]
s_waitcnt lgkmcnt(12)
ds_read_b64_tr_b16 a[154:155], v182 offset:8712
v_mov_b32 v253, 0x0c0c0c0c
v_mfma_f32_16x16x32_bf16 v[188:191], a[64:67], v[64:67], 0
s_waitcnt lgkmcnt(12)
ds_read_b64_tr_b16 a[156:157], v182 offset:12296
v_mov_b32 v169, 0x07060302
v_mfma_f32_16x16x32_bf16 v[188:191], a[68:71], v[68:71], v[188:191]
s_waitcnt lgkmcnt(12)
ds_read_b64_tr_b16 a[158:159], v182 offset:12808
v_cvt_pk_bf16_f32 v25, v204, v205
v_mfma_f32_16x16x32_bf16 v[188:191], a[72:75], v[72:75], v[188:191]
s_waitcnt lgkmcnt(12)
ds_read_b64_tr_b16 a[128:129], v182 offset:0
v_cvt_pk_bf16_f32 v27, v206, v207
v_mfma_f32_16x16x32_bf16 v[188:191], a[76:79], v[76:79], v[188:191]
s_waitcnt lgkmcnt(12)
ds_read_b64_tr_b16 a[130:131], v182 offset:512
v_lshl_add_u32 v181, v95, 3, s7
v_mfma_f32_16x16x32_bf16 v[204:207], v[76:79], a[188:191], 0
s_waitcnt lgkmcnt(12)
ds_read_b64_tr_b16 a[132:133], v182 offset:4096
v_lshl_add_u32 v248, v87, 5, v248
v_mfma_f32_16x16x32_bf16 v[204:207], v[72:75], a[184:187], v[204:207]
s_waitcnt lgkmcnt(12)
ds_read_b64_tr_b16 a[134:135], v182 offset:4608
v_cvt_pk_bf16_f32 v24, v188, v189
v_mfma_f32_16x16x32_bf16 v[204:207], v[68:71], a[180:183], v[204:207]
s_waitcnt lgkmcnt(12)
ds_read_b64_tr_b16 a[136:137], v182 offset:8192
v_cvt_pk_bf16_f32 v26, v190, v191
v_mfma_f32_16x16x32_bf16 v[204:207], v[64:67], a[176:179], v[204:207]
s_waitcnt lgkmcnt(12)
ds_read_b64_tr_b16 a[138:139], v182 offset:8704
v_lshl_add_u32 v250, v95, 2, s52
v_mfma_f32_16x16x32_bf16 v[188:191], v[24:27], v[32:35], 0
s_waitcnt lgkmcnt(12)
ds_read_b64_tr_b16 a[140:141], v182 offset:12288
v_lshl_add_u32 v244, v84, 6, v244
v_mfma_f32_16x16x32_bf16 v[188:191], v[28:31], v[36:39], v[188:191]
s_waitcnt lgkmcnt(12)
ds_read_b64_tr_b16 a[142:143], v182 offset:12800
v_cvt_pk_bf16_f32 v14, v204, v205
v_cvt_pk_bf16_f32 v15, v206, v207
v_mfma_f32_16x16x32_bf16 v[204:207], v[64:67], a[160:163], 0
s_waitcnt lgkmcnt(12)
ds_write_b32 v167, v208 offset:0
v_mfma_f32_16x16x32_bf16 v[204:207], v[68:71], a[164:167], v[204:207]
s_waitcnt lgkmcnt(12)
v_exp_f32 v192, v192
v_mfma_f32_16x16x32_bf16 v[204:207], v[72:75], a[168:171], v[204:207]
s_waitcnt lgkmcnt(9)
v_exp_f32 v193, v193
v_mfma_f32_16x16x32_bf16 v[204:207], v[76:79], a[172:175], v[204:207]
v_exp_f32 v194, v194
v_exp_f32 v195, v195
v_cvt_pk_bf16_f32 v104, v192, v193
v_cvt_pk_bf16_f32 v105, v194, v195
v_mfma_f32_16x16x32_bf16 v[192:195], v[76:79], a[156:159], 0
s_waitcnt lgkmcnt(8)
v_exp_f32 v196, v196
v_mfma_f32_16x16x32_bf16 v[192:195], v[72:75], a[152:155], v[192:195]
s_waitcnt lgkmcnt(7)
v_cvt_pk_bf16_f32 v12, v204, v205
v_cvt_pk_bf16_f32 v13, v206, v207
v_mfma_f32_16x16x32_bf16 v[192:195], v[68:71], a[148:151], v[192:195]
s_waitcnt lgkmcnt(6)
v_exp_f32 v197, v197
v_mfma_f32_16x16x32_bf16 v[192:195], v[64:67], a[144:147], v[192:195]
s_waitcnt lgkmcnt(3)
v_exp_f32 v198, v198
v_mfma_f32_16x16x32_bf16 v[204:207], v[64:67], a[128:131], 0
s_waitcnt lgkmcnt(1)
v_exp_f32 v199, v199
v_mfma_f32_16x16x32_bf16 v[204:207], v[72:75], a[136:139], v[204:207]
v_cvt_pk_bf16_f32 v114, v196, v197
v_cvt_pk_bf16_f32 v115, v198, v199
v_mfma_f32_16x16x32_bf16 v[204:207], v[76:79], a[140:143], v[204:207]
v_cvt_pk_bf16_f32 v10, v192, v193
v_cvt_pk_bf16_f32 v11, v194, v195
v_mfma_f32_16x16x32_bf16 v[204:207], v[68:71], a[132:135], v[204:207]
v_exp_f32 v211, v211
v_mfma_f32_16x16x32_bf16 v[192:195], v[52:55], a[132:135], 0
v_cvt_pk_bf16_f32 v209, v210, v211
v_add_f32 v161, v210, v211
v_mfma_f32_16x16x32_bf16 v[192:195], v[48:51], a[128:131], v[192:195]
ds_write_b32 v167, v209 offset:4
v_mfma_f32_16x16x32_bf16 v[192:195], v[56:59], a[136:139], v[192:195]
s_waitcnt vmcnt(4)
s_barrier
v_mfma_f32_16x16x32_bf16 v[192:195], v[60:63], a[140:143], v[192:195]
v_cvt_pk_bf16_f32 v8, v204, v205
v_cvt_pk_bf16_f32 v9, v206, v207
v_mfma_f32_16x16x32_bf16 v[204:207], v[60:63], a[156:159], 0
v_add_f32 v210, v160, v161
v_mad_u32_u24 v181, v82, s14, v181
v_mfma_f32_16x16x32_bf16 v[204:207], v[56:59], a[152:155], v[204:207]
ds_write_b32 v167, v210 offset:8
v_mfma_f32_16x16x32_bf16 v[204:207], v[52:55], a[148:151], v[204:207]
v_cvt_pk_bf16_f32 v16, v192, v193
v_cvt_pk_bf16_f32 v17, v194, v195
v_mfma_f32_16x16x32_bf16 v[204:207], v[48:51], a[144:147], v[204:207]
v_exp_f32 v188, v188
v_mfma_f32_16x16x32_bf16 v[192:195], v[48:51], a[160:163], 0
ds_read_b128 v[208:211], v242 offset:0
v_lshl_add_u32 v248, v83, 3, v248
v_mfma_f32_16x16x32_bf16 v[192:195], v[52:55], a[164:167], v[192:195]
v_exp_f32 v189, v189
v_mfma_f32_16x16x32_bf16 v[192:195], v[56:59], a[168:171], v[192:195]
s_nop 0
v_cvt_pk_bf16_f32 v18, v204, v205
v_cvt_pk_bf16_f32 v19, v206, v207
v_mfma_f32_16x16x32_bf16 v[192:195], v[60:63], a[172:175], v[192:195]
v_add_f32 v160, v188, v189
v_cvt_pk_bf16_f32 v188, v188, v189
v_mfma_f32_16x16x32_bf16 v[204:207], v[60:63], a[188:191], 0
ds_write_b32 v167, v188 offset:256
v_mfma_f32_16x16x32_bf16 v[204:207], v[52:55], a[180:183], v[204:207]
v_exp_f32 v190, v190
v_mfma_f32_16x16x32_bf16 v[204:207], v[48:51], a[176:179], v[204:207]
v_exp_f32 v191, v191
v_mfma_f32_16x16x32_bf16 v[204:207], v[56:59], a[184:187], v[204:207]
v_cvt_pk_bf16_f32 v189, v190, v191
v_add_f32 v161, v190, v191
v_mfma_f32_16x16x32_bf16 v[196:199], v[220:223], a[184:187], 0
ds_write_b32 v167, v189 offset:260
v_mfma_f32_16x16x32_bf16 v[196:199], v[232:235], a[188:191], v[196:199]
v_add_f32 v190, v160, v161
v_cvt_pk_bf16_f32 v20, v192, v193
v_mfma_f32_16x16x32_bf16 v[196:199], v[224:227], a[180:183], v[196:199]
s_waitcnt lgkmcnt(1)
ds_write_b32 v167, v190 offset:264
v_mfma_f32_16x16x32_bf16 v[196:199], v[228:231], a[176:179], v[196:199]
s_mov_b32 vcc_lo, 0xffff0000
s_mov_b32 vcc_hi, 0xffff0000
v_cndmask_b32 v253, v253, v169, vcc
v_mfma_f32_16x16x32_bf16 v[188:191], v[228:231], a[160:163], 0
v_exp_f32 v212, v212
v_mfma_f32_16x16x32_bf16 v[188:191], v[224:227], a[164:167], v[188:191]
v_exp_f32 v214, v214
v_mfma_f32_16x16x32_bf16 v[188:191], v[220:223], a[168:171], v[188:191]
v_cvt_pk_bf16_f32 v94, v196, v197
v_cvt_pk_bf16_f32 v95, v198, v199
v_mfma_f32_16x16x32_bf16 v[188:191], v[232:235], a[172:175], v[188:191]
v_perm_b32 v116, v214, v212, v252
v_perm_b32 v117, v214, v212, v253
v_mfma_f32_16x16x32_bf16 v[196:199], v[232:235], a[156:159], 0
ds_read_b128 v[212:215], v242 offset:256
v_cvt_pk_bf16_f32 v21, v194, v195
v_mfma_f32_16x16x32_bf16 v[196:199], v[220:223], a[152:155], v[196:199]
ds_read_b128 v[192:195], v242 offset:512
v_cvt_pk_bf16_f32 v22, v204, v205
v_mfma_f32_16x16x32_bf16 v[196:199], v[224:227], a[148:151], v[196:199]
ds_write_b32 v181, v14 offset:7296
v_mfma_f32_16x16x32_bf16 v[196:199], v[228:231], a[144:147], v[196:199]
ds_write_b32 v181, v15 offset:7300
v_cvt_pk_bf16_f32 v90, v188, v189
v_cvt_pk_bf16_f32 v91, v190, v191
v_mfma_f32_16x16x32_bf16 v[188:191], v[228:231], a[128:131], 0
ds_write_b32 v181, v12 offset:7168
v_mfma_f32_16x16x32_bf16 v[188:191], v[220:223], a[136:139], v[188:191]
ds_write_b32 v181, v13 offset:7172
v_mfma_f32_16x16x32_bf16 v[188:191], v[232:235], a[140:143], v[188:191]
s_waitcnt lgkmcnt(5)
ds_write_b32 v181, v10 offset:7040
v_mfma_f32_16x16x32_bf16 v[188:191], v[224:227], a[132:135], v[188:191]
ds_write_b32 v181, v11 offset:7044
v_exp_f32 v200, v200
v_exp_f32 v201, v201
v_exp_f32 v202, v202
v_exp_f32 v203, v203
v_cvt_pk_bf16_f32 v120, v200, v201
v_cvt_pk_bf16_f32 v121, v202, v203
v_mfma_f32_16x16x32_bf16 v[200:203], v[212:215], a[132:135], 0
s_waitcnt lgkmcnt(6)
ds_read_b128 v[228:231], v242 offset:4224
v_cvt_pk_bf16_f32 v23, v206, v207
v_mfma_f32_16x16x32_bf16 v[200:203], v[208:211], a[128:131], v[200:203]
ds_read_b128 v[204:207], v242 offset:768
v_mad_u32_u24 v250, v82, s8, v250
v_mfma_f32_16x16x32_bf16 v[200:203], v[192:195], a[136:139], v[200:203]
ds_read_b128 v[224:227], v242 offset:4480
v_lshl_add_u32 v244, v82, 4, v244
v_cvt_pk_bf16_f32 v82, v188, v189
v_cvt_pk_bf16_f32 v83, v190, v191
v_cvt_pk_bf16_f32 v86, v196, v197
v_cvt_pk_bf16_f32 v87, v198, v199
s_mul_i32 s48, s43, 3168
s_add_u32 s49, s49, s48
s_add_u32 s49, s49, 50688
s_mov_b32 s48, 8192
ds_read_b128 v[220:223], v242 offset:4736
ds_read_b128 v[232:235], v242 offset:4992
v_add_f32 v216, v216, v217
v_add_f32 v218, v218, v219
v_exp_f32 v216, v216
v_lshl_add_u32 v166, v89, 2, s15
s_waitcnt lgkmcnt(3)
v_mfma_f32_16x16x32_bf16 v[200:203], v[204:207], a[140:143], v[200:203]
ds_write_b32 v181, v8 offset:6912
v_mfma_f32_16x16x32_bf16 v[188:191], v[204:207], a[156:159], 0
ds_write_b32 v181, v9 offset:6916
v_mfma_f32_16x16x32_bf16 v[188:191], v[192:195], a[152:155], v[188:191]
v_exp_f32 v218, v218
v_mfma_f32_16x16x32_bf16 v[188:191], v[212:215], a[148:151], v[188:191]
v_perm_b32 v132, v218, v216, v252
v_perm_b32 v133, v218, v216, v253
v_mfma_f32_16x16x32_bf16 v[188:191], v[208:211], a[144:147], v[188:191]
v_cvt_pk_bf16_f32 v48, v200, v201
v_cvt_pk_bf16_f32 v49, v202, v203
v_mfma_f32_16x16x32_bf16 v[196:199], v[208:211], a[160:163], 0
v_mad_u32_u24 v166, v81, s14, v166
v_lshl_add_u32 v248, v88, 1, v248
v_mfma_f32_16x16x32_bf16 v[196:199], v[212:215], a[164:167], v[196:199]
ds_write_b32 v166, v236 offset:0
v_mfma_f32_16x16x32_bf16 v[196:199], v[192:195], a[168:171], v[196:199]
v_cvt_pk_bf16_f32 v52, v188, v189
v_cvt_pk_bf16_f32 v53, v190, v191
v_mfma_f32_16x16x32_bf16 v[196:199], v[204:207], a[172:175], v[196:199]
s_waitcnt lgkmcnt(5)
v_mov_b32 v185, v184
v_mov_b32 v186, v184
v_mfma_f32_16x16x32_bf16 v[188:191], v[204:207], a[188:191], 0
buffer_load_dwordx4 v174, s[36:39], s99 offen offset:0 lds
v_mfma_f32_16x16x32_bf16 v[188:191], v[192:195], a[184:187], v[188:191]
s_add_u32 s99, s57, 2048
buffer_load_dwordx4 v174, s[36:39], s100 offen offset:1024 lds
v_mfma_f32_16x16x32_bf16 v[188:191], v[212:215], a[180:183], v[188:191]
s_waitcnt lgkmcnt(3)
s_add_u32 s100, s57, 3072
v_cvt_pk_bf16_f32 v56, v196, v197
v_mfma_f32_16x16x32_bf16 v[188:191], v[208:211], a[176:179], v[188:191]
v_cvt_pk_bf16_f32 v57, v198, v199
v_mov_b32 v187, v184
v_mfma_f32_16x16x32_bf16 v[192:195], a[64:67], v[228:231], 0
v_mov_b32 v118, 0
v_mov_b32 v119, 0
v_mfma_f32_16x16x32_bf16 v[192:195], a[68:71], v[224:227], v[192:195]
v_mov_b32 v255, 0
v_mov_b32 v134, 0
v_mfma_f32_16x16x32_bf16 v[192:195], a[72:75], v[220:223], v[192:195]
v_cvt_pk_bf16_f32 v60, v188, v189
v_cvt_pk_bf16_f32 v61, v190, v191
v_mfma_f32_16x16x32_bf16 v[192:195], a[76:79], v[232:235], v[192:195]
v_mov_b32 v135, 0
s_nop 0
v_mfma_f32_16x16x32_bf16 v[188:191], a[92:95], v[232:235], 0
buffer_load_dwordx4 v174, s[36:39], s99 offen offset:2048 lds
v_mfma_f32_16x16x32_bf16 v[188:191], a[88:91], v[220:223], v[188:191]
s_add_u32 s99, s57, 8192
buffer_load_dwordx4 v174, s[36:39], s100 offen offset:3072 lds
v_mfma_f32_16x16x32_bf16 v[188:191], a[84:87], v[224:227], v[188:191]
s_add_u32 m0, s98, 63744
s_add_u32 s100, s57, 9216
v_cvt_pk_bf16_f32 v8, v192, v193
v_mfma_f32_16x16x32_bf16 v[188:191], a[80:83], v[228:231], v[188:191]
v_cvt_pk_bf16_f32 v9, v194, v195
s_nop 0
v_mfma_f32_16x16x32_bf16 v[192:195], a[96:99], v[228:231], 0
ds_write_b32 v181, v16 offset:0
v_mfma_f32_16x16x32_bf16 v[192:195], a[100:103], v[224:227], v[192:195]
ds_write_b32 v181, v17 offset:4
v_mfma_f32_16x16x32_bf16 v[192:195], a[104:107], v[220:223], v[192:195]
s_nop 0
v_cvt_pk_bf16_f32 v10, v188, v189
v_cvt_pk_bf16_f32 v11, v190, v191
v_mfma_f32_16x16x32_bf16 v[192:195], a[108:111], v[232:235], v[192:195]
ds_write_b32 v181, v18 offset:128
v_mfma_f32_16x16x32_bf16 v[188:191], a[124:127], v[232:235], 0
buffer_load_dwordx4 v174, s[36:39], s99 offen offset:0 lds
v_mfma_f32_16x16x32_bf16 v[188:191], a[120:123], v[220:223], v[188:191]
s_add_u32 s99, s57, 10240
buffer_load_dwordx4 v174, s[36:39], s100 offen offset:1024 lds
v_mfma_f32_16x16x32_bf16 v[188:191], a[116:119], v[224:227], v[188:191]
s_add_u32 s100, s57, 11264
v_cvt_pk_bf16_f32 v12, v192, v193
v_cvt_pk_bf16_f32 v13, v194, v195
v_mfma_f32_16x16x32_bf16 v[188:191], a[112:115], v[228:231], v[188:191]
s_waitcnt vmcnt(6)
s_barrier
v_mfma_f32_16x16x32_bf16 v[192:195], v[228:231], a[128:131], 0
s_mov_b32 s98, s50
ds_write_b32 v181, v19 offset:132
v_mfma_f32_16x16x32_bf16 v[192:195], v[224:227], a[132:135], v[192:195]
s_nop 1
v_cvt_pk_bf16_f32 v14, v188, v189
v_mfma_f32_16x16x32_bf16 v[192:195], v[220:223], a[136:139], v[192:195]
v_cvt_pk_bf16_f32 v15, v190, v191
v_mfma_f32_16x16x32_bf16 v[192:195], v[232:235], a[140:143], v[192:195]
ds_write_b32 v181, v20 offset:256
v_mfma_f32_16x16x32_bf16 v[188:191], v[12:15], v[156:159], 0
buffer_load_dwordx4 v174, s[36:39], s99 offen offset:2048 lds
v_mfma_f32_16x16x32_bf16 v[188:191], v[8:11], v[152:155], v[188:191]
s_add_u32 s99, s98, s51
buffer_load_dwordx4 v174, s[36:39], s100 offen offset:3072 lds
v_mfma_f32_16x16x32_bf16 v[196:199], v[8:11], v[96:99], 0
s_add_u32 s100, s99, s51
ds_write_b32 v181, v21 offset:260
v_mfma_f32_16x16x32_bf16 v[196:199], v[12:15], v[100:103], v[196:199]
s_add_u32 m0, s49, 0
v_cvt_pk_bf16_f32 v50, v192, v193
v_cvt_pk_bf16_f32 v51, v194, v195
v_mfma_f32_16x16x32_bf16 v[200:203], v[232:235], a[156:159], 0
s_add_u32 s101, s100, s51
ds_read_b128 v[204:207], v242 offset:8448
ds_read_b128 v[208:211], v242 offset:8704
v_mfma_f32_16x16x32_bf16 v[200:203], v[220:223], a[152:155], v[200:203]
ds_read_b128 v[212:215], v242 offset:8960
ds_read_b128 v[192:195], v242 offset:9216
v_mfma_f32_16x16x32_bf16 v[200:203], v[224:227], a[148:151], v[200:203]
ds_write_b32 v181, v22 offset:384
v_mfma_f32_16x16x32_bf16 v[200:203], v[228:231], a[144:147], v[200:203]
ds_write_b32 v181, v23 offset:388
v_mfma_f32_16x16x32_bf16 v[216:219], v[228:231], a[160:163], 0
ds_read2_b32 v[236:237], v246 offset0:0 offset1:8
s_nop 0
v_mfma_f32_16x16x32_bf16 v[216:219], v[224:227], a[164:167], v[216:219]
v_exp_f32 v188, v188
v_mfma_f32_16x16x32_bf16 v[216:219], v[220:223], a[168:171], v[216:219]
v_exp_f32 v189, v189
v_mfma_f32_16x16x32_bf16 v[216:219], v[232:235], a[172:175], v[216:219]
v_exp_f32 v190, v190
v_exp_f32 v191, v191
v_cvt_pk_bf16_f32 v106, v188, v189
v_cvt_pk_bf16_f32 v107, v190, v191
v_mfma_f32_16x16x32_bf16 v[188:191], v[232:235], a[188:191], 0
v_cvt_pk_bf16_f32 v54, v200, v201
v_cvt_pk_bf16_f32 v55, v202, v203
v_mfma_f32_16x16x32_bf16 v[188:191], v[220:223], a[184:187], v[188:191]
v_exp_f32 v196, v196
v_mfma_f32_16x16x32_bf16 v[188:191], v[224:227], a[180:183], v[188:191]
s_waitcnt lgkmcnt(6)
v_exp_f32 v197, v197
v_mfma_f32_16x16x32_bf16 v[188:191], v[228:231], a[176:179], v[188:191]
s_waitcnt lgkmcnt(5)
v_exp_f32 v198, v198
v_mfma_f32_16x16x32_bf16 v[200:203], a[64:67], v[204:207], 0
s_waitcnt lgkmcnt(4)
v_exp_f32 v199, v199
v_mfma_f32_16x16x32_bf16 v[200:203], a[68:71], v[208:211], v[200:203]
s_waitcnt lgkmcnt(3)
v_cvt_pk_bf16_f32 v122, v196, v197
v_cvt_pk_bf16_f32 v62, v188, v189
v_mfma_f32_16x16x32_bf16 v[200:203], a[72:75], v[212:215], v[200:203]
v_cvt_pk_bf16_f32 v63, v190, v191
v_cvt_pk_bf16_f32 v123, v198, v199
v_mfma_f32_16x16x32_bf16 v[200:203], a[76:79], v[192:195], v[200:203]
v_cvt_pk_bf16_f32 v58, v216, v217
v_cvt_pk_bf16_f32 v59, v218, v219
v_mfma_f32_16x16x32_bf16 v[188:191], a[92:95], v[192:195], 0
s_waitcnt lgkmcnt(0)
ds_write_b32 v164, v144 offset:512
v_mfma_f32_16x16x32_bf16 v[188:191], a[88:91], v[212:215], v[188:191]
s_nop 1
v_cvt_pk_bf16_f32 v16, v200, v201
v_mfma_f32_16x16x32_bf16 v[188:191], a[84:87], v[208:211], v[188:191]
v_cvt_pk_bf16_f32 v17, v202, v203
v_mfma_f32_16x16x32_bf16 v[188:191], a[80:83], v[204:207], v[188:191]
ds_write_b32 v164, v145 offset:516
v_mfma_f32_16x16x32_bf16 v[196:199], a[96:99], v[204:207], 0
ds_write_b32 v164, v146 offset:576
v_mfma_f32_16x16x32_bf16 v[196:199], a[100:103], v[208:211], v[196:199]
ds_write_b32 v164, v147 offset:580
v_mfma_f32_16x16x32_bf16 v[196:199], a[104:107], v[212:215], v[196:199]
s_nop 1
v_cvt_pk_bf16_f32 v18, v188, v189
v_mfma_f32_16x16x32_bf16 v[196:199], a[108:111], v[192:195], v[196:199]
v_cvt_pk_bf16_f32 v19, v190, v191
s_nop 0
v_mfma_f32_16x16x32_bf16 v[188:191], a[124:127], v[192:195], 0
ds_write_b32 v165, v148 offset:512
v_mfma_f32_16x16x32_bf16 v[188:191], a[120:123], v[212:215], v[188:191]
ds_write_b32 v165, v149 offset:516
v_mfma_f32_16x16x32_bf16 v[188:191], a[116:119], v[208:211], v[188:191]
ds_write_b32 v165, v150 offset:576
v_mfma_f32_16x16x32_bf16 v[188:191], a[112:115], v[204:207], v[188:191]
ds_write_b32 v165, v151 offset:580
v_cvt_pk_bf16_f32 v20, v196, v197
v_cvt_pk_bf16_f32 v21, v198, v199
v_mfma_f32_16x16x32_bf16 v[196:199], v[204:207], a[128:131], 0
ds_write_b32 v164, v32 offset:7424
v_mfma_f32_16x16x32_bf16 v[196:199], v[208:211], a[132:135], v[196:199]
ds_write_b32 v164, v33 offset:7428
v_mfma_f32_16x16x32_bf16 v[196:199], v[212:215], a[136:139], v[196:199]
ds_write_b32 v164, v34 offset:7488
v_mfma_f32_16x16x32_bf16 v[196:199], v[192:195], a[140:143], v[196:199]
ds_write_b32 v164, v35 offset:7492
v_cvt_pk_bf16_f32 v22, v188, v189
v_cvt_pk_bf16_f32 v23, v190, v191
s_nop 1
v_mfma_f32_16x16x32_bf16 v[188:191], v[20:23], v[156:159], 0
ds_read_b128 v[228:231], v242 offset:16896
ds_read_b128 v[224:227], v242 offset:17152
v_mfma_f32_16x16x32_bf16 v[188:191], v[16:19], v[152:155], v[188:191]
ds_read_b128 v[220:223], v242 offset:17408
v_cvt_pk_bf16_f32 v64, v196, v197
v_mfma_f32_16x16x32_bf16 v[200:203], v[16:19], v[96:99], 0
ds_read_b128 v[232:235], v242 offset:17664
v_cvt_pk_bf16_f32 v65, v198, v199
v_mfma_f32_16x16x32_bf16 v[200:203], v[20:23], v[100:103], v[200:203]
ds_write_b32 v165, v36 offset:7424
v_mfma_f32_16x16x32_bf16 v[196:199], v[192:195], a[156:159], 0
ds_write_b32 v165, v37 offset:7428
v_mfma_f32_16x16x32_bf16 v[196:199], v[212:215], a[152:155], v[196:199]
ds_write_b32 v165, v38 offset:7488
v_mfma_f32_16x16x32_bf16 v[196:199], v[208:211], a[148:151], v[196:199]
ds_write_b32 v165, v39 offset:7492
v_mfma_f32_16x16x32_bf16 v[196:199], v[204:207], a[144:147], v[196:199]
v_exp_f32 v188, v188
v_mfma_f32_16x16x32_bf16 v[216:219], v[204:207], a[160:163], 0
v_exp_f32 v189, v189
v_mfma_f32_16x16x32_bf16 v[216:219], v[208:211], a[164:167], v[216:219]
v_exp_f32 v190, v190
v_mfma_f32_16x16x32_bf16 v[216:219], v[212:215], a[168:171], v[216:219]
v_exp_f32 v191, v191
v_mfma_f32_16x16x32_bf16 v[216:219], v[192:195], a[172:175], v[216:219]
v_cvt_pk_bf16_f32 v68, v196, v197
v_cvt_pk_bf16_f32 v69, v198, v199
v_mfma_f32_16x16x32_bf16 v[196:199], v[192:195], a[188:191], 0
v_cvt_pk_bf16_f32 v108, v188, v189
v_cvt_pk_bf16_f32 v109, v190, v191
v_mfma_f32_16x16x32_bf16 v[196:199], v[212:215], a[184:187], v[196:199]
s_waitcnt lgkmcnt(6)
v_exp_f32 v200, v200
v_mfma_f32_16x16x32_bf16 v[196:199], v[208:211], a[180:183], v[196:199]
s_waitcnt lgkmcnt(5)
v_cvt_pk_bf16_f32 v72, v216, v217
v_cvt_pk_bf16_f32 v73, v218, v219
v_mfma_f32_16x16x32_bf16 v[196:199], v[204:207], a[176:179], v[196:199]
s_waitcnt lgkmcnt(4)
v_exp_f32 v201, v201
v_mfma_f32_16x16x32_bf16 v[188:191], a[64:67], v[228:231], 0
v_exp_f32 v202, v202
v_mfma_f32_16x16x32_bf16 v[188:191], a[68:71], v[224:227], v[188:191]
v_exp_f32 v203, v203
v_mfma_f32_16x16x32_bf16 v[188:191], a[72:75], v[220:223], v[188:191]
s_nop 0
v_cvt_pk_bf16_f32 v76, v196, v197
v_cvt_pk_bf16_f32 v77, v198, v199
v_mfma_f32_16x16x32_bf16 v[188:191], a[76:79], v[232:235], v[188:191]
buffer_load_dwordx4 v243, s[16:19], s98 offen offset:0 nt lds
v_mfma_f32_16x16x32_bf16 v[192:195], a[92:95], v[232:235], 0
buffer_load_dwordx4 v243, s[16:19], s99 offen offset:1056 nt lds
v_mfma_f32_16x16x32_bf16 v[192:195], a[88:91], v[220:223], v[192:195]
v_cvt_pk_bf16_f32 v124, v200, v201
v_cvt_pk_bf16_f32 v125, v202, v203
v_mfma_f32_16x16x32_bf16 v[192:195], a[84:87], v[224:227], v[192:195]
s_nop 0
v_cvt_pk_bf16_f32 v32, v188, v189
v_cvt_pk_bf16_f32 v33, v190, v191
v_mfma_f32_16x16x32_bf16 v[192:195], a[80:83], v[228:231], v[192:195]
ds_write_b32 v164, v24 offset:6912
v_mfma_f32_16x16x32_bf16 v[188:191], a[96:99], v[228:231], 0
ds_write_b32 v164, v25 offset:6916
v_mfma_f32_16x16x32_bf16 v[188:191], a[100:103], v[224:227], v[188:191]
ds_write_b32 v164, v26 offset:6976
v_mfma_f32_16x16x32_bf16 v[188:191], a[104:107], v[220:223], v[188:191]
s_nop 1
v_cvt_pk_bf16_f32 v34, v192, v193
v_mfma_f32_16x16x32_bf16 v[188:191], a[108:111], v[232:235], v[188:191]
buffer_load_dwordx4 v243, s[16:19], s100 offen offset:2112 nt lds
v_cvt_pk_bf16_f32 v35, v194, v195
v_mfma_f32_16x16x32_bf16 v[192:195], a[124:127], v[232:235], 0
buffer_load_dwordx4 v243, s[16:19], s101 offen offset:3168 nt lds
v_mfma_f32_16x16x32_bf16 v[192:195], a[120:123], v[220:223], v[192:195]
ds_write_b32 v164, v27 offset:6980
v_mfma_f32_16x16x32_bf16 v[192:195], a[116:119], v[224:227], v[192:195]
s_nop 0
v_cvt_pk_bf16_f32 v36, v188, v189
v_cvt_pk_bf16_f32 v37, v190, v191
v_mfma_f32_16x16x32_bf16 v[192:195], a[112:115], v[228:231], v[192:195]
ds_write_b32 v165, v28 offset:6912
v_mfma_f32_16x16x32_bf16 v[188:191], v[228:231], a[128:131], 0
ds_write_b32 v165, v29 offset:6916
v_mfma_f32_16x16x32_bf16 v[188:191], v[224:227], a[132:135], v[188:191]
ds_write_b32 v165, v30 offset:6976
v_mfma_f32_16x16x32_bf16 v[188:191], v[220:223], a[136:139], v[188:191]
s_nop 1
v_cvt_pk_bf16_f32 v38, v192, v193
v_mfma_f32_16x16x32_bf16 v[188:191], v[232:235], a[140:143], v[188:191]
v_cvt_pk_bf16_f32 v39, v194, v195
s_nop 1
v_mfma_f32_16x16x32_bf16 v[192:195], v[36:39], v[156:159], 0
ds_write_b32 v165, v31 offset:6980
v_mfma_f32_16x16x32_bf16 v[192:195], v[32:35], v[152:155], v[192:195]
s_nop 1
v_cvt_pk_bf16_f32 v80, v188, v189
v_mfma_f32_16x16x32_bf16 v[196:199], v[32:35], v[96:99], 0
v_cvt_pk_bf16_f32 v81, v190, v191
s_nop 0
v_mfma_f32_16x16x32_bf16 v[196:199], v[36:39], v[100:103], v[196:199]
s_nop 0
v_exp_f32 v192, v192
v_mfma_f32_16x16x32_bf16 v[188:191], v[232:235], a[156:159], 0
ds_read_b128 v[200:203], v242 offset:12672
ds_read_b128 v[204:207], v242 offset:12928
v_mfma_f32_16x16x32_bf16 v[188:191], v[220:223], a[152:155], v[188:191]
ds_read_b128 v[208:211], v242 offset:13184
ds_read_b128 v[212:215], v242 offset:13440
v_mfma_f32_16x16x32_bf16 v[188:191], v[224:227], a[148:151], v[188:191]
v_exp_f32 v193, v193
v_mfma_f32_16x16x32_bf16 v[188:191], v[228:231], a[144:147], v[188:191]
v_exp_f32 v194, v194
v_mfma_f32_16x16x32_bf16 v[216:219], v[228:231], a[160:163], 0
v_exp_f32 v195, v195
v_mfma_f32_16x16x32_bf16 v[216:219], v[224:227], a[164:167], v[216:219]
v_cvt_pk_bf16_f32 v112, v192, v193
v_cvt_pk_bf16_f32 v113, v194, v195
v_mfma_f32_16x16x32_bf16 v[216:219], v[220:223], a[168:171], v[216:219]
s_nop 0
v_cvt_pk_bf16_f32 v84, v188, v189
v_cvt_pk_bf16_f32 v85, v190, v191
v_mfma_f32_16x16x32_bf16 v[216:219], v[232:235], a[172:175], v[216:219]
v_exp_f32 v196, v196
v_mfma_f32_16x16x32_bf16 v[188:191], v[232:235], a[188:191], 0
v_exp_f32 v197, v197
v_mfma_f32_16x16x32_bf16 v[188:191], v[220:223], a[184:187], v[188:191]
v_exp_f32 v198, v198
v_mfma_f32_16x16x32_bf16 v[188:191], v[224:227], a[180:183], v[188:191]
s_waitcnt lgkmcnt(3)
v_exp_f32 v199, v199
v_mfma_f32_16x16x32_bf16 v[188:191], v[228:231], a[176:179], v[188:191]
s_waitcnt lgkmcnt(2)
v_cvt_pk_bf16_f32 v128, v196, v197
v_cvt_pk_bf16_f32 v129, v198, v199
v_mfma_f32_16x16x32_bf16 v[192:195], a[64:67], v[200:203], 0
s_waitcnt vmcnt(4)
s_barrier
v_mfma_f32_16x16x32_bf16 v[192:195], a[68:71], v[204:207], v[192:195]
s_waitcnt lgkmcnt(0)
ds_read_b64_tr_b16 a[192:193], v182 offset:0
v_cvt_pk_bf16_f32 v92, v188, v189
v_mfma_f32_16x16x32_bf16 v[192:195], a[72:75], v[208:211], v[192:195]
ds_read_b64_tr_b16 a[194:195], v182 offset:512
v_cvt_pk_bf16_f32 v93, v190, v191
v_mfma_f32_16x16x32_bf16 v[192:195], a[76:79], v[212:215], v[192:195]
ds_read_b64_tr_b16 a[196:197], v182 offset:4096
v_cvt_pk_bf16_f32 v88, v216, v217
v_mfma_f32_16x16x32_bf16 v[188:191], a[92:95], v[212:215], 0
ds_read_b64_tr_b16 a[198:199], v182 offset:4608
v_cvt_pk_bf16_f32 v89, v218, v219
v_mfma_f32_16x16x32_bf16 v[188:191], a[88:91], v[208:211], v[188:191]
ds_read_b64_tr_b16 a[200:201], v182 offset:8192
v_mfma_f32_16x16x32_bf16 v[188:191], a[84:87], v[204:207], v[188:191]
ds_read_b64_tr_b16 a[202:203], v182 offset:8704
v_cvt_pk_bf16_f32 v24, v192, v193
v_mfma_f32_16x16x32_bf16 v[188:191], a[80:83], v[200:203], v[188:191]
ds_read_b64_tr_b16 a[204:205], v182 offset:12288
v_cvt_pk_bf16_f32 v25, v194, v195
v_mfma_f32_16x16x32_bf16 v[192:195], a[96:99], v[200:203], 0
ds_read_b64_tr_b16 a[206:207], v182 offset:12800
ds_read_b128 v[216:219], v247 offset:0
v_mfma_f32_16x16x32_bf16 v[192:195], a[100:103], v[204:207], v[192:195]
ds_read_b64_tr_b16 a[208:209], v182 offset:8
v_mfma_f32_16x16x32_bf16 v[192:195], a[104:107], v[208:211], v[192:195]
ds_read_b64_tr_b16 a[210:211], v182 offset:520
v_cvt_pk_bf16_f32 v26, v188, v189
v_mfma_f32_16x16x32_bf16 v[192:195], a[108:111], v[212:215], v[192:195]
ds_read_b64_tr_b16 a[212:213], v182 offset:4104
v_cvt_pk_bf16_f32 v27, v190, v191
v_mfma_f32_16x16x32_bf16 v[188:191], a[124:127], v[212:215], 0
ds_read_b64_tr_b16 a[214:215], v182 offset:4616
s_nop 0
v_mfma_f32_16x16x32_bf16 v[188:191], a[120:123], v[208:211], v[188:191]
ds_read_b64_tr_b16 a[216:217], v182 offset:8200
v_mfma_f32_16x16x32_bf16 v[188:191], a[116:119], v[204:207], v[188:191]
s_waitcnt lgkmcnt(13)
ds_read_b64_tr_b16 a[218:219], v182 offset:8712
v_cvt_pk_bf16_f32 v28, v192, v193
v_mfma_f32_16x16x32_bf16 v[188:191], a[112:115], v[200:203], v[188:191]
s_waitcnt lgkmcnt(13)
ds_read_b64_tr_b16 a[220:221], v182 offset:12296
v_cvt_pk_bf16_f32 v29, v194, v195
v_mfma_f32_16x16x32_bf16 v[192:195], v[200:203], a[128:131], 0
s_waitcnt lgkmcnt(13)
ds_read_b64_tr_b16 a[222:223], v182 offset:12808
s_nop 0
v_mfma_f32_16x16x32_bf16 v[192:195], v[204:207], a[132:135], v[192:195]
s_waitcnt lgkmcnt(13)
ds_read_b64_tr_b16 a[224:225], v183 offset:0
v_cvt_pk_bf16_f32 v30, v188, v189
v_mfma_f32_16x16x32_bf16 v[192:195], v[208:211], a[136:139], v[192:195]
s_waitcnt lgkmcnt(13)
ds_read_b64_tr_b16 a[226:227], v183 offset:512
v_cvt_pk_bf16_f32 v31, v190, v191
v_mfma_f32_16x16x32_bf16 v[192:195], v[212:215], a[140:143], v[192:195]
s_waitcnt lgkmcnt(13)
s_nop 1
v_mfma_f32_16x16x32_bf16 v[188:191], v[28:31], v[156:159], 0
s_waitcnt lgkmcnt(12)
s_nop 1
v_mfma_f32_16x16x32_bf16 v[188:191], v[24:27], v[152:155], v[188:191]
s_waitcnt lgkmcnt(10)
v_cvt_pk_bf16_f32 v66, v192, v193
v_cvt_pk_bf16_f32 v67, v194, v195
v_mfma_f32_16x16x32_bf16 v[192:195], v[24:27], v[96:99], 0
s_waitcnt lgkmcnt(9)
s_nop 1
v_mfma_f32_16x16x32_bf16 v[192:195], v[28:31], v[100:103], v[192:195]
s_waitcnt lgkmcnt(8)
v_mov_b64 v[168:169], 0
v_mov_b64 v[170:171], 0
v_mfma_f32_16x16x32_bf16 v[196:199], v[212:215], a[156:159], 0
s_waitcnt lgkmcnt(7)
v_mov_b64 v[172:173], 0
v_mov_b64 v[174:175], 0
v_mfma_f32_16x16x32_bf16 v[196:199], v[208:211], a[152:155], v[196:199]
s_waitcnt lgkmcnt(6)
v_mov_b64 v[176:177], 0
v_mov_b64 v[178:179], 0
v_mfma_f32_16x16x32_bf16 v[196:199], v[204:207], a[148:151], v[196:199]
s_waitcnt lgkmcnt(5)
v_exp_f32 v188, v188
v_mfma_f32_16x16x32_bf16 v[196:199], v[200:203], a[144:147], v[196:199]
s_waitcnt lgkmcnt(4)
ds_read_b128 v[152:155], v242 offset:21120
ds_read_b128 v[156:159], v242 offset:21376
v_smfmac_f32_16x16x64_bf16 v[168:171], v[216:219], v[0:7], v251
s_waitcnt lgkmcnt(5)
ds_read_b128 v[160:163], v242 offset:21632
ds_read_b128 v[164:167], v242 offset:21888
v_smfmac_f32_16x16x64_bf16 v[172:175], v[216:219], v[16:23], v251
s_waitcnt lgkmcnt(6)
ds_read_b64_tr_b16 a[228:229], v183 offset:4096
v_cvt_pk_bf16_f32 v70, v196, v197
v_smfmac_f32_16x16x64_bf16 v[176:179], v[216:219], v[32:39], v251
s_waitcnt lgkmcnt(6)
ds_read_b64_tr_b16 a[230:231], v183 offset:4608
v_cvt_pk_bf16_f32 v71, v198, v199
v_mfma_f32_16x16x32_bf16 v[196:199], v[200:203], a[160:163], 0
s_waitcnt lgkmcnt(6)
ds_read_b64_tr_b16 a[232:233], v183 offset:8192
v_add_f32 v168, v168, v169
v_mfma_f32_16x16x32_bf16 v[196:199], v[204:207], a[164:167], v[196:199]
ds_read_b64_tr_b16 a[234:235], v183 offset:8704
v_mfma_f32_16x16x32_bf16 v[196:199], v[208:211], a[168:171], v[196:199]
ds_read_b64_tr_b16 a[236:237], v183 offset:12288
v_mfma_f32_16x16x32_bf16 v[196:199], v[212:215], a[172:175], v[196:199]
ds_read_b64_tr_b16 a[238:239], v183 offset:12800
s_nop 0
v_smfmac_f32_16x16x64_bf16 v[170:173], v[216:219], v[8:15], v251
ds_read_b64_tr_b16 a[240:241], v183 offset:8
s_nop 0
v_smfmac_f32_16x16x64_bf16 v[174:177], v[216:219], v[24:31], v251
ds_read_b64_tr_b16 a[242:243], v183 offset:520
s_nop 0
v_smfmac_f32_16x16x64_bf16 v[178:181], v[216:219], v[40:47], v251
ds_read_b64_tr_b16 a[244:245], v183 offset:4104
v_cvt_pk_bf16_f32 v74, v196, v197
v_mfma_f32_16x16x32_bf16 v[216:219], v[212:215], a[188:191], 0
ds_read_b64_tr_b16 a[246:247], v183 offset:4616
v_mov_b64 v[196:197], 0
v_mfma_f32_16x16x32_bf16 v[216:219], v[208:211], a[184:187], v[216:219]
ds_read_b64_tr_b16 a[248:249], v183 offset:8200
v_cvt_pk_bf16_f32 v75, v198, v199
v_mfma_f32_16x16x32_bf16 v[216:219], v[204:207], a[180:183], v[216:219]
s_waitcnt lgkmcnt(13)
ds_read_b64_tr_b16 a[250:251], v183 offset:8712
ds_read_b128 v[204:207], v242 offset:512
v_mfma_f32_16x16x32_bf16 v[216:219], v[200:203], a[176:179], v[216:219]
s_waitcnt lgkmcnt(13)
ds_read_b64_tr_b16 a[252:253], v183 offset:12296
v_exp_f32 v189, v189
v_exp_f32 v190, v190
v_exp_f32 v191, v191
v_cvt_pk_bf16_f32 v110, v188, v189
v_cvt_pk_bf16_f32 v111, v190, v191
v_add_f32 v170, v170, v171
v_add_f32 v172, v172, v173
v_smfmac_f32_16x16x64_bf16 v[196:199], v[184:187], v[104:111], v251
s_waitcnt lgkmcnt(11)
ds_read_b64_tr_b16 a[254:255], v183 offset:12808
ds_read_b128 v[188:191], v242 offset:768
v_smfmac_f32_16x16x64_bf16 v[196:199], v[184:187], v[112:119], v251 abid:1
s_waitcnt lgkmcnt(12)
ds_read_b128 v[200:203], v242 offset:256
ds_read_b128 v[208:211], v242 offset:0
v_mfma_f32_16x16x32_bf16 v[136:139], a[192:195], v[152:155], 0
s_waitcnt lgkmcnt(13)
v_exp_f32 v168, v168
v_mfma_f32_16x16x32_bf16 v[136:139], a[196:199], v[156:159], v[136:139]
s_waitcnt lgkmcnt(12)
v_exp_f32 v170, v170
v_mfma_f32_16x16x32_bf16 v[136:139], a[200:203], v[160:163], v[136:139]
s_waitcnt lgkmcnt(11)
v_exp_f32 v172, v172
v_mfma_f32_16x16x32_bf16 v[136:139], a[204:207], v[164:167], v[136:139]
s_waitcnt lgkmcnt(10)
v_add_f32 v174, v174, v175
v_add_f32 v176, v176, v177
v_mfma_f32_16x16x32_bf16 v[140:143], a[220:223], v[164:167], 0
s_waitcnt lgkmcnt(3)
s_barrier
v_mfma_f32_16x16x32_bf16 v[140:143], a[216:219], v[160:163], v[140:143]
s_add_u32 s98, s98, s48
v_exp_f32 v174, v174
v_mfma_f32_16x16x32_bf16 v[140:143], a[212:215], v[156:159], v[140:143]
s_add_u32 s99, s98, s51
v_exp_f32 v176, v176
v_mfma_f32_16x16x32_bf16 v[140:143], a[208:211], v[152:155], v[140:143]
s_add_u32 s100, s99, s51
v_add_f32 v178, v178, v179
v_add_f32 v180, v168, v170
v_mfma_f32_16x16x32_bf16 v[144:147], a[224:227], v[152:155], 0
s_add_u32 m0, s49, 8448
v_cvt_pk_bf16_f32 v169, v168, v170
v_add_f32 v180, v180, v172
v_mfma_f32_16x16x32_bf16 v[144:147], a[228:231], v[156:159], v[144:147]
s_add_u32 s101, s100, s51
ds_write_b16 v248, v169 offset:0
v_mfma_f32_16x16x32_bf16 v[144:147], a[232:235], v[160:163], v[144:147]
s_waitcnt lgkmcnt(3)
ds_write_b16_d16_hi v248, v169 offset:4
v_mfma_f32_16x16x32_bf16 v[144:147], a[236:239], v[164:167], v[144:147]
buffer_load_dwordx4 v243, s[16:19], s98 offen offset:0 nt lds
v_mfma_f32_16x16x32_bf16 v[148:151], a[252:255], v[164:167], 0
buffer_load_dwordx4 v243, s[16:19], s99 offen offset:1056 nt lds
v_mfma_f32_16x16x32_bf16 v[148:151], a[244:247], v[156:159], v[148:151]
s_add_u32 s98, s98, s48
v_exp_f32 v178, v178
v_mfma_f32_16x16x32_bf16 v[148:151], a[240:243], v[152:155], v[148:151]
s_add_u32 s99, s98, s51
v_add_f32 v180, v180, v174
v_add_f32 v180, v180, v176
v_mfma_f32_16x16x32_bf16 v[148:151], a[248:251], v[160:163], v[148:151]
buffer_load_dwordx4 v243, s[16:19], s100 offen offset:2112 nt lds
v_mfma_f32_16x16x32_bf16 v[164:167], a[248:251], v[204:207], 0
buffer_load_dwordx4 v243, s[16:19], s101 offen offset:3168 nt lds
v_mfma_f32_16x16x32_bf16 v[164:167], a[252:255], v[188:191], v[164:167]
s_add_u32 s100, s99, s51
v_add_f32 v180, v180, v178
s_waitcnt lgkmcnt(3)
v_mfma_f32_16x16x32_bf16 v[164:167], a[244:247], v[200:203], v[164:167]
s_add_u32 m0, s49, 16896
v_cvt_pk_bf16_f32 v173, v172, v174
s_waitcnt lgkmcnt(2)
v_mfma_f32_16x16x32_bf16 v[164:167], a[240:243], v[208:211], v[164:167]
s_add_u32 s101, s100, s51
ds_write_b16 v248, v173 offset:272
v_add_f32_dpp v180, v180, v180 row_ror:8 row_mask:0xf bank_mask:0xf
v_cvt_pk_bf16_f32 v177, v176, v178
s_nop 0
v_add_f32_dpp v180, v180, v180 row_ror:4 row_mask:0xf bank_mask:0xf
ds_write_b16_d16_hi v248, v173 offset:276
ds_write_b16 v248, v177 offset:544
ds_write_b32 v250, v180 offset:256
ds_write_b16_d16_hi v248, v177 offset:548
v_add_f32 v196, v196, v197
v_cvt_pk_bf16_f32 v78, v216, v217
v_mfma_f32_32x32x16_bf16 v[168:183], v[236:239], v[116:119], 0
s_bfe_i32 s57, s3, 0x10000
v_rcp_f32 v254, v196
v_exp_f32 v192, v192
v_exp_f32 v193, v193
v_mfma_f32_16x16x32_bf16 v[160:163], a[224:227], v[208:211], 0
s_and_b32 s51, s57, 13106176
v_exp_f32 v194, v194
v_mfma_f32_16x16x32_bf16 v[160:163], a[228:231], v[200:203], v[160:163]
s_and_b32 s54, s57, s5
v_exp_f32 v195, v195
v_mfma_f32_16x16x32_bf16 v[160:163], a[232:235], v[204:207], v[160:163]
s_add_u32 s50, s50, 13107200
v_cvt_pk_bf16_f32 v126, v192, v193
v_cvt_pk_bf16_f32 v127, v194, v195
v_mfma_f32_16x16x32_bf16 v[160:163], a[236:239], v[188:191], v[160:163]
buffer_load_dwordx4 v243, s[16:19], s98 offen offset:0 nt lds
v_mfma_f32_16x16x32_bf16 v[156:159], a[220:223], v[188:191], 0
buffer_load_dwordx4 v243, s[16:19], s99 offen offset:1056 nt lds
v_mfma_f32_16x16x32_bf16 v[156:159], a[216:219], v[204:207], v[156:159]
s_lshl3_add_u32 s48, s51, 8192
v_cvt_pk_bf16_f32 v79, v218, v219
v_max3_f32 v255, v255, v196, v254
v_mfma_f32_16x16x32_bf16 v[156:159], a[212:215], v[200:203], v[156:159]
s_mov_b32 s47, s46
v_add_u32 v245, 1728, v245
v_add_u32 v246, 1728, v246
v_mfma_f32_16x16x32_bf16 v[156:159], a[208:211], v[208:211], v[156:159]
buffer_load_dwordx4 v243, s[16:19], s100 offen offset:2112 nt lds
v_mfma_f32_16x16x32_bf16 v[152:155], a[192:195], v[208:211], 0
buffer_load_dwordx4 v243, s[16:19], s101 offen offset:3168 nt lds
v_mfma_f32_16x16x32_bf16 v[152:155], a[196:199], v[200:203], v[152:155]
s_lshr_b32 s3, s3, 1
v_add_u32 v247, 1728, v247
s_sub_u32 s45, s45, 1
v_mfma_f32_16x16x32_bf16 v[152:155], a[200:203], v[204:207], v[152:155]
s_sub_u32 s50, s50, s54
s_add_u32 s52, s46, 20480
s_sub_u32 s49, s49, s56
v_mfma_f32_16x16x32_bf16 v[152:155], a[204:207], v[188:191], v[152:155]
s_sub_u32 s51, s51, 32
s_add_u32 s53, s46, 0
s_mov_b32 m0, s58
v_mfma_f32_16x16x32_bf16 v[168:171], v[48:51], v[104:107], v[168:171]
v_mfma_f32_16x16x32_bf16 v[168:171], v[64:67], v[108:111], v[168:171]
v_mfma_f32_16x16x32_bf16 v[168:171], v[80:83], v[112:115], v[168:171]
v_mfma_f32_16x16x32_bf16 v[172:175], v[84:87], v[112:115], v[172:175]
v_mfma_f32_16x16x32_bf16 v[172:175], v[52:55], v[104:107], v[172:175]
v_mfma_f32_16x16x32_bf16 v[172:175], v[68:71], v[108:111], v[172:175]
s_nop 7
s_waitcnt lgkmcnt(0)
s_branch L_entryf
L_spin:
ds_read_addtid_b32 v188 offset:65280
s_waitcnt lgkmcnt(0)
v_cmp_lt_u32 vcc, s45, v188
s_nop 1
s_cbranch_vccnz L_spin
s_branch L_back
.p2align 6
L_loopf:
v_mfma_f32_16x16x32_bf16 v[152:155], a[192:195], v[204:207], 0
s_mov_b32 m0, s59
v_cvt_pk_bf16_f32 v102, v232, v233
v_cvt_pk_bf16_f32 v103, v234, v235
v_mfma_f32_16x16x32_bf16 v[152:155], a[196:199], v[208:211], v[152:155]
s_add_u32 s52, s47, 8192
ds_read_addtid_b32 v188 offset:65280
v_cvt_pk_bf16_f32 v106, v200, v201
v_mfma_f32_16x16x32_bf16 v[152:155], a[200:203], v[212:215], v[152:155]
s_add_u32 s53, s47, 12288
v_cvt_pk_bf16_f32 v107, v202, v203
s_bfe_i32 s57, s3, 0x10000
v_mfma_f32_16x16x32_bf16 v[152:155], a[204:207], v[216:219], v[152:155]
s_mov_b32 s47, s46
v_exp_f32 v196, v196
v_mfma_f32_16x16x32_bf16 v[156:159], a[220:223], v[216:219], 0
s_and_b32 s54, s57, s5
v_exp_f32 v197, v197
v_mfma_f32_16x16x32_bf16 v[156:159], a[216:219], v[212:215], v[156:159]
s_lshr_b32 s3, s3, 1
v_exp_f32 v198, v198
v_mfma_f32_16x16x32_bf16 v[156:159], a[212:215], v[208:211], v[156:159]
v_exp_f32 v199, v199
v_mfma_f32_16x16x32_bf16 v[156:159], a[208:211], v[204:207], v[156:159]
s_waitcnt lgkmcnt(0)
v_cmp_lt_u32 vcc, s45, v188
v_cvt_pk_bf16_f32 v104, v196, v197
v_mfma_f32_16x16x32_bf16 v[160:163], a[224:227], v[204:207], 0
s_cbranch_vccnz L_spin
L_back:
ds_read_b128 v[188:191], v242 offset:0
v_cvt_pk_bf16_f32 v105, v198, v199
v_mfma_f32_16x16x32_bf16 v[160:163], a[228:231], v[208:211], v[160:163]
s_mov_b32 s98, s50
ds_read_b128 v[196:199], v242 offset:256
ds_read_b128 v[232:235], v242 offset:512
v_mfma_f32_16x16x32_bf16 v[160:163], a[232:235], v[212:215], v[160:163]
s_add_u32 s99, s98, s51
v_exp_f32 v192, v192
v_mfma_f32_16x16x32_bf16 v[160:163], a[236:239], v[216:219], v[160:163]
s_add_u32 s100, s99, s51
v_exp_f32 v193, v193
v_mfma_f32_16x16x32_bf16 v[164:167], a[252:255], v[216:219], 0
s_add_u32 m0, s49, 0
v_mov_b64 v[216:217], s[96:97]
v_mov_b64 v[218:219], s[96:97]
v_mfma_f32_16x16x32_bf16 v[164:167], a[248:251], v[212:215], v[164:167]
s_add_u32 s101, s100, s51
v_exp_f32 v194, v194
v_mfma_f32_16x16x32_bf16 v[164:167], a[244:247], v[208:211], v[164:167]
s_waitcnt lgkmcnt(2)
v_exp_f32 v195, v195
v_mfma_f32_16x16x32_bf16 v[164:167], a[240:243], v[204:207], v[164:167]
s_sub_u32 s45, s45, 1
v_cvt_pk_bf16_f32 v110, v192, v193
v_cvt_pk_bf16_f32 v111, v194, v195
v_smfmac_f32_16x16x64_bf16 v[216:219], v[238:241], v[96:103], v251
s_add_u32 s50, s50, 13107200
ds_read_b128 v[192:195], v242 offset:768
s_sub_u32 s50, s50, s54
v_mfma_f32_16x16x32_bf16 v[204:207], v[0:3], v[96:99], 0
v_exp_f32 v220, v220
v_mfma_f32_16x16x32_bf16 v[204:207], v[4:7], v[100:103], v[204:207]
v_exp_f32 v221, v221
v_mfma_f32_16x16x32_bf16 v[208:211], v[12:15], v[100:103], 0
v_exp_f32 v222, v222
v_mfma_f32_16x16x32_bf16 v[208:211], v[8:11], v[96:99], v[208:211]
s_waitcnt lgkmcnt(2)
v_exp_f32 v223, v223
v_mfma_f32_16x16x32_bf16 v[200:203], a[64:67], v[188:191], 0
s_waitcnt lgkmcnt(1)
v_cvt_pk_bf16_f32 v108, v220, v221
v_cvt_pk_bf16_f32 v109, v222, v223
v_mfma_f32_16x16x32_bf16 v[200:203], a[68:71], v[196:199], v[200:203]
s_waitcnt lgkmcnt(0)
v_exp_f32 v224, v224
v_mfma_f32_16x16x32_bf16 v[200:203], a[72:75], v[232:235], v[200:203]
v_exp_f32 v225, v225
v_mfma_f32_16x16x32_bf16 v[200:203], a[76:79], v[192:195], v[200:203]
v_exp_f32 v226, v226
v_mfma_f32_16x16x32_bf16 v[212:215], a[92:95], v[192:195], 0
v_exp_f32 v227, v227
v_mfma_f32_16x16x32_bf16 v[212:215], a[88:91], v[232:235], v[212:215]
v_cvt_pk_bf16_f32 v112, v224, v225
v_cvt_pk_bf16_f32 v113, v226, v227
v_mfma_f32_16x16x32_bf16 v[212:215], a[84:87], v[196:199], v[212:215]
s_nop 0
v_cvt_pk_bf16_f32 v0, v200, v201
v_cvt_pk_bf16_f32 v1, v202, v203
v_mfma_f32_16x16x32_bf16 v[212:215], a[80:83], v[188:191], v[212:215]
buffer_load_dwordx4 v243, s[16:19], s98 offen offset:0 nt lds
v_mfma_f32_16x16x32_bf16 v[220:223], a[96:99], v[188:191], 0
s_add_u32 s98, s98, s48
v_exp_f32 v228, v228
v_mfma_f32_16x16x32_bf16 v[220:223], a[100:103], v[196:199], v[220:223]
v_exp_f32 v229, v229
v_mfma_f32_16x16x32_bf16 v[220:223], a[104:107], v[232:235], v[220:223]
s_nop 0
v_cvt_pk_bf16_f32 v2, v212, v213
v_cvt_pk_bf16_f32 v3, v214, v215
v_mfma_f32_16x16x32_bf16 v[220:223], a[108:111], v[192:195], v[220:223]
v_mov_b64 v[200:201], 0
v_cvt_pk_bf16_f32 v114, v228, v229
v_mfma_f32_16x16x32_bf16 v[212:215], a[124:127], v[192:195], 0
v_exp_f32 v230, v230
v_mfma_f32_16x16x32_bf16 v[212:215], a[120:123], v[232:235], v[212:215]
v_exp_f32 v231, v231
v_mfma_f32_16x16x32_bf16 v[212:215], a[116:119], v[196:199], v[212:215]
v_cvt_pk_bf16_f32 v115, v230, v231
v_add_f32 v216, v216, v217
v_mfma_f32_16x16x32_bf16 v[212:215], a[112:115], v[188:191], v[212:215]
v_add_f32 v218, v218, v219
v_cvt_pk_bf16_f32 v4, v220, v221
v_smfmac_f32_16x16x64_bf16 v[200:203], v[184:187], v[104:111], v251
ds_read_b128 v[188:191], v242 offset:4992
v_cvt_pk_bf16_f32 v5, v222, v223
v_smfmac_f32_16x16x64_bf16 v[200:203], v[184:187], v[112:119], v251 abid:1
ds_read_b128 v[192:195], v242 offset:4736
ds_read_b128 v[196:199], v242 offset:4480
v_mfma_f32_16x16x32_bf16 v[168:171], v[80:83], v[112:115], v[168:171]
ds_read_b128 v[224:227], v242 offset:4224
v_cvt_pk_bf16_f32 v6, v212, v213
v_mfma_f32_16x16x32_bf16 v[168:171], v[64:67], v[108:111], v[168:171]
v_exp_f32 v216, v216
v_mfma_f32_16x16x32_bf16 v[168:171], v[48:51], v[104:107], v[168:171]
v_add_f32 v200, v200, v201
v_cvt_pk_bf16_f32 v7, v214, v215
v_mfma_f32_16x16x32_bf16 v[172:175], v[52:55], v[104:107], v[172:175]
v_rcp_f32 v254, v200
v_mfma_f32_16x16x32_bf16 v[172:175], v[68:71], v[108:111], v[172:175]
s_waitcnt lgkmcnt(3)
v_max3_f32 v255, v255, v200, v254
v_mfma_f32_16x16x32_bf16 v[172:175], v[84:87], v[112:115], v[172:175]
s_waitcnt lgkmcnt(2)
v_exp_f32 v218, v218
v_mfma_f32_16x16x32_bf16 v[176:179], v[88:91], v[112:115], v[176:179]
v_perm_b32 v132, v218, v216, v252
v_perm_b32 v133, v218, v216, v253
v_mfma_f32_16x16x32_bf16 v[176:179], v[72:75], v[108:111], v[176:179]
v_exp_f32 v204, v204
v_mfma_f32_16x16x32_bf16 v[176:179], v[56:59], v[104:107], v[176:179]
v_exp_f32 v205, v205
v_mfma_f32_16x16x32_bf16 v[180:183], v[60:63], v[104:107], v[180:183]
v_exp_f32 v206, v206
v_mfma_f32_16x16x32_bf16 v[180:183], v[76:79], v[108:111], v[180:183]
v_exp_f32 v207, v207
v_mfma_f32_16x16x32_bf16 v[180:183], v[92:95], v[112:115], v[180:183]
v_cvt_pk_bf16_f32 v120, v204, v205
v_cvt_pk_bf16_f32 v121, v206, v207
v_mfma_f32_16x16x32_bf16 v[200:203], v[36:39], v[100:103], 0
s_waitcnt lgkmcnt(1)
v_exp_f32 v208, v208
v_mfma_f32_16x16x32_bf16 v[200:203], v[32:35], v[96:99], v[200:203]
s_waitcnt lgkmcnt(0)
v_exp_f32 v209, v209
v_mfma_f32_16x16x32_bf16 v[216:219], v[16:19], v[96:99], 0
v_exp_f32 v210, v210
v_mfma_f32_16x16x32_bf16 v[216:219], v[20:23], v[100:103], v[216:219]
v_exp_f32 v211, v211
v_mfma_f32_16x16x32_bf16 v[220:223], a[124:127], v[188:191], 0
s_nop 0
v_exp_f32 v200, v200
v_mfma_f32_16x16x32_bf16 v[220:223], a[120:123], v[192:195], v[220:223]
v_exp_f32 v201, v201
v_mfma_f32_16x16x32_bf16 v[220:223], a[116:119], v[196:199], v[220:223]
v_exp_f32 v202, v202
v_mfma_f32_16x16x32_bf16 v[220:223], a[112:115], v[224:227], v[220:223]
buffer_load_dwordx4 v243, s[16:19], s99 offen offset:1056 nt lds
v_mfma_f32_16x16x32_bf16 v[228:231], a[96:99], v[224:227], 0
s_add_u32 s99, s98, s51
ds_read_b128 v[212:215], v242 offset:16896
v_cvt_pk_bf16_f32 v128, v200, v201
v_mfma_f32_16x16x32_bf16 v[228:231], a[100:103], v[196:199], v[228:231]
v_exp_f32 v203, v203
v_mfma_f32_16x16x32_bf16 v[228:231], a[104:107], v[192:195], v[228:231]
v_cvt_pk_bf16_f32 v129, v202, v203
v_cvt_pk_bf16_f32 v14, v220, v221
v_mfma_f32_16x16x32_bf16 v[228:231], a[108:111], v[188:191], v[228:231]
v_cvt_pk_bf16_f32 v15, v222, v223
v_cvt_pk_bf16_f32 v122, v208, v209
v_mfma_f32_16x16x32_bf16 v[232:235], a[92:95], v[188:191], 0
ds_read_b128 v[220:223], v242 offset:17152
v_cvt_pk_bf16_f32 v123, v210, v211
v_mfma_f32_16x16x32_bf16 v[232:235], a[88:91], v[192:195], v[232:235]
v_exp_f32 v216, v216
v_mfma_f32_16x16x32_bf16 v[232:235], a[84:87], v[196:199], v[232:235]
v_cvt_pk_bf16_f32 v12, v228, v229
v_cvt_pk_bf16_f32 v13, v230, v231
v_mfma_f32_16x16x32_bf16 v[232:235], a[80:83], v[224:227], v[232:235]
ds_read_b128 v[228:231], v242 offset:17408
v_fmac_f32 v136, v168, v254
v_mfma_f32_16x16x32_bf16 v[200:203], a[64:67], v[224:227], 0
ds_read_b128 v[224:227], v242 offset:17664
v_fmac_f32 v137, v169, v254
v_mfma_f32_16x16x32_bf16 v[200:203], a[68:71], v[196:199], v[200:203]
v_exp_f32 v217, v217
v_mfma_f32_16x16x32_bf16 v[200:203], a[72:75], v[192:195], v[200:203]
v_cvt_pk_bf16_f32 v10, v232, v233
v_cvt_pk_bf16_f32 v11, v234, v235
v_mfma_f32_16x16x32_bf16 v[200:203], a[76:79], v[188:191], v[200:203]
v_exp_f32 v218, v218
v_mfma_f32_16x16x32_bf16 v[188:191], v[28:31], v[100:103], 0
v_exp_f32 v219, v219
v_mfma_f32_16x16x32_bf16 v[188:191], v[24:27], v[96:99], v[188:191]
s_waitcnt lgkmcnt(3)
v_cvt_pk_bf16_f32 v124, v216, v217
v_cvt_pk_bf16_f32 v125, v218, v219
v_mfma_f32_16x16x32_bf16 v[192:195], v[40:43], v[96:99], 0
v_cvt_pk_bf16_f32 v8, v200, v201
v_cvt_pk_bf16_f32 v9, v202, v203
v_mfma_f32_16x16x32_bf16 v[192:195], v[44:47], v[100:103], v[192:195]
s_waitcnt lgkmcnt(2)
v_exp_f32 v188, v188
v_mfma_f32_16x16x32_bf16 v[196:199], a[64:67], v[212:215], 0
s_waitcnt lgkmcnt(1)
v_exp_f32 v189, v189
v_mfma_f32_16x16x32_bf16 v[196:199], a[68:71], v[220:223], v[196:199]
s_waitcnt lgkmcnt(0)
v_exp_f32 v190, v190
v_mfma_f32_16x16x32_bf16 v[196:199], a[72:75], v[228:231], v[196:199]
v_exp_f32 v191, v191
v_mfma_f32_16x16x32_bf16 v[196:199], a[76:79], v[224:227], v[196:199]
buffer_load_dwordx4 v243, s[16:19], s100 offen offset:2112 nt lds
v_mfma_f32_16x16x32_bf16 v[200:203], a[92:95], v[224:227], 0
s_add_u32 s100, s99, s51
ds_read_b128 v[208:211], v242 offset:8960
ds_read_b128 v[216:219], v242 offset:9216
v_mfma_f32_16x16x32_bf16 v[200:203], a[88:91], v[228:231], v[200:203]
ds_read_b128 v[204:207], v242 offset:8704
v_cvt_pk_bf16_f32 v126, v188, v189
v_mfma_f32_16x16x32_bf16 v[200:203], a[84:87], v[220:223], v[200:203]
v_cvt_pk_bf16_f32 v32, v196, v197
v_cvt_pk_bf16_f32 v33, v198, v199
v_mfma_f32_16x16x32_bf16 v[200:203], a[80:83], v[212:215], v[200:203]
ds_read_b128 v[196:199], v242 offset:8448
v_cvt_pk_bf16_f32 v127, v190, v191
v_mfma_f32_16x16x32_bf16 v[232:235], a[96:99], v[212:215], 0
v_exp_f32 v192, v192
v_mfma_f32_16x16x32_bf16 v[232:235], a[100:103], v[220:223], v[232:235]
v_exp_f32 v193, v193
v_mfma_f32_16x16x32_bf16 v[232:235], a[104:107], v[228:231], v[232:235]
s_nop 0
v_cvt_pk_bf16_f32 v34, v200, v201
v_cvt_pk_bf16_f32 v35, v202, v203
v_mfma_f32_16x16x32_bf16 v[232:235], a[108:111], v[224:227], v[232:235]
v_exp_f32 v194, v194
v_mfma_f32_16x16x32_bf16 v[200:203], a[124:127], v[224:227], 0
v_exp_f32 v195, v195
v_mfma_f32_16x16x32_bf16 v[200:203], a[116:119], v[220:223], v[200:203]
v_cvt_pk_bf16_f32 v130, v192, v193
v_cvt_pk_bf16_f32 v131, v194, v195
v_mfma_f32_16x16x32_bf16 v[200:203], a[112:115], v[212:215], v[200:203]
s_waitcnt lgkmcnt(3)
v_fmac_f32 v144, v176, v254
v_fmac_f32 v145, v177, v254
v_mfma_f32_16x16x32_bf16 v[200:203], a[120:123], v[228:231], v[200:203]
s_waitcnt lgkmcnt(2)
v_fmac_f32 v138, v170, v254
v_fmac_f32 v139, v171, v254
v_mfma_f32_16x16x32_bf16 v[212:215], a[120:123], v[208:211], 0
s_waitcnt lgkmcnt(1)
v_cvt_pk_bf16_f32 v136, v136, v137
v_fmac_f32 v146, v178, v254
v_mfma_f32_16x16x32_bf16 v[212:215], a[124:127], v[216:219], v[212:215]
s_waitcnt lgkmcnt(0)
v_fmac_f32 v147, v179, v254
v_cvt_pk_bf16_f32 v144, v144, v145
v_mfma_f32_16x16x32_bf16 v[212:215], a[116:119], v[204:207], v[212:215]
v_cvt_pk_bf16_f32 v137, v138, v139
v_fmac_f32 v140, v172, v254
v_mfma_f32_16x16x32_bf16 v[212:215], a[112:115], v[196:199], v[212:215]
v_fmac_f32 v141, v173, v254
v_fmac_f32 v142, v174, v254
v_mfma_f32_16x16x32_bf16 v[188:191], a[96:99], v[196:199], 0
v_fmac_f32 v143, v175, v254
v_fmac_f32 v148, v180, v254
v_mfma_f32_16x16x32_bf16 v[188:191], a[100:103], v[204:207], v[188:191]
v_fmac_f32 v149, v181, v254
v_fmac_f32 v150, v182, v254
v_mfma_f32_16x16x32_bf16 v[188:191], a[104:107], v[208:211], v[188:191]
v_fmac_f32 v151, v183, v254
v_cvt_pk_bf16_f32 v145, v146, v147
v_mfma_f32_16x16x32_bf16 v[188:191], a[108:111], v[216:219], v[188:191]
v_cvt_pk_bf16_f32 v138, v140, v141
v_cvt_pk_bf16_f32 v139, v142, v143
v_mfma_f32_16x16x32_bf16 v[192:195], a[92:95], v[216:219], 0
v_cvt_pk_bf16_f32 v146, v148, v149
v_cvt_pk_bf16_f32 v147, v150, v151
v_mfma_f32_16x16x32_bf16 v[192:195], a[88:91], v[208:211], v[192:195]
v_pk_max_i16 v136, v136, 0
v_pk_max_i16 v137, v137, 0
v_mfma_f32_16x16x32_bf16 v[192:195], a[84:87], v[204:207], v[192:195]
v_cvt_pk_bf16_f32 v20, v188, v189
v_cvt_pk_bf16_f32 v21, v190, v191
v_mfma_f32_16x16x32_bf16 v[192:195], a[80:83], v[196:199], v[192:195]
v_pk_max_i16 v138, v138, 0
v_pk_max_i16 v139, v139, 0
v_mfma_f32_16x16x32_bf16 v[188:191], a[64:67], v[196:199], 0
v_pk_max_i16 v144, v144, 0
v_pk_max_i16 v145, v145, 0
v_mfma_f32_16x16x32_bf16 v[188:191], a[68:71], v[204:207], v[188:191]
v_pk_max_i16 v146, v146, 0
v_pk_max_i16 v147, v147, 0
v_mfma_f32_16x16x32_bf16 v[188:191], a[72:75], v[208:211], v[188:191]
v_mov_b64 v[140:141], v[136:137]
v_mov_b64 v[142:143], v[138:139]
v_mfma_f32_16x16x32_bf16 v[188:191], a[76:79], v[216:219], v[188:191]
v_mov_b32_dpp v136, v144 row_ror:8 row_mask:0xf bank_mask:0xc
v_mov_b32_dpp v137, v145 row_ror:8 row_mask:0xf bank_mask:0xc
v_mov_b32_dpp v138, v146 row_ror:8 row_mask:0xf bank_mask:0xc
v_mov_b32_dpp v139, v147 row_ror:8 row_mask:0xf bank_mask:0xc
v_mov_b32_dpp v144, v140 row_ror:8 row_mask:0xf bank_mask:0x3
v_mov_b32_dpp v145, v141 row_ror:8 row_mask:0xf bank_mask:0x3
v_mov_b32_dpp v146, v142 row_ror:8 row_mask:0xf bank_mask:0x3
v_mov_b32_dpp v147, v143 row_ror:8 row_mask:0xf bank_mask:0x3
v_mfma_f32_32x32x16_bf16 v[168:183], v[236:239], v[132:135], 0
buffer_store_dwordx4 v[136:139], v244, s[20:23], s52 offen offset:0 nt
buffer_store_dwordx4 v[144:147], v244, s[20:23], s52 offen offset:2048 nt
v_cvt_pk_bf16_f32 v38, v200, v201
v_mov_b64 v[200:201], 0
v_cvt_pk_bf16_f32 v39, v202, v203
v_cvt_pk_bf16_f32 v16, v188, v189
v_smfmac_f32_16x16x64_bf16 v[200:203], v[184:187], v[120:127], v251
s_add_u32 s52, s46, 20480
v_cvt_pk_bf16_f32 v17, v190, v191
v_smfmac_f32_16x16x64_bf16 v[200:203], v[184:187], v[128:135], v251 abid:1
v_cvt_pk_bf16_f32 v18, v192, v193
v_mfma_f32_16x16x32_bf16 v[168:171], v[80:83], v[128:131], v[168:171]
v_cvt_pk_bf16_f32 v19, v194, v195
v_cvt_pk_bf16_f32 v22, v212, v213
v_mfma_f32_16x16x32_bf16 v[168:171], v[64:67], v[124:127], v[168:171]
v_cvt_pk_bf16_f32 v23, v214, v215
v_cvt_pk_bf16_f32 v36, v232, v233
v_mfma_f32_16x16x32_bf16 v[168:171], v[48:51], v[120:123], v[168:171]
v_add_f32 v200, v200, v201
v_cvt_pk_bf16_f32 v37, v234, v235
v_mfma_f32_16x16x32_bf16 v[172:175], v[52:55], v[120:123], v[172:175]
v_rcp_f32 v254, v200
v_mfma_f32_16x16x32_bf16 v[172:175], v[68:71], v[124:127], v[172:175]
v_max3_f32 v255, v255, v200, v254
s_nop 0
v_mfma_f32_16x16x32_bf16 v[172:175], v[84:87], v[128:131], v[172:175]
v_fmac_f32 v152, v168, v254
v_fmac_f32 v153, v169, v254
v_mfma_f32_16x16x32_bf16 v[176:179], v[88:91], v[128:131], v[176:179]
v_fmac_f32 v154, v170, v254
v_fmac_f32 v155, v171, v254
v_mfma_f32_16x16x32_bf16 v[176:179], v[72:75], v[124:127], v[176:179]
v_cvt_pk_bf16_f32 v152, v152, v153
v_cvt_pk_bf16_f32 v153, v154, v155
v_mfma_f32_16x16x32_bf16 v[176:179], v[56:59], v[120:123], v[176:179]
v_fmac_f32 v156, v172, v254
v_fmac_f32 v157, v173, v254
v_mfma_f32_16x16x32_bf16 v[180:183], v[60:63], v[120:123], v[180:183]
v_fmac_f32 v158, v174, v254
v_fmac_f32 v159, v175, v254
v_mfma_f32_16x16x32_bf16 v[180:183], v[76:79], v[124:127], v[180:183]
v_cvt_pk_bf16_f32 v154, v156, v157
v_cvt_pk_bf16_f32 v155, v158, v159
v_mfma_f32_16x16x32_bf16 v[180:183], v[92:95], v[128:131], v[180:183]
v_fmac_f32 v160, v176, v254
v_fmac_f32 v161, v177, v254
v_mfma_f32_16x16x32_bf16 v[188:191], v[196:199], a[128:131], 0
v_fmac_f32 v162, v178, v254
v_fmac_f32 v163, v179, v254
v_mfma_f32_16x16x32_bf16 v[188:191], v[204:207], a[132:135], v[188:191]
v_cvt_pk_bf16_f32 v160, v160, v161
v_cvt_pk_bf16_f32 v161, v162, v163
v_mfma_f32_16x16x32_bf16 v[188:191], v[208:211], a[136:139], v[188:191]
v_fmac_f32 v164, v180, v254
v_fmac_f32 v165, v181, v254
v_mfma_f32_16x16x32_bf16 v[188:191], v[216:219], a[140:143], v[188:191]
v_fmac_f32 v166, v182, v254
v_fmac_f32 v167, v183, v254
v_mfma_f32_16x16x32_bf16 v[192:195], v[216:219], a[156:159], 0
ds_read_b128 v[200:203], v242 offset:12672
ds_read_b128 v[212:215], v242 offset:12928
v_mfma_f32_16x16x32_bf16 v[192:195], v[208:211], a[152:155], v[192:195]
ds_read_b128 v[220:223], v242 offset:13184
ds_read_b128 v[224:227], v242 offset:13440
v_mfma_f32_16x16x32_bf16 v[192:195], v[204:207], a[148:151], v[192:195]
v_cvt_pk_bf16_f32 v64, v188, v189
v_cvt_pk_bf16_f32 v65, v190, v191
v_mfma_f32_16x16x32_bf16 v[192:195], v[196:199], a[144:147], v[192:195]
v_cvt_pk_bf16_f32 v162, v164, v165
v_cvt_pk_bf16_f32 v163, v166, v167
v_mfma_f32_16x16x32_bf16 v[228:231], v[196:199], a[160:163], 0
v_pk_max_i16 v152, v152, 0
v_pk_max_i16 v153, v153, 0
v_mfma_f32_16x16x32_bf16 v[228:231], v[204:207], a[164:167], v[228:231]
v_pk_max_i16 v154, v154, 0
v_pk_max_i16 v155, v155, 0
v_mfma_f32_16x16x32_bf16 v[228:231], v[208:211], a[168:171], v[228:231]
v_cvt_pk_bf16_f32 v68, v192, v193
v_cvt_pk_bf16_f32 v69, v194, v195
v_mfma_f32_16x16x32_bf16 v[228:231], v[216:219], a[172:175], v[228:231]
v_pk_max_i16 v160, v160, 0
v_pk_max_i16 v161, v161, 0
v_mfma_f32_16x16x32_bf16 v[188:191], v[216:219], a[188:191], 0
v_pk_max_i16 v162, v162, 0
v_pk_max_i16 v163, v163, 0
v_mfma_f32_16x16x32_bf16 v[188:191], v[208:211], a[184:187], v[188:191]
v_mov_b64 v[156:157], v[152:153]
v_mov_b64 v[158:159], v[154:155]
v_mfma_f32_16x16x32_bf16 v[188:191], v[204:207], a[180:183], v[188:191]
s_waitcnt lgkmcnt(3)
v_cvt_pk_bf16_f32 v72, v228, v229
v_cvt_pk_bf16_f32 v73, v230, v231
v_mfma_f32_16x16x32_bf16 v[188:191], v[196:199], a[176:179], v[188:191]
buffer_load_dwordx4 v243, s[16:19], s101 offen offset:3168 nt lds
v_mfma_f32_16x16x32_bf16 v[196:199], a[64:67], v[200:203], 0
s_add_u32 m0, s49, 8448
v_mov_b32_dpp v152, v160 row_ror:8 row_mask:0xf bank_mask:0xc
s_waitcnt lgkmcnt(2)
v_mfma_f32_16x16x32_bf16 v[196:199], a[68:71], v[212:215], v[196:199]
s_add_u32 s101, s100, s51
v_mov_b32_dpp v153, v161 row_ror:8 row_mask:0xf bank_mask:0xc
s_waitcnt lgkmcnt(1)
v_mfma_f32_16x16x32_bf16 v[196:199], a[72:75], v[220:223], v[196:199]
s_waitcnt lgkmcnt(0)
v_cvt_pk_bf16_f32 v76, v188, v189
v_cvt_pk_bf16_f32 v77, v190, v191
v_mfma_f32_16x16x32_bf16 v[196:199], a[76:79], v[224:227], v[196:199]
v_mov_b32_dpp v154, v162 row_ror:8 row_mask:0xf bank_mask:0xc
v_mov_b32_dpp v155, v163 row_ror:8 row_mask:0xf bank_mask:0xc
v_mfma_f32_16x16x32_bf16 v[204:207], a[92:95], v[224:227], 0
v_mov_b32_dpp v160, v156 row_ror:8 row_mask:0xf bank_mask:0x3
v_mov_b32_dpp v161, v157 row_ror:8 row_mask:0xf bank_mask:0x3
v_mfma_f32_16x16x32_bf16 v[204:207], a[88:91], v[220:223], v[204:207]
v_mov_b32_dpp v162, v158 row_ror:8 row_mask:0xf bank_mask:0x3
v_mov_b32_dpp v163, v159 row_ror:8 row_mask:0xf bank_mask:0x3
v_mfma_f32_16x16x32_bf16 v[204:207], a[84:87], v[212:215], v[204:207]
v_cvt_pk_bf16_f32 v24, v196, v197
v_cvt_pk_bf16_f32 v25, v198, v199
v_mfma_f32_16x16x32_bf16 v[204:207], a[80:83], v[200:203], v[204:207]
s_nop 2
v_mfma_f32_16x16x32_bf16 v[188:191], a[96:99], v[200:203], 0
s_nop 2
v_mfma_f32_16x16x32_bf16 v[188:191], a[100:103], v[212:215], v[188:191]
v_cvt_pk_bf16_f32 v26, v204, v205
v_cvt_pk_bf16_f32 v27, v206, v207
v_mfma_f32_16x16x32_bf16 v[188:191], a[104:107], v[220:223], v[188:191]
v_mfma_f32_16x16x32_bf16 v[188:191], a[108:111], v[224:227], v[188:191]
s_nop 2
v_mfma_f32_16x16x32_bf16 v[192:195], a[124:127], v[224:227], 0
s_nop 2
v_mfma_f32_16x16x32_bf16 v[192:195], a[120:123], v[220:223], v[192:195]
v_cvt_pk_bf16_f32 v28, v188, v189
v_cvt_pk_bf16_f32 v29, v190, v191
v_mfma_f32_16x16x32_bf16 v[192:195], a[116:119], v[212:215], v[192:195]
v_mfma_f32_16x16x32_bf16 v[192:195], a[112:115], v[200:203], v[192:195]
s_nop 2
v_mfma_f32_16x16x32_bf16 v[188:191], v[200:203], a[128:131], 0
s_nop 2
v_mfma_f32_16x16x32_bf16 v[188:191], v[212:215], a[132:135], v[188:191]
v_cvt_pk_bf16_f32 v30, v192, v193
v_cvt_pk_bf16_f32 v31, v194, v195
v_mfma_f32_16x16x32_bf16 v[188:191], v[220:223], a[136:139], v[188:191]
v_mfma_f32_16x16x32_bf16 v[188:191], v[224:227], a[140:143], v[188:191]
buffer_load_dwordx4 v243, s[16:19], s98 offen offset:0 nt lds
v_mfma_f32_16x16x32_bf16 v[192:195], v[224:227], a[156:159], 0
s_add_u32 s98, s98, s48
ds_read_b128 v[196:199], v242 offset:21120
ds_read_b128 v[204:207], v242 offset:21376
v_mfma_f32_16x16x32_bf16 v[192:195], v[220:223], a[152:155], v[192:195]
ds_read_b128 v[208:211], v242 offset:21632
ds_read_b128 v[216:219], v242 offset:21888
v_mfma_f32_16x16x32_bf16 v[192:195], v[212:215], a[148:151], v[192:195]
v_cvt_pk_bf16_f32 v66, v188, v189
v_cvt_pk_bf16_f32 v67, v190, v191
v_mfma_f32_16x16x32_bf16 v[192:195], v[200:203], a[144:147], v[192:195]
s_nop 2
v_mfma_f32_16x16x32_bf16 v[188:191], v[200:203], a[160:163], 0
s_nop 2
v_mfma_f32_16x16x32_bf16 v[188:191], v[212:215], a[164:167], v[188:191]
v_cvt_pk_bf16_f32 v70, v192, v193
v_cvt_pk_bf16_f32 v71, v194, v195
v_mfma_f32_16x16x32_bf16 v[188:191], v[220:223], a[168:171], v[188:191]
v_mfma_f32_16x16x32_bf16 v[188:191], v[224:227], a[172:175], v[188:191]
s_nop 2
v_mfma_f32_16x16x32_bf16 v[192:195], v[224:227], a[188:191], 0
s_nop 2
v_mfma_f32_16x16x32_bf16 v[192:195], v[220:223], a[184:187], v[192:195]
v_cvt_pk_bf16_f32 v74, v188, v189
v_cvt_pk_bf16_f32 v75, v190, v191
v_mfma_f32_16x16x32_bf16 v[192:195], v[212:215], a[180:183], v[192:195]
s_waitcnt lgkmcnt(3)
v_mfma_f32_16x16x32_bf16 v[192:195], v[200:203], a[176:179], v[192:195]
s_waitcnt lgkmcnt(2)
s_nop 1
v_mfma_f32_16x16x32_bf16 v[188:191], a[64:67], v[196:199], 0
s_waitcnt lgkmcnt(1)
s_nop 1
v_mfma_f32_16x16x32_bf16 v[188:191], a[68:71], v[204:207], v[188:191]
s_waitcnt lgkmcnt(0)
v_cvt_pk_bf16_f32 v78, v192, v193
v_cvt_pk_bf16_f32 v79, v194, v195
v_mfma_f32_16x16x32_bf16 v[188:191], a[72:75], v[208:211], v[188:191]
v_mfma_f32_16x16x32_bf16 v[188:191], a[76:79], v[216:219], v[188:191]
ds_read_b128 v[238:241], v245 offset:0
ds_read2_b32 v[236:237], v246 offset0:0 offset1:8
v_mfma_f32_16x16x32_bf16 v[192:195], a[92:95], v[216:219], 0
v_add_u32 v245, 1728, v245
v_add_u32 v246, 1728, v246
v_mfma_f32_16x16x32_bf16 v[192:195], a[88:91], v[208:211], v[192:195]
s_nop 1
v_cvt_pk_bf16_f32 v40, v188, v189
v_mfma_f32_16x16x32_bf16 v[192:195], a[84:87], v[204:207], v[192:195]
v_cvt_pk_bf16_f32 v41, v190, v191
v_mfma_f32_16x16x32_bf16 v[192:195], a[80:83], v[196:199], v[192:195]
buffer_load_dwordx4 v243, s[16:19], s99 offen offset:1056 nt lds
v_mfma_f32_16x16x32_bf16 v[188:191], a[96:99], v[196:199], 0
s_add_u32 s99, s98, s51
s_nop 1
v_mfma_f32_16x16x32_bf16 v[188:191], a[100:103], v[204:207], v[188:191]
s_nop 1
v_cvt_pk_bf16_f32 v42, v192, v193
v_mfma_f32_16x16x32_bf16 v[188:191], a[104:107], v[208:211], v[188:191]
v_cvt_pk_bf16_f32 v43, v194, v195
v_mfma_f32_16x16x32_bf16 v[188:191], a[108:111], v[216:219], v[188:191]
ds_read_b128 v[192:195], v247 offset:0
v_add_u32 v247, 1728, v247
v_mfma_f32_16x16x32_bf16 v[200:203], a[124:127], v[216:219], 0
s_nop 2
v_mfma_f32_16x16x32_bf16 v[200:203], a[120:123], v[208:211], v[200:203]
s_nop 0
v_cvt_pk_bf16_f32 v44, v188, v189
v_cvt_pk_bf16_f32 v45, v190, v191
v_mfma_f32_16x16x32_bf16 v[200:203], a[116:119], v[204:207], v[200:203]
v_mfma_f32_16x16x32_bf16 v[200:203], a[112:115], v[196:199], v[200:203]
s_nop 2
v_mfma_f32_16x16x32_bf16 v[188:191], a[0:3], v[196:199], 0
s_waitcnt lgkmcnt(1)
s_nop 1
v_mfma_f32_16x16x32_bf16 v[188:191], a[4:7], v[204:207], v[188:191]
v_cvt_pk_bf16_f32 v46, v200, v201
v_cvt_pk_bf16_f32 v47, v202, v203
v_mfma_f32_16x16x32_bf16 v[188:191], a[8:11], v[208:211], v[188:191]
v_mfma_f32_16x16x32_bf16 v[188:191], a[12:15], v[216:219], v[188:191]
s_nop 2
v_mfma_f32_16x16x32_bf16 v[200:203], a[28:31], v[216:219], 0
s_nop 2
v_mfma_f32_16x16x32_bf16 v[200:203], a[24:27], v[208:211], v[200:203]
v_cvt_pk_bf16_f32 v96, v188, v189
v_cvt_pk_bf16_f32 v97, v190, v191
v_mfma_f32_16x16x32_bf16 v[200:203], a[20:23], v[204:207], v[200:203]
v_mfma_f32_16x16x32_bf16 v[200:203], a[16:19], v[196:199], v[200:203]
v_mov_b64 v[168:169], 0
v_mov_b64 v[170:171], 0
v_mfma_f32_16x16x32_bf16 v[188:191], a[32:35], v[196:199], 0
s_waitcnt lgkmcnt(0)
v_mov_b64 v[172:173], 0
v_mov_b64 v[174:175], 0
v_mfma_f32_16x16x32_bf16 v[188:191], a[36:39], v[204:207], v[188:191]
v_mov_b64 v[176:177], 0
v_mov_b64 v[178:179], 0
v_mfma_f32_16x16x32_bf16 v[188:191], a[40:43], v[208:211], v[188:191]
v_cvt_pk_bf16_f32 v98, v200, v201
v_cvt_pk_bf16_f32 v99, v202, v203
v_mfma_f32_16x16x32_bf16 v[188:191], a[44:47], v[216:219], v[188:191]
s_nop 2
v_smfmac_f32_16x16x64_bf16 v[168:171], v[192:195], v[0:7], v251
s_nop 2
v_smfmac_f32_16x16x64_bf16 v[172:175], v[192:195], v[16:23], v251
v_cvt_pk_bf16_f32 v100, v188, v189
v_smfmac_f32_16x16x64_bf16 v[176:179], v[192:195], v[32:39], v251
v_cvt_pk_bf16_f32 v101, v190, v191
v_mfma_f32_16x16x32_bf16 v[188:191], a[60:63], v[216:219], 0
v_add_f32 v168, v168, v169
v_mfma_f32_16x16x32_bf16 v[188:191], a[56:59], v[208:211], v[188:191]
v_exp_f32 v168, v168
v_mfma_f32_16x16x32_bf16 v[188:191], a[52:55], v[204:207], v[188:191]
v_mfma_f32_16x16x32_bf16 v[188:191], a[48:51], v[196:199], v[188:191]
s_nop 2
v_smfmac_f32_16x16x64_bf16 v[170:173], v[192:195], v[8:15], v251
s_nop 2
v_smfmac_f32_16x16x64_bf16 v[174:177], v[192:195], v[24:31], v251
v_cvt_pk_bf16_f32 v102, v188, v189
v_smfmac_f32_16x16x64_bf16 v[178:181], v[192:195], v[40:47], v251
v_cvt_pk_bf16_f32 v103, v190, v191
v_mfma_f32_16x16x32_bf16 v[136:139], a[192:195], v[196:199], 0
v_add_f32 v170, v170, v171
v_add_f32 v172, v172, v173
v_mfma_f32_16x16x32_bf16 v[136:139], a[196:199], v[204:207], v[136:139]
v_exp_f32 v170, v170
v_mfma_f32_16x16x32_bf16 v[136:139], a[200:203], v[208:211], v[136:139]
v_exp_f32 v172, v172
v_mfma_f32_16x16x32_bf16 v[136:139], a[204:207], v[216:219], v[136:139]
buffer_load_dwordx4 v243, s[16:19], s100 offen offset:2112 nt lds
v_mfma_f32_16x16x32_bf16 v[140:143], a[220:223], v[216:219], 0
s_add_u32 s100, s99, s51
v_add_f32 v174, v174, v175
v_add_f32 v176, v176, v177
v_mfma_f32_16x16x32_bf16 v[140:143], a[216:219], v[208:211], v[140:143]
v_exp_f32 v174, v174
v_mfma_f32_16x16x32_bf16 v[140:143], a[212:215], v[204:207], v[140:143]
v_exp_f32 v176, v176
v_mfma_f32_16x16x32_bf16 v[140:143], a[208:211], v[196:199], v[140:143]
v_add_f32 v178, v178, v179
v_add_f32 v180, v168, v170
v_mfma_f32_16x16x32_bf16 v[144:147], a[224:227], v[196:199], 0
v_cvt_pk_bf16_f32 v169, v168, v170
v_add_f32 v180, v180, v172
v_mfma_f32_16x16x32_bf16 v[144:147], a[228:231], v[204:207], v[144:147]
ds_write_b16 v248, v169 offset:0
v_mfma_f32_16x16x32_bf16 v[144:147], a[232:235], v[208:211], v[144:147]
ds_write_b16_d16_hi v248, v169 offset:4
v_mfma_f32_16x16x32_bf16 v[144:147], a[236:239], v[216:219], v[144:147]
v_mov_b64 v[188:189], s[96:97]
v_mov_b64 v[190:191], s[96:97]
v_mfma_f32_16x16x32_bf16 v[148:151], a[252:255], v[216:219], 0
v_exp_f32 v178, v178
v_mfma_f32_16x16x32_bf16 v[148:151], a[248:251], v[208:211], v[148:151]
v_add_f32 v180, v180, v174
v_add_f32 v180, v180, v176
v_mfma_f32_16x16x32_bf16 v[148:151], a[244:247], v[204:207], v[148:151]
v_add_f32 v180, v180, v178
v_cvt_pk_bf16_f32 v173, v172, v174
v_mfma_f32_16x16x32_bf16 v[148:151], a[240:243], v[196:199], v[148:151]
ds_write_b16 v248, v173 offset:272
v_smfmac_f32_16x16x64_bf16 v[188:191], v[238:241], v[96:103], v251
ds_write_b16_d16_hi v248, v173 offset:276
v_mfma_f32_16x16x32_bf16 v[192:195], v[0:3], v[96:99], 0
v_add_f32_dpp v180, v180, v180 row_ror:8 row_mask:0xf bank_mask:0xf
v_cvt_pk_bf16_f32 v177, v176, v178
v_mfma_f32_16x16x32_bf16 v[192:195], v[4:7], v[100:103], v[192:195]
ds_write_b16 v248, v177 offset:544
v_mfma_f32_16x16x32_bf16 v[200:203], v[196:199], a[128:131], 0
ds_write_b16_d16_hi v248, v177 offset:548
v_mfma_f32_16x16x32_bf16 v[200:203], v[204:207], a[132:135], v[200:203]
v_add_f32 v188, v188, v189
v_add_f32 v190, v190, v191
v_mfma_f32_16x16x32_bf16 v[200:203], v[208:211], a[136:139], v[200:203]
v_exp_f32 v188, v188
v_mfma_f32_16x16x32_bf16 v[200:203], v[216:219], a[140:143], v[200:203]
buffer_load_dwordx4 v243, s[16:19], s101 offen offset:3168 nt lds
v_mfma_f32_16x16x32_bf16 v[212:215], v[216:219], a[156:159], 0
s_add_u32 m0, s49, 16896
ds_read_b128 v[232:235], v242 offset:768
v_add_f32_dpp v180, v180, v180 row_ror:4 row_mask:0xf bank_mask:0xf
v_mfma_f32_16x16x32_bf16 v[212:215], v[208:211], a[152:155], v[212:215]
s_add_u32 s101, s100, s51
ds_write_b32 v250, v180 offset:256
v_mfma_f32_16x16x32_bf16 v[212:215], v[204:207], a[148:151], v[212:215]
s_and_b32 s51, s57, 13106176
ds_read_b128 v[220:223], v242 offset:512
v_cvt_pk_bf16_f32 v82, v200, v201
v_mfma_f32_16x16x32_bf16 v[212:215], v[196:199], a[144:147], v[212:215]
s_sub_u32 s49, s49, s56
ds_read_b128 v[224:227], v242 offset:256
v_cvt_pk_bf16_f32 v83, v202, v203
v_mfma_f32_16x16x32_bf16 v[200:203], v[196:199], a[160:163], 0
s_lshl3_add_u32 s48, s51, 8192
ds_read_b128 v[228:231], v242 offset:0
s_sub_u32 s51, s51, 32
v_mfma_f32_16x16x32_bf16 v[200:203], v[204:207], a[164:167], v[200:203]
v_exp_f32 v190, v190
v_mfma_f32_16x16x32_bf16 v[200:203], v[208:211], a[168:171], v[200:203]
v_perm_b32 v116, v190, v188, v252
v_perm_b32 v117, v190, v188, v253
v_mfma_f32_16x16x32_bf16 v[200:203], v[216:219], a[172:175], v[200:203]
v_exp_f32 v192, v192
v_mfma_f32_16x16x32_bf16 v[188:191], v[216:219], a[188:191], 0
v_exp_f32 v193, v193
v_mfma_f32_16x16x32_bf16 v[188:191], v[208:211], a[184:187], v[188:191]
v_exp_f32 v194, v194
v_mfma_f32_16x16x32_bf16 v[188:191], v[204:207], a[180:183], v[188:191]
v_exp_f32 v195, v195
v_mfma_f32_16x16x32_bf16 v[188:191], v[196:199], a[176:179], v[188:191]
v_cvt_pk_bf16_f32 v104, v192, v193
v_cvt_pk_bf16_f32 v105, v194, v195
v_mfma_f32_16x16x32_bf16 v[196:199], v[12:15], v[100:103], 0
v_cvt_pk_bf16_f32 v90, v200, v201
v_cvt_pk_bf16_f32 v91, v202, v203
v_mfma_f32_16x16x32_bf16 v[196:199], v[8:11], v[96:99], v[196:199]
s_waitcnt lgkmcnt(4)
v_cvt_pk_bf16_f32 v86, v212, v213
v_cvt_pk_bf16_f32 v94, v188, v189
v_mfma_f32_16x16x32_bf16 v[192:195], v[16:19], v[96:99], 0
v_cvt_pk_bf16_f32 v95, v190, v191
v_cvt_pk_bf16_f32 v87, v214, v215
v_mfma_f32_16x16x32_bf16 v[192:195], v[20:23], v[100:103], v[192:195]
s_waitcnt lgkmcnt(2)
v_exp_f32 v196, v196
v_mfma_f32_32x32x16_bf16 v[168:183], v[236:239], v[116:119], 0
buffer_store_dwordx4 v[152:155], v244, s[20:23], s53 offen offset:0 nt
buffer_store_dwordx4 v[160:163], v244, s[20:23], s53 offen offset:2048 nt
v_exp_f32 v197, v197
v_exp_f32 v198, v198
v_mfma_f32_16x16x32_bf16 v[188:191], v[232:235], a[188:191], 0
s_waitcnt lgkmcnt(0)
v_exp_f32 v192, v192
v_mfma_f32_16x16x32_bf16 v[188:191], v[220:223], a[184:187], v[188:191]
s_add_u32 s53, s46, 0
v_exp_f32 v193, v193
v_mfma_f32_16x16x32_bf16 v[188:191], v[224:227], a[180:183], v[188:191]
v_exp_f32 v194, v194
v_mfma_f32_16x16x32_bf16 v[188:191], v[228:231], a[176:179], v[188:191]
v_exp_f32 v195, v195
v_mfma_f32_16x16x32_bf16 v[200:203], v[228:231], a[160:163], 0
v_cvt_pk_bf16_f32 v108, v192, v193
v_cvt_pk_bf16_f32 v109, v194, v195
v_mfma_f32_16x16x32_bf16 v[200:203], v[224:227], a[164:167], v[200:203]
v_exp_f32 v199, v199
v_mfma_f32_16x16x32_bf16 v[200:203], v[220:223], a[168:171], v[200:203]
s_nop 0
v_cvt_pk_bf16_f32 v60, v188, v189
v_cvt_pk_bf16_f32 v61, v190, v191
v_mfma_f32_16x16x32_bf16 v[200:203], v[232:235], a[172:175], v[200:203]
v_cvt_pk_bf16_f32 v106, v196, v197
v_cvt_pk_bf16_f32 v107, v198, v199
v_mfma_f32_16x16x32_bf16 v[188:191], v[232:235], a[156:159], 0
s_nop 2
v_mfma_f32_16x16x32_bf16 v[188:191], v[220:223], a[152:155], v[188:191]
s_nop 0
v_cvt_pk_bf16_f32 v56, v200, v201
v_cvt_pk_bf16_f32 v57, v202, v203
v_mfma_f32_16x16x32_bf16 v[188:191], v[224:227], a[148:151], v[188:191]
v_mfma_f32_16x16x32_bf16 v[188:191], v[228:231], a[144:147], v[188:191]
s_nop 2
v_mfma_f32_16x16x32_bf16 v[192:195], v[228:231], a[128:131], 0
s_nop 2
v_mfma_f32_16x16x32_bf16 v[192:195], v[224:227], a[132:135], v[192:195]
v_cvt_pk_bf16_f32 v52, v188, v189
v_cvt_pk_bf16_f32 v53, v190, v191
v_mfma_f32_16x16x32_bf16 v[192:195], v[220:223], a[136:139], v[192:195]
v_mfma_f32_16x16x32_bf16 v[192:195], v[232:235], a[140:143], v[192:195]
s_nop 2
v_mfma_f32_16x16x32_bf16 v[188:191], v[24:27], v[96:99], 0
s_nop 2
v_mfma_f32_16x16x32_bf16 v[188:191], v[28:31], v[100:103], v[188:191]
v_cvt_pk_bf16_f32 v48, v192, v193
v_cvt_pk_bf16_f32 v49, v194, v195
v_mfma_f32_16x16x32_bf16 v[192:195], v[36:39], v[100:103], 0
s_nop 2
v_mfma_f32_16x16x32_bf16 v[192:195], v[32:35], v[96:99], v[192:195]
s_nop 0
v_exp_f32 v188, v188
v_mfma_f32_16x16x32_bf16 v[196:199], v[40:43], v[96:99], 0
v_exp_f32 v189, v189
v_mfma_f32_16x16x32_bf16 v[196:199], v[44:47], v[100:103], v[196:199]
v_exp_f32 v190, v190
v_mfma_f32_16x16x32_bf16 v[200:203], a[0:3], v[228:231], 0
v_exp_f32 v191, v191
v_mfma_f32_16x16x32_bf16 v[200:203], a[4:7], v[224:227], v[200:203]
v_cvt_pk_bf16_f32 v110, v188, v189
v_cvt_pk_bf16_f32 v111, v190, v191
v_mfma_f32_16x16x32_bf16 v[200:203], a[8:11], v[220:223], v[200:203]
v_exp_f32 v192, v192
v_mfma_f32_16x16x32_bf16 v[200:203], a[12:15], v[232:235], v[200:203]
buffer_load_dwordx4 v243, s[16:19], s98 offen offset:0 nt lds
v_mfma_f32_16x16x32_bf16 v[188:191], a[28:31], v[232:235], 0
v_exp_f32 v193, v193
v_mfma_f32_16x16x32_bf16 v[188:191], a[24:27], v[220:223], v[188:191]
v_exp_f32 v194, v194
v_mfma_f32_16x16x32_bf16 v[188:191], a[20:23], v[224:227], v[188:191]
v_exp_f32 v195, v195
v_mfma_f32_16x16x32_bf16 v[188:191], a[16:19], v[228:231], v[188:191]
v_cvt_pk_bf16_f32 v96, v200, v201
v_cvt_pk_bf16_f32 v97, v202, v203
v_mfma_f32_16x16x32_bf16 v[200:203], a[32:35], v[228:231], 0
v_cvt_pk_bf16_f32 v112, v192, v193
v_cvt_pk_bf16_f32 v113, v194, v195
v_mfma_f32_16x16x32_bf16 v[200:203], a[36:39], v[224:227], v[200:203]
v_exp_f32 v196, v196
v_mfma_f32_16x16x32_bf16 v[200:203], a[40:43], v[220:223], v[200:203]
v_cvt_pk_bf16_f32 v98, v188, v189
v_cvt_pk_bf16_f32 v99, v190, v191
v_mfma_f32_16x16x32_bf16 v[200:203], a[44:47], v[232:235], v[200:203]
v_exp_f32 v197, v197
v_mfma_f32_16x16x32_bf16 v[188:191], a[60:63], v[232:235], 0
v_exp_f32 v198, v198
v_mfma_f32_16x16x32_bf16 v[188:191], a[56:59], v[220:223], v[188:191]
v_exp_f32 v199, v199
v_mfma_f32_16x16x32_bf16 v[188:191], a[52:55], v[224:227], v[188:191]
v_cvt_pk_bf16_f32 v114, v196, v197
v_cvt_pk_bf16_f32 v115, v198, v199
v_mfma_f32_16x16x32_bf16 v[188:191], a[48:51], v[228:231], v[188:191]
v_cvt_pk_bf16_f32 v100, v200, v201
v_cvt_pk_bf16_f32 v101, v202, v203
v_mfma_f32_16x16x32_bf16 v[152:155], a[192:195], v[228:231], 0
s_nop 2
v_mfma_f32_16x16x32_bf16 v[152:155], a[196:199], v[224:227], v[152:155]
s_nop 0
v_cvt_pk_bf16_f32 v102, v188, v189
v_cvt_pk_bf16_f32 v103, v190, v191
v_mfma_f32_16x16x32_bf16 v[152:155], a[200:203], v[220:223], v[152:155]
v_mfma_f32_16x16x32_bf16 v[152:155], a[204:207], v[232:235], v[152:155]
v_mfma_f32_16x16x32_bf16 v[156:159], a[220:223], v[232:235], 0
ds_read_b128 v[188:191], v242 offset:4224
ds_read_b128 v[192:195], v242 offset:4480
v_mfma_f32_16x16x32_bf16 v[156:159], a[216:219], v[220:223], v[156:159]
ds_read_b128 v[196:199], v242 offset:4736
ds_read_b128 v[200:203], v242 offset:4992
v_mfma_f32_16x16x32_bf16 v[156:159], a[212:215], v[224:227], v[156:159]
v_mfma_f32_16x16x32_bf16 v[156:159], a[208:211], v[228:231], v[156:159]
buffer_load_dwordx4 v243, s[16:19], s99 offen offset:1056 nt lds
v_mfma_f32_16x16x32_bf16 v[160:163], a[224:227], v[228:231], 0
v_mfma_f32_16x16x32_bf16 v[160:163], a[228:231], v[224:227], v[160:163]
v_mfma_f32_16x16x32_bf16 v[160:163], a[232:235], v[220:223], v[160:163]
s_waitcnt lgkmcnt(2)
v_mfma_f32_16x16x32_bf16 v[160:163], a[236:239], v[232:235], v[160:163]
v_mov_b64 v[204:205], s[96:97]
v_mov_b64 v[206:207], s[96:97]
v_mfma_f32_16x16x32_bf16 v[164:167], a[252:255], v[232:235], 0
v_mfma_f32_16x16x32_bf16 v[164:167], a[248:251], v[220:223], v[164:167]
v_mfma_f32_16x16x32_bf16 v[164:167], a[244:247], v[224:227], v[164:167]
v_mfma_f32_16x16x32_bf16 v[164:167], a[240:243], v[228:231], v[164:167]
v_smfmac_f32_16x16x64_bf16 v[204:207], v[238:241], v[96:103], v251
s_nop 2
v_mfma_f32_16x16x32_bf16 v[208:211], v[0:3], v[96:99], 0
s_nop 2
v_mfma_f32_16x16x32_bf16 v[208:211], v[4:7], v[100:103], v[208:211]
s_waitcnt lgkmcnt(0)
v_add_f32 v204, v204, v205
v_add_f32 v206, v206, v207
v_mfma_f32_16x16x32_bf16 v[212:215], v[12:15], v[100:103], 0
v_exp_f32 v204, v204
v_mfma_f32_16x16x32_bf16 v[212:215], v[8:11], v[96:99], v[212:215]
v_exp_f32 v206, v206
v_mfma_f32_16x16x32_bf16 v[216:219], v[188:191], a[128:131], 0
v_perm_b32 v132, v206, v204, v252
v_perm_b32 v133, v206, v204, v253
v_mfma_f32_16x16x32_bf16 v[216:219], v[192:195], a[132:135], v[216:219]
v_exp_f32 v208, v208
v_mfma_f32_16x16x32_bf16 v[216:219], v[196:199], a[136:139], v[216:219]
v_exp_f32 v209, v209
v_mfma_f32_16x16x32_bf16 v[216:219], v[200:203], a[140:143], v[216:219]
v_exp_f32 v210, v210
v_mfma_f32_16x16x32_bf16 v[204:207], v[200:203], a[156:159], 0
ds_read_b128 v[232:235], v242 offset:17664
v_cvt_pk_bf16_f32 v120, v208, v209
v_mfma_f32_16x16x32_bf16 v[204:207], v[196:199], a[152:155], v[204:207]
ds_read_b128 v[220:223], v242 offset:17408
ds_read_b128 v[224:227], v242 offset:17152
v_mfma_f32_16x16x32_bf16 v[204:207], v[192:195], a[148:151], v[204:207]
ds_read_b128 v[228:231], v242 offset:16896
v_cvt_pk_bf16_f32 v50, v216, v217
v_mfma_f32_16x16x32_bf16 v[204:207], v[188:191], a[144:147], v[204:207]
v_exp_f32 v211, v211
s_nop 0
v_cvt_pk_bf16_f32 v121, v210, v211
v_mfma_f32_16x16x32_bf16 v[208:211], v[188:191], a[160:163], 0
v_cvt_pk_bf16_f32 v51, v218, v219
s_nop 0
v_mfma_f32_16x16x32_bf16 v[208:211], v[192:195], a[164:167], v[208:211]
s_nop 0
v_cvt_pk_bf16_f32 v54, v204, v205
v_cvt_pk_bf16_f32 v55, v206, v207
v_mfma_f32_16x16x32_bf16 v[208:211], v[196:199], a[168:171], v[208:211]
v_exp_f32 v212, v212
v_mfma_f32_16x16x32_bf16 v[208:211], v[200:203], a[172:175], v[208:211]
v_mov_b64 v[204:205], 0
s_nop 0
v_mfma_f32_16x16x32_bf16 v[216:219], v[200:203], a[188:191], 0
v_exp_f32 v213, v213
v_mfma_f32_16x16x32_bf16 v[216:219], v[196:199], a[184:187], v[216:219]
v_exp_f32 v214, v214
v_mfma_f32_16x16x32_bf16 v[216:219], v[192:195], a[180:183], v[216:219]
s_nop 0
v_cvt_pk_bf16_f32 v58, v208, v209
v_cvt_pk_bf16_f32 v59, v210, v211
v_mfma_f32_16x16x32_bf16 v[216:219], v[188:191], a[176:179], v[216:219]
v_exp_f32 v215, v215
v_smfmac_f32_16x16x64_bf16 v[204:207], v[184:187], v[104:111], v251
v_cvt_pk_bf16_f32 v122, v212, v213
v_smfmac_f32_16x16x64_bf16 v[204:207], v[184:187], v[112:119], v251 abid:1
s_waitcnt lgkmcnt(3)
v_cvt_pk_bf16_f32 v123, v214, v215
v_mfma_f32_16x16x32_bf16 v[188:191], v[16:19], v[96:99], 0
s_waitcnt lgkmcnt(1)
v_cvt_pk_bf16_f32 v62, v216, v217
v_cvt_pk_bf16_f32 v63, v218, v219
v_mfma_f32_16x16x32_bf16 v[188:191], v[20:23], v[100:103], v[188:191]
s_waitcnt lgkmcnt(0)
v_add_f32 v204, v204, v205
s_nop 0
v_mfma_f32_16x16x32_bf16 v[192:195], v[28:31], v[100:103], 0
v_rcp_f32 v254, v204
v_mfma_f32_16x16x32_bf16 v[192:195], v[24:27], v[96:99], v[192:195]
v_max3_f32 v255, v255, v204, v254
s_nop 0
v_mfma_f32_16x16x32_bf16 v[196:199], v[32:35], v[96:99], 0
v_exp_f32 v188, v188
v_mfma_f32_16x16x32_bf16 v[196:199], v[36:39], v[100:103], v[196:199]
v_exp_f32 v189, v189
v_mfma_f32_16x16x32_bf16 v[200:203], v[232:235], a[188:191], 0
v_exp_f32 v190, v190
v_mfma_f32_16x16x32_bf16 v[200:203], v[220:223], a[184:187], v[200:203]
v_exp_f32 v191, v191
v_mfma_f32_16x16x32_bf16 v[200:203], v[224:227], a[180:183], v[200:203]
v_cvt_pk_bf16_f32 v124, v188, v189
v_cvt_pk_bf16_f32 v125, v190, v191
v_mfma_f32_16x16x32_bf16 v[200:203], v[228:231], a[176:179], v[200:203]
buffer_load_dwordx4 v243, s[16:19], s100 offen offset:2112 nt lds
v_mfma_f32_16x16x32_bf16 v[204:207], v[228:231], a[160:163], 0
v_exp_f32 v192, v192
v_mfma_f32_16x16x32_bf16 v[204:207], v[224:227], a[164:167], v[204:207]
v_exp_f32 v193, v193
v_mfma_f32_16x16x32_bf16 v[204:207], v[220:223], a[168:171], v[204:207]
v_exp_f32 v194, v194
v_mfma_f32_16x16x32_bf16 v[204:207], v[232:235], a[172:175], v[204:207]
buffer_load_dwordx4 v243, s[16:19], s101 offen offset:3168 nt lds
v_mfma_f32_16x16x32_bf16 v[208:211], v[232:235], a[156:159], 0
s_mov_b32 m0, s58
v_exp_f32 v195, v195
v_mfma_f32_16x16x32_bf16 v[208:211], v[220:223], a[152:155], v[208:211]
v_cvt_pk_bf16_f32 v126, v192, v193
v_cvt_pk_bf16_f32 v127, v194, v195
v_mfma_f32_16x16x32_bf16 v[208:211], v[224:227], a[148:151], v[208:211]
v_cvt_pk_bf16_f32 v88, v204, v205
v_cvt_pk_bf16_f32 v89, v206, v207
v_mfma_f32_16x16x32_bf16 v[208:211], v[228:231], a[144:147], v[208:211]
v_cvt_pk_bf16_f32 v92, v200, v201
v_cvt_pk_bf16_f32 v93, v202, v203
v_mfma_f32_16x16x32_bf16 v[188:191], v[228:231], a[128:131], 0
v_exp_f32 v196, v196
v_mfma_f32_16x16x32_bf16 v[188:191], v[224:227], a[132:135], v[188:191]
v_exp_f32 v197, v197
v_mfma_f32_16x16x32_bf16 v[188:191], v[220:223], a[136:139], v[188:191]
s_nop 0
v_cvt_pk_bf16_f32 v84, v208, v209
v_cvt_pk_bf16_f32 v85, v210, v211
v_mfma_f32_16x16x32_bf16 v[188:191], v[232:235], a[140:143], v[188:191]
v_exp_f32 v198, v198
v_mfma_f32_16x16x32_bf16 v[192:195], v[40:43], v[96:99], 0
v_exp_f32 v199, v199
v_mfma_f32_16x16x32_bf16 v[192:195], v[44:47], v[100:103], v[192:195]
v_cvt_pk_bf16_f32 v128, v196, v197
v_cvt_pk_bf16_f32 v129, v198, v199
v_mfma_f32_16x16x32_bf16 v[168:171], v[48:51], v[104:107], v[168:171]
s_nop 0
v_cvt_pk_bf16_f32 v80, v188, v189
v_cvt_pk_bf16_f32 v81, v190, v191
v_mfma_f32_16x16x32_bf16 v[168:171], v[64:67], v[108:111], v[168:171]
s_nop 0
v_exp_f32 v192, v192
v_mfma_f32_16x16x32_bf16 v[168:171], v[80:83], v[112:115], v[168:171]
v_exp_f32 v193, v193
v_mfma_f32_16x16x32_bf16 v[172:175], v[84:87], v[112:115], v[172:175]
v_exp_f32 v194, v194
v_mfma_f32_16x16x32_bf16 v[172:175], v[52:55], v[104:107], v[172:175]
v_exp_f32 v195, v195
v_mfma_f32_16x16x32_bf16 v[172:175], v[68:71], v[108:111], v[172:175]
v_cvt_pk_bf16_f32 v130, v192, v193
v_cvt_pk_bf16_f32 v131, v194, v195
L_entryf:
v_mfma_f32_16x16x32_bf16 v[176:179], v[72:75], v[108:111], v[176:179]
v_fmac_f32 v136, v168, v254
v_fmac_f32 v137, v169, v254
v_mfma_f32_16x16x32_bf16 v[176:179], v[88:91], v[112:115], v[176:179]
v_fmac_f32 v138, v170, v254
v_fmac_f32 v139, v171, v254
v_mfma_f32_16x16x32_bf16 v[176:179], v[56:59], v[104:107], v[176:179]
v_cvt_pk_bf16_f32 v136, v136, v137
v_fmac_f32 v140, v172, v254
v_mfma_f32_16x16x32_bf16 v[180:183], v[60:63], v[104:107], v[180:183]
v_fmac_f32 v141, v173, v254
v_fmac_f32 v142, v174, v254
v_mfma_f32_16x16x32_bf16 v[180:183], v[76:79], v[108:111], v[180:183]
v_fmac_f32 v143, v175, v254
v_cvt_pk_bf16_f32 v137, v138, v139
v_mfma_f32_16x16x32_bf16 v[180:183], v[92:95], v[112:115], v[180:183]
v_fmac_f32 v144, v176, v254
v_fmac_f32 v145, v177, v254
v_mfma_f32_16x16x32_bf16 v[188:191], a[0:3], v[228:231], 0
v_fmac_f32 v146, v178, v254
v_fmac_f32 v147, v179, v254
v_mfma_f32_16x16x32_bf16 v[188:191], a[4:7], v[224:227], v[188:191]
v_cvt_pk_bf16_f32 v144, v144, v145
v_cvt_pk_bf16_f32 v145, v146, v147
v_mfma_f32_16x16x32_bf16 v[188:191], a[8:11], v[220:223], v[188:191]
v_fmac_f32 v148, v180, v254
v_fmac_f32 v149, v181, v254
v_mfma_f32_16x16x32_bf16 v[188:191], a[12:15], v[232:235], v[188:191]
v_fmac_f32 v150, v182, v254
v_fmac_f32 v151, v183, v254
v_mfma_f32_16x16x32_bf16 v[192:195], a[28:31], v[232:235], 0
v_cvt_pk_bf16_f32 v138, v140, v141
v_cvt_pk_bf16_f32 v139, v142, v143
v_mfma_f32_16x16x32_bf16 v[192:195], a[24:27], v[220:223], v[192:195]
v_cvt_pk_bf16_f32 v146, v148, v149
v_cvt_pk_bf16_f32 v147, v150, v151
v_mfma_f32_16x16x32_bf16 v[192:195], a[20:23], v[224:227], v[192:195]
v_cvt_pk_bf16_f32 v96, v188, v189
v_cvt_pk_bf16_f32 v97, v190, v191
v_mfma_f32_16x16x32_bf16 v[192:195], a[16:19], v[228:231], v[192:195]
ds_read_b128 v[188:191], v249 offset:0
ds_read_b128 v[196:199], v249 offset:272
v_mfma_f32_16x16x32_bf16 v[200:203], a[32:35], v[228:231], 0
ds_read_b128 v[204:207], v249 offset:544
v_pk_max_i16 v136, v136, 0
v_mfma_f32_16x16x32_bf16 v[200:203], a[36:39], v[224:227], v[200:203]
v_pk_max_i16 v137, v137, 0
v_pk_max_i16 v138, v138, 0
v_mfma_f32_16x16x32_bf16 v[200:203], a[40:43], v[220:223], v[200:203]
v_cvt_pk_bf16_f32 v98, v192, v193
v_cvt_pk_bf16_f32 v99, v194, v195
v_mfma_f32_16x16x32_bf16 v[200:203], a[44:47], v[232:235], v[200:203]
v_mov_b64 v[192:193], 0
v_mov_b64 v[194:195], 0
v_mfma_f32_16x16x32_bf16 v[208:211], a[60:63], v[232:235], 0
v_pk_max_i16 v139, v139, 0
v_pk_max_i16 v144, v144, 0
v_mfma_f32_16x16x32_bf16 v[208:211], a[56:59], v[220:223], v[208:211]
v_pk_max_i16 v145, v145, 0
v_pk_max_i16 v146, v146, 0
v_mfma_f32_16x16x32_bf16 v[208:211], a[52:55], v[224:227], v[208:211]
s_waitcnt lgkmcnt(2)
v_mov_b64 v[212:213], 0
v_mov_b64 v[214:215], 0
v_mfma_f32_16x16x32_bf16 v[208:211], a[48:51], v[228:231], v[208:211]
s_waitcnt lgkmcnt(1)
v_cvt_pk_bf16_f32 v100, v200, v201
v_cvt_pk_bf16_f32 v101, v202, v203
v_smfmac_f32_16x16x64_bf16 v[192:195], v[188:191], v[48:55], v251
s_waitcnt lgkmcnt(0)
v_pk_max_i16 v147, v147, 0
v_smfmac_f32_16x16x64_bf16 v[192:195], v[196:199], v[64:71], v251
s_nop 0
v_cvt_pk_bf16_f32 v102, v208, v209
v_smfmac_f32_16x16x64_bf16 v[192:195], v[204:207], v[80:87], v251
v_cvt_pk_bf16_f32 v103, v210, v211
v_smfmac_f32_16x16x64_bf16 v[212:215], v[204:207], v[88:95], v251
v_mov_b64 v[200:201], s[96:97]
v_smfmac_f32_16x16x64_bf16 v[212:215], v[196:199], v[72:79], v251
v_mov_b64 v[202:203], s[96:97]
v_smfmac_f32_16x16x64_bf16 v[212:215], v[188:191], v[56:63], v251
v_mov_b64 v[140:141], v[136:137]
v_smfmac_f32_16x16x64_bf16 v[200:203], v[238:241], v[96:103], v251
v_mov_b64 v[142:143], v[138:139]
v_mfma_f32_16x16x32_bf16 v[188:191], v[0:3], v[96:99], 0
v_mov_b32_dpp v136, v144 row_ror:8 row_mask:0xf bank_mask:0xc
v_mov_b32_dpp v137, v145 row_ror:8 row_mask:0xf bank_mask:0xc
v_mfma_f32_16x16x32_bf16 v[188:191], v[4:7], v[100:103], v[188:191]
v_mov_b32_dpp v138, v146 row_ror:8 row_mask:0xf bank_mask:0xc
v_mov_b32_dpp v139, v147 row_ror:8 row_mask:0xf bank_mask:0xc
v_mfma_f32_16x16x32_bf16 v[196:199], v[12:15], v[100:103], 0
v_mov_b32_dpp v144, v140 row_ror:8 row_mask:0xf bank_mask:0x3
v_mov_b32_dpp v145, v141 row_ror:8 row_mask:0xf bank_mask:0x3
v_mfma_f32_16x16x32_bf16 v[196:199], v[8:11], v[96:99], v[196:199]
v_mov_b32_dpp v146, v142 row_ror:8 row_mask:0xf bank_mask:0x3
v_mov_b32_dpp v147, v143 row_ror:8 row_mask:0xf bank_mask:0x3
v_mfma_f32_16x16x32_bf16 v[204:207], v[16:19], v[96:99], 0
v_exp_f32 v188, v188
v_mfma_f32_16x16x32_bf16 v[204:207], v[20:23], v[100:103], v[204:207]
v_exp_f32 v189, v189
v_mfma_f32_16x16x32_bf16 v[208:211], v[28:31], v[100:103], 0
v_exp_f32 v190, v190
v_mfma_f32_16x16x32_bf16 v[208:211], v[24:27], v[96:99], v[208:211]
v_exp_f32 v191, v191
v_mfma_f32_32x32x16_bf16 v[168:183], v[236:239], v[132:135], 0
buffer_store_dwordx4 v[136:139], v244, s[20:23], s52 offen offset:0 nt
buffer_store_dwordx4 v[144:147], v244, s[20:23], s52 offen offset:2048 nt
v_cvt_pk_bf16_f32 v104, v188, v189
v_cvt_pk_bf16_f32 v105, v190, v191
v_add_f32 v192, v192, v193
v_add_f32 v194, v194, v195
v_mfma_f32_16x16x32_bf16 v[136:139], a[192:195], v[228:231], 0
s_add_u32 s52, s46, 16384
ds_write_b32 v250, v192 offset:0
v_mfma_f32_16x16x32_bf16 v[136:139], a[196:199], v[224:227], v[136:139]
ds_write_b32 v250, v194 offset:64
v_mfma_f32_16x16x32_bf16 v[136:139], a[200:203], v[220:223], v[136:139]
v_add_f32 v200, v200, v201
v_add_f32 v202, v202, v203
v_mfma_f32_16x16x32_bf16 v[136:139], a[204:207], v[232:235], v[136:139]
v_exp_f32 v200, v200
v_mfma_f32_16x16x32_bf16 v[140:143], a[220:223], v[232:235], 0
v_exp_f32 v202, v202
v_mfma_f32_16x16x32_bf16 v[140:143], a[216:219], v[220:223], v[140:143]
v_perm_b32 v116, v202, v200, v252
v_perm_b32 v117, v202, v200, v253
v_mfma_f32_16x16x32_bf16 v[140:143], a[212:215], v[224:227], v[140:143]
v_exp_f32 v196, v196
v_mfma_f32_16x16x32_bf16 v[140:143], a[208:211], v[228:231], v[140:143]
v_exp_f32 v197, v197
v_mfma_f32_16x16x32_bf16 v[144:147], a[224:227], v[228:231], 0
v_exp_f32 v198, v198
v_mfma_f32_16x16x32_bf16 v[144:147], a[228:231], v[224:227], v[144:147]
v_exp_f32 v199, v199
v_mfma_f32_16x16x32_bf16 v[144:147], a[232:235], v[220:223], v[144:147]
v_cvt_pk_bf16_f32 v106, v196, v197
v_cvt_pk_bf16_f32 v107, v198, v199
v_mfma_f32_16x16x32_bf16 v[144:147], a[236:239], v[232:235], v[144:147]
v_mov_b64 v[188:189], 0
v_add_f32 v212, v212, v213
v_mfma_f32_16x16x32_bf16 v[148:151], a[252:255], v[232:235], 0
ds_write_b32 v250, v212 offset:128
v_mfma_f32_16x16x32_bf16 v[148:151], a[248:251], v[220:223], v[148:151]
v_exp_f32 v204, v204
v_mfma_f32_16x16x32_bf16 v[148:151], a[244:247], v[224:227], v[148:151]
v_exp_f32 v205, v205
v_mfma_f32_16x16x32_bf16 v[148:151], a[240:243], v[228:231], v[148:151]
v_exp_f32 v206, v206
v_smfmac_f32_16x16x64_bf16 v[188:191], v[184:187], v[120:127], v251
ds_read_b128 v[196:199], v242 offset:4224
v_cvt_pk_bf16_f32 v108, v204, v205
v_smfmac_f32_16x16x64_bf16 v[188:191], v[184:187], v[128:135], v251 abid:1
ds_read_b128 v[216:219], v242 offset:4992
v_add_f32 v214, v214, v215
v_mfma_f32_16x16x32_bf16 v[168:171], v[80:83], v[128:131], v[168:171]
ds_write_b32 v250, v214 offset:192
v_mfma_f32_16x16x32_bf16 v[168:171], v[64:67], v[124:127], v[168:171]
v_exp_f32 v207, v207
v_mfma_f32_16x16x32_bf16 v[168:171], v[48:51], v[120:123], v[168:171]
v_cvt_pk_bf16_f32 v109, v206, v207
v_add_f32 v188, v188, v189
v_mfma_f32_16x16x32_bf16 v[172:175], v[52:55], v[120:123], v[172:175]
ds_read_b128 v[204:207], v242 offset:4480
v_add_u32 v250, 1728, v250
v_mfma_f32_16x16x32_bf16 v[172:175], v[68:71], v[124:127], v[172:175]
v_exp_f32 v208, v208
v_mfma_f32_16x16x32_bf16 v[172:175], v[84:87], v[128:131], v[172:175]
v_exp_f32 v209, v209
v_mfma_f32_16x16x32_bf16 v[176:179], v[88:91], v[128:131], v[176:179]
v_exp_f32 v210, v210
v_mfma_f32_16x16x32_bf16 v[176:179], v[72:75], v[124:127], v[176:179]
v_exp_f32 v211, v211
v_mfma_f32_16x16x32_bf16 v[176:179], v[56:59], v[120:123], v[176:179]
v_cvt_pk_bf16_f32 v110, v208, v209
v_cvt_pk_bf16_f32 v111, v210, v211
v_mfma_f32_16x16x32_bf16 v[180:183], v[60:63], v[120:123], v[180:183]
ds_read_b128 v[208:211], v242 offset:4736
v_mfma_f32_16x16x32_bf16 v[180:183], v[76:79], v[124:127], v[180:183]
v_rcp_f32 v254, v188
v_mfma_f32_16x16x32_bf16 v[180:183], v[92:95], v[128:131], v[180:183]
s_waitcnt lgkmcnt(4)
v_max3_f32 v255, v255, v188, v254
v_fmac_f32 v152, v168, v254
v_mfma_f32_16x16x32_bf16 v[192:195], v[36:39], v[100:103], 0
s_waitcnt lgkmcnt(3)
v_fmac_f32 v153, v169, v254
v_fmac_f32 v160, v176, v254
v_mfma_f32_16x16x32_bf16 v[192:195], v[32:35], v[96:99], v[192:195]
v_fmac_f32 v161, v177, v254
v_fmac_f32 v154, v170, v254
v_mfma_f32_16x16x32_bf16 v[200:203], v[40:43], v[96:99], 0
v_fmac_f32 v155, v171, v254
v_cvt_pk_bf16_f32 v152, v152, v153
v_mfma_f32_16x16x32_bf16 v[200:203], v[44:47], v[100:103], v[200:203]
s_waitcnt lgkmcnt(1)
v_fmac_f32 v162, v178, v254
v_fmac_f32 v163, v179, v254
v_mfma_f32_16x16x32_bf16 v[220:223], a[0:3], v[196:199], 0
s_waitcnt lgkmcnt(0)
v_cvt_pk_bf16_f32 v160, v160, v161
v_fmac_f32 v156, v172, v254
v_mfma_f32_16x16x32_bf16 v[220:223], a[4:7], v[204:207], v[220:223]
v_fmac_f32 v157, v173, v254
v_fmac_f32 v158, v174, v254
v_mfma_f32_16x16x32_bf16 v[220:223], a[8:11], v[208:211], v[220:223]
v_fmac_f32 v159, v175, v254
v_cvt_pk_bf16_f32 v153, v154, v155
v_mfma_f32_16x16x32_bf16 v[220:223], a[12:15], v[216:219], v[220:223]
v_fmac_f32 v164, v180, v254
v_fmac_f32 v165, v181, v254
v_mfma_f32_16x16x32_bf16 v[224:227], a[28:31], v[216:219], 0
v_fmac_f32 v166, v182, v254
v_fmac_f32 v167, v183, v254
v_mfma_f32_16x16x32_bf16 v[224:227], a[24:27], v[208:211], v[224:227]
v_cvt_pk_bf16_f32 v161, v162, v163
v_cvt_pk_bf16_f32 v154, v156, v157
v_mfma_f32_16x16x32_bf16 v[224:227], a[20:23], v[204:207], v[224:227]
v_cvt_pk_bf16_f32 v155, v158, v159
v_cvt_pk_bf16_f32 v162, v164, v165
v_mfma_f32_16x16x32_bf16 v[224:227], a[16:19], v[196:199], v[224:227]
v_cvt_pk_bf16_f32 v163, v166, v167
v_pk_max_i16 v152, v152, 0
v_mfma_f32_16x16x32_bf16 v[228:231], a[32:35], v[196:199], 0
v_pk_max_i16 v153, v153, 0
v_pk_max_i16 v154, v154, 0
v_mfma_f32_16x16x32_bf16 v[228:231], a[36:39], v[204:207], v[228:231]
v_pk_max_i16 v155, v155, 0
v_pk_max_i16 v160, v160, 0
v_mfma_f32_16x16x32_bf16 v[228:231], a[40:43], v[208:211], v[228:231]
v_pk_max_i16 v161, v161, 0
v_pk_max_i16 v162, v162, 0
v_mfma_f32_16x16x32_bf16 v[228:231], a[44:47], v[216:219], v[228:231]
v_pk_max_i16 v163, v163, 0
v_mov_b64 v[156:157], v[152:153]
v_mfma_f32_16x16x32_bf16 v[188:191], a[60:63], v[216:219], 0
v_mov_b64 v[158:159], v[154:155]
v_mov_b32_dpp v152, v160 row_ror:8 row_mask:0xf bank_mask:0xc
v_mfma_f32_16x16x32_bf16 v[188:191], a[56:59], v[208:211], v[188:191]
v_mov_b32_dpp v153, v161 row_ror:8 row_mask:0xf bank_mask:0xc
v_mov_b32_dpp v154, v162 row_ror:8 row_mask:0xf bank_mask:0xc
v_mfma_f32_16x16x32_bf16 v[188:191], a[52:55], v[204:207], v[188:191]
v_mov_b32_dpp v155, v163 row_ror:8 row_mask:0xf bank_mask:0xc
v_mov_b32_dpp v160, v156 row_ror:8 row_mask:0xf bank_mask:0x3
v_mfma_f32_16x16x32_bf16 v[188:191], a[48:51], v[196:199], v[188:191]
v_mov_b32_dpp v161, v157 row_ror:8 row_mask:0xf bank_mask:0x3
v_mov_b32_dpp v162, v158 row_ror:8 row_mask:0xf bank_mask:0x3
v_mov_b32_dpp v163, v159 row_ror:8 row_mask:0xf bank_mask:0x3
v_mfma_f32_32x32x16_bf16 v[168:183], v[236:239], v[116:119], 0
buffer_store_dwordx4 v[152:155], v244, s[20:23], s53 offen offset:0 nt
buffer_store_dwordx4 v[160:163], v244, s[20:23], s53 offen offset:2048 nt
v_cvt_pk_bf16_f32 v96, v220, v221
v_cvt_pk_bf16_f32 v97, v222, v223
v_cvt_pk_bf16_f32 v98, v224, v225
v_cvt_pk_bf16_f32 v99, v226, v227
v_mfma_f32_16x16x32_bf16 v[152:155], a[192:195], v[196:199], 0
s_add_u32 s53, s46, 4096
v_cvt_pk_bf16_f32 v100, v228, v229
v_cvt_pk_bf16_f32 v101, v230, v231
v_mfma_f32_16x16x32_bf16 v[152:155], a[196:199], v[204:207], v[152:155]
s_add_u32 s46, s46, 13107200
v_cvt_pk_bf16_f32 v102, v188, v189
v_cvt_pk_bf16_f32 v103, v190, v191
v_mfma_f32_16x16x32_bf16 v[152:155], a[200:203], v[208:211], v[152:155]
v_exp_f32 v192, v192
v_mfma_f32_16x16x32_bf16 v[152:155], a[204:207], v[216:219], v[152:155]
v_exp_f32 v193, v193
v_mfma_f32_16x16x32_bf16 v[156:159], a[220:223], v[216:219], 0
v_exp_f32 v194, v194
v_mfma_f32_16x16x32_bf16 v[156:159], a[216:219], v[208:211], v[156:159]
v_exp_f32 v195, v195
v_mfma_f32_16x16x32_bf16 v[156:159], a[212:215], v[204:207], v[156:159]
v_cvt_pk_bf16_f32 v112, v192, v193
v_cvt_pk_bf16_f32 v113, v194, v195
v_mfma_f32_16x16x32_bf16 v[156:159], a[208:211], v[196:199], v[156:159]
v_exp_f32 v200, v200
v_mfma_f32_16x16x32_bf16 v[160:163], a[224:227], v[196:199], 0
v_exp_f32 v201, v201
v_mfma_f32_16x16x32_bf16 v[160:163], a[228:231], v[204:207], v[160:163]
v_exp_f32 v202, v202
v_mfma_f32_16x16x32_bf16 v[160:163], a[232:235], v[208:211], v[160:163]
v_exp_f32 v203, v203
v_mfma_f32_16x16x32_bf16 v[160:163], a[236:239], v[216:219], v[160:163]
v_mov_b64 v[188:189], s[96:97]
v_mov_b64 v[190:191], s[96:97]
v_mfma_f32_16x16x32_bf16 v[164:167], a[252:255], v[216:219], 0
v_cvt_pk_bf16_f32 v114, v200, v201
v_cvt_pk_bf16_f32 v115, v202, v203
v_mfma_f32_16x16x32_bf16 v[164:167], a[248:251], v[208:211], v[164:167]
v_mfma_f32_16x16x32_bf16 v[164:167], a[244:247], v[204:207], v[164:167]
v_mfma_f32_16x16x32_bf16 v[164:167], a[240:243], v[196:199], v[164:167]
v_smfmac_f32_16x16x64_bf16 v[188:191], v[238:241], v[96:103], v251
s_nop 2
v_mfma_f32_16x16x32_bf16 v[192:195], v[0:3], v[96:99], 0
s_nop 2
v_mfma_f32_16x16x32_bf16 v[192:195], v[4:7], v[100:103], v[192:195]
v_mov_b64 v[196:197], 0
v_add_f32 v188, v188, v189
v_mfma_f32_16x16x32_bf16 v[200:203], v[12:15], v[100:103], 0
v_add_f32 v190, v190, v191
s_nop 0
v_mfma_f32_16x16x32_bf16 v[200:203], v[8:11], v[96:99], v[200:203]
v_exp_f32 v188, v188
v_mfma_f32_16x16x32_bf16 v[204:207], v[16:19], v[96:99], 0
v_exp_f32 v190, v190
v_mfma_f32_16x16x32_bf16 v[204:207], v[20:23], v[100:103], v[204:207]
v_perm_b32 v132, v190, v188, v252
v_perm_b32 v133, v190, v188, v253
v_smfmac_f32_16x16x64_bf16 v[196:199], v[184:187], v[104:111], v251
ds_read_b128 v[188:191], v242 offset:8448
ds_read_b128 v[208:211], v242 offset:8704
v_smfmac_f32_16x16x64_bf16 v[196:199], v[184:187], v[112:119], v251 abid:1
ds_read_b128 v[212:215], v242 offset:8960
ds_read_b128 v[216:219], v242 offset:9216
v_mfma_f32_16x16x32_bf16 v[168:171], v[80:83], v[112:115], v[168:171]
v_exp_f32 v192, v192
v_mfma_f32_16x16x32_bf16 v[168:171], v[64:67], v[108:111], v[168:171]
v_exp_f32 v193, v193
v_mfma_f32_16x16x32_bf16 v[168:171], v[48:51], v[104:107], v[168:171]
s_nop 0
v_add_f32 v196, v196, v197
v_cvt_pk_bf16_f32 v120, v192, v193
v_mfma_f32_16x16x32_bf16 v[172:175], v[52:55], v[104:107], v[172:175]
v_rcp_f32 v254, v196
v_mfma_f32_16x16x32_bf16 v[172:175], v[68:71], v[108:111], v[172:175]
s_waitcnt lgkmcnt(3)
v_max3_f32 v255, v255, v196, v254
v_fmac_f32 v136, v168, v254
v_mfma_f32_16x16x32_bf16 v[172:175], v[84:87], v[112:115], v[172:175]
v_exp_f32 v194, v194
v_mfma_f32_16x16x32_bf16 v[176:179], v[88:91], v[112:115], v[176:179]
v_exp_f32 v195, v195
v_mfma_f32_16x16x32_bf16 v[176:179], v[72:75], v[108:111], v[176:179]
v_cvt_pk_bf16_f32 v121, v194, v195
v_fmac_f32 v137, v169, v254
v_mfma_f32_16x16x32_bf16 v[176:179], v[56:59], v[104:107], v[176:179]
v_fmac_f32 v138, v170, v254
v_fmac_f32 v139, v171, v254
v_mfma_f32_16x16x32_bf16 v[180:183], v[60:63], v[104:107], v[180:183]
v_cvt_pk_bf16_f32 v136, v136, v137
v_cvt_pk_bf16_f32 v137, v138, v139
v_mfma_f32_16x16x32_bf16 v[180:183], v[76:79], v[108:111], v[180:183]
v_fmac_f32 v140, v172, v254
v_fmac_f32 v141, v173, v254
v_mfma_f32_16x16x32_bf16 v[180:183], v[92:95], v[112:115], v[180:183]
s_waitcnt lgkmcnt(2)
v_fmac_f32 v144, v176, v254
v_fmac_f32 v145, v177, v254
v_mfma_f32_16x16x32_bf16 v[220:223], v[24:27], v[96:99], 0
s_waitcnt lgkmcnt(0)
v_fmac_f32 v146, v178, v254
v_fmac_f32 v147, v179, v254
v_mfma_f32_16x16x32_bf16 v[220:223], v[28:31], v[100:103], v[220:223]
v_cvt_pk_bf16_f32 v144, v144, v145
v_fmac_f32 v142, v174, v254
v_mfma_f32_16x16x32_bf16 v[224:227], v[36:39], v[100:103], 0
v_fmac_f32 v143, v175, v254
v_fmac_f32 v148, v180, v254
v_mfma_f32_16x16x32_bf16 v[224:227], v[32:35], v[96:99], v[224:227]
v_fmac_f32 v149, v181, v254
v_fmac_f32 v150, v182, v254
v_mfma_f32_16x16x32_bf16 v[228:231], v[40:43], v[96:99], 0
v_fmac_f32 v151, v183, v254
v_cvt_pk_bf16_f32 v145, v146, v147
v_mfma_f32_16x16x32_bf16 v[228:231], v[44:47], v[100:103], v[228:231]
v_cvt_pk_bf16_f32 v138, v140, v141
v_cvt_pk_bf16_f32 v139, v142, v143
v_mfma_f32_16x16x32_bf16 v[196:199], a[0:3], v[188:191], 0
v_cvt_pk_bf16_f32 v146, v148, v149
v_cvt_pk_bf16_f32 v147, v150, v151
v_mfma_f32_16x16x32_bf16 v[196:199], a[4:7], v[208:211], v[196:199]
v_pk_max_i16 v136, v136, 0
v_pk_max_i16 v137, v137, 0
v_mfma_f32_16x16x32_bf16 v[196:199], a[8:11], v[212:215], v[196:199]
v_pk_max_i16 v138, v138, 0
v_pk_max_i16 v139, v139, 0
v_mfma_f32_16x16x32_bf16 v[196:199], a[12:15], v[216:219], v[196:199]
v_pk_max_i16 v144, v144, 0
v_pk_max_i16 v145, v145, 0
v_mfma_f32_16x16x32_bf16 v[192:195], a[28:31], v[216:219], 0
v_pk_max_i16 v146, v146, 0
v_pk_max_i16 v147, v147, 0
v_mfma_f32_16x16x32_bf16 v[192:195], a[24:27], v[212:215], v[192:195]
v_mov_b64 v[140:141], v[136:137]
v_mov_b64 v[142:143], v[138:139]
v_mfma_f32_16x16x32_bf16 v[192:195], a[20:23], v[208:211], v[192:195]
v_cvt_pk_bf16_f32 v96, v196, v197
v_cvt_pk_bf16_f32 v97, v198, v199
v_mfma_f32_16x16x32_bf16 v[192:195], a[16:19], v[188:191], v[192:195]
v_mov_b32_dpp v136, v144 row_ror:8 row_mask:0xf bank_mask:0xc
v_mov_b32_dpp v137, v145 row_ror:8 row_mask:0xf bank_mask:0xc
v_mfma_f32_16x16x32_bf16 v[196:199], a[32:35], v[188:191], 0
v_mov_b32_dpp v138, v146 row_ror:8 row_mask:0xf bank_mask:0xc
v_mov_b32_dpp v139, v147 row_ror:8 row_mask:0xf bank_mask:0xc
v_mfma_f32_16x16x32_bf16 v[196:199], a[36:39], v[208:211], v[196:199]
v_mov_b32_dpp v144, v140 row_ror:8 row_mask:0xf bank_mask:0x3
v_mov_b32_dpp v145, v141 row_ror:8 row_mask:0xf bank_mask:0x3
v_mfma_f32_16x16x32_bf16 v[196:199], a[40:43], v[212:215], v[196:199]
v_cvt_pk_bf16_f32 v98, v192, v193
v_cvt_pk_bf16_f32 v99, v194, v195
v_mfma_f32_16x16x32_bf16 v[196:199], a[44:47], v[216:219], v[196:199]
v_mov_b32_dpp v146, v142 row_ror:8 row_mask:0xf bank_mask:0x3
v_mov_b32_dpp v147, v143 row_ror:8 row_mask:0xf bank_mask:0x3
v_mfma_f32_16x16x32_bf16 v[192:195], a[60:63], v[216:219], 0
v_exp_f32 v200, v200
v_mfma_f32_16x16x32_bf16 v[192:195], a[56:59], v[212:215], v[192:195]
v_exp_f32 v201, v201
v_mfma_f32_16x16x32_bf16 v[192:195], a[52:55], v[208:211], v[192:195]
s_nop 0
v_cvt_pk_bf16_f32 v100, v196, v197
v_cvt_pk_bf16_f32 v101, v198, v199
v_mfma_f32_16x16x32_bf16 v[192:195], a[48:51], v[188:191], v[192:195]
v_exp_f32 v202, v202
v_mfma_f32_32x32x16_bf16 v[168:183], v[236:239], v[132:135], 0
buffer_store_dwordx4 v[136:139], v244, s[20:23], s52 offen offset:0 nt
buffer_store_dwordx4 v[144:147], v244, s[20:23], s52 offen offset:2048 nt
v_exp_f32 v203, v203
v_cvt_pk_bf16_f32 v122, v200, v201
v_cvt_pk_bf16_f32 v123, v202, v203
v_mfma_f32_16x16x32_bf16 v[136:139], a[192:195], v[188:191], 0
v_cvt_pk_bf16_f32 v102, v192, v193
v_cvt_pk_bf16_f32 v103, v194, v195
v_mfma_f32_16x16x32_bf16 v[136:139], a[196:199], v[208:211], v[136:139]
v_exp_f32 v204, v204
v_mfma_f32_16x16x32_bf16 v[136:139], a[200:203], v[212:215], v[136:139]
v_exp_f32 v205, v205
v_mfma_f32_16x16x32_bf16 v[136:139], a[204:207], v[216:219], v[136:139]
v_exp_f32 v206, v206
v_mfma_f32_16x16x32_bf16 v[140:143], a[220:223], v[216:219], 0
v_exp_f32 v207, v207
v_mfma_f32_16x16x32_bf16 v[140:143], a[216:219], v[212:215], v[140:143]
v_exp_f32 v220, v220
v_mfma_f32_16x16x32_bf16 v[140:143], a[212:215], v[208:211], v[140:143]
v_exp_f32 v221, v221
v_mfma_f32_16x16x32_bf16 v[140:143], a[208:211], v[188:191], v[140:143]
v_exp_f32 v222, v222
v_mfma_f32_16x16x32_bf16 v[144:147], a[224:227], v[188:191], 0
v_exp_f32 v223, v223
v_mfma_f32_16x16x32_bf16 v[144:147], a[228:231], v[208:211], v[144:147]
v_cvt_pk_bf16_f32 v124, v204, v205
v_cvt_pk_bf16_f32 v125, v206, v207
v_mfma_f32_16x16x32_bf16 v[144:147], a[232:235], v[212:215], v[144:147]
v_cvt_pk_bf16_f32 v126, v220, v221
v_cvt_pk_bf16_f32 v127, v222, v223
v_mfma_f32_16x16x32_bf16 v[144:147], a[236:239], v[216:219], v[144:147]
v_mov_b64 v[192:193], s[96:97]
v_mov_b64 v[194:195], s[96:97]
v_mfma_f32_16x16x32_bf16 v[148:151], a[252:255], v[216:219], 0
v_exp_f32 v224, v224
v_mfma_f32_16x16x32_bf16 v[148:151], a[248:251], v[212:215], v[148:151]
v_exp_f32 v225, v225
v_mfma_f32_16x16x32_bf16 v[148:151], a[244:247], v[208:211], v[148:151]
v_exp_f32 v226, v226
v_mfma_f32_16x16x32_bf16 v[148:151], a[240:243], v[188:191], v[148:151]
v_exp_f32 v227, v227
v_smfmac_f32_16x16x64_bf16 v[192:195], v[238:241], v[96:103], v251
v_mov_b64 v[188:189], 0
v_mfma_f32_16x16x32_bf16 v[196:199], v[0:3], v[96:99], 0
v_exp_f32 v228, v228
v_mfma_f32_16x16x32_bf16 v[196:199], v[4:7], v[100:103], v[196:199]
v_exp_f32 v229, v229
v_mfma_f32_16x16x32_bf16 v[200:203], v[12:15], v[100:103], 0
v_exp_f32 v230, v230
v_mfma_f32_16x16x32_bf16 v[200:203], v[8:11], v[96:99], v[200:203]
v_exp_f32 v231, v231
v_smfmac_f32_16x16x64_bf16 v[188:191], v[184:187], v[120:127], v251
ds_read_b128 v[204:207], v242 offset:12672
v_cvt_pk_bf16_f32 v128, v224, v225
v_cvt_pk_bf16_f32 v129, v226, v227
v_cvt_pk_bf16_f32 v130, v228, v229
v_cvt_pk_bf16_f32 v131, v230, v231
v_add_f32 v192, v192, v193
v_add_f32 v194, v194, v195
v_smfmac_f32_16x16x64_bf16 v[188:191], v[184:187], v[128:135], v251 abid:1
ds_read_b128 v[208:211], v242 offset:12928
ds_read_b128 v[212:215], v242 offset:13184
v_mfma_f32_16x16x32_bf16 v[168:171], v[80:83], v[128:131], v[168:171]
ds_read_b128 v[216:219], v242 offset:13440
v_add_u32 v242, s56, v242
v_mfma_f32_16x16x32_bf16 v[168:171], v[64:67], v[124:127], v[168:171]
s_sub_u32 s56, 0, s56
v_exp_f32 v192, v192
v_mfma_f32_16x16x32_bf16 v[168:171], v[48:51], v[120:123], v[168:171]
v_exp_f32 v194, v194
v_mfma_f32_16x16x32_bf16 v[172:175], v[52:55], v[120:123], v[172:175]
v_perm_b32 v116, v194, v192, v252
v_perm_b32 v117, v194, v192, v253
v_mfma_f32_16x16x32_bf16 v[172:175], v[68:71], v[124:127], v[172:175]
v_add_f32 v188, v188, v189
v_mfma_f32_16x16x32_bf16 v[172:175], v[84:87], v[128:131], v[172:175]
v_rcp_f32 v254, v188
v_mfma_f32_16x16x32_bf16 v[176:179], v[88:91], v[128:131], v[176:179]
v_max3_f32 v255, v255, v188, v254
v_fmac_f32 v152, v168, v254
v_mfma_f32_16x16x32_bf16 v[176:179], v[72:75], v[124:127], v[176:179]
v_fmac_f32 v153, v169, v254
v_fmac_f32 v154, v170, v254
v_mfma_f32_16x16x32_bf16 v[176:179], v[56:59], v[120:123], v[176:179]
v_fmac_f32 v155, v171, v254
v_cvt_pk_bf16_f32 v152, v152, v153
v_mfma_f32_16x16x32_bf16 v[180:183], v[60:63], v[120:123], v[180:183]
v_mov_b32 v192, s45
v_fmac_f32 v156, v172, v254
v_mfma_f32_16x16x32_bf16 v[180:183], v[76:79], v[124:127], v[180:183]
s_waitcnt lgkmcnt(3)
v_fmac_f32 v157, v173, v254
v_fmac_f32 v160, v176, v254
v_mfma_f32_16x16x32_bf16 v[180:183], v[92:95], v[128:131], v[180:183]
s_waitcnt vmcnt(6)
ds_write_addtid_b32 v192 offset:65280
v_mfma_f32_16x16x32_bf16 v[220:223], v[20:23], v[100:103], 0
s_waitcnt lgkmcnt(2)
v_fmac_f32 v161, v177, v254
v_fmac_f32 v162, v178, v254
v_mfma_f32_16x16x32_bf16 v[220:223], v[16:19], v[96:99], v[220:223]
s_waitcnt lgkmcnt(1)
v_fmac_f32 v163, v179, v254
v_cvt_pk_bf16_f32 v160, v160, v161
v_mfma_f32_16x16x32_bf16 v[192:195], v[24:27], v[96:99], 0
v_fmac_f32 v158, v174, v254
v_fmac_f32 v159, v175, v254
v_mfma_f32_16x16x32_bf16 v[192:195], v[28:31], v[100:103], v[192:195]
v_cvt_pk_bf16_f32 v153, v154, v155
v_fmac_f32 v164, v180, v254
v_mfma_f32_16x16x32_bf16 v[224:227], v[36:39], v[100:103], 0
v_fmac_f32 v165, v181, v254
v_fmac_f32 v166, v182, v254
v_mfma_f32_16x16x32_bf16 v[224:227], v[32:35], v[96:99], v[224:227]
v_fmac_f32 v167, v183, v254
v_cvt_pk_bf16_f32 v161, v162, v163
v_mfma_f32_16x16x32_bf16 v[228:231], v[40:43], v[96:99], 0
v_cvt_pk_bf16_f32 v154, v156, v157
v_cvt_pk_bf16_f32 v155, v158, v159
v_mfma_f32_16x16x32_bf16 v[228:231], v[44:47], v[100:103], v[228:231]
v_cvt_pk_bf16_f32 v162, v164, v165
v_cvt_pk_bf16_f32 v163, v166, v167
v_mfma_f32_16x16x32_bf16 v[188:191], a[0:3], v[204:207], 0
v_pk_max_i16 v152, v152, 0
v_pk_max_i16 v153, v153, 0
v_mfma_f32_16x16x32_bf16 v[188:191], a[4:7], v[208:211], v[188:191]
v_pk_max_i16 v154, v154, 0
v_pk_max_i16 v155, v155, 0
v_mfma_f32_16x16x32_bf16 v[188:191], a[8:11], v[212:215], v[188:191]
v_pk_max_i16 v160, v160, 0
v_pk_max_i16 v161, v161, 0
v_mfma_f32_16x16x32_bf16 v[188:191], a[12:15], v[216:219], v[188:191]
v_pk_max_i16 v162, v162, 0
v_pk_max_i16 v163, v163, 0
v_mfma_f32_16x16x32_bf16 v[232:235], a[28:31], v[216:219], 0
v_mov_b64 v[156:157], v[152:153]
v_mov_b64 v[158:159], v[154:155]
v_mfma_f32_16x16x32_bf16 v[232:235], a[24:27], v[212:215], v[232:235]
v_mov_b32_dpp v152, v160 row_ror:8 row_mask:0xf bank_mask:0xc
v_mov_b32_dpp v153, v161 row_ror:8 row_mask:0xf bank_mask:0xc
v_mfma_f32_16x16x32_bf16 v[232:235], a[20:23], v[208:211], v[232:235]
v_cvt_pk_bf16_f32 v96, v188, v189
v_cvt_pk_bf16_f32 v97, v190, v191
v_mfma_f32_16x16x32_bf16 v[232:235], a[16:19], v[204:207], v[232:235]
v_mov_b32_dpp v154, v162 row_ror:8 row_mask:0xf bank_mask:0xc
v_mov_b32_dpp v155, v163 row_ror:8 row_mask:0xf bank_mask:0xc
v_mfma_f32_16x16x32_bf16 v[188:191], a[32:35], v[204:207], 0
v_mov_b32_dpp v160, v156 row_ror:8 row_mask:0xf bank_mask:0x3
v_mov_b32_dpp v161, v157 row_ror:8 row_mask:0xf bank_mask:0x3
v_mfma_f32_16x16x32_bf16 v[188:191], a[36:39], v[208:211], v[188:191]
v_mov_b32_dpp v162, v158 row_ror:8 row_mask:0xf bank_mask:0x3
v_mov_b32_dpp v163, v159 row_ror:8 row_mask:0xf bank_mask:0x3
v_mfma_f32_16x16x32_bf16 v[188:191], a[40:43], v[212:215], v[188:191]
v_cvt_pk_bf16_f32 v98, v232, v233
v_cvt_pk_bf16_f32 v99, v234, v235
v_mfma_f32_16x16x32_bf16 v[188:191], a[44:47], v[216:219], v[188:191]
v_exp_f32 v200, v200
v_mfma_f32_16x16x32_bf16 v[232:235], a[60:63], v[216:219], 0
v_exp_f32 v201, v201
v_mfma_f32_16x16x32_bf16 v[232:235], a[56:59], v[212:215], v[232:235]
v_exp_f32 v202, v202
v_mfma_f32_16x16x32_bf16 v[232:235], a[52:55], v[208:211], v[232:235]
v_exp_f32 v203, v203
v_mfma_f32_16x16x32_bf16 v[232:235], a[48:51], v[204:207], v[232:235]
v_cvt_pk_bf16_f32 v100, v188, v189
v_cvt_pk_bf16_f32 v101, v190, v191
v_mfma_f32_32x32x16_bf16 v[168:183], v[236:239], v[116:119], 0
s_cmp_lg_u32 s45, 0
buffer_store_dwordx4 v[152:155], v244, s[20:23], s53 offen offset:0 nt
buffer_store_dwordx4 v[160:163], v244, s[20:23], s53 offen offset:2048 nt
s_cbranch_scc1 L_loopf
v_mfma_f32_16x16x32_bf16 v[152:155], a[192:195], v[204:207], 0
s_barrier
v_mfma_f32_16x16x32_bf16 v[152:155], a[196:199], v[208:211], v[152:155]
s_add_u32 s52, s47, 8192
v_cvt_pk_bf16_f32 v102, v232, v233
v_cvt_pk_bf16_f32 v103, v234, v235
v_mfma_f32_16x16x32_bf16 v[152:155], a[200:203], v[212:215], v[152:155]
s_lshl_b32 s55, s41, 9
v_mov_b64 v[188:189], s[96:97]
v_mov_b64 v[190:191], s[96:97]
v_mfma_f32_16x16x32_bf16 v[152:155], a[204:207], v[216:219], v[152:155]
s_add_u32 s53, s47, 12288
v_exp_f32 v220, v220
v_mfma_f32_16x16x32_bf16 v[156:159], a[220:223], v[216:219], 0
v_exp_f32 v221, v221
v_mfma_f32_16x16x32_bf16 v[156:159], a[216:219], v[212:215], v[156:159]
v_exp_f32 v222, v222
v_mfma_f32_16x16x32_bf16 v[156:159], a[212:215], v[208:211], v[156:159]
v_exp_f32 v223, v223
v_mfma_f32_16x16x32_bf16 v[156:159], a[208:211], v[204:207], v[156:159]
v_cvt_pk_bf16_f32 v108, v220, v221
v_cvt_pk_bf16_f32 v109, v222, v223
v_mfma_f32_16x16x32_bf16 v[160:163], a[224:227], v[204:207], 0
v_exp_f32 v192, v192
v_mfma_f32_16x16x32_bf16 v[160:163], a[228:231], v[208:211], v[160:163]
v_exp_f32 v193, v193
v_mfma_f32_16x16x32_bf16 v[160:163], a[232:235], v[212:215], v[160:163]
v_exp_f32 v194, v194
v_mfma_f32_16x16x32_bf16 v[160:163], a[236:239], v[216:219], v[160:163]
v_exp_f32 v196, v196
v_mfma_f32_16x16x32_bf16 v[164:167], a[252:255], v[216:219], 0
v_exp_f32 v197, v197
v_mfma_f32_16x16x32_bf16 v[164:167], a[248:251], v[212:215], v[164:167]
v_exp_f32 v198, v198
v_mfma_f32_16x16x32_bf16 v[164:167], a[244:247], v[208:211], v[164:167]
ds_read_b128 v[208:211], v242 offset:768
v_cvt_pk_bf16_f32 v104, v196, v197
v_mfma_f32_16x16x32_bf16 v[164:167], a[240:243], v[204:207], v[164:167]
v_exp_f32 v199, v199
v_smfmac_f32_16x16x64_bf16 v[188:191], v[238:241], v[96:103], v251
s_mul_i32 s54, s41, 13824
s_add_u32 s54, s54, 102400
v_cvt_pk_bf16_f32 v105, v198, v199
v_mfma_f32_16x16x32_bf16 v[204:207], v[0:3], v[96:99], 0
ds_read_b128 v[196:199], v242 offset:256
v_cvt_pk_bf16_f32 v110, v192, v193
v_mfma_f32_16x16x32_bf16 v[204:207], v[4:7], v[100:103], v[204:207]
v_exp_f32 v195, v195
v_mfma_f32_16x16x32_bf16 v[216:219], v[12:15], v[100:103], 0
v_cvt_pk_bf16_f32 v111, v194, v195
v_cvt_pk_bf16_f32 v106, v200, v201
v_mfma_f32_16x16x32_bf16 v[216:219], v[8:11], v[96:99], v[216:219]
ds_read_b128 v[192:195], v242 offset:0
v_cvt_pk_bf16_f32 v107, v202, v203
v_mfma_f32_16x16x32_bf16 v[220:223], v[16:19], v[96:99], 0
ds_read_b128 v[200:203], v242 offset:512
v_mov_b64 v[212:213], 0
v_mfma_f32_16x16x32_bf16 v[220:223], v[20:23], v[100:103], v[220:223]
v_exp_f32 v224, v224
v_smfmac_f32_16x16x64_bf16 v[212:215], v[184:187], v[104:111], v251
s_mov_b32 vcc_lo, 0xf0000f
s_mov_b32 vcc_hi, 0xf0000f00
v_exp_f32 v225, v225
v_exp_f32 v226, v226
v_exp_f32 v227, v227
v_exp_f32 v228, v228
v_exp_f32 v229, v229
v_exp_f32 v230, v230
v_exp_f32 v231, v231
v_cvt_pk_bf16_f32 v112, v224, v225
v_cvt_pk_bf16_f32 v113, v226, v227
v_cvt_pk_bf16_f32 v114, v228, v229
v_cvt_pk_bf16_f32 v115, v230, v231
v_add_f32 v188, v188, v189
v_add_f32 v190, v190, v191
v_smfmac_f32_16x16x64_bf16 v[212:215], v[184:187], v[112:119], v251 abid:1
s_waitcnt lgkmcnt(3)
s_lshl_b32 s48, s43, 7
s_add_u32 s48, s48, s44
s_add_u32 s48, s48, 0
v_mfma_f32_16x16x32_bf16 v[168:171], v[80:83], v[112:115], v[168:171]
s_waitcnt lgkmcnt(2)
v_exp_f32 v188, v188
v_mfma_f32_16x16x32_bf16 v[168:171], v[64:67], v[108:111], v[168:171]
v_exp_f32 v190, v190
v_mfma_f32_16x16x32_bf16 v[168:171], v[48:51], v[104:107], v[168:171]
v_perm_b32 v132, v190, v188, v252
v_perm_b32 v133, v190, v188, v253
v_mfma_f32_16x16x32_bf16 v[188:191], v[24:27], v[96:99], 0
s_waitcnt lgkmcnt(1)
v_add_f32 v212, v212, v213
v_mbcnt_lo_u32_b32 v245, -1, 0
v_mfma_f32_16x16x32_bf16 v[188:191], v[28:31], v[100:103], v[188:191]
s_waitcnt lgkmcnt(0)
v_rcp_f32 v254, v212
v_mfma_f32_16x16x32_bf16 v[172:175], v[52:55], v[104:107], v[172:175]
v_fmac_f32 v136, v168, v254
v_fmac_f32 v137, v169, v254
v_mfma_f32_16x16x32_bf16 v[172:175], v[68:71], v[108:111], v[172:175]
v_fmac_f32 v138, v170, v254
v_fmac_f32 v139, v171, v254
v_mfma_f32_16x16x32_bf16 v[172:175], v[84:87], v[112:115], v[172:175]
v_cvt_pk_bf16_f32 v136, v136, v137
v_cvt_pk_bf16_f32 v137, v138, v139
v_mfma_f32_16x16x32_bf16 v[224:227], v[32:35], v[96:99], 0
v_pk_max_i16 v136, v136, 0
v_pk_max_i16 v137, v137, 0
v_mfma_f32_16x16x32_bf16 v[224:227], v[36:39], v[100:103], v[224:227]
v_mbcnt_hi_u32_b32 v245, -1, v245
v_bfe_u32 v246, v245, 2, 2
v_mfma_f32_16x16x32_bf16 v[176:179], v[56:59], v[104:107], v[176:179]
v_fmac_f32 v140, v172, v254
v_fmac_f32 v141, v173, v254
v_mfma_f32_16x16x32_bf16 v[176:179], v[72:75], v[108:111], v[176:179]
v_fmac_f32 v142, v174, v254
v_fmac_f32 v143, v175, v254
v_mfma_f32_16x16x32_bf16 v[176:179], v[88:91], v[112:115], v[176:179]
v_cvt_pk_bf16_f32 v138, v140, v141
v_cvt_pk_bf16_f32 v139, v142, v143
v_mfma_f32_16x16x32_bf16 v[228:231], v[40:43], v[96:99], 0
v_pk_max_i16 v138, v138, 0
v_pk_max_i16 v139, v139, 0
v_mfma_f32_16x16x32_bf16 v[228:231], v[44:47], v[100:103], v[228:231]
v_mov_b64 v[140:141], v[136:137]
v_mov_b64 v[142:143], v[138:139]
v_mfma_f32_16x16x32_bf16 v[180:183], v[60:63], v[104:107], v[180:183]
v_fmac_f32 v144, v176, v254
v_fmac_f32 v145, v177, v254
v_mfma_f32_16x16x32_bf16 v[180:183], v[76:79], v[108:111], v[180:183]
v_fmac_f32 v146, v178, v254
v_fmac_f32 v147, v179, v254
v_mfma_f32_16x16x32_bf16 v[180:183], v[92:95], v[112:115], v[180:183]
v_cvt_pk_bf16_f32 v144, v144, v145
v_cvt_pk_bf16_f32 v145, v146, v147
v_mfma_f32_16x16x32_bf16 v[0:3], a[192:195], v[192:195], 0
v_pk_max_i16 v144, v144, 0
v_pk_max_i16 v145, v145, 0
v_mfma_f32_16x16x32_bf16 v[0:3], a[196:199], v[196:199], v[0:3]
v_mov_b32_dpp v136, v144 row_ror:8 row_mask:0xf bank_mask:0xc
v_mov_b32_dpp v137, v145 row_ror:8 row_mask:0xf bank_mask:0xc
v_mfma_f32_16x16x32_bf16 v[0:3], a[200:203], v[200:203], v[0:3]
v_fmac_f32 v148, v180, v254
v_fmac_f32 v149, v181, v254
v_mfma_f32_16x16x32_bf16 v[0:3], a[204:207], v[208:211], v[0:3]
v_fmac_f32 v150, v182, v254
v_fmac_f32 v151, v183, v254
v_mfma_f32_16x16x32_bf16 v[4:7], a[220:223], v[208:211], 0
v_cvt_pk_bf16_f32 v146, v148, v149
v_cvt_pk_bf16_f32 v147, v150, v151
v_mfma_f32_16x16x32_bf16 v[4:7], a[216:219], v[200:203], v[4:7]
v_pk_max_i16 v146, v146, 0
v_pk_max_i16 v147, v147, 0
v_mfma_f32_16x16x32_bf16 v[4:7], a[212:215], v[196:199], v[4:7]
v_mov_b32_dpp v138, v146 row_ror:8 row_mask:0xf bank_mask:0xc
v_mov_b32_dpp v139, v147 row_ror:8 row_mask:0xf bank_mask:0xc
v_mfma_f32_16x16x32_bf16 v[4:7], a[208:211], v[192:195], v[4:7]
v_mov_b32_dpp v144, v140 row_ror:8 row_mask:0xf bank_mask:0x3
v_mov_b32_dpp v145, v141 row_ror:8 row_mask:0xf bank_mask:0x3
v_mfma_f32_16x16x32_bf16 v[8:11], a[224:227], v[192:195], 0
v_mov_b32_dpp v146, v142 row_ror:8 row_mask:0xf bank_mask:0x3
v_mov_b32_dpp v147, v143 row_ror:8 row_mask:0xf bank_mask:0x3
v_mfma_f32_16x16x32_bf16 v[8:11], a[228:231], v[196:199], v[8:11]
ds_read_b128 v[232:235], v242 offset:4480
v_mov_b32 v247, s54
v_mfma_f32_16x16x32_bf16 v[8:11], a[232:235], v[200:203], v[8:11]
v_mul_u32_u24 v246, 1728, v246
v_add_u32 v247, v246, v247
v_mfma_f32_16x16x32_bf16 v[8:11], a[236:239], v[208:211], v[8:11]
v_bfe_u32 v246, v245, 0, 2
v_mul_u32_u24 v246, 272, v246
v_mfma_f32_16x16x32_bf16 v[12:15], a[252:255], v[208:211], 0
ds_read_b128 v[208:211], v242 offset:4736
v_add_u32 v247, v246, v247
v_mfma_f32_16x16x32_bf16 v[12:15], a[248:251], v[200:203], v[12:15]
ds_read_b128 v[200:203], v242 offset:4992
v_bfe_u32 v246, v245, 4, 2
v_mfma_f32_16x16x32_bf16 v[12:15], a[244:247], v[196:199], v[12:15]
v_lshl_add_u32 v247, v246, 4, v247
v_mov_b32 v243, s54
v_mfma_f32_16x16x32_bf16 v[12:15], a[240:243], v[192:195], v[12:15]
ds_read_b128 v[196:199], v247 offset:0
ds_read_b128 v[192:195], v247 offset:64
v_mfma_f32_32x32x16_bf16 v[168:183], v[236:239], v[132:135], 0
buffer_store_dwordx4 v[136:139], v244, s[20:23], s52 offen offset:0 nt
buffer_store_dwordx4 v[144:147], v244, s[20:23], s52 offen offset:2048 nt
v_bfe_u32 v246, v245, 2, 2
v_add_u32 v243, 256, v243
v_mul_u32_u24 v246, 1728, v246
v_add_u32 v243, v246, v243
v_bfe_u32 v246, v245, 0, 2
v_mul_u32_u24 v246, 272, v246
v_add_u32 v243, v246, v243
v_mov_b32 v249, s54
v_bfe_u32 v246, v245, 4, 2
v_add_u32 v249, 1136, v249
v_mul_u32_u24 v246, 1728, v246
v_add_u32 v249, v246, v249
v_bfe_u32 v246, v245, 0, 4
v_lshl_add_u32 v249, v246, 3, v249
ds_read_b64 v[32:33], v249 offset:0
ds_read_b64 v[34:35], v249 offset:6912
ds_read_b64 v[36:37], v249 offset:128
ds_read_b64 v[38:39], v249 offset:7040
ds_read_b64 v[40:41], v249 offset:256
ds_read_b64 v[42:43], v249 offset:7168
ds_read_b64 v[44:45], v249 offset:384
ds_read_b64 v[46:47], v249 offset:7296
v_mov_b32 v250, s55
v_add_u32 v250, 160960, v250
v_bfe_u32 v246, v245, 0, 4
v_lshl_add_u32 v250, v246, 4, v250
ds_read_b64 v[96:97], v250 offset:0
ds_read_b32 v102, v250 offset:8
ds_read_b64 v[100:101], v250 offset:256
ds_read_b32 v103, v250 offset:264
v_mov_b64 v[98:99], 0
v_exp_f32 v188, v188
v_exp_f32 v189, v189
v_exp_f32 v190, v190
v_exp_f32 v191, v191
v_cvt_pk_bf16_f32 v126, v188, v189
v_cvt_pk_bf16_f32 v127, v190, v191
ds_read_b128 v[188:191], v247 offset:128
v_exp_f32 v204, v204
s_waitcnt lgkmcnt(4)
v_cndmask_b32 v96, 0, v96, vcc
v_cndmask_b32 v97, 0, v97, vcc
v_exp_f32 v205, v205
v_max3_f32 v255, v255, v212, v254
v_mfma_f32_16x16x32_bf16 v[196:199], v[32:35], v[96:99], v[196:199]
s_waitcnt lgkmcnt(1)
ds_read_b128 v[212:215], v242 offset:4224
v_cvt_pk_bf16_f32 v120, v204, v205
v_mfma_f32_16x16x32_bf16 v[192:195], v[36:39], v[96:99], v[192:195]
v_exp_f32 v206, v206
v_exp_f32 v207, v207
v_mov_b32 v248, 24576
s_waitcnt lgkmcnt(1)
v_mfma_f32_16x16x32_bf16 v[188:191], v[40:43], v[96:99], v[188:191]
v_cvt_pk_bf16_f32 v121, v206, v207
ds_read_b128 v[204:207], v247 offset:192
v_exp_f32 v216, v216
v_exp_f32 v217, v217
v_exp_f32 v218, v218
v_exp_f32 v219, v219
v_cvt_pk_bf16_f32 v122, v216, v217
v_cvt_pk_bf16_f32 v123, v218, v219
ds_read_b128 v[216:219], v243 offset:0
v_exp_f32 v220, v220
v_exp_f32 v221, v221
v_exp_f32 v222, v222
v_cvt_pk_bf16_f32 v124, v220, v221
s_waitcnt lgkmcnt(1)
v_mfma_f32_16x16x32_bf16 v[204:207], v[44:47], v[96:99], v[204:207]
v_exp_f32 v223, v223
v_mov_b64 v[220:221], 0
v_cvt_pk_bf16_f32 v125, v222, v223
v_exp_f32 v224, v224
v_cndmask_b32 v100, 0, v100, vcc
v_smfmac_f32_16x16x64_bf16 v[220:223], v[184:187], v[120:127], v251
s_lshl_b32 s51, s43, 7
s_add_u32 s51, s51, s44
s_add_u32 s51, s51, 52428800
v_exp_f32 v225, v225
v_exp_f32 v226, v226
v_exp_f32 v227, v227
v_exp_f32 v228, v228
v_exp_f32 v229, v229
v_exp_f32 v230, v230
v_exp_f32 v231, v231
v_cvt_pk_bf16_f32 v128, v224, v225
v_cvt_pk_bf16_f32 v129, v226, v227
ds_read_b128 v[224:227], v247 offset:6912
v_cvt_pk_bf16_f32 v130, v228, v229
v_cvt_pk_bf16_f32 v131, v230, v231
v_cndmask_b32 v101, 0, v101, vcc
v_bfe_u32 v246, v245, 0, 2
v_smfmac_f32_16x16x64_bf16 v[220:223], v[184:187], v[128:135], v251 abid:1
s_waitcnt lgkmcnt(1)
ds_read_b128 v[228:231], v247 offset:6976
v_add_f32 v216, v216, v217
v_mfma_f32_16x16x32_bf16 v[16:19], a[192:195], v[212:215], 0
v_add_f32 v218, v218, v219
v_add_f32 v216, v216, v102
v_mfma_f32_16x16x32_bf16 v[16:19], a[196:199], v[232:235], v[16:19]
v_add_f32 v216, v216, v218
v_add_f32 v220, v220, v221
v_mfma_f32_16x16x32_bf16 v[16:19], a[200:203], v[208:211], v[16:19]
v_rcp_f32 v217, v216
v_mfma_f32_16x16x32_bf16 v[16:19], a[204:207], v[200:203], v[16:19]
v_rcp_f32 v254, v220
v_mfma_f32_16x16x32_bf16 v[20:23], a[220:223], v[200:203], 0
v_max3_f32 v255, v255, v216, v217
v_max3_f32 v255, v255, v220, v254
v_mfma_f32_16x16x32_bf16 v[20:23], a[216:219], v[208:211], v[20:23]
ds_read_b128 v[220:223], v247 offset:7040
v_fmac_f32 v8, v188, v217
v_mfma_f32_16x16x32_bf16 v[20:23], a[212:215], v[232:235], v[20:23]
v_fmac_f32 v9, v189, v217
v_fmac_f32 v10, v190, v217
v_mfma_f32_16x16x32_bf16 v[20:23], a[208:211], v[212:215], v[20:23]
v_fmac_f32 v11, v191, v217
v_lshl_add_u32 v248, v246, 8, v248
v_mfma_f32_16x16x32_bf16 v[24:27], a[224:227], v[212:215], 0
ds_read_b128 v[188:191], v247 offset:7104
v_bfe_u32 v246, v245, 2, 2
v_mfma_f32_16x16x32_bf16 v[24:27], a[228:231], v[232:235], v[24:27]
v_fmac_f32 v0, v196, v217
v_fmac_f32 v1, v197, v217
v_mfma_f32_16x16x32_bf16 v[24:27], a[232:235], v[208:211], v[24:27]
s_waitcnt lgkmcnt(3)
v_mul_u32_u24 v246, 13107200, v246
v_fmac_f32 v2, v198, v217
v_mfma_f32_16x16x32_bf16 v[24:27], a[236:239], v[200:203], v[24:27]
v_fmac_f32 v3, v199, v217
v_cvt_pk_bf16_f32 v0, v0, v1
v_mfma_f32_16x16x32_bf16 v[28:31], a[252:255], v[200:203], 0
s_waitcnt lgkmcnt(2)
v_cvt_pk_bf16_f32 v8, v8, v9
v_fmac_f32 v4, v192, v217
v_mfma_f32_16x16x32_bf16 v[28:31], a[248:251], v[208:211], v[28:31]
v_fmac_f32 v5, v193, v217
v_fmac_f32 v6, v194, v217
v_mfma_f32_16x16x32_bf16 v[28:31], a[244:247], v[232:235], v[28:31]
v_fmac_f32 v7, v195, v217
v_add_u32 v248, v246, v248
v_mfma_f32_16x16x32_bf16 v[28:31], a[240:243], v[212:215], v[28:31]
ds_read_b128 v[192:195], v243 offset:6912
v_cvt_pk_bf16_f32 v1, v2, v3
v_mfma_f32_16x16x32_bf16 v[168:171], v[48:51], v[120:123], v[168:171]
v_fmac_f32 v12, v204, v217
v_fmac_f32 v13, v205, v217
v_mfma_f32_16x16x32_bf16 v[168:171], v[64:67], v[124:127], v[168:171]
v_fmac_f32 v14, v206, v217
v_fmac_f32 v15, v207, v217
v_mfma_f32_16x16x32_bf16 v[168:171], v[80:83], v[128:131], v[168:171]
s_waitcnt lgkmcnt(2)
v_cvt_pk_bf16_f32 v9, v10, v11
v_bfe_u32 v246, v245, 4, 2
v_mfma_f32_16x16x32_bf16 v[172:175], v[84:87], v[128:131], v[172:175]
v_cvt_pk_bf16_f32 v2, v4, v5
v_cvt_pk_bf16_f32 v3, v6, v7
v_mfma_f32_16x16x32_bf16 v[172:175], v[52:55], v[120:123], v[172:175]
v_cvt_pk_bf16_f32 v10, v12, v13
v_cvt_pk_bf16_f32 v11, v14, v15
v_mfma_f32_16x16x32_bf16 v[172:175], v[68:71], v[124:127], v[172:175]
s_waitcnt lgkmcnt(0)
v_lshl_add_u32 v248, v246, 4, v248
v_pk_max_i16 v0, v0, 0
v_mfma_f32_16x16x32_bf16 v[176:179], v[72:75], v[124:127], v[176:179]
v_pk_max_i16 v1, v1, 0
v_pk_max_i16 v2, v2, 0
v_mfma_f32_16x16x32_bf16 v[176:179], v[88:91], v[128:131], v[176:179]
v_pk_max_i16 v3, v3, 0
v_pk_max_i16 v8, v8, 0
v_mfma_f32_16x16x32_bf16 v[176:179], v[56:59], v[120:123], v[176:179]
v_pk_max_i16 v9, v9, 0
v_pk_max_i16 v10, v10, 0
v_mfma_f32_16x16x32_bf16 v[180:183], v[60:63], v[120:123], v[180:183]
v_pk_max_i16 v11, v11, 0
v_fmac_f32 v152, v168, v254
v_mfma_f32_16x16x32_bf16 v[180:183], v[76:79], v[124:127], v[180:183]
buffer_store_dwordx4 v[0:3], v248, s[20:23], s48 offen offset:0 nt
buffer_store_dwordx4 v[8:11], v248, s[20:23], s48 offen offset:64 nt
v_fmac_f32 v153, v169, v254
v_fmac_f32 v160, v176, v254
v_fmac_f32 v161, v177, v254
v_fmac_f32 v154, v170, v254
v_mfma_f32_16x16x32_bf16 v[180:183], v[92:95], v[128:131], v[180:183]
v_fmac_f32 v155, v171, v254
v_cvt_pk_bf16_f32 v152, v152, v153
v_mfma_f32_16x16x32_bf16 v[224:227], v[32:35], v[98:101], v[224:227]
v_fmac_f32 v162, v178, v254
v_fmac_f32 v163, v179, v254
v_mfma_f32_16x16x32_bf16 v[228:231], v[36:39], v[98:101], v[228:231]
v_cvt_pk_bf16_f32 v160, v160, v161
v_fmac_f32 v156, v172, v254
v_mfma_f32_16x16x32_bf16 v[220:223], v[40:43], v[98:101], v[220:223]
v_fmac_f32 v157, v173, v254
v_fmac_f32 v158, v174, v254
v_mfma_f32_16x16x32_bf16 v[188:191], v[44:47], v[98:101], v[188:191]
v_fmac_f32 v159, v175, v254
v_cvt_pk_bf16_f32 v153, v154, v155
v_fmac_f32 v164, v180, v254
v_fmac_f32 v165, v181, v254
v_fmac_f32 v166, v182, v254
v_fmac_f32 v167, v183, v254
v_cvt_pk_bf16_f32 v161, v162, v163
v_cvt_pk_bf16_f32 v154, v156, v157
v_cvt_pk_bf16_f32 v155, v158, v159
v_cvt_pk_bf16_f32 v162, v164, v165
v_cvt_pk_bf16_f32 v163, v166, v167
v_pk_max_i16 v152, v152, 0
v_pk_max_i16 v153, v153, 0
v_pk_max_i16 v154, v154, 0
v_pk_max_i16 v155, v155, 0
v_pk_max_i16 v160, v160, 0
v_pk_max_i16 v161, v161, 0
v_pk_max_i16 v162, v162, 0
v_pk_max_i16 v163, v163, 0
v_mov_b64 v[156:157], v[152:153]
v_mov_b64 v[158:159], v[154:155]
v_mov_b32_dpp v152, v160 row_ror:8 row_mask:0xf bank_mask:0xc
v_mov_b32_dpp v153, v161 row_ror:8 row_mask:0xf bank_mask:0xc
v_mov_b32_dpp v154, v162 row_ror:8 row_mask:0xf bank_mask:0xc
v_mov_b32_dpp v155, v163 row_ror:8 row_mask:0xf bank_mask:0xc
v_mov_b32_dpp v160, v156 row_ror:8 row_mask:0xf bank_mask:0x3
v_mov_b32_dpp v161, v157 row_ror:8 row_mask:0xf bank_mask:0x3
v_mov_b32_dpp v162, v158 row_ror:8 row_mask:0xf bank_mask:0x3
v_mov_b32_dpp v163, v159 row_ror:8 row_mask:0xf bank_mask:0x3
buffer_store_dwordx4 v[152:155], v244, s[20:23], s53 offen offset:0 nt
buffer_store_dwordx4 v[160:163], v244, s[20:23], s53 offen offset:2048 nt
v_add_f32 v192, v192, v193
v_add_f32 v194, v194, v195
v_add_f32 v192, v192, v103
v_add_f32 v192, v192, v194
v_rcp_f32 v193, v192
s_nop 0
v_fmac_f32 v16, v224, v193
v_fmac_f32 v17, v225, v193
v_fmac_f32 v24, v220, v193
v_fmac_f32 v25, v221, v193
v_fmac_f32 v18, v226, v193
v_fmac_f32 v19, v227, v193
v_cvt_pk_bf16_f32 v16, v16, v17
v_fmac_f32 v26, v222, v193
v_fmac_f32 v27, v223, v193
v_cvt_pk_bf16_f32 v24, v24, v25
v_fmac_f32 v20, v228, v193
v_fmac_f32 v21, v229, v193
v_fmac_f32 v22, v230, v193
v_fmac_f32 v23, v231, v193
v_cvt_pk_bf16_f32 v17, v18, v19
v_fmac_f32 v28, v188, v193
v_fmac_f32 v29, v189, v193
v_fmac_f32 v30, v190, v193
v_fmac_f32 v31, v191, v193
v_cvt_pk_bf16_f32 v25, v26, v27
v_cvt_pk_bf16_f32 v18, v20, v21
v_cvt_pk_bf16_f32 v19, v22, v23
v_cvt_pk_bf16_f32 v26, v28, v29
v_cvt_pk_bf16_f32 v27, v30, v31
v_pk_max_i16 v16, v16, 0
v_pk_max_i16 v17, v17, 0
v_pk_max_i16 v18, v18, 0
v_pk_max_i16 v19, v19, 0
v_pk_max_i16 v24, v24, 0
v_pk_max_i16 v25, v25, 0
v_pk_max_i16 v26, v26, 0
v_pk_max_i16 v27, v27, 0
buffer_store_dwordx4 v[16:19], v248, s[20:23], s51 offen offset:0 nt
buffer_store_dwordx4 v[24:27], v248, s[20:23], s51 offen offset:64 nt
v_max3_f32 v255, v255, v192, v193
v_mov_b32 v1, 0x53800000
v_cmp_nle_f32 vcc, v255, v1
s_lshl_b32 s52, s41, 2
s_add_u32 s52, s52, 163008
s_or_b32 s3, vcc_lo, vcc_hi
v_mov_b32 v2, s52
v_mov_b32 v3, s3
ds_write_b32 v2, v3
v_mov_b32 v2, 163008
s_waitcnt lgkmcnt(0)
s_barrier
ds_read_b128 v[4:7], v2
s_waitcnt lgkmcnt(0)
v_or_b32 v4, v4, v5
v_or3_b32 v4, v4, v6, v7
s_nop 0
v_readfirstlane_b32 s3, v4
s_nop 3
s_cmp_eq_u32 s3, 0
s_cbranch_scc1 L_end
L_fast_end:
s_waitcnt vmcnt(0)
s_barrier
s_mov_b32 s45, 8
s_mov_b32 s3, 64
s_mov_b32 s46, s44
s_mov_b32 s47, 0x7ff00000
s_mov_b32 s56, 50688
v_mbcnt_lo_u32_b32 v48, -1, 0
v_mbcnt_hi_u32_b32 v48, -1, v48
v_lshlrev_b32 v53, 4, v48
s_lshl_b32 s54, s41, 13
s_add_u32 s57, s54, 4096
v_and_b32 v49, 16, v48
v_lshlrev_b32 v52, 2, v49
v_lshlrev_b32 v49, 1, v49
v_xor_b32 v50, v53, v49
s_mul_i32 s49, s42, 25344
s_mul_i32 s53, s43, 1056
s_add_u32 s49, s49, s53
s_add_u32 m0, s49, 0
s_lshl_b32 s55, s43, 10
s_add_u32 s55, s55, s44
s_add_u32 s48, s55, 0
v_mov_b32 v237, 0
v_bfe_u32 v49, v48, 0, 2
v_lshl_add_u32 v237, v49, 4, v237
v_bfe_u32 v49, v48, 4, 2
v_lshl_add_u32 v237, v49, 6, v237
v_bfe_u32 v49, v48, 2, 2
v_lshl_add_u32 v237, v49, 8, v237
v_xor_b32 v51, 64, v50
s_lshl_b32 s53, s43, 14
v_mov_b32 v248, s53
v_add_u32 v248, 50688, v248
v_bfe_u32 v49, v48, 4, 2
v_lshl_add_u32 v248, v49, 10, v248
v_bfe_u32 v49, v48, 2, 2
v_lshl_add_u32 v248, v49, 7, v248
v_bfe_u32 v49, v48, 3, 1
v_lshl_add_u32 v248, v49, 5, v248
v_bfe_u32 v49, v48, 4, 1
v_lshl_add_u32 v248, v49, 6, v248
v_bfe_u32 v49, v48, 0, 2
v_lshl_add_u32 v248, v49, 3, v248
v_mov_b32 v252, s53
v_add_u32 v252, 116224, v252
v_bfe_u32 v49, v48, 4, 2
v_lshl_add_u32 v252, v49, 10, v252
v_bfe_u32 v49, v48, 2, 2
v_lshl_add_u32 v252, v49, 7, v252
v_bfe_u32 v49, v48, 3, 1
v_lshl_add_u32 v252, v49, 6, v252
v_bfe_u32 v49, v48, 0, 2
v_lshl_add_u32 v252, v49, 4, v252
s_mul_i32 s53, s42, 25344
v_bfe_u32 v49, v48, 2, 2
v_mov_b32 v236, s53
v_mul_u32_u24 v49, 1056, v49
v_add_u32 v236, v49, v236
v_bfe_u32 v49, v48, 0, 2
s_add_u32 s53, s54, 83456
v_lshl_add_u32 v236, v49, 6, v236
v_add_u32 v104, s53, v50
v_add_u32 v105, s53, v51
v_bfe_u32 v49, v48, 4, 2
s_lshl_b32 s53, s41, 12
v_lshl_add_u32 v236, v49, 4, v236
v_mov_b32 v54, s53
v_add_u32 v54, 50688, v54
v_bfe_u32 v49, v48, 3, 1
v_lshl_add_u32 v54, v49, 14, v54
v_bfe_u32 v49, v48, 4, 2
v_lshl_add_u32 v54, v49, 7, v54
v_bfe_u32 v49, v48, 2, 1
v_lshl_add_u32 v54, v49, 6, v54
v_bfe_u32 v49, v48, 5, 1
v_lshl_add_u32 v54, v49, 5, v54
v_bfe_u32 v49, v48, 0, 2
v_lshl_add_u32 v54, v49, 3, v54
s_lshl_b32 s53, s43, 7
v_mov_b32 v239, s53
v_bfe_u32 v49, v48, 0, 4
v_lshl_add_u32 v239, v49, 8, v239
s_mul_i32 s52, s41, 12288
s_add_u32 s52, s52, 101376
v_bfe_u32 v49, v48, 4, 2
v_lshl_add_u32 v239, v49, 4, v239
v_mov_b32 v241, s52
v_add_u32 v241, 8192, v241
v_bfe_u32 v49, v48, 4, 2
v_lshl_add_u32 v241, v49, 1, v241
v_bfe_u32 v49, v48, 0, 4
v_lshl_add_u32 v241, v49, 3, v241
buffer_load_dwordx4 v[152:155], v53, s[24:27], s54 offen offset:0
v_mov_b32 v240, s52
v_bfe_u32 v49, v48, 2, 2
v_lshl_add_u32 v240, v49, 7, v240
buffer_load_dwordx4 v[156:159], v53, s[24:27], s54 offen offset:1024
v_lshlrev_b32 v49, 2, v48
v_xor_b32 v49, v49, v48
v_and_b32 v49, 48, v49
buffer_load_dwordx4 v[160:163], v53, s[24:27], s54 offen offset:2048
s_lshl_b32 s53, s41, 10
v_add_u32 v240, v49, v240
v_mov_b32 v254, s53
v_add_u32 v254, 150528, v254
buffer_load_dwordx4 v[164:167], v53, s[24:27], s54 offen offset:3072
v_bfe_u32 v49, v48, 0, 6
v_mov_b32 v40, 0
v_mov_b32 v41, 0
buffer_load_dwordx4 v[168:171], v53, s[24:27], s57 offen offset:0
v_mov_b32 v42, 0
v_mov_b32 v43, 0
v_lshl_add_u32 v254, v49, 4, v254
buffer_load_dwordx4 v[172:175], v53, s[24:27], s57 offen offset:1024
ds_write_b128 v254, v[40:43] offset:0
buffer_load_dwordx4 v[176:179], v53, s[24:27], s57 offen offset:2048
ds_write_b128 v254, v[40:43] offset:256
buffer_load_dwordx4 v[180:183], v53, s[24:27], s57 offen offset:3072
buffer_load_dwordx4 v237, s[16:19], s48 offen nt lds
s_add_u32 m0, s49, 2112
s_add_u32 s48, s55, 2048
v_mov_b32 v245, s52
v_add_u32 v245, 4096, v245
buffer_load_dwordx4 v237, s[16:19], s48 offen nt lds
s_add_u32 m0, s49, 4224
s_add_u32 s48, s55, 4096
v_bfe_u32 v49, v48, 0, 2
buffer_load_dwordx4 v237, s[16:19], s48 offen nt lds
s_add_u32 m0, s49, 6336
s_add_u32 s48, s55, 6144
s_mov_b32 vcc_lo, 0x11111111
s_mov_b32 vcc_hi, 0x11111111
buffer_load_dwordx4 v237, s[16:19], s48 offen nt lds
s_add_u32 m0, s54, 50688
v_lshl_add_u32 v245, v49, 7, v245
v_mov_b32 v254, 150528
v_lshlrev_b32 v49, 4, v48
buffer_load_dwordx4 v50, s[28:31], s54 offen offset:0 lds
v_cndmask_b32 v240, v254, v240, vcc
v_xor_b32 v49, v49, v48
v_and_b32 v49, 48, v49
buffer_load_dwordx4 v51, s[28:31], s54 offen offset:1024 lds
s_mov_b32 vcc_lo, 0xf000f
s_mov_b32 vcc_hi, 0xf000f
v_add_u32 v245, v49, v245
buffer_load_dwordx4 v50, s[28:31], s54 offen offset:2048 lds
v_cndmask_b32 v242, v254, v245, vcc
s_mov_b32 vcc_lo, 0xf000f0
s_mov_b32 vcc_hi, 0xf000f0
buffer_load_dwordx4 v51, s[28:31], s54 offen offset:3072 lds
s_add_u32 m0, s57, 50688
v_cndmask_b32 v243, v254, v245, vcc
s_mov_b32 vcc_lo, 0xf000f00
s_mov_b32 vcc_hi, 0xf000f00
buffer_load_dwordx4 v50, s[28:31], s57 offen offset:0 lds
v_cndmask_b32 v244, v254, v245, vcc
s_mov_b32 vcc_lo, 0xf000f000
s_mov_b32 vcc_hi, 0xf000f000
v_mov_b32 v246, s52
buffer_load_dwordx4 v51, s[28:31], s57 offen offset:1024 lds
v_add_u32 v246, 4096, v246
v_bfe_u32 v49, v48, 0, 2
v_cndmask_b32 v245, v254, v245, vcc
buffer_load_dwordx4 v50, s[28:31], s57 offen offset:2048 lds
v_lshl_add_u32 v246, v49, 7, v246
v_mov_b32 v254, 154880
v_bfe_u32 v49, v48, 2, 2
buffer_load_dwordx4 v51, s[28:31], s57 offen offset:3072 lds
s_add_u32 m0, s49, 16896
s_mov_b32 vcc_lo, 0xf000f
s_mov_b32 vcc_hi, 0xf000f
v_lshl_add_u32 v254, v49, 3, v254
v_cndmask_b32 v246, v254, v246, vcc
v_xor_b32 v249, 32, v248
v_xor_b32 v250, 64, v248
v_xor_b32 v251, 96, v248
s_mul_i32 s4, s43, 13107200
s_add_u32 s4, s4, s44
s_add_u32 s4, s4, 24576
s_add_u32 s5, s55, 104857600
s_sub_u32 s5, s5, s4
s_add_u32 s48, s4, 0
v_xor_b32 v52, v53, v52
v_xor_b32 v55, 96, v54
v_xor_b32 v253, 64, v252
v_lshlrev_b32 v49, 4, v48
v_xor_b32 v49, v49, v48
v_and_b32 v49, 48, v49
v_add_u32 v246, v49, v246
v_add_u32 v246, v49, v246
v_mov_b32 v50, s52
v_bfe_u32 v49, v48, 0, 4
v_lshl_add_u32 v50, v49, 7, v50
v_lshlrev_b32 v49, 4, v48
v_xor_b32 v49, v49, v48
v_and_b32 v49, 48, v49
v_add_u32 v50, v49, v50
v_mov_b32 v51, s52
v_add_u32 v51, 8192, v51
v_bfe_u32 v49, v48, 4, 2
v_lshl_add_u32 v51, v49, 9, v51
v_bfe_u32 v49, v48, 0, 4
v_lshl_add_u32 v51, v49, 3, v51
s_add_u32 s50, s55, 13107200
s_mov_b32 s51, 2048
v_xor_b32 v247, 32, v48
s_mov_b32 s52, 0x7ff00000
v_lshlrev_b32 v247, 2, v247
s_waitcnt vmcnt(19)
v_and_b32 v254, 0xffff0000, v152
buffer_load_dwordx4 v237, s[16:19], s48 offen nt lds
s_add_u32 m0, s49, 19008
s_add_u32 s48, s4, 26214400
v_and_b32 v255, 0xffff0000, v153
v_lshlrev_b32 v152, 16, v152
v_lshlrev_b32 v153, 16, v153
v_mul_f32 v254, s40, v254
v_mul_f32 v152, s40, v152
v_mul_f32 v255, s40, v255
v_mul_f32 v153, s40, v153
v_cvt_pk_bf16_f32 v152, v152, v254
v_cvt_pk_bf16_f32 v153, v153, v255
v_and_b32 v254, 0xffff0000, v154
v_and_b32 v255, 0xffff0000, v155
v_lshlrev_b32 v154, 16, v154
v_lshlrev_b32 v155, 16, v155
v_mul_f32 v254, s40, v254
v_mul_f32 v154, s40, v154
v_mul_f32 v255, s40, v255
v_mul_f32 v155, s40, v155
v_cvt_pk_bf16_f32 v154, v154, v254
v_cvt_pk_bf16_f32 v155, v155, v255
s_waitcnt vmcnt(19)
v_and_b32 v254, 0xffff0000, v156
v_and_b32 v255, 0xffff0000, v157
v_lshlrev_b32 v156, 16, v156
v_lshlrev_b32 v157, 16, v157
v_mul_f32 v254, s40, v254
v_mul_f32 v156, s40, v156
v_mul_f32 v255, s40, v255
v_mul_f32 v157, s40, v157
v_cvt_pk_bf16_f32 v156, v156, v254
buffer_load_dwordx4 v237, s[16:19], s48 offen nt lds
s_add_u32 m0, s49, 21120
s_add_u32 s48, s4, 52428800
v_cvt_pk_bf16_f32 v157, v157, v255
v_and_b32 v254, 0xffff0000, v158
v_and_b32 v255, 0xffff0000, v159
v_lshlrev_b32 v158, 16, v158
v_lshlrev_b32 v159, 16, v159
v_mul_f32 v254, s40, v254
v_mul_f32 v158, s40, v158
v_mul_f32 v255, s40, v255
v_mul_f32 v159, s40, v159
v_cvt_pk_bf16_f32 v158, v158, v254
v_cvt_pk_bf16_f32 v159, v159, v255
s_waitcnt vmcnt(19)
v_and_b32 v254, 0xffff0000, v160
v_and_b32 v255, 0xffff0000, v161
v_lshlrev_b32 v160, 16, v160
v_lshlrev_b32 v161, 16, v161
v_mul_f32 v254, s40, v254
v_mul_f32 v160, s40, v160
v_mul_f32 v255, s40, v255
v_mul_f32 v161, s40, v161
v_cvt_pk_bf16_f32 v160, v160, v254
v_cvt_pk_bf16_f32 v161, v161, v255
v_and_b32 v254, 0xffff0000, v162
v_and_b32 v255, 0xffff0000, v163
v_lshlrev_b32 v162, 16, v162
v_lshlrev_b32 v163, 16, v163
v_mul_f32 v254, s40, v254
v_mul_f32 v162, s40, v162
v_mul_f32 v255, s40, v255
v_mul_f32 v163, s40, v163
v_cvt_pk_bf16_f32 v162, v162, v254
buffer_load_dwordx4 v237, s[16:19], s48 offen nt lds
s_add_u32 m0, s49, 23232
s_add_u32 s48, s4, 78643200
ds_write_b128 v104, v[152:155] offset:0
ds_write_b128 v105, v[156:159] offset:1024
v_cvt_pk_bf16_f32 v163, v163, v255
s_waitcnt vmcnt(19)
v_and_b32 v254, 0xffff0000, v164
v_and_b32 v255, 0xffff0000, v165
v_lshlrev_b32 v164, 16, v164
v_lshlrev_b32 v165, 16, v165
v_mul_f32 v254, s40, v254
v_mul_f32 v164, s40, v164
v_mul_f32 v255, s40, v255
v_mul_f32 v165, s40, v165
v_cvt_pk_bf16_f32 v164, v164, v254
v_cvt_pk_bf16_f32 v165, v165, v255
v_and_b32 v254, 0xffff0000, v166
v_and_b32 v255, 0xffff0000, v167
v_lshlrev_b32 v166, 16, v166
v_lshlrev_b32 v167, 16, v167
v_mul_f32 v254, s40, v254
buffer_load_dwordx4 v237, s[16:19], s48 offen nt lds
s_add_u32 m0, s54, 116224
s_add_u32 s48, s55, 8192
ds_write_b128 v104, v[160:163] offset:2048
v_mul_f32 v166, s40, v166
v_mul_f32 v255, s40, v255
v_mul_f32 v167, s40, v167
v_cvt_pk_bf16_f32 v166, v166, v254
v_cvt_pk_bf16_f32 v167, v167, v255
s_waitcnt vmcnt(19)
v_and_b32 v254, 0xffff0000, v168
v_and_b32 v255, 0xffff0000, v169
v_lshlrev_b32 v168, 16, v168
v_lshlrev_b32 v169, 16, v169
v_mul_f32 v254, s40, v254
v_mul_f32 v168, s40, v168
v_mul_f32 v255, s40, v255
v_mul_f32 v169, s40, v169
v_cvt_pk_bf16_f32 v168, v168, v254
v_cvt_pk_bf16_f32 v169, v169, v255
v_and_b32 v254, 0xffff0000, v170
v_and_b32 v255, 0xffff0000, v171
v_lshlrev_b32 v170, 16, v170
v_lshlrev_b32 v171, 16, v171
v_mul_f32 v254, s40, v254
v_mul_f32 v170, s40, v170
v_mul_f32 v255, s40, v255
v_mul_f32 v171, s40, v171
buffer_load_dwordx4 v52, s[32:35], s54 offen offset:0 lds
ds_write_b128 v105, v[164:167] offset:3072
v_cvt_pk_bf16_f32 v170, v170, v254
v_cvt_pk_bf16_f32 v171, v171, v255
s_waitcnt vmcnt(19)
v_and_b32 v254, 0xffff0000, v172
v_and_b32 v255, 0xffff0000, v173
v_lshlrev_b32 v172, 16, v172
v_lshlrev_b32 v173, 16, v173
v_mul_f32 v254, s40, v254
v_mul_f32 v172, s40, v172
v_mul_f32 v255, s40, v255
v_mul_f32 v173, s40, v173
v_cvt_pk_bf16_f32 v172, v172, v254
v_cvt_pk_bf16_f32 v173, v173, v255
v_and_b32 v254, 0xffff0000, v174
v_and_b32 v255, 0xffff0000, v175
v_lshlrev_b32 v174, 16, v174
v_lshlrev_b32 v175, 16, v175
v_mul_f32 v254, s40, v254
v_mul_f32 v174, s40, v174
v_mul_f32 v255, s40, v255
v_mul_f32 v175, s40, v175
v_cvt_pk_bf16_f32 v174, v174, v254
v_cvt_pk_bf16_f32 v175, v175, v255
s_waitcnt vmcnt(18)
v_and_b32 v254, 0xffff0000, v176
v_and_b32 v255, 0xffff0000, v177
v_lshlrev_b32 v176, 16, v176
buffer_load_dwordx4 v52, s[32:35], s54 offen offset:1024 lds
ds_write_b128 v104, v[168:171] offset:4096
v_lshlrev_b32 v177, 16, v177
v_mul_f32 v254, s40, v254
v_mul_f32 v176, s40, v176
v_mul_f32 v255, s40, v255
v_mul_f32 v177, s40, v177
v_cvt_pk_bf16_f32 v176, v176, v254
v_cvt_pk_bf16_f32 v177, v177, v255
v_and_b32 v254, 0xffff0000, v178
v_and_b32 v255, 0xffff0000, v179
v_lshlrev_b32 v178, 16, v178
v_lshlrev_b32 v179, 16, v179
v_mul_f32 v254, s40, v254
v_mul_f32 v178, s40, v178
v_mul_f32 v255, s40, v255
v_mul_f32 v179, s40, v179
v_cvt_pk_bf16_f32 v178, v178, v254
v_cvt_pk_bf16_f32 v179, v179, v255
s_waitcnt vmcnt(18)
v_and_b32 v254, 0xffff0000, v180
v_and_b32 v255, 0xffff0000, v181
v_lshlrev_b32 v180, 16, v180
v_lshlrev_b32 v181, 16, v181
v_mul_f32 v254, s40, v254
v_mul_f32 v180, s40, v180
v_mul_f32 v255, s40, v255
v_mul_f32 v181, s40, v181
buffer_load_dwordx4 v52, s[32:35], s54 offen offset:2048 lds
ds_write_b128 v105, v[172:175] offset:5120
ds_write_b128 v104, v[176:179] offset:6144
v_cvt_pk_bf16_f32 v180, v180, v254
v_cvt_pk_bf16_f32 v181, v181, v255
v_and_b32 v254, 0xffff0000, v182
v_and_b32 v255, 0xffff0000, v183
v_lshlrev_b32 v182, 16, v182
v_lshlrev_b32 v183, 16, v183
v_mul_f32 v254, s40, v254
v_mul_f32 v182, s40, v182
v_mul_f32 v255, s40, v255
v_mul_f32 v183, s40, v183
v_cvt_pk_bf16_f32 v182, v182, v254
v_cvt_pk_bf16_f32 v183, v183, v255
ds_write_b128 v105, v[180:183] offset:7168
buffer_load_dwordx4 v52, s[32:35], s54 offen offset:3072 lds
s_add_u32 m0, s57, 116224
v_xor_b32 v254, 32, v54
v_xor_b32 v255, 64, v54
s_mov_b32 s53, 0x7ff00000
buffer_load_dwordx4 v52, s[32:35], s57 offen offset:0 lds
buffer_load_dwordx4 v52, s[32:35], s57 offen offset:1024 lds
s_waitcnt vmcnt(10) lgkmcnt(0)
s_barrier
ds_read_b64_tr_b16 a[64:65], v248 offset:0
ds_read_b64_tr_b16 a[66:67], v248 offset:512
ds_read_b128 v[188:191], v236 offset:0
ds_read_b64_tr_b16 a[68:69], v248 offset:4096
ds_read_b64_tr_b16 a[70:71], v248 offset:4608
buffer_load_dwordx4 v52, s[32:35], s57 offen offset:2048 lds
ds_read_b128 v[196:199], v236 offset:256
ds_read_b64_tr_b16 a[72:73], v248 offset:8192
ds_read_b64_tr_b16 a[74:75], v248 offset:8704
ds_read_b128 v[200:203], v236 offset:512
ds_read_b64_tr_b16 a[76:77], v248 offset:12288
ds_read_b64_tr_b16 a[78:79], v248 offset:12800
ds_read_b128 v[204:207], v236 offset:768
ds_read_b64_tr_b16 a[92:93], v249 offset:12288
ds_read_b64_tr_b16 a[94:95], v249 offset:12800
ds_read_b64_tr_b16 a[88:89], v249 offset:8192
ds_read_b64_tr_b16 a[90:91], v249 offset:8704
ds_read_b64_tr_b16 a[84:85], v249 offset:4096
ds_read_b64_tr_b16 a[86:87], v249 offset:4608
ds_read_b64_tr_b16 a[80:81], v249 offset:0
ds_read_b64_tr_b16 a[82:83], v249 offset:512
s_waitcnt lgkmcnt(15)
v_mfma_f32_16x16x32_bf16 v[192:195], a[64:67], v[188:191], 0
ds_read_b64_tr_b16 a[96:97], v250 offset:0
ds_read_b64_tr_b16 a[98:99], v250 offset:512
s_waitcnt lgkmcnt(15)
v_mfma_f32_16x16x32_bf16 v[192:195], a[68:71], v[196:199], v[192:195]
s_waitcnt lgkmcnt(14)
ds_read_b64_tr_b16 a[100:101], v250 offset:4096
s_waitcnt lgkmcnt(14)
v_mfma_f32_16x16x32_bf16 v[192:195], a[72:75], v[200:203], v[192:195]
s_waitcnt lgkmcnt(11)
ds_read_b64_tr_b16 a[102:103], v250 offset:4608
ds_read_b64_tr_b16 a[104:105], v250 offset:8192
v_mfma_f32_16x16x32_bf16 v[192:195], a[76:79], v[204:207], v[192:195]
s_waitcnt lgkmcnt(9)
ds_read_b64_tr_b16 a[106:107], v250 offset:8704
ds_read_b64_tr_b16 a[108:109], v250 offset:12288
v_mfma_f32_16x16x32_bf16 v[208:211], a[92:95], v[204:207], 0
s_waitcnt lgkmcnt(7)
buffer_load_dwordx4 v52, s[32:35], s57 offen offset:3072 lds
s_add_u32 m0, s49, 8448
v_mfma_f32_16x16x32_bf16 v[208:211], a[88:91], v[200:203], v[208:211]
ds_read_b64_tr_b16 a[110:111], v250 offset:12800
v_cvt_pk_bf16_f32 v0, v192, v193
v_mfma_f32_16x16x32_bf16 v[208:211], a[84:87], v[196:199], v[208:211]
s_waitcnt lgkmcnt(6)
ds_read_b64_tr_b16 a[124:125], v251 offset:12288
v_cvt_pk_bf16_f32 v1, v194, v195
v_mfma_f32_16x16x32_bf16 v[208:211], a[80:83], v[188:191], v[208:211]
s_waitcnt lgkmcnt(6)
ds_read_b64_tr_b16 a[126:127], v251 offset:12800
ds_read_b64_tr_b16 a[120:121], v251 offset:8192
v_mfma_f32_16x16x32_bf16 v[192:195], a[96:99], v[188:191], 0
s_waitcnt lgkmcnt(6)
ds_read_b64_tr_b16 a[122:123], v251 offset:8704
ds_read_b64_tr_b16 a[116:117], v251 offset:4096
v_mfma_f32_16x16x32_bf16 v[192:195], a[100:103], v[196:199], v[192:195]
s_waitcnt lgkmcnt(6)
ds_read_b64_tr_b16 a[118:119], v251 offset:4608
v_cvt_pk_bf16_f32 v2, v208, v209
v_mfma_f32_16x16x32_bf16 v[192:195], a[104:107], v[200:203], v[192:195]
ds_read_b64_tr_b16 a[112:113], v251 offset:0
s_waitcnt lgkmcnt(7)
v_mfma_f32_16x16x32_bf16 v[192:195], a[108:111], v[204:207], v[192:195]
ds_read_b64_tr_b16 a[114:115], v251 offset:512
v_cvt_pk_bf16_f32 v3, v210, v211
ds_read_b128 v[184:187], v236 offset:4992
s_waitcnt lgkmcnt(7)
v_mfma_f32_16x16x32_bf16 v[208:211], a[124:127], v[204:207], 0
s_waitcnt lgkmcnt(6)
buffer_load_dwordx4 v[120:123], v53, s[36:39], s54 offen offset:0
s_waitcnt lgkmcnt(5)
v_mfma_f32_16x16x32_bf16 v[208:211], a[120:123], v[200:203], v[208:211]
s_waitcnt lgkmcnt(4)
ds_read_b128 v[216:219], v236 offset:4736
s_waitcnt lgkmcnt(4)
v_mfma_f32_16x16x32_bf16 v[208:211], a[116:119], v[196:199], v[208:211]
ds_read_b128 v[204:207], v236 offset:4480
v_cvt_pk_bf16_f32 v5, v194, v195
v_cvt_pk_bf16_f32 v4, v192, v193
s_waitcnt lgkmcnt(3)
v_mfma_f32_16x16x32_bf16 v[208:211], a[112:115], v[188:191], v[208:211]
ds_read_b128 v[192:195], v236 offset:4224
s_waitcnt lgkmcnt(3)
v_mfma_f32_16x16x32_bf16 v[200:203], a[124:127], v[184:187], 0
ds_read_b64_tr_b16 a[0:1], v248 offset:32768
ds_read_b64_tr_b16 a[2:3], v248 offset:33280
v_mfma_f32_16x16x32_bf16 v[220:223], a[92:95], v[184:187], 0
ds_read_b64_tr_b16 a[4:5], v248 offset:36864
s_waitcnt lgkmcnt(5)
v_mfma_f32_16x16x32_bf16 v[200:203], a[120:123], v[216:219], v[200:203]
ds_read_b64_tr_b16 a[6:7], v248 offset:37376
s_waitcnt lgkmcnt(5)
v_mfma_f32_16x16x32_bf16 v[200:203], a[116:119], v[204:207], v[200:203]
ds_read_b64_tr_b16 a[8:9], v248 offset:40960
v_cvt_pk_bf16_f32 v6, v208, v209
v_mfma_f32_16x16x32_bf16 v[220:223], a[88:91], v[216:219], v[220:223]
buffer_load_dwordx4 v[124:127], v53, s[36:39], s54 offen offset:1024
s_waitcnt lgkmcnt(5)
v_mfma_f32_16x16x32_bf16 v[200:203], a[112:115], v[192:195], v[200:203]
ds_read_b64_tr_b16 a[10:11], v248 offset:41472
v_cvt_pk_bf16_f32 v7, v210, v211
v_mfma_f32_16x16x32_bf16 v[208:211], a[96:99], v[192:195], 0
s_waitcnt lgkmcnt(4)
ds_read_b64_tr_b16 a[12:13], v248 offset:45056
ds_read_b64_tr_b16 a[14:15], v248 offset:45568
v_mfma_f32_16x16x32_bf16 v[208:211], a[100:103], v[204:207], v[208:211]
s_waitcnt lgkmcnt(5)
ds_read_b64_tr_b16 a[16:17], v249 offset:32768
ds_read_b64_tr_b16 a[18:19], v249 offset:33280
v_mfma_f32_16x16x32_bf16 v[208:211], a[104:107], v[216:219], v[208:211]
s_waitcnt lgkmcnt(6)
ds_read_b64_tr_b16 a[20:21], v249 offset:36864
ds_read_b64_tr_b16 a[22:23], v249 offset:37376
v_mfma_f32_16x16x32_bf16 v[208:211], a[108:111], v[184:187], v[208:211]
s_waitcnt lgkmcnt(7)
ds_read_b64_tr_b16 a[24:25], v249 offset:40960
ds_read_b64_tr_b16 a[26:27], v249 offset:41472
v_mfma_f32_16x16x32_bf16 v[220:223], a[84:87], v[204:207], v[220:223]
ds_read_b64_tr_b16 a[28:29], v249 offset:45056
ds_read_b64_tr_b16 a[30:31], v249 offset:45568
v_mfma_f32_16x16x32_bf16 v[220:223], a[80:83], v[192:195], v[220:223]
s_waitcnt lgkmcnt(10)
ds_read_b64_tr_b16 a[32:33], v250 offset:32768
ds_read_b64_tr_b16 a[34:35], v250 offset:33280
v_mfma_f32_16x16x32_bf16 v[188:191], a[64:67], v[192:195], 0
s_waitcnt lgkmcnt(10)
ds_read_b64_tr_b16 a[36:37], v250 offset:36864
ds_read_b64_tr_b16 a[38:39], v250 offset:37376
v_mfma_f32_16x16x32_bf16 v[188:191], a[72:75], v[216:219], v[188:191]
s_waitcnt lgkmcnt(10)
buffer_load_dwordx4 v[128:131], v53, s[36:39], s54 offen offset:2048
ds_read_b64_tr_b16 a[40:41], v250 offset:40960
v_mfma_f32_16x16x32_bf16 v[188:191], a[76:79], v[184:187], v[188:191]
s_waitcnt lgkmcnt(9)
ds_read_b64_tr_b16 a[42:43], v250 offset:41472
ds_read_b64_tr_b16 a[44:45], v250 offset:45056
v_mfma_f32_16x16x32_bf16 v[188:191], a[68:71], v[204:207], v[188:191]
s_waitcnt lgkmcnt(9)
ds_read_b64_tr_b16 a[46:47], v250 offset:45568
ds_read_b64_tr_b16 a[48:49], v251 offset:32768
ds_read_b64_tr_b16 a[50:51], v251 offset:33280
ds_read_b64_tr_b16 a[52:53], v251 offset:36864
ds_read_b64_tr_b16 a[54:55], v251 offset:37376
ds_read_b64_tr_b16 a[56:57], v251 offset:40960
ds_read_b64_tr_b16 a[58:59], v251 offset:41472
s_waitcnt vmcnt(11)
s_barrier
ds_read_b128 v[56:59], v236 offset:16896
ds_read_b128 v[60:63], v236 offset:17152
ds_read_b128 v[64:67], v236 offset:17408
ds_read_b128 v[68:71], v236 offset:17664
ds_read_b128 v[72:75], v236 offset:21120
ds_read_b128 v[76:79], v236 offset:21376
ds_read_b128 v[80:83], v236 offset:21632
ds_read_b128 v[84:87], v236 offset:21888
ds_read_b64_tr_b16 a[60:61], v251 offset:45056
ds_read_b64_tr_b16 a[62:63], v251 offset:45568
v_cvt_pk_bf16_f32 v14, v200, v201
buffer_load_dwordx4 v[132:135], v53, s[36:39], s54 offen offset:3072
v_cvt_pk_bf16_f32 v15, v202, v203
v_cvt_pk_bf16_f32 v9, v190, v191
v_cvt_pk_bf16_f32 v8, v188, v189
v_cvt_pk_bf16_f32 v13, v210, v211
v_cvt_pk_bf16_f32 v12, v208, v209
v_cvt_pk_bf16_f32 v10, v220, v221
v_cvt_pk_bf16_f32 v11, v222, v223
s_waitcnt lgkmcnt(9)
v_mfma_f32_16x16x32_bf16 v[156:159], a[64:67], v[56:59], 0
s_waitcnt lgkmcnt(7)
v_mfma_f32_16x16x32_bf16 v[156:159], a[68:71], v[60:63], v[156:159]
s_waitcnt lgkmcnt(3)
v_mfma_f32_16x16x32_bf16 v[156:159], a[72:75], v[64:67], v[156:159]
s_waitcnt lgkmcnt(0)
v_mfma_f32_16x16x32_bf16 v[156:159], a[76:79], v[68:71], v[156:159]
s_nop 2
v_mfma_f32_16x16x32_bf16 v[160:163], a[92:95], v[68:71], 0
s_nop 2
v_mfma_f32_16x16x32_bf16 v[160:163], a[88:91], v[64:67], v[160:163]
s_waitcnt vmcnt(4)
s_barrier
v_mfma_f32_16x16x32_bf16 v[160:163], a[84:87], v[60:63], v[160:163]
buffer_load_dwordx4 v[136:139], v53, s[36:39], s57 offen offset:0
ds_read_b64_tr_b16 a[128:129], v252 offset:0
v_mfma_f32_16x16x32_bf16 v[160:163], a[80:83], v[56:59], v[160:163]
ds_read_b64_tr_b16 a[130:131], v252 offset:512
ds_read_b64_tr_b16 a[132:133], v252 offset:4096
v_mfma_f32_16x16x32_bf16 v[164:167], a[96:99], v[56:59], 0
ds_read_b64_tr_b16 a[134:135], v252 offset:4608
ds_read_b64_tr_b16 a[136:137], v252 offset:8192
v_mfma_f32_16x16x32_bf16 v[164:167], a[100:103], v[60:63], v[164:167]
ds_read_b64_tr_b16 a[138:139], v252 offset:8704
ds_read_b64_tr_b16 a[140:141], v252 offset:12288
v_mfma_f32_16x16x32_bf16 v[164:167], a[104:107], v[64:67], v[164:167]
ds_read_b64_tr_b16 a[142:143], v252 offset:12800
ds_read_b64_tr_b16 a[144:145], v252 offset:8
v_mfma_f32_16x16x32_bf16 v[164:167], a[108:111], v[68:71], v[164:167]
ds_read_b64_tr_b16 a[146:147], v252 offset:520
ds_read_b64_tr_b16 a[148:149], v252 offset:4104
v_mfma_f32_16x16x32_bf16 v[168:171], a[124:127], v[68:71], 0
s_waitcnt lgkmcnt(10)
ds_read_b64_tr_b16 a[150:151], v252 offset:4616
v_cvt_pk_bf16_f32 v88, v156, v157
v_mfma_f32_16x16x32_bf16 v[168:171], a[120:123], v[64:67], v[168:171]
s_waitcnt lgkmcnt(9)
ds_read_b64_tr_b16 a[152:153], v252 offset:8200
v_cvt_pk_bf16_f32 v89, v158, v159
v_mfma_f32_16x16x32_bf16 v[168:171], a[116:119], v[60:63], v[168:171]
s_waitcnt lgkmcnt(8)
ds_read_b64_tr_b16 a[154:155], v252 offset:8712
ds_read_b64_tr_b16 a[156:157], v252 offset:12296
v_mfma_f32_16x16x32_bf16 v[168:171], a[112:115], v[56:59], v[168:171]
s_waitcnt lgkmcnt(8)
buffer_load_dwordx4 v[140:143], v53, s[36:39], s57 offen offset:1024
ds_read_b64_tr_b16 a[158:159], v252 offset:12808
v_mfma_f32_16x16x32_bf16 v[172:175], a[64:67], v[72:75], 0
s_waitcnt lgkmcnt(7)
ds_read_b64_tr_b16 a[160:161], v253 offset:0
v_cvt_pk_bf16_f32 v90, v160, v161
v_mfma_f32_16x16x32_bf16 v[172:175], a[68:71], v[76:79], v[172:175]
s_waitcnt lgkmcnt(6)
ds_read_b64_tr_b16 a[162:163], v253 offset:512
v_cvt_pk_bf16_f32 v91, v162, v163
v_mfma_f32_16x16x32_bf16 v[172:175], a[72:75], v[80:83], v[172:175]
s_waitcnt lgkmcnt(6)
ds_read_b64_tr_b16 a[164:165], v253 offset:4096
ds_read_b64_tr_b16 a[166:167], v253 offset:4608
v_mfma_f32_16x16x32_bf16 v[172:175], a[76:79], v[84:87], v[172:175]
s_waitcnt lgkmcnt(7)
ds_read_b64_tr_b16 a[168:169], v253 offset:8192
ds_read_b64_tr_b16 a[170:171], v253 offset:8704
v_mfma_f32_16x16x32_bf16 v[176:179], a[92:95], v[84:87], 0
s_waitcnt lgkmcnt(7)
ds_read_b64_tr_b16 a[172:173], v253 offset:12288
v_cvt_pk_bf16_f32 v92, v164, v165
v_mfma_f32_16x16x32_bf16 v[176:179], a[88:91], v[80:83], v[176:179]
s_waitcnt lgkmcnt(7)
ds_read_b64_tr_b16 a[174:175], v253 offset:12800
v_cvt_pk_bf16_f32 v93, v166, v167
v_mfma_f32_16x16x32_bf16 v[176:179], a[84:87], v[76:79], v[176:179]
s_waitcnt lgkmcnt(7)
ds_read_b64_tr_b16 a[176:177], v253 offset:8
ds_read_b64_tr_b16 a[178:179], v253 offset:520
v_mfma_f32_16x16x32_bf16 v[176:179], a[80:83], v[72:75], v[176:179]
s_waitcnt lgkmcnt(8)
ds_read_b64_tr_b16 a[180:181], v253 offset:4104
ds_read_b64_tr_b16 a[182:183], v253 offset:4616
v_mfma_f32_16x16x32_bf16 v[180:183], a[96:99], v[72:75], 0
s_waitcnt lgkmcnt(8)
buffer_load_dwordx4 v[144:147], v53, s[36:39], s57 offen offset:2048
v_cvt_pk_bf16_f32 v94, v168, v169
v_mfma_f32_16x16x32_bf16 v[180:183], a[100:103], v[76:79], v[180:183]
s_waitcnt lgkmcnt(6)
ds_read_b64_tr_b16 a[184:185], v253 offset:8200
v_cvt_pk_bf16_f32 v95, v170, v171
v_mfma_f32_16x16x32_bf16 v[180:183], a[104:107], v[80:83], v[180:183]
s_waitcnt lgkmcnt(6)
ds_read_b64_tr_b16 a[186:187], v253 offset:8712
ds_read_b64_tr_b16 a[188:189], v253 offset:12296
v_mfma_f32_16x16x32_bf16 v[180:183], a[108:111], v[84:87], v[180:183]
s_waitcnt lgkmcnt(7)
ds_read_b64_tr_b16 a[190:191], v253 offset:12808
v_cvt_pk_bf16_f32 v96, v172, v173
v_mfma_f32_16x16x32_bf16 v[152:155], a[124:127], v[84:87], 0
s_waitcnt lgkmcnt(6)
v_cvt_pk_bf16_f32 v97, v174, v175
v_cvt_pk_bf16_f32 v98, v176, v177
v_mfma_f32_16x16x32_bf16 v[152:155], a[120:123], v[80:83], v[152:155]
s_waitcnt lgkmcnt(4)
v_cvt_pk_bf16_f32 v99, v178, v179
v_cvt_pk_bf16_f32 v100, v180, v181
v_mfma_f32_16x16x32_bf16 v[152:155], a[116:119], v[76:79], v[152:155]
v_cvt_pk_bf16_f32 v101, v182, v183
v_mov_b32 v253, 0
v_mfma_f32_16x16x32_bf16 v[152:155], a[112:115], v[72:75], v[152:155]
s_waitcnt lgkmcnt(3)
v_mov_b32 v252, 1.0
s_nop 0
v_mfma_f32_16x16x32_bf16 v[156:159], a[0:3], v[56:59], 0
s_waitcnt lgkmcnt(1)
s_nop 1
v_mfma_f32_16x16x32_bf16 v[156:159], a[4:7], v[60:63], v[156:159]
s_waitcnt lgkmcnt(0)
buffer_load_dwordx4 v[148:151], v53, s[36:39], s57 offen offset:3072
v_cvt_pk_bf16_f32 v102, v152, v153
v_mfma_f32_16x16x32_bf16 v[156:159], a[8:11], v[64:67], v[156:159]
v_cvt_pk_bf16_f32 v103, v154, v155
v_mfma_f32_16x16x32_bf16 v[156:159], a[12:15], v[68:71], v[156:159]
s_nop 2
v_mfma_f32_16x16x32_bf16 v[160:163], a[28:31], v[68:71], 0
s_nop 2
v_mfma_f32_16x16x32_bf16 v[160:163], a[24:27], v[64:67], v[160:163]
v_cvt_pk_bf16_f32 v104, v156, v157
v_cvt_pk_bf16_f32 v105, v158, v159
v_mfma_f32_16x16x32_bf16 v[160:163], a[20:23], v[60:63], v[160:163]
v_mfma_f32_16x16x32_bf16 v[160:163], a[16:19], v[56:59], v[160:163]
s_nop 2
v_mfma_f32_16x16x32_bf16 v[164:167], a[32:35], v[56:59], 0
s_nop 2
v_mfma_f32_16x16x32_bf16 v[164:167], a[36:39], v[60:63], v[164:167]
v_cvt_pk_bf16_f32 v106, v160, v161
v_cvt_pk_bf16_f32 v107, v162, v163
v_mfma_f32_16x16x32_bf16 v[164:167], a[40:43], v[64:67], v[164:167]
buffer_load_dwordx4 v237, s[16:19], s48 offen nt lds
s_add_u32 m0, s49, 10560
v_mfma_f32_16x16x32_bf16 v[164:167], a[44:47], v[68:71], v[164:167]
s_add_u32 s48, s55, 10240
s_nop 1
v_mfma_f32_16x16x32_bf16 v[168:171], a[60:63], v[68:71], 0
s_nop 2
v_mfma_f32_16x16x32_bf16 v[168:171], a[56:59], v[64:67], v[168:171]
v_cvt_pk_bf16_f32 v108, v164, v165
v_cvt_pk_bf16_f32 v109, v166, v167
v_mfma_f32_16x16x32_bf16 v[168:171], a[52:55], v[60:63], v[168:171]
v_mfma_f32_16x16x32_bf16 v[168:171], a[48:51], v[56:59], v[168:171]
s_nop 2
v_mfma_f32_16x16x32_bf16 v[172:175], a[0:3], v[72:75], 0
s_waitcnt vmcnt(8)
ds_write_b64 v54, v[120:121] offset:0
v_mfma_f32_16x16x32_bf16 v[172:175], a[4:7], v[76:79], v[172:175]
ds_write_b64 v254, v[122:123] offset:0
v_mfma_f32_16x16x32_bf16 v[172:175], a[8:11], v[80:83], v[172:175]
buffer_load_dwordx4 v237, s[16:19], s48 offen nt lds
v_mfma_f32_16x16x32_bf16 v[172:175], a[12:15], v[84:87], v[172:175]
s_add_u32 m0, s49, 12672
s_add_u32 s48, s55, 12288
v_cvt_pk_bf16_f32 v110, v168, v169
v_mfma_f32_16x16x32_bf16 v[176:179], a[28:31], v[84:87], 0
s_waitcnt vmcnt(8)
ds_write_b64 v54, v[124:125] offset:512
v_mfma_f32_16x16x32_bf16 v[176:179], a[24:27], v[80:83], v[176:179]
ds_write_b64 v254, v[126:127] offset:512
v_mfma_f32_16x16x32_bf16 v[176:179], a[20:23], v[76:79], v[176:179]
s_waitcnt vmcnt(7)
ds_write_b64 v255, v[128:129] offset:1024
v_mfma_f32_16x16x32_bf16 v[176:179], a[16:19], v[72:75], v[176:179]
ds_write_b64 v55, v[130:131] offset:1024
v_mfma_f32_16x16x32_bf16 v[180:183], a[32:35], v[72:75], 0
s_waitcnt vmcnt(6)
ds_write_b64 v255, v[132:133] offset:1536
v_mfma_f32_16x16x32_bf16 v[180:183], a[36:39], v[76:79], v[180:183]
ds_write_b64 v55, v[134:135] offset:1536
v_mfma_f32_16x16x32_bf16 v[180:183], a[40:43], v[80:83], v[180:183]
buffer_load_dwordx4 v237, s[16:19], s48 offen nt lds
s_add_u32 m0, s49, 14784
v_mfma_f32_16x16x32_bf16 v[180:183], a[44:47], v[84:87], v[180:183]
s_add_u32 s48, s55, 14336
v_cvt_pk_bf16_f32 v111, v170, v171
v_cvt_pk_bf16_f32 v112, v172, v173
v_mfma_f32_16x16x32_bf16 v[152:155], a[60:63], v[84:87], 0
s_waitcnt vmcnt(6)
ds_write_b64 v54, v[136:137] offset:2048
v_mfma_f32_16x16x32_bf16 v[152:155], a[56:59], v[80:83], v[152:155]
ds_write_b64 v254, v[138:139] offset:2048
v_mfma_f32_16x16x32_bf16 v[152:155], a[52:55], v[76:79], v[152:155]
s_waitcnt vmcnt(5)
ds_write_b64 v54, v[140:141] offset:2560
v_mfma_f32_16x16x32_bf16 v[152:155], a[48:51], v[72:75], v[152:155]
ds_write_b64 v254, v[142:143] offset:2560
v_mfma_f32_16x16x32_bf16 v[156:159], v[56:59], a[128:131], 0
s_waitcnt vmcnt(4)
ds_write_b64 v255, v[144:145] offset:3072
v_mfma_f32_16x16x32_bf16 v[156:159], v[60:63], a[132:135], v[156:159]
ds_write_b64 v55, v[146:147] offset:3072
v_mfma_f32_16x16x32_bf16 v[156:159], v[64:67], a[136:139], v[156:159]
buffer_load_dwordx4 v237, s[16:19], s48 offen nt lds
s_add_u32 m0, s49, 16896
v_mfma_f32_16x16x32_bf16 v[156:159], v[68:71], a[140:143], v[156:159]
s_add_u32 s48, s55, 16384
buffer_load_dwordx4 v237, s[16:19], s48 offen nt lds
s_add_u32 m0, s49, 19008
v_mfma_f32_16x16x32_bf16 v[160:163], v[68:71], a[156:159], 0
s_add_u32 s48, s55, 18432
buffer_load_dwordx4 v237, s[16:19], s48 offen nt lds
s_add_u32 m0, s49, 21120
v_mfma_f32_16x16x32_bf16 v[160:163], v[64:67], a[152:155], v[160:163]
s_add_u32 s48, s55, 20480
buffer_load_dwordx4 v237, s[16:19], s48 offen nt lds
s_add_u32 m0, s49, 23232
v_mfma_f32_16x16x32_bf16 v[160:163], v[60:63], a[148:151], v[160:163]
s_add_u32 s48, s55, 22528
buffer_load_dwordx4 v237, s[16:19], s48 offen nt lds
v_cvt_pk_bf16_f32 v113, v174, v175
v_mfma_f32_16x16x32_bf16 v[160:163], v[56:59], a[144:147], v[160:163]
s_add_u32 s49, s49, 50688
v_cvt_pk_bf16_f32 v114, v176, v177
v_cvt_pk_bf16_f32 v115, v178, v179
v_mfma_f32_16x16x32_bf16 v[164:167], v[56:59], a[160:163], 0
s_waitcnt vmcnt(8)
ds_write_b64 v255, v[148:149] offset:3584
v_mfma_f32_16x16x32_bf16 v[164:167], v[60:63], a[164:167], v[164:167]
ds_write_b64 v55, v[150:151] offset:3584
v_mfma_f32_16x16x32_bf16 v[164:167], v[64:67], a[168:171], v[164:167]
v_cvt_pk_bf16_f32 v116, v180, v181
v_cvt_pk_bf16_f32 v117, v182, v183
v_mfma_f32_16x16x32_bf16 v[164:167], v[68:71], a[172:175], v[164:167]
v_cvt_pk_bf16_f32 v118, v152, v153
v_cvt_pk_bf16_f32 v119, v154, v155
v_mfma_f32_16x16x32_bf16 v[168:171], v[68:71], a[188:191], 0
v_cvt_pk_bf16_f32 v156, v156, v157
v_cvt_pk_bf16_f32 v157, v158, v159
v_mfma_f32_16x16x32_bf16 v[168:171], v[64:67], a[184:187], v[168:171]
v_cvt_pk_bf16_f32 v160, v160, v161
v_cvt_pk_bf16_f32 v161, v162, v163
v_mfma_f32_16x16x32_bf16 v[168:171], v[60:63], a[180:183], v[168:171]
s_waitcnt lgkmcnt(0)
s_barrier
v_mfma_f32_16x16x32_bf16 v[168:171], v[56:59], a[176:179], v[168:171]
ds_read_b64_tr_b16 a[192:193], v248 offset:0
ds_read_b64_tr_b16 a[194:195], v248 offset:512
v_mfma_f32_16x16x32_bf16 v[172:175], v[72:75], a[128:131], 0
ds_read_b64_tr_b16 a[196:197], v248 offset:4096
ds_read_b64_tr_b16 a[198:199], v248 offset:4608
v_mfma_f32_16x16x32_bf16 v[172:175], v[76:79], a[132:135], v[172:175]
ds_read_b64_tr_b16 a[200:201], v248 offset:8192
ds_read_b64_tr_b16 a[202:203], v248 offset:8704
v_mfma_f32_16x16x32_bf16 v[172:175], v[80:83], a[136:139], v[172:175]
ds_read_b64_tr_b16 a[204:205], v248 offset:12288
ds_read_b64_tr_b16 a[206:207], v248 offset:12800
v_mfma_f32_16x16x32_bf16 v[172:175], v[84:87], a[140:143], v[172:175]
ds_read_b64_tr_b16 a[208:209], v249 offset:0
ds_read_b64_tr_b16 a[210:211], v249 offset:512
v_mfma_f32_16x16x32_bf16 v[176:179], v[84:87], a[156:159], 0
ds_read_b64_tr_b16 a[212:213], v249 offset:4096
ds_read_b64_tr_b16 a[214:215], v249 offset:4608
v_mfma_f32_16x16x32_bf16 v[176:179], v[80:83], a[152:155], v[176:179]
s_waitcnt lgkmcnt(10)
ds_read_b64_tr_b16 a[216:217], v249 offset:8192
ds_read_b64_tr_b16 a[218:219], v249 offset:8704
v_mfma_f32_16x16x32_bf16 v[176:179], v[76:79], a[148:151], v[176:179]
s_waitcnt lgkmcnt(10)
ds_read_b64_tr_b16 a[220:221], v249 offset:12288
ds_read_b64_tr_b16 a[222:223], v249 offset:12800
v_mfma_f32_16x16x32_bf16 v[176:179], v[72:75], a[144:147], v[176:179]
s_waitcnt lgkmcnt(10)
ds_read_b64_tr_b16 a[224:225], v250 offset:0
ds_read_b64_tr_b16 a[226:227], v250 offset:512
v_mfma_f32_16x16x32_bf16 v[180:183], v[72:75], a[160:163], 0
s_waitcnt lgkmcnt(10)
ds_read_b64_tr_b16 a[228:229], v250 offset:4096
ds_read_b64_tr_b16 a[230:231], v250 offset:4608
v_mfma_f32_16x16x32_bf16 v[180:183], v[76:79], a[164:167], v[180:183]
s_waitcnt lgkmcnt(10)
ds_read_b64_tr_b16 a[232:233], v250 offset:8192
ds_read_b64_tr_b16 a[234:235], v250 offset:8704
v_mfma_f32_16x16x32_bf16 v[180:183], v[80:83], a[168:171], v[180:183]
s_waitcnt lgkmcnt(10)
ds_read_b64_tr_b16 a[236:237], v250 offset:12288
ds_read_b64_tr_b16 a[238:239], v250 offset:12800
v_mfma_f32_16x16x32_bf16 v[180:183], v[84:87], a[172:175], v[180:183]
s_waitcnt lgkmcnt(10)
ds_read_b64_tr_b16 a[240:241], v251 offset:0
ds_read_b64_tr_b16 a[242:243], v251 offset:512
v_mfma_f32_16x16x32_bf16 v[152:155], v[84:87], a[188:191], 0
s_waitcnt lgkmcnt(10)
ds_read_b64_tr_b16 a[244:245], v251 offset:4096
ds_read_b64_tr_b16 a[246:247], v251 offset:4608
v_mfma_f32_16x16x32_bf16 v[152:155], v[80:83], a[184:187], v[152:155]
s_waitcnt lgkmcnt(10)
ds_read_b64_tr_b16 a[248:249], v251 offset:8192
ds_read_b64_tr_b16 a[250:251], v251 offset:8704
v_mfma_f32_16x16x32_bf16 v[152:155], v[76:79], a[180:183], v[152:155]
s_waitcnt lgkmcnt(10)
ds_read_b64_tr_b16 a[252:253], v251 offset:12288
ds_read_b64_tr_b16 a[254:255], v251 offset:12800
v_mfma_f32_16x16x32_bf16 v[152:155], v[72:75], a[176:179], v[152:155]
s_waitcnt lgkmcnt(10)
ds_write_b128 v50, v[88:91] offset:0
ds_write_b128 v50, v[104:107] offset:4096
ds_write_b64 v51, v[156:157] offset:0
ds_write_b128 v50, v[92:95] offset:64
ds_write_b128 v50, v[108:111] offset:4160
ds_write_b64 v51, v[160:161] offset:128
v_cvt_pk_bf16_f32 v164, v164, v165
v_cvt_pk_bf16_f32 v165, v166, v167
v_cvt_pk_bf16_f32 v168, v168, v169
v_cvt_pk_bf16_f32 v169, v170, v171
v_cvt_pk_bf16_f32 v172, v172, v173
v_cvt_pk_bf16_f32 v173, v174, v175
v_cvt_pk_bf16_f32 v176, v176, v177
v_cvt_pk_bf16_f32 v177, v178, v179
v_cvt_pk_bf16_f32 v180, v180, v181
v_cvt_pk_bf16_f32 v181, v182, v183
v_cvt_pk_bf16_f32 v152, v152, v153
v_cvt_pk_bf16_f32 v153, v154, v155
v_mov_b32 v105, 0
v_mov_b32 v107, 0
v_mov_b32 v109, 0
v_mov_b32 v111, 0
v_mov_b32 v133, 0
v_mov_b32 v134, 0
v_mov_b32 v135, 0
v_mov_b32 v149, 0
v_mov_b32 v150, 0
v_mov_b32 v151, 0
v_mov_b32 v248, 1.0
v_mov_b32 v249, 1.0
v_mov_b32 v251, 1.0
ds_write_b64 v51, v[164:165] offset:256
ds_write_b64 v51, v[168:169] offset:384
ds_write_b128 v50, v[96:99] offset:2048
ds_write_b128 v50, v[112:115] offset:6144
ds_write_b64 v51, v[172:173] offset:2048
ds_write_b64 v51, v[176:177] offset:2176
s_waitcnt vmcnt(4)
s_barrier
ds_read_b128 v[200:203], v236 offset:8704
ds_read_b128 v[212:215], v236 offset:8448
ds_read_b128 v[224:227], v236 offset:8960
ds_read_b128 v[228:231], v236 offset:9216
ds_read_b128 v[192:195], v236 offset:13440
ds_read_b128 v[204:207], v236 offset:12928
ds_read_b128 v[208:211], v236 offset:12672
ds_write_b128 v50, v[100:103] offset:2112
ds_write_b128 v50, v[116:119] offset:6208
s_waitcnt lgkmcnt(8)
v_mfma_f32_16x16x32_bf16 v[184:187], a[68:71], v[200:203], 0
s_waitcnt lgkmcnt(6)
ds_write_b64 v51, v[180:181] offset:2304
v_mfma_f32_16x16x32_bf16 v[184:187], a[64:67], v[212:215], v[184:187]
s_waitcnt lgkmcnt(2)
ds_write_b64 v51, v[152:153] offset:2432
v_mfma_f32_16x16x32_bf16 v[184:187], a[72:75], v[224:227], v[184:187]
v_mfma_f32_16x16x32_bf16 v[184:187], a[76:79], v[228:231], v[184:187]
s_nop 2
v_mfma_f32_16x16x32_bf16 v[188:191], a[92:95], v[228:231], 0
s_nop 2
v_mfma_f32_16x16x32_bf16 v[188:191], a[88:91], v[224:227], v[188:191]
v_cvt_pk_bf16_f32 v16, v184, v185
v_cvt_pk_bf16_f32 v17, v186, v187
v_mfma_f32_16x16x32_bf16 v[188:191], a[84:87], v[200:203], v[188:191]
ds_read_b128 v[184:187], v236 offset:13184
v_mfma_f32_16x16x32_bf16 v[188:191], a[80:83], v[212:215], v[188:191]
s_nop 2
v_mfma_f32_16x16x32_bf16 v[196:199], a[96:99], v[212:215], 0
s_nop 2
v_mfma_f32_16x16x32_bf16 v[196:199], a[100:103], v[200:203], v[196:199]
v_cvt_pk_bf16_f32 v18, v188, v189
v_cvt_pk_bf16_f32 v19, v190, v191
v_mfma_f32_16x16x32_bf16 v[196:199], a[104:107], v[224:227], v[196:199]
v_mfma_f32_16x16x32_bf16 v[196:199], a[108:111], v[228:231], v[196:199]
s_nop 2
v_mfma_f32_16x16x32_bf16 v[188:191], a[124:127], v[228:231], 0
s_waitcnt lgkmcnt(0)
s_nop 1
v_mfma_f32_16x16x32_bf16 v[188:191], a[116:119], v[200:203], v[188:191]
v_cvt_pk_bf16_f32 v21, v198, v199
v_cvt_pk_bf16_f32 v20, v196, v197
v_mfma_f32_16x16x32_bf16 v[188:191], a[112:115], v[212:215], v[188:191]
v_mfma_f32_16x16x32_bf16 v[188:191], a[120:123], v[224:227], v[188:191]
s_nop 2
v_mfma_f32_16x16x32_bf16 v[196:199], a[120:123], v[184:187], 0
s_nop 2
v_mfma_f32_16x16x32_bf16 v[196:199], a[124:127], v[192:195], v[196:199]
v_cvt_pk_bf16_f32 v23, v190, v191
v_cvt_pk_bf16_f32 v22, v188, v189
v_mfma_f32_16x16x32_bf16 v[196:199], a[116:119], v[204:207], v[196:199]
v_mfma_f32_16x16x32_bf16 v[196:199], a[112:115], v[208:211], v[196:199]
s_nop 2
v_mfma_f32_16x16x32_bf16 v[188:191], a[96:99], v[208:211], 0
s_nop 2
v_mfma_f32_16x16x32_bf16 v[188:191], a[100:103], v[204:207], v[188:191]
v_cvt_pk_bf16_f32 v30, v196, v197
v_cvt_pk_bf16_f32 v31, v198, v199
v_mfma_f32_16x16x32_bf16 v[188:191], a[104:107], v[184:187], v[188:191]
v_mfma_f32_16x16x32_bf16 v[188:191], a[108:111], v[192:195], v[188:191]
s_nop 2
v_mfma_f32_16x16x32_bf16 v[212:215], a[92:95], v[192:195], 0
s_nop 2
v_mfma_f32_16x16x32_bf16 v[212:215], a[88:91], v[184:187], v[212:215]
v_cvt_pk_bf16_f32 v29, v190, v191
v_cvt_pk_bf16_f32 v28, v188, v189
v_mfma_f32_16x16x32_bf16 v[212:215], a[84:87], v[204:207], v[212:215]
v_mfma_f32_16x16x32_bf16 v[212:215], a[80:83], v[208:211], v[212:215]
s_nop 2
v_mfma_f32_16x16x32_bf16 v[188:191], a[64:67], v[208:211], 0
s_nop 2
v_mfma_f32_16x16x32_bf16 v[188:191], a[72:75], v[184:187], v[188:191]
v_cvt_pk_bf16_f32 v27, v214, v215
v_cvt_pk_bf16_f32 v26, v212, v213
v_mfma_f32_16x16x32_bf16 v[188:191], a[76:79], v[192:195], v[188:191]
s_waitcnt vmcnt(0)
s_barrier
v_mfma_f32_16x16x32_bf16 v[188:191], a[68:71], v[204:207], v[188:191]
s_mov_b32 s48, s50
ds_read_b128 v[196:199], v236 offset:17152
ds_read_b128 v[200:203], v236 offset:16896
ds_read_b128 v[216:219], v236 offset:17408
ds_read_b128 v[220:223], v236 offset:17664
ds_read_u16 v108, v241 offset:256
ds_read_b128 v[204:207], v236 offset:21376
ds_read_b128 v[208:211], v236 offset:21120
ds_read_b128 v[52:55], v240 offset:64
v_cvt_pk_bf16_f32 v24, v188, v189
v_cvt_pk_bf16_f32 v25, v190, v191
s_add_u32 m0, s49, 0
s_add_u32 s50, s50, 13107200
buffer_load_dwordx4 v237, s[16:19], s48 offen nt lds
ds_read_b128 v[192:195], v236 offset:21888
ds_read_b128 v[48:51], v240 offset:0
ds_read_u16 v110, v241 offset:384
v_add_u32 v240, 0x200, v240
s_add_u32 s48, s48, s51
s_add_u32 m0, s49, 2112
ds_read_u16 v106, v241 offset:128
buffer_load_dwordx4 v237, s[16:19], s48 offen nt lds
s_waitcnt lgkmcnt(11)
v_mfma_f32_16x16x32_bf16 v[184:187], a[68:71], v[196:199], 0
s_waitcnt lgkmcnt(9)
ds_read_u16 v104, v241 offset:0
s_add_u32 m0, s49, 4224
v_mfma_f32_16x16x32_bf16 v[184:187], a[64:67], v[200:203], v[184:187]
s_waitcnt lgkmcnt(6)
s_add_u32 s48, s48, s51
buffer_load_dwordx4 v237, s[16:19], s48 offen nt lds
v_mfma_f32_16x16x32_bf16 v[184:187], a[72:75], v[216:219], v[184:187]
s_add_u32 m0, s49, 6336
s_add_u32 s48, s48, s51
buffer_load_dwordx4 v237, s[16:19], s48 offen nt lds
v_mfma_f32_16x16x32_bf16 v[184:187], a[76:79], v[220:223], v[184:187]
s_add_u32 m0, s49, 8448
s_add_u32 s48, s48, s51
buffer_load_dwordx4 v237, s[16:19], s48 offen nt lds
v_mfma_f32_16x16x32_bf16 v[188:191], a[92:95], v[220:223], 0
s_add_u32 m0, s49, 10560
s_mov_b32 s47, s46
s_add_u32 s48, s48, s51
v_mfma_f32_16x16x32_bf16 v[188:191], a[88:91], v[216:219], v[188:191]
s_bfe_i32 s57, s3, 0x10000
buffer_load_dwordx4 v237, s[16:19], s48 offen nt lds
v_cvt_pk_bf16_f32 v32, v184, v185
v_mfma_f32_16x16x32_bf16 v[188:191], a[84:87], v[196:199], v[188:191]
s_and_b32 s54, s57, s5
v_cvt_pk_bf16_f32 v33, v186, v187
s_sub_u32 s45, s45, 1
v_mfma_f32_16x16x32_bf16 v[188:191], a[80:83], v[200:203], v[188:191]
s_sub_u32 s50, s50, s54
s_add_u32 s52, s46, 20480
s_lshr_b32 s3, s3, 1
v_mfma_f32_16x16x32_bf16 v[184:187], a[96:99], v[200:203], 0
s_waitcnt lgkmcnt(0)
s_nop 1
v_mfma_f32_16x16x32_bf16 v[184:187], a[100:103], v[196:199], v[184:187]
v_cvt_pk_bf16_f32 v35, v190, v191
v_cvt_pk_bf16_f32 v34, v188, v189
v_mfma_f32_16x16x32_bf16 v[184:187], a[104:107], v[216:219], v[184:187]
v_mfma_f32_16x16x32_bf16 v[184:187], a[108:111], v[220:223], v[184:187]
s_nop 2
v_mfma_f32_16x16x32_bf16 v[188:191], a[124:127], v[220:223], 0
s_nop 2
v_mfma_f32_16x16x32_bf16 v[188:191], a[120:123], v[216:219], v[188:191]
v_cvt_pk_bf16_f32 v37, v186, v187
v_cvt_pk_bf16_f32 v36, v184, v185
v_mfma_f32_16x16x32_bf16 v[188:191], a[116:119], v[196:199], v[188:191]
ds_read_b128 v[196:199], v236 offset:21632
v_mfma_f32_16x16x32_bf16 v[188:191], a[112:115], v[200:203], v[188:191]
s_nop 7
v_cvt_pk_bf16_f32 v39, v190, v191
v_cvt_pk_bf16_f32 v38, v188, v189
s_nop 7
s_waitcnt lgkmcnt(0)
s_branch L_entrys
.p2align 6
L_loops:
s_waitcnt vmcnt(8)
s_barrier
v_mfma_f32_16x16x32_bf16 v[176:179], a[224:227], v[220:223], 0
s_add_u32 s52, s47, 8192
v_exp_f32 v187, v187
v_mfma_f32_16x16x32_bf16 v[176:179], a[228:231], v[224:227], v[176:179]
s_add_u32 s53, s47, 12288
v_add_f32 v248, v184, v185
v_add_f32 v248, v248, v186
v_mfma_f32_16x16x32_bf16 v[176:179], a[232:235], v[212:215], v[176:179]
s_mov_b32 s47, s46
v_add_f32 v248, v248, v187
v_cvt_pk_bf16_f32 v120, v184, v185
v_mfma_f32_16x16x32_bf16 v[176:179], a[236:239], v[216:219], v[176:179]
s_bfe_i32 s57, s3, 0x10000
v_cvt_pk_bf16_f32 v121, v186, v187
v_sub_f32 v193, v193, v254
v_mfma_f32_16x16x32_bf16 v[180:183], a[252:255], v[216:219], 0
s_and_b32 s54, s57, s5
v_exp_f32 v188, v188
v_mfma_f32_16x16x32_bf16 v[180:183], a[248:251], v[212:215], v[180:183]
s_sub_u32 s45, s45, 1
v_exp_f32 v190, v190
v_mfma_f32_16x16x32_bf16 v[180:183], a[244:247], v[224:227], v[180:183]
s_lshr_b32 s3, s3, 1
v_sub_f32 v194, v194, v254
v_add_f32 v248, v248, v188
v_mfma_f32_16x16x32_bf16 v[180:183], a[240:243], v[220:223], v[180:183]
v_exp_f32 v189, v189
v_mfma_f32_16x16x32_bf16 v[212:215], v[0:3], v[112:115], 0
v_add_f32 v248, v248, v189
v_sub_f32 v191, v191, v254
v_mfma_f32_16x16x32_bf16 v[212:215], v[4:7], v[116:119], v[212:215]
v_exp_f32 v191, v191
v_mfma_f32_16x16x32_bf16 v[216:219], v[12:15], v[116:119], 0
v_sub_f32 v195, v195, v254
v_sub_f32 v192, v192, v254
v_mfma_f32_16x16x32_bf16 v[216:219], v[8:11], v[112:115], v[216:219]
v_exp_f32 v192, v192
v_mfma_f32_16x16x32_bf16 v[220:223], v[16:19], v[112:115], 0
v_exp_f32 v194, v194
v_mfma_f32_16x16x32_bf16 v[220:223], v[20:23], v[116:119], v[220:223]
v_exp_f32 v193, v193
v_mfma_f32_16x16x32_bf16 v[224:227], v[28:31], v[116:119], 0
v_add_f32 v248, v248, v190
v_add_f32 v248, v248, v191
v_mfma_f32_16x16x32_bf16 v[224:227], v[24:27], v[112:115], v[224:227]
v_exp_f32 v195, v195
v_mfma_f32_16x16x32_bf16 v[228:231], v[32:35], v[112:115], 0
v_add_f32 v248, v248, v192
v_add_f32 v248, v248, v193
v_mfma_f32_16x16x32_bf16 v[228:231], v[36:39], v[116:119], v[228:231]
v_add_f32 v248, v248, v194
v_add_f32 v248, v248, v195
v_mfma_f32_16x16x32_bf16 v[232:235], v[44:47], v[116:119], 0
v_cvt_pk_bf16_f32 v123, v190, v191
v_cvt_pk_bf16_f32 v122, v188, v189
v_mfma_f32_16x16x32_bf16 v[232:235], v[40:43], v[112:115], v[232:235]
s_mov_b32 s48, s50
ds_read_b128 v[188:191], v236 offset:0
v_cvt_pk_bf16_f32 v125, v194, v195
v_mfma_f32_16x16x32_bf16 v[184:187], v[48:51], v[112:115], 0
s_add_u32 m0, s49, 0
ds_read_b128 v[48:51], v240 offset:0
v_cvt_pk_bf16_f32 v124, v192, v193
v_mfma_f32_16x16x32_bf16 v[184:187], v[52:55], v[116:119], v[184:187]
s_add_u32 s50, s50, 13107200
buffer_load_dwordx4 v237, s[16:19], s48 offen nt lds
v_sub_f32 v196, v196, v254
v_sub_f32 v197, v197, v254
v_sub_f32 v199, v199, v254
v_sub_f32 v198, v198, v254
v_exp_f32 v196, v196
v_exp_f32 v197, v197
v_add_f32 v248, v248, v196
v_add_f32 v248, v248, v197
v_exp_f32 v198, v198
s_waitcnt lgkmcnt(1)
v_mfma_f32_16x16x32_bf16 v[192:195], a[64:67], v[188:191], 0
s_sub_u32 s50, s50, s54
ds_read_b128 v[52:55], v240 offset:64
v_exp_f32 v199, v199
v_add_f32 v248, v248, v198
v_add_f32 v248, v248, v199
v_cvt_pk_bf16_f32 v126, v196, v197
v_cvt_pk_bf16_f32 v127, v198, v199
ds_read_b128 v[196:199], v236 offset:256
v_sub_f32 v200, v200, v254
v_sub_f32 v203, v203, v254
v_sub_f32 v201, v201, v254
v_exp_f32 v201, v201
v_sub_f32 v202, v202, v254
v_exp_f32 v202, v202
v_exp_f32 v200, v200
v_exp_f32 v203, v203
v_add_f32 v248, v248, v200
v_add_f32 v248, v248, v201
v_add_f32 v248, v248, v202
v_add_f32 v248, v248, v203
v_cvt_pk_bf16_f32 v128, v200, v201
v_cvt_pk_bf16_f32 v129, v202, v203
v_sub_f32 v204, v204, v254
v_sub_f32 v205, v205, v254
s_waitcnt lgkmcnt(0)
v_mfma_f32_16x16x32_bf16 v[192:195], a[68:71], v[196:199], v[192:195]
ds_read_b128 v[200:203], v236 offset:512
v_exp_f32 v204, v204
v_sub_f32 v206, v206, v254
v_add_f32 v248, v248, v204
v_exp_f32 v206, v206
v_sub_f32 v207, v207, v254
v_exp_f32 v205, v205
v_exp_f32 v207, v207
v_add_f32 v248, v248, v205
v_cvt_pk_bf16_f32 v130, v204, v205
v_add_f32 v248, v248, v206
v_add_f32 v248, v248, v207
v_cvt_pk_bf16_f32 v131, v206, v207
v_sub_f32 v208, v208, v254
v_exp_f32 v208, v208
v_max3_f32 v254, v212, v213, v214
s_waitcnt lgkmcnt(0)
v_mfma_f32_16x16x32_bf16 v[192:195], a[72:75], v[200:203], v[192:195]
ds_read_b128 v[204:207], v236 offset:768
v_add_f32 v248, v248, v208
v_cvt_pk_bf16_f32 v132, v208, 0
v_max3_f32 v254, v254, v215, v216
v_max3_f32 v254, v254, v217, v218
v_max3_f32 v254, v254, v219, v220
v_max3_f32 v254, v254, v221, v222
v_max3_f32 v254, v254, v223, v224
v_max3_f32 v254, v254, v225, v226
v_max3_f32 v254, v254, v227, v228
v_max3_f32 v254, v254, v229, v230
v_max3_f32 v254, v254, v231, v232
v_max3_f32 v254, v254, v233, v234
v_max3_f32 v254, v254, v235, v184
v_add_u32 v240, 0x200, v240
ds_swizzle_b32 v250, v248 offset:0x401F
ds_swizzle_b32 v255, v254 offset:0x401F
s_waitcnt lgkmcnt(2)
v_mfma_f32_16x16x32_bf16 v[192:195], a[76:79], v[204:207], v[192:195]
s_nop 2
v_mfma_f32_16x16x32_bf16 v[208:211], a[92:95], v[204:207], 0
s_nop 2
v_mfma_f32_16x16x32_bf16 v[208:211], a[88:91], v[200:203], v[208:211]
v_cvt_pk_bf16_f32 v0, v192, v193
v_cvt_pk_bf16_f32 v1, v194, v195
v_mfma_f32_16x16x32_bf16 v[208:211], a[84:87], v[196:199], v[208:211]
v_mfma_f32_16x16x32_bf16 v[208:211], a[80:83], v[188:191], v[208:211]
s_waitcnt lgkmcnt(0)
v_add_f32 v248, v248, v250
v_max_f32 v254, v254, v255
v_mfma_f32_16x16x32_bf16 v[192:195], a[96:99], v[188:191], 0
ds_bpermute_b32 v250, v247, v248
v_mfma_f32_16x16x32_bf16 v[192:195], a[100:103], v[196:199], v[192:195]
ds_bpermute_b32 v255, v247, v254
v_mfma_f32_16x16x32_bf16 v[192:195], a[104:107], v[200:203], v[192:195]
v_cvt_pk_bf16_f32 v2, v208, v209
v_cvt_pk_bf16_f32 v3, v210, v211
v_mfma_f32_16x16x32_bf16 v[192:195], a[108:111], v[204:207], v[192:195]
s_nop 2
v_mfma_f32_16x16x32_bf16 v[208:211], a[124:127], v[204:207], 0
s_nop 2
v_mfma_f32_16x16x32_bf16 v[208:211], a[120:123], v[200:203], v[208:211]
v_cvt_pk_bf16_f32 v5, v194, v195
v_cvt_pk_bf16_f32 v4, v192, v193
v_mfma_f32_16x16x32_bf16 v[208:211], a[116:119], v[196:199], v[208:211]
s_waitcnt lgkmcnt(1)
v_add_f32 v248, v248, v250
v_mfma_f32_16x16x32_bf16 v[208:211], a[112:115], v[188:191], v[208:211]
s_waitcnt lgkmcnt(0)
v_rcp_f32 v251, v248
v_mfma_f32_16x16x32_bf16 v[188:191], v[56:59], v[120:123], 0
v_max_f32 v254, v254, v255
v_sub_f32 v214, v214, v254
v_mfma_f32_16x16x32_bf16 v[188:191], v[104:107], v[132:135], v[188:191]
s_add_u32 s48, s48, s51
v_sub_f32 v215, v215, v254
v_cvt_pk_bf16_f32 v6, v208, v209
v_mfma_f32_16x16x32_bf16 v[188:191], v[72:75], v[124:127], v[188:191]
s_add_u32 m0, s49, 2112
v_cvt_pk_bf16_f32 v7, v210, v211
v_sub_f32 v212, v212, v254
v_mfma_f32_16x16x32_bf16 v[188:191], v[88:91], v[128:131], v[188:191]
buffer_load_dwordx4 v237, s[16:19], s48 offen nt lds
v_sub_f32 v213, v213, v254
v_mfma_f32_16x16x32_bf16 v[196:199], v[92:95], v[128:131], 0
v_exp_f32 v212, v212
v_mfma_f32_16x16x32_bf16 v[196:199], v[76:79], v[124:127], v[196:199]
v_exp_f32 v214, v214
v_mfma_f32_16x16x32_bf16 v[196:199], v[106:109], v[132:135], v[196:199]
v_exp_f32 v213, v213
v_mfma_f32_16x16x32_bf16 v[196:199], v[60:63], v[120:123], v[196:199]
ds_read_b128 v[204:207], v236 offset:4480
v_sub_f32 v216, v216, v254
v_mfma_f32_16x16x32_bf16 v[200:203], v[64:67], v[120:123], 0
ds_read_b128 v[192:195], v236 offset:4224
v_sub_f32 v217, v217, v254
v_mfma_f32_16x16x32_bf16 v[200:203], v[108:111], v[132:135], v[200:203]
v_exp_f32 v215, v215
v_mfma_f32_16x16x32_bf16 v[200:203], v[80:83], v[124:127], v[200:203]
v_exp_f32 v217, v217
v_mfma_f32_16x16x32_bf16 v[200:203], v[96:99], v[128:131], v[200:203]
v_sub_f32 v218, v218, v254
v_add_f32 v249, v212, v213
v_mfma_f32_16x16x32_bf16 v[208:211], v[100:103], v[128:131], 0
v_add_f32 v249, v249, v214
v_add_f32 v249, v249, v215
v_mfma_f32_16x16x32_bf16 v[208:211], v[84:87], v[124:127], v[208:211]
s_waitcnt lgkmcnt(1)
v_exp_f32 v216, v216
v_mfma_f32_16x16x32_bf16 v[208:211], v[110:113], v[132:135], v[208:211]
s_waitcnt lgkmcnt(0)
v_sub_f32 v219, v219, v254
v_sub_f32 v220, v220, v254
v_mfma_f32_16x16x32_bf16 v[208:211], v[68:71], v[120:123], v[208:211]
v_exp_f32 v218, v218
v_sub_f32 v223, v223, v254
v_add_f32 v249, v249, v216
v_add_f32 v249, v249, v217
v_exp_f32 v219, v219
v_add_f32 v249, v249, v218
v_add_f32 v249, v249, v219
v_exp_f32 v220, v220
v_sub_f32 v224, v224, v254
v_exp_f32 v223, v223
v_sub_f32 v221, v221, v254
v_exp_f32 v224, v224
v_exp_f32 v221, v221
v_sub_f32 v222, v222, v254
v_sub_f32 v225, v225, v254
v_add_f32 v249, v249, v220
v_add_f32 v249, v249, v221
v_exp_f32 v222, v222
v_exp_f32 v225, v225
v_add_f32 v249, v249, v222
v_add_f32 v249, v249, v223
v_add_f32 v249, v249, v224
v_sub_f32 v226, v226, v254
v_add_f32 v249, v249, v225
v_exp_f32 v226, v226
v_sub_f32 v227, v227, v254
v_exp_f32 v227, v227
v_sub_f32 v228, v228, v254
v_exp_f32 v228, v228
v_add_f32 v249, v249, v226
v_sub_f32 v232, v232, v254
v_sub_f32 v229, v229, v254
v_sub_f32 v230, v230, v254
v_exp_f32 v230, v230
v_exp_f32 v229, v229
v_add_f32 v249, v249, v227
v_add_f32 v249, v249, v228
v_add_f32 v249, v249, v229
v_exp_f32 v232, v232
v_sub_f32 v233, v233, v254
v_exp_f32 v233, v233
v_sub_f32 v231, v231, v254
v_exp_f32 v231, v231
v_sub_f32 v234, v234, v254
v_sub_f32 v235, v235, v254
v_add_f32 v249, v249, v230
v_add_f32 v249, v249, v231
v_add_f32 v249, v249, v232
v_exp_f32 v234, v234
v_exp_f32 v235, v235
v_sub_f32 v184, v184, v254
v_exp_f32 v184, v184
v_add_f32 v249, v249, v233
v_cvt_pk_bf16_f32 v148, v184, 0
v_add_f32 v249, v249, v234
v_add_f32 v249, v249, v235
v_add_f32 v249, v249, v184
v_fmac_f32 v161, v201, v251
v_fmac_f32 v163, v203, v251
v_fmac_f32 v160, v200, v251
v_fmac_f32 v162, v202, v251
ds_read_b128 v[184:187], v236 offset:4992
v_cvt_pk_bf16_f32 v138, v216, v217
v_cvt_pk_bf16_f32 v139, v218, v219
v_fmac_f32 v167, v211, v251
v_fmac_f32 v165, v209, v251
v_fmac_f32 v166, v210, v251
v_fmac_f32 v164, v208, v251
v_cvt_pk_bf16_f32 v140, v220, v221
v_cvt_pk_bf16_f32 v141, v222, v223
v_fmac_f32 v155, v191, v251
v_fmac_f32 v154, v190, v251
v_fmac_f32 v152, v188, v251
v_fmac_f32 v153, v189, v251
v_cvt_pk_bf16_f32 v137, v214, v215
v_cvt_pk_bf16_f32 v136, v212, v213
v_cvt_pk_bf16_f32 v143, v226, v227
v_cvt_pk_bf16_f32 v142, v224, v225
v_cvt_pk_bf16_f32 v145, v230, v231
v_cvt_pk_bf16_f32 v144, v228, v229
v_fmac_f32 v156, v196, v251
v_fmac_f32 v157, v197, v251
s_waitcnt lgkmcnt(0)
v_mfma_f32_16x16x32_bf16 v[200:203], a[124:127], v[184:187], 0
ds_read_b128 v[216:219], v236 offset:4736
v_fmac_f32 v158, v198, v251
v_fmac_f32 v159, v199, v251
v_cvt_pk_bf16_f32 v147, v234, v235
v_cvt_pk_bf16_f32 v146, v232, v233
v_cvt_pk_bf16_f32 v160, v160, v161
v_cvt_pk_bf16_f32 v161, v162, v163
v_cvt_pk_bf16_f32 v163, v166, v167
v_cvt_pk_bf16_f32 v162, v164, v165
v_cvt_pk_bf16_f32 v152, v152, v153
v_cvt_pk_bf16_f32 v153, v154, v155
v_pk_max_i16 v160, v160, 0
v_pk_max_i16 v162, v162, 0
v_pk_max_i16 v153, v153, 0
v_pk_max_i16 v161, v161, 0
v_pk_max_i16 v163, v163, 0
v_cvt_pk_bf16_f32 v155, v158, v159
v_pk_max_i16 v155, v155, 0
v_pk_max_i16 v152, v152, 0
v_cvt_pk_bf16_f32 v154, v156, v157
v_pk_max_i16 v154, v154, 0
s_waitcnt lgkmcnt(0)
v_mfma_f32_16x16x32_bf16 v[200:203], a[120:123], v[216:219], v[200:203]
ds_swizzle_b32 v250, v249 offset:0x401F
buffer_store_dwordx4 v[152:155], v239, s[20:23], s52 offen offset:0 nt
buffer_store_dwordx4 v[160:163], v239, s[20:23], s52 offen offset:64 nt
s_add_u32 s52, s46, 20480
v_mfma_f32_16x16x32_bf16 v[200:203], a[116:119], v[204:207], v[200:203]
v_mfma_f32_16x16x32_bf16 v[200:203], a[112:115], v[192:195], v[200:203]
s_nop 2
v_mfma_f32_16x16x32_bf16 v[208:211], a[96:99], v[192:195], 0
s_waitcnt lgkmcnt(0)
v_add_f32 v249, v249, v250
v_mfma_f32_16x16x32_bf16 v[208:211], a[100:103], v[204:207], v[208:211]
s_add_u32 m0, s49, 4224
ds_bpermute_b32 v250, v247, v249
v_mfma_f32_16x16x32_bf16 v[208:211], a[104:107], v[216:219], v[208:211]
s_add_u32 s48, s48, s51
buffer_load_dwordx4 v237, s[16:19], s48 offen nt lds
v_cvt_pk_bf16_f32 v14, v200, v201
v_mfma_f32_16x16x32_bf16 v[208:211], a[108:111], v[184:187], v[208:211]
ds_read_b128 v[212:215], v236 offset:8448
v_cvt_pk_bf16_f32 v15, v202, v203
v_mfma_f32_16x16x32_bf16 v[220:223], a[92:95], v[184:187], 0
ds_read_b128 v[200:203], v236 offset:8704
ds_read_b128 v[224:227], v236 offset:8960
v_mfma_f32_16x16x32_bf16 v[220:223], a[88:91], v[216:219], v[220:223]
ds_read_b128 v[228:231], v236 offset:9216
v_mfma_f32_16x16x32_bf16 v[220:223], a[84:87], v[204:207], v[220:223]
v_cvt_pk_bf16_f32 v13, v210, v211
v_cvt_pk_bf16_f32 v12, v208, v209
v_mfma_f32_16x16x32_bf16 v[220:223], a[80:83], v[192:195], v[220:223]
s_waitcnt lgkmcnt(4)
v_add_f32 v249, v249, v250
s_nop 0
v_mfma_f32_16x16x32_bf16 v[188:191], a[64:67], v[192:195], 0
v_rcp_f32 v252, v249
v_mfma_f32_16x16x32_bf16 v[188:191], a[72:75], v[216:219], v[188:191]
s_waitcnt lgkmcnt(3)
s_nop 0
v_cvt_pk_bf16_f32 v10, v220, v221
v_mfma_f32_16x16x32_bf16 v[188:191], a[76:79], v[184:187], v[188:191]
s_waitcnt lgkmcnt(1)
v_cvt_pk_bf16_f32 v11, v222, v223
v_mfma_f32_16x16x32_bf16 v[188:191], a[68:71], v[204:207], v[188:191]
s_waitcnt lgkmcnt(0)
s_nop 1
v_mfma_f32_16x16x32_bf16 v[184:187], a[68:71], v[200:203], 0
s_nop 2
v_mfma_f32_16x16x32_bf16 v[184:187], a[64:67], v[212:215], v[184:187]
v_cvt_pk_bf16_f32 v9, v190, v191
v_cvt_pk_bf16_f32 v8, v188, v189
v_mfma_f32_16x16x32_bf16 v[184:187], a[72:75], v[224:227], v[184:187]
v_mfma_f32_16x16x32_bf16 v[184:187], a[76:79], v[228:231], v[184:187]
s_nop 2
v_mfma_f32_16x16x32_bf16 v[188:191], a[92:95], v[228:231], 0
s_nop 2
v_mfma_f32_16x16x32_bf16 v[188:191], a[88:91], v[224:227], v[188:191]
v_cvt_pk_bf16_f32 v16, v184, v185
v_cvt_pk_bf16_f32 v17, v186, v187
v_mfma_f32_16x16x32_bf16 v[188:191], a[84:87], v[200:203], v[188:191]
v_mfma_f32_16x16x32_bf16 v[188:191], a[80:83], v[212:215], v[188:191]
ds_read_b128 v[184:187], v236 offset:13184
ds_read_b128 v[192:195], v236 offset:13440
v_mfma_f32_16x16x32_bf16 v[196:199], a[96:99], v[212:215], 0
ds_read_b128 v[204:207], v236 offset:12928
ds_read_b128 v[208:211], v236 offset:12672
v_mfma_f32_16x16x32_bf16 v[196:199], a[100:103], v[200:203], v[196:199]
s_add_u32 m0, s49, 6336
s_add_u32 s48, s48, s51
v_cvt_pk_bf16_f32 v18, v188, v189
v_mfma_f32_16x16x32_bf16 v[196:199], a[104:107], v[224:227], v[196:199]
buffer_load_dwordx4 v237, s[16:19], s48 offen nt lds
v_cvt_pk_bf16_f32 v19, v190, v191
v_mfma_f32_16x16x32_bf16 v[196:199], a[108:111], v[228:231], v[196:199]
s_nop 2
v_mfma_f32_16x16x32_bf16 v[188:191], a[124:127], v[228:231], 0
s_nop 2
v_mfma_f32_16x16x32_bf16 v[188:191], a[116:119], v[200:203], v[188:191]
s_waitcnt lgkmcnt(2)
v_cvt_pk_bf16_f32 v21, v198, v199
v_cvt_pk_bf16_f32 v20, v196, v197
v_mfma_f32_16x16x32_bf16 v[188:191], a[112:115], v[212:215], v[188:191]
s_waitcnt lgkmcnt(0)
v_mfma_f32_16x16x32_bf16 v[188:191], a[120:123], v[224:227], v[188:191]
s_nop 2
v_mfma_f32_16x16x32_bf16 v[196:199], a[120:123], v[184:187], 0
s_nop 2
v_mfma_f32_16x16x32_bf16 v[196:199], a[124:127], v[192:195], v[196:199]
v_cvt_pk_bf16_f32 v23, v190, v191
v_cvt_pk_bf16_f32 v22, v188, v189
v_mfma_f32_16x16x32_bf16 v[196:199], a[116:119], v[204:207], v[196:199]
v_mfma_f32_16x16x32_bf16 v[196:199], a[112:115], v[208:211], v[196:199]
s_nop 2
v_mfma_f32_16x16x32_bf16 v[188:191], a[96:99], v[208:211], 0
s_nop 2
v_mfma_f32_16x16x32_bf16 v[188:191], a[100:103], v[204:207], v[188:191]
v_cvt_pk_bf16_f32 v30, v196, v197
v_cvt_pk_bf16_f32 v31, v198, v199
v_mfma_f32_16x16x32_bf16 v[188:191], a[104:107], v[184:187], v[188:191]
v_mfma_f32_16x16x32_bf16 v[188:191], a[108:111], v[192:195], v[188:191]
ds_read_b128 v[196:199], v236 offset:17152
ds_read_b128 v[200:203], v236 offset:16896
v_mfma_f32_16x16x32_bf16 v[212:215], a[92:95], v[192:195], 0
ds_read_b128 v[216:219], v236 offset:17408
ds_read_b128 v[220:223], v236 offset:17664
v_mfma_f32_16x16x32_bf16 v[212:215], a[88:91], v[184:187], v[212:215]
s_nop 1
v_cvt_pk_bf16_f32 v29, v190, v191
v_mfma_f32_16x16x32_bf16 v[212:215], a[84:87], v[204:207], v[212:215]
v_cvt_pk_bf16_f32 v28, v188, v189
v_mfma_f32_16x16x32_bf16 v[212:215], a[80:83], v[208:211], v[212:215]
s_nop 2
v_mfma_f32_16x16x32_bf16 v[188:191], a[64:67], v[208:211], 0
s_nop 2
v_mfma_f32_16x16x32_bf16 v[188:191], a[72:75], v[184:187], v[188:191]
s_add_u32 m0, s49, 8448
v_cvt_pk_bf16_f32 v27, v214, v215
v_cvt_pk_bf16_f32 v26, v212, v213
v_mfma_f32_16x16x32_bf16 v[188:191], a[76:79], v[192:195], v[188:191]
s_add_u32 s48, s48, s51
buffer_load_dwordx4 v237, s[16:19], s48 offen nt lds
v_mfma_f32_16x16x32_bf16 v[188:191], a[68:71], v[204:207], v[188:191]
s_waitcnt lgkmcnt(0)
s_nop 1
v_mfma_f32_16x16x32_bf16 v[184:187], a[68:71], v[196:199], 0
s_nop 2
v_mfma_f32_16x16x32_bf16 v[184:187], a[64:67], v[200:203], v[184:187]
v_cvt_pk_bf16_f32 v24, v188, v189
v_cvt_pk_bf16_f32 v25, v190, v191
v_mfma_f32_16x16x32_bf16 v[184:187], a[72:75], v[216:219], v[184:187]
v_mfma_f32_16x16x32_bf16 v[184:187], a[76:79], v[220:223], v[184:187]
s_nop 2
v_mfma_f32_16x16x32_bf16 v[188:191], a[92:95], v[220:223], 0
s_nop 2
v_mfma_f32_16x16x32_bf16 v[188:191], a[88:91], v[216:219], v[188:191]
v_cvt_pk_bf16_f32 v32, v184, v185
v_cvt_pk_bf16_f32 v33, v186, v187
v_mfma_f32_16x16x32_bf16 v[188:191], a[84:87], v[196:199], v[188:191]
v_mfma_f32_16x16x32_bf16 v[188:191], a[80:83], v[200:203], v[188:191]
s_nop 2
v_mfma_f32_16x16x32_bf16 v[184:187], a[96:99], v[200:203], 0
s_nop 2
v_mfma_f32_16x16x32_bf16 v[184:187], a[100:103], v[196:199], v[184:187]
v_cvt_pk_bf16_f32 v35, v190, v191
v_cvt_pk_bf16_f32 v34, v188, v189
v_mfma_f32_16x16x32_bf16 v[184:187], a[104:107], v[216:219], v[184:187]
v_mfma_f32_16x16x32_bf16 v[184:187], a[108:111], v[220:223], v[184:187]
s_nop 2
v_mfma_f32_16x16x32_bf16 v[188:191], a[124:127], v[220:223], 0
s_nop 2
v_mfma_f32_16x16x32_bf16 v[188:191], a[120:123], v[216:219], v[188:191]
v_cvt_pk_bf16_f32 v37, v186, v187
v_cvt_pk_bf16_f32 v36, v184, v185
v_mfma_f32_16x16x32_bf16 v[188:191], a[116:119], v[196:199], v[188:191]
v_mfma_f32_16x16x32_bf16 v[188:191], a[112:115], v[200:203], v[188:191]
s_nop 2
v_mfma_f32_16x16x32_bf16 v[184:187], v[56:59], v[136:139], 0
s_nop 2
v_mfma_f32_16x16x32_bf16 v[184:187], v[104:107], v[148:151], v[184:187]
s_add_u32 m0, s49, 10560
ds_read_u16 v104, v241 offset:0
v_cvt_pk_bf16_f32 v39, v190, v191
v_mfma_f32_16x16x32_bf16 v[184:187], v[72:75], v[140:143], v[184:187]
s_add_u32 s48, s48, s51
buffer_load_dwordx4 v237, s[16:19], s48 offen nt lds
v_cvt_pk_bf16_f32 v38, v188, v189
v_mfma_f32_16x16x32_bf16 v[184:187], v[88:91], v[144:147], v[184:187]
s_nop 2
v_mfma_f32_16x16x32_bf16 v[188:191], v[92:95], v[144:147], 0
s_nop 2
v_mfma_f32_16x16x32_bf16 v[188:191], v[76:79], v[140:143], v[188:191]
v_fmac_f32 v170, v186, v252
v_fmac_f32 v168, v184, v252
v_mfma_f32_16x16x32_bf16 v[188:191], v[106:109], v[148:151], v[188:191]
ds_read_u16 v106, v241 offset:128
v_fmac_f32 v171, v187, v252
v_mfma_f32_16x16x32_bf16 v[188:191], v[60:63], v[136:139], v[188:191]
s_waitcnt lgkmcnt(1)
ds_read_b128 v[192:195], v236 offset:21888
v_fmac_f32 v169, v185, v252
v_mfma_f32_16x16x32_bf16 v[200:203], v[64:67], v[136:139], 0
ds_read_b128 v[196:199], v236 offset:21632
ds_read_b128 v[204:207], v236 offset:21376
v_mfma_f32_16x16x32_bf16 v[200:203], v[108:111], v[148:151], v[200:203]
ds_read_b128 v[208:211], v236 offset:21120
v_fmac_f32 v174, v190, v252
v_mfma_f32_16x16x32_bf16 v[200:203], v[80:83], v[140:143], v[200:203]
ds_read_u16 v108, v241 offset:256
v_fmac_f32 v175, v191, v252
v_mfma_f32_16x16x32_bf16 v[200:203], v[96:99], v[144:147], v[200:203]
v_fmac_f32 v172, v188, v252
v_fmac_f32 v173, v189, v252
v_mfma_f32_16x16x32_bf16 v[184:187], v[100:103], v[144:147], 0
s_waitcnt lgkmcnt(5)
v_cvt_pk_bf16_f32 v168, v168, v169
v_cvt_pk_bf16_f32 v169, v170, v171
v_mfma_f32_16x16x32_bf16 v[184:187], v[84:87], v[140:143], v[184:187]
s_waitcnt lgkmcnt(4)
v_fmac_f32 v178, v202, v252
v_fmac_f32 v176, v200, v252
v_mfma_f32_16x16x32_bf16 v[184:187], v[110:113], v[148:151], v[184:187]
s_waitcnt lgkmcnt(2)
ds_read_u16 v110, v241 offset:384
v_fmac_f32 v177, v201, v252
v_mfma_f32_16x16x32_bf16 v[184:187], v[68:71], v[136:139], v[184:187]
L_entrys:
s_waitcnt lgkmcnt(2)
v_fmac_f32 v179, v203, v252
v_cvt_pk_bf16_f32 v176, v176, v177
v_mfma_f32_16x16x32_bf16 v[188:191], a[124:127], v[192:195], 0
s_waitcnt lgkmcnt(1)
v_cvt_pk_bf16_f32 v177, v178, v179
v_cvt_pk_bf16_f32 v171, v174, v175
v_mfma_f32_16x16x32_bf16 v[188:191], a[120:123], v[196:199], v[188:191]
v_fmac_f32 v180, v184, v252
v_fmac_f32 v181, v185, v252
v_mfma_f32_16x16x32_bf16 v[188:191], a[116:119], v[204:207], v[188:191]
v_fmac_f32 v183, v187, v252
v_fmac_f32 v182, v186, v252
v_mfma_f32_16x16x32_bf16 v[188:191], a[112:115], v[208:211], v[188:191]
v_cvt_pk_bf16_f32 v178, v180, v181
v_cvt_pk_bf16_f32 v170, v172, v173
v_mfma_f32_16x16x32_bf16 v[184:187], a[96:99], v[208:211], 0
s_waitcnt lgkmcnt(0)
v_cvt_pk_bf16_f32 v179, v182, v183
v_pk_max_i16 v168, v168, 0
v_mfma_f32_16x16x32_bf16 v[184:187], a[100:103], v[204:207], v[184:187]
s_add_u32 s48, s48, s51
v_cvt_pk_bf16_f32 v46, v188, v189
v_cvt_pk_bf16_f32 v47, v190, v191
v_mfma_f32_16x16x32_bf16 v[184:187], a[104:107], v[196:199], v[184:187]
s_add_u32 m0, s49, 12672
v_pk_max_i16 v176, v176, 0
v_pk_max_i16 v170, v170, 0
v_mfma_f32_16x16x32_bf16 v[184:187], a[108:111], v[192:195], v[184:187]
buffer_load_dwordx4 v237, s[16:19], s48 offen nt lds
v_pk_max_i16 v179, v179, 0
v_mfma_f32_16x16x32_bf16 v[188:191], a[92:95], v[192:195], 0
v_pk_max_i16 v178, v178, 0
v_pk_max_i16 v169, v169, 0
v_mfma_f32_16x16x32_bf16 v[188:191], a[88:91], v[196:199], v[188:191]
v_pk_max_i16 v177, v177, 0
v_pk_max_i16 v171, v171, 0
v_mfma_f32_16x16x32_bf16 v[188:191], a[84:87], v[204:207], v[188:191]
buffer_store_dwordx4 v[168:171], v239, s[20:23], s53 offen offset:0 nt
buffer_store_dwordx4 v[176:179], v239, s[20:23], s53 offen offset:64 nt
v_cvt_pk_bf16_f32 v44, v184, v185
v_cvt_pk_bf16_f32 v45, v186, v187
v_add_u32 v241, 0x200, v241
s_add_u32 s53, s46, 0
v_mfma_f32_16x16x32_bf16 v[188:191], a[80:83], v[208:211], v[188:191]
s_nop 2
v_mfma_f32_16x16x32_bf16 v[184:187], a[64:67], v[208:211], 0
s_nop 2
v_mfma_f32_16x16x32_bf16 v[184:187], a[72:75], v[196:199], v[184:187]
v_cvt_pk_bf16_f32 v42, v188, v189
v_cvt_pk_bf16_f32 v43, v190, v191
v_mfma_f32_16x16x32_bf16 v[184:187], a[76:79], v[192:195], v[184:187]
v_mfma_f32_16x16x32_bf16 v[184:187], a[68:71], v[204:207], v[184:187]
s_nop 2
v_mfma_f32_16x16x32_bf16 v[188:191], a[4:7], v[204:207], 0
s_nop 2
v_mfma_f32_16x16x32_bf16 v[188:191], a[0:3], v[208:211], v[188:191]
v_cvt_pk_bf16_f32 v41, v186, v187
v_cvt_pk_bf16_f32 v40, v184, v185
v_mfma_f32_16x16x32_bf16 v[188:191], a[8:11], v[196:199], v[188:191]
v_mfma_f32_16x16x32_bf16 v[188:191], a[12:15], v[192:195], v[188:191]
s_nop 2
v_mfma_f32_16x16x32_bf16 v[184:187], a[28:31], v[192:195], 0
s_nop 2
v_mfma_f32_16x16x32_bf16 v[184:187], a[24:27], v[196:199], v[184:187]
v_cvt_pk_bf16_f32 v112, v188, v189
v_cvt_pk_bf16_f32 v113, v190, v191
v_mfma_f32_16x16x32_bf16 v[184:187], a[20:23], v[204:207], v[184:187]
v_mfma_f32_16x16x32_bf16 v[184:187], a[16:19], v[208:211], v[184:187]
s_nop 2
v_mfma_f32_16x16x32_bf16 v[188:191], a[32:35], v[208:211], 0
s_nop 2
v_mfma_f32_16x16x32_bf16 v[188:191], a[36:39], v[204:207], v[188:191]
s_add_u32 m0, s49, 14784
v_cvt_pk_bf16_f32 v114, v184, v185
v_cvt_pk_bf16_f32 v115, v186, v187
v_mfma_f32_16x16x32_bf16 v[188:191], a[40:43], v[196:199], v[188:191]
s_add_u32 s48, s48, s51
buffer_load_dwordx4 v237, s[16:19], s48 offen nt lds
v_mfma_f32_16x16x32_bf16 v[188:191], a[44:47], v[192:195], v[188:191]
s_nop 2
v_mfma_f32_16x16x32_bf16 v[184:187], a[60:63], v[192:195], 0
s_nop 2
v_mfma_f32_16x16x32_bf16 v[184:187], a[56:59], v[196:199], v[184:187]
v_cvt_pk_bf16_f32 v116, v188, v189
v_cvt_pk_bf16_f32 v117, v190, v191
v_mfma_f32_16x16x32_bf16 v[184:187], a[52:55], v[204:207], v[184:187]
v_mfma_f32_16x16x32_bf16 v[184:187], a[48:51], v[208:211], v[184:187]
s_nop 2
v_mfma_f32_16x16x32_bf16 v[152:155], a[192:195], v[208:211], 0
s_nop 2
v_mfma_f32_16x16x32_bf16 v[152:155], a[196:199], v[204:207], v[152:155]
v_cvt_pk_bf16_f32 v118, v184, v185
v_cvt_pk_bf16_f32 v119, v186, v187
v_mfma_f32_16x16x32_bf16 v[152:155], a[200:203], v[196:199], v[152:155]
v_mfma_f32_16x16x32_bf16 v[152:155], a[204:207], v[192:195], v[152:155]
v_mfma_f32_16x16x32_bf16 v[156:159], a[220:223], v[192:195], 0
v_mfma_f32_16x16x32_bf16 v[156:159], a[216:219], v[196:199], v[156:159]
v_mfma_f32_16x16x32_bf16 v[156:159], a[212:215], v[204:207], v[156:159]
v_mfma_f32_16x16x32_bf16 v[156:159], a[208:211], v[208:211], v[156:159]
v_mfma_f32_16x16x32_bf16 v[160:163], a[224:227], v[208:211], 0
v_mfma_f32_16x16x32_bf16 v[160:163], a[228:231], v[204:207], v[160:163]
v_mfma_f32_16x16x32_bf16 v[160:163], a[232:235], v[196:199], v[160:163]
v_mfma_f32_16x16x32_bf16 v[160:163], a[236:239], v[192:195], v[160:163]
v_mfma_f32_16x16x32_bf16 v[164:167], a[252:255], v[192:195], 0
v_mfma_f32_16x16x32_bf16 v[164:167], a[248:251], v[196:199], v[164:167]
s_add_u32 s48, s48, s51
s_add_u32 m0, s49, 16896
v_mfma_f32_16x16x32_bf16 v[164:167], a[244:247], v[204:207], v[164:167]
buffer_load_dwordx4 v237, s[16:19], s48 offen nt lds
v_mfma_f32_16x16x32_bf16 v[164:167], a[240:243], v[208:211], v[164:167]
v_mfma_f32_16x16x32_bf16 v[184:187], v[0:3], v[112:115], 0
v_mfma_f32_16x16x32_bf16 v[184:187], v[4:7], v[116:119], v[184:187]
s_nop 2
v_mfma_f32_16x16x32_bf16 v[188:191], v[12:15], v[116:119], 0
s_nop 2
v_mfma_f32_16x16x32_bf16 v[188:191], v[8:11], v[112:115], v[188:191]
v_max3_f32 v254, v184, v185, v186
s_nop 0
v_mfma_f32_16x16x32_bf16 v[200:203], v[16:19], v[112:115], 0
s_nop 2
v_mfma_f32_16x16x32_bf16 v[200:203], v[20:23], v[116:119], v[200:203]
s_nop 0
v_max3_f32 v254, v254, v187, v188
v_max3_f32 v254, v254, v189, v190
v_mfma_f32_16x16x32_bf16 v[212:215], v[28:31], v[116:119], 0
s_nop 2
v_mfma_f32_16x16x32_bf16 v[212:215], v[24:27], v[112:115], v[212:215]
v_max3_f32 v254, v254, v191, v200
v_max3_f32 v254, v254, v201, v202
v_mfma_f32_16x16x32_bf16 v[216:219], v[32:35], v[112:115], 0
s_nop 2
v_mfma_f32_16x16x32_bf16 v[216:219], v[36:39], v[116:119], v[216:219]
s_nop 0
v_max3_f32 v254, v254, v203, v212
v_max3_f32 v254, v254, v213, v214
v_mfma_f32_16x16x32_bf16 v[220:223], v[44:47], v[116:119], 0
s_nop 2
v_mfma_f32_16x16x32_bf16 v[220:223], v[40:43], v[112:115], v[220:223]
v_max3_f32 v254, v254, v215, v216
v_max3_f32 v254, v254, v217, v218
v_mfma_f32_16x16x32_bf16 v[224:227], v[48:51], v[112:115], 0
s_nop 2
v_mfma_f32_16x16x32_bf16 v[224:227], v[52:55], v[116:119], v[224:227]
s_nop 0
v_max3_f32 v254, v254, v219, v220
v_max3_f32 v254, v254, v221, v222
v_mfma_f32_16x16x32_bf16 v[228:231], v[208:211], a[128:131], 0
s_nop 2
v_mfma_f32_16x16x32_bf16 v[228:231], v[204:207], a[132:135], v[228:231]
v_max3_f32 v254, v254, v223, v224
v_mfma_f32_16x16x32_bf16 v[228:231], v[196:199], a[136:139], v[228:231]
ds_swizzle_b32 v255, v254 offset:0x401F
v_mfma_f32_16x16x32_bf16 v[228:231], v[192:195], a[140:143], v[228:231]
s_add_u32 m0, s49, 19008
s_add_u32 s48, s48, s51
buffer_load_dwordx4 v237, s[16:19], s48 offen nt lds
v_mfma_f32_16x16x32_bf16 v[232:235], v[192:195], a[156:159], 0
s_nop 2
v_mfma_f32_16x16x32_bf16 v[232:235], v[196:199], a[152:155], v[232:235]
v_cvt_pk_bf16_f32 v91, v230, v231
v_cvt_pk_bf16_f32 v90, v228, v229
v_mfma_f32_16x16x32_bf16 v[232:235], v[204:207], a[148:151], v[232:235]
v_mfma_f32_16x16x32_bf16 v[232:235], v[208:211], a[144:147], v[232:235]
s_nop 2
v_mfma_f32_16x16x32_bf16 v[228:231], v[208:211], a[160:163], 0
s_waitcnt lgkmcnt(0)
v_max_f32 v254, v254, v255
s_nop 0
v_mfma_f32_16x16x32_bf16 v[228:231], v[204:207], a[164:167], v[228:231]
ds_bpermute_b32 v255, v247, v254
v_mfma_f32_16x16x32_bf16 v[228:231], v[196:199], a[168:171], v[228:231]
v_cvt_pk_bf16_f32 v95, v234, v235
v_cvt_pk_bf16_f32 v94, v232, v233
v_mfma_f32_16x16x32_bf16 v[228:231], v[192:195], a[172:175], v[228:231]
s_nop 2
v_mfma_f32_16x16x32_bf16 v[232:235], v[192:195], a[188:191], 0
ds_read_b128 v[192:195], v236 offset:4224
s_nop 0
v_mfma_f32_16x16x32_bf16 v[232:235], v[204:207], a[180:183], v[232:235]
ds_read_b128 v[204:207], v236 offset:4480
v_cvt_pk_bf16_f32 v99, v230, v231
v_mfma_f32_16x16x32_bf16 v[232:235], v[208:211], a[176:179], v[232:235]
ds_read_b128 v[208:211], v236 offset:4736
v_cvt_pk_bf16_f32 v98, v228, v229
v_mfma_f32_16x16x32_bf16 v[232:235], v[196:199], a[184:187], v[232:235]
s_waitcnt lgkmcnt(3)
ds_read_b128 v[196:199], v236 offset:4992
v_max_f32 v254, v254, v255
v_sub_f32 v184, v184, v254
v_sub_f32 v185, v185, v254
v_exp_f32 v184, v184
v_exp_f32 v185, v185
v_sub_f32 v187, v187, v254
v_cvt_pk_bf16_f32 v103, v234, v235
v_cvt_pk_bf16_f32 v102, v232, v233
v_add_f32 v248, v184, v185
v_sub_f32 v186, v186, v254
v_exp_f32 v186, v186
v_cvt_pk_bf16_f32 v120, v184, v185
v_add_f32 v248, v248, v186
s_waitcnt lgkmcnt(1)
v_mfma_f32_16x16x32_bf16 v[228:231], v[208:211], a[184:187], 0
v_sub_f32 v188, v188, v254
s_waitcnt lgkmcnt(0)
v_mfma_f32_16x16x32_bf16 v[228:231], v[196:199], a[188:191], v[228:231]
v_exp_f32 v187, v187
v_mfma_f32_16x16x32_bf16 v[228:231], v[204:207], a[180:183], v[228:231]
v_cvt_pk_bf16_f32 v121, v186, v187
v_add_f32 v248, v248, v187
v_mfma_f32_16x16x32_bf16 v[228:231], v[192:195], a[176:179], v[228:231]
v_sub_f32 v189, v189, v254
v_sub_f32 v190, v190, v254
v_mfma_f32_16x16x32_bf16 v[232:235], v[192:195], a[160:163], 0
v_exp_f32 v189, v189
v_mfma_f32_16x16x32_bf16 v[232:235], v[204:207], a[164:167], v[232:235]
v_exp_f32 v190, v190
v_mfma_f32_16x16x32_bf16 v[232:235], v[208:211], a[168:171], v[232:235]
s_nop 0
v_cvt_pk_bf16_f32 v71, v230, v231
v_cvt_pk_bf16_f32 v70, v228, v229
v_mfma_f32_16x16x32_bf16 v[232:235], v[196:199], a[172:175], v[232:235]
s_add_u32 s48, s48, s51
v_exp_f32 v188, v188
v_mfma_f32_16x16x32_bf16 v[228:231], v[196:199], a[156:159], 0
s_add_u32 m0, s49, 21120
v_add_f32 v248, v248, v188
v_sub_f32 v191, v191, v254
v_mfma_f32_16x16x32_bf16 v[228:231], v[208:211], a[152:155], v[228:231]
buffer_load_dwordx4 v237, s[16:19], s48 offen nt lds
v_cvt_pk_bf16_f32 v66, v232, v233
v_mfma_f32_16x16x32_bf16 v[228:231], v[204:207], a[148:151], v[228:231]
v_cvt_pk_bf16_f32 v67, v234, v235
v_add_f32 v248, v248, v189
v_mfma_f32_16x16x32_bf16 v[228:231], v[192:195], a[144:147], v[228:231]
v_exp_f32 v191, v191
v_mfma_f32_16x16x32_bf16 v[232:235], v[192:195], a[128:131], 0
ds_read_b128 v[192:195], v236 offset:0
v_cvt_pk_bf16_f32 v122, v188, v189
v_mfma_f32_16x16x32_bf16 v[232:235], v[208:211], a[136:139], v[232:235]
ds_read_b128 v[208:211], v236 offset:256
v_add_f32 v248, v248, v190
v_mfma_f32_16x16x32_bf16 v[232:235], v[196:199], a[140:143], v[232:235]
ds_read_b128 v[196:199], v236 offset:512
v_cvt_pk_bf16_f32 v62, v228, v229
v_mfma_f32_16x16x32_bf16 v[232:235], v[204:207], a[132:135], v[232:235]
ds_read_b128 v[204:207], v236 offset:768
v_cvt_pk_bf16_f32 v63, v230, v231
v_add_f32 v248, v248, v191
v_cvt_pk_bf16_f32 v123, v190, v191
v_sub_f32 v200, v200, v254
v_exp_f32 v200, v200
v_sub_f32 v201, v201, v254
v_exp_f32 v201, v201
v_cvt_pk_bf16_f32 v59, v234, v235
v_cvt_pk_bf16_f32 v58, v232, v233
v_sub_f32 v203, v203, v254
s_waitcnt lgkmcnt(2)
v_mfma_f32_16x16x32_bf16 v[228:231], v[208:211], a[132:135], 0
ds_read_b128 v[188:191], v242 offset:64
v_sub_f32 v202, v202, v254
v_mfma_f32_16x16x32_bf16 v[228:231], v[192:195], a[128:131], v[228:231]
s_waitcnt lgkmcnt(2)
v_exp_f32 v203, v203
v_mfma_f32_16x16x32_bf16 v[228:231], v[196:199], a[136:139], v[228:231]
s_waitcnt lgkmcnt(1)
v_exp_f32 v202, v202
v_mfma_f32_16x16x32_bf16 v[228:231], v[204:207], a[140:143], v[228:231]
v_add_f32 v248, v248, v200
v_add_f32 v248, v248, v201
v_mfma_f32_16x16x32_bf16 v[184:187], v[204:207], a[156:159], 0
v_add_f32 v248, v248, v202
v_add_f32 v248, v248, v203
v_mfma_f32_16x16x32_bf16 v[184:187], v[196:199], a[152:155], v[184:187]
v_cvt_pk_bf16_f32 v124, v200, v201
v_cvt_pk_bf16_f32 v125, v202, v203
v_mfma_f32_16x16x32_bf16 v[184:187], v[208:211], a[148:151], v[184:187]
s_waitcnt lgkmcnt(0)
v_cvt_pk_bf16_f32 v56, v228, v229
v_cvt_pk_bf16_f32 v57, v230, v231
v_mfma_f32_16x16x32_bf16 v[184:187], v[192:195], a[144:147], v[184:187]
v_sub_f32 v212, v212, v254
v_sub_f32 v213, v213, v254
v_mfma_f32_16x16x32_bf16 v[228:231], v[192:195], a[160:163], 0
v_exp_f32 v212, v212
v_mfma_f32_16x16x32_bf16 v[228:231], v[208:211], a[164:167], v[228:231]
v_sub_f32 v214, v214, v254
v_add_f32 v248, v248, v212
v_mfma_f32_16x16x32_bf16 v[228:231], v[196:199], a[168:171], v[228:231]
v_cvt_pk_bf16_f32 v60, v184, v185
v_cvt_pk_bf16_f32 v61, v186, v187
v_mfma_f32_16x16x32_bf16 v[228:231], v[204:207], a[172:175], v[228:231]
s_add_u32 m0, s49, 23232
ds_read_b128 v[184:187], v242 offset:0
v_sub_f32 v215, v215, v254
v_mfma_f32_16x16x32_bf16 v[232:235], v[204:207], a[188:191], 0
s_add_u32 s48, s48, s51
buffer_load_dwordx4 v237, s[16:19], s48 offen nt lds
v_sub_f32 v216, v216, v254
v_mfma_f32_16x16x32_bf16 v[232:235], v[196:199], a[184:187], v[232:235]
s_sub_u32 s49, s49, s56
v_exp_f32 v213, v213
v_mfma_f32_16x16x32_bf16 v[232:235], v[208:211], a[180:183], v[232:235]
s_and_b32 s51, s57, 26212352
v_exp_f32 v214, v214
v_mfma_f32_16x16x32_bf16 v[232:235], v[192:195], a[176:179], v[232:235]
s_add_u32 s51, s51, 2048
v_cvt_pk_bf16_f32 v126, v212, v213
v_add_f32 v248, v248, v213
v_mfma_f32_16x16x32_bf16 v[200:203], v[4:7], v[188:191], 0
v_add_f32 v248, v248, v214
s_waitcnt lgkmcnt(0)
v_mfma_f32_16x16x32_bf16 v[200:203], v[0:3], v[184:187], v[200:203]
s_nop 0
v_cvt_pk_bf16_f32 v69, v234, v235
v_cvt_pk_bf16_f32 v68, v232, v233
v_mfma_f32_16x16x32_bf16 v[232:235], v[32:35], v[184:187], 0
ds_read_b128 v[184:187], v245 offset:64
v_sub_f32 v218, v218, v254
v_mfma_f32_16x16x32_bf16 v[232:235], v[36:39], v[188:191], v[232:235]
ds_read_b128 v[188:191], v243 offset:0
v_exp_f32 v215, v215
s_nop 0
v_add_f32 v248, v248, v215
v_cvt_pk_bf16_f32 v127, v214, v215
ds_read_b128 v[212:215], v243 offset:64
v_exp_f32 v216, v216
v_sub_f32 v217, v217, v254
v_add_f32 v248, v248, v216
v_exp_f32 v218, v218
v_sub_f32 v219, v219, v254
v_exp_f32 v217, v217
v_exp_f32 v219, v219
v_cvt_pk_bf16_f32 v128, v216, v217
v_cvt_pk_bf16_f32 v129, v218, v219
v_add_f32 v248, v248, v217
v_add_f32 v248, v248, v218
v_add_f32 v248, v248, v219
v_cvt_pk_bf16_f32 v64, v228, v229
v_cvt_pk_bf16_f32 v65, v230, v231
v_sub_f32 v220, v220, v254
v_sub_f32 v221, v221, v254
s_waitcnt lgkmcnt(0)
v_mfma_f32_16x16x32_bf16 v[200:203], v[12:15], v[212:215], v[200:203]
ds_read_b128 v[216:219], v244 offset:0
ds_read_b128 v[228:231], v245 offset:0
v_mfma_f32_16x16x32_bf16 v[200:203], v[8:11], v[188:191], v[200:203]
v_exp_f32 v220, v220
v_mfma_f32_16x16x32_bf16 v[232:235], v[40:43], v[188:191], v[232:235]
ds_read_b128 v[188:191], v244 offset:64
v_add_f32 v248, v248, v220
v_mfma_f32_16x16x32_bf16 v[232:235], v[44:47], v[212:215], v[232:235]
v_exp_f32 v221, v221
v_sub_f32 v223, v223, v254
v_add_f32 v248, v248, v221
v_exp_f32 v223, v223
v_sub_f32 v222, v222, v254
v_exp_f32 v222, v222
v_cvt_pk_bf16_f32 v130, v220, v221
v_mov_b32 v221, 0xff800000
v_add_f32 v248, v248, v222
v_cvt_pk_bf16_f32 v131, v222, v223
v_add_f32 v248, v248, v223
v_sub_f32 v224, v224, v254
v_exp_f32 v224, v224
s_waitcnt lgkmcnt(0)
v_mfma_f32_16x16x32_bf16 v[200:203], v[20:23], v[188:191], v[200:203]
v_cvt_pk_bf16_f32 v132, v224, 0
v_add_f32 v248, v248, v224
v_mfma_f32_16x16x32_bf16 v[200:203], v[16:19], v[216:219], v[200:203]
ds_swizzle_b32 v250, v248 offset:0x401F
v_add_u32 v245, 0x200, v245
v_mfma_f32_16x16x32_bf16 v[232:235], v[48:51], v[216:219], v[232:235]
v_add_u32 v244, 0x200, v244
v_add_u32 v243, 0x200, v243
v_mfma_f32_16x16x32_bf16 v[232:235], v[52:55], v[188:191], v[232:235]
v_add_u32 v242, 0x200, v242
s_nop 0
v_mfma_f32_16x16x32_bf16 v[200:203], v[24:27], v[228:231], v[200:203]
s_nop 2
v_mfma_f32_16x16x32_bf16 v[200:203], v[28:31], v[184:187], v[200:203]
s_nop 0
v_mov_b32_dpp v233, v221 quad_perm:[0,1,2,3] row_mask:0xf bank_mask:0xc
v_mov_b32_dpp v232, v221 quad_perm:[0,1,2,3] row_mask:0xf bank_mask:0x8
v_mfma_f32_16x16x32_bf16 v[184:187], a[0:3], v[192:195], 0
v_mov_b32_dpp v234, v221 quad_perm:[0,1,2,3] row_mask:0xf bank_mask:0xc
v_mov_b32_dpp v235, v221 quad_perm:[0,1,2,3] row_mask:0xf bank_mask:0xc
v_mfma_f32_16x16x32_bf16 v[184:187], a[4:7], v[208:211], v[184:187]
s_waitcnt lgkmcnt(0)
v_max3_f32 v223, v200, v201, v202
v_max3_f32 v223, v223, v203, v232
v_mfma_f32_16x16x32_bf16 v[184:187], a[8:11], v[196:199], v[184:187]
v_max3_f32 v223, v223, v233, v234
v_max_f32 v223, v223, v235
v_mfma_f32_16x16x32_bf16 v[184:187], a[12:15], v[204:207], v[184:187]
s_nop 0
v_max_f32_dpp v223, v223, v223 row_ror:8 row_mask:0xf bank_mask:0xf
v_add_f32 v248, v248, v250
v_mfma_f32_16x16x32_bf16 v[188:191], a[28:31], v[204:207], 0
ds_bpermute_b32 v250, v247, v248
v_mfma_f32_16x16x32_bf16 v[188:191], a[24:27], v[196:199], v[188:191]
v_max_f32_dpp v223, v223, v223 row_ror:4 row_mask:0xf bank_mask:0xf
v_mfma_f32_16x16x32_bf16 v[188:191], a[20:23], v[208:211], v[188:191]
ds_swizzle_b32 v221, v223 offset:0x401F
v_cvt_pk_bf16_f32 v113, v186, v187
v_mfma_f32_16x16x32_bf16 v[188:191], a[16:19], v[192:195], v[188:191]
v_cvt_pk_bf16_f32 v112, v184, v185
s_nop 0
v_mfma_f32_16x16x32_bf16 v[184:187], a[32:35], v[192:195], 0
s_nop 2
v_mfma_f32_16x16x32_bf16 v[184:187], a[36:39], v[208:211], v[184:187]
s_nop 0
v_cvt_pk_bf16_f32 v115, v190, v191
v_cvt_pk_bf16_f32 v114, v188, v189
v_mfma_f32_16x16x32_bf16 v[184:187], a[40:43], v[196:199], v[184:187]
s_waitcnt lgkmcnt(1)
v_add_f32 v248, v248, v250
v_mfma_f32_16x16x32_bf16 v[184:187], a[44:47], v[204:207], v[184:187]
v_rcp_f32 v251, v248
v_mfma_f32_16x16x32_bf16 v[188:191], a[60:63], v[204:207], 0
s_waitcnt lgkmcnt(0)
v_max_f32 v223, v223, v221
s_nop 0
v_mfma_f32_16x16x32_bf16 v[188:191], a[56:59], v[196:199], v[188:191]
ds_bpermute_b32 v221, v247, v223
v_mfma_f32_16x16x32_bf16 v[188:191], a[52:55], v[208:211], v[188:191]
v_cvt_pk_bf16_f32 v117, v186, v187
v_cvt_pk_bf16_f32 v116, v184, v185
v_mfma_f32_16x16x32_bf16 v[188:191], a[48:51], v[192:195], v[188:191]
s_nop 2
v_mfma_f32_16x16x32_bf16 v[168:171], a[192:195], v[192:195], 0
s_nop 2
v_mfma_f32_16x16x32_bf16 v[168:171], a[196:199], v[208:211], v[168:171]
v_cvt_pk_bf16_f32 v119, v190, v191
v_cvt_pk_bf16_f32 v118, v188, v189
v_mfma_f32_16x16x32_bf16 v[168:171], a[200:203], v[196:199], v[168:171]
v_mfma_f32_16x16x32_bf16 v[168:171], a[204:207], v[204:207], v[168:171]
s_waitcnt lgkmcnt(0)
v_max_f32 v223, v223, v221
v_sub_f32 v200, v200, v223
v_mfma_f32_16x16x32_bf16 v[172:175], a[220:223], v[204:207], 0
v_exp_f32 v200, v200
v_mfma_f32_16x16x32_bf16 v[172:175], a[216:219], v[196:199], v[172:175]
v_sub_f32 v201, v201, v223
v_sub_f32 v202, v202, v223
v_mfma_f32_16x16x32_bf16 v[172:175], a[212:215], v[208:211], v[172:175]
v_exp_f32 v202, v202
v_mfma_f32_16x16x32_bf16 v[172:175], a[208:211], v[192:195], v[172:175]
v_exp_f32 v201, v201
v_mfma_f32_16x16x32_bf16 v[176:179], a[224:227], v[192:195], 0
v_add_f32 v220, v200, v201
v_add_f32 v220, v220, v202
v_mfma_f32_16x16x32_bf16 v[176:179], a[228:231], v[208:211], v[176:179]
v_sub_f32 v203, v203, v223
v_sub_f32 v233, v233, v223
v_mfma_f32_16x16x32_bf16 v[176:179], a[232:235], v[196:199], v[176:179]
v_exp_f32 v233, v233
v_mfma_f32_16x16x32_bf16 v[176:179], a[236:239], v[204:207], v[176:179]
v_exp_f32 v203, v203
v_mfma_f32_16x16x32_bf16 v[180:183], a[252:255], v[204:207], 0
v_sub_f32 v232, v232, v223
v_sub_f32 v234, v234, v223
v_mfma_f32_16x16x32_bf16 v[180:183], a[248:251], v[196:199], v[180:183]
v_exp_f32 v232, v232
v_mfma_f32_16x16x32_bf16 v[180:183], a[244:247], v[208:211], v[180:183]
v_exp_f32 v234, v234
v_mfma_f32_16x16x32_bf16 v[180:183], a[240:243], v[192:195], v[180:183]
v_add_f32 v220, v220, v203
v_add_f32 v220, v220, v232
v_mfma_f32_16x16x32_bf16 v[184:187], v[0:3], v[112:115], 0
v_add_f32 v220, v220, v233
v_add_f32 v220, v220, v234
v_mfma_f32_16x16x32_bf16 v[184:187], v[4:7], v[116:119], v[184:187]
v_sub_f32 v235, v235, v223
v_cvt_pk_bf16_f32 v200, v200, v201
v_mfma_f32_16x16x32_bf16 v[188:191], v[12:15], v[116:119], 0
v_exp_f32 v235, v235
v_mfma_f32_16x16x32_bf16 v[188:191], v[8:11], v[112:115], v[188:191]
v_add_f32 v220, v220, v235
v_cvt_pk_bf16_f32 v201, v202, v203
v_mfma_f32_16x16x32_bf16 v[192:195], v[16:19], v[112:115], 0
v_cvt_pk_bf16_f32 v202, v232, v233
v_cvt_pk_bf16_f32 v203, v234, v235
v_mfma_f32_16x16x32_bf16 v[192:195], v[20:23], v[116:119], v[192:195]
ds_read_b128 v[196:199], v236 offset:8448
v_add_f32_dpp v220, v220, v220 row_ror:8 row_mask:0xf bank_mask:0xf
v_mfma_f32_16x16x32_bf16 v[208:211], v[28:31], v[116:119], 0
ds_read_b128 v[204:207], v236 offset:8704
v_add_f32_dpp v220, v220, v220 row_ror:4 row_mask:0xf bank_mask:0xf
v_mfma_f32_16x16x32_bf16 v[208:211], v[24:27], v[112:115], v[208:211]
ds_write_b32 v246, v220 offset:4096
ds_read_b128 v[212:215], v236 offset:8960
v_mfma_f32_16x16x32_bf16 v[216:219], v[32:35], v[112:115], 0
ds_read_b128 v[224:227], v236 offset:9216
v_max3_f32 v254, v184, v185, v186
v_mfma_f32_16x16x32_bf16 v[216:219], v[36:39], v[116:119], v[216:219]
v_max3_f32 v254, v254, v187, v188
v_max3_f32 v254, v254, v189, v190
v_mfma_f32_16x16x32_bf16 v[228:231], v[44:47], v[116:119], 0
v_max3_f32 v254, v254, v191, v192
v_max3_f32 v254, v254, v193, v194
v_mfma_f32_16x16x32_bf16 v[228:231], v[40:43], v[112:115], v[228:231]
s_waitcnt lgkmcnt(4)
v_max3_f32 v254, v254, v195, v208
v_max3_f32 v254, v254, v209, v210
v_mfma_f32_16x16x32_bf16 v[232:235], v[48:51], v[112:115], 0
s_waitcnt lgkmcnt(3)
v_max3_f32 v254, v254, v211, v216
v_max3_f32 v254, v254, v217, v218
v_mfma_f32_16x16x32_bf16 v[232:235], v[52:55], v[116:119], v[232:235]
s_waitcnt lgkmcnt(1)
v_max3_f32 v254, v254, v219, v228
v_max3_f32 v254, v254, v229, v230
v_mfma_f32_16x16x32_bf16 v[220:223], v[196:199], a[128:131], 0
s_waitcnt lgkmcnt(0)
s_nop 1
v_mfma_f32_16x16x32_bf16 v[220:223], v[204:207], a[132:135], v[220:223]
v_max3_f32 v254, v254, v231, v232
v_mfma_f32_16x16x32_bf16 v[220:223], v[212:215], a[136:139], v[220:223]
ds_swizzle_b32 v255, v254 offset:0x401F
v_mfma_f32_16x16x32_bf16 v[220:223], v[224:227], a[140:143], v[220:223]
s_nop 7
v_cvt_pk_bf16_f32 v73, v222, v223
v_cvt_pk_bf16_f32 v72, v220, v221
v_mfma_f32_16x16x32_bf16 v[220:223], v[224:227], a[156:159], 0
v_mfma_f32_16x16x32_bf16 v[220:223], v[212:215], a[152:155], v[220:223]
v_mfma_f32_16x16x32_bf16 v[220:223], v[204:207], a[148:151], v[220:223]
s_waitcnt lgkmcnt(0)
v_max_f32 v254, v254, v255
v_mfma_f32_16x16x32_bf16 v[220:223], v[196:199], a[144:147], v[220:223]
ds_bpermute_b32 v255, v247, v254
s_nop 6
v_cvt_pk_bf16_f32 v76, v220, v221
v_cvt_pk_bf16_f32 v77, v222, v223
v_mfma_f32_16x16x32_bf16 v[220:223], v[196:199], a[160:163], 0
v_mfma_f32_16x16x32_bf16 v[220:223], v[204:207], a[164:167], v[220:223]
v_mfma_f32_16x16x32_bf16 v[220:223], v[212:215], a[168:171], v[220:223]
s_waitcnt lgkmcnt(0)
v_max_f32 v254, v254, v255
v_mfma_f32_16x16x32_bf16 v[220:223], v[224:227], a[172:175], v[220:223]
v_sub_f32 v184, v184, v254
v_exp_f32 v184, v184
v_sub_f32 v185, v185, v254
v_sub_f32 v187, v187, v254
v_exp_f32 v185, v185
s_nop 2
v_cvt_pk_bf16_f32 v81, v222, v223
v_cvt_pk_bf16_f32 v80, v220, v221
v_mfma_f32_16x16x32_bf16 v[220:223], v[224:227], a[188:191], 0
ds_read_b128 v[224:227], v236 offset:12672
v_add_f32 v249, v184, v185
v_mfma_f32_16x16x32_bf16 v[220:223], v[204:207], a[180:183], v[220:223]
ds_read_b128 v[204:207], v236 offset:12928
v_sub_f32 v186, v186, v254
v_mfma_f32_16x16x32_bf16 v[220:223], v[196:199], a[176:179], v[220:223]
ds_read_b128 v[196:199], v236 offset:13184
v_cvt_pk_bf16_f32 v136, v184, v185
v_mfma_f32_16x16x32_bf16 v[220:223], v[212:215], a[184:187], v[220:223]
ds_read_b128 v[212:215], v236 offset:13440
v_exp_f32 v186, v186
v_exp_f32 v187, v187
v_add_f32 v249, v249, v186
v_add_f32 v249, v249, v187
v_cvt_pk_bf16_f32 v137, v186, v187
v_sub_f32 v189, v189, v254
v_sub_f32 v188, v188, v254
v_cvt_pk_bf16_f32 v84, v220, v221
v_cvt_pk_bf16_f32 v85, v222, v223
v_exp_f32 v188, v188
v_exp_f32 v189, v189
v_sub_f32 v191, v191, v254
s_waitcnt lgkmcnt(1)
v_mfma_f32_16x16x32_bf16 v[184:187], v[196:199], a[184:187], 0
v_sub_f32 v190, v190, v254
s_waitcnt lgkmcnt(0)
v_mfma_f32_16x16x32_bf16 v[184:187], v[212:215], a[188:191], v[184:187]
v_exp_f32 v190, v190
v_mfma_f32_16x16x32_bf16 v[184:187], v[204:207], a[180:183], v[184:187]
v_exp_f32 v191, v191
v_mfma_f32_16x16x32_bf16 v[184:187], v[224:227], a[176:179], v[184:187]
v_add_f32 v249, v249, v188
v_add_f32 v249, v249, v189
v_mfma_f32_16x16x32_bf16 v[220:223], v[224:227], a[160:163], 0
v_add_f32 v249, v249, v190
v_cvt_pk_bf16_f32 v139, v190, v191
v_mfma_f32_16x16x32_bf16 v[220:223], v[204:207], a[164:167], v[220:223]
v_cvt_pk_bf16_f32 v138, v188, v189
v_add_f32 v249, v249, v191
v_mfma_f32_16x16x32_bf16 v[220:223], v[196:199], a[168:171], v[220:223]
v_cvt_pk_bf16_f32 v86, v184, v185
v_cvt_pk_bf16_f32 v87, v186, v187
v_mfma_f32_16x16x32_bf16 v[220:223], v[212:215], a[172:175], v[220:223]
v_sub_f32 v192, v192, v254
v_sub_f32 v194, v194, v254
v_mfma_f32_16x16x32_bf16 v[184:187], v[212:215], a[156:159], 0
v_exp_f32 v192, v192
v_mfma_f32_16x16x32_bf16 v[184:187], v[196:199], a[152:155], v[184:187]
v_add_f32 v249, v249, v192
v_sub_f32 v193, v193, v254
v_mfma_f32_16x16x32_bf16 v[184:187], v[204:207], a[148:151], v[184:187]
v_cvt_pk_bf16_f32 v83, v222, v223
v_cvt_pk_bf16_f32 v82, v220, v221
v_mfma_f32_16x16x32_bf16 v[184:187], v[224:227], a[144:147], v[184:187]
v_exp_f32 v193, v193
v_mfma_f32_16x16x32_bf16 v[220:223], v[224:227], a[128:131], 0
ds_read_b128 v[224:227], v236 offset:16896
v_sub_f32 v209, v209, v254
v_mfma_f32_16x16x32_bf16 v[220:223], v[196:199], a[136:139], v[220:223]
ds_read_b128 v[196:199], v236 offset:17152
v_sub_f32 v208, v208, v254
v_mfma_f32_16x16x32_bf16 v[220:223], v[212:215], a[140:143], v[220:223]
ds_read_b128 v[212:215], v236 offset:17408
v_cvt_pk_bf16_f32 v79, v186, v187
v_mfma_f32_16x16x32_bf16 v[220:223], v[204:207], a[132:135], v[220:223]
ds_read_b128 v[204:207], v236 offset:17664
v_cvt_pk_bf16_f32 v78, v184, v185
v_exp_f32 v208, v208
v_exp_f32 v209, v209
v_exp_f32 v194, v194
v_add_f32 v249, v249, v193
v_add_f32 v249, v249, v194
v_sub_f32 v195, v195, v254
v_cvt_pk_bf16_f32 v74, v220, v221
v_cvt_pk_bf16_f32 v75, v222, v223
s_waitcnt lgkmcnt(2)
v_mfma_f32_16x16x32_bf16 v[184:187], v[196:199], a[132:135], 0
v_exp_f32 v195, v195
v_mfma_f32_16x16x32_bf16 v[184:187], v[224:227], a[128:131], v[184:187]
s_waitcnt lgkmcnt(1)
v_sub_f32 v216, v216, v254
v_sub_f32 v211, v211, v254
v_mfma_f32_16x16x32_bf16 v[184:187], v[212:215], a[136:139], v[184:187]
s_waitcnt lgkmcnt(0)
v_sub_f32 v210, v210, v254
v_add_f32 v249, v249, v195
v_mfma_f32_16x16x32_bf16 v[184:187], v[204:207], a[140:143], v[184:187]
v_exp_f32 v211, v211
v_mfma_f32_16x16x32_bf16 v[220:223], v[204:207], a[156:159], 0
v_exp_f32 v210, v210
v_mfma_f32_16x16x32_bf16 v[220:223], v[212:215], a[152:155], v[220:223]
v_add_f32 v249, v249, v208
v_sub_f32 v219, v219, v254
v_mfma_f32_16x16x32_bf16 v[220:223], v[196:199], a[148:151], v[220:223]
s_nop 0
v_cvt_pk_bf16_f32 v89, v186, v187
v_cvt_pk_bf16_f32 v88, v184, v185
v_mfma_f32_16x16x32_bf16 v[220:223], v[224:227], a[144:147], v[220:223]
v_exp_f32 v216, v216
v_mfma_f32_16x16x32_bf16 v[184:187], v[224:227], a[160:163], 0
v_sub_f32 v217, v217, v254
v_add_f32 v249, v249, v209
v_mfma_f32_16x16x32_bf16 v[184:187], v[196:199], a[164:167], v[184:187]
v_sub_f32 v228, v228, v254
v_add_f32 v249, v249, v210
v_mfma_f32_16x16x32_bf16 v[184:187], v[212:215], a[168:171], v[184:187]
v_exp_f32 v217, v217
v_mfma_f32_16x16x32_bf16 v[184:187], v[204:207], a[172:175], v[184:187]
v_sub_f32 v229, v229, v254
v_sub_f32 v218, v218, v254
v_mfma_f32_16x16x32_bf16 v[188:191], v[204:207], a[188:191], 0
v_exp_f32 v218, v218
v_mfma_f32_16x16x32_bf16 v[188:191], v[212:215], a[184:187], v[188:191]
v_add_f32 v249, v249, v211
v_add_f32 v249, v249, v216
v_mfma_f32_16x16x32_bf16 v[188:191], v[196:199], a[180:183], v[188:191]
v_cvt_pk_bf16_f32 v96, v184, v185
v_cvt_pk_bf16_f32 v97, v186, v187
v_mfma_f32_16x16x32_bf16 v[188:191], v[224:227], a[176:179], v[188:191]
v_exp_f32 v219, v219
v_mfma_f32_16x16x32_bf16 v[184:187], a[0:3], v[224:227], 0
v_add_f32 v249, v249, v217
v_add_f32 v249, v249, v218
v_mfma_f32_16x16x32_bf16 v[184:187], a[4:7], v[196:199], v[184:187]
v_add_f32 v249, v249, v219
v_cvt_pk_bf16_f32 v144, v216, v217
v_mfma_f32_16x16x32_bf16 v[184:187], a[8:11], v[212:215], v[184:187]
v_cvt_pk_bf16_f32 v100, v188, v189
v_cvt_pk_bf16_f32 v101, v190, v191
v_mfma_f32_16x16x32_bf16 v[184:187], a[12:15], v[204:207], v[184:187]
v_cvt_pk_bf16_f32 v145, v218, v219
v_cvt_pk_bf16_f32 v92, v220, v221
v_mfma_f32_16x16x32_bf16 v[188:191], a[28:31], v[204:207], 0
v_cvt_pk_bf16_f32 v93, v222, v223
v_sub_f32 v232, v232, v254
v_mfma_f32_16x16x32_bf16 v[188:191], a[24:27], v[212:215], v[188:191]
v_exp_f32 v228, v228
v_mfma_f32_16x16x32_bf16 v[188:191], a[20:23], v[196:199], v[188:191]
v_cvt_pk_bf16_f32 v112, v184, v185
v_cvt_pk_bf16_f32 v113, v186, v187
v_mfma_f32_16x16x32_bf16 v[188:191], a[16:19], v[224:227], v[188:191]
v_exp_f32 v229, v229
v_mfma_f32_16x16x32_bf16 v[184:187], a[32:35], v[224:227], 0
v_add_f32 v249, v249, v228
v_sub_f32 v231, v231, v254
v_mfma_f32_16x16x32_bf16 v[184:187], a[36:39], v[196:199], v[184:187]
v_exp_f32 v232, v232
v_mfma_f32_16x16x32_bf16 v[184:187], a[40:43], v[212:215], v[184:187]
s_nop 0
v_cvt_pk_bf16_f32 v115, v190, v191
v_cvt_pk_bf16_f32 v114, v188, v189
v_mfma_f32_16x16x32_bf16 v[184:187], a[44:47], v[204:207], v[184:187]
v_sub_f32 v230, v230, v254
v_add_f32 v249, v249, v229
v_mfma_f32_16x16x32_bf16 v[188:191], a[60:63], v[204:207], 0
v_cvt_pk_bf16_f32 v140, v192, v193
v_mov_b32 v192, v202
v_mfma_f32_16x16x32_bf16 v[188:191], a[56:59], v[212:215], v[188:191]
v_cvt_pk_bf16_f32 v142, v208, v209
v_mov_b32_dpp v209, v201 row_ror:8 row_mask:0xf bank_mask:0xf
v_mfma_f32_16x16x32_bf16 v[188:191], a[52:55], v[196:199], v[188:191]
v_cvt_pk_bf16_f32 v116, v184, v185
v_cvt_pk_bf16_f32 v117, v186, v187
v_mfma_f32_16x16x32_bf16 v[188:191], a[48:51], v[224:227], v[188:191]
v_mov_b32_dpp v208, v200 row_ror:8 row_mask:0xf bank_mask:0xf
v_cvt_pk_bf16_f32 v143, v210, v211
v_mfma_f32_16x16x32_bf16 v[216:219], v[56:59], v[120:123], 0
v_mov_b32_dpp v211, v201 row_ror:4 row_mask:0xf bank_mask:0xf
v_mov_b32_dpp v210, v200 row_ror:4 row_mask:0xf bank_mask:0xf
v_mfma_f32_16x16x32_bf16 v[216:219], v[104:107], v[132:135], v[216:219]
v_cvt_pk_bf16_f32 v141, v194, v195
v_mov_b32_dpp v194, v202 row_ror:12 row_mask:0xf bank_mask:0xf
v_mfma_f32_16x16x32_bf16 v[216:219], v[72:75], v[124:127], v[216:219]
v_cvt_pk_bf16_f32 v118, v188, v189
v_cvt_pk_bf16_f32 v119, v190, v191
v_mfma_f32_16x16x32_bf16 v[216:219], v[88:91], v[128:131], v[216:219]
v_mov_b32_dpp v195, v203 row_ror:12 row_mask:0xf bank_mask:0xf
v_mov_b32 v193, v203
v_mfma_f32_16x16x32_bf16 v[220:223], v[92:95], v[128:131], 0
v_mov_b32_dpp v203, v201 row_ror:12 row_mask:0xf bank_mask:0xf
v_mov_b32_dpp v202, v200 row_ror:12 row_mask:0xf bank_mask:0xf
v_mfma_f32_16x16x32_bf16 v[220:223], v[76:79], v[124:127], v[220:223]
v_exp_f32 v230, v230
v_mfma_f32_16x16x32_bf16 v[220:223], v[106:109], v[132:135], v[220:223]
v_fmac_f32 v154, v218, v251
v_fmac_f32 v152, v216, v251
v_mfma_f32_16x16x32_bf16 v[220:223], v[60:63], v[120:123], v[220:223]
v_fmac_f32 v155, v219, v251
v_fmac_f32 v153, v217, v251
v_mfma_f32_16x16x32_bf16 v[188:191], v[64:67], v[120:123], 0
v_exp_f32 v231, v231
v_mfma_f32_16x16x32_bf16 v[188:191], v[108:111], v[132:135], v[188:191]
v_add_f32 v249, v249, v230
v_add_f32 v249, v249, v231
v_mfma_f32_16x16x32_bf16 v[188:191], v[80:83], v[124:127], v[188:191]
v_cvt_pk_bf16_f32 v146, v228, v229
v_cvt_pk_bf16_f32 v147, v230, v231
v_mfma_f32_16x16x32_bf16 v[188:191], v[96:99], v[128:131], v[188:191]
v_add_f32 v249, v249, v232
v_fmac_f32 v156, v220, v251
v_mfma_f32_16x16x32_bf16 v[184:187], v[100:103], v[128:131], 0
ds_swizzle_b32 v250, v249 offset:0x401F
v_fmac_f32 v158, v222, v251
v_mfma_f32_16x16x32_bf16 v[184:187], v[84:87], v[124:127], v[184:187]
v_fmac_f32 v157, v221, v251
v_fmac_f32 v159, v223, v251
v_mfma_f32_16x16x32_bf16 v[184:187], v[68:71], v[120:123], v[184:187]
v_fmac_f32 v161, v189, v251
v_fmac_f32 v160, v188, v251
v_mfma_f32_16x16x32_bf16 v[184:187], v[110:113], v[132:135], v[184:187]
v_mov_b32_dpp v132, v192 row_ror:8 row_mask:0xf bank_mask:0xf
v_fmac_f32 v163, v191, v251
v_fmac_f32 v162, v190, v251
v_mfma_f32_16x16x32_bf16 v[216:219], v[110:113], v[132:135], 0
v_cvt_pk_bf16_f32 v152, v152, v153
v_cvt_pk_bf16_f32 v153, v154, v155
v_mfma_f32_16x16x32_bf16 v[216:219], v[84:87], v[208:211], v[216:219]
s_nop 0
v_fmac_f32 v167, v187, v251
v_fmac_f32 v164, v184, v251
v_mfma_f32_16x16x32_bf16 v[216:219], v[100:103], v[192:195], v[216:219]
s_waitcnt lgkmcnt(0)
v_fmac_f32 v165, v185, v251
v_fmac_f32 v166, v186, v251
v_mfma_f32_16x16x32_bf16 v[216:219], v[68:71], v[200:203], v[216:219]
v_add_f32 v249, v249, v250
v_pk_max_i16 v153, v153, 0
v_mfma_f32_16x16x32_bf16 v[188:191], v[64:67], v[200:203], 0
ds_bpermute_b32 v250, v247, v249
v_mfma_f32_16x16x32_bf16 v[188:191], v[80:83], v[208:211], v[188:191]
v_cvt_pk_bf16_f32 v160, v160, v161
v_cvt_pk_bf16_f32 v161, v162, v163
v_mfma_f32_16x16x32_bf16 v[188:191], v[96:99], v[192:195], v[188:191]
v_cvt_pk_bf16_f32 v216, v216, v217
v_cvt_pk_bf16_f32 v217, v218, v219
v_mfma_f32_16x16x32_bf16 v[188:191], v[108:111], v[132:135], v[188:191]
ds_write_b64 v246, v[216:217] offset:24
v_mfma_f32_16x16x32_bf16 v[228:231], v[106:109], v[132:135], 0
v_cvt_pk_bf16_f32 v162, v164, v165
v_pk_max_i16 v160, v160, 0
v_mfma_f32_16x16x32_bf16 v[228:231], v[76:79], v[208:211], v[228:231]
v_pk_max_i16 v161, v161, 0
v_cvt_pk_bf16_f32 v163, v166, v167
v_mfma_f32_16x16x32_bf16 v[228:231], v[92:95], v[192:195], v[228:231]
s_waitcnt lgkmcnt(1)
v_cvt_pk_bf16_f32 v188, v188, v189
v_cvt_pk_bf16_f32 v189, v190, v191
v_mfma_f32_16x16x32_bf16 v[228:231], v[60:63], v[200:203], v[228:231]
ds_write_b64 v246, v[188:189] offset:16
v_mfma_f32_16x16x32_bf16 v[184:187], v[56:59], v[200:203], 0
v_pk_max_i16 v163, v163, 0
v_cvt_pk_bf16_f32 v155, v158, v159
v_mfma_f32_16x16x32_bf16 v[184:187], v[72:75], v[208:211], v[184:187]
v_pk_max_i16 v162, v162, 0
v_cvt_pk_bf16_f32 v154, v156, v157
v_mfma_f32_16x16x32_bf16 v[184:187], v[88:91], v[192:195], v[184:187]
v_cvt_pk_bf16_f32 v228, v228, v229
v_cvt_pk_bf16_f32 v229, v230, v231
v_mfma_f32_16x16x32_bf16 v[184:187], v[104:107], v[132:135], v[184:187]
ds_write_b64 v246, v[228:229] offset:8
v_mfma_f32_16x16x32_bf16 v[188:191], v[0:3], v[112:115], 0
v_pk_max_i16 v154, v154, 0
v_pk_max_i16 v152, v152, 0
v_mfma_f32_16x16x32_bf16 v[188:191], v[4:7], v[116:119], v[188:191]
v_pk_max_i16 v155, v155, 0
v_add_f32 v249, v249, v250
v_mfma_f32_16x16x32_bf16 v[192:195], v[12:15], v[116:119], 0
buffer_store_dwordx4 v[152:155], v239, s[20:23], s52 offen offset:0 nt
buffer_store_dwordx4 v[160:163], v239, s[20:23], s52 offen offset:64 nt
v_cvt_pk_bf16_f32 v184, v184, v185
v_cvt_pk_bf16_f32 v185, v186, v187
v_rcp_f32 v252, v249
v_max3_f32 v254, v188, v189, v190
v_cvt_pk_bf16_f32 v148, v232, 0
s_add_u32 s52, s46, 16384
v_mfma_f32_16x16x32_bf16 v[192:195], v[8:11], v[112:115], v[192:195]
ds_write_b64 v246, v[184:185] offset:0
v_mfma_f32_16x16x32_bf16 v[200:203], v[16:19], v[112:115], 0
s_nop 0
v_add_u32 v246, 0x200, v246
s_nop 0
v_mfma_f32_16x16x32_bf16 v[200:203], v[20:23], v[116:119], v[200:203]
s_nop 1
v_max3_f32 v254, v254, v191, v192
v_mfma_f32_16x16x32_bf16 v[184:187], v[28:31], v[116:119], 0
v_max3_f32 v254, v254, v193, v194
s_nop 0
v_mfma_f32_16x16x32_bf16 v[184:187], v[24:27], v[112:115], v[184:187]
s_nop 0
v_max3_f32 v254, v254, v195, v200
v_max3_f32 v254, v254, v201, v202
v_mfma_f32_16x16x32_bf16 v[208:211], v[32:35], v[112:115], 0
s_nop 2
v_mfma_f32_16x16x32_bf16 v[208:211], v[36:39], v[116:119], v[208:211]
v_max3_f32 v254, v254, v203, v184
v_max3_f32 v254, v254, v185, v186
v_mfma_f32_16x16x32_bf16 v[216:219], v[44:47], v[116:119], 0
s_nop 2
v_mfma_f32_16x16x32_bf16 v[216:219], v[40:43], v[112:115], v[216:219]
s_nop 0
v_max3_f32 v254, v254, v187, v208
v_max3_f32 v254, v254, v209, v210
v_mfma_f32_16x16x32_bf16 v[220:223], v[48:51], v[112:115], 0
s_nop 2
v_mfma_f32_16x16x32_bf16 v[220:223], v[52:55], v[116:119], v[220:223]
v_max3_f32 v254, v254, v211, v216
v_max3_f32 v254, v254, v217, v218
v_mfma_f32_16x16x32_bf16 v[152:155], a[192:195], v[224:227], 0
s_nop 2
v_mfma_f32_16x16x32_bf16 v[152:155], a[196:199], v[196:199], v[152:155]
s_nop 0
v_max3_f32 v254, v254, v219, v220
v_mfma_f32_16x16x32_bf16 v[152:155], a[200:203], v[212:215], v[152:155]
ds_swizzle_b32 v255, v254 offset:0x401F
v_mfma_f32_16x16x32_bf16 v[152:155], a[204:207], v[204:207], v[152:155]
v_mfma_f32_16x16x32_bf16 v[156:159], a[220:223], v[204:207], 0
v_mfma_f32_16x16x32_bf16 v[156:159], a[216:219], v[212:215], v[156:159]
v_mfma_f32_16x16x32_bf16 v[156:159], a[212:215], v[196:199], v[156:159]
v_mfma_f32_16x16x32_bf16 v[156:159], a[208:211], v[224:227], v[156:159]
v_mfma_f32_16x16x32_bf16 v[160:163], a[224:227], v[224:227], 0
s_waitcnt lgkmcnt(0)
v_max_f32 v254, v254, v255
v_mfma_f32_16x16x32_bf16 v[160:163], a[228:231], v[196:199], v[160:163]
ds_bpermute_b32 v255, v247, v254
v_mfma_f32_16x16x32_bf16 v[160:163], a[232:235], v[212:215], v[160:163]
v_mfma_f32_16x16x32_bf16 v[160:163], a[236:239], v[204:207], v[160:163]
v_mfma_f32_16x16x32_bf16 v[164:167], a[252:255], v[204:207], 0
v_mfma_f32_16x16x32_bf16 v[164:167], a[248:251], v[212:215], v[164:167]
v_mfma_f32_16x16x32_bf16 v[164:167], a[244:247], v[196:199], v[164:167]
v_mfma_f32_16x16x32_bf16 v[164:167], a[240:243], v[224:227], v[164:167]
s_waitcnt lgkmcnt(0)
v_max_f32 v254, v254, v255
v_sub_f32 v188, v188, v254
v_mfma_f32_16x16x32_bf16 v[196:199], v[56:59], v[136:139], 0
v_sub_f32 v190, v190, v254
v_sub_f32 v189, v189, v254
v_mfma_f32_16x16x32_bf16 v[196:199], v[104:107], v[148:151], v[196:199]
v_exp_f32 v189, v189
v_mfma_f32_16x16x32_bf16 v[196:199], v[72:75], v[140:143], v[196:199]
v_exp_f32 v188, v188
v_mfma_f32_16x16x32_bf16 v[196:199], v[88:91], v[144:147], v[196:199]
v_add_f32 v248, v188, v189
v_sub_f32 v191, v191, v254
v_mfma_f32_16x16x32_bf16 v[204:207], v[92:95], v[144:147], 0
v_exp_f32 v191, v191
v_mfma_f32_16x16x32_bf16 v[204:207], v[76:79], v[140:143], v[204:207]
v_exp_f32 v190, v190
v_mfma_f32_16x16x32_bf16 v[204:207], v[106:109], v[148:151], v[204:207]
v_cvt_pk_bf16_f32 v120, v188, v189
v_add_f32 v248, v248, v190
v_mfma_f32_16x16x32_bf16 v[204:207], v[60:63], v[136:139], v[204:207]
ds_read_b128 v[212:215], v236 offset:4224
v_add_f32 v248, v248, v191
v_mfma_f32_16x16x32_bf16 v[228:231], v[64:67], v[136:139], 0
ds_read_b128 v[224:227], v236 offset:4480
v_cvt_pk_bf16_f32 v121, v190, v191
v_mfma_f32_16x16x32_bf16 v[228:231], v[108:111], v[148:151], v[228:231]
v_fmac_f32 v170, v198, v252
v_fmac_f32 v171, v199, v252
v_mfma_f32_16x16x32_bf16 v[228:231], v[80:83], v[140:143], v[228:231]
v_fmac_f32 v168, v196, v252
v_fmac_f32 v169, v197, v252
v_mfma_f32_16x16x32_bf16 v[228:231], v[96:99], v[144:147], v[228:231]
ds_read_b128 v[196:199], v236 offset:4736
v_fmac_f32 v175, v207, v252
v_mfma_f32_16x16x32_bf16 v[232:235], v[100:103], v[144:147], 0
v_fmac_f32 v172, v204, v252
v_fmac_f32 v174, v206, v252
v_mfma_f32_16x16x32_bf16 v[232:235], v[84:87], v[140:143], v[232:235]
s_waitcnt lgkmcnt(2)
v_fmac_f32 v173, v205, v252
v_fmac_f32 v177, v229, v252
v_mfma_f32_16x16x32_bf16 v[232:235], v[110:113], v[148:151], v[232:235]
s_waitcnt lgkmcnt(1)
ds_read_b128 v[204:207], v236 offset:4992
v_fmac_f32 v176, v228, v252
v_mfma_f32_16x16x32_bf16 v[232:235], v[68:71], v[136:139], v[232:235]
v_fmac_f32 v178, v230, v252
v_fmac_f32 v179, v231, v252
v_mfma_f32_16x16x32_bf16 v[188:191], a[0:3], v[212:215], 0
v_cvt_pk_bf16_f32 v176, v176, v177
v_cvt_pk_bf16_f32 v168, v168, v169
v_mfma_f32_16x16x32_bf16 v[188:191], a[4:7], v[224:227], v[188:191]
s_waitcnt lgkmcnt(1)
v_cvt_pk_bf16_f32 v169, v170, v171
v_fmac_f32 v181, v233, v252
v_mfma_f32_16x16x32_bf16 v[188:191], a[8:11], v[196:199], v[188:191]
v_fmac_f32 v182, v234, v252
v_fmac_f32 v180, v232, v252
v_fmac_f32 v183, v235, v252
v_cvt_pk_bf16_f32 v170, v172, v173
v_pk_max_i16 v170, v170, 0
s_waitcnt lgkmcnt(0)
v_mfma_f32_16x16x32_bf16 v[188:191], a[12:15], v[204:207], v[188:191]
v_cvt_pk_bf16_f32 v171, v174, v175
v_pk_max_i16 v176, v176, 0
v_mfma_f32_16x16x32_bf16 v[232:235], a[28:31], v[204:207], 0
v_pk_max_i16 v171, v171, 0
v_cvt_pk_bf16_f32 v177, v178, v179
v_mfma_f32_16x16x32_bf16 v[232:235], a[24:27], v[196:199], v[232:235]
v_cvt_pk_bf16_f32 v178, v180, v181
v_pk_max_i16 v177, v177, 0
v_mfma_f32_16x16x32_bf16 v[232:235], a[20:23], v[224:227], v[232:235]
v_cvt_pk_bf16_f32 v112, v188, v189
v_cvt_pk_bf16_f32 v113, v190, v191
v_mfma_f32_16x16x32_bf16 v[232:235], a[16:19], v[212:215], v[232:235]
v_pk_max_i16 v168, v168, 0
v_cvt_pk_bf16_f32 v179, v182, v183
v_mfma_f32_16x16x32_bf16 v[188:191], a[32:35], v[212:215], 0
v_pk_max_i16 v179, v179, 0
v_pk_max_i16 v169, v169, 0
v_mfma_f32_16x16x32_bf16 v[188:191], a[36:39], v[224:227], v[188:191]
v_pk_max_i16 v178, v178, 0
v_sub_f32 v192, v192, v254
v_mfma_f32_16x16x32_bf16 v[188:191], a[40:43], v[196:199], v[188:191]
buffer_store_dwordx4 v[168:171], v239, s[20:23], s53 offen offset:0 nt
buffer_store_dwordx4 v[176:179], v239, s[20:23], s53 offen offset:64 nt
v_sub_f32 v193, v193, v254
v_exp_f32 v192, v192
v_exp_f32 v193, v193
v_sub_f32 v195, v195, v254
v_exp_f32 v195, v195
v_mfma_f32_16x16x32_bf16 v[188:191], a[44:47], v[204:207], v[188:191]
s_add_u32 s53, s46, 4096
v_add_f32 v248, v248, v192
v_sub_f32 v194, v194, v254
v_mfma_f32_16x16x32_bf16 v[228:231], a[60:63], v[204:207], 0
s_add_u32 s46, s46, 13107200
v_cvt_pk_bf16_f32 v114, v232, v233
v_cvt_pk_bf16_f32 v115, v234, v235
v_mfma_f32_16x16x32_bf16 v[228:231], a[56:59], v[196:199], v[228:231]
v_cvt_pk_bf16_f32 v117, v190, v191
v_cvt_pk_bf16_f32 v116, v188, v189
v_mfma_f32_16x16x32_bf16 v[228:231], a[52:55], v[224:227], v[228:231]
v_exp_f32 v194, v194
v_mfma_f32_16x16x32_bf16 v[228:231], a[48:51], v[212:215], v[228:231]
v_add_f32 v248, v248, v193
v_add_f32 v248, v248, v194
v_mfma_f32_16x16x32_bf16 v[168:171], a[192:195], v[212:215], 0
v_add_f32 v248, v248, v195
v_cvt_pk_bf16_f32 v122, v192, v193
v_mfma_f32_16x16x32_bf16 v[168:171], a[196:199], v[224:227], v[168:171]
v_cvt_pk_bf16_f32 v123, v194, v195
v_sub_f32 v201, v201, v254
v_mfma_f32_16x16x32_bf16 v[168:171], a[200:203], v[196:199], v[168:171]
v_cvt_pk_bf16_f32 v119, v230, v231
v_cvt_pk_bf16_f32 v118, v228, v229
v_mfma_f32_16x16x32_bf16 v[168:171], a[204:207], v[204:207], v[168:171]
v_sub_f32 v202, v202, v254
v_sub_f32 v200, v200, v254
v_mfma_f32_16x16x32_bf16 v[172:175], a[220:223], v[204:207], 0
v_exp_f32 v200, v200
v_mfma_f32_16x16x32_bf16 v[172:175], a[216:219], v[196:199], v[172:175]
v_exp_f32 v202, v202
v_mfma_f32_16x16x32_bf16 v[172:175], a[212:215], v[224:227], v[172:175]
v_exp_f32 v201, v201
v_mfma_f32_16x16x32_bf16 v[172:175], a[208:211], v[212:215], v[172:175]
v_sub_f32 v203, v203, v254
v_add_f32 v248, v248, v200
v_mfma_f32_16x16x32_bf16 v[176:179], a[224:227], v[212:215], 0
v_exp_f32 v203, v203
v_mfma_f32_16x16x32_bf16 v[176:179], a[228:231], v[224:227], v[176:179]
v_cvt_pk_bf16_f32 v125, v202, v203
v_add_f32 v248, v248, v201
v_mfma_f32_16x16x32_bf16 v[176:179], a[232:235], v[196:199], v[176:179]
v_add_f32 v248, v248, v202
v_cvt_pk_bf16_f32 v124, v200, v201
v_mfma_f32_16x16x32_bf16 v[176:179], a[236:239], v[204:207], v[176:179]
v_add_f32 v248, v248, v203
v_sub_f32 v184, v184, v254
v_mfma_f32_16x16x32_bf16 v[180:183], a[252:255], v[204:207], 0
v_sub_f32 v185, v185, v254
v_sub_f32 v187, v187, v254
v_mfma_f32_16x16x32_bf16 v[180:183], a[248:251], v[196:199], v[180:183]
v_sub_f32 v186, v186, v254
v_sub_f32 v220, v220, v254
v_mfma_f32_16x16x32_bf16 v[180:183], a[244:247], v[224:227], v[180:183]
v_exp_f32 v184, v184
v_mfma_f32_16x16x32_bf16 v[180:183], a[240:243], v[212:215], v[180:183]
v_add_f32 v248, v248, v184
v_sub_f32 v216, v216, v254
v_mfma_f32_16x16x32_bf16 v[188:191], v[0:3], v[112:115], 0
v_exp_f32 v187, v187
v_mfma_f32_16x16x32_bf16 v[188:191], v[4:7], v[116:119], v[188:191]
v_exp_f32 v186, v186
v_mfma_f32_16x16x32_bf16 v[192:195], v[12:15], v[116:119], 0
v_exp_f32 v185, v185
v_mfma_f32_16x16x32_bf16 v[192:195], v[8:11], v[112:115], v[192:195]
v_add_f32 v248, v248, v185
v_add_f32 v248, v248, v186
v_mfma_f32_16x16x32_bf16 v[196:199], v[16:19], v[112:115], 0
v_add_f32 v248, v248, v187
v_cvt_pk_bf16_f32 v127, v186, v187
v_mfma_f32_16x16x32_bf16 v[196:199], v[20:23], v[116:119], v[196:199]
v_cvt_pk_bf16_f32 v126, v184, v185
v_sub_f32 v218, v218, v254
v_mfma_f32_16x16x32_bf16 v[200:203], v[28:31], v[116:119], 0
v_exp_f32 v220, v220
v_mfma_f32_16x16x32_bf16 v[200:203], v[24:27], v[112:115], v[200:203]
v_cvt_pk_bf16_f32 v132, v220, 0
v_sub_f32 v217, v217, v254
v_mfma_f32_16x16x32_bf16 v[204:207], v[32:35], v[112:115], 0
v_sub_f32 v211, v211, v254
v_sub_f32 v210, v210, v254
v_mfma_f32_16x16x32_bf16 v[204:207], v[36:39], v[116:119], v[204:207]
v_sub_f32 v219, v219, v254
v_sub_f32 v208, v208, v254
v_mfma_f32_16x16x32_bf16 v[212:215], v[44:47], v[116:119], 0
v_sub_f32 v209, v209, v254
v_max3_f32 v254, v188, v189, v190
v_mfma_f32_16x16x32_bf16 v[212:215], v[40:43], v[112:115], v[212:215]
v_exp_f32 v209, v209
v_mfma_f32_16x16x32_bf16 v[224:227], v[48:51], v[112:115], 0
v_exp_f32 v208, v208
v_mfma_f32_16x16x32_bf16 v[224:227], v[52:55], v[116:119], v[224:227]
v_exp_f32 v217, v217
v_mfma_f32_16x16x32_bf16 v[184:187], v[56:59], v[120:123], 0
v_exp_f32 v210, v210
v_mfma_f32_16x16x32_bf16 v[184:187], v[104:107], v[132:135], v[184:187]
v_exp_f32 v218, v218
v_mfma_f32_16x16x32_bf16 v[184:187], v[72:75], v[124:127], v[184:187]
v_exp_f32 v211, v211
v_exp_f32 v216, v216
v_exp_f32 v219, v219
v_cvt_pk_bf16_f32 v129, v210, v211
v_cvt_pk_bf16_f32 v131, v218, v219
v_cvt_pk_bf16_f32 v130, v216, v217
v_cvt_pk_bf16_f32 v128, v208, v209
v_add_f32 v248, v248, v208
v_add_f32 v248, v248, v209
v_mfma_f32_16x16x32_bf16 v[184:187], v[88:91], v[128:131], v[184:187]
v_add_f32 v248, v248, v210
v_add_f32 v248, v248, v211
v_mfma_f32_16x16x32_bf16 v[208:211], v[92:95], v[128:131], 0
v_max3_f32 v254, v254, v191, v192
v_max3_f32 v254, v254, v193, v194
v_mfma_f32_16x16x32_bf16 v[208:211], v[76:79], v[124:127], v[208:211]
v_max3_f32 v254, v254, v195, v196
v_max3_f32 v254, v254, v197, v198
v_mfma_f32_16x16x32_bf16 v[208:211], v[106:109], v[132:135], v[208:211]
v_max3_f32 v254, v254, v199, v200
v_max3_f32 v254, v254, v201, v202
v_mfma_f32_16x16x32_bf16 v[208:211], v[60:63], v[120:123], v[208:211]
v_max3_f32 v254, v254, v203, v204
v_max3_f32 v254, v254, v205, v206
v_mfma_f32_16x16x32_bf16 v[228:231], v[64:67], v[120:123], 0
v_max3_f32 v254, v254, v207, v212
v_max3_f32 v254, v254, v213, v214
v_mfma_f32_16x16x32_bf16 v[228:231], v[108:111], v[132:135], v[228:231]
v_max3_f32 v254, v254, v215, v224
v_add_f32 v248, v248, v216
v_mfma_f32_16x16x32_bf16 v[228:231], v[80:83], v[124:127], v[228:231]
ds_swizzle_b32 v255, v254 offset:0x401F
v_add_f32 v248, v248, v217
v_mfma_f32_16x16x32_bf16 v[228:231], v[96:99], v[128:131], v[228:231]
v_add_f32 v248, v248, v218
v_add_f32 v248, v248, v219
v_mfma_f32_16x16x32_bf16 v[232:235], v[100:103], v[128:131], 0
ds_read_b128 v[216:219], v236 offset:8448
v_add_f32 v248, v248, v220
v_mfma_f32_16x16x32_bf16 v[232:235], v[84:87], v[124:127], v[232:235]
ds_read_b128 v[220:223], v236 offset:8704
ds_swizzle_b32 v250, v248 offset:0x401F
v_mfma_f32_16x16x32_bf16 v[232:235], v[110:113], v[132:135], v[232:235]
v_mfma_f32_16x16x32_bf16 v[232:235], v[68:71], v[120:123], v[232:235]
s_waitcnt lgkmcnt(3)
v_max_f32 v254, v254, v255
ds_bpermute_b32 v255, v247, v254
s_waitcnt lgkmcnt(1)
v_add_f32 v248, v248, v250
ds_bpermute_b32 v250, v247, v248
s_waitcnt lgkmcnt(1)
v_max_f32 v254, v254, v255
v_sub_f32 v188, v188, v254
v_exp_f32 v188, v188
v_sub_f32 v189, v189, v254
v_sub_f32 v190, v190, v254
v_sub_f32 v191, v191, v254
v_exp_f32 v189, v189
v_exp_f32 v191, v191
v_exp_f32 v190, v190
v_add_f32 v249, v188, v189
v_add_f32 v249, v249, v190
v_add_f32 v249, v249, v191
v_cvt_pk_bf16_f32 v137, v190, v191
v_cvt_pk_bf16_f32 v136, v188, v189
v_mfma_f32_16x16x32_bf16 v[188:191], a[0:3], v[216:219], 0
s_waitcnt lgkmcnt(0)
v_sub_f32 v192, v192, v254
v_sub_f32 v195, v195, v254
v_mfma_f32_16x16x32_bf16 v[188:191], a[4:7], v[220:223], v[188:191]
v_exp_f32 v192, v192
v_sub_f32 v193, v193, v254
v_sub_f32 v194, v194, v254
v_exp_f32 v195, v195
v_exp_f32 v193, v193
v_exp_f32 v194, v194
v_add_f32 v249, v249, v192
v_add_f32 v249, v249, v193
v_add_f32 v249, v249, v194
v_add_f32 v249, v249, v195
v_cvt_pk_bf16_f32 v139, v194, v195
v_cvt_pk_bf16_f32 v138, v192, v193
ds_read_b128 v[192:195], v236 offset:8960
v_sub_f32 v198, v198, v254
v_sub_f32 v197, v197, v254
v_sub_f32 v196, v196, v254
v_exp_f32 v196, v196
v_exp_f32 v198, v198
v_sub_f32 v202, v202, v254
v_sub_f32 v200, v200, v254
v_exp_f32 v197, v197
v_sub_f32 v201, v201, v254
v_sub_f32 v199, v199, v254
v_exp_f32 v199, v199
v_exp_f32 v200, v200
v_add_f32 v249, v249, v196
v_add_f32 v249, v249, v197
v_add_f32 v249, v249, v198
s_waitcnt lgkmcnt(0)
v_mfma_f32_16x16x32_bf16 v[188:191], a[8:11], v[192:195], v[188:191]
v_sub_f32 v203, v203, v254
v_add_f32 v249, v249, v199
v_add_f32 v249, v249, v200
v_exp_f32 v201, v201
v_exp_f32 v202, v202
v_exp_f32 v203, v203
v_sub_f32 v204, v204, v254
v_exp_f32 v204, v204
v_add_f32 v249, v249, v201
v_add_f32 v249, v249, v202
v_add_f32 v249, v249, v203
v_sub_f32 v205, v205, v254
v_sub_f32 v206, v206, v254
v_exp_f32 v205, v205
v_exp_f32 v206, v206
v_add_f32 v249, v249, v204
v_add_f32 v249, v249, v205
v_sub_f32 v207, v207, v254
v_exp_f32 v207, v207
v_add_f32 v249, v249, v206
v_add_f32 v249, v249, v207
v_cvt_pk_bf16_f32 v145, v206, v207
v_cvt_pk_bf16_f32 v144, v204, v205
ds_read_b128 v[204:207], v236 offset:9216
v_add_f32 v248, v248, v250
v_rcp_f32 v251, v248
v_sub_f32 v212, v212, v254
v_fmac_f32 v152, v184, v251
v_fmac_f32 v153, v185, v251
v_fmac_f32 v155, v187, v251
v_fmac_f32 v154, v186, v251
v_fmac_f32 v157, v209, v251
v_fmac_f32 v159, v211, v251
v_fmac_f32 v158, v210, v251
v_fmac_f32 v156, v208, v251
v_exp_f32 v212, v212
v_sub_f32 v213, v213, v254
v_exp_f32 v213, v213
v_sub_f32 v214, v214, v254
v_exp_f32 v214, v214
s_waitcnt lgkmcnt(0)
v_mfma_f32_16x16x32_bf16 v[188:191], a[12:15], v[204:207], v[188:191]
v_sub_f32 v215, v215, v254
v_add_f32 v249, v249, v212
v_mfma_f32_16x16x32_bf16 v[184:187], a[28:31], v[204:207], 0
v_exp_f32 v215, v215
v_mfma_f32_16x16x32_bf16 v[184:187], a[24:27], v[192:195], v[184:187]
v_add_f32 v249, v249, v213
v_add_f32 v249, v249, v214
v_mfma_f32_16x16x32_bf16 v[184:187], a[20:23], v[220:223], v[184:187]
v_add_f32 v249, v249, v215
v_cvt_pk_bf16_f32 v147, v214, v215
v_mfma_f32_16x16x32_bf16 v[184:187], a[16:19], v[216:219], v[184:187]
v_cvt_pk_bf16_f32 v146, v212, v213
v_fmac_f32 v163, v231, v251
v_mfma_f32_16x16x32_bf16 v[208:211], a[32:35], v[216:219], 0
v_fmac_f32 v161, v229, v251
v_cvt_pk_bf16_f32 v152, v152, v153
v_mfma_f32_16x16x32_bf16 v[208:211], a[36:39], v[220:223], v[208:211]
v_fmac_f32 v167, v235, v251
v_fmac_f32 v160, v228, v251
v_mfma_f32_16x16x32_bf16 v[208:211], a[40:43], v[192:195], v[208:211]
v_fmac_f32 v164, v232, v251
v_cvt_pk_bf16_f32 v160, v160, v161
v_mfma_f32_16x16x32_bf16 v[208:211], a[44:47], v[204:207], v[208:211]
v_cvt_pk_bf16_f32 v153, v154, v155
v_cvt_pk_bf16_f32 v154, v156, v157
v_mfma_f32_16x16x32_bf16 v[212:215], a[60:63], v[204:207], 0
v_fmac_f32 v166, v234, v251
v_fmac_f32 v162, v230, v251
v_mfma_f32_16x16x32_bf16 v[212:215], a[56:59], v[192:195], v[212:215]
v_fmac_f32 v165, v233, v251
v_cvt_pk_bf16_f32 v155, v158, v159
v_mfma_f32_16x16x32_bf16 v[212:215], a[52:55], v[220:223], v[212:215]
v_cvt_pk_bf16_f32 v161, v162, v163
v_cvt_pk_bf16_f32 v162, v164, v165
v_mfma_f32_16x16x32_bf16 v[212:215], a[48:51], v[216:219], v[212:215]
v_cvt_pk_bf16_f32 v163, v166, v167
v_pk_max_i16 v162, v162, 0
v_pk_max_i16 v161, v161, 0
v_pk_max_i16 v163, v163, 0
v_pk_max_i16 v153, v153, 0
v_pk_max_i16 v155, v155, 0
v_pk_max_i16 v152, v152, 0
v_pk_max_i16 v160, v160, 0
v_pk_max_i16 v154, v154, 0
buffer_store_dwordx4 v[152:155], v239, s[20:23], s52 offen offset:0 nt
buffer_store_dwordx4 v[160:163], v239, s[20:23], s52 offen offset:64 nt
v_cvt_pk_bf16_f32 v112, v188, v189
v_cvt_pk_bf16_f32 v113, v190, v191
v_cvt_pk_bf16_f32 v114, v184, v185
v_cvt_pk_bf16_f32 v115, v186, v187
v_cvt_pk_bf16_f32 v118, v212, v213
v_cvt_pk_bf16_f32 v119, v214, v215
v_cvt_pk_bf16_f32 v116, v208, v209
v_cvt_pk_bf16_f32 v117, v210, v211
v_mfma_f32_16x16x32_bf16 v[152:155], a[192:195], v[216:219], 0
v_sub_f32 v224, v224, v254
v_cvt_pk_bf16_f32 v142, v200, v201
v_mfma_f32_16x16x32_bf16 v[152:155], a[196:199], v[220:223], v[152:155]
v_exp_f32 v224, v224
v_mfma_f32_16x16x32_bf16 v[152:155], a[200:203], v[192:195], v[152:155]
v_cvt_pk_bf16_f32 v141, v198, v199
v_cvt_pk_bf16_f32 v140, v196, v197
v_mfma_f32_16x16x32_bf16 v[152:155], a[204:207], v[204:207], v[152:155]
v_add_f32 v249, v249, v224
v_cvt_pk_bf16_f32 v143, v202, v203
v_mfma_f32_16x16x32_bf16 v[156:159], a[220:223], v[204:207], 0
ds_swizzle_b32 v250, v249 offset:0x401F
v_cvt_pk_bf16_f32 v148, v224, 0
v_mfma_f32_16x16x32_bf16 v[156:159], a[216:219], v[192:195], v[156:159]
v_mfma_f32_16x16x32_bf16 v[156:159], a[212:215], v[220:223], v[156:159]
v_mfma_f32_16x16x32_bf16 v[156:159], a[208:211], v[216:219], v[156:159]
v_mfma_f32_16x16x32_bf16 v[160:163], a[224:227], v[216:219], 0
v_mfma_f32_16x16x32_bf16 v[160:163], a[228:231], v[220:223], v[160:163]
v_mfma_f32_16x16x32_bf16 v[160:163], a[232:235], v[192:195], v[160:163]
s_waitcnt lgkmcnt(0)
v_add_f32 v249, v249, v250
v_mfma_f32_16x16x32_bf16 v[160:163], a[236:239], v[204:207], v[160:163]
ds_bpermute_b32 v250, v247, v249
v_mfma_f32_16x16x32_bf16 v[164:167], a[252:255], v[204:207], 0
v_mfma_f32_16x16x32_bf16 v[164:167], a[248:251], v[192:195], v[164:167]
v_mfma_f32_16x16x32_bf16 v[164:167], a[244:247], v[220:223], v[164:167]
v_mfma_f32_16x16x32_bf16 v[164:167], a[240:243], v[216:219], v[164:167]
v_mfma_f32_16x16x32_bf16 v[184:187], v[0:3], v[112:115], 0
v_mfma_f32_16x16x32_bf16 v[184:187], v[4:7], v[116:119], v[184:187]
s_waitcnt lgkmcnt(0)
v_add_f32 v249, v249, v250
s_nop 0
v_mfma_f32_16x16x32_bf16 v[188:191], v[12:15], v[116:119], 0
v_rcp_f32 v252, v249
v_mfma_f32_16x16x32_bf16 v[188:191], v[8:11], v[112:115], v[188:191]
s_nop 1
v_max3_f32 v254, v184, v185, v186
v_mfma_f32_16x16x32_bf16 v[192:195], v[16:19], v[112:115], 0
s_nop 2
v_mfma_f32_16x16x32_bf16 v[192:195], v[20:23], v[116:119], v[192:195]
v_max3_f32 v254, v254, v187, v188
v_max3_f32 v254, v254, v189, v190
v_mfma_f32_16x16x32_bf16 v[196:199], v[28:31], v[116:119], 0
s_nop 2
v_mfma_f32_16x16x32_bf16 v[196:199], v[24:27], v[112:115], v[196:199]
s_nop 0
v_max3_f32 v254, v254, v191, v192
v_max3_f32 v254, v254, v193, v194
v_mfma_f32_16x16x32_bf16 v[200:203], v[32:35], v[112:115], 0
s_nop 2
v_mfma_f32_16x16x32_bf16 v[200:203], v[36:39], v[116:119], v[200:203]
v_max3_f32 v254, v254, v195, v196
v_max3_f32 v254, v254, v197, v198
v_mfma_f32_16x16x32_bf16 v[204:207], v[44:47], v[116:119], 0
s_nop 2
v_mfma_f32_16x16x32_bf16 v[204:207], v[40:43], v[112:115], v[204:207]
s_nop 0
v_max3_f32 v254, v254, v199, v200
v_max3_f32 v254, v254, v201, v202
v_mfma_f32_16x16x32_bf16 v[208:211], v[48:51], v[112:115], 0
s_nop 2
v_mfma_f32_16x16x32_bf16 v[208:211], v[52:55], v[116:119], v[208:211]
v_max3_f32 v254, v254, v203, v204
v_max3_f32 v254, v254, v205, v206
v_mfma_f32_16x16x32_bf16 v[212:215], v[56:59], v[136:139], 0
s_nop 2
v_mfma_f32_16x16x32_bf16 v[212:215], v[104:107], v[148:151], v[212:215]
s_nop 0
v_max3_f32 v254, v254, v207, v208
v_mfma_f32_16x16x32_bf16 v[212:215], v[72:75], v[140:143], v[212:215]
ds_swizzle_b32 v255, v254 offset:0x401F
v_mfma_f32_16x16x32_bf16 v[212:215], v[88:91], v[144:147], v[212:215]
s_nop 2
v_mfma_f32_16x16x32_bf16 v[216:219], v[92:95], v[144:147], 0
s_nop 2
v_mfma_f32_16x16x32_bf16 v[216:219], v[76:79], v[140:143], v[216:219]
v_fmac_f32 v169, v213, v252
v_fmac_f32 v168, v212, v252
v_mfma_f32_16x16x32_bf16 v[216:219], v[106:109], v[148:151], v[216:219]
v_fmac_f32 v171, v215, v252
v_fmac_f32 v170, v214, v252
v_mfma_f32_16x16x32_bf16 v[216:219], v[60:63], v[136:139], v[216:219]
ds_read_b128 v[220:223], v236 offset:12672
ds_read_b128 v[224:227], v236 offset:12928
v_mfma_f32_16x16x32_bf16 v[228:231], v[64:67], v[136:139], 0
s_waitcnt lgkmcnt(2)
ds_read_b128 v[212:215], v236 offset:13184
v_cvt_pk_bf16_f32 v168, v168, v169
v_mfma_f32_16x16x32_bf16 v[228:231], v[108:111], v[148:151], v[228:231]
s_nop 0
v_fmac_f32 v172, v216, v252
v_fmac_f32 v174, v218, v252
v_mfma_f32_16x16x32_bf16 v[228:231], v[80:83], v[140:143], v[228:231]
v_fmac_f32 v173, v217, v252
v_fmac_f32 v175, v219, v252
v_mfma_f32_16x16x32_bf16 v[228:231], v[96:99], v[144:147], v[228:231]
ds_read_b128 v[216:219], v236 offset:13440
v_cvt_pk_bf16_f32 v169, v170, v171
v_mfma_f32_16x16x32_bf16 v[232:235], v[100:103], v[144:147], 0
v_cvt_pk_bf16_f32 v170, v172, v173
v_cvt_pk_bf16_f32 v171, v174, v175
v_mfma_f32_16x16x32_bf16 v[232:235], v[84:87], v[140:143], v[232:235]
s_waitcnt lgkmcnt(2)
v_pk_max_i16 v170, v170, 0
v_fmac_f32 v178, v230, v252
v_mfma_f32_16x16x32_bf16 v[232:235], v[110:113], v[148:151], v[232:235]
s_waitcnt lgkmcnt(1)
v_fmac_f32 v179, v231, v252
v_fmac_f32 v176, v228, v252
v_mfma_f32_16x16x32_bf16 v[232:235], v[68:71], v[136:139], v[232:235]
v_fmac_f32 v177, v229, v252
v_cvt_pk_bf16_f32 v176, v176, v177
v_mfma_f32_16x16x32_bf16 v[228:231], a[0:3], v[220:223], 0
v_cvt_pk_bf16_f32 v177, v178, v179
v_pk_max_i16 v169, v169, 0
v_mfma_f32_16x16x32_bf16 v[228:231], a[4:7], v[224:227], v[228:231]
s_waitcnt lgkmcnt(0)
v_pk_max_i16 v171, v171, 0
v_fmac_f32 v182, v234, v252
v_mfma_f32_16x16x32_bf16 v[228:231], a[8:11], v[212:215], v[228:231]
v_fmac_f32 v181, v233, v252
v_fmac_f32 v183, v235, v252
v_mfma_f32_16x16x32_bf16 v[228:231], a[12:15], v[216:219], v[228:231]
v_fmac_f32 v180, v232, v252
v_cvt_pk_bf16_f32 v179, v182, v183
v_mfma_f32_16x16x32_bf16 v[232:235], a[28:31], v[216:219], 0
v_cvt_pk_bf16_f32 v178, v180, v181
v_pk_max_i16 v178, v178, 0
v_mfma_f32_16x16x32_bf16 v[232:235], a[24:27], v[212:215], v[232:235]
v_pk_max_i16 v179, v179, 0
v_pk_max_i16 v176, v176, 0
v_mfma_f32_16x16x32_bf16 v[232:235], a[20:23], v[224:227], v[232:235]
v_cvt_pk_bf16_f32 v113, v230, v231
v_cvt_pk_bf16_f32 v112, v228, v229
v_mfma_f32_16x16x32_bf16 v[232:235], a[16:19], v[220:223], v[232:235]
v_pk_max_i16 v168, v168, 0
v_pk_max_i16 v177, v177, 0
v_mfma_f32_16x16x32_bf16 v[228:231], a[32:35], v[220:223], 0
buffer_store_dwordx4 v[168:171], v239, s[20:23], s53 offen offset:0 nt
buffer_store_dwordx4 v[176:179], v239, s[20:23], s53 offen offset:64 nt
v_add_u32 v236, s56, v236
v_max_f32 v254, v254, v255
s_sub_u32 s56, 0, s56
v_cvt_pk_bf16_f32 v115, v234, v235
v_cvt_pk_bf16_f32 v114, v232, v233
v_mfma_f32_16x16x32_bf16 v[228:231], a[36:39], v[224:227], v[228:231]
ds_bpermute_b32 v255, v247, v254
v_mfma_f32_16x16x32_bf16 v[228:231], a[40:43], v[212:215], v[228:231]
v_mfma_f32_16x16x32_bf16 v[228:231], a[44:47], v[216:219], v[228:231]
s_nop 2
v_mfma_f32_16x16x32_bf16 v[232:235], a[60:63], v[216:219], 0
s_nop 2
v_mfma_f32_16x16x32_bf16 v[232:235], a[56:59], v[212:215], v[232:235]
v_cvt_pk_bf16_f32 v116, v228, v229
v_cvt_pk_bf16_f32 v117, v230, v231
v_mfma_f32_16x16x32_bf16 v[232:235], a[52:55], v[224:227], v[232:235]
v_mfma_f32_16x16x32_bf16 v[232:235], a[48:51], v[220:223], v[232:235]
s_waitcnt lgkmcnt(0)
v_max_f32 v254, v254, v255
v_sub_f32 v184, v184, v254
v_mfma_f32_16x16x32_bf16 v[168:171], a[192:195], v[220:223], 0
v_exp_f32 v184, v184
v_mfma_f32_16x16x32_bf16 v[168:171], a[196:199], v[224:227], v[168:171]
v_sub_f32 v185, v185, v254
v_sub_f32 v186, v186, v254
v_mfma_f32_16x16x32_bf16 v[168:171], a[200:203], v[212:215], v[168:171]
v_cvt_pk_bf16_f32 v119, v234, v235
v_cvt_pk_bf16_f32 v118, v232, v233
v_mfma_f32_16x16x32_bf16 v[168:171], a[204:207], v[216:219], v[168:171]
v_exp_f32 v186, v186
v_mfma_f32_16x16x32_bf16 v[172:175], a[220:223], v[216:219], 0
v_exp_f32 v185, v185
v_mfma_f32_16x16x32_bf16 v[172:175], a[216:219], v[212:215], v[172:175]
v_sub_f32 v189, v189, v254
v_sub_f32 v187, v187, v254
v_mfma_f32_16x16x32_bf16 v[172:175], a[212:215], v[224:227], v[172:175]
v_sub_f32 v188, v188, v254
v_sub_f32 v190, v190, v254
v_mfma_f32_16x16x32_bf16 v[172:175], a[208:211], v[220:223], v[172:175]
s_cmp_lg_u32 s45, 0
s_cbranch_scc1 L_loops
v_mfma_f32_16x16x32_bf16 v[176:179], a[224:227], v[220:223], 0
s_waitcnt vmcnt(8)
s_barrier
v_mfma_f32_16x16x32_bf16 v[176:179], a[228:231], v[224:227], v[176:179]
s_add_u32 s52, s47, 8192
ds_read_b128 v[232:235], v236 offset:0
v_add_f32 v248, v184, v185
v_mfma_f32_16x16x32_bf16 v[176:179], a[232:235], v[212:215], v[176:179]
s_add_u32 s53, s47, 12288
v_exp_f32 v188, v188
v_mfma_f32_16x16x32_bf16 v[176:179], a[236:239], v[216:219], v[176:179]
v_add_f32 v248, v248, v186
v_sub_f32 v191, v191, v254
v_mfma_f32_16x16x32_bf16 v[180:183], a[252:255], v[216:219], 0
v_exp_f32 v187, v187
v_mfma_f32_16x16x32_bf16 v[180:183], a[248:251], v[212:215], v[180:183]
v_exp_f32 v190, v190
v_mfma_f32_16x16x32_bf16 v[180:183], a[244:247], v[224:227], v[180:183]
v_add_f32 v248, v248, v187
v_add_f32 v248, v248, v188
v_mfma_f32_16x16x32_bf16 v[180:183], a[240:243], v[220:223], v[180:183]
s_waitcnt lgkmcnt(0)
v_exp_f32 v189, v189
v_mfma_f32_16x16x32_bf16 v[228:231], v[0:3], v[112:115], 0
v_add_f32 v248, v248, v189
v_add_f32 v248, v248, v190
v_mfma_f32_16x16x32_bf16 v[228:231], v[4:7], v[116:119], v[228:231]
v_exp_f32 v191, v191
v_cvt_pk_bf16_f32 v122, v188, v189
v_add_f32 v248, v248, v191
v_cvt_pk_bf16_f32 v123, v190, v191
v_mfma_f32_16x16x32_bf16 v[188:191], v[12:15], v[116:119], 0
v_sub_f32 v193, v193, v254
v_sub_f32 v194, v194, v254
v_mfma_f32_16x16x32_bf16 v[188:191], v[8:11], v[112:115], v[188:191]
v_sub_f32 v195, v195, v254
v_exp_f32 v194, v194
v_sub_f32 v192, v192, v254
v_exp_f32 v192, v192
v_sub_f32 v196, v196, v254
v_exp_f32 v193, v193
v_sub_f32 v197, v197, v254
v_sub_f32 v199, v199, v254
v_sub_f32 v198, v198, v254
v_exp_f32 v195, v195
v_add_f32 v248, v248, v192
v_add_f32 v248, v248, v193
v_exp_f32 v196, v196
v_exp_f32 v197, v197
v_add_f32 v248, v248, v194
v_add_f32 v248, v248, v195
v_add_f32 v248, v248, v196
v_add_f32 v248, v248, v197
v_exp_f32 v198, v198
v_sub_f32 v200, v200, v254
v_sub_f32 v203, v203, v254
v_exp_f32 v199, v199
v_sub_f32 v201, v201, v254
v_exp_f32 v201, v201
v_sub_f32 v202, v202, v254
v_exp_f32 v202, v202
v_add_f32 v248, v248, v198
v_exp_f32 v200, v200
v_add_f32 v248, v248, v199
v_add_f32 v248, v248, v200
v_add_f32 v248, v248, v201
v_exp_f32 v203, v203
v_add_f32 v248, v248, v202
v_add_f32 v248, v248, v203
v_cvt_pk_bf16_f32 v128, v200, v201
v_cvt_pk_bf16_f32 v129, v202, v203
v_mfma_f32_16x16x32_bf16 v[200:203], v[16:19], v[112:115], 0
v_sub_f32 v204, v204, v254
v_sub_f32 v205, v205, v254
v_mfma_f32_16x16x32_bf16 v[200:203], v[20:23], v[116:119], v[200:203]
v_exp_f32 v204, v204
v_sub_f32 v206, v206, v254
v_add_f32 v248, v248, v204
v_exp_f32 v206, v206
v_sub_f32 v207, v207, v254
v_exp_f32 v205, v205
v_exp_f32 v207, v207
v_add_f32 v248, v248, v205
v_add_f32 v248, v248, v206
v_add_f32 v248, v248, v207
v_cvt_pk_bf16_f32 v130, v204, v205
v_cvt_pk_bf16_f32 v131, v206, v207
v_mfma_f32_16x16x32_bf16 v[204:207], v[28:31], v[116:119], 0
v_sub_f32 v208, v208, v254
v_cvt_pk_bf16_f32 v120, v184, v185
v_mfma_f32_16x16x32_bf16 v[204:207], v[24:27], v[112:115], v[204:207]
v_exp_f32 v208, v208
s_nop 0
v_add_f32 v248, v248, v208
v_cvt_pk_bf16_f32 v132, v208, 0
v_mfma_f32_16x16x32_bf16 v[208:211], v[32:35], v[112:115], 0
ds_swizzle_b32 v250, v248 offset:0x401F
v_cvt_pk_bf16_f32 v121, v186, v187
v_mfma_f32_16x16x32_bf16 v[208:211], v[36:39], v[116:119], v[208:211]
ds_read_b128 v[184:187], v236 offset:256
v_cvt_pk_bf16_f32 v126, v196, v197
v_mfma_f32_16x16x32_bf16 v[212:215], v[44:47], v[116:119], 0
v_cvt_pk_bf16_f32 v125, v194, v195
v_cvt_pk_bf16_f32 v127, v198, v199
v_mfma_f32_16x16x32_bf16 v[212:215], v[40:43], v[112:115], v[212:215]
ds_read_b128 v[196:199], v236 offset:768
v_cvt_pk_bf16_f32 v124, v192, v193
v_mfma_f32_16x16x32_bf16 v[216:219], v[48:51], v[112:115], 0
ds_read_b128 v[192:195], v236 offset:512
v_max3_f32 v254, v228, v229, v230
v_mfma_f32_16x16x32_bf16 v[216:219], v[52:55], v[116:119], v[216:219]
v_max3_f32 v254, v254, v231, v188
v_max3_f32 v254, v254, v189, v190
v_mfma_f32_16x16x32_bf16 v[220:223], v[56:59], v[120:123], 0
s_waitcnt lgkmcnt(3)
v_add_f32 v248, v248, v250
v_max3_f32 v254, v254, v191, v200
v_mfma_f32_16x16x32_bf16 v[220:223], v[104:107], v[132:135], v[220:223]
s_waitcnt lgkmcnt(2)
ds_bpermute_b32 v250, v247, v248
v_mfma_f32_16x16x32_bf16 v[220:223], v[72:75], v[124:127], v[220:223]
v_max3_f32 v254, v254, v201, v202
v_max3_f32 v254, v254, v203, v204
v_mfma_f32_16x16x32_bf16 v[220:223], v[88:91], v[128:131], v[220:223]
s_waitcnt lgkmcnt(2)
v_max3_f32 v254, v254, v205, v206
v_max3_f32 v254, v254, v207, v208
v_mfma_f32_16x16x32_bf16 v[224:227], v[92:95], v[128:131], 0
s_waitcnt lgkmcnt(1)
v_max3_f32 v254, v254, v209, v210
v_max3_f32 v254, v254, v211, v212
v_mfma_f32_16x16x32_bf16 v[224:227], v[76:79], v[124:127], v[224:227]
v_max3_f32 v254, v254, v213, v214
v_max3_f32 v254, v254, v215, v216
v_mfma_f32_16x16x32_bf16 v[224:227], v[106:109], v[132:135], v[224:227]
ds_swizzle_b32 v255, v254 offset:0x401F
v_mbcnt_lo_u32_b32 v242, -1, 0
v_mfma_f32_16x16x32_bf16 v[224:227], v[60:63], v[120:123], v[224:227]
s_waitcnt lgkmcnt(1)
v_add_f32 v248, v248, v250
v_rcp_f32 v251, v248
s_nop 0
v_fmac_f32 v152, v220, v251
v_fmac_f32 v153, v221, v251
v_fmac_f32 v154, v222, v251
v_fmac_f32 v155, v223, v251
v_mfma_f32_16x16x32_bf16 v[220:223], v[64:67], v[120:123], 0
v_fmac_f32 v156, v224, v251
v_fmac_f32 v157, v225, v251
v_mfma_f32_16x16x32_bf16 v[220:223], v[108:111], v[132:135], v[220:223]
v_fmac_f32 v158, v226, v251
v_fmac_f32 v159, v227, v251
v_mfma_f32_16x16x32_bf16 v[220:223], v[80:83], v[124:127], v[220:223]
s_waitcnt lgkmcnt(0)
v_cvt_pk_bf16_f32 v152, v152, v153
v_cvt_pk_bf16_f32 v153, v154, v155
v_mfma_f32_16x16x32_bf16 v[220:223], v[96:99], v[128:131], v[220:223]
v_cvt_pk_bf16_f32 v154, v156, v157
v_cvt_pk_bf16_f32 v155, v158, v159
v_mfma_f32_16x16x32_bf16 v[224:227], v[100:103], v[128:131], 0
v_pk_max_i16 v152, v152, 0
v_pk_max_i16 v153, v153, 0
v_mfma_f32_16x16x32_bf16 v[224:227], v[84:87], v[124:127], v[224:227]
v_max_f32 v254, v254, v255
v_pk_max_i16 v154, v154, 0
v_mfma_f32_16x16x32_bf16 v[224:227], v[110:113], v[132:135], v[224:227]
ds_bpermute_b32 v255, v247, v254
v_mfma_f32_16x16x32_bf16 v[224:227], v[68:71], v[120:123], v[224:227]
v_fmac_f32 v160, v220, v251
v_fmac_f32 v161, v221, v251
v_mfma_f32_16x16x32_bf16 v[0:3], a[192:195], v[232:235], 0
v_fmac_f32 v162, v222, v251
v_fmac_f32 v163, v223, v251
v_mfma_f32_16x16x32_bf16 v[0:3], a[196:199], v[184:187], v[0:3]
v_cvt_pk_bf16_f32 v160, v160, v161
v_cvt_pk_bf16_f32 v161, v162, v163
v_mfma_f32_16x16x32_bf16 v[0:3], a[200:203], v[192:195], v[0:3]
v_fmac_f32 v164, v224, v251
v_fmac_f32 v165, v225, v251
v_mfma_f32_16x16x32_bf16 v[0:3], a[204:207], v[196:199], v[0:3]
v_fmac_f32 v166, v226, v251
v_fmac_f32 v167, v227, v251
v_mfma_f32_16x16x32_bf16 v[4:7], a[220:223], v[196:199], 0
s_waitcnt lgkmcnt(0)
v_max_f32 v254, v254, v255
v_sub_f32 v228, v228, v254
v_mfma_f32_16x16x32_bf16 v[4:7], a[216:219], v[192:195], v[4:7]
v_sub_f32 v229, v229, v254
v_sub_f32 v230, v230, v254
v_mfma_f32_16x16x32_bf16 v[4:7], a[212:215], v[184:187], v[4:7]
v_exp_f32 v228, v228
v_mfma_f32_16x16x32_bf16 v[4:7], a[208:211], v[232:235], v[4:7]
ds_read_b128 v[220:223], v236 offset:4224
v_sub_f32 v231, v231, v254
v_mfma_f32_16x16x32_bf16 v[8:11], a[224:227], v[232:235], 0
v_exp_f32 v229, v229
v_mfma_f32_16x16x32_bf16 v[8:11], a[228:231], v[184:187], v[8:11]
v_exp_f32 v230, v230
v_mfma_f32_16x16x32_bf16 v[8:11], a[232:235], v[192:195], v[8:11]
v_exp_f32 v231, v231
v_mfma_f32_16x16x32_bf16 v[8:11], a[236:239], v[196:199], v[8:11]
v_add_f32 v249, v228, v229
v_add_f32 v249, v249, v230
v_mfma_f32_16x16x32_bf16 v[12:15], a[252:255], v[196:199], 0
ds_read_b128 v[196:199], v236 offset:4736
v_add_f32 v249, v249, v231
v_mfma_f32_16x16x32_bf16 v[12:15], a[248:251], v[192:195], v[12:15]
s_waitcnt lgkmcnt(1)
ds_read_b128 v[192:195], v236 offset:4992
v_cvt_pk_bf16_f32 v136, v228, v229
v_mfma_f32_16x16x32_bf16 v[12:15], a[244:247], v[184:187], v[12:15]
v_cvt_pk_bf16_f32 v137, v230, v231
v_sub_f32 v188, v188, v254
v_mfma_f32_16x16x32_bf16 v[12:15], a[240:243], v[232:235], v[12:15]
ds_read_b128 v[228:231], v236 offset:4480
v_sub_f32 v189, v189, v254
v_mfma_f32_16x16x32_bf16 v[16:19], a[192:195], v[220:223], 0
v_exp_f32 v188, v188
v_exp_f32 v189, v189
v_sub_f32 v190, v190, v254
v_cvt_pk_bf16_f32 v138, v188, v189
v_sub_f32 v191, v191, v254
v_exp_f32 v190, v190
v_exp_f32 v191, v191
v_sub_f32 v216, v216, v254
v_cvt_pk_bf16_f32 v139, v190, v191
v_exp_f32 v216, v216
v_sub_f32 v200, v200, v254
v_cvt_pk_bf16_f32 v148, v216, 0
s_waitcnt lgkmcnt(0)
v_mfma_f32_16x16x32_bf16 v[16:19], a[196:199], v[228:231], v[16:19]
v_sub_f32 v201, v201, v254
v_sub_f32 v202, v202, v254
v_mfma_f32_16x16x32_bf16 v[16:19], a[200:203], v[196:199], v[16:19]
v_exp_f32 v200, v200
v_mfma_f32_16x16x32_bf16 v[16:19], a[204:207], v[192:195], v[16:19]
v_exp_f32 v201, v201
v_mfma_f32_16x16x32_bf16 v[20:23], a[220:223], v[192:195], 0
v_exp_f32 v202, v202
v_mfma_f32_16x16x32_bf16 v[20:23], a[216:219], v[196:199], v[20:23]
v_sub_f32 v203, v203, v254
v_sub_f32 v204, v204, v254
v_mfma_f32_16x16x32_bf16 v[20:23], a[212:215], v[228:231], v[20:23]
v_exp_f32 v203, v203
v_mfma_f32_16x16x32_bf16 v[20:23], a[208:211], v[220:223], v[20:23]
v_exp_f32 v204, v204
v_mfma_f32_16x16x32_bf16 v[24:27], a[224:227], v[220:223], 0
v_sub_f32 v205, v205, v254
v_sub_f32 v206, v206, v254
v_mfma_f32_16x16x32_bf16 v[24:27], a[228:231], v[228:231], v[24:27]
v_exp_f32 v205, v205
v_mfma_f32_16x16x32_bf16 v[24:27], a[232:235], v[196:199], v[24:27]
v_exp_f32 v206, v206
v_mfma_f32_16x16x32_bf16 v[24:27], a[236:239], v[192:195], v[24:27]
v_sub_f32 v207, v207, v254
v_cvt_pk_bf16_f32 v140, v200, v201
v_mfma_f32_16x16x32_bf16 v[28:31], a[252:255], v[192:195], 0
v_exp_f32 v207, v207
v_mfma_f32_16x16x32_bf16 v[28:31], a[248:251], v[196:199], v[28:31]
v_cvt_pk_bf16_f32 v141, v202, v203
v_cvt_pk_bf16_f32 v142, v204, v205
v_mfma_f32_16x16x32_bf16 v[28:31], a[244:247], v[228:231], v[28:31]
v_cvt_pk_bf16_f32 v143, v206, v207
v_sub_f32 v208, v208, v254
v_mfma_f32_16x16x32_bf16 v[28:31], a[240:243], v[220:223], v[28:31]
v_sub_f32 v209, v209, v254
v_sub_f32 v210, v210, v254
v_mfma_f32_16x16x32_bf16 v[228:231], v[56:59], v[136:139], 0
v_exp_f32 v208, v208
v_mfma_f32_16x16x32_bf16 v[228:231], v[104:107], v[148:151], v[228:231]
v_exp_f32 v209, v209
v_mfma_f32_16x16x32_bf16 v[228:231], v[72:75], v[140:143], v[228:231]
v_exp_f32 v210, v210
v_sub_f32 v211, v211, v254
v_exp_f32 v211, v211
v_sub_f32 v212, v212, v254
v_exp_f32 v212, v212
v_sub_f32 v213, v213, v254
v_exp_f32 v213, v213
v_sub_f32 v214, v214, v254
v_exp_f32 v214, v214
v_sub_f32 v215, v215, v254
v_exp_f32 v215, v215
v_cvt_pk_bf16_f32 v144, v208, v209
v_cvt_pk_bf16_f32 v145, v210, v211
v_cvt_pk_bf16_f32 v146, v212, v213
v_cvt_pk_bf16_f32 v147, v214, v215
v_cvt_pk_bf16_f32 v162, v164, v165
v_cvt_pk_bf16_f32 v163, v166, v167
v_mfma_f32_16x16x32_bf16 v[228:231], v[88:91], v[144:147], v[228:231]
v_pk_max_i16 v155, v155, 0
v_pk_max_i16 v160, v160, 0
v_mfma_f32_16x16x32_bf16 v[192:195], v[92:95], v[144:147], 0
v_pk_max_i16 v161, v161, 0
v_pk_max_i16 v162, v162, 0
v_mfma_f32_16x16x32_bf16 v[192:195], v[76:79], v[140:143], v[192:195]
v_pk_max_i16 v163, v163, 0
v_mbcnt_hi_u32_b32 v242, -1, v242
v_mfma_f32_16x16x32_bf16 v[192:195], v[106:109], v[148:151], v[192:195]
buffer_store_dwordx4 v[152:155], v239, s[20:23], s52 offen offset:0 nt
buffer_store_dwordx4 v[160:163], v239, s[20:23], s52 offen offset:64 nt
s_mul_i32 s54, s41, 12288
s_add_u32 s54, s54, 105472
v_mov_b32 v244, s54
v_bfe_u32 v243, v242, 0, 4
v_lshl_add_u32 v244, v243, 7, v244
v_lshlrev_b32 v243, 4, v242
v_xor_b32 v243, v243, v242
v_and_b32 v243, 48, v243
v_mfma_f32_16x16x32_bf16 v[192:195], v[60:63], v[136:139], v[192:195]
v_add_u32 v244, v243, v244
v_add_u32 v244, v243, v244
v_mfma_f32_16x16x32_bf16 v[220:223], v[64:67], v[136:139], 0
ds_read_b128 v[184:187], v244 offset:0
ds_read_b128 v[232:235], v244 offset:16
v_mfma_f32_16x16x32_bf16 v[220:223], v[108:111], v[148:151], v[220:223]
ds_read_b128 v[196:199], v244 offset:2048
v_add_f32 v249, v249, v188
v_mfma_f32_16x16x32_bf16 v[220:223], v[80:83], v[140:143], v[220:223]
ds_read_b32 v188, v244 offset:4096
v_add_f32 v249, v249, v189
v_mfma_f32_16x16x32_bf16 v[220:223], v[96:99], v[144:147], v[220:223]
v_add_f32 v249, v249, v190
v_add_f32 v249, v249, v191
v_mfma_f32_16x16x32_bf16 v[224:227], v[100:103], v[144:147], 0
v_mov_b32 v245, 24576
v_bfe_u32 v243, v242, 0, 2
v_mfma_f32_16x16x32_bf16 v[224:227], v[84:87], v[140:143], v[224:227]
v_lshl_add_u32 v245, v243, 8, v245
v_bfe_u32 v243, v242, 2, 2
v_mfma_f32_16x16x32_bf16 v[224:227], v[110:113], v[148:151], v[224:227]
s_waitcnt lgkmcnt(2)
v_lshlrev_b32 v190, 16, v184
v_lshlrev_b32 v191, 16, v185
v_mfma_f32_16x16x32_bf16 v[224:227], v[68:71], v[136:139], v[224:227]
s_waitcnt lgkmcnt(1)
s_waitcnt lgkmcnt(0)
ds_swizzle_b32 v189, v188 offset:0x401F
v_and_b32 v184, 0xffff0000, v184
v_and_b32 v185, 0xffff0000, v185
v_mul_u32_u24 v243, 13107200, v243
v_add_u32 v245, v243, v245
s_lshl_b32 s48, s43, 7
s_add_u32 s48, s48, s44
s_add_u32 s48, s48, 0
v_bfe_u32 v243, v242, 4, 2
v_lshl_add_u32 v245, v243, 4, v245
v_add_f32 v249, v249, v200
v_add_f32 v249, v249, v201
v_add_f32 v249, v249, v202
v_add_f32 v249, v249, v203
ds_read_b128 v[200:203], v244 offset:2064
v_add_f32 v249, v249, v204
ds_read_b32 v204, v244 offset:6144
v_add_f32 v249, v249, v205
v_add_f32 v249, v249, v206
v_add_f32 v249, v249, v207
v_add_f32 v249, v249, v208
v_add_f32 v249, v249, v209
v_add_f32 v249, v249, v210
v_add_f32 v249, v249, v211
v_add_f32 v249, v249, v212
v_add_f32 v249, v249, v213
v_add_f32 v249, v249, v214
v_add_f32 v249, v249, v215
v_add_f32 v249, v249, v216
ds_swizzle_b32 v250, v249 offset:0x401F
v_lshlrev_b32 v206, 16, v196
v_lshlrev_b32 v207, 16, v197
v_and_b32 v196, 0xffff0000, v196
v_and_b32 v197, 0xffff0000, v197
s_waitcnt lgkmcnt(1)
ds_swizzle_b32 v205, v204 offset:0x401F
v_add_f32 v188, v188, v189
ds_bpermute_b32 v189, v247, v188
s_lshl_b32 s51, s43, 7
s_add_u32 s51, s51, s44
s_add_u32 s51, s51, 52428800
s_waitcnt lgkmcnt(2)
v_add_f32 v249, v249, v250
ds_bpermute_b32 v250, v247, v249
s_waitcnt lgkmcnt(2)
v_add_f32 v204, v204, v205
ds_bpermute_b32 v205, v247, v204
s_waitcnt lgkmcnt(2)
v_add_f32 v188, v188, v189
v_rcp_f32 v189, v188
s_nop 0
v_fmac_f32 v0, v190, v189
v_fmac_f32 v2, v191, v189
v_lshlrev_b32 v190, 16, v186
v_lshlrev_b32 v191, 16, v187
v_fmac_f32 v4, v190, v189
v_fmac_f32 v6, v191, v189
v_lshlrev_b32 v190, 16, v232
v_lshlrev_b32 v191, 16, v233
v_and_b32 v232, 0xffff0000, v232
v_fmac_f32 v8, v190, v189
v_fmac_f32 v10, v191, v189
v_fmac_f32 v1, v184, v189
v_fmac_f32 v9, v232, v189
v_and_b32 v233, 0xffff0000, v233
v_lshlrev_b32 v190, 16, v234
v_lshlrev_b32 v191, 16, v235
v_fmac_f32 v3, v185, v189
v_and_b32 v186, 0xffff0000, v186
v_and_b32 v187, 0xffff0000, v187
v_fmac_f32 v11, v233, v189
v_and_b32 v234, 0xffff0000, v234
v_and_b32 v235, 0xffff0000, v235
v_cvt_pk_bf16_f32 v0, v0, v1
v_cvt_pk_bf16_f32 v8, v8, v9
v_fmac_f32 v5, v186, v189
v_fmac_f32 v7, v187, v189
v_fmac_f32 v12, v190, v189
v_fmac_f32 v13, v234, v189
v_fmac_f32 v14, v191, v189
v_fmac_f32 v15, v235, v189
v_cvt_pk_bf16_f32 v1, v2, v3
v_cvt_pk_bf16_f32 v9, v10, v11
v_cvt_pk_bf16_f32 v2, v4, v5
v_cvt_pk_bf16_f32 v3, v6, v7
v_cvt_pk_bf16_f32 v10, v12, v13
v_cvt_pk_bf16_f32 v11, v14, v15
v_pk_max_i16 v0, v0, 0
v_pk_max_i16 v1, v1, 0
v_pk_max_i16 v2, v2, 0
v_pk_max_i16 v3, v3, 0
v_pk_max_i16 v8, v8, 0
v_pk_max_i16 v9, v9, 0
v_pk_max_i16 v10, v10, 0
v_pk_max_i16 v11, v11, 0
buffer_store_dwordx4 v[0:3], v245, s[20:23], s48 offen offset:0 nt
buffer_store_dwordx4 v[8:11], v245, s[20:23], s48 offen offset:64 nt
s_waitcnt lgkmcnt(1)
v_add_f32 v249, v249, v250
v_rcp_f32 v252, v249
s_nop 0
v_fmac_f32 v168, v228, v252
v_fmac_f32 v169, v229, v252
v_fmac_f32 v176, v220, v252
v_fmac_f32 v177, v221, v252
v_fmac_f32 v170, v230, v252
v_fmac_f32 v171, v231, v252
v_cvt_pk_bf16_f32 v168, v168, v169
v_fmac_f32 v178, v222, v252
v_fmac_f32 v179, v223, v252
v_cvt_pk_bf16_f32 v176, v176, v177
v_fmac_f32 v172, v192, v252
v_fmac_f32 v173, v193, v252
v_fmac_f32 v174, v194, v252
v_fmac_f32 v175, v195, v252
v_cvt_pk_bf16_f32 v169, v170, v171
v_fmac_f32 v180, v224, v252
v_fmac_f32 v181, v225, v252
v_fmac_f32 v182, v226, v252
v_fmac_f32 v183, v227, v252
v_cvt_pk_bf16_f32 v177, v178, v179
v_cvt_pk_bf16_f32 v170, v172, v173
v_cvt_pk_bf16_f32 v171, v174, v175
v_cvt_pk_bf16_f32 v178, v180, v181
v_cvt_pk_bf16_f32 v179, v182, v183
v_pk_max_i16 v168, v168, 0
v_pk_max_i16 v169, v169, 0
v_pk_max_i16 v170, v170, 0
v_pk_max_i16 v171, v171, 0
v_pk_max_i16 v176, v176, 0
v_pk_max_i16 v177, v177, 0
v_pk_max_i16 v178, v178, 0
v_pk_max_i16 v179, v179, 0
buffer_store_dwordx4 v[168:171], v239, s[20:23], s53 offen offset:0 nt
buffer_store_dwordx4 v[176:179], v239, s[20:23], s53 offen offset:64 nt
s_waitcnt lgkmcnt(0)
v_add_f32 v204, v204, v205
v_rcp_f32 v205, v204
s_nop 0
v_fmac_f32 v16, v206, v205
v_fmac_f32 v18, v207, v205
v_lshlrev_b32 v206, 16, v198
v_lshlrev_b32 v207, 16, v199
v_fmac_f32 v20, v206, v205
v_fmac_f32 v22, v207, v205
v_lshlrev_b32 v206, 16, v200
v_lshlrev_b32 v207, 16, v201
v_and_b32 v200, 0xffff0000, v200
v_fmac_f32 v24, v206, v205
v_fmac_f32 v26, v207, v205
v_fmac_f32 v17, v196, v205
v_fmac_f32 v25, v200, v205
v_and_b32 v201, 0xffff0000, v201
v_lshlrev_b32 v206, 16, v202
v_lshlrev_b32 v207, 16, v203
v_fmac_f32 v19, v197, v205
v_and_b32 v198, 0xffff0000, v198
v_and_b32 v199, 0xffff0000, v199
v_fmac_f32 v27, v201, v205
v_and_b32 v202, 0xffff0000, v202
v_and_b32 v203, 0xffff0000, v203
v_cvt_pk_bf16_f32 v16, v16, v17
v_cvt_pk_bf16_f32 v24, v24, v25
v_fmac_f32 v21, v198, v205
v_fmac_f32 v23, v199, v205
v_fmac_f32 v28, v206, v205
v_fmac_f32 v29, v202, v205
v_fmac_f32 v30, v207, v205
v_fmac_f32 v31, v203, v205
v_cvt_pk_bf16_f32 v17, v18, v19
v_cvt_pk_bf16_f32 v25, v26, v27
v_cvt_pk_bf16_f32 v18, v20, v21
v_cvt_pk_bf16_f32 v19, v22, v23
v_cvt_pk_bf16_f32 v26, v28, v29
v_cvt_pk_bf16_f32 v27, v30, v31
v_pk_max_i16 v16, v16, 0
v_pk_max_i16 v17, v17, 0
v_pk_max_i16 v18, v18, 0
v_pk_max_i16 v19, v19, 0
v_pk_max_i16 v24, v24, 0
v_pk_max_i16 v25, v25, 0
v_pk_max_i16 v26, v26, 0
v_pk_max_i16 v27, v27, 0
buffer_store_dwordx4 v[16:19], v245, s[20:23], s51 offen offset:0 nt
buffer_store_dwordx4 v[24:27], v245, s[20:23], s51 offen offset:64 nt
L_end:
s_endpgm
.section .rodata,"a"
.p2align 6
.amdhsa_kernel standalone__attention_interact_autoint__recsys_kernel
  .amdhsa_next_free_vgpr 512
  .amdhsa_next_free_sgpr 102
  .amdhsa_accum_offset 256
  .amdhsa_group_segment_fixed_size 0
  .amdhsa_kernarg_size 64
  .amdhsa_user_sgpr_count 2
  .amdhsa_user_sgpr_kernarg_segment_ptr 1
  .amdhsa_system_sgpr_workgroup_id_x 1
.end_amdhsa_kernel
```

```asm
; @launch grid=(256,1,1) block=(256,1,1) lds=163840
.amdgcn_target "amdgcn-amd-amdhsa--gfx950"
.text
.globl standalone__attention_interact_autoint__recsys_kernel
.p2align 8
.type standalone__attention_interact_autoint__recsys_kernel,@function
standalone__attention_interact_autoint__recsys_kernel:
s_cmp_ge_u32 s2, 256
s_cbranch_scc1 L_end
s_load_dwordx2 s[24:25], s[0:1], 8
s_load_dwordx2 s[16:17], s[0:1], 0
s_load_dwordx2 s[28:29], s[0:1], 16
s_load_dwordx2 s[32:33], s[0:1], 24
s_load_dwordx2 s[36:37], s[0:1], 32
s_load_dwordx2 s[20:21], s[0:1], 40
s_getpc_b64 s[58:59]
L_pc:
s_lshl_b32 s3, s2, 8
s_and_b32 s3, s3, 0x7800
v_lshrrev_b32 v2, 4, v0
v_lshl_add_u32 v2, v2, 7, s3
v_min_u32 v2, L_fast_end-L_pc-4, v2
global_load_dword v96, v2, s[58:59]
v_lshrrev_b32 v1, 6, v0
s_mov_b32 s19, 0x20000
v_readfirstlane_b32 s41, v1
s_mov_b32 s18, 104857600
s_mov_b32 s26, 32768
s_mov_b32 s27, s19
s_lshr_b32 s42, s41, 1
s_and_b32 s43, s41, 1
s_lshl1_add_u32 s44, s2, s42
s_mul_i32 s44, s44, 25600
s_mov_b64 s[30:31], s[26:27]
s_mov_b64 s[34:35], s[26:27]
s_mov_b64 s[38:39], s[26:27]
s_lshl_b32 s54, s41, 13
s_mul_i32 s49, s42, 25344
s_mul_i32 s53, s43, 1056
s_add_u32 s49, s49, s53
s_lshl_b32 s55, s43, 10
s_add_u32 s55, s55, s44
s_lshl_b32 s6, s2, 7
s_and_b32 s6, s6, 0x7c00
s_add_u32 s57, s54, 4096
s_add_u32 m0, s49, 21120
s_add_u32 s48, s55, 20480
v_and_b32 v168, 63, v0
v_lshlrev_b32 v175, 4, v168
v_and_b32 v243, 48, v175
v_and_b32 v169, 48, v168
v_lshl_add_u32 v243, v169, 2, v243
v_and_b32 v169, 12, v168
v_lshl_add_u32 v243, v169, 6, v243
v_lshrrev_b32 v169, 5, v0
v_lshlrev_b32 v169, 7, v169
s_waitcnt lgkmcnt(0)
buffer_load_dword v97, v169, s[24:27], s6 offen
buffer_load_dword v98, v169, s[28:31], s6 offen
buffer_load_dword v99, v169, s[32:35], s6 offen
buffer_load_dword v100, v169, s[36:39], s6 offen
buffer_load_dwordx4 v[104:107], v175, s[24:27], s54 offen offset:0
buffer_load_dwordx4 v[108:111], v175, s[24:27], s54 offen offset:1024
buffer_load_dwordx4 v[112:115], v175, s[24:27], s54 offen offset:2048
buffer_load_dwordx4 v[116:119], v175, s[24:27], s54 offen offset:3072
buffer_load_dwordx4 v[120:123], v175, s[24:27], s57 offen offset:0
buffer_load_dwordx4 v[124:127], v175, s[24:27], s57 offen offset:1024
buffer_load_dwordx4 v[128:131], v175, s[24:27], s57 offen offset:2048
buffer_load_dwordx4 v[132:135], v175, s[24:27], s57 offen offset:3072
buffer_load_dwordx4 v243, s[16:19], s48 offen nt lds
s_add_u32 m0, s49, 23232
s_add_u32 s48, s55, 22528
buffer_load_dwordx4 v243, s[16:19], s48 offen nt lds
s_add_u32 m0, s49, 0
s_add_u32 s48, s55, 0
buffer_load_dwordx4 v243, s[16:19], s48 offen nt lds
s_add_u32 m0, s49, 2112
s_add_u32 s48, s55, 2048
buffer_load_dwordx4 v243, s[16:19], s48 offen nt lds
s_mov_b32 s40, 0x3e38aa3b
s_mov_b32 s22, s18
s_mov_b32 s23, s19
s_mov_b32 s45, 8
s_mov_b32 s3, 64
s_mov_b32 s46, s44
s_mov_b32 s47, 0x7ff00000
s_mov_b32 s56, 50688
s_mov_b32 s96, 0x3b8265d9
s_mov_b32 s97, 0
s_mul_i32 s98, s42, 25344
s_lshl_b32 s53, s43, 13
s_add_u32 s98, s98, s53
s_add_u32 s53, s98, 4224
s_add_u32 m0, s98, 102400
v_and_b32 v169, 16, v168
v_lshlrev_b32 v180, 2, v169
v_lshlrev_b32 v169, 1, v169
v_xor_b32 v170, v175, v169
v_add_u32 v172, s53, v170
v_xor_b32 v171, 64, v170
v_add_u32 v173, s53, v171
s_mul_i32 s4, s43, 13107200
s_add_u32 s4, s4, s44
s_add_u32 s4, s4, 24576
s_mul_i32 s5, s43, -52424704
s_add_u32 s5, s5, 104833024
s_add_u32 s99, s4, 0
s_add_u32 s100, s4, 26212288
s_mul_i32 s53, s43, 25344
s_add_u32 s7, s53, 4224
v_lshrrev_b32 v82, 4, v168
v_lshl_add_u32 v176, v82, 10, s7
v_bfe_u32 v83, v168, 2, 2
v_lshl_add_u32 v176, v83, 7, v176
v_bfe_u32 v84, v168, 3, 1
v_lshl_add_u32 v176, v84, 5, v176
v_bfe_u32 v85, v168, 4, 1
v_lshl_add_u32 v176, v85, 6, v176
v_and_b32 v86, 3, v168
v_lshl_add_u32 v176, v86, 3, v176
v_xor_b32 v177, 32, v176
v_xor_b32 v178, 64, v176
s_mul_i32 s53, s42, 25344
v_lshl_add_u32 v242, v86, 6, s53
v_lshl_add_u32 v242, v82, 4, v242
s_mov_b32 s6, 1056
v_mad_u32_u24 v242, v83, s6, v242
s_waitcnt vmcnt(11)
v_and_b32 v160, 0xffff0000, v104
v_and_b32 v161, 0xffff0000, v105
v_and_b32 v162, 0xffff0000, v106
v_and_b32 v163, 0xffff0000, v107
v_lshlrev_b32 v104, 16, v104
v_lshlrev_b32 v105, 16, v105
v_lshlrev_b32 v106, 16, v106
v_lshlrev_b32 v107, 16, v107
v_mul_f32 v160, s40, v160
v_mul_f32 v104, s40, v104
v_mul_f32 v161, s40, v161
v_mul_f32 v105, s40, v105
v_mul_f32 v162, s40, v162
v_mul_f32 v106, s40, v106
v_mul_f32 v163, s40, v163
v_mul_f32 v107, s40, v107
v_cvt_pk_bf16_f32 v104, v104, v160
v_cvt_pk_bf16_f32 v105, v105, v161
v_cvt_pk_bf16_f32 v106, v106, v162
v_cvt_pk_bf16_f32 v107, v107, v163
ds_write_b128 v172, v[104:107] offset:0
buffer_load_dwordx4 v170, s[28:31], s54 offen offset:0 lds
buffer_load_dwordx4 v171, s[28:31], s54 offen offset:1024 lds
buffer_load_dwordx4 v170, s[28:31], s54 offen offset:2048 lds
buffer_load_dwordx4 v171, s[28:31], s54 offen offset:3072 lds
s_add_u32 m0, s98, 106496
s_waitcnt vmcnt(14)
v_and_b32 v160, 0xffff0000, v108
v_and_b32 v161, 0xffff0000, v109
v_and_b32 v162, 0xffff0000, v110
v_and_b32 v163, 0xffff0000, v111
v_lshlrev_b32 v108, 16, v108
v_lshlrev_b32 v109, 16, v109
v_lshlrev_b32 v110, 16, v110
v_lshlrev_b32 v111, 16, v111
v_mul_f32 v160, s40, v160
v_mul_f32 v108, s40, v108
v_mul_f32 v161, s40, v161
v_mul_f32 v109, s40, v109
v_mul_f32 v162, s40, v162
v_mul_f32 v110, s40, v110
v_mul_f32 v163, s40, v163
v_mul_f32 v111, s40, v111
v_cvt_pk_bf16_f32 v108, v108, v160
v_cvt_pk_bf16_f32 v109, v109, v161
v_cvt_pk_bf16_f32 v110, v110, v162
v_cvt_pk_bf16_f32 v111, v111, v163
ds_write_b128 v173, v[108:111] offset:1024
buffer_load_dwordx4 v170, s[28:31], s57 offen offset:0 lds
buffer_load_dwordx4 v171, s[28:31], s57 offen offset:1024 lds
buffer_load_dwordx4 v170, s[28:31], s57 offen offset:2048 lds
buffer_load_dwordx4 v171, s[28:31], s57 offen offset:3072 lds
s_add_u32 m0, s49, 50688
s_waitcnt vmcnt(17)
v_and_b32 v160, 0xffff0000, v112
v_and_b32 v161, 0xffff0000, v113
v_and_b32 v162, 0xffff0000, v114
v_and_b32 v163, 0xffff0000, v115
v_lshlrev_b32 v112, 16, v112
v_lshlrev_b32 v113, 16, v113
v_lshlrev_b32 v114, 16, v114
v_lshlrev_b32 v115, 16, v115
v_mul_f32 v160, s40, v160
v_mul_f32 v112, s40, v112
v_mul_f32 v161, s40, v161
v_mul_f32 v113, s40, v113
v_mul_f32 v162, s40, v162
v_mul_f32 v114, s40, v114
v_mul_f32 v163, s40, v163
v_mul_f32 v115, s40, v115
v_cvt_pk_bf16_f32 v112, v112, v160
v_cvt_pk_bf16_f32 v113, v113, v161
v_cvt_pk_bf16_f32 v114, v114, v162
v_cvt_pk_bf16_f32 v115, v115, v163
ds_write_b128 v172, v[112:115] offset:2048
s_waitcnt vmcnt(16)
v_and_b32 v160, 0xffff0000, v116
v_and_b32 v161, 0xffff0000, v117
v_and_b32 v162, 0xffff0000, v118
v_and_b32 v163, 0xffff0000, v119
v_lshlrev_b32 v116, 16, v116
v_lshlrev_b32 v117, 16, v117
v_lshlrev_b32 v118, 16, v118
v_lshlrev_b32 v119, 16, v119
v_mul_f32 v160, s40, v160
v_mul_f32 v116, s40, v116
v_mul_f32 v161, s40, v161
v_mul_f32 v117, s40, v117
v_mul_f32 v162, s40, v162
v_mul_f32 v118, s40, v118
v_mul_f32 v163, s40, v163
v_mul_f32 v119, s40, v119
v_cvt_pk_bf16_f32 v116, v116, v160
v_cvt_pk_bf16_f32 v117, v117, v161
v_cvt_pk_bf16_f32 v118, v118, v162
v_cvt_pk_bf16_f32 v119, v119, v163
ds_write_b128 v173, v[116:119] offset:3072
s_waitcnt vmcnt(15)
v_and_b32 v160, 0xffff0000, v120
v_and_b32 v161, 0xffff0000, v121
v_and_b32 v162, 0xffff0000, v122
v_and_b32 v163, 0xffff0000, v123
v_lshlrev_b32 v120, 16, v120
v_lshlrev_b32 v121, 16, v121
v_lshlrev_b32 v122, 16, v122
v_lshlrev_b32 v123, 16, v123
v_mul_f32 v160, s40, v160
v_mul_f32 v120, s40, v120
v_mul_f32 v161, s40, v161
v_mul_f32 v121, s40, v121
v_mul_f32 v162, s40, v162
v_mul_f32 v122, s40, v122
v_mul_f32 v163, s40, v163
v_mul_f32 v123, s40, v123
v_cvt_pk_bf16_f32 v120, v120, v160
v_cvt_pk_bf16_f32 v121, v121, v161
v_cvt_pk_bf16_f32 v122, v122, v162
v_cvt_pk_bf16_f32 v123, v123, v163
ds_write_b128 v172, v[120:123] offset:4096
s_waitcnt vmcnt(14)
v_and_b32 v160, 0xffff0000, v124
v_and_b32 v161, 0xffff0000, v125
v_and_b32 v162, 0xffff0000, v126
v_and_b32 v163, 0xffff0000, v127
v_lshlrev_b32 v124, 16, v124
v_lshlrev_b32 v125, 16, v125
v_lshlrev_b32 v126, 16, v126
v_lshlrev_b32 v127, 16, v127
v_mul_f32 v160, s40, v160
v_mul_f32 v124, s40, v124
v_mul_f32 v161, s40, v161
v_mul_f32 v125, s40, v125
v_mul_f32 v162, s40, v162
v_mul_f32 v126, s40, v126
v_mul_f32 v163, s40, v163
v_mul_f32 v127, s40, v127
v_cvt_pk_bf16_f32 v124, v124, v160
v_cvt_pk_bf16_f32 v125, v125, v161
v_cvt_pk_bf16_f32 v126, v126, v162
v_cvt_pk_bf16_f32 v127, v127, v163
ds_write_b128 v173, v[124:127] offset:5120
s_waitcnt vmcnt(13)
v_and_b32 v160, 0xffff0000, v128
v_and_b32 v161, 0xffff0000, v129
v_and_b32 v162, 0xffff0000, v130
v_and_b32 v163, 0xffff0000, v131
v_lshlrev_b32 v128, 16, v128
v_lshlrev_b32 v129, 16, v129
v_lshlrev_b32 v130, 16, v130
v_lshlrev_b32 v131, 16, v131
v_mul_f32 v160, s40, v160
v_mul_f32 v128, s40, v128
v_mul_f32 v161, s40, v161
v_mul_f32 v129, s40, v129
v_mul_f32 v162, s40, v162
v_mul_f32 v130, s40, v130
v_mul_f32 v163, s40, v163
v_mul_f32 v131, s40, v131
v_cvt_pk_bf16_f32 v128, v128, v160
v_cvt_pk_bf16_f32 v129, v129, v161
v_cvt_pk_bf16_f32 v130, v130, v162
v_cvt_pk_bf16_f32 v131, v131, v163
ds_write_b128 v172, v[128:131] offset:6144
s_waitcnt vmcnt(12)
v_and_b32 v160, 0xffff0000, v132
v_and_b32 v161, 0xffff0000, v133
v_and_b32 v162, 0xffff0000, v134
v_and_b32 v163, 0xffff0000, v135
v_lshlrev_b32 v132, 16, v132
v_lshlrev_b32 v133, 16, v133
v_lshlrev_b32 v134, 16, v134
v_lshlrev_b32 v135, 16, v135
v_mul_f32 v160, s40, v160
v_mul_f32 v132, s40, v132
v_mul_f32 v161, s40, v161
v_mul_f32 v133, s40, v133
v_mul_f32 v162, s40, v162
v_mul_f32 v134, s40, v134
v_mul_f32 v163, s40, v163
v_mul_f32 v135, s40, v135
v_cvt_pk_bf16_f32 v132, v132, v160
v_cvt_pk_bf16_f32 v133, v133, v161
v_cvt_pk_bf16_f32 v134, v134, v162
v_cvt_pk_bf16_f32 v135, v135, v163
ds_write_b128 v173, v[132:135] offset:7168
buffer_load_dwordx4 v243, s[16:19], s99 offen offset:0 nt lds
buffer_load_dwordx4 v243, s[16:19], s100 offen offset:2112 nt lds
s_add_u32 m0, s49, 54912
s_add_u32 s99, s4, 52428800
buffer_load_dwordx4 v243, s[16:19], s99 offen offset:0 nt lds
s_add_u32 s100, s4, 78641088
buffer_load_dwordx4 v243, s[16:19], s100 offen offset:2112 nt lds
s_add_u32 m0, s98, 59648
s_add_u32 s99, s55, 4096
s_add_u32 s100, s55, 4032
s_waitcnt vmcnt(12) lgkmcnt(0)
s_barrier
ds_read_b64_tr_b16 a[4:5], v176 offset:4096
ds_read_b128 v[224:227], v242 offset:21376
ds_read_b64_tr_b16 a[6:7], v176 offset:4608
ds_read_b128 v[220:223], v242 offset:21632
ds_read_b64_tr_b16 a[8:9], v176 offset:8192
ds_read_b128 v[232:235], v242 offset:21888
ds_read_b64_tr_b16 a[10:11], v176 offset:8704
ds_read_b128 v[228:231], v242 offset:21120
ds_read_b64_tr_b16 a[12:13], v176 offset:12288
ds_read_b128 v[188:191], v242 offset:0
ds_read_b64_tr_b16 a[14:15], v176 offset:12800
ds_read_b128 v[192:195], v242 offset:256
ds_read_b64_tr_b16 a[0:1], v176 offset:0
ds_read_b128 v[196:199], v242 offset:512
ds_read_b64_tr_b16 a[2:3], v176 offset:512
ds_read_b128 v[200:203], v242 offset:768
ds_read_b64_tr_b16 a[16:17], v177 offset:0
ds_read_b64_tr_b16 a[18:19], v177 offset:512
ds_read_b64_tr_b16 a[20:21], v177 offset:4096
ds_read_b64_tr_b16 a[22:23], v177 offset:4608
ds_read_b64_tr_b16 a[24:25], v177 offset:8192
ds_read_b64_tr_b16 a[26:27], v177 offset:8704
ds_read_b64_tr_b16 a[28:29], v177 offset:12288
ds_read_b64_tr_b16 a[30:31], v177 offset:12800
ds_read_b64_tr_b16 a[32:33], v178 offset:0
ds_read_b64_tr_b16 a[34:35], v178 offset:512
ds_read_b64_tr_b16 a[36:37], v178 offset:4096
ds_read_b64_tr_b16 a[38:39], v178 offset:4608
s_waitcnt lgkmcnt(15)
v_mfma_f32_16x16x32_bf16 v[204:207], a[4:7], v[224:227], 0
s_mov_b32 s51, -32
ds_read_b64_tr_b16 a[40:41], v178 offset:8192
v_xor_b32 v179, 96, v176
v_mfma_f32_16x16x32_bf16 v[204:207], a[8:11], v[220:223], v[204:207]
s_waitcnt lgkmcnt(14)
ds_read_b64_tr_b16 a[42:43], v178 offset:8704
v_add_u32 v176, 98176, v176
v_mfma_f32_16x16x32_bf16 v[204:207], a[12:15], v[232:235], v[204:207]
ds_read_b64_tr_b16 a[44:45], v178 offset:12288
v_lshrrev_b32 v80, 3, v168
v_mfma_f32_16x16x32_bf16 v[204:207], a[0:3], v[228:231], v[204:207]
ds_read_b64_tr_b16 a[46:47], v178 offset:12800
v_lshlrev_b32 v174, 8, v80
v_mfma_f32_16x16x32_bf16 v[208:211], a[0:3], v[188:191], 0
ds_read_b64_tr_b16 a[48:49], v179 offset:0
v_and_b32 v81, 7, v168
v_mfma_f32_16x16x32_bf16 v[208:211], a[4:7], v[192:195], v[208:211]
s_waitcnt lgkmcnt(15)
ds_read_b64_tr_b16 a[50:51], v179 offset:512
v_cvt_pk_bf16_f32 v152, v204, v205
v_mfma_f32_16x16x32_bf16 v[208:211], a[8:11], v[196:199], v[208:211]
s_waitcnt lgkmcnt(10)
ds_read_b64_tr_b16 a[52:53], v179 offset:4096
v_cvt_pk_bf16_f32 v153, v206, v207
v_mfma_f32_16x16x32_bf16 v[208:211], a[12:15], v[200:203], v[208:211]
ds_read_b64_tr_b16 a[54:55], v179 offset:4608
v_lshl_add_u32 v174, v81, 4, v174
v_mfma_f32_16x16x32_bf16 v[212:215], a[28:31], v[200:203], 0
ds_read_b64_tr_b16 a[56:57], v179 offset:8192
v_add_u32 v177, 98176, v177
v_mfma_f32_16x16x32_bf16 v[212:215], a[24:27], v[196:199], v[212:215]
ds_read_b64_tr_b16 a[58:59], v179 offset:8704
v_xor_b32 v174, v174, v180
v_mfma_f32_16x16x32_bf16 v[212:215], a[20:23], v[192:195], v[212:215]
ds_read_b64_tr_b16 a[60:61], v179 offset:12288
v_cvt_pk_bf16_f32 v96, v208, v209
v_mfma_f32_16x16x32_bf16 v[212:215], a[16:19], v[188:191], v[212:215]
s_waitcnt lgkmcnt(13)
ds_read_b64_tr_b16 a[62:63], v179 offset:12800
v_cvt_pk_bf16_f32 v97, v210, v211
v_mfma_f32_16x16x32_bf16 v[204:207], a[16:19], v[228:231], 0
s_waitcnt vmcnt(4)
s_barrier
v_mfma_f32_16x16x32_bf16 v[204:207], a[28:31], v[232:235], v[204:207]
s_waitcnt lgkmcnt(10)
ds_read_b64_tr_b16 a[64:65], v176 offset:0
v_xor_b32 v180, v175, v180
v_mfma_f32_16x16x32_bf16 v[204:207], a[24:27], v[220:223], v[204:207]
s_waitcnt lgkmcnt(10)
ds_read_b64_tr_b16 a[66:67], v176 offset:512
v_add_u32 v178, 98176, v178
v_mfma_f32_16x16x32_bf16 v[204:207], a[20:23], v[224:227], v[204:207]
s_waitcnt lgkmcnt(10)
ds_read_b64_tr_b16 a[68:69], v176 offset:4096
v_add_u32 v179, 98176, v179
v_mfma_f32_16x16x32_bf16 v[208:211], a[36:39], v[224:227], 0
s_waitcnt lgkmcnt(10)
ds_read_b64_tr_b16 a[70:71], v176 offset:4608
v_and_b32 v88, 1, v168
v_mfma_f32_16x16x32_bf16 v[208:211], a[40:43], v[220:223], v[208:211]
s_waitcnt lgkmcnt(10)
ds_read_b64_tr_b16 a[72:73], v176 offset:8192
v_cvt_pk_bf16_f32 v154, v204, v205
v_mfma_f32_16x16x32_bf16 v[208:211], a[44:47], v[232:235], v[208:211]
s_waitcnt lgkmcnt(10)
ds_read_b64_tr_b16 a[74:75], v176 offset:8704
v_cvt_pk_bf16_f32 v155, v206, v207
v_mfma_f32_16x16x32_bf16 v[208:211], a[32:35], v[228:231], v[208:211]
s_waitcnt lgkmcnt(10)
ds_read_b64_tr_b16 a[76:77], v176 offset:12288
v_mov_b32 v236, 0
v_mfma_f32_16x16x32_bf16 v[204:207], a[32:35], v[188:191], 0
s_waitcnt lgkmcnt(10)
ds_read_b64_tr_b16 a[78:79], v176 offset:12800
v_cvt_pk_bf16_f32 v98, v212, v213
v_mfma_f32_16x16x32_bf16 v[204:207], a[36:39], v[192:195], v[204:207]
s_waitcnt lgkmcnt(10)
ds_read_b64_tr_b16 a[80:81], v177 offset:0
v_cvt_pk_bf16_f32 v156, v208, v209
v_mfma_f32_16x16x32_bf16 v[204:207], a[40:43], v[196:199], v[204:207]
s_waitcnt lgkmcnt(9)
ds_read_b64_tr_b16 a[82:83], v177 offset:512
v_cvt_pk_bf16_f32 v157, v210, v211
v_mfma_f32_16x16x32_bf16 v[204:207], a[44:47], v[200:203], v[204:207]
buffer_load_dwordx4 v180, s[32:35], s54 offen offset:0 lds
v_mfma_f32_16x16x32_bf16 v[208:211], a[60:63], v[200:203], 0
buffer_load_dwordx4 v180, s[32:35], s54 offen offset:1024 lds
v_mfma_f32_16x16x32_bf16 v[208:211], a[52:55], v[192:195], v[208:211]
ds_read_b64_tr_b16 a[84:85], v177 offset:4096
v_cvt_pk_bf16_f32 v99, v214, v215
v_mfma_f32_16x16x32_bf16 v[208:211], a[48:51], v[188:191], v[208:211]
s_waitcnt lgkmcnt(10)
ds_read_b64_tr_b16 a[86:87], v177 offset:4608
v_cvt_pk_bf16_f32 v100, v204, v205
v_mfma_f32_16x16x32_bf16 v[208:211], a[56:59], v[196:199], v[208:211]
s_waitcnt lgkmcnt(10)
ds_read_b64_tr_b16 a[88:89], v177 offset:8192
v_cvt_pk_bf16_f32 v101, v206, v207
v_mfma_f32_16x16x32_bf16 v[204:207], a[56:59], v[220:223], 0
s_waitcnt lgkmcnt(10)
ds_read_b64_tr_b16 a[90:91], v177 offset:8704
v_lshrrev_b32 v91, 5, v168
v_mfma_f32_16x16x32_bf16 v[204:207], a[60:63], v[232:235], v[204:207]
s_waitcnt lgkmcnt(10)
ds_read_b64_tr_b16 a[92:93], v177 offset:12288
v_cvt_pk_bf16_f32 v102, v208, v209
v_mfma_f32_16x16x32_bf16 v[204:207], a[52:55], v[224:227], v[204:207]
s_waitcnt lgkmcnt(10)
ds_read_b64_tr_b16 a[94:95], v177 offset:12800
v_cvt_pk_bf16_f32 v103, v210, v211
v_mfma_f32_16x16x32_bf16 v[204:207], a[48:51], v[228:231], v[204:207]
s_waitcnt lgkmcnt(10)
ds_read_b64_tr_b16 a[96:97], v178 offset:0
v_lshlrev_b32 v16, 4, v86
v_mfma_f32_16x16x32_bf16 v[208:211], a[64:67], v[228:231], 0
s_waitcnt lgkmcnt(10)
ds_read_b64_tr_b16 a[98:99], v178 offset:512
v_bfe_u32 v87, v168, 1, 1
v_mfma_f32_16x16x32_bf16 v[208:211], a[68:71], v[224:227], v[208:211]
s_waitcnt lgkmcnt(10)
ds_read_b64_tr_b16 a[100:101], v178 offset:4096
v_cvt_pk_bf16_f32 v158, v204, v205
v_mfma_f32_16x16x32_bf16 v[208:211], a[72:75], v[220:223], v[208:211]
s_waitcnt lgkmcnt(10)
ds_read_b64_tr_b16 a[102:103], v178 offset:4608
v_cvt_pk_bf16_f32 v159, v206, v207
v_mfma_f32_16x16x32_bf16 v[208:211], a[76:79], v[232:235], v[208:211]
s_waitcnt lgkmcnt(10)
ds_read_b64_tr_b16 a[104:105], v178 offset:8192
v_lshlrev_b32 v92, 5, v84
v_mfma_f32_16x16x32_bf16 v[204:207], a[76:79], v[200:203], 0
buffer_load_dwordx4 v180, s[32:35], s54 offen offset:2048 lds
v_mfma_f32_16x16x32_bf16 v[204:207], a[64:67], v[188:191], v[204:207]
buffer_load_dwordx4 v180, s[32:35], s54 offen offset:3072 lds
v_mfma_f32_16x16x32_bf16 v[204:207], a[68:71], v[192:195], v[204:207]
s_waitcnt lgkmcnt(7)
ds_read_b64_tr_b16 a[106:107], v178 offset:8704
s_add_u32 m0, s98, 63744
v_mfma_f32_16x16x32_bf16 v[204:207], a[72:75], v[196:199], v[204:207]
ds_read_b64_tr_b16 a[108:109], v178 offset:12288
v_cvt_pk_bf16_f32 v40, v208, v209
v_cvt_pk_bf16_f32 v41, v210, v211
v_mfma_f32_16x16x32_bf16 v[208:211], a[88:91], v[196:199], 0
ds_read_b64_tr_b16 a[110:111], v178 offset:12800
v_lshlrev_b32 v93, 4, v87
v_mfma_f32_16x16x32_bf16 v[208:211], a[84:87], v[192:195], v[208:211]
s_waitcnt lgkmcnt(8)
ds_read_b64_tr_b16 a[112:113], v179 offset:0
v_cvt_pk_bf16_f32 v0, v204, v205
v_mfma_f32_16x16x32_bf16 v[208:211], a[80:83], v[188:191], v[208:211]
ds_read_b64_tr_b16 a[114:115], v179 offset:512
v_cvt_pk_bf16_f32 v1, v206, v207
v_mfma_f32_16x16x32_bf16 v[208:211], a[92:95], v[200:203], v[208:211]
ds_read_b64_tr_b16 a[116:117], v179 offset:4096
v_lshlrev_b32 v94, 4, v83
v_mfma_f32_16x16x32_bf16 v[204:207], a[92:95], v[232:235], 0
s_waitcnt lgkmcnt(10)
ds_read_b64_tr_b16 a[118:119], v179 offset:4608
v_and_b32 v95, 15, v168
v_mfma_f32_16x16x32_bf16 v[204:207], a[88:91], v[220:223], v[204:207]
s_waitcnt lgkmcnt(10)
ds_read_b64_tr_b16 a[120:121], v179 offset:8192
v_cvt_pk_bf16_f32 v2, v208, v209
v_mfma_f32_16x16x32_bf16 v[204:207], a[84:87], v[224:227], v[204:207]
s_waitcnt lgkmcnt(10)
ds_read_b64_tr_b16 a[122:123], v179 offset:8704
v_cvt_pk_bf16_f32 v3, v210, v211
v_mfma_f32_16x16x32_bf16 v[204:207], a[80:83], v[228:231], v[204:207]
s_waitcnt lgkmcnt(10)
ds_read_b64_tr_b16 a[124:125], v179 offset:12288
v_mov_b32 v169, 163024
v_mfma_f32_16x16x32_bf16 v[208:211], a[96:99], v[228:231], 0
s_waitcnt lgkmcnt(9)
ds_read_b64_tr_b16 a[126:127], v179 offset:12800
v_mov_b32 v184, 0
v_mfma_f32_16x16x32_bf16 v[208:211], a[100:103], v[224:227], v[208:211]
s_waitcnt lgkmcnt(8)
buffer_load_dwordx4 v180, s[32:35], s57 offen offset:0 lds
v_mfma_f32_16x16x32_bf16 v[208:211], a[104:107], v[220:223], v[208:211]
buffer_load_dwordx4 v180, s[32:35], s57 offen offset:1024 lds
v_mfma_f32_16x16x32_bf16 v[208:211], a[108:111], v[232:235], v[208:211]
v_cvt_pk_bf16_f32 v42, v204, v205
v_cvt_pk_bf16_f32 v43, v206, v207
v_mfma_f32_16x16x32_bf16 v[204:207], a[108:111], v[200:203], 0
s_mul_i32 s53, s41, 816
s_add_u32 s53, s53, 157696
v_lshl_add_u32 v249, v83, 6, s53
v_mfma_f32_16x16x32_bf16 v[204:207], a[96:99], v[188:191], v[204:207]
s_add_u32 s8, s53, 256
v_cvt_pk_bf16_f32 v44, v208, v209
v_cvt_pk_bf16_f32 v45, v210, v211
v_mfma_f32_16x16x32_bf16 v[204:207], a[100:103], v[192:195], v[204:207]
s_waitcnt lgkmcnt(2)
v_lshl_add_u32 v249, v88, 5, v249
v_lshl_add_u32 v249, v85, 4, v249
v_mfma_f32_16x16x32_bf16 v[204:207], a[104:107], v[196:199], v[204:207]
s_add_u32 s9, s53, 256
s_mov_b32 vcc_lo, 0x33333333
s_mov_b32 vcc_hi, 0xcccccccc
v_mfma_f32_16x16x32_bf16 v[208:211], a[120:123], v[196:199], 0
v_mov_b32 v166, s8
v_cndmask_b32 v249, v166, v249, vcc
v_mfma_f32_16x16x32_bf16 v[208:211], a[116:119], v[192:195], v[208:211]
s_waitcnt lgkmcnt(0)
v_cvt_pk_bf16_f32 v4, v204, v205
v_cvt_pk_bf16_f32 v5, v206, v207
v_mfma_f32_16x16x32_bf16 v[208:211], a[112:115], v[188:191], v[208:211]
s_mov_b32 s8, 272
v_lshl_add_u32 v166, v83, 2, s9
v_lshl_add_u32 v248, v82, 6, s53
v_mfma_f32_16x16x32_bf16 v[208:211], a[124:127], v[200:203], v[208:211]
s_lshl_b32 s53, s41, 8
v_mad_u32_u24 v166, v86, s8, v166
v_mov_b32 v251, 0x44444444
v_mfma_f32_16x16x32_bf16 v[188:191], a[124:127], v[232:235], 0
s_add_u32 s10, s53, 101376
ds_write_b32 v166, v236 offset:0
v_mfma_f32_16x16x32_bf16 v[188:191], a[120:123], v[220:223], v[188:191]
s_nop 0
v_cvt_pk_bf16_f32 v6, v208, v209
v_cvt_pk_bf16_f32 v7, v210, v211
v_mfma_f32_16x16x32_bf16 v[188:191], a[116:119], v[224:227], v[188:191]
buffer_load_dwordx4 v180, s[32:35], s57 offen offset:2048 lds
v_mfma_f32_16x16x32_bf16 v[188:191], a[112:115], v[228:231], v[188:191]
buffer_load_dwordx4 v180, s[32:35], s57 offen offset:3072 lds
v_mfma_f32_16x16x32_bf16 v[192:195], v[4:7], v[156:159], 0
s_add_u32 m0, s49, 4224
v_lshl_add_u32 v166, v168, 2, s10
v_bfe_u32 v89, v168, 3, 2
v_mfma_f32_16x16x32_bf16 v[192:195], v[0:3], v[152:155], v[192:195]
ds_write_b32 v166, v166 offset:0
v_mfma_f32_16x16x32_bf16 v[196:199], v[40:43], v[152:155], 0
v_cvt_pk_bf16_f32 v46, v188, v189
v_cvt_pk_bf16_f32 v47, v190, v191
s_mul_i32 s52, s41, 13824
s_add_u32 s52, s52, 102400
v_mfma_f32_16x16x32_bf16 v[196:199], v[44:47], v[156:159], v[196:199]
s_add_u32 s14, s52, 1072
v_lshl_add_u32 v164, v86, 7, s52
v_mov_b32 v166, s14
v_mfma_f32_16x16x32_bf16 v[188:191], v[44:47], v[100:103], 0
s_mov_b32 s14, 1728
v_lshl_add_u32 v164, v91, 4, v164
v_lshl_add_u32 v164, v85, 3, v164
v_mfma_f32_16x16x32_bf16 v[188:191], v[40:43], v[96:99], v[188:191]
s_add_u32 s13, s52, 512
v_mad_u32_u24 v164, v83, s14, v164
v_xor_b32 v164, v16, v164
v_mfma_f32_16x16x32_bf16 v[200:203], v[0:3], v[96:99], 0
s_waitcnt vmcnt(8) lgkmcnt(0)
s_barrier
v_mfma_f32_16x16x32_bf16 v[200:203], v[4:7], v[100:103], v[200:203]
s_add_u32 s12, s52, 1136
ds_read_b128 v[48:51], v242 offset:50688
ds_read_b128 v[52:55], v242 offset:50944
ds_read_b128 v[56:59], v242 offset:51200
ds_read_b128 v[60:63], v242 offset:51456
ds_read_b128 v[64:67], v242 offset:54912
ds_read_b128 v[68:71], v242 offset:55168
ds_read_b128 v[72:75], v242 offset:55424
ds_read_b128 v[76:79], v242 offset:55680
v_xor_b32 v165, 32, v164
v_exp_f32 v188, v188
v_exp_f32 v189, v189
v_exp_f32 v190, v190
v_exp_f32 v191, v191
v_lshl_add_u32 v245, v84, 8, s52
v_lshl_add_u32 v245, v87, 7, v245
v_lshl_add_u32 v245, v88, 6, v245
v_cvt_pk_bf16_f32 v130, v188, v189
s_waitcnt lgkmcnt(7)
v_mfma_f32_16x16x32_bf16 v[204:207], a[64:67], v[48:51], 0
s_waitcnt lgkmcnt(5)
buffer_load_dwordx4 v243, s[16:19], s99 offen offset:0 nt lds
v_mfma_f32_16x16x32_bf16 v[204:207], a[68:71], v[52:55], v[204:207]
s_waitcnt lgkmcnt(4)
buffer_load_dwordx4 v243, s[16:19], s100 offen offset:2112 nt lds
v_mfma_f32_16x16x32_bf16 v[204:207], a[72:75], v[56:59], v[204:207]
s_add_u32 m0, s49, 8448
s_add_u32 s99, s55, 8192
s_add_u32 s100, s55, 8128
v_mfma_f32_16x16x32_bf16 v[204:207], a[76:79], v[60:63], v[204:207]
s_add_u32 s7, s52, 1136
v_cvt_pk_bf16_f32 v131, v190, v191
v_lshl_add_u32 v245, v82, 4, v245
v_mfma_f32_16x16x32_bf16 v[208:211], a[92:95], v[60:63], 0
s_add_u32 s15, s52, 1072
v_xor_b32 v245, v92, v245
v_xor_b32 v245, v93, v245
v_mfma_f32_16x16x32_bf16 v[208:211], a[88:91], v[56:59], v[208:211]
v_cvt_pk_bf16_f32 v136, v204, v205
v_cvt_pk_bf16_f32 v138, v206, v207
v_mfma_f32_16x16x32_bf16 v[208:211], a[84:87], v[52:55], v[208:211]
ds_write_b32 v164, v136 offset:0
v_mfma_f32_16x16x32_bf16 v[208:211], a[80:83], v[48:51], v[208:211]
buffer_load_dwordx4 v243, s[16:19], s99 offen offset:0 nt lds
v_mfma_f32_16x16x32_bf16 v[204:207], a[96:99], v[48:51], 0
s_add_u32 s99, s55, 12288
buffer_load_dwordx4 v243, s[16:19], s100 offen offset:2112 nt lds
v_mfma_f32_16x16x32_bf16 v[204:207], a[100:103], v[52:55], v[204:207]
s_add_u32 m0, s49, 12672
s_add_u32 s100, s55, 12224
v_lshl_add_u32 v247, v83, 7, s13
v_mfma_f32_16x16x32_bf16 v[204:207], a[104:107], v[56:59], v[204:207]
s_waitcnt lgkmcnt(1)
v_cvt_pk_bf16_f32 v137, v208, v209
v_cvt_pk_bf16_f32 v139, v210, v211
v_mfma_f32_16x16x32_bf16 v[204:207], a[108:111], v[60:63], v[204:207]
ds_write_b32 v164, v137 offset:4
v_mfma_f32_16x16x32_bf16 v[212:215], a[124:127], v[60:63], 0
ds_write_b32 v164, v138 offset:64
v_mfma_f32_16x16x32_bf16 v[212:215], a[116:119], v[52:55], v[212:215]
ds_write_b32 v164, v139 offset:68
v_mfma_f32_16x16x32_bf16 v[212:215], a[112:115], v[48:51], v[212:215]
buffer_load_dwordx4 v243, s[16:19], s99 offen offset:0 nt lds
v_mfma_f32_16x16x32_bf16 v[212:215], a[120:123], v[56:59], v[212:215]
s_add_u32 s99, s55, 16384
buffer_load_dwordx4 v243, s[16:19], s100 offen offset:2112 nt lds
v_mfma_f32_16x16x32_bf16 v[208:211], a[56:59], v[56:59], 0
s_add_u32 m0, s49, 16896
s_add_u32 s100, s55, 16320
v_cvt_pk_bf16_f32 v140, v204, v205
v_mfma_f32_16x16x32_bf16 v[208:211], a[60:63], v[60:63], v[208:211]
ds_write_b32 v165, v140 offset:0
v_mfma_f32_16x16x32_bf16 v[208:211], a[52:55], v[52:55], v[208:211]
v_cvt_pk_bf16_f32 v142, v206, v207
v_cvt_pk_bf16_f32 v141, v212, v213
v_mfma_f32_16x16x32_bf16 v[208:211], a[48:51], v[48:51], v[208:211]
ds_write_b32 v165, v141 offset:4
v_mfma_f32_16x16x32_bf16 v[204:207], a[32:35], v[48:51], 0
ds_write_b32 v165, v142 offset:64
v_mfma_f32_16x16x32_bf16 v[204:207], a[36:39], v[52:55], v[204:207]
buffer_load_dwordx4 v243, s[16:19], s99 offen offset:0 nt lds
v_mfma_f32_16x16x32_bf16 v[204:207], a[40:43], v[56:59], v[204:207]
buffer_load_dwordx4 v243, s[16:19], s100 offen offset:2112 nt lds
v_mfma_f32_16x16x32_bf16 v[204:207], a[44:47], v[60:63], v[204:207]
s_add_u32 m0, s98, 59648
v_cvt_pk_bf16_f32 v143, v214, v215
v_cvt_pk_bf16_f32 v149, v208, v209
v_mfma_f32_16x16x32_bf16 v[212:215], a[28:31], v[60:63], 0
ds_write_b32 v165, v143 offset:68
v_mfma_f32_16x16x32_bf16 v[212:215], a[24:27], v[56:59], v[212:215]
s_waitcnt vmcnt(8)
s_barrier
v_mfma_f32_16x16x32_bf16 v[212:215], a[20:23], v[52:55], v[212:215]
ds_read_b128 v[238:241], v245 offset:0
v_cvt_pk_bf16_f32 v151, v210, v211
v_mfma_f32_16x16x32_bf16 v[212:215], a[16:19], v[48:51], v[212:215]
v_cvt_pk_bf16_f32 v148, v204, v205
v_cvt_pk_bf16_f32 v150, v206, v207
v_mfma_f32_16x16x32_bf16 v[208:211], a[0:3], v[48:51], 0
s_add_u32 s58, s53, 36096
s_xor_b32 s59, s53, 256
s_add_u32 s59, s59, 36096
v_mfma_f32_16x16x32_bf16 v[208:211], a[8:11], v[56:59], v[208:211]
s_mul_i32 s53, s43, 25344
v_cvt_pk_bf16_f32 v145, v212, v213
v_cvt_pk_bf16_f32 v147, v214, v215
v_mfma_f32_16x16x32_bf16 v[208:211], a[12:15], v[60:63], v[208:211]
s_add_u32 s11, s53, 59648
v_lshl_add_u32 v247, v88, 6, v247
v_lshl_add_u32 v247, v82, 4, v247
v_mfma_f32_16x16x32_bf16 v[208:211], a[4:7], v[52:55], v[208:211]
s_lshl_b32 s53, s43, 7
s_mov_b32 vcc_lo, 0x33333333
s_mov_b32 vcc_hi, 0x33333333
v_mfma_f32_16x16x32_bf16 v[204:207], a[4:7], v[68:71], 0
v_xor_b32 v247, v94, v247
v_lshl_add_u32 v244, v81, 8, s53
v_mfma_f32_16x16x32_bf16 v[204:207], a[0:3], v[64:67], v[204:207]
s_lshl_b32 s53, s41, 9
v_cvt_pk_bf16_f32 v144, v208, v209
v_cvt_pk_bf16_f32 v146, v210, v211
v_mfma_f32_16x16x32_bf16 v[204:207], a[8:11], v[72:75], v[204:207]
s_add_u32 s9, s53, 160960
s_lshl_b32 s57, s43, 14
s_lshl_b32 s53, s42, 7
s_add_u32 s57, s57, s53
v_mfma_f32_16x16x32_bf16 v[204:207], a[12:15], v[76:79], v[204:207]
s_add_u32 s99, s57, 0
s_add_u32 s100, s57, 1024
v_cndmask_b32 v247, v166, v247, vcc
v_mfma_f32_16x16x32_bf16 v[208:211], v[136:139], v[144:147], 0
s_waitcnt lgkmcnt(0)
s_mov_b32 vcc_lo, 0xf0000f
s_mov_b32 vcc_hi, 0xf0000f00
v_mfma_f32_16x16x32_bf16 v[208:211], v[140:143], v[148:151], v[208:211]
v_lshl_add_u32 v167, v95, 4, s9
v_cndmask_b32 v167, v169, v167, vcc
s_mov_b32 vcc_lo, 0x33333333
s_mov_b32 vcc_hi, 0x33333333
v_mov_b32 v169, 0x3f803f80
v_cndmask_b32 v184, v184, v169, vcc
s_mov_b32 vcc_lo, 0xaaaaaaaa
s_mov_b32 vcc_hi, 0xaaaaaaaa
v_mov_b32 v169, 0xeeeeeeee
v_cndmask_b32 v251, v251, v169, vcc
s_mov_b32 vcc_lo, 0x0
s_mov_b32 vcc_hi, 0xaaaaaaaa
v_mov_b32 v169, 0xe4eeeeee
v_cndmask_b32 v251, v251, v169, vcc
v_mov_b64 v[212:213], s[96:97]
v_mov_b64 v[214:215], s[96:97]
v_mov_b64 v[216:217], s[96:97]
v_mov_b64 v[218:219], s[96:97]
v_smfmac_f32_16x16x64_bf16 v[212:215], v[238:241], v[152:159], v251
s_mov_b32 vcc_lo, 0xffff
s_mov_b32 vcc_hi, 0xffff
v_cvt_pk_bf16_f32 v32, v204, v205
v_smfmac_f32_16x16x64_bf16 v[216:219], v[238:241], v[96:103], v251
s_lshl_b32 s50, s43, 12
s_add_u32 s50, s50, s44
s_add_u32 s50, s50, 13107200
v_cvt_pk_bf16_f32 v34, v206, v207
v_mfma_f32_16x16x32_bf16 v[204:207], a[28:31], v[76:79], 0
v_lshl_add_u32 v182, v82, 10, s11
v_lshl_add_u32 v182, v83, 7, v182
v_mfma_f32_16x16x32_bf16 v[204:207], a[24:27], v[72:75], v[204:207]
v_lshl_add_u32 v182, v84, 6, v182
v_lshl_add_u32 v182, v86, 4, v182
v_mfma_f32_16x16x32_bf16 v[204:207], a[20:23], v[68:71], v[204:207]
ds_read_b64_tr_b16 a[144:145], v182 offset:8
v_xor_b32 v183, 64, v182
v_mfma_f32_16x16x32_bf16 v[204:207], a[16:19], v[64:67], v[204:207]
ds_read_b64_tr_b16 a[176:177], v183 offset:8
v_exp_f32 v208, v208
v_exp_f32 v209, v209
v_exp_f32 v210, v210
v_add_f32 v160, v208, v209
s_nop 2
v_cvt_pk_bf16_f32 v33, v204, v205
v_cvt_pk_bf16_f32 v35, v206, v207
v_mfma_f32_16x16x32_bf16 v[204:207], a[32:35], v[64:67], 0
ds_read_b64_tr_b16 a[178:179], v183 offset:520
v_cvt_pk_bf16_f32 v208, v208, v209
v_mfma_f32_16x16x32_bf16 v[204:207], a[36:39], v[68:71], v[204:207]
ds_read_b64_tr_b16 a[180:181], v183 offset:4104
v_bfe_u32 v90, v168, 2, 1
v_mfma_f32_16x16x32_bf16 v[204:207], a[40:43], v[72:75], v[204:207]
ds_read_b64_tr_b16 a[182:183], v183 offset:4616
v_lshl_add_u32 v246, v89, 7, s12
v_mfma_f32_16x16x32_bf16 v[204:207], a[44:47], v[76:79], v[204:207]
ds_read_b64_tr_b16 a[184:185], v183 offset:8200
v_lshl_add_u32 v246, v90, 6, v246
v_mfma_f32_16x16x32_bf16 v[188:191], a[60:63], v[76:79], 0
ds_read_b64_tr_b16 a[186:187], v183 offset:8712
v_lshl_add_u32 v246, v86, 3, v246
v_mfma_f32_16x16x32_bf16 v[188:191], a[52:55], v[68:71], v[188:191]
ds_read_b64_tr_b16 a[188:189], v183 offset:12296
v_lshl_add_u32 v246, v91, 2, v246
v_mfma_f32_16x16x32_bf16 v[188:191], a[48:51], v[64:67], v[188:191]
ds_read_b64_tr_b16 a[190:191], v183 offset:12808
v_cvt_pk_bf16_f32 v36, v204, v205
v_mfma_f32_16x16x32_bf16 v[188:191], a[56:59], v[72:75], v[188:191]
ds_read_b64_tr_b16 a[160:161], v183 offset:0
v_cvt_pk_bf16_f32 v38, v206, v207
v_mfma_f32_16x16x32_bf16 v[204:207], a[120:123], v[72:75], 0
s_waitcnt lgkmcnt(9)
ds_read_b64_tr_b16 a[162:163], v183 offset:512
v_mov_b32 v252, 0x0c0c0c0c
v_mfma_f32_16x16x32_bf16 v[204:207], a[124:127], v[76:79], v[204:207]
s_waitcnt lgkmcnt(9)
ds_read_b64_tr_b16 a[164:165], v183 offset:4096
v_cvt_pk_bf16_f32 v37, v188, v189
v_mfma_f32_16x16x32_bf16 v[204:207], a[116:119], v[68:71], v[204:207]
ds_read_b64_tr_b16 a[166:167], v183 offset:4608
v_cvt_pk_bf16_f32 v39, v190, v191
v_mfma_f32_16x16x32_bf16 v[204:207], a[112:115], v[64:67], v[204:207]
ds_read_b64_tr_b16 a[168:169], v183 offset:8192
v_mov_b32 v169, 0x07060302
v_mfma_f32_16x16x32_bf16 v[188:191], a[96:99], v[64:67], 0
ds_read_b64_tr_b16 a[170:171], v183 offset:8704
v_cndmask_b32 v252, v252, v169, vcc
v_mfma_f32_16x16x32_bf16 v[188:191], a[100:103], v[68:71], v[188:191]
s_waitcnt lgkmcnt(12)
ds_read_b64_tr_b16 a[172:173], v183 offset:12288
v_cvt_pk_bf16_f32 v29, v204, v205
v_mfma_f32_16x16x32_bf16 v[188:191], a[104:107], v[72:75], v[188:191]
s_waitcnt lgkmcnt(12)
ds_read_b64_tr_b16 a[174:175], v183 offset:12800
v_cvt_pk_bf16_f32 v31, v206, v207
v_mfma_f32_16x16x32_bf16 v[188:191], a[108:111], v[76:79], v[188:191]
s_waitcnt lgkmcnt(12)
ds_read_b64_tr_b16 a[146:147], v182 offset:520
v_add_f32 v212, v212, v213
v_mfma_f32_16x16x32_bf16 v[204:207], a[92:95], v[76:79], 0
s_waitcnt lgkmcnt(12)
ds_read_b64_tr_b16 a[148:149], v182 offset:4104
v_add_f32 v214, v214, v215
v_mfma_f32_16x16x32_bf16 v[204:207], a[88:91], v[72:75], v[204:207]
s_waitcnt lgkmcnt(12)
ds_read_b64_tr_b16 a[150:151], v182 offset:4616
v_cvt_pk_bf16_f32 v28, v188, v189
v_mfma_f32_16x16x32_bf16 v[204:207], a[84:87], v[68:71], v[204:207]
s_waitcnt lgkmcnt(12)
ds_read_b64_tr_b16 a[152:153], v182 offset:8200
v_cvt_pk_bf16_f32 v30, v190, v191
v_mfma_f32_16x16x32_bf16 v[204:207], a[80:83], v[64:67], v[204:207]
s_waitcnt lgkmcnt(12)
ds_read_b64_tr_b16 a[154:155], v182 offset:8712
v_mov_b32 v253, 0x0c0c0c0c
v_mfma_f32_16x16x32_bf16 v[188:191], a[64:67], v[64:67], 0
s_waitcnt lgkmcnt(12)
ds_read_b64_tr_b16 a[156:157], v182 offset:12296
v_mov_b32 v169, 0x07060302
v_mfma_f32_16x16x32_bf16 v[188:191], a[68:71], v[68:71], v[188:191]
s_waitcnt lgkmcnt(12)
ds_read_b64_tr_b16 a[158:159], v182 offset:12808
v_cvt_pk_bf16_f32 v25, v204, v205
v_mfma_f32_16x16x32_bf16 v[188:191], a[72:75], v[72:75], v[188:191]
s_waitcnt lgkmcnt(12)
ds_read_b64_tr_b16 a[128:129], v182 offset:0
v_cvt_pk_bf16_f32 v27, v206, v207
v_mfma_f32_16x16x32_bf16 v[188:191], a[76:79], v[76:79], v[188:191]
s_waitcnt lgkmcnt(12)
ds_read_b64_tr_b16 a[130:131], v182 offset:512
v_lshl_add_u32 v181, v95, 3, s7
v_mfma_f32_16x16x32_bf16 v[204:207], v[76:79], a[188:191], 0
s_waitcnt lgkmcnt(12)
ds_read_b64_tr_b16 a[132:133], v182 offset:4096
v_lshl_add_u32 v248, v87, 5, v248
v_mfma_f32_16x16x32_bf16 v[204:207], v[72:75], a[184:187], v[204:207]
s_waitcnt lgkmcnt(12)
ds_read_b64_tr_b16 a[134:135], v182 offset:4608
v_cvt_pk_bf16_f32 v24, v188, v189
v_mfma_f32_16x16x32_bf16 v[204:207], v[68:71], a[180:183], v[204:207]
s_waitcnt lgkmcnt(12)
ds_read_b64_tr_b16 a[136:137], v182 offset:8192
v_cvt_pk_bf16_f32 v26, v190, v191
v_mfma_f32_16x16x32_bf16 v[204:207], v[64:67], a[176:179], v[204:207]
s_waitcnt lgkmcnt(12)
ds_read_b64_tr_b16 a[138:139], v182 offset:8704
v_lshl_add_u32 v250, v95, 2, s52
v_mfma_f32_16x16x32_bf16 v[188:191], v[24:27], v[32:35], 0
s_waitcnt lgkmcnt(12)
ds_read_b64_tr_b16 a[140:141], v182 offset:12288
v_lshl_add_u32 v244, v84, 6, v244
v_mfma_f32_16x16x32_bf16 v[188:191], v[28:31], v[36:39], v[188:191]
s_waitcnt lgkmcnt(12)
ds_read_b64_tr_b16 a[142:143], v182 offset:12800
v_cvt_pk_bf16_f32 v14, v204, v205
v_cvt_pk_bf16_f32 v15, v206, v207
v_mfma_f32_16x16x32_bf16 v[204:207], v[64:67], a[160:163], 0
s_waitcnt lgkmcnt(12)
ds_write_b32 v167, v208 offset:0
v_mfma_f32_16x16x32_bf16 v[204:207], v[68:71], a[164:167], v[204:207]
s_waitcnt lgkmcnt(12)
v_exp_f32 v192, v192
v_mfma_f32_16x16x32_bf16 v[204:207], v[72:75], a[168:171], v[204:207]
s_waitcnt lgkmcnt(9)
v_exp_f32 v193, v193
v_mfma_f32_16x16x32_bf16 v[204:207], v[76:79], a[172:175], v[204:207]
v_exp_f32 v194, v194
v_exp_f32 v195, v195
v_cvt_pk_bf16_f32 v104, v192, v193
v_cvt_pk_bf16_f32 v105, v194, v195
v_mfma_f32_16x16x32_bf16 v[192:195], v[76:79], a[156:159], 0
s_waitcnt lgkmcnt(8)
v_exp_f32 v196, v196
v_mfma_f32_16x16x32_bf16 v[192:195], v[72:75], a[152:155], v[192:195]
s_waitcnt lgkmcnt(7)
v_cvt_pk_bf16_f32 v12, v204, v205
v_cvt_pk_bf16_f32 v13, v206, v207
v_mfma_f32_16x16x32_bf16 v[192:195], v[68:71], a[148:151], v[192:195]
s_waitcnt lgkmcnt(6)
v_exp_f32 v197, v197
v_mfma_f32_16x16x32_bf16 v[192:195], v[64:67], a[144:147], v[192:195]
s_waitcnt lgkmcnt(3)
v_exp_f32 v198, v198
v_mfma_f32_16x16x32_bf16 v[204:207], v[64:67], a[128:131], 0
s_waitcnt lgkmcnt(1)
v_exp_f32 v199, v199
v_mfma_f32_16x16x32_bf16 v[204:207], v[72:75], a[136:139], v[204:207]
v_cvt_pk_bf16_f32 v114, v196, v197
v_cvt_pk_bf16_f32 v115, v198, v199
v_mfma_f32_16x16x32_bf16 v[204:207], v[76:79], a[140:143], v[204:207]
v_cvt_pk_bf16_f32 v10, v192, v193
v_cvt_pk_bf16_f32 v11, v194, v195
v_mfma_f32_16x16x32_bf16 v[204:207], v[68:71], a[132:135], v[204:207]
v_exp_f32 v211, v211
v_mfma_f32_16x16x32_bf16 v[192:195], v[52:55], a[132:135], 0
v_cvt_pk_bf16_f32 v209, v210, v211
v_add_f32 v161, v210, v211
v_mfma_f32_16x16x32_bf16 v[192:195], v[48:51], a[128:131], v[192:195]
ds_write_b32 v167, v209 offset:4
v_mfma_f32_16x16x32_bf16 v[192:195], v[56:59], a[136:139], v[192:195]
s_waitcnt vmcnt(4)
s_barrier
v_mfma_f32_16x16x32_bf16 v[192:195], v[60:63], a[140:143], v[192:195]
v_cvt_pk_bf16_f32 v8, v204, v205
v_cvt_pk_bf16_f32 v9, v206, v207
v_mfma_f32_16x16x32_bf16 v[204:207], v[60:63], a[156:159], 0
v_add_f32 v210, v160, v161
v_mad_u32_u24 v181, v82, s14, v181
v_mfma_f32_16x16x32_bf16 v[204:207], v[56:59], a[152:155], v[204:207]
ds_write_b32 v167, v210 offset:8
v_mfma_f32_16x16x32_bf16 v[204:207], v[52:55], a[148:151], v[204:207]
v_cvt_pk_bf16_f32 v16, v192, v193
v_cvt_pk_bf16_f32 v17, v194, v195
v_mfma_f32_16x16x32_bf16 v[204:207], v[48:51], a[144:147], v[204:207]
v_exp_f32 v188, v188
v_mfma_f32_16x16x32_bf16 v[192:195], v[48:51], a[160:163], 0
ds_read_b128 v[208:211], v242 offset:0
v_lshl_add_u32 v248, v83, 3, v248
v_mfma_f32_16x16x32_bf16 v[192:195], v[52:55], a[164:167], v[192:195]
v_exp_f32 v189, v189
v_mfma_f32_16x16x32_bf16 v[192:195], v[56:59], a[168:171], v[192:195]
s_nop 0
v_cvt_pk_bf16_f32 v18, v204, v205
v_cvt_pk_bf16_f32 v19, v206, v207
v_mfma_f32_16x16x32_bf16 v[192:195], v[60:63], a[172:175], v[192:195]
v_add_f32 v160, v188, v189
v_cvt_pk_bf16_f32 v188, v188, v189
v_mfma_f32_16x16x32_bf16 v[204:207], v[60:63], a[188:191], 0
ds_write_b32 v167, v188 offset:256
v_mfma_f32_16x16x32_bf16 v[204:207], v[52:55], a[180:183], v[204:207]
v_exp_f32 v190, v190
v_mfma_f32_16x16x32_bf16 v[204:207], v[48:51], a[176:179], v[204:207]
v_exp_f32 v191, v191
v_mfma_f32_16x16x32_bf16 v[204:207], v[56:59], a[184:187], v[204:207]
v_cvt_pk_bf16_f32 v189, v190, v191
v_add_f32 v161, v190, v191
v_mfma_f32_16x16x32_bf16 v[196:199], v[220:223], a[184:187], 0
ds_write_b32 v167, v189 offset:260
v_mfma_f32_16x16x32_bf16 v[196:199], v[232:235], a[188:191], v[196:199]
v_add_f32 v190, v160, v161
v_cvt_pk_bf16_f32 v20, v192, v193
v_mfma_f32_16x16x32_bf16 v[196:199], v[224:227], a[180:183], v[196:199]
s_waitcnt lgkmcnt(1)
ds_write_b32 v167, v190 offset:264
v_mfma_f32_16x16x32_bf16 v[196:199], v[228:231], a[176:179], v[196:199]
s_mov_b32 vcc_lo, 0xffff0000
s_mov_b32 vcc_hi, 0xffff0000
v_cndmask_b32 v253, v253, v169, vcc
v_mfma_f32_16x16x32_bf16 v[188:191], v[228:231], a[160:163], 0
v_exp_f32 v212, v212
v_mfma_f32_16x16x32_bf16 v[188:191], v[224:227], a[164:167], v[188:191]
v_exp_f32 v214, v214
v_mfma_f32_16x16x32_bf16 v[188:191], v[220:223], a[168:171], v[188:191]
v_cvt_pk_bf16_f32 v94, v196, v197
v_cvt_pk_bf16_f32 v95, v198, v199
v_mfma_f32_16x16x32_bf16 v[188:191], v[232:235], a[172:175], v[188:191]
v_perm_b32 v116, v214, v212, v252
v_perm_b32 v117, v214, v212, v253
v_mfma_f32_16x16x32_bf16 v[196:199], v[232:235], a[156:159], 0
ds_read_b128 v[212:215], v242 offset:256
v_cvt_pk_bf16_f32 v21, v194, v195
v_mfma_f32_16x16x32_bf16 v[196:199], v[220:223], a[152:155], v[196:199]
ds_read_b128 v[192:195], v242 offset:512
v_cvt_pk_bf16_f32 v22, v204, v205
v_mfma_f32_16x16x32_bf16 v[196:199], v[224:227], a[148:151], v[196:199]
ds_write_b32 v181, v14 offset:7296
v_mfma_f32_16x16x32_bf16 v[196:199], v[228:231], a[144:147], v[196:199]
ds_write_b32 v181, v15 offset:7300
v_cvt_pk_bf16_f32 v90, v188, v189
v_cvt_pk_bf16_f32 v91, v190, v191
v_mfma_f32_16x16x32_bf16 v[188:191], v[228:231], a[128:131], 0
ds_write_b32 v181, v12 offset:7168
v_mfma_f32_16x16x32_bf16 v[188:191], v[220:223], a[136:139], v[188:191]
ds_write_b32 v181, v13 offset:7172
v_mfma_f32_16x16x32_bf16 v[188:191], v[232:235], a[140:143], v[188:191]
s_waitcnt lgkmcnt(5)
ds_write_b32 v181, v10 offset:7040
v_mfma_f32_16x16x32_bf16 v[188:191], v[224:227], a[132:135], v[188:191]
ds_write_b32 v181, v11 offset:7044
v_exp_f32 v200, v200
v_exp_f32 v201, v201
v_exp_f32 v202, v202
v_exp_f32 v203, v203
v_cvt_pk_bf16_f32 v120, v200, v201
v_cvt_pk_bf16_f32 v121, v202, v203
v_mfma_f32_16x16x32_bf16 v[200:203], v[212:215], a[132:135], 0
s_waitcnt lgkmcnt(6)
ds_read_b128 v[228:231], v242 offset:4224
v_cvt_pk_bf16_f32 v23, v206, v207
v_mfma_f32_16x16x32_bf16 v[200:203], v[208:211], a[128:131], v[200:203]
ds_read_b128 v[204:207], v242 offset:768
v_mad_u32_u24 v250, v82, s8, v250
v_mfma_f32_16x16x32_bf16 v[200:203], v[192:195], a[136:139], v[200:203]
ds_read_b128 v[224:227], v242 offset:4480
v_lshl_add_u32 v244, v82, 4, v244
v_cvt_pk_bf16_f32 v82, v188, v189
v_cvt_pk_bf16_f32 v83, v190, v191
v_cvt_pk_bf16_f32 v86, v196, v197
v_cvt_pk_bf16_f32 v87, v198, v199
s_mul_i32 s48, s43, 3168
s_add_u32 s49, s49, s48
s_add_u32 s49, s49, 50688
s_mov_b32 s48, 8192
ds_read_b128 v[220:223], v242 offset:4736
ds_read_b128 v[232:235], v242 offset:4992
v_add_f32 v216, v216, v217
v_add_f32 v218, v218, v219
v_exp_f32 v216, v216
v_lshl_add_u32 v166, v89, 2, s15
s_waitcnt lgkmcnt(3)
v_mfma_f32_16x16x32_bf16 v[200:203], v[204:207], a[140:143], v[200:203]
ds_write_b32 v181, v8 offset:6912
v_mfma_f32_16x16x32_bf16 v[188:191], v[204:207], a[156:159], 0
ds_write_b32 v181, v9 offset:6916
v_mfma_f32_16x16x32_bf16 v[188:191], v[192:195], a[152:155], v[188:191]
v_exp_f32 v218, v218
v_mfma_f32_16x16x32_bf16 v[188:191], v[212:215], a[148:151], v[188:191]
v_perm_b32 v132, v218, v216, v252
v_perm_b32 v133, v218, v216, v253
v_mfma_f32_16x16x32_bf16 v[188:191], v[208:211], a[144:147], v[188:191]
v_cvt_pk_bf16_f32 v48, v200, v201
v_cvt_pk_bf16_f32 v49, v202, v203
v_mfma_f32_16x16x32_bf16 v[196:199], v[208:211], a[160:163], 0
v_mad_u32_u24 v166, v81, s14, v166
v_lshl_add_u32 v248, v88, 1, v248
v_mfma_f32_16x16x32_bf16 v[196:199], v[212:215], a[164:167], v[196:199]
ds_write_b32 v166, v236 offset:0
v_mfma_f32_16x16x32_bf16 v[196:199], v[192:195], a[168:171], v[196:199]
v_cvt_pk_bf16_f32 v52, v188, v189
v_cvt_pk_bf16_f32 v53, v190, v191
v_mfma_f32_16x16x32_bf16 v[196:199], v[204:207], a[172:175], v[196:199]
s_waitcnt lgkmcnt(5)
v_mov_b32 v185, v184
v_mov_b32 v186, v184
v_mfma_f32_16x16x32_bf16 v[188:191], v[204:207], a[188:191], 0
buffer_load_dwordx4 v174, s[36:39], s99 offen offset:0 lds
v_mfma_f32_16x16x32_bf16 v[188:191], v[192:195], a[184:187], v[188:191]
s_add_u32 s99, s57, 2048
buffer_load_dwordx4 v174, s[36:39], s100 offen offset:1024 lds
v_mfma_f32_16x16x32_bf16 v[188:191], v[212:215], a[180:183], v[188:191]
s_waitcnt lgkmcnt(3)
s_add_u32 s100, s57, 3072
v_cvt_pk_bf16_f32 v56, v196, v197
v_mfma_f32_16x16x32_bf16 v[188:191], v[208:211], a[176:179], v[188:191]
v_cvt_pk_bf16_f32 v57, v198, v199
v_mov_b32 v187, v184
v_mfma_f32_16x16x32_bf16 v[192:195], a[64:67], v[228:231], 0
v_mov_b32 v118, 0
v_mov_b32 v119, 0
v_mfma_f32_16x16x32_bf16 v[192:195], a[68:71], v[224:227], v[192:195]
v_mov_b32 v255, 0
v_mov_b32 v134, 0
v_mfma_f32_16x16x32_bf16 v[192:195], a[72:75], v[220:223], v[192:195]
v_cvt_pk_bf16_f32 v60, v188, v189
v_cvt_pk_bf16_f32 v61, v190, v191
v_mfma_f32_16x16x32_bf16 v[192:195], a[76:79], v[232:235], v[192:195]
v_mov_b32 v135, 0
s_nop 0
v_mfma_f32_16x16x32_bf16 v[188:191], a[92:95], v[232:235], 0
buffer_load_dwordx4 v174, s[36:39], s99 offen offset:2048 lds
v_mfma_f32_16x16x32_bf16 v[188:191], a[88:91], v[220:223], v[188:191]
s_add_u32 s99, s57, 8192
buffer_load_dwordx4 v174, s[36:39], s100 offen offset:3072 lds
v_mfma_f32_16x16x32_bf16 v[188:191], a[84:87], v[224:227], v[188:191]
s_add_u32 m0, s98, 63744
s_add_u32 s100, s57, 9216
v_cvt_pk_bf16_f32 v8, v192, v193
v_mfma_f32_16x16x32_bf16 v[188:191], a[80:83], v[228:231], v[188:191]
v_cvt_pk_bf16_f32 v9, v194, v195
s_nop 0
v_mfma_f32_16x16x32_bf16 v[192:195], a[96:99], v[228:231], 0
ds_write_b32 v181, v16 offset:0
v_mfma_f32_16x16x32_bf16 v[192:195], a[100:103], v[224:227], v[192:195]
ds_write_b32 v181, v17 offset:4
v_mfma_f32_16x16x32_bf16 v[192:195], a[104:107], v[220:223], v[192:195]
s_nop 0
v_cvt_pk_bf16_f32 v10, v188, v189
v_cvt_pk_bf16_f32 v11, v190, v191
v_mfma_f32_16x16x32_bf16 v[192:195], a[108:111], v[232:235], v[192:195]
ds_write_b32 v181, v18 offset:128
v_mfma_f32_16x16x32_bf16 v[188:191], a[124:127], v[232:235], 0
buffer_load_dwordx4 v174, s[36:39], s99 offen offset:0 lds
v_mfma_f32_16x16x32_bf16 v[188:191], a[120:123], v[220:223], v[188:191]
s_add_u32 s99, s57, 10240
buffer_load_dwordx4 v174, s[36:39], s100 offen offset:1024 lds
v_mfma_f32_16x16x32_bf16 v[188:191], a[116:119], v[224:227], v[188:191]
s_add_u32 s100, s57, 11264
v_cvt_pk_bf16_f32 v12, v192, v193
v_cvt_pk_bf16_f32 v13, v194, v195
v_mfma_f32_16x16x32_bf16 v[188:191], a[112:115], v[228:231], v[188:191]
s_waitcnt vmcnt(6)
s_barrier
v_mfma_f32_16x16x32_bf16 v[192:195], v[228:231], a[128:131], 0
s_mov_b32 s98, s50
ds_write_b32 v181, v19 offset:132
v_mfma_f32_16x16x32_bf16 v[192:195], v[224:227], a[132:135], v[192:195]
s_nop 1
v_cvt_pk_bf16_f32 v14, v188, v189
v_mfma_f32_16x16x32_bf16 v[192:195], v[220:223], a[136:139], v[192:195]
v_cvt_pk_bf16_f32 v15, v190, v191
v_mfma_f32_16x16x32_bf16 v[192:195], v[232:235], a[140:143], v[192:195]
ds_write_b32 v181, v20 offset:256
v_mfma_f32_16x16x32_bf16 v[188:191], v[12:15], v[156:159], 0
buffer_load_dwordx4 v174, s[36:39], s99 offen offset:2048 lds
v_mfma_f32_16x16x32_bf16 v[188:191], v[8:11], v[152:155], v[188:191]
s_add_u32 s99, s98, s51
buffer_load_dwordx4 v174, s[36:39], s100 offen offset:3072 lds
v_mfma_f32_16x16x32_bf16 v[196:199], v[8:11], v[96:99], 0
s_add_u32 s100, s99, s51
ds_write_b32 v181, v21 offset:260
v_mfma_f32_16x16x32_bf16 v[196:199], v[12:15], v[100:103], v[196:199]
s_add_u32 m0, s49, 0
v_cvt_pk_bf16_f32 v50, v192, v193
v_cvt_pk_bf16_f32 v51, v194, v195
v_mfma_f32_16x16x32_bf16 v[200:203], v[232:235], a[156:159], 0
s_add_u32 s101, s100, s51
ds_read_b128 v[204:207], v242 offset:8448
ds_read_b128 v[208:211], v242 offset:8704
v_mfma_f32_16x16x32_bf16 v[200:203], v[220:223], a[152:155], v[200:203]
ds_read_b128 v[212:215], v242 offset:8960
ds_read_b128 v[192:195], v242 offset:9216
v_mfma_f32_16x16x32_bf16 v[200:203], v[224:227], a[148:151], v[200:203]
ds_write_b32 v181, v22 offset:384
v_mfma_f32_16x16x32_bf16 v[200:203], v[228:231], a[144:147], v[200:203]
ds_write_b32 v181, v23 offset:388
v_mfma_f32_16x16x32_bf16 v[216:219], v[228:231], a[160:163], 0
ds_read2_b32 v[236:237], v246 offset0:0 offset1:8
s_nop 0
v_mfma_f32_16x16x32_bf16 v[216:219], v[224:227], a[164:167], v[216:219]
v_exp_f32 v188, v188
v_mfma_f32_16x16x32_bf16 v[216:219], v[220:223], a[168:171], v[216:219]
v_exp_f32 v189, v189
v_mfma_f32_16x16x32_bf16 v[216:219], v[232:235], a[172:175], v[216:219]
v_exp_f32 v190, v190
v_exp_f32 v191, v191
v_cvt_pk_bf16_f32 v106, v188, v189
v_cvt_pk_bf16_f32 v107, v190, v191
v_mfma_f32_16x16x32_bf16 v[188:191], v[232:235], a[188:191], 0
v_cvt_pk_bf16_f32 v54, v200, v201
v_cvt_pk_bf16_f32 v55, v202, v203
v_mfma_f32_16x16x32_bf16 v[188:191], v[220:223], a[184:187], v[188:191]
v_exp_f32 v196, v196
v_mfma_f32_16x16x32_bf16 v[188:191], v[224:227], a[180:183], v[188:191]
s_waitcnt lgkmcnt(6)
v_exp_f32 v197, v197
v_mfma_f32_16x16x32_bf16 v[188:191], v[228:231], a[176:179], v[188:191]
s_waitcnt lgkmcnt(5)
v_exp_f32 v198, v198
v_mfma_f32_16x16x32_bf16 v[200:203], a[64:67], v[204:207], 0
s_waitcnt lgkmcnt(4)
v_exp_f32 v199, v199
v_mfma_f32_16x16x32_bf16 v[200:203], a[68:71], v[208:211], v[200:203]
s_waitcnt lgkmcnt(3)
v_cvt_pk_bf16_f32 v122, v196, v197
v_cvt_pk_bf16_f32 v62, v188, v189
v_mfma_f32_16x16x32_bf16 v[200:203], a[72:75], v[212:215], v[200:203]
v_cvt_pk_bf16_f32 v63, v190, v191
v_cvt_pk_bf16_f32 v123, v198, v199
v_mfma_f32_16x16x32_bf16 v[200:203], a[76:79], v[192:195], v[200:203]
v_cvt_pk_bf16_f32 v58, v216, v217
v_cvt_pk_bf16_f32 v59, v218, v219
v_mfma_f32_16x16x32_bf16 v[188:191], a[92:95], v[192:195], 0
s_waitcnt lgkmcnt(0)
ds_write_b32 v164, v144 offset:512
v_mfma_f32_16x16x32_bf16 v[188:191], a[88:91], v[212:215], v[188:191]
s_nop 1
v_cvt_pk_bf16_f32 v16, v200, v201
v_mfma_f32_16x16x32_bf16 v[188:191], a[84:87], v[208:211], v[188:191]
v_cvt_pk_bf16_f32 v17, v202, v203
v_mfma_f32_16x16x32_bf16 v[188:191], a[80:83], v[204:207], v[188:191]
ds_write_b32 v164, v145 offset:516
v_mfma_f32_16x16x32_bf16 v[196:199], a[96:99], v[204:207], 0
ds_write_b32 v164, v146 offset:576
v_mfma_f32_16x16x32_bf16 v[196:199], a[100:103], v[208:211], v[196:199]
ds_write_b32 v164, v147 offset:580
v_mfma_f32_16x16x32_bf16 v[196:199], a[104:107], v[212:215], v[196:199]
s_nop 1
v_cvt_pk_bf16_f32 v18, v188, v189
v_mfma_f32_16x16x32_bf16 v[196:199], a[108:111], v[192:195], v[196:199]
v_cvt_pk_bf16_f32 v19, v190, v191
s_nop 0
v_mfma_f32_16x16x32_bf16 v[188:191], a[124:127], v[192:195], 0
ds_write_b32 v165, v148 offset:512
v_mfma_f32_16x16x32_bf16 v[188:191], a[120:123], v[212:215], v[188:191]
ds_write_b32 v165, v149 offset:516
v_mfma_f32_16x16x32_bf16 v[188:191], a[116:119], v[208:211], v[188:191]
ds_write_b32 v165, v150 offset:576
v_mfma_f32_16x16x32_bf16 v[188:191], a[112:115], v[204:207], v[188:191]
ds_write_b32 v165, v151 offset:580
v_cvt_pk_bf16_f32 v20, v196, v197
v_cvt_pk_bf16_f32 v21, v198, v199
v_mfma_f32_16x16x32_bf16 v[196:199], v[204:207], a[128:131], 0
ds_write_b32 v164, v32 offset:7424
v_mfma_f32_16x16x32_bf16 v[196:199], v[208:211], a[132:135], v[196:199]
ds_write_b32 v164, v33 offset:7428
v_mfma_f32_16x16x32_bf16 v[196:199], v[212:215], a[136:139], v[196:199]
ds_write_b32 v164, v34 offset:7488
v_mfma_f32_16x16x32_bf16 v[196:199], v[192:195], a[140:143], v[196:199]
ds_write_b32 v164, v35 offset:7492
v_cvt_pk_bf16_f32 v22, v188, v189
v_cvt_pk_bf16_f32 v23, v190, v191
s_nop 1
v_mfma_f32_16x16x32_bf16 v[188:191], v[20:23], v[156:159], 0
ds_read_b128 v[228:231], v242 offset:16896
ds_read_b128 v[224:227], v242 offset:17152
v_mfma_f32_16x16x32_bf16 v[188:191], v[16:19], v[152:155], v[188:191]
ds_read_b128 v[220:223], v242 offset:17408
v_cvt_pk_bf16_f32 v64, v196, v197
v_mfma_f32_16x16x32_bf16 v[200:203], v[16:19], v[96:99], 0
ds_read_b128 v[232:235], v242 offset:17664
v_cvt_pk_bf16_f32 v65, v198, v199
v_mfma_f32_16x16x32_bf16 v[200:203], v[20:23], v[100:103], v[200:203]
ds_write_b32 v165, v36 offset:7424
v_mfma_f32_16x16x32_bf16 v[196:199], v[192:195], a[156:159], 0
ds_write_b32 v165, v37 offset:7428
v_mfma_f32_16x16x32_bf16 v[196:199], v[212:215], a[152:155], v[196:199]
ds_write_b32 v165, v38 offset:7488
v_mfma_f32_16x16x32_bf16 v[196:199], v[208:211], a[148:151], v[196:199]
ds_write_b32 v165, v39 offset:7492
v_mfma_f32_16x16x32_bf16 v[196:199], v[204:207], a[144:147], v[196:199]
v_exp_f32 v188, v188
v_mfma_f32_16x16x32_bf16 v[216:219], v[204:207], a[160:163], 0
v_exp_f32 v189, v189
v_mfma_f32_16x16x32_bf16 v[216:219], v[208:211], a[164:167], v[216:219]
v_exp_f32 v190, v190
v_mfma_f32_16x16x32_bf16 v[216:219], v[212:215], a[168:171], v[216:219]
v_exp_f32 v191, v191
v_mfma_f32_16x16x32_bf16 v[216:219], v[192:195], a[172:175], v[216:219]
v_cvt_pk_bf16_f32 v68, v196, v197
v_cvt_pk_bf16_f32 v69, v198, v199
v_mfma_f32_16x16x32_bf16 v[196:199], v[192:195], a[188:191], 0
v_cvt_pk_bf16_f32 v108, v188, v189
v_cvt_pk_bf16_f32 v109, v190, v191
v_mfma_f32_16x16x32_bf16 v[196:199], v[212:215], a[184:187], v[196:199]
s_waitcnt lgkmcnt(6)
v_exp_f32 v200, v200
v_mfma_f32_16x16x32_bf16 v[196:199], v[208:211], a[180:183], v[196:199]
s_waitcnt lgkmcnt(5)
v_cvt_pk_bf16_f32 v72, v216, v217
v_cvt_pk_bf16_f32 v73, v218, v219
v_mfma_f32_16x16x32_bf16 v[196:199], v[204:207], a[176:179], v[196:199]
s_waitcnt lgkmcnt(4)
v_exp_f32 v201, v201
v_mfma_f32_16x16x32_bf16 v[188:191], a[64:67], v[228:231], 0
v_exp_f32 v202, v202
v_mfma_f32_16x16x32_bf16 v[188:191], a[68:71], v[224:227], v[188:191]
v_exp_f32 v203, v203
v_mfma_f32_16x16x32_bf16 v[188:191], a[72:75], v[220:223], v[188:191]
s_nop 0
v_cvt_pk_bf16_f32 v76, v196, v197
v_cvt_pk_bf16_f32 v77, v198, v199
v_mfma_f32_16x16x32_bf16 v[188:191], a[76:79], v[232:235], v[188:191]
buffer_load_dwordx4 v243, s[16:19], s98 offen offset:0 nt lds
v_mfma_f32_16x16x32_bf16 v[192:195], a[92:95], v[232:235], 0
buffer_load_dwordx4 v243, s[16:19], s99 offen offset:1056 nt lds
v_mfma_f32_16x16x32_bf16 v[192:195], a[88:91], v[220:223], v[192:195]
v_cvt_pk_bf16_f32 v124, v200, v201
v_cvt_pk_bf16_f32 v125, v202, v203
v_mfma_f32_16x16x32_bf16 v[192:195], a[84:87], v[224:227], v[192:195]
s_nop 0
v_cvt_pk_bf16_f32 v32, v188, v189
v_cvt_pk_bf16_f32 v33, v190, v191
v_mfma_f32_16x16x32_bf16 v[192:195], a[80:83], v[228:231], v[192:195]
ds_write_b32 v164, v24 offset:6912
v_mfma_f32_16x16x32_bf16 v[188:191], a[96:99], v[228:231], 0
ds_write_b32 v164, v25 offset:6916
v_mfma_f32_16x16x32_bf16 v[188:191], a[100:103], v[224:227], v[188:191]
ds_write_b32 v164, v26 offset:6976
v_mfma_f32_16x16x32_bf16 v[188:191], a[104:107], v[220:223], v[188:191]
s_nop 1
v_cvt_pk_bf16_f32 v34, v192, v193
v_mfma_f32_16x16x32_bf16 v[188:191], a[108:111], v[232:235], v[188:191]
buffer_load_dwordx4 v243, s[16:19], s100 offen offset:2112 nt lds
v_cvt_pk_bf16_f32 v35, v194, v195
v_mfma_f32_16x16x32_bf16 v[192:195], a[124:127], v[232:235], 0
buffer_load_dwordx4 v243, s[16:19], s101 offen offset:3168 nt lds
v_mfma_f32_16x16x32_bf16 v[192:195], a[120:123], v[220:223], v[192:195]
ds_write_b32 v164, v27 offset:6980
v_mfma_f32_16x16x32_bf16 v[192:195], a[116:119], v[224:227], v[192:195]
s_nop 0
v_cvt_pk_bf16_f32 v36, v188, v189
v_cvt_pk_bf16_f32 v37, v190, v191
v_mfma_f32_16x16x32_bf16 v[192:195], a[112:115], v[228:231], v[192:195]
ds_write_b32 v165, v28 offset:6912
v_mfma_f32_16x16x32_bf16 v[188:191], v[228:231], a[128:131], 0
ds_write_b32 v165, v29 offset:6916
v_mfma_f32_16x16x32_bf16 v[188:191], v[224:227], a[132:135], v[188:191]
ds_write_b32 v165, v30 offset:6976
v_mfma_f32_16x16x32_bf16 v[188:191], v[220:223], a[136:139], v[188:191]
s_nop 1
v_cvt_pk_bf16_f32 v38, v192, v193
v_mfma_f32_16x16x32_bf16 v[188:191], v[232:235], a[140:143], v[188:191]
v_cvt_pk_bf16_f32 v39, v194, v195
s_nop 1
v_mfma_f32_16x16x32_bf16 v[192:195], v[36:39], v[156:159], 0
ds_write_b32 v165, v31 offset:6980
v_mfma_f32_16x16x32_bf16 v[192:195], v[32:35], v[152:155], v[192:195]
s_nop 1
v_cvt_pk_bf16_f32 v80, v188, v189
v_mfma_f32_16x16x32_bf16 v[196:199], v[32:35], v[96:99], 0
v_cvt_pk_bf16_f32 v81, v190, v191
s_nop 0
v_mfma_f32_16x16x32_bf16 v[196:199], v[36:39], v[100:103], v[196:199]
s_nop 0
v_exp_f32 v192, v192
v_mfma_f32_16x16x32_bf16 v[188:191], v[232:235], a[156:159], 0
ds_read_b128 v[200:203], v242 offset:12672
ds_read_b128 v[204:207], v242 offset:12928
v_mfma_f32_16x16x32_bf16 v[188:191], v[220:223], a[152:155], v[188:191]
ds_read_b128 v[208:211], v242 offset:13184
ds_read_b128 v[212:215], v242 offset:13440
v_mfma_f32_16x16x32_bf16 v[188:191], v[224:227], a[148:151], v[188:191]
v_exp_f32 v193, v193
v_mfma_f32_16x16x32_bf16 v[188:191], v[228:231], a[144:147], v[188:191]
v_exp_f32 v194, v194
v_mfma_f32_16x16x32_bf16 v[216:219], v[228:231], a[160:163], 0
v_exp_f32 v195, v195
v_mfma_f32_16x16x32_bf16 v[216:219], v[224:227], a[164:167], v[216:219]
v_cvt_pk_bf16_f32 v112, v192, v193
v_cvt_pk_bf16_f32 v113, v194, v195
v_mfma_f32_16x16x32_bf16 v[216:219], v[220:223], a[168:171], v[216:219]
s_nop 0
v_cvt_pk_bf16_f32 v84, v188, v189
v_cvt_pk_bf16_f32 v85, v190, v191
v_mfma_f32_16x16x32_bf16 v[216:219], v[232:235], a[172:175], v[216:219]
v_exp_f32 v196, v196
v_mfma_f32_16x16x32_bf16 v[188:191], v[232:235], a[188:191], 0
v_exp_f32 v197, v197
v_mfma_f32_16x16x32_bf16 v[188:191], v[220:223], a[184:187], v[188:191]
v_exp_f32 v198, v198
v_mfma_f32_16x16x32_bf16 v[188:191], v[224:227], a[180:183], v[188:191]
s_waitcnt lgkmcnt(3)
v_exp_f32 v199, v199
v_mfma_f32_16x16x32_bf16 v[188:191], v[228:231], a[176:179], v[188:191]
s_waitcnt lgkmcnt(2)
v_cvt_pk_bf16_f32 v128, v196, v197
v_cvt_pk_bf16_f32 v129, v198, v199
v_mfma_f32_16x16x32_bf16 v[192:195], a[64:67], v[200:203], 0
s_waitcnt vmcnt(4)
s_barrier
v_mfma_f32_16x16x32_bf16 v[192:195], a[68:71], v[204:207], v[192:195]
s_waitcnt lgkmcnt(0)
ds_read_b64_tr_b16 a[192:193], v182 offset:0
v_cvt_pk_bf16_f32 v92, v188, v189
v_mfma_f32_16x16x32_bf16 v[192:195], a[72:75], v[208:211], v[192:195]
ds_read_b64_tr_b16 a[194:195], v182 offset:512
v_cvt_pk_bf16_f32 v93, v190, v191
v_mfma_f32_16x16x32_bf16 v[192:195], a[76:79], v[212:215], v[192:195]
ds_read_b64_tr_b16 a[196:197], v182 offset:4096
v_cvt_pk_bf16_f32 v88, v216, v217
v_mfma_f32_16x16x32_bf16 v[188:191], a[92:95], v[212:215], 0
ds_read_b64_tr_b16 a[198:199], v182 offset:4608
v_cvt_pk_bf16_f32 v89, v218, v219
v_mfma_f32_16x16x32_bf16 v[188:191], a[88:91], v[208:211], v[188:191]
ds_read_b64_tr_b16 a[200:201], v182 offset:8192
v_mfma_f32_16x16x32_bf16 v[188:191], a[84:87], v[204:207], v[188:191]
ds_read_b64_tr_b16 a[202:203], v182 offset:8704
v_cvt_pk_bf16_f32 v24, v192, v193
v_mfma_f32_16x16x32_bf16 v[188:191], a[80:83], v[200:203], v[188:191]
ds_read_b64_tr_b16 a[204:205], v182 offset:12288
v_cvt_pk_bf16_f32 v25, v194, v195
v_mfma_f32_16x16x32_bf16 v[192:195], a[96:99], v[200:203], 0
ds_read_b64_tr_b16 a[206:207], v182 offset:12800
ds_read_b128 v[216:219], v247 offset:0
v_mfma_f32_16x16x32_bf16 v[192:195], a[100:103], v[204:207], v[192:195]
ds_read_b64_tr_b16 a[208:209], v182 offset:8
v_mfma_f32_16x16x32_bf16 v[192:195], a[104:107], v[208:211], v[192:195]
ds_read_b64_tr_b16 a[210:211], v182 offset:520
v_cvt_pk_bf16_f32 v26, v188, v189
v_mfma_f32_16x16x32_bf16 v[192:195], a[108:111], v[212:215], v[192:195]
ds_read_b64_tr_b16 a[212:213], v182 offset:4104
v_cvt_pk_bf16_f32 v27, v190, v191
v_mfma_f32_16x16x32_bf16 v[188:191], a[124:127], v[212:215], 0
ds_read_b64_tr_b16 a[214:215], v182 offset:4616
s_nop 0
v_mfma_f32_16x16x32_bf16 v[188:191], a[120:123], v[208:211], v[188:191]
ds_read_b64_tr_b16 a[216:217], v182 offset:8200
v_mfma_f32_16x16x32_bf16 v[188:191], a[116:119], v[204:207], v[188:191]
s_waitcnt lgkmcnt(13)
ds_read_b64_tr_b16 a[218:219], v182 offset:8712
v_cvt_pk_bf16_f32 v28, v192, v193
v_mfma_f32_16x16x32_bf16 v[188:191], a[112:115], v[200:203], v[188:191]
s_waitcnt lgkmcnt(13)
ds_read_b64_tr_b16 a[220:221], v182 offset:12296
v_cvt_pk_bf16_f32 v29, v194, v195
v_mfma_f32_16x16x32_bf16 v[192:195], v[200:203], a[128:131], 0
s_waitcnt lgkmcnt(13)
ds_read_b64_tr_b16 a[222:223], v182 offset:12808
s_nop 0
v_mfma_f32_16x16x32_bf16 v[192:195], v[204:207], a[132:135], v[192:195]
s_waitcnt lgkmcnt(13)
ds_read_b64_tr_b16 a[224:225], v183 offset:0
v_cvt_pk_bf16_f32 v30, v188, v189
v_mfma_f32_16x16x32_bf16 v[192:195], v[208:211], a[136:139], v[192:195]
s_waitcnt lgkmcnt(13)
ds_read_b64_tr_b16 a[226:227], v183 offset:512
v_cvt_pk_bf16_f32 v31, v190, v191
v_mfma_f32_16x16x32_bf16 v[192:195], v[212:215], a[140:143], v[192:195]
s_waitcnt lgkmcnt(13)
s_nop 1
v_mfma_f32_16x16x32_bf16 v[188:191], v[28:31], v[156:159], 0
s_waitcnt lgkmcnt(12)
s_nop 1
v_mfma_f32_16x16x32_bf16 v[188:191], v[24:27], v[152:155], v[188:191]
s_waitcnt lgkmcnt(10)
v_cvt_pk_bf16_f32 v66, v192, v193
v_cvt_pk_bf16_f32 v67, v194, v195
v_mfma_f32_16x16x32_bf16 v[192:195], v[24:27], v[96:99], 0
s_waitcnt lgkmcnt(9)
s_nop 1
v_mfma_f32_16x16x32_bf16 v[192:195], v[28:31], v[100:103], v[192:195]
s_waitcnt lgkmcnt(8)
v_mov_b64 v[168:169], 0
v_mov_b64 v[170:171], 0
v_mfma_f32_16x16x32_bf16 v[196:199], v[212:215], a[156:159], 0
s_waitcnt lgkmcnt(7)
v_mov_b64 v[172:173], 0
v_mov_b64 v[174:175], 0
v_mfma_f32_16x16x32_bf16 v[196:199], v[208:211], a[152:155], v[196:199]
s_waitcnt lgkmcnt(6)
v_mov_b64 v[176:177], 0
v_mov_b64 v[178:179], 0
v_mfma_f32_16x16x32_bf16 v[196:199], v[204:207], a[148:151], v[196:199]
s_waitcnt lgkmcnt(5)
v_exp_f32 v188, v188
v_mfma_f32_16x16x32_bf16 v[196:199], v[200:203], a[144:147], v[196:199]
s_waitcnt lgkmcnt(4)
ds_read_b128 v[152:155], v242 offset:21120
ds_read_b128 v[156:159], v242 offset:21376
v_smfmac_f32_16x16x64_bf16 v[168:171], v[216:219], v[0:7], v251
s_waitcnt lgkmcnt(5)
ds_read_b128 v[160:163], v242 offset:21632
ds_read_b128 v[164:167], v242 offset:21888
v_smfmac_f32_16x16x64_bf16 v[172:175], v[216:219], v[16:23], v251
s_waitcnt lgkmcnt(6)
ds_read_b64_tr_b16 a[228:229], v183 offset:4096
v_cvt_pk_bf16_f32 v70, v196, v197
v_smfmac_f32_16x16x64_bf16 v[176:179], v[216:219], v[32:39], v251
s_waitcnt lgkmcnt(6)
ds_read_b64_tr_b16 a[230:231], v183 offset:4608
v_cvt_pk_bf16_f32 v71, v198, v199
v_mfma_f32_16x16x32_bf16 v[196:199], v[200:203], a[160:163], 0
s_waitcnt lgkmcnt(6)
ds_read_b64_tr_b16 a[232:233], v183 offset:8192
v_add_f32 v168, v168, v169
v_mfma_f32_16x16x32_bf16 v[196:199], v[204:207], a[164:167], v[196:199]
ds_read_b64_tr_b16 a[234:235], v183 offset:8704
v_mfma_f32_16x16x32_bf16 v[196:199], v[208:211], a[168:171], v[196:199]
ds_read_b64_tr_b16 a[236:237], v183 offset:12288
v_mfma_f32_16x16x32_bf16 v[196:199], v[212:215], a[172:175], v[196:199]
ds_read_b64_tr_b16 a[238:239], v183 offset:12800
s_nop 0
v_smfmac_f32_16x16x64_bf16 v[170:173], v[216:219], v[8:15], v251
ds_read_b64_tr_b16 a[240:241], v183 offset:8
s_nop 0
v_smfmac_f32_16x16x64_bf16 v[174:177], v[216:219], v[24:31], v251
ds_read_b64_tr_b16 a[242:243], v183 offset:520
s_nop 0
v_smfmac_f32_16x16x64_bf16 v[178:181], v[216:219], v[40:47], v251
ds_read_b64_tr_b16 a[244:245], v183 offset:4104
v_cvt_pk_bf16_f32 v74, v196, v197
v_mfma_f32_16x16x32_bf16 v[216:219], v[212:215], a[188:191], 0
ds_read_b64_tr_b16 a[246:247], v183 offset:4616
v_mov_b64 v[196:197], 0
v_mfma_f32_16x16x32_bf16 v[216:219], v[208:211], a[184:187], v[216:219]
ds_read_b64_tr_b16 a[248:249], v183 offset:8200
v_cvt_pk_bf16_f32 v75, v198, v199
v_mfma_f32_16x16x32_bf16 v[216:219], v[204:207], a[180:183], v[216:219]
s_waitcnt lgkmcnt(13)
ds_read_b64_tr_b16 a[250:251], v183 offset:8712
ds_read_b128 v[204:207], v242 offset:512
v_mfma_f32_16x16x32_bf16 v[216:219], v[200:203], a[176:179], v[216:219]
s_waitcnt lgkmcnt(13)
ds_read_b64_tr_b16 a[252:253], v183 offset:12296
v_exp_f32 v189, v189
v_exp_f32 v190, v190
v_exp_f32 v191, v191
v_cvt_pk_bf16_f32 v110, v188, v189
v_cvt_pk_bf16_f32 v111, v190, v191
v_add_f32 v170, v170, v171
v_add_f32 v172, v172, v173
v_smfmac_f32_16x16x64_bf16 v[196:199], v[184:187], v[104:111], v251
s_waitcnt lgkmcnt(11)
ds_read_b64_tr_b16 a[254:255], v183 offset:12808
ds_read_b128 v[188:191], v242 offset:768
v_smfmac_f32_16x16x64_bf16 v[196:199], v[184:187], v[112:119], v251 abid:1
s_waitcnt lgkmcnt(12)
ds_read_b128 v[200:203], v242 offset:256
ds_read_b128 v[208:211], v242 offset:0
v_mfma_f32_16x16x32_bf16 v[136:139], a[192:195], v[152:155], 0
s_waitcnt lgkmcnt(13)
v_exp_f32 v168, v168
v_mfma_f32_16x16x32_bf16 v[136:139], a[196:199], v[156:159], v[136:139]
s_waitcnt lgkmcnt(12)
v_exp_f32 v170, v170
v_mfma_f32_16x16x32_bf16 v[136:139], a[200:203], v[160:163], v[136:139]
s_waitcnt lgkmcnt(11)
v_exp_f32 v172, v172
v_mfma_f32_16x16x32_bf16 v[136:139], a[204:207], v[164:167], v[136:139]
s_waitcnt lgkmcnt(10)
v_add_f32 v174, v174, v175
v_add_f32 v176, v176, v177
v_mfma_f32_16x16x32_bf16 v[140:143], a[220:223], v[164:167], 0
s_waitcnt lgkmcnt(3)
s_barrier
v_mfma_f32_16x16x32_bf16 v[140:143], a[216:219], v[160:163], v[140:143]
s_add_u32 s98, s98, s48
v_exp_f32 v174, v174
v_mfma_f32_16x16x32_bf16 v[140:143], a[212:215], v[156:159], v[140:143]
s_add_u32 s99, s98, s51
v_exp_f32 v176, v176
v_mfma_f32_16x16x32_bf16 v[140:143], a[208:211], v[152:155], v[140:143]
s_add_u32 s100, s99, s51
v_add_f32 v178, v178, v179
v_add_f32 v180, v168, v170
v_mfma_f32_16x16x32_bf16 v[144:147], a[224:227], v[152:155], 0
s_add_u32 m0, s49, 8448
v_cvt_pk_bf16_f32 v169, v168, v170
v_add_f32 v180, v180, v172
v_mfma_f32_16x16x32_bf16 v[144:147], a[228:231], v[156:159], v[144:147]
s_add_u32 s101, s100, s51
ds_write_b16 v248, v169 offset:0
v_mfma_f32_16x16x32_bf16 v[144:147], a[232:235], v[160:163], v[144:147]
s_waitcnt lgkmcnt(3)
ds_write_b16_d16_hi v248, v169 offset:4
v_mfma_f32_16x16x32_bf16 v[144:147], a[236:239], v[164:167], v[144:147]
buffer_load_dwordx4 v243, s[16:19], s98 offen offset:0 nt lds
v_mfma_f32_16x16x32_bf16 v[148:151], a[252:255], v[164:167], 0
buffer_load_dwordx4 v243, s[16:19], s99 offen offset:1056 nt lds
v_mfma_f32_16x16x32_bf16 v[148:151], a[244:247], v[156:159], v[148:151]
s_add_u32 s98, s98, s48
v_exp_f32 v178, v178
v_mfma_f32_16x16x32_bf16 v[148:151], a[240:243], v[152:155], v[148:151]
s_add_u32 s99, s98, s51
v_add_f32 v180, v180, v174
v_add_f32 v180, v180, v176
v_mfma_f32_16x16x32_bf16 v[148:151], a[248:251], v[160:163], v[148:151]
buffer_load_dwordx4 v243, s[16:19], s100 offen offset:2112 nt lds
v_mfma_f32_16x16x32_bf16 v[164:167], a[248:251], v[204:207], 0
buffer_load_dwordx4 v243, s[16:19], s101 offen offset:3168 nt lds
v_mfma_f32_16x16x32_bf16 v[164:167], a[252:255], v[188:191], v[164:167]
s_add_u32 s100, s99, s51
v_add_f32 v180, v180, v178
s_waitcnt lgkmcnt(3)
v_mfma_f32_16x16x32_bf16 v[164:167], a[244:247], v[200:203], v[164:167]
s_add_u32 m0, s49, 16896
v_cvt_pk_bf16_f32 v173, v172, v174
s_waitcnt lgkmcnt(2)
v_mfma_f32_16x16x32_bf16 v[164:167], a[240:243], v[208:211], v[164:167]
s_add_u32 s101, s100, s51
ds_write_b16 v248, v173 offset:272
v_add_f32_dpp v180, v180, v180 row_ror:8 row_mask:0xf bank_mask:0xf
v_cvt_pk_bf16_f32 v177, v176, v178
s_nop 0
v_add_f32_dpp v180, v180, v180 row_ror:4 row_mask:0xf bank_mask:0xf
ds_write_b16_d16_hi v248, v173 offset:276
ds_write_b16 v248, v177 offset:544
ds_write_b32 v250, v180 offset:256
ds_write_b16_d16_hi v248, v177 offset:548
v_add_f32 v196, v196, v197
v_cvt_pk_bf16_f32 v78, v216, v217
v_mfma_f32_32x32x16_bf16 v[168:183], v[236:239], v[116:119], 0
s_bfe_i32 s57, s3, 0x10000
v_rcp_f32 v254, v196
v_exp_f32 v192, v192
v_exp_f32 v193, v193
v_mfma_f32_16x16x32_bf16 v[160:163], a[224:227], v[208:211], 0
s_and_b32 s51, s57, 13106176
v_exp_f32 v194, v194
v_mfma_f32_16x16x32_bf16 v[160:163], a[228:231], v[200:203], v[160:163]
s_and_b32 s54, s57, s5
v_exp_f32 v195, v195
v_mfma_f32_16x16x32_bf16 v[160:163], a[232:235], v[204:207], v[160:163]
s_add_u32 s50, s50, 13107200
v_cvt_pk_bf16_f32 v126, v192, v193
v_cvt_pk_bf16_f32 v127, v194, v195
v_mfma_f32_16x16x32_bf16 v[160:163], a[236:239], v[188:191], v[160:163]
buffer_load_dwordx4 v243, s[16:19], s98 offen offset:0 nt lds
v_mfma_f32_16x16x32_bf16 v[156:159], a[220:223], v[188:191], 0
buffer_load_dwordx4 v243, s[16:19], s99 offen offset:1056 nt lds
v_mfma_f32_16x16x32_bf16 v[156:159], a[216:219], v[204:207], v[156:159]
s_lshl3_add_u32 s48, s51, 8192
v_cvt_pk_bf16_f32 v79, v218, v219
v_max3_f32 v255, v255, v196, v254
v_mfma_f32_16x16x32_bf16 v[156:159], a[212:215], v[200:203], v[156:159]
s_mov_b32 s47, s46
v_add_u32 v245, 1728, v245
v_add_u32 v246, 1728, v246
v_mfma_f32_16x16x32_bf16 v[156:159], a[208:211], v[208:211], v[156:159]
buffer_load_dwordx4 v243, s[16:19], s100 offen offset:2112 nt lds
v_mfma_f32_16x16x32_bf16 v[152:155], a[192:195], v[208:211], 0
buffer_load_dwordx4 v243, s[16:19], s101 offen offset:3168 nt lds
v_mfma_f32_16x16x32_bf16 v[152:155], a[196:199], v[200:203], v[152:155]
s_lshr_b32 s3, s3, 1
v_add_u32 v247, 1728, v247
s_sub_u32 s45, s45, 1
v_mfma_f32_16x16x32_bf16 v[152:155], a[200:203], v[204:207], v[152:155]
s_sub_u32 s50, s50, s54
s_add_u32 s52, s46, 20480
s_sub_u32 s49, s49, s56
v_mfma_f32_16x16x32_bf16 v[152:155], a[204:207], v[188:191], v[152:155]
s_sub_u32 s51, s51, 32
s_add_u32 s53, s46, 0
s_mov_b32 m0, s58
v_mfma_f32_16x16x32_bf16 v[168:171], v[48:51], v[104:107], v[168:171]
v_mfma_f32_16x16x32_bf16 v[168:171], v[64:67], v[108:111], v[168:171]
v_mfma_f32_16x16x32_bf16 v[168:171], v[80:83], v[112:115], v[168:171]
v_mfma_f32_16x16x32_bf16 v[172:175], v[84:87], v[112:115], v[172:175]
v_mfma_f32_16x16x32_bf16 v[172:175], v[52:55], v[104:107], v[172:175]
v_mfma_f32_16x16x32_bf16 v[172:175], v[68:71], v[108:111], v[172:175]
s_nop 7
s_waitcnt lgkmcnt(0)
s_branch L_entryf
L_spin:
ds_read_addtid_b32 v188 offset:65280
s_waitcnt lgkmcnt(0)
v_cmp_lt_u32 vcc, s45, v188
s_nop 1
s_cbranch_vccnz L_spin
s_branch L_back
.p2align 6
L_loopf:
v_mfma_f32_16x16x32_bf16 v[152:155], a[192:195], v[204:207], 0
s_mov_b32 m0, s59
v_cvt_pk_bf16_f32 v102, v232, v233
v_cvt_pk_bf16_f32 v103, v234, v235
v_mfma_f32_16x16x32_bf16 v[152:155], a[196:199], v[208:211], v[152:155]
s_add_u32 s52, s47, 8192
ds_read_addtid_b32 v188 offset:65280
v_cvt_pk_bf16_f32 v106, v200, v201
v_mfma_f32_16x16x32_bf16 v[152:155], a[200:203], v[212:215], v[152:155]
s_add_u32 s53, s47, 12288
v_cvt_pk_bf16_f32 v107, v202, v203
s_bfe_i32 s57, s3, 0x10000
v_mfma_f32_16x16x32_bf16 v[152:155], a[204:207], v[216:219], v[152:155]
s_mov_b32 s47, s46
v_exp_f32 v196, v196
v_mfma_f32_16x16x32_bf16 v[156:159], a[220:223], v[216:219], 0
s_and_b32 s54, s57, s5
v_exp_f32 v197, v197
v_mfma_f32_16x16x32_bf16 v[156:159], a[216:219], v[212:215], v[156:159]
s_lshr_b32 s3, s3, 1
v_exp_f32 v198, v198
v_mfma_f32_16x16x32_bf16 v[156:159], a[212:215], v[208:211], v[156:159]
v_exp_f32 v199, v199
v_mfma_f32_16x16x32_bf16 v[156:159], a[208:211], v[204:207], v[156:159]
s_waitcnt lgkmcnt(0)
v_cmp_lt_u32 vcc, s45, v188
v_cvt_pk_bf16_f32 v104, v196, v197
v_mfma_f32_16x16x32_bf16 v[160:163], a[224:227], v[204:207], 0
s_cbranch_vccnz L_spin
L_back:
ds_read_b128 v[188:191], v242 offset:0
v_cvt_pk_bf16_f32 v105, v198, v199
v_mfma_f32_16x16x32_bf16 v[160:163], a[228:231], v[208:211], v[160:163]
s_mov_b32 s98, s50
ds_read_b128 v[196:199], v242 offset:256
ds_read_b128 v[232:235], v242 offset:512
v_mfma_f32_16x16x32_bf16 v[160:163], a[232:235], v[212:215], v[160:163]
s_add_u32 s99, s98, s51
v_exp_f32 v192, v192
v_mfma_f32_16x16x32_bf16 v[160:163], a[236:239], v[216:219], v[160:163]
s_add_u32 s100, s99, s51
v_exp_f32 v193, v193
v_mfma_f32_16x16x32_bf16 v[164:167], a[252:255], v[216:219], 0
s_add_u32 m0, s49, 0
v_mov_b64 v[216:217], s[96:97]
v_mov_b64 v[218:219], s[96:97]
v_mfma_f32_16x16x32_bf16 v[164:167], a[248:251], v[212:215], v[164:167]
s_add_u32 s101, s100, s51
v_exp_f32 v194, v194
v_mfma_f32_16x16x32_bf16 v[164:167], a[244:247], v[208:211], v[164:167]
s_waitcnt lgkmcnt(2)
v_exp_f32 v195, v195
v_mfma_f32_16x16x32_bf16 v[164:167], a[240:243], v[204:207], v[164:167]
s_sub_u32 s45, s45, 1
v_cvt_pk_bf16_f32 v110, v192, v193
v_cvt_pk_bf16_f32 v111, v194, v195
v_smfmac_f32_16x16x64_bf16 v[216:219], v[238:241], v[96:103], v251
s_add_u32 s50, s50, 13107200
ds_read_b128 v[192:195], v242 offset:768
s_sub_u32 s50, s50, s54
v_mfma_f32_16x16x32_bf16 v[204:207], v[0:3], v[96:99], 0
v_exp_f32 v220, v220
v_mfma_f32_16x16x32_bf16 v[204:207], v[4:7], v[100:103], v[204:207]
v_exp_f32 v221, v221
v_mfma_f32_16x16x32_bf16 v[208:211], v[12:15], v[100:103], 0
v_exp_f32 v222, v222
v_mfma_f32_16x16x32_bf16 v[208:211], v[8:11], v[96:99], v[208:211]
s_waitcnt lgkmcnt(2)
v_exp_f32 v223, v223
v_mfma_f32_16x16x32_bf16 v[200:203], a[64:67], v[188:191], 0
s_waitcnt lgkmcnt(1)
v_cvt_pk_bf16_f32 v108, v220, v221
v_cvt_pk_bf16_f32 v109, v222, v223
v_mfma_f32_16x16x32_bf16 v[200:203], a[68:71], v[196:199], v[200:203]
s_waitcnt lgkmcnt(0)
v_exp_f32 v224, v224
v_mfma_f32_16x16x32_bf16 v[200:203], a[72:75], v[232:235], v[200:203]
v_exp_f32 v225, v225
v_mfma_f32_16x16x32_bf16 v[200:203], a[76:79], v[192:195], v[200:203]
v_exp_f32 v226, v226
v_mfma_f32_16x16x32_bf16 v[212:215], a[92:95], v[192:195], 0
v_exp_f32 v227, v227
v_mfma_f32_16x16x32_bf16 v[212:215], a[88:91], v[232:235], v[212:215]
v_cvt_pk_bf16_f32 v112, v224, v225
v_cvt_pk_bf16_f32 v113, v226, v227
v_mfma_f32_16x16x32_bf16 v[212:215], a[84:87], v[196:199], v[212:215]
s_nop 0
v_cvt_pk_bf16_f32 v0, v200, v201
v_cvt_pk_bf16_f32 v1, v202, v203
v_mfma_f32_16x16x32_bf16 v[212:215], a[80:83], v[188:191], v[212:215]
buffer_load_dwordx4 v243, s[16:19], s98 offen offset:0 nt lds
v_mfma_f32_16x16x32_bf16 v[220:223], a[96:99], v[188:191], 0
s_add_u32 s98, s98, s48
v_exp_f32 v228, v228
v_mfma_f32_16x16x32_bf16 v[220:223], a[100:103], v[196:199], v[220:223]
v_exp_f32 v229, v229
v_mfma_f32_16x16x32_bf16 v[220:223], a[104:107], v[232:235], v[220:223]
s_nop 0
v_cvt_pk_bf16_f32 v2, v212, v213
v_cvt_pk_bf16_f32 v3, v214, v215
v_mfma_f32_16x16x32_bf16 v[220:223], a[108:111], v[192:195], v[220:223]
v_mov_b64 v[200:201], 0
v_cvt_pk_bf16_f32 v114, v228, v229
v_mfma_f32_16x16x32_bf16 v[212:215], a[124:127], v[192:195], 0
v_exp_f32 v230, v230
v_mfma_f32_16x16x32_bf16 v[212:215], a[120:123], v[232:235], v[212:215]
v_exp_f32 v231, v231
v_mfma_f32_16x16x32_bf16 v[212:215], a[116:119], v[196:199], v[212:215]
v_cvt_pk_bf16_f32 v115, v230, v231
v_add_f32 v216, v216, v217
v_mfma_f32_16x16x32_bf16 v[212:215], a[112:115], v[188:191], v[212:215]
v_add_f32 v218, v218, v219
v_cvt_pk_bf16_f32 v4, v220, v221
v_smfmac_f32_16x16x64_bf16 v[200:203], v[184:187], v[104:111], v251
ds_read_b128 v[188:191], v242 offset:4992
v_cvt_pk_bf16_f32 v5, v222, v223
v_smfmac_f32_16x16x64_bf16 v[200:203], v[184:187], v[112:119], v251 abid:1
ds_read_b128 v[192:195], v242 offset:4736
ds_read_b128 v[196:199], v242 offset:4480
v_mfma_f32_16x16x32_bf16 v[168:171], v[80:83], v[112:115], v[168:171]
ds_read_b128 v[224:227], v242 offset:4224
v_cvt_pk_bf16_f32 v6, v212, v213
v_mfma_f32_16x16x32_bf16 v[168:171], v[64:67], v[108:111], v[168:171]
v_exp_f32 v216, v216
v_mfma_f32_16x16x32_bf16 v[168:171], v[48:51], v[104:107], v[168:171]
v_add_f32 v200, v200, v201
v_cvt_pk_bf16_f32 v7, v214, v215
v_mfma_f32_16x16x32_bf16 v[172:175], v[52:55], v[104:107], v[172:175]
v_rcp_f32 v254, v200
v_mfma_f32_16x16x32_bf16 v[172:175], v[68:71], v[108:111], v[172:175]
s_waitcnt lgkmcnt(3)
v_max3_f32 v255, v255, v200, v254
v_mfma_f32_16x16x32_bf16 v[172:175], v[84:87], v[112:115], v[172:175]
s_waitcnt lgkmcnt(2)
v_exp_f32 v218, v218
v_mfma_f32_16x16x32_bf16 v[176:179], v[88:91], v[112:115], v[176:179]
v_perm_b32 v132, v218, v216, v252
v_perm_b32 v133, v218, v216, v253
v_mfma_f32_16x16x32_bf16 v[176:179], v[72:75], v[108:111], v[176:179]
v_exp_f32 v204, v204
v_mfma_f32_16x16x32_bf16 v[176:179], v[56:59], v[104:107], v[176:179]
v_exp_f32 v205, v205
v_mfma_f32_16x16x32_bf16 v[180:183], v[60:63], v[104:107], v[180:183]
v_exp_f32 v206, v206
v_mfma_f32_16x16x32_bf16 v[180:183], v[76:79], v[108:111], v[180:183]
v_exp_f32 v207, v207
v_mfma_f32_16x16x32_bf16 v[180:183], v[92:95], v[112:115], v[180:183]
v_cvt_pk_bf16_f32 v120, v204, v205
v_cvt_pk_bf16_f32 v121, v206, v207
v_mfma_f32_16x16x32_bf16 v[200:203], v[36:39], v[100:103], 0
s_waitcnt lgkmcnt(1)
v_exp_f32 v208, v208
v_mfma_f32_16x16x32_bf16 v[200:203], v[32:35], v[96:99], v[200:203]
s_waitcnt lgkmcnt(0)
v_exp_f32 v209, v209
v_mfma_f32_16x16x32_bf16 v[216:219], v[16:19], v[96:99], 0
v_exp_f32 v210, v210
v_mfma_f32_16x16x32_bf16 v[216:219], v[20:23], v[100:103], v[216:219]
v_exp_f32 v211, v211
v_mfma_f32_16x16x32_bf16 v[220:223], a[124:127], v[188:191], 0
s_nop 0
v_exp_f32 v200, v200
v_mfma_f32_16x16x32_bf16 v[220:223], a[120:123], v[192:195], v[220:223]
v_exp_f32 v201, v201
v_mfma_f32_16x16x32_bf16 v[220:223], a[116:119], v[196:199], v[220:223]
v_exp_f32 v202, v202
v_mfma_f32_16x16x32_bf16 v[220:223], a[112:115], v[224:227], v[220:223]
buffer_load_dwordx4 v243, s[16:19], s99 offen offset:1056 nt lds
v_mfma_f32_16x16x32_bf16 v[228:231], a[96:99], v[224:227], 0
s_add_u32 s99, s98, s51
ds_read_b128 v[212:215], v242 offset:16896
v_cvt_pk_bf16_f32 v128, v200, v201
v_mfma_f32_16x16x32_bf16 v[228:231], a[100:103], v[196:199], v[228:231]
v_exp_f32 v203, v203
v_mfma_f32_16x16x32_bf16 v[228:231], a[104:107], v[192:195], v[228:231]
v_cvt_pk_bf16_f32 v129, v202, v203
v_cvt_pk_bf16_f32 v14, v220, v221
v_mfma_f32_16x16x32_bf16 v[228:231], a[108:111], v[188:191], v[228:231]
v_cvt_pk_bf16_f32 v15, v222, v223
v_cvt_pk_bf16_f32 v122, v208, v209
v_mfma_f32_16x16x32_bf16 v[232:235], a[92:95], v[188:191], 0
ds_read_b128 v[220:223], v242 offset:17152
v_cvt_pk_bf16_f32 v123, v210, v211
v_mfma_f32_16x16x32_bf16 v[232:235], a[88:91], v[192:195], v[232:235]
v_exp_f32 v216, v216
v_mfma_f32_16x16x32_bf16 v[232:235], a[84:87], v[196:199], v[232:235]
v_cvt_pk_bf16_f32 v12, v228, v229
v_cvt_pk_bf16_f32 v13, v230, v231
v_mfma_f32_16x16x32_bf16 v[232:235], a[80:83], v[224:227], v[232:235]
ds_read_b128 v[228:231], v242 offset:17408
v_fmac_f32 v136, v168, v254
v_mfma_f32_16x16x32_bf16 v[200:203], a[64:67], v[224:227], 0
ds_read_b128 v[224:227], v242 offset:17664
v_fmac_f32 v137, v169, v254
v_mfma_f32_16x16x32_bf16 v[200:203], a[68:71], v[196:199], v[200:203]
v_exp_f32 v217, v217
v_mfma_f32_16x16x32_bf16 v[200:203], a[72:75], v[192:195], v[200:203]
v_cvt_pk_bf16_f32 v10, v232, v233
v_cvt_pk_bf16_f32 v11, v234, v235
v_mfma_f32_16x16x32_bf16 v[200:203], a[76:79], v[188:191], v[200:203]
v_exp_f32 v218, v218
v_mfma_f32_16x16x32_bf16 v[188:191], v[28:31], v[100:103], 0
v_exp_f32 v219, v219
v_mfma_f32_16x16x32_bf16 v[188:191], v[24:27], v[96:99], v[188:191]
s_waitcnt lgkmcnt(3)
v_cvt_pk_bf16_f32 v124, v216, v217
v_cvt_pk_bf16_f32 v125, v218, v219
v_mfma_f32_16x16x32_bf16 v[192:195], v[40:43], v[96:99], 0
v_cvt_pk_bf16_f32 v8, v200, v201
v_cvt_pk_bf16_f32 v9, v202, v203
v_mfma_f32_16x16x32_bf16 v[192:195], v[44:47], v[100:103], v[192:195]
s_waitcnt lgkmcnt(2)
v_exp_f32 v188, v188
v_mfma_f32_16x16x32_bf16 v[196:199], a[64:67], v[212:215], 0
s_waitcnt lgkmcnt(1)
v_exp_f32 v189, v189
v_mfma_f32_16x16x32_bf16 v[196:199], a[68:71], v[220:223], v[196:199]
s_waitcnt lgkmcnt(0)
v_exp_f32 v190, v190
v_mfma_f32_16x16x32_bf16 v[196:199], a[72:75], v[228:231], v[196:199]
v_exp_f32 v191, v191
v_mfma_f32_16x16x32_bf16 v[196:199], a[76:79], v[224:227], v[196:199]
buffer_load_dwordx4 v243, s[16:19], s100 offen offset:2112 nt lds
v_mfma_f32_16x16x32_bf16 v[200:203], a[92:95], v[224:227], 0
s_add_u32 s100, s99, s51
ds_read_b128 v[208:211], v242 offset:8960
ds_read_b128 v[216:219], v242 offset:9216
v_mfma_f32_16x16x32_bf16 v[200:203], a[88:91], v[228:231], v[200:203]
ds_read_b128 v[204:207], v242 offset:8704
v_cvt_pk_bf16_f32 v126, v188, v189
v_mfma_f32_16x16x32_bf16 v[200:203], a[84:87], v[220:223], v[200:203]
v_cvt_pk_bf16_f32 v32, v196, v197
v_cvt_pk_bf16_f32 v33, v198, v199
v_mfma_f32_16x16x32_bf16 v[200:203], a[80:83], v[212:215], v[200:203]
ds_read_b128 v[196:199], v242 offset:8448
v_cvt_pk_bf16_f32 v127, v190, v191
v_mfma_f32_16x16x32_bf16 v[232:235], a[96:99], v[212:215], 0
v_exp_f32 v192, v192
v_mfma_f32_16x16x32_bf16 v[232:235], a[100:103], v[220:223], v[232:235]
v_exp_f32 v193, v193
v_mfma_f32_16x16x32_bf16 v[232:235], a[104:107], v[228:231], v[232:235]
s_nop 0
v_cvt_pk_bf16_f32 v34, v200, v201
v_cvt_pk_bf16_f32 v35, v202, v203
v_mfma_f32_16x16x32_bf16 v[232:235], a[108:111], v[224:227], v[232:235]
v_exp_f32 v194, v194
v_mfma_f32_16x16x32_bf16 v[200:203], a[124:127], v[224:227], 0
v_exp_f32 v195, v195
v_mfma_f32_16x16x32_bf16 v[200:203], a[116:119], v[220:223], v[200:203]
v_cvt_pk_bf16_f32 v130, v192, v193
v_cvt_pk_bf16_f32 v131, v194, v195
v_mfma_f32_16x16x32_bf16 v[200:203], a[112:115], v[212:215], v[200:203]
s_waitcnt lgkmcnt(3)
v_fmac_f32 v144, v176, v254
v_fmac_f32 v145, v177, v254
v_mfma_f32_16x16x32_bf16 v[200:203], a[120:123], v[228:231], v[200:203]
s_waitcnt lgkmcnt(2)
v_fmac_f32 v138, v170, v254
v_fmac_f32 v139, v171, v254
v_mfma_f32_16x16x32_bf16 v[212:215], a[120:123], v[208:211], 0
s_waitcnt lgkmcnt(1)
v_cvt_pk_bf16_f32 v136, v136, v137
v_fmac_f32 v146, v178, v254
v_mfma_f32_16x16x32_bf16 v[212:215], a[124:127], v[216:219], v[212:215]
s_waitcnt lgkmcnt(0)
v_fmac_f32 v147, v179, v254
v_cvt_pk_bf16_f32 v144, v144, v145
v_mfma_f32_16x16x32_bf16 v[212:215], a[116:119], v[204:207], v[212:215]
v_cvt_pk_bf16_f32 v137, v138, v139
v_fmac_f32 v140, v172, v254
v_mfma_f32_16x16x32_bf16 v[212:215], a[112:115], v[196:199], v[212:215]
v_fmac_f32 v141, v173, v254
v_fmac_f32 v142, v174, v254
v_mfma_f32_16x16x32_bf16 v[188:191], a[96:99], v[196:199], 0
v_fmac_f32 v143, v175, v254
v_fmac_f32 v148, v180, v254
v_mfma_f32_16x16x32_bf16 v[188:191], a[100:103], v[204:207], v[188:191]
v_fmac_f32 v149, v181, v254
v_fmac_f32 v150, v182, v254
v_mfma_f32_16x16x32_bf16 v[188:191], a[104:107], v[208:211], v[188:191]
v_fmac_f32 v151, v183, v254
v_cvt_pk_bf16_f32 v145, v146, v147
v_mfma_f32_16x16x32_bf16 v[188:191], a[108:111], v[216:219], v[188:191]
v_cvt_pk_bf16_f32 v138, v140, v141
v_cvt_pk_bf16_f32 v139, v142, v143
v_mfma_f32_16x16x32_bf16 v[192:195], a[92:95], v[216:219], 0
v_cvt_pk_bf16_f32 v146, v148, v149
v_cvt_pk_bf16_f32 v147, v150, v151
v_mfma_f32_16x16x32_bf16 v[192:195], a[88:91], v[208:211], v[192:195]
v_pk_max_i16 v136, v136, 0
v_pk_max_i16 v137, v137, 0
v_mfma_f32_16x16x32_bf16 v[192:195], a[84:87], v[204:207], v[192:195]
v_cvt_pk_bf16_f32 v20, v188, v189
v_cvt_pk_bf16_f32 v21, v190, v191
v_mfma_f32_16x16x32_bf16 v[192:195], a[80:83], v[196:199], v[192:195]
v_pk_max_i16 v138, v138, 0
v_pk_max_i16 v139, v139, 0
v_mfma_f32_16x16x32_bf16 v[188:191], a[64:67], v[196:199], 0
v_pk_max_i16 v144, v144, 0
v_pk_max_i16 v145, v145, 0
v_mfma_f32_16x16x32_bf16 v[188:191], a[68:71], v[204:207], v[188:191]
v_pk_max_i16 v146, v146, 0
v_pk_max_i16 v147, v147, 0
v_mfma_f32_16x16x32_bf16 v[188:191], a[72:75], v[208:211], v[188:191]
v_mov_b64 v[140:141], v[136:137]
v_mov_b64 v[142:143], v[138:139]
v_mfma_f32_16x16x32_bf16 v[188:191], a[76:79], v[216:219], v[188:191]
v_mov_b32_dpp v136, v144 row_ror:8 row_mask:0xf bank_mask:0xc
v_mov_b32_dpp v137, v145 row_ror:8 row_mask:0xf bank_mask:0xc
v_mov_b32_dpp v138, v146 row_ror:8 row_mask:0xf bank_mask:0xc
v_mov_b32_dpp v139, v147 row_ror:8 row_mask:0xf bank_mask:0xc
v_mov_b32_dpp v144, v140 row_ror:8 row_mask:0xf bank_mask:0x3
v_mov_b32_dpp v145, v141 row_ror:8 row_mask:0xf bank_mask:0x3
v_mov_b32_dpp v146, v142 row_ror:8 row_mask:0xf bank_mask:0x3
v_mov_b32_dpp v147, v143 row_ror:8 row_mask:0xf bank_mask:0x3
v_mfma_f32_32x32x16_bf16 v[168:183], v[236:239], v[132:135], 0
buffer_store_dwordx4 v[136:139], v244, s[20:23], s52 offen offset:0 nt
buffer_store_dwordx4 v[144:147], v244, s[20:23], s52 offen offset:2048 nt
v_cvt_pk_bf16_f32 v38, v200, v201
v_mov_b64 v[200:201], 0
v_cvt_pk_bf16_f32 v39, v202, v203
v_cvt_pk_bf16_f32 v16, v188, v189
v_smfmac_f32_16x16x64_bf16 v[200:203], v[184:187], v[120:127], v251
s_add_u32 s52, s46, 20480
v_cvt_pk_bf16_f32 v17, v190, v191
v_smfmac_f32_16x16x64_bf16 v[200:203], v[184:187], v[128:135], v251 abid:1
v_cvt_pk_bf16_f32 v18, v192, v193
v_mfma_f32_16x16x32_bf16 v[168:171], v[80:83], v[128:131], v[168:171]
v_cvt_pk_bf16_f32 v19, v194, v195
v_cvt_pk_bf16_f32 v22, v212, v213
v_mfma_f32_16x16x32_bf16 v[168:171], v[64:67], v[124:127], v[168:171]
v_cvt_pk_bf16_f32 v23, v214, v215
v_cvt_pk_bf16_f32 v36, v232, v233
v_mfma_f32_16x16x32_bf16 v[168:171], v[48:51], v[120:123], v[168:171]
v_add_f32 v200, v200, v201
v_cvt_pk_bf16_f32 v37, v234, v235
v_mfma_f32_16x16x32_bf16 v[172:175], v[52:55], v[120:123], v[172:175]
v_rcp_f32 v254, v200
v_mfma_f32_16x16x32_bf16 v[172:175], v[68:71], v[124:127], v[172:175]
v_max3_f32 v255, v255, v200, v254
s_nop 0
v_mfma_f32_16x16x32_bf16 v[172:175], v[84:87], v[128:131], v[172:175]
v_fmac_f32 v152, v168, v254
v_fmac_f32 v153, v169, v254
v_mfma_f32_16x16x32_bf16 v[176:179], v[88:91], v[128:131], v[176:179]
v_fmac_f32 v154, v170, v254
v_fmac_f32 v155, v171, v254
v_mfma_f32_16x16x32_bf16 v[176:179], v[72:75], v[124:127], v[176:179]
v_cvt_pk_bf16_f32 v152, v152, v153
v_cvt_pk_bf16_f32 v153, v154, v155
v_mfma_f32_16x16x32_bf16 v[176:179], v[56:59], v[120:123], v[176:179]
v_fmac_f32 v156, v172, v254
v_fmac_f32 v157, v173, v254
v_mfma_f32_16x16x32_bf16 v[180:183], v[60:63], v[120:123], v[180:183]
v_fmac_f32 v158, v174, v254
v_fmac_f32 v159, v175, v254
v_mfma_f32_16x16x32_bf16 v[180:183], v[76:79], v[124:127], v[180:183]
v_cvt_pk_bf16_f32 v154, v156, v157
v_cvt_pk_bf16_f32 v155, v158, v159
v_mfma_f32_16x16x32_bf16 v[180:183], v[92:95], v[128:131], v[180:183]
v_fmac_f32 v160, v176, v254
v_fmac_f32 v161, v177, v254
v_mfma_f32_16x16x32_bf16 v[188:191], v[196:199], a[128:131], 0
v_fmac_f32 v162, v178, v254
v_fmac_f32 v163, v179, v254
v_mfma_f32_16x16x32_bf16 v[188:191], v[204:207], a[132:135], v[188:191]
v_cvt_pk_bf16_f32 v160, v160, v161
v_cvt_pk_bf16_f32 v161, v162, v163
v_mfma_f32_16x16x32_bf16 v[188:191], v[208:211], a[136:139], v[188:191]
v_fmac_f32 v164, v180, v254
v_fmac_f32 v165, v181, v254
v_mfma_f32_16x16x32_bf16 v[188:191], v[216:219], a[140:143], v[188:191]
v_fmac_f32 v166, v182, v254
v_fmac_f32 v167, v183, v254
v_mfma_f32_16x16x32_bf16 v[192:195], v[216:219], a[156:159], 0
ds_read_b128 v[200:203], v242 offset:12672
ds_read_b128 v[212:215], v242 offset:12928
v_mfma_f32_16x16x32_bf16 v[192:195], v[208:211], a[152:155], v[192:195]
ds_read_b128 v[220:223], v242 offset:13184
ds_read_b128 v[224:227], v242 offset:13440
v_mfma_f32_16x16x32_bf16 v[192:195], v[204:207], a[148:151], v[192:195]
v_cvt_pk_bf16_f32 v64, v188, v189
v_cvt_pk_bf16_f32 v65, v190, v191
v_mfma_f32_16x16x32_bf16 v[192:195], v[196:199], a[144:147], v[192:195]
v_cvt_pk_bf16_f32 v162, v164, v165
v_cvt_pk_bf16_f32 v163, v166, v167
v_mfma_f32_16x16x32_bf16 v[228:231], v[196:199], a[160:163], 0
v_pk_max_i16 v152, v152, 0
v_pk_max_i16 v153, v153, 0
v_mfma_f32_16x16x32_bf16 v[228:231], v[204:207], a[164:167], v[228:231]
v_pk_max_i16 v154, v154, 0
v_pk_max_i16 v155, v155, 0
v_mfma_f32_16x16x32_bf16 v[228:231], v[208:211], a[168:171], v[228:231]
v_cvt_pk_bf16_f32 v68, v192, v193
v_cvt_pk_bf16_f32 v69, v194, v195
v_mfma_f32_16x16x32_bf16 v[228:231], v[216:219], a[172:175], v[228:231]
v_pk_max_i16 v160, v160, 0
v_pk_max_i16 v161, v161, 0
v_mfma_f32_16x16x32_bf16 v[188:191], v[216:219], a[188:191], 0
v_pk_max_i16 v162, v162, 0
v_pk_max_i16 v163, v163, 0
v_mfma_f32_16x16x32_bf16 v[188:191], v[208:211], a[184:187], v[188:191]
v_mov_b64 v[156:157], v[152:153]
v_mov_b64 v[158:159], v[154:155]
v_mfma_f32_16x16x32_bf16 v[188:191], v[204:207], a[180:183], v[188:191]
s_waitcnt lgkmcnt(3)
v_cvt_pk_bf16_f32 v72, v228, v229
v_cvt_pk_bf16_f32 v73, v230, v231
v_mfma_f32_16x16x32_bf16 v[188:191], v[196:199], a[176:179], v[188:191]
buffer_load_dwordx4 v243, s[16:19], s101 offen offset:3168 nt lds
v_mfma_f32_16x16x32_bf16 v[196:199], a[64:67], v[200:203], 0
s_add_u32 m0, s49, 8448
v_mov_b32_dpp v152, v160 row_ror:8 row_mask:0xf bank_mask:0xc
s_waitcnt lgkmcnt(2)
v_mfma_f32_16x16x32_bf16 v[196:199], a[68:71], v[212:215], v[196:199]
s_add_u32 s101, s100, s51
v_mov_b32_dpp v153, v161 row_ror:8 row_mask:0xf bank_mask:0xc
s_waitcnt lgkmcnt(1)
v_mfma_f32_16x16x32_bf16 v[196:199], a[72:75], v[220:223], v[196:199]
s_waitcnt lgkmcnt(0)
v_cvt_pk_bf16_f32 v76, v188, v189
v_cvt_pk_bf16_f32 v77, v190, v191
v_mfma_f32_16x16x32_bf16 v[196:199], a[76:79], v[224:227], v[196:199]
v_mov_b32_dpp v154, v162 row_ror:8 row_mask:0xf bank_mask:0xc
v_mov_b32_dpp v155, v163 row_ror:8 row_mask:0xf bank_mask:0xc
v_mfma_f32_16x16x32_bf16 v[204:207], a[92:95], v[224:227], 0
v_mov_b32_dpp v160, v156 row_ror:8 row_mask:0xf bank_mask:0x3
v_mov_b32_dpp v161, v157 row_ror:8 row_mask:0xf bank_mask:0x3
v_mfma_f32_16x16x32_bf16 v[204:207], a[88:91], v[220:223], v[204:207]
v_mov_b32_dpp v162, v158 row_ror:8 row_mask:0xf bank_mask:0x3
v_mov_b32_dpp v163, v159 row_ror:8 row_mask:0xf bank_mask:0x3
v_mfma_f32_16x16x32_bf16 v[204:207], a[84:87], v[212:215], v[204:207]
v_cvt_pk_bf16_f32 v24, v196, v197
v_cvt_pk_bf16_f32 v25, v198, v199
v_mfma_f32_16x16x32_bf16 v[204:207], a[80:83], v[200:203], v[204:207]
s_nop 2
v_mfma_f32_16x16x32_bf16 v[188:191], a[96:99], v[200:203], 0
s_nop 2
v_mfma_f32_16x16x32_bf16 v[188:191], a[100:103], v[212:215], v[188:191]
v_cvt_pk_bf16_f32 v26, v204, v205
v_cvt_pk_bf16_f32 v27, v206, v207
v_mfma_f32_16x16x32_bf16 v[188:191], a[104:107], v[220:223], v[188:191]
v_mfma_f32_16x16x32_bf16 v[188:191], a[108:111], v[224:227], v[188:191]
s_nop 2
v_mfma_f32_16x16x32_bf16 v[192:195], a[124:127], v[224:227], 0
s_nop 2
v_mfma_f32_16x16x32_bf16 v[192:195], a[120:123], v[220:223], v[192:195]
v_cvt_pk_bf16_f32 v28, v188, v189
v_cvt_pk_bf16_f32 v29, v190, v191
v_mfma_f32_16x16x32_bf16 v[192:195], a[116:119], v[212:215], v[192:195]
v_mfma_f32_16x16x32_bf16 v[192:195], a[112:115], v[200:203], v[192:195]
s_nop 2
v_mfma_f32_16x16x32_bf16 v[188:191], v[200:203], a[128:131], 0
s_nop 2
v_mfma_f32_16x16x32_bf16 v[188:191], v[212:215], a[132:135], v[188:191]
v_cvt_pk_bf16_f32 v30, v192, v193
v_cvt_pk_bf16_f32 v31, v194, v195
v_mfma_f32_16x16x32_bf16 v[188:191], v[220:223], a[136:139], v[188:191]
v_mfma_f32_16x16x32_bf16 v[188:191], v[224:227], a[140:143], v[188:191]
buffer_load_dwordx4 v243, s[16:19], s98 offen offset:0 nt lds
v_mfma_f32_16x16x32_bf16 v[192:195], v[224:227], a[156:159], 0
s_add_u32 s98, s98, s48
ds_read_b128 v[196:199], v242 offset:21120
ds_read_b128 v[204:207], v242 offset:21376
v_mfma_f32_16x16x32_bf16 v[192:195], v[220:223], a[152:155], v[192:195]
ds_read_b128 v[208:211], v242 offset:21632
ds_read_b128 v[216:219], v242 offset:21888
v_mfma_f32_16x16x32_bf16 v[192:195], v[212:215], a[148:151], v[192:195]
v_cvt_pk_bf16_f32 v66, v188, v189
v_cvt_pk_bf16_f32 v67, v190, v191
v_mfma_f32_16x16x32_bf16 v[192:195], v[200:203], a[144:147], v[192:195]
s_nop 2
v_mfma_f32_16x16x32_bf16 v[188:191], v[200:203], a[160:163], 0
s_nop 2
v_mfma_f32_16x16x32_bf16 v[188:191], v[212:215], a[164:167], v[188:191]
v_cvt_pk_bf16_f32 v70, v192, v193
v_cvt_pk_bf16_f32 v71, v194, v195
v_mfma_f32_16x16x32_bf16 v[188:191], v[220:223], a[168:171], v[188:191]
v_mfma_f32_16x16x32_bf16 v[188:191], v[224:227], a[172:175], v[188:191]
s_nop 2
v_mfma_f32_16x16x32_bf16 v[192:195], v[224:227], a[188:191], 0
s_nop 2
v_mfma_f32_16x16x32_bf16 v[192:195], v[220:223], a[184:187], v[192:195]
v_cvt_pk_bf16_f32 v74, v188, v189
v_cvt_pk_bf16_f32 v75, v190, v191
v_mfma_f32_16x16x32_bf16 v[192:195], v[212:215], a[180:183], v[192:195]
s_waitcnt lgkmcnt(3)
v_mfma_f32_16x16x32_bf16 v[192:195], v[200:203], a[176:179], v[192:195]
s_waitcnt lgkmcnt(2)
s_nop 1
v_mfma_f32_16x16x32_bf16 v[188:191], a[64:67], v[196:199], 0
s_waitcnt lgkmcnt(1)
s_nop 1
v_mfma_f32_16x16x32_bf16 v[188:191], a[68:71], v[204:207], v[188:191]
s_waitcnt lgkmcnt(0)
v_cvt_pk_bf16_f32 v78, v192, v193
v_cvt_pk_bf16_f32 v79, v194, v195
v_mfma_f32_16x16x32_bf16 v[188:191], a[72:75], v[208:211], v[188:191]
v_mfma_f32_16x16x32_bf16 v[188:191], a[76:79], v[216:219], v[188:191]
ds_read_b128 v[238:241], v245 offset:0
ds_read2_b32 v[236:237], v246 offset0:0 offset1:8
v_mfma_f32_16x16x32_bf16 v[192:195], a[92:95], v[216:219], 0
v_add_u32 v245, 1728, v245
v_add_u32 v246, 1728, v246
v_mfma_f32_16x16x32_bf16 v[192:195], a[88:91], v[208:211], v[192:195]
s_nop 1
v_cvt_pk_bf16_f32 v40, v188, v189
v_mfma_f32_16x16x32_bf16 v[192:195], a[84:87], v[204:207], v[192:195]
v_cvt_pk_bf16_f32 v41, v190, v191
v_mfma_f32_16x16x32_bf16 v[192:195], a[80:83], v[196:199], v[192:195]
buffer_load_dwordx4 v243, s[16:19], s99 offen offset:1056 nt lds
v_mfma_f32_16x16x32_bf16 v[188:191], a[96:99], v[196:199], 0
s_add_u32 s99, s98, s51
s_nop 1
v_mfma_f32_16x16x32_bf16 v[188:191], a[100:103], v[204:207], v[188:191]
s_nop 1
v_cvt_pk_bf16_f32 v42, v192, v193
v_mfma_f32_16x16x32_bf16 v[188:191], a[104:107], v[208:211], v[188:191]
v_cvt_pk_bf16_f32 v43, v194, v195
v_mfma_f32_16x16x32_bf16 v[188:191], a[108:111], v[216:219], v[188:191]
ds_read_b128 v[192:195], v247 offset:0
v_add_u32 v247, 1728, v247
v_mfma_f32_16x16x32_bf16 v[200:203], a[124:127], v[216:219], 0
s_nop 2
v_mfma_f32_16x16x32_bf16 v[200:203], a[120:123], v[208:211], v[200:203]
s_nop 0
v_cvt_pk_bf16_f32 v44, v188, v189
v_cvt_pk_bf16_f32 v45, v190, v191
v_mfma_f32_16x16x32_bf16 v[200:203], a[116:119], v[204:207], v[200:203]
v_mfma_f32_16x16x32_bf16 v[200:203], a[112:115], v[196:199], v[200:203]
s_nop 2
v_mfma_f32_16x16x32_bf16 v[188:191], a[0:3], v[196:199], 0
s_waitcnt lgkmcnt(1)
s_nop 1
v_mfma_f32_16x16x32_bf16 v[188:191], a[4:7], v[204:207], v[188:191]
v_cvt_pk_bf16_f32 v46, v200, v201
v_cvt_pk_bf16_f32 v47, v202, v203
v_mfma_f32_16x16x32_bf16 v[188:191], a[8:11], v[208:211], v[188:191]
v_mfma_f32_16x16x32_bf16 v[188:191], a[12:15], v[216:219], v[188:191]
s_nop 2
v_mfma_f32_16x16x32_bf16 v[200:203], a[28:31], v[216:219], 0
s_nop 2
v_mfma_f32_16x16x32_bf16 v[200:203], a[24:27], v[208:211], v[200:203]
v_cvt_pk_bf16_f32 v96, v188, v189
v_cvt_pk_bf16_f32 v97, v190, v191
v_mfma_f32_16x16x32_bf16 v[200:203], a[20:23], v[204:207], v[200:203]
v_mfma_f32_16x16x32_bf16 v[200:203], a[16:19], v[196:199], v[200:203]
v_mov_b64 v[168:169], 0
v_mov_b64 v[170:171], 0
v_mfma_f32_16x16x32_bf16 v[188:191], a[32:35], v[196:199], 0
s_waitcnt lgkmcnt(0)
v_mov_b64 v[172:173], 0
v_mov_b64 v[174:175], 0
v_mfma_f32_16x16x32_bf16 v[188:191], a[36:39], v[204:207], v[188:191]
v_mov_b64 v[176:177], 0
v_mov_b64 v[178:179], 0
v_mfma_f32_16x16x32_bf16 v[188:191], a[40:43], v[208:211], v[188:191]
v_cvt_pk_bf16_f32 v98, v200, v201
v_cvt_pk_bf16_f32 v99, v202, v203
v_mfma_f32_16x16x32_bf16 v[188:191], a[44:47], v[216:219], v[188:191]
s_nop 2
v_smfmac_f32_16x16x64_bf16 v[168:171], v[192:195], v[0:7], v251
s_nop 2
v_smfmac_f32_16x16x64_bf16 v[172:175], v[192:195], v[16:23], v251
v_cvt_pk_bf16_f32 v100, v188, v189
v_smfmac_f32_16x16x64_bf16 v[176:179], v[192:195], v[32:39], v251
v_cvt_pk_bf16_f32 v101, v190, v191
v_mfma_f32_16x16x32_bf16 v[188:191], a[60:63], v[216:219], 0
v_add_f32 v168, v168, v169
v_mfma_f32_16x16x32_bf16 v[188:191], a[56:59], v[208:211], v[188:191]
v_exp_f32 v168, v168
v_mfma_f32_16x16x32_bf16 v[188:191], a[52:55], v[204:207], v[188:191]
v_mfma_f32_16x16x32_bf16 v[188:191], a[48:51], v[196:199], v[188:191]
s_nop 2
v_smfmac_f32_16x16x64_bf16 v[170:173], v[192:195], v[8:15], v251
s_nop 2
v_smfmac_f32_16x16x64_bf16 v[174:177], v[192:195], v[24:31], v251
v_cvt_pk_bf16_f32 v102, v188, v189
v_smfmac_f32_16x16x64_bf16 v[178:181], v[192:195], v[40:47], v251
v_cvt_pk_bf16_f32 v103, v190, v191
v_mfma_f32_16x16x32_bf16 v[136:139], a[192:195], v[196:199], 0
v_add_f32 v170, v170, v171
v_add_f32 v172, v172, v173
v_mfma_f32_16x16x32_bf16 v[136:139], a[196:199], v[204:207], v[136:139]
v_exp_f32 v170, v170
v_mfma_f32_16x16x32_bf16 v[136:139], a[200:203], v[208:211], v[136:139]
v_exp_f32 v172, v172
v_mfma_f32_16x16x32_bf16 v[136:139], a[204:207], v[216:219], v[136:139]
buffer_load_dwordx4 v243, s[16:19], s100 offen offset:2112 nt lds
v_mfma_f32_16x16x32_bf16 v[140:143], a[220:223], v[216:219], 0
s_add_u32 s100, s99, s51
v_add_f32 v174, v174, v175
v_add_f32 v176, v176, v177
v_mfma_f32_16x16x32_bf16 v[140:143], a[216:219], v[208:211], v[140:143]
v_exp_f32 v174, v174
v_mfma_f32_16x16x32_bf16 v[140:143], a[212:215], v[204:207], v[140:143]
v_exp_f32 v176, v176
v_mfma_f32_16x16x32_bf16 v[140:143], a[208:211], v[196:199], v[140:143]
v_add_f32 v178, v178, v179
v_add_f32 v180, v168, v170
v_mfma_f32_16x16x32_bf16 v[144:147], a[224:227], v[196:199], 0
v_cvt_pk_bf16_f32 v169, v168, v170
v_add_f32 v180, v180, v172
v_mfma_f32_16x16x32_bf16 v[144:147], a[228:231], v[204:207], v[144:147]
ds_write_b16 v248, v169 offset:0
v_mfma_f32_16x16x32_bf16 v[144:147], a[232:235], v[208:211], v[144:147]
ds_write_b16_d16_hi v248, v169 offset:4
v_mfma_f32_16x16x32_bf16 v[144:147], a[236:239], v[216:219], v[144:147]
v_mov_b64 v[188:189], s[96:97]
v_mov_b64 v[190:191], s[96:97]
v_mfma_f32_16x16x32_bf16 v[148:151], a[252:255], v[216:219], 0
v_exp_f32 v178, v178
v_mfma_f32_16x16x32_bf16 v[148:151], a[248:251], v[208:211], v[148:151]
v_add_f32 v180, v180, v174
v_add_f32 v180, v180, v176
v_mfma_f32_16x16x32_bf16 v[148:151], a[244:247], v[204:207], v[148:151]
v_add_f32 v180, v180, v178
v_cvt_pk_bf16_f32 v173, v172, v174
v_mfma_f32_16x16x32_bf16 v[148:151], a[240:243], v[196:199], v[148:151]
ds_write_b16 v248, v173 offset:272
v_smfmac_f32_16x16x64_bf16 v[188:191], v[238:241], v[96:103], v251
ds_write_b16_d16_hi v248, v173 offset:276
v_mfma_f32_16x16x32_bf16 v[192:195], v[0:3], v[96:99], 0
v_add_f32_dpp v180, v180, v180 row_ror:8 row_mask:0xf bank_mask:0xf
v_cvt_pk_bf16_f32 v177, v176, v178
v_mfma_f32_16x16x32_bf16 v[192:195], v[4:7], v[100:103], v[192:195]
ds_write_b16 v248, v177 offset:544
v_mfma_f32_16x16x32_bf16 v[200:203], v[196:199], a[128:131], 0
ds_write_b16_d16_hi v248, v177 offset:548
v_mfma_f32_16x16x32_bf16 v[200:203], v[204:207], a[132:135], v[200:203]
v_add_f32 v188, v188, v189
v_add_f32 v190, v190, v191
v_mfma_f32_16x16x32_bf16 v[200:203], v[208:211], a[136:139], v[200:203]
v_exp_f32 v188, v188
v_mfma_f32_16x16x32_bf16 v[200:203], v[216:219], a[140:143], v[200:203]
buffer_load_dwordx4 v243, s[16:19], s101 offen offset:3168 nt lds
v_mfma_f32_16x16x32_bf16 v[212:215], v[216:219], a[156:159], 0
s_add_u32 m0, s49, 16896
ds_read_b128 v[232:235], v242 offset:768
v_add_f32_dpp v180, v180, v180 row_ror:4 row_mask:0xf bank_mask:0xf
v_mfma_f32_16x16x32_bf16 v[212:215], v[208:211], a[152:155], v[212:215]
s_add_u32 s101, s100, s51
ds_write_b32 v250, v180 offset:256
v_mfma_f32_16x16x32_bf16 v[212:215], v[204:207], a[148:151], v[212:215]
s_and_b32 s51, s57, 13106176
ds_read_b128 v[220:223], v242 offset:512
v_cvt_pk_bf16_f32 v82, v200, v201
v_mfma_f32_16x16x32_bf16 v[212:215], v[196:199], a[144:147], v[212:215]
s_sub_u32 s49, s49, s56
ds_read_b128 v[224:227], v242 offset:256
v_cvt_pk_bf16_f32 v83, v202, v203
v_mfma_f32_16x16x32_bf16 v[200:203], v[196:199], a[160:163], 0
s_lshl3_add_u32 s48, s51, 8192
ds_read_b128 v[228:231], v242 offset:0
s_sub_u32 s51, s51, 32
v_mfma_f32_16x16x32_bf16 v[200:203], v[204:207], a[164:167], v[200:203]
v_exp_f32 v190, v190
v_mfma_f32_16x16x32_bf16 v[200:203], v[208:211], a[168:171], v[200:203]
v_perm_b32 v116, v190, v188, v252
v_perm_b32 v117, v190, v188, v253
v_mfma_f32_16x16x32_bf16 v[200:203], v[216:219], a[172:175], v[200:203]
v_exp_f32 v192, v192
v_mfma_f32_16x16x32_bf16 v[188:191], v[216:219], a[188:191], 0
v_exp_f32 v193, v193
v_mfma_f32_16x16x32_bf16 v[188:191], v[208:211], a[184:187], v[188:191]
v_exp_f32 v194, v194
v_mfma_f32_16x16x32_bf16 v[188:191], v[204:207], a[180:183], v[188:191]
v_exp_f32 v195, v195
v_mfma_f32_16x16x32_bf16 v[188:191], v[196:199], a[176:179], v[188:191]
v_cvt_pk_bf16_f32 v104, v192, v193
v_cvt_pk_bf16_f32 v105, v194, v195
v_mfma_f32_16x16x32_bf16 v[196:199], v[12:15], v[100:103], 0
v_cvt_pk_bf16_f32 v90, v200, v201
v_cvt_pk_bf16_f32 v91, v202, v203
v_mfma_f32_16x16x32_bf16 v[196:199], v[8:11], v[96:99], v[196:199]
s_waitcnt lgkmcnt(4)
v_cvt_pk_bf16_f32 v86, v212, v213
v_cvt_pk_bf16_f32 v94, v188, v189
v_mfma_f32_16x16x32_bf16 v[192:195], v[16:19], v[96:99], 0
v_cvt_pk_bf16_f32 v95, v190, v191
v_cvt_pk_bf16_f32 v87, v214, v215
v_mfma_f32_16x16x32_bf16 v[192:195], v[20:23], v[100:103], v[192:195]
s_waitcnt lgkmcnt(2)
v_exp_f32 v196, v196
v_mfma_f32_32x32x16_bf16 v[168:183], v[236:239], v[116:119], 0
buffer_store_dwordx4 v[152:155], v244, s[20:23], s53 offen offset:0 nt
buffer_store_dwordx4 v[160:163], v244, s[20:23], s53 offen offset:2048 nt
v_exp_f32 v197, v197
v_exp_f32 v198, v198
v_mfma_f32_16x16x32_bf16 v[188:191], v[232:235], a[188:191], 0
s_waitcnt lgkmcnt(0)
v_exp_f32 v192, v192
v_mfma_f32_16x16x32_bf16 v[188:191], v[220:223], a[184:187], v[188:191]
s_add_u32 s53, s46, 0
v_exp_f32 v193, v193
v_mfma_f32_16x16x32_bf16 v[188:191], v[224:227], a[180:183], v[188:191]
v_exp_f32 v194, v194
v_mfma_f32_16x16x32_bf16 v[188:191], v[228:231], a[176:179], v[188:191]
v_exp_f32 v195, v195
v_mfma_f32_16x16x32_bf16 v[200:203], v[228:231], a[160:163], 0
v_cvt_pk_bf16_f32 v108, v192, v193
v_cvt_pk_bf16_f32 v109, v194, v195
v_mfma_f32_16x16x32_bf16 v[200:203], v[224:227], a[164:167], v[200:203]
v_exp_f32 v199, v199
v_mfma_f32_16x16x32_bf16 v[200:203], v[220:223], a[168:171], v[200:203]
s_nop 0
v_cvt_pk_bf16_f32 v60, v188, v189
v_cvt_pk_bf16_f32 v61, v190, v191
v_mfma_f32_16x16x32_bf16 v[200:203], v[232:235], a[172:175], v[200:203]
v_cvt_pk_bf16_f32 v106, v196, v197
v_cvt_pk_bf16_f32 v107, v198, v199
v_mfma_f32_16x16x32_bf16 v[188:191], v[232:235], a[156:159], 0
s_nop 2
v_mfma_f32_16x16x32_bf16 v[188:191], v[220:223], a[152:155], v[188:191]
s_nop 0
v_cvt_pk_bf16_f32 v56, v200, v201
v_cvt_pk_bf16_f32 v57, v202, v203
v_mfma_f32_16x16x32_bf16 v[188:191], v[224:227], a[148:151], v[188:191]
v_mfma_f32_16x16x32_bf16 v[188:191], v[228:231], a[144:147], v[188:191]
s_nop 2
v_mfma_f32_16x16x32_bf16 v[192:195], v[228:231], a[128:131], 0
s_nop 2
v_mfma_f32_16x16x32_bf16 v[192:195], v[224:227], a[132:135], v[192:195]
v_cvt_pk_bf16_f32 v52, v188, v189
v_cvt_pk_bf16_f32 v53, v190, v191
v_mfma_f32_16x16x32_bf16 v[192:195], v[220:223], a[136:139], v[192:195]
v_mfma_f32_16x16x32_bf16 v[192:195], v[232:235], a[140:143], v[192:195]
s_nop 2
v_mfma_f32_16x16x32_bf16 v[188:191], v[24:27], v[96:99], 0
s_nop 2
v_mfma_f32_16x16x32_bf16 v[188:191], v[28:31], v[100:103], v[188:191]
v_cvt_pk_bf16_f32 v48, v192, v193
v_cvt_pk_bf16_f32 v49, v194, v195
v_mfma_f32_16x16x32_bf16 v[192:195], v[36:39], v[100:103], 0
s_nop 2
v_mfma_f32_16x16x32_bf16 v[192:195], v[32:35], v[96:99], v[192:195]
s_nop 0
v_exp_f32 v188, v188
v_mfma_f32_16x16x32_bf16 v[196:199], v[40:43], v[96:99], 0
v_exp_f32 v189, v189
v_mfma_f32_16x16x32_bf16 v[196:199], v[44:47], v[100:103], v[196:199]
v_exp_f32 v190, v190
v_mfma_f32_16x16x32_bf16 v[200:203], a[0:3], v[228:231], 0
v_exp_f32 v191, v191
v_mfma_f32_16x16x32_bf16 v[200:203], a[4:7], v[224:227], v[200:203]
v_cvt_pk_bf16_f32 v110, v188, v189
v_cvt_pk_bf16_f32 v111, v190, v191
v_mfma_f32_16x16x32_bf16 v[200:203], a[8:11], v[220:223], v[200:203]
v_exp_f32 v192, v192
v_mfma_f32_16x16x32_bf16 v[200:203], a[12:15], v[232:235], v[200:203]
buffer_load_dwordx4 v243, s[16:19], s98 offen offset:0 nt lds
v_mfma_f32_16x16x32_bf16 v[188:191], a[28:31], v[232:235], 0
v_exp_f32 v193, v193
v_mfma_f32_16x16x32_bf16 v[188:191], a[24:27], v[220:223], v[188:191]
v_exp_f32 v194, v194
v_mfma_f32_16x16x32_bf16 v[188:191], a[20:23], v[224:227], v[188:191]
v_exp_f32 v195, v195
v_mfma_f32_16x16x32_bf16 v[188:191], a[16:19], v[228:231], v[188:191]
v_cvt_pk_bf16_f32 v96, v200, v201
v_cvt_pk_bf16_f32 v97, v202, v203
v_mfma_f32_16x16x32_bf16 v[200:203], a[32:35], v[228:231], 0
v_cvt_pk_bf16_f32 v112, v192, v193
v_cvt_pk_bf16_f32 v113, v194, v195
v_mfma_f32_16x16x32_bf16 v[200:203], a[36:39], v[224:227], v[200:203]
v_exp_f32 v196, v196
v_mfma_f32_16x16x32_bf16 v[200:203], a[40:43], v[220:223], v[200:203]
v_cvt_pk_bf16_f32 v98, v188, v189
v_cvt_pk_bf16_f32 v99, v190, v191
v_mfma_f32_16x16x32_bf16 v[200:203], a[44:47], v[232:235], v[200:203]
v_exp_f32 v197, v197
v_mfma_f32_16x16x32_bf16 v[188:191], a[60:63], v[232:235], 0
v_exp_f32 v198, v198
v_mfma_f32_16x16x32_bf16 v[188:191], a[56:59], v[220:223], v[188:191]
v_exp_f32 v199, v199
v_mfma_f32_16x16x32_bf16 v[188:191], a[52:55], v[224:227], v[188:191]
v_cvt_pk_bf16_f32 v114, v196, v197
v_cvt_pk_bf16_f32 v115, v198, v199
v_mfma_f32_16x16x32_bf16 v[188:191], a[48:51], v[228:231], v[188:191]
v_cvt_pk_bf16_f32 v100, v200, v201
v_cvt_pk_bf16_f32 v101, v202, v203
v_mfma_f32_16x16x32_bf16 v[152:155], a[192:195], v[228:231], 0
s_nop 2
v_mfma_f32_16x16x32_bf16 v[152:155], a[196:199], v[224:227], v[152:155]
s_nop 0
v_cvt_pk_bf16_f32 v102, v188, v189
v_cvt_pk_bf16_f32 v103, v190, v191
v_mfma_f32_16x16x32_bf16 v[152:155], a[200:203], v[220:223], v[152:155]
v_mfma_f32_16x16x32_bf16 v[152:155], a[204:207], v[232:235], v[152:155]
v_mfma_f32_16x16x32_bf16 v[156:159], a[220:223], v[232:235], 0
ds_read_b128 v[188:191], v242 offset:4224
ds_read_b128 v[192:195], v242 offset:4480
v_mfma_f32_16x16x32_bf16 v[156:159], a[216:219], v[220:223], v[156:159]
ds_read_b128 v[196:199], v242 offset:4736
ds_read_b128 v[200:203], v242 offset:4992
v_mfma_f32_16x16x32_bf16 v[156:159], a[212:215], v[224:227], v[156:159]
v_mfma_f32_16x16x32_bf16 v[156:159], a[208:211], v[228:231], v[156:159]
buffer_load_dwordx4 v243, s[16:19], s99 offen offset:1056 nt lds
v_mfma_f32_16x16x32_bf16 v[160:163], a[224:227], v[228:231], 0
v_mfma_f32_16x16x32_bf16 v[160:163], a[228:231], v[224:227], v[160:163]
v_mfma_f32_16x16x32_bf16 v[160:163], a[232:235], v[220:223], v[160:163]
s_waitcnt lgkmcnt(2)
v_mfma_f32_16x16x32_bf16 v[160:163], a[236:239], v[232:235], v[160:163]
v_mov_b64 v[204:205], s[96:97]
v_mov_b64 v[206:207], s[96:97]
v_mfma_f32_16x16x32_bf16 v[164:167], a[252:255], v[232:235], 0
v_mfma_f32_16x16x32_bf16 v[164:167], a[248:251], v[220:223], v[164:167]
v_mfma_f32_16x16x32_bf16 v[164:167], a[244:247], v[224:227], v[164:167]
v_mfma_f32_16x16x32_bf16 v[164:167], a[240:243], v[228:231], v[164:167]
v_smfmac_f32_16x16x64_bf16 v[204:207], v[238:241], v[96:103], v251
s_nop 2
v_mfma_f32_16x16x32_bf16 v[208:211], v[0:3], v[96:99], 0
s_nop 2
v_mfma_f32_16x16x32_bf16 v[208:211], v[4:7], v[100:103], v[208:211]
s_waitcnt lgkmcnt(0)
v_add_f32 v204, v204, v205
v_add_f32 v206, v206, v207
v_mfma_f32_16x16x32_bf16 v[212:215], v[12:15], v[100:103], 0
v_exp_f32 v204, v204
v_mfma_f32_16x16x32_bf16 v[212:215], v[8:11], v[96:99], v[212:215]
v_exp_f32 v206, v206
v_mfma_f32_16x16x32_bf16 v[216:219], v[188:191], a[128:131], 0
v_perm_b32 v132, v206, v204, v252
v_perm_b32 v133, v206, v204, v253
v_mfma_f32_16x16x32_bf16 v[216:219], v[192:195], a[132:135], v[216:219]
v_exp_f32 v208, v208
v_mfma_f32_16x16x32_bf16 v[216:219], v[196:199], a[136:139], v[216:219]
v_exp_f32 v209, v209
v_mfma_f32_16x16x32_bf16 v[216:219], v[200:203], a[140:143], v[216:219]
v_exp_f32 v210, v210
v_mfma_f32_16x16x32_bf16 v[204:207], v[200:203], a[156:159], 0
ds_read_b128 v[232:235], v242 offset:17664
v_cvt_pk_bf16_f32 v120, v208, v209
v_mfma_f32_16x16x32_bf16 v[204:207], v[196:199], a[152:155], v[204:207]
ds_read_b128 v[220:223], v242 offset:17408
ds_read_b128 v[224:227], v242 offset:17152
v_mfma_f32_16x16x32_bf16 v[204:207], v[192:195], a[148:151], v[204:207]
ds_read_b128 v[228:231], v242 offset:16896
v_cvt_pk_bf16_f32 v50, v216, v217
v_mfma_f32_16x16x32_bf16 v[204:207], v[188:191], a[144:147], v[204:207]
v_exp_f32 v211, v211
s_nop 0
v_cvt_pk_bf16_f32 v121, v210, v211
v_mfma_f32_16x16x32_bf16 v[208:211], v[188:191], a[160:163], 0
v_cvt_pk_bf16_f32 v51, v218, v219
s_nop 0
v_mfma_f32_16x16x32_bf16 v[208:211], v[192:195], a[164:167], v[208:211]
s_nop 0
v_cvt_pk_bf16_f32 v54, v204, v205
v_cvt_pk_bf16_f32 v55, v206, v207
v_mfma_f32_16x16x32_bf16 v[208:211], v[196:199], a[168:171], v[208:211]
v_exp_f32 v212, v212
v_mfma_f32_16x16x32_bf16 v[208:211], v[200:203], a[172:175], v[208:211]
v_mov_b64 v[204:205], 0
s_nop 0
v_mfma_f32_16x16x32_bf16 v[216:219], v[200:203], a[188:191], 0
v_exp_f32 v213, v213
v_mfma_f32_16x16x32_bf16 v[216:219], v[196:199], a[184:187], v[216:219]
v_exp_f32 v214, v214
v_mfma_f32_16x16x32_bf16 v[216:219], v[192:195], a[180:183], v[216:219]
s_nop 0
v_cvt_pk_bf16_f32 v58, v208, v209
v_cvt_pk_bf16_f32 v59, v210, v211
v_mfma_f32_16x16x32_bf16 v[216:219], v[188:191], a[176:179], v[216:219]
v_exp_f32 v215, v215
v_smfmac_f32_16x16x64_bf16 v[204:207], v[184:187], v[104:111], v251
v_cvt_pk_bf16_f32 v122, v212, v213
v_smfmac_f32_16x16x64_bf16 v[204:207], v[184:187], v[112:119], v251 abid:1
s_waitcnt lgkmcnt(3)
v_cvt_pk_bf16_f32 v123, v214, v215
v_mfma_f32_16x16x32_bf16 v[188:191], v[16:19], v[96:99], 0
s_waitcnt lgkmcnt(1)
v_cvt_pk_bf16_f32 v62, v216, v217
v_cvt_pk_bf16_f32 v63, v218, v219
v_mfma_f32_16x16x32_bf16 v[188:191], v[20:23], v[100:103], v[188:191]
s_waitcnt lgkmcnt(0)
v_add_f32 v204, v204, v205
s_nop 0
v_mfma_f32_16x16x32_bf16 v[192:195], v[28:31], v[100:103], 0
v_rcp_f32 v254, v204
v_mfma_f32_16x16x32_bf16 v[192:195], v[24:27], v[96:99], v[192:195]
v_max3_f32 v255, v255, v204, v254
s_nop 0
v_mfma_f32_16x16x32_bf16 v[196:199], v[32:35], v[96:99], 0
v_exp_f32 v188, v188
v_mfma_f32_16x16x32_bf16 v[196:199], v[36:39], v[100:103], v[196:199]
v_exp_f32 v189, v189
v_mfma_f32_16x16x32_bf16 v[200:203], v[232:235], a[188:191], 0
v_exp_f32 v190, v190
v_mfma_f32_16x16x32_bf16 v[200:203], v[220:223], a[184:187], v[200:203]
v_exp_f32 v191, v191
v_mfma_f32_16x16x32_bf16 v[200:203], v[224:227], a[180:183], v[200:203]
v_cvt_pk_bf16_f32 v124, v188, v189
v_cvt_pk_bf16_f32 v125, v190, v191
v_mfma_f32_16x16x32_bf16 v[200:203], v[228:231], a[176:179], v[200:203]
buffer_load_dwordx4 v243, s[16:19], s100 offen offset:2112 nt lds
v_mfma_f32_16x16x32_bf16 v[204:207], v[228:231], a[160:163], 0
v_exp_f32 v192, v192
v_mfma_f32_16x16x32_bf16 v[204:207], v[224:227], a[164:167], v[204:207]
v_exp_f32 v193, v193
v_mfma_f32_16x16x32_bf16 v[204:207], v[220:223], a[168:171], v[204:207]
v_exp_f32 v194, v194
v_mfma_f32_16x16x32_bf16 v[204:207], v[232:235], a[172:175], v[204:207]
buffer_load_dwordx4 v243, s[16:19], s101 offen offset:3168 nt lds
v_mfma_f32_16x16x32_bf16 v[208:211], v[232:235], a[156:159], 0
s_mov_b32 m0, s58
v_exp_f32 v195, v195
v_mfma_f32_16x16x32_bf16 v[208:211], v[220:223], a[152:155], v[208:211]
v_cvt_pk_bf16_f32 v126, v192, v193
v_cvt_pk_bf16_f32 v127, v194, v195
v_mfma_f32_16x16x32_bf16 v[208:211], v[224:227], a[148:151], v[208:211]
v_cvt_pk_bf16_f32 v88, v204, v205
v_cvt_pk_bf16_f32 v89, v206, v207
v_mfma_f32_16x16x32_bf16 v[208:211], v[228:231], a[144:147], v[208:211]
v_cvt_pk_bf16_f32 v92, v200, v201
v_cvt_pk_bf16_f32 v93, v202, v203
v_mfma_f32_16x16x32_bf16 v[188:191], v[228:231], a[128:131], 0
v_exp_f32 v196, v196
v_mfma_f32_16x16x32_bf16 v[188:191], v[224:227], a[132:135], v[188:191]
v_exp_f32 v197, v197
v_mfma_f32_16x16x32_bf16 v[188:191], v[220:223], a[136:139], v[188:191]
s_nop 0
v_cvt_pk_bf16_f32 v84, v208, v209
v_cvt_pk_bf16_f32 v85, v210, v211
v_mfma_f32_16x16x32_bf16 v[188:191], v[232:235], a[140:143], v[188:191]
v_exp_f32 v198, v198
v_mfma_f32_16x16x32_bf16 v[192:195], v[40:43], v[96:99], 0
v_exp_f32 v199, v199
v_mfma_f32_16x16x32_bf16 v[192:195], v[44:47], v[100:103], v[192:195]
v_cvt_pk_bf16_f32 v128, v196, v197
v_cvt_pk_bf16_f32 v129, v198, v199
v_mfma_f32_16x16x32_bf16 v[168:171], v[48:51], v[104:107], v[168:171]
s_nop 0
v_cvt_pk_bf16_f32 v80, v188, v189
v_cvt_pk_bf16_f32 v81, v190, v191
v_mfma_f32_16x16x32_bf16 v[168:171], v[64:67], v[108:111], v[168:171]
s_nop 0
v_exp_f32 v192, v192
v_mfma_f32_16x16x32_bf16 v[168:171], v[80:83], v[112:115], v[168:171]
v_exp_f32 v193, v193
v_mfma_f32_16x16x32_bf16 v[172:175], v[84:87], v[112:115], v[172:175]
v_exp_f32 v194, v194
v_mfma_f32_16x16x32_bf16 v[172:175], v[52:55], v[104:107], v[172:175]
v_exp_f32 v195, v195
v_mfma_f32_16x16x32_bf16 v[172:175], v[68:71], v[108:111], v[172:175]
v_cvt_pk_bf16_f32 v130, v192, v193
v_cvt_pk_bf16_f32 v131, v194, v195
L_entryf:
v_mfma_f32_16x16x32_bf16 v[176:179], v[72:75], v[108:111], v[176:179]
v_fmac_f32 v136, v168, v254
v_fmac_f32 v137, v169, v254
v_mfma_f32_16x16x32_bf16 v[176:179], v[88:91], v[112:115], v[176:179]
v_fmac_f32 v138, v170, v254
v_fmac_f32 v139, v171, v254
v_mfma_f32_16x16x32_bf16 v[176:179], v[56:59], v[104:107], v[176:179]
v_cvt_pk_bf16_f32 v136, v136, v137
v_fmac_f32 v140, v172, v254
v_mfma_f32_16x16x32_bf16 v[180:183], v[60:63], v[104:107], v[180:183]
v_fmac_f32 v141, v173, v254
v_fmac_f32 v142, v174, v254
v_mfma_f32_16x16x32_bf16 v[180:183], v[76:79], v[108:111], v[180:183]
v_fmac_f32 v143, v175, v254
v_cvt_pk_bf16_f32 v137, v138, v139
v_mfma_f32_16x16x32_bf16 v[180:183], v[92:95], v[112:115], v[180:183]
v_fmac_f32 v144, v176, v254
v_fmac_f32 v145, v177, v254
v_mfma_f32_16x16x32_bf16 v[188:191], a[0:3], v[228:231], 0
v_fmac_f32 v146, v178, v254
v_fmac_f32 v147, v179, v254
v_mfma_f32_16x16x32_bf16 v[188:191], a[4:7], v[224:227], v[188:191]
v_cvt_pk_bf16_f32 v144, v144, v145
v_cvt_pk_bf16_f32 v145, v146, v147
v_mfma_f32_16x16x32_bf16 v[188:191], a[8:11], v[220:223], v[188:191]
v_fmac_f32 v148, v180, v254
v_fmac_f32 v149, v181, v254
v_mfma_f32_16x16x32_bf16 v[188:191], a[12:15], v[232:235], v[188:191]
v_fmac_f32 v150, v182, v254
v_fmac_f32 v151, v183, v254
v_mfma_f32_16x16x32_bf16 v[192:195], a[28:31], v[232:235], 0
v_cvt_pk_bf16_f32 v138, v140, v141
v_cvt_pk_bf16_f32 v139, v142, v143
v_mfma_f32_16x16x32_bf16 v[192:195], a[24:27], v[220:223], v[192:195]
v_cvt_pk_bf16_f32 v146, v148, v149
v_cvt_pk_bf16_f32 v147, v150, v151
v_mfma_f32_16x16x32_bf16 v[192:195], a[20:23], v[224:227], v[192:195]
v_cvt_pk_bf16_f32 v96, v188, v189
v_cvt_pk_bf16_f32 v97, v190, v191
v_mfma_f32_16x16x32_bf16 v[192:195], a[16:19], v[228:231], v[192:195]
ds_read_b128 v[188:191], v249 offset:0
ds_read_b128 v[196:199], v249 offset:272
v_mfma_f32_16x16x32_bf16 v[200:203], a[32:35], v[228:231], 0
ds_read_b128 v[204:207], v249 offset:544
v_pk_max_i16 v136, v136, 0
v_mfma_f32_16x16x32_bf16 v[200:203], a[36:39], v[224:227], v[200:203]
v_pk_max_i16 v137, v137, 0
v_pk_max_i16 v138, v138, 0
v_mfma_f32_16x16x32_bf16 v[200:203], a[40:43], v[220:223], v[200:203]
v_cvt_pk_bf16_f32 v98, v192, v193
v_cvt_pk_bf16_f32 v99, v194, v195
v_mfma_f32_16x16x32_bf16 v[200:203], a[44:47], v[232:235], v[200:203]
v_mov_b64 v[192:193], 0
v_mov_b64 v[194:195], 0
v_mfma_f32_16x16x32_bf16 v[208:211], a[60:63], v[232:235], 0
v_pk_max_i16 v139, v139, 0
v_pk_max_i16 v144, v144, 0
v_mfma_f32_16x16x32_bf16 v[208:211], a[56:59], v[220:223], v[208:211]
v_pk_max_i16 v145, v145, 0
v_pk_max_i16 v146, v146, 0
v_mfma_f32_16x16x32_bf16 v[208:211], a[52:55], v[224:227], v[208:211]
s_waitcnt lgkmcnt(2)
v_mov_b64 v[212:213], 0
v_mov_b64 v[214:215], 0
v_mfma_f32_16x16x32_bf16 v[208:211], a[48:51], v[228:231], v[208:211]
s_waitcnt lgkmcnt(1)
v_cvt_pk_bf16_f32 v100, v200, v201
v_cvt_pk_bf16_f32 v101, v202, v203
v_smfmac_f32_16x16x64_bf16 v[192:195], v[188:191], v[48:55], v251
s_waitcnt lgkmcnt(0)
v_pk_max_i16 v147, v147, 0
v_smfmac_f32_16x16x64_bf16 v[192:195], v[196:199], v[64:71], v251
s_nop 0
v_cvt_pk_bf16_f32 v102, v208, v209
v_smfmac_f32_16x16x64_bf16 v[192:195], v[204:207], v[80:87], v251
v_cvt_pk_bf16_f32 v103, v210, v211
v_smfmac_f32_16x16x64_bf16 v[212:215], v[204:207], v[88:95], v251
v_mov_b64 v[200:201], s[96:97]
v_smfmac_f32_16x16x64_bf16 v[212:215], v[196:199], v[72:79], v251
v_mov_b64 v[202:203], s[96:97]
v_smfmac_f32_16x16x64_bf16 v[212:215], v[188:191], v[56:63], v251
v_mov_b64 v[140:141], v[136:137]
v_smfmac_f32_16x16x64_bf16 v[200:203], v[238:241], v[96:103], v251
v_mov_b64 v[142:143], v[138:139]
v_mfma_f32_16x16x32_bf16 v[188:191], v[0:3], v[96:99], 0
v_mov_b32_dpp v136, v144 row_ror:8 row_mask:0xf bank_mask:0xc
v_mov_b32_dpp v137, v145 row_ror:8 row_mask:0xf bank_mask:0xc
v_mfma_f32_16x16x32_bf16 v[188:191], v[4:7], v[100:103], v[188:191]
v_mov_b32_dpp v138, v146 row_ror:8 row_mask:0xf bank_mask:0xc
v_mov_b32_dpp v139, v147 row_ror:8 row_mask:0xf bank_mask:0xc
v_mfma_f32_16x16x32_bf16 v[196:199], v[12:15], v[100:103], 0
v_mov_b32_dpp v144, v140 row_ror:8 row_mask:0xf bank_mask:0x3
v_mov_b32_dpp v145, v141 row_ror:8 row_mask:0xf bank_mask:0x3
v_mfma_f32_16x16x32_bf16 v[196:199], v[8:11], v[96:99], v[196:199]
v_mov_b32_dpp v146, v142 row_ror:8 row_mask:0xf bank_mask:0x3
v_mov_b32_dpp v147, v143 row_ror:8 row_mask:0xf bank_mask:0x3
v_mfma_f32_16x16x32_bf16 v[204:207], v[16:19], v[96:99], 0
v_exp_f32 v188, v188
v_mfma_f32_16x16x32_bf16 v[204:207], v[20:23], v[100:103], v[204:207]
v_exp_f32 v189, v189
v_mfma_f32_16x16x32_bf16 v[208:211], v[28:31], v[100:103], 0
v_exp_f32 v190, v190
v_mfma_f32_16x16x32_bf16 v[208:211], v[24:27], v[96:99], v[208:211]
v_exp_f32 v191, v191
v_mfma_f32_32x32x16_bf16 v[168:183], v[236:239], v[132:135], 0
buffer_store_dwordx4 v[136:139], v244, s[20:23], s52 offen offset:0 nt
buffer_store_dwordx4 v[144:147], v244, s[20:23], s52 offen offset:2048 nt
v_cvt_pk_bf16_f32 v104, v188, v189
v_cvt_pk_bf16_f32 v105, v190, v191
v_add_f32 v192, v192, v193
v_add_f32 v194, v194, v195
v_mfma_f32_16x16x32_bf16 v[136:139], a[192:195], v[228:231], 0
s_add_u32 s52, s46, 16384
ds_write_b32 v250, v192 offset:0
v_mfma_f32_16x16x32_bf16 v[136:139], a[196:199], v[224:227], v[136:139]
ds_write_b32 v250, v194 offset:64
v_mfma_f32_16x16x32_bf16 v[136:139], a[200:203], v[220:223], v[136:139]
v_add_f32 v200, v200, v201
v_add_f32 v202, v202, v203
v_mfma_f32_16x16x32_bf16 v[136:139], a[204:207], v[232:235], v[136:139]
v_exp_f32 v200, v200
v_mfma_f32_16x16x32_bf16 v[140:143], a[220:223], v[232:235], 0
v_exp_f32 v202, v202
v_mfma_f32_16x16x32_bf16 v[140:143], a[216:219], v[220:223], v[140:143]
v_perm_b32 v116, v202, v200, v252
v_perm_b32 v117, v202, v200, v253
v_mfma_f32_16x16x32_bf16 v[140:143], a[212:215], v[224:227], v[140:143]
v_exp_f32 v196, v196
v_mfma_f32_16x16x32_bf16 v[140:143], a[208:211], v[228:231], v[140:143]
v_exp_f32 v197, v197
v_mfma_f32_16x16x32_bf16 v[144:147], a[224:227], v[228:231], 0
v_exp_f32 v198, v198
v_mfma_f32_16x16x32_bf16 v[144:147], a[228:231], v[224:227], v[144:147]
v_exp_f32 v199, v199
v_mfma_f32_16x16x32_bf16 v[144:147], a[232:235], v[220:223], v[144:147]
v_cvt_pk_bf16_f32 v106, v196, v197
v_cvt_pk_bf16_f32 v107, v198, v199
v_mfma_f32_16x16x32_bf16 v[144:147], a[236:239], v[232:235], v[144:147]
v_mov_b64 v[188:189], 0
v_add_f32 v212, v212, v213
v_mfma_f32_16x16x32_bf16 v[148:151], a[252:255], v[232:235], 0
ds_write_b32 v250, v212 offset:128
v_mfma_f32_16x16x32_bf16 v[148:151], a[248:251], v[220:223], v[148:151]
v_exp_f32 v204, v204
v_mfma_f32_16x16x32_bf16 v[148:151], a[244:247], v[224:227], v[148:151]
v_exp_f32 v205, v205
v_mfma_f32_16x16x32_bf16 v[148:151], a[240:243], v[228:231], v[148:151]
v_exp_f32 v206, v206
v_smfmac_f32_16x16x64_bf16 v[188:191], v[184:187], v[120:127], v251
ds_read_b128 v[196:199], v242 offset:4224
v_cvt_pk_bf16_f32 v108, v204, v205
v_smfmac_f32_16x16x64_bf16 v[188:191], v[184:187], v[128:135], v251 abid:1
ds_read_b128 v[216:219], v242 offset:4992
v_add_f32 v214, v214, v215
v_mfma_f32_16x16x32_bf16 v[168:171], v[80:83], v[128:131], v[168:171]
ds_write_b32 v250, v214 offset:192
v_mfma_f32_16x16x32_bf16 v[168:171], v[64:67], v[124:127], v[168:171]
v_exp_f32 v207, v207
v_mfma_f32_16x16x32_bf16 v[168:171], v[48:51], v[120:123], v[168:171]
v_cvt_pk_bf16_f32 v109, v206, v207
v_add_f32 v188, v188, v189
v_mfma_f32_16x16x32_bf16 v[172:175], v[52:55], v[120:123], v[172:175]
ds_read_b128 v[204:207], v242 offset:4480
v_add_u32 v250, 1728, v250
v_mfma_f32_16x16x32_bf16 v[172:175], v[68:71], v[124:127], v[172:175]
v_exp_f32 v208, v208
v_mfma_f32_16x16x32_bf16 v[172:175], v[84:87], v[128:131], v[172:175]
v_exp_f32 v209, v209
v_mfma_f32_16x16x32_bf16 v[176:179], v[88:91], v[128:131], v[176:179]
v_exp_f32 v210, v210
v_mfma_f32_16x16x32_bf16 v[176:179], v[72:75], v[124:127], v[176:179]
v_exp_f32 v211, v211
v_mfma_f32_16x16x32_bf16 v[176:179], v[56:59], v[120:123], v[176:179]
v_cvt_pk_bf16_f32 v110, v208, v209
v_cvt_pk_bf16_f32 v111, v210, v211
v_mfma_f32_16x16x32_bf16 v[180:183], v[60:63], v[120:123], v[180:183]
ds_read_b128 v[208:211], v242 offset:4736
v_mfma_f32_16x16x32_bf16 v[180:183], v[76:79], v[124:127], v[180:183]
v_rcp_f32 v254, v188
v_mfma_f32_16x16x32_bf16 v[180:183], v[92:95], v[128:131], v[180:183]
s_waitcnt lgkmcnt(4)
v_max3_f32 v255, v255, v188, v254
v_fmac_f32 v152, v168, v254
v_mfma_f32_16x16x32_bf16 v[192:195], v[36:39], v[100:103], 0
s_waitcnt lgkmcnt(3)
v_fmac_f32 v153, v169, v254
v_fmac_f32 v160, v176, v254
v_mfma_f32_16x16x32_bf16 v[192:195], v[32:35], v[96:99], v[192:195]
v_fmac_f32 v161, v177, v254
v_fmac_f32 v154, v170, v254
v_mfma_f32_16x16x32_bf16 v[200:203], v[40:43], v[96:99], 0
v_fmac_f32 v155, v171, v254
v_cvt_pk_bf16_f32 v152, v152, v153
v_mfma_f32_16x16x32_bf16 v[200:203], v[44:47], v[100:103], v[200:203]
s_waitcnt lgkmcnt(1)
v_fmac_f32 v162, v178, v254
v_fmac_f32 v163, v179, v254
v_mfma_f32_16x16x32_bf16 v[220:223], a[0:3], v[196:199], 0
s_waitcnt lgkmcnt(0)
v_cvt_pk_bf16_f32 v160, v160, v161
v_fmac_f32 v156, v172, v254
v_mfma_f32_16x16x32_bf16 v[220:223], a[4:7], v[204:207], v[220:223]
v_fmac_f32 v157, v173, v254
v_fmac_f32 v158, v174, v254
v_mfma_f32_16x16x32_bf16 v[220:223], a[8:11], v[208:211], v[220:223]
v_fmac_f32 v159, v175, v254
v_cvt_pk_bf16_f32 v153, v154, v155
v_mfma_f32_16x16x32_bf16 v[220:223], a[12:15], v[216:219], v[220:223]
v_fmac_f32 v164, v180, v254
v_fmac_f32 v165, v181, v254
v_mfma_f32_16x16x32_bf16 v[224:227], a[28:31], v[216:219], 0
v_fmac_f32 v166, v182, v254
v_fmac_f32 v167, v183, v254
v_mfma_f32_16x16x32_bf16 v[224:227], a[24:27], v[208:211], v[224:227]
v_cvt_pk_bf16_f32 v161, v162, v163
v_cvt_pk_bf16_f32 v154, v156, v157
v_mfma_f32_16x16x32_bf16 v[224:227], a[20:23], v[204:207], v[224:227]
v_cvt_pk_bf16_f32 v155, v158, v159
v_cvt_pk_bf16_f32 v162, v164, v165
v_mfma_f32_16x16x32_bf16 v[224:227], a[16:19], v[196:199], v[224:227]
v_cvt_pk_bf16_f32 v163, v166, v167
v_pk_max_i16 v152, v152, 0
v_mfma_f32_16x16x32_bf16 v[228:231], a[32:35], v[196:199], 0
v_pk_max_i16 v153, v153, 0
v_pk_max_i16 v154, v154, 0
v_mfma_f32_16x16x32_bf16 v[228:231], a[36:39], v[204:207], v[228:231]
v_pk_max_i16 v155, v155, 0
v_pk_max_i16 v160, v160, 0
v_mfma_f32_16x16x32_bf16 v[228:231], a[40:43], v[208:211], v[228:231]
v_pk_max_i16 v161, v161, 0
v_pk_max_i16 v162, v162, 0
v_mfma_f32_16x16x32_bf16 v[228:231], a[44:47], v[216:219], v[228:231]
v_pk_max_i16 v163, v163, 0
v_mov_b64 v[156:157], v[152:153]
v_mfma_f32_16x16x32_bf16 v[188:191], a[60:63], v[216:219], 0
v_mov_b64 v[158:159], v[154:155]
v_mov_b32_dpp v152, v160 row_ror:8 row_mask:0xf bank_mask:0xc
v_mfma_f32_16x16x32_bf16 v[188:191], a[56:59], v[208:211], v[188:191]
v_mov_b32_dpp v153, v161 row_ror:8 row_mask:0xf bank_mask:0xc
v_mov_b32_dpp v154, v162 row_ror:8 row_mask:0xf bank_mask:0xc
v_mfma_f32_16x16x32_bf16 v[188:191], a[52:55], v[204:207], v[188:191]
v_mov_b32_dpp v155, v163 row_ror:8 row_mask:0xf bank_mask:0xc
v_mov_b32_dpp v160, v156 row_ror:8 row_mask:0xf bank_mask:0x3
v_mfma_f32_16x16x32_bf16 v[188:191], a[48:51], v[196:199], v[188:191]
v_mov_b32_dpp v161, v157 row_ror:8 row_mask:0xf bank_mask:0x3
v_mov_b32_dpp v162, v158 row_ror:8 row_mask:0xf bank_mask:0x3
v_mov_b32_dpp v163, v159 row_ror:8 row_mask:0xf bank_mask:0x3
v_mfma_f32_32x32x16_bf16 v[168:183], v[236:239], v[116:119], 0
buffer_store_dwordx4 v[152:155], v244, s[20:23], s53 offen offset:0 nt
buffer_store_dwordx4 v[160:163], v244, s[20:23], s53 offen offset:2048 nt
v_cvt_pk_bf16_f32 v96, v220, v221
v_cvt_pk_bf16_f32 v97, v222, v223
v_cvt_pk_bf16_f32 v98, v224, v225
v_cvt_pk_bf16_f32 v99, v226, v227
v_mfma_f32_16x16x32_bf16 v[152:155], a[192:195], v[196:199], 0
s_add_u32 s53, s46, 4096
v_cvt_pk_bf16_f32 v100, v228, v229
v_cvt_pk_bf16_f32 v101, v230, v231
v_mfma_f32_16x16x32_bf16 v[152:155], a[196:199], v[204:207], v[152:155]
s_add_u32 s46, s46, 13107200
v_cvt_pk_bf16_f32 v102, v188, v189
v_cvt_pk_bf16_f32 v103, v190, v191
v_mfma_f32_16x16x32_bf16 v[152:155], a[200:203], v[208:211], v[152:155]
v_exp_f32 v192, v192
v_mfma_f32_16x16x32_bf16 v[152:155], a[204:207], v[216:219], v[152:155]
v_exp_f32 v193, v193
v_mfma_f32_16x16x32_bf16 v[156:159], a[220:223], v[216:219], 0
v_exp_f32 v194, v194
v_mfma_f32_16x16x32_bf16 v[156:159], a[216:219], v[208:211], v[156:159]
v_exp_f32 v195, v195
v_mfma_f32_16x16x32_bf16 v[156:159], a[212:215], v[204:207], v[156:159]
v_cvt_pk_bf16_f32 v112, v192, v193
v_cvt_pk_bf16_f32 v113, v194, v195
v_mfma_f32_16x16x32_bf16 v[156:159], a[208:211], v[196:199], v[156:159]
v_exp_f32 v200, v200
v_mfma_f32_16x16x32_bf16 v[160:163], a[224:227], v[196:199], 0
v_exp_f32 v201, v201
v_mfma_f32_16x16x32_bf16 v[160:163], a[228:231], v[204:207], v[160:163]
v_exp_f32 v202, v202
v_mfma_f32_16x16x32_bf16 v[160:163], a[232:235], v[208:211], v[160:163]
v_exp_f32 v203, v203
v_mfma_f32_16x16x32_bf16 v[160:163], a[236:239], v[216:219], v[160:163]
v_mov_b64 v[188:189], s[96:97]
v_mov_b64 v[190:191], s[96:97]
v_mfma_f32_16x16x32_bf16 v[164:167], a[252:255], v[216:219], 0
v_cvt_pk_bf16_f32 v114, v200, v201
v_cvt_pk_bf16_f32 v115, v202, v203
v_mfma_f32_16x16x32_bf16 v[164:167], a[248:251], v[208:211], v[164:167]
v_mfma_f32_16x16x32_bf16 v[164:167], a[244:247], v[204:207], v[164:167]
v_mfma_f32_16x16x32_bf16 v[164:167], a[240:243], v[196:199], v[164:167]
v_smfmac_f32_16x16x64_bf16 v[188:191], v[238:241], v[96:103], v251
s_nop 2
v_mfma_f32_16x16x32_bf16 v[192:195], v[0:3], v[96:99], 0
s_nop 2
v_mfma_f32_16x16x32_bf16 v[192:195], v[4:7], v[100:103], v[192:195]
v_mov_b64 v[196:197], 0
v_add_f32 v188, v188, v189
v_mfma_f32_16x16x32_bf16 v[200:203], v[12:15], v[100:103], 0
v_add_f32 v190, v190, v191
s_nop 0
v_mfma_f32_16x16x32_bf16 v[200:203], v[8:11], v[96:99], v[200:203]
v_exp_f32 v188, v188
v_mfma_f32_16x16x32_bf16 v[204:207], v[16:19], v[96:99], 0
v_exp_f32 v190, v190
v_mfma_f32_16x16x32_bf16 v[204:207], v[20:23], v[100:103], v[204:207]
v_perm_b32 v132, v190, v188, v252
v_perm_b32 v133, v190, v188, v253
v_smfmac_f32_16x16x64_bf16 v[196:199], v[184:187], v[104:111], v251
ds_read_b128 v[188:191], v242 offset:8448
ds_read_b128 v[208:211], v242 offset:8704
v_smfmac_f32_16x16x64_bf16 v[196:199], v[184:187], v[112:119], v251 abid:1
ds_read_b128 v[212:215], v242 offset:8960
ds_read_b128 v[216:219], v242 offset:9216
v_mfma_f32_16x16x32_bf16 v[168:171], v[80:83], v[112:115], v[168:171]
v_exp_f32 v192, v192
v_mfma_f32_16x16x32_bf16 v[168:171], v[64:67], v[108:111], v[168:171]
v_exp_f32 v193, v193
v_mfma_f32_16x16x32_bf16 v[168:171], v[48:51], v[104:107], v[168:171]
s_nop 0
v_add_f32 v196, v196, v197
v_cvt_pk_bf16_f32 v120, v192, v193
v_mfma_f32_16x16x32_bf16 v[172:175], v[52:55], v[104:107], v[172:175]
v_rcp_f32 v254, v196
v_mfma_f32_16x16x32_bf16 v[172:175], v[68:71], v[108:111], v[172:175]
s_waitcnt lgkmcnt(3)
v_max3_f32 v255, v255, v196, v254
v_fmac_f32 v136, v168, v254
v_mfma_f32_16x16x32_bf16 v[172:175], v[84:87], v[112:115], v[172:175]
v_exp_f32 v194, v194
v_mfma_f32_16x16x32_bf16 v[176:179], v[88:91], v[112:115], v[176:179]
v_exp_f32 v195, v195
v_mfma_f32_16x16x32_bf16 v[176:179], v[72:75], v[108:111], v[176:179]
v_cvt_pk_bf16_f32 v121, v194, v195
v_fmac_f32 v137, v169, v254
v_mfma_f32_16x16x32_bf16 v[176:179], v[56:59], v[104:107], v[176:179]
v_fmac_f32 v138, v170, v254
v_fmac_f32 v139, v171, v254
v_mfma_f32_16x16x32_bf16 v[180:183], v[60:63], v[104:107], v[180:183]
v_cvt_pk_bf16_f32 v136, v136, v137
v_cvt_pk_bf16_f32 v137, v138, v139
v_mfma_f32_16x16x32_bf16 v[180:183], v[76:79], v[108:111], v[180:183]
v_fmac_f32 v140, v172, v254
v_fmac_f32 v141, v173, v254
v_mfma_f32_16x16x32_bf16 v[180:183], v[92:95], v[112:115], v[180:183]
s_waitcnt lgkmcnt(2)
v_fmac_f32 v144, v176, v254
v_fmac_f32 v145, v177, v254
v_mfma_f32_16x16x32_bf16 v[220:223], v[24:27], v[96:99], 0
s_waitcnt lgkmcnt(0)
v_fmac_f32 v146, v178, v254
v_fmac_f32 v147, v179, v254
v_mfma_f32_16x16x32_bf16 v[220:223], v[28:31], v[100:103], v[220:223]
v_cvt_pk_bf16_f32 v144, v144, v145
v_fmac_f32 v142, v174, v254
v_mfma_f32_16x16x32_bf16 v[224:227], v[36:39], v[100:103], 0
v_fmac_f32 v143, v175, v254
v_fmac_f32 v148, v180, v254
v_mfma_f32_16x16x32_bf16 v[224:227], v[32:35], v[96:99], v[224:227]
v_fmac_f32 v149, v181, v254
v_fmac_f32 v150, v182, v254
v_mfma_f32_16x16x32_bf16 v[228:231], v[40:43], v[96:99], 0
v_fmac_f32 v151, v183, v254
v_cvt_pk_bf16_f32 v145, v146, v147
v_mfma_f32_16x16x32_bf16 v[228:231], v[44:47], v[100:103], v[228:231]
v_cvt_pk_bf16_f32 v138, v140, v141
v_cvt_pk_bf16_f32 v139, v142, v143
v_mfma_f32_16x16x32_bf16 v[196:199], a[0:3], v[188:191], 0
v_cvt_pk_bf16_f32 v146, v148, v149
v_cvt_pk_bf16_f32 v147, v150, v151
v_mfma_f32_16x16x32_bf16 v[196:199], a[4:7], v[208:211], v[196:199]
v_pk_max_i16 v136, v136, 0
v_pk_max_i16 v137, v137, 0
v_mfma_f32_16x16x32_bf16 v[196:199], a[8:11], v[212:215], v[196:199]
v_pk_max_i16 v138, v138, 0
v_pk_max_i16 v139, v139, 0
v_mfma_f32_16x16x32_bf16 v[196:199], a[12:15], v[216:219], v[196:199]
v_pk_max_i16 v144, v144, 0
v_pk_max_i16 v145, v145, 0
v_mfma_f32_16x16x32_bf16 v[192:195], a[28:31], v[216:219], 0
v_pk_max_i16 v146, v146, 0
v_pk_max_i16 v147, v147, 0
v_mfma_f32_16x16x32_bf16 v[192:195], a[24:27], v[212:215], v[192:195]
v_mov_b64 v[140:141], v[136:137]
v_mov_b64 v[142:143], v[138:139]
v_mfma_f32_16x16x32_bf16 v[192:195], a[20:23], v[208:211], v[192:195]
v_cvt_pk_bf16_f32 v96, v196, v197
v_cvt_pk_bf16_f32 v97, v198, v199
v_mfma_f32_16x16x32_bf16 v[192:195], a[16:19], v[188:191], v[192:195]
v_mov_b32_dpp v136, v144 row_ror:8 row_mask:0xf bank_mask:0xc
v_mov_b32_dpp v137, v145 row_ror:8 row_mask:0xf bank_mask:0xc
v_mfma_f32_16x16x32_bf16 v[196:199], a[32:35], v[188:191], 0
v_mov_b32_dpp v138, v146 row_ror:8 row_mask:0xf bank_mask:0xc
v_mov_b32_dpp v139, v147 row_ror:8 row_mask:0xf bank_mask:0xc
v_mfma_f32_16x16x32_bf16 v[196:199], a[36:39], v[208:211], v[196:199]
v_mov_b32_dpp v144, v140 row_ror:8 row_mask:0xf bank_mask:0x3
v_mov_b32_dpp v145, v141 row_ror:8 row_mask:0xf bank_mask:0x3
v_mfma_f32_16x16x32_bf16 v[196:199], a[40:43], v[212:215], v[196:199]
v_cvt_pk_bf16_f32 v98, v192, v193
v_cvt_pk_bf16_f32 v99, v194, v195
v_mfma_f32_16x16x32_bf16 v[196:199], a[44:47], v[216:219], v[196:199]
v_mov_b32_dpp v146, v142 row_ror:8 row_mask:0xf bank_mask:0x3
v_mov_b32_dpp v147, v143 row_ror:8 row_mask:0xf bank_mask:0x3
v_mfma_f32_16x16x32_bf16 v[192:195], a[60:63], v[216:219], 0
v_exp_f32 v200, v200
v_mfma_f32_16x16x32_bf16 v[192:195], a[56:59], v[212:215], v[192:195]
v_exp_f32 v201, v201
v_mfma_f32_16x16x32_bf16 v[192:195], a[52:55], v[208:211], v[192:195]
s_nop 0
v_cvt_pk_bf16_f32 v100, v196, v197
v_cvt_pk_bf16_f32 v101, v198, v199
v_mfma_f32_16x16x32_bf16 v[192:195], a[48:51], v[188:191], v[192:195]
v_exp_f32 v202, v202
v_mfma_f32_32x32x16_bf16 v[168:183], v[236:239], v[132:135], 0
buffer_store_dwordx4 v[136:139], v244, s[20:23], s52 offen offset:0 nt
buffer_store_dwordx4 v[144:147], v244, s[20:23], s52 offen offset:2048 nt
v_exp_f32 v203, v203
v_cvt_pk_bf16_f32 v122, v200, v201
v_cvt_pk_bf16_f32 v123, v202, v203
v_mfma_f32_16x16x32_bf16 v[136:139], a[192:195], v[188:191], 0
v_cvt_pk_bf16_f32 v102, v192, v193
v_cvt_pk_bf16_f32 v103, v194, v195
v_mfma_f32_16x16x32_bf16 v[136:139], a[196:199], v[208:211], v[136:139]
v_exp_f32 v204, v204
v_mfma_f32_16x16x32_bf16 v[136:139], a[200:203], v[212:215], v[136:139]
v_exp_f32 v205, v205
v_mfma_f32_16x16x32_bf16 v[136:139], a[204:207], v[216:219], v[136:139]
v_exp_f32 v206, v206
v_mfma_f32_16x16x32_bf16 v[140:143], a[220:223], v[216:219], 0
v_exp_f32 v207, v207
v_mfma_f32_16x16x32_bf16 v[140:143], a[216:219], v[212:215], v[140:143]
v_exp_f32 v220, v220
v_mfma_f32_16x16x32_bf16 v[140:143], a[212:215], v[208:211], v[140:143]
v_exp_f32 v221, v221
v_mfma_f32_16x16x32_bf16 v[140:143], a[208:211], v[188:191], v[140:143]
v_exp_f32 v222, v222
v_mfma_f32_16x16x32_bf16 v[144:147], a[224:227], v[188:191], 0
v_exp_f32 v223, v223
v_mfma_f32_16x16x32_bf16 v[144:147], a[228:231], v[208:211], v[144:147]
v_cvt_pk_bf16_f32 v124, v204, v205
v_cvt_pk_bf16_f32 v125, v206, v207
v_mfma_f32_16x16x32_bf16 v[144:147], a[232:235], v[212:215], v[144:147]
v_cvt_pk_bf16_f32 v126, v220, v221
v_cvt_pk_bf16_f32 v127, v222, v223
v_mfma_f32_16x16x32_bf16 v[144:147], a[236:239], v[216:219], v[144:147]
v_mov_b64 v[192:193], s[96:97]
v_mov_b64 v[194:195], s[96:97]
v_mfma_f32_16x16x32_bf16 v[148:151], a[252:255], v[216:219], 0
v_exp_f32 v224, v224
v_mfma_f32_16x16x32_bf16 v[148:151], a[248:251], v[212:215], v[148:151]
v_exp_f32 v225, v225
v_mfma_f32_16x16x32_bf16 v[148:151], a[244:247], v[208:211], v[148:151]
v_exp_f32 v226, v226
v_mfma_f32_16x16x32_bf16 v[148:151], a[240:243], v[188:191], v[148:151]
v_exp_f32 v227, v227
v_smfmac_f32_16x16x64_bf16 v[192:195], v[238:241], v[96:103], v251
v_mov_b64 v[188:189], 0
v_mfma_f32_16x16x32_bf16 v[196:199], v[0:3], v[96:99], 0
v_exp_f32 v228, v228
v_mfma_f32_16x16x32_bf16 v[196:199], v[4:7], v[100:103], v[196:199]
v_exp_f32 v229, v229
v_mfma_f32_16x16x32_bf16 v[200:203], v[12:15], v[100:103], 0
v_exp_f32 v230, v230
v_mfma_f32_16x16x32_bf16 v[200:203], v[8:11], v[96:99], v[200:203]
v_exp_f32 v231, v231
v_smfmac_f32_16x16x64_bf16 v[188:191], v[184:187], v[120:127], v251
ds_read_b128 v[204:207], v242 offset:12672
v_cvt_pk_bf16_f32 v128, v224, v225
v_cvt_pk_bf16_f32 v129, v226, v227
v_cvt_pk_bf16_f32 v130, v228, v229
v_cvt_pk_bf16_f32 v131, v230, v231
v_add_f32 v192, v192, v193
v_add_f32 v194, v194, v195
v_smfmac_f32_16x16x64_bf16 v[188:191], v[184:187], v[128:135], v251 abid:1
ds_read_b128 v[208:211], v242 offset:12928
ds_read_b128 v[212:215], v242 offset:13184
v_mfma_f32_16x16x32_bf16 v[168:171], v[80:83], v[128:131], v[168:171]
ds_read_b128 v[216:219], v242 offset:13440
v_add_u32 v242, s56, v242
v_mfma_f32_16x16x32_bf16 v[168:171], v[64:67], v[124:127], v[168:171]
s_sub_u32 s56, 0, s56
v_exp_f32 v192, v192
v_mfma_f32_16x16x32_bf16 v[168:171], v[48:51], v[120:123], v[168:171]
v_exp_f32 v194, v194
v_mfma_f32_16x16x32_bf16 v[172:175], v[52:55], v[120:123], v[172:175]
v_perm_b32 v116, v194, v192, v252
v_perm_b32 v117, v194, v192, v253
v_mfma_f32_16x16x32_bf16 v[172:175], v[68:71], v[124:127], v[172:175]
v_add_f32 v188, v188, v189
v_mfma_f32_16x16x32_bf16 v[172:175], v[84:87], v[128:131], v[172:175]
v_rcp_f32 v254, v188
v_mfma_f32_16x16x32_bf16 v[176:179], v[88:91], v[128:131], v[176:179]
v_max3_f32 v255, v255, v188, v254
v_fmac_f32 v152, v168, v254
v_mfma_f32_16x16x32_bf16 v[176:179], v[72:75], v[124:127], v[176:179]
v_fmac_f32 v153, v169, v254
v_fmac_f32 v154, v170, v254
v_mfma_f32_16x16x32_bf16 v[176:179], v[56:59], v[120:123], v[176:179]
v_fmac_f32 v155, v171, v254
v_cvt_pk_bf16_f32 v152, v152, v153
v_mfma_f32_16x16x32_bf16 v[180:183], v[60:63], v[120:123], v[180:183]
v_mov_b32 v192, s45
v_fmac_f32 v156, v172, v254
v_mfma_f32_16x16x32_bf16 v[180:183], v[76:79], v[124:127], v[180:183]
s_waitcnt lgkmcnt(3)
v_fmac_f32 v157, v173, v254
v_fmac_f32 v160, v176, v254
v_mfma_f32_16x16x32_bf16 v[180:183], v[92:95], v[128:131], v[180:183]
s_waitcnt vmcnt(6)
ds_write_addtid_b32 v192 offset:65280
v_mfma_f32_16x16x32_bf16 v[220:223], v[20:23], v[100:103], 0
s_waitcnt lgkmcnt(2)
v_fmac_f32 v161, v177, v254
v_fmac_f32 v162, v178, v254
v_mfma_f32_16x16x32_bf16 v[220:223], v[16:19], v[96:99], v[220:223]
s_waitcnt lgkmcnt(1)
v_fmac_f32 v163, v179, v254
v_cvt_pk_bf16_f32 v160, v160, v161
v_mfma_f32_16x16x32_bf16 v[192:195], v[24:27], v[96:99], 0
v_fmac_f32 v158, v174, v254
v_fmac_f32 v159, v175, v254
v_mfma_f32_16x16x32_bf16 v[192:195], v[28:31], v[100:103], v[192:195]
v_cvt_pk_bf16_f32 v153, v154, v155
v_fmac_f32 v164, v180, v254
v_mfma_f32_16x16x32_bf16 v[224:227], v[36:39], v[100:103], 0
v_fmac_f32 v165, v181, v254
v_fmac_f32 v166, v182, v254
v_mfma_f32_16x16x32_bf16 v[224:227], v[32:35], v[96:99], v[224:227]
v_fmac_f32 v167, v183, v254
v_cvt_pk_bf16_f32 v161, v162, v163
v_mfma_f32_16x16x32_bf16 v[228:231], v[40:43], v[96:99], 0
v_cvt_pk_bf16_f32 v154, v156, v157
v_cvt_pk_bf16_f32 v155, v158, v159
v_mfma_f32_16x16x32_bf16 v[228:231], v[44:47], v[100:103], v[228:231]
v_cvt_pk_bf16_f32 v162, v164, v165
v_cvt_pk_bf16_f32 v163, v166, v167
v_mfma_f32_16x16x32_bf16 v[188:191], a[0:3], v[204:207], 0
v_pk_max_i16 v152, v152, 0
v_pk_max_i16 v153, v153, 0
v_mfma_f32_16x16x32_bf16 v[188:191], a[4:7], v[208:211], v[188:191]
v_pk_max_i16 v154, v154, 0
v_pk_max_i16 v155, v155, 0
v_mfma_f32_16x16x32_bf16 v[188:191], a[8:11], v[212:215], v[188:191]
v_pk_max_i16 v160, v160, 0
v_pk_max_i16 v161, v161, 0
v_mfma_f32_16x16x32_bf16 v[188:191], a[12:15], v[216:219], v[188:191]
v_pk_max_i16 v162, v162, 0
v_pk_max_i16 v163, v163, 0
v_mfma_f32_16x16x32_bf16 v[232:235], a[28:31], v[216:219], 0
v_mov_b64 v[156:157], v[152:153]
v_mov_b64 v[158:159], v[154:155]
v_mfma_f32_16x16x32_bf16 v[232:235], a[24:27], v[212:215], v[232:235]
v_mov_b32_dpp v152, v160 row_ror:8 row_mask:0xf bank_mask:0xc
v_mov_b32_dpp v153, v161 row_ror:8 row_mask:0xf bank_mask:0xc
v_mfma_f32_16x16x32_bf16 v[232:235], a[20:23], v[208:211], v[232:235]
v_cvt_pk_bf16_f32 v96, v188, v189
v_cvt_pk_bf16_f32 v97, v190, v191
v_mfma_f32_16x16x32_bf16 v[232:235], a[16:19], v[204:207], v[232:235]
v_mov_b32_dpp v154, v162 row_ror:8 row_mask:0xf bank_mask:0xc
v_mov_b32_dpp v155, v163 row_ror:8 row_mask:0xf bank_mask:0xc
v_mfma_f32_16x16x32_bf16 v[188:191], a[32:35], v[204:207], 0
v_mov_b32_dpp v160, v156 row_ror:8 row_mask:0xf bank_mask:0x3
v_mov_b32_dpp v161, v157 row_ror:8 row_mask:0xf bank_mask:0x3
v_mfma_f32_16x16x32_bf16 v[188:191], a[36:39], v[208:211], v[188:191]
v_mov_b32_dpp v162, v158 row_ror:8 row_mask:0xf bank_mask:0x3
v_mov_b32_dpp v163, v159 row_ror:8 row_mask:0xf bank_mask:0x3
v_mfma_f32_16x16x32_bf16 v[188:191], a[40:43], v[212:215], v[188:191]
v_cvt_pk_bf16_f32 v98, v232, v233
v_cvt_pk_bf16_f32 v99, v234, v235
v_mfma_f32_16x16x32_bf16 v[188:191], a[44:47], v[216:219], v[188:191]
v_exp_f32 v200, v200
v_mfma_f32_16x16x32_bf16 v[232:235], a[60:63], v[216:219], 0
v_exp_f32 v201, v201
v_mfma_f32_16x16x32_bf16 v[232:235], a[56:59], v[212:215], v[232:235]
v_exp_f32 v202, v202
v_mfma_f32_16x16x32_bf16 v[232:235], a[52:55], v[208:211], v[232:235]
v_exp_f32 v203, v203
v_mfma_f32_16x16x32_bf16 v[232:235], a[48:51], v[204:207], v[232:235]
v_cvt_pk_bf16_f32 v100, v188, v189
v_cvt_pk_bf16_f32 v101, v190, v191
v_mfma_f32_32x32x16_bf16 v[168:183], v[236:239], v[116:119], 0
s_cmp_lg_u32 s45, 0
buffer_store_dwordx4 v[152:155], v244, s[20:23], s53 offen offset:0 nt
buffer_store_dwordx4 v[160:163], v244, s[20:23], s53 offen offset:2048 nt
s_cbranch_scc1 L_loopf
v_mfma_f32_16x16x32_bf16 v[152:155], a[192:195], v[204:207], 0
s_barrier
v_mfma_f32_16x16x32_bf16 v[152:155], a[196:199], v[208:211], v[152:155]
s_add_u32 s52, s47, 8192
v_cvt_pk_bf16_f32 v102, v232, v233
v_cvt_pk_bf16_f32 v103, v234, v235
v_mfma_f32_16x16x32_bf16 v[152:155], a[200:203], v[212:215], v[152:155]
s_lshl_b32 s55, s41, 9
v_mov_b64 v[188:189], s[96:97]
v_mov_b64 v[190:191], s[96:97]
v_mfma_f32_16x16x32_bf16 v[152:155], a[204:207], v[216:219], v[152:155]
s_add_u32 s53, s47, 12288
v_exp_f32 v220, v220
v_mfma_f32_16x16x32_bf16 v[156:159], a[220:223], v[216:219], 0
v_exp_f32 v221, v221
v_mfma_f32_16x16x32_bf16 v[156:159], a[216:219], v[212:215], v[156:159]
v_exp_f32 v222, v222
v_mfma_f32_16x16x32_bf16 v[156:159], a[212:215], v[208:211], v[156:159]
v_exp_f32 v223, v223
v_mfma_f32_16x16x32_bf16 v[156:159], a[208:211], v[204:207], v[156:159]
v_cvt_pk_bf16_f32 v108, v220, v221
v_cvt_pk_bf16_f32 v109, v222, v223
v_mfma_f32_16x16x32_bf16 v[160:163], a[224:227], v[204:207], 0
v_exp_f32 v192, v192
v_mfma_f32_16x16x32_bf16 v[160:163], a[228:231], v[208:211], v[160:163]
v_exp_f32 v193, v193
v_mfma_f32_16x16x32_bf16 v[160:163], a[232:235], v[212:215], v[160:163]
v_exp_f32 v194, v194
v_mfma_f32_16x16x32_bf16 v[160:163], a[236:239], v[216:219], v[160:163]
v_exp_f32 v196, v196
v_mfma_f32_16x16x32_bf16 v[164:167], a[252:255], v[216:219], 0
v_exp_f32 v197, v197
v_mfma_f32_16x16x32_bf16 v[164:167], a[248:251], v[212:215], v[164:167]
v_exp_f32 v198, v198
v_mfma_f32_16x16x32_bf16 v[164:167], a[244:247], v[208:211], v[164:167]
ds_read_b128 v[208:211], v242 offset:768
v_cvt_pk_bf16_f32 v104, v196, v197
v_mfma_f32_16x16x32_bf16 v[164:167], a[240:243], v[204:207], v[164:167]
v_exp_f32 v199, v199
v_smfmac_f32_16x16x64_bf16 v[188:191], v[238:241], v[96:103], v251
s_mul_i32 s54, s41, 13824
s_add_u32 s54, s54, 102400
v_cvt_pk_bf16_f32 v105, v198, v199
v_mfma_f32_16x16x32_bf16 v[204:207], v[0:3], v[96:99], 0
ds_read_b128 v[196:199], v242 offset:256
v_cvt_pk_bf16_f32 v110, v192, v193
v_mfma_f32_16x16x32_bf16 v[204:207], v[4:7], v[100:103], v[204:207]
v_exp_f32 v195, v195
v_mfma_f32_16x16x32_bf16 v[216:219], v[12:15], v[100:103], 0
v_cvt_pk_bf16_f32 v111, v194, v195
v_cvt_pk_bf16_f32 v106, v200, v201
v_mfma_f32_16x16x32_bf16 v[216:219], v[8:11], v[96:99], v[216:219]
ds_read_b128 v[192:195], v242 offset:0
v_cvt_pk_bf16_f32 v107, v202, v203
v_mfma_f32_16x16x32_bf16 v[220:223], v[16:19], v[96:99], 0
ds_read_b128 v[200:203], v242 offset:512
v_mov_b64 v[212:213], 0
v_mfma_f32_16x16x32_bf16 v[220:223], v[20:23], v[100:103], v[220:223]
v_exp_f32 v224, v224
v_smfmac_f32_16x16x64_bf16 v[212:215], v[184:187], v[104:111], v251
s_mov_b32 vcc_lo, 0xf0000f
s_mov_b32 vcc_hi, 0xf0000f00
v_exp_f32 v225, v225
v_exp_f32 v226, v226
v_exp_f32 v227, v227
v_exp_f32 v228, v228
v_exp_f32 v229, v229
v_exp_f32 v230, v230
v_exp_f32 v231, v231
v_cvt_pk_bf16_f32 v112, v224, v225
v_cvt_pk_bf16_f32 v113, v226, v227
v_cvt_pk_bf16_f32 v114, v228, v229
v_cvt_pk_bf16_f32 v115, v230, v231
v_add_f32 v188, v188, v189
v_add_f32 v190, v190, v191
v_smfmac_f32_16x16x64_bf16 v[212:215], v[184:187], v[112:119], v251 abid:1
s_waitcnt lgkmcnt(3)
s_lshl_b32 s48, s43, 7
s_add_u32 s48, s48, s44
s_add_u32 s48, s48, 0
v_mfma_f32_16x16x32_bf16 v[168:171], v[80:83], v[112:115], v[168:171]
s_waitcnt lgkmcnt(2)
v_exp_f32 v188, v188
v_mfma_f32_16x16x32_bf16 v[168:171], v[64:67], v[108:111], v[168:171]
s_add_u32 s98, s48, 26214400
v_exp_f32 v190, v190
v_mfma_f32_16x16x32_bf16 v[168:171], v[48:51], v[104:107], v[168:171]
v_perm_b32 v132, v190, v188, v252
v_perm_b32 v133, v190, v188, v253
v_mfma_f32_16x16x32_bf16 v[188:191], v[24:27], v[96:99], 0
s_waitcnt lgkmcnt(1)
v_add_f32 v212, v212, v213
v_mbcnt_lo_u32_b32 v245, -1, 0
v_mfma_f32_16x16x32_bf16 v[188:191], v[28:31], v[100:103], v[188:191]
s_waitcnt lgkmcnt(0)
v_rcp_f32 v254, v212
v_mfma_f32_16x16x32_bf16 v[172:175], v[52:55], v[104:107], v[172:175]
v_fmac_f32 v136, v168, v254
v_fmac_f32 v137, v169, v254
v_mfma_f32_16x16x32_bf16 v[172:175], v[68:71], v[108:111], v[172:175]
v_fmac_f32 v138, v170, v254
v_fmac_f32 v139, v171, v254
v_mfma_f32_16x16x32_bf16 v[172:175], v[84:87], v[112:115], v[172:175]
v_cvt_pk_bf16_f32 v136, v136, v137
v_cvt_pk_bf16_f32 v137, v138, v139
v_mfma_f32_16x16x32_bf16 v[224:227], v[32:35], v[96:99], 0
v_pk_max_i16 v136, v136, 0
v_pk_max_i16 v137, v137, 0
v_mfma_f32_16x16x32_bf16 v[224:227], v[36:39], v[100:103], v[224:227]
v_mbcnt_hi_u32_b32 v245, -1, v245
v_bfe_u32 v246, v245, 2, 2
v_mfma_f32_16x16x32_bf16 v[176:179], v[56:59], v[104:107], v[176:179]
v_fmac_f32 v140, v172, v254
v_fmac_f32 v141, v173, v254
v_mfma_f32_16x16x32_bf16 v[176:179], v[72:75], v[108:111], v[176:179]
v_fmac_f32 v142, v174, v254
v_fmac_f32 v143, v175, v254
v_mfma_f32_16x16x32_bf16 v[176:179], v[88:91], v[112:115], v[176:179]
v_cvt_pk_bf16_f32 v138, v140, v141
v_cvt_pk_bf16_f32 v139, v142, v143
v_mfma_f32_16x16x32_bf16 v[228:231], v[40:43], v[96:99], 0
v_pk_max_i16 v138, v138, 0
v_pk_max_i16 v139, v139, 0
v_mfma_f32_16x16x32_bf16 v[228:231], v[44:47], v[100:103], v[228:231]
v_mov_b64 v[140:141], v[136:137]
v_mov_b64 v[142:143], v[138:139]
v_mfma_f32_16x16x32_bf16 v[180:183], v[60:63], v[104:107], v[180:183]
v_fmac_f32 v144, v176, v254
v_fmac_f32 v145, v177, v254
v_mfma_f32_16x16x32_bf16 v[180:183], v[76:79], v[108:111], v[180:183]
v_fmac_f32 v146, v178, v254
v_fmac_f32 v147, v179, v254
v_mfma_f32_16x16x32_bf16 v[180:183], v[92:95], v[112:115], v[180:183]
v_cvt_pk_bf16_f32 v144, v144, v145
v_cvt_pk_bf16_f32 v145, v146, v147
v_mfma_f32_16x16x32_bf16 v[0:3], a[192:195], v[192:195], 0
v_pk_max_i16 v144, v144, 0
v_pk_max_i16 v145, v145, 0
v_mfma_f32_16x16x32_bf16 v[0:3], a[196:199], v[196:199], v[0:3]
v_mov_b32_dpp v136, v144 row_ror:8 row_mask:0xf bank_mask:0xc
v_mov_b32_dpp v137, v145 row_ror:8 row_mask:0xf bank_mask:0xc
v_mfma_f32_16x16x32_bf16 v[0:3], a[200:203], v[200:203], v[0:3]
v_fmac_f32 v148, v180, v254
v_fmac_f32 v149, v181, v254
v_mfma_f32_16x16x32_bf16 v[0:3], a[204:207], v[208:211], v[0:3]
v_fmac_f32 v150, v182, v254
v_fmac_f32 v151, v183, v254
v_mfma_f32_16x16x32_bf16 v[4:7], a[220:223], v[208:211], 0
v_cvt_pk_bf16_f32 v146, v148, v149
v_cvt_pk_bf16_f32 v147, v150, v151
v_mfma_f32_16x16x32_bf16 v[4:7], a[216:219], v[200:203], v[4:7]
v_pk_max_i16 v146, v146, 0
v_pk_max_i16 v147, v147, 0
v_mfma_f32_16x16x32_bf16 v[4:7], a[212:215], v[196:199], v[4:7]
v_mov_b32_dpp v138, v146 row_ror:8 row_mask:0xf bank_mask:0xc
v_mov_b32_dpp v139, v147 row_ror:8 row_mask:0xf bank_mask:0xc
v_mfma_f32_16x16x32_bf16 v[4:7], a[208:211], v[192:195], v[4:7]
v_mov_b32_dpp v144, v140 row_ror:8 row_mask:0xf bank_mask:0x3
v_mov_b32_dpp v145, v141 row_ror:8 row_mask:0xf bank_mask:0x3
v_mfma_f32_16x16x32_bf16 v[8:11], a[224:227], v[192:195], 0
v_mov_b32_dpp v146, v142 row_ror:8 row_mask:0xf bank_mask:0x3
v_mov_b32_dpp v147, v143 row_ror:8 row_mask:0xf bank_mask:0x3
v_mfma_f32_16x16x32_bf16 v[8:11], a[228:231], v[196:199], v[8:11]
ds_read_b128 v[232:235], v242 offset:4480
v_mov_b32 v247, s54
v_mfma_f32_16x16x32_bf16 v[8:11], a[232:235], v[200:203], v[8:11]
v_mul_u32_u24 v246, 1728, v246
v_add_u32 v247, v246, v247
v_mfma_f32_16x16x32_bf16 v[8:11], a[236:239], v[208:211], v[8:11]
v_bfe_u32 v246, v245, 0, 2
v_mul_u32_u24 v246, 272, v246
v_mfma_f32_16x16x32_bf16 v[12:15], a[252:255], v[208:211], 0
ds_read_b128 v[208:211], v242 offset:4736
v_add_u32 v247, v246, v247
v_mfma_f32_16x16x32_bf16 v[12:15], a[248:251], v[200:203], v[12:15]
ds_read_b128 v[200:203], v242 offset:4992
v_bfe_u32 v246, v245, 4, 2
v_mfma_f32_16x16x32_bf16 v[12:15], a[244:247], v[196:199], v[12:15]
v_lshl_add_u32 v247, v246, 4, v247
v_mov_b32 v243, s54
v_mfma_f32_16x16x32_bf16 v[12:15], a[240:243], v[192:195], v[12:15]
ds_read_b128 v[196:199], v247 offset:0
ds_read_b128 v[192:195], v247 offset:64
v_mfma_f32_32x32x16_bf16 v[168:183], v[236:239], v[132:135], 0
buffer_store_dwordx4 v[136:139], v244, s[20:23], s52 offen offset:0 nt
buffer_store_dwordx4 v[144:147], v244, s[20:23], s52 offen offset:2048 nt
v_bfe_u32 v246, v245, 2, 2
v_add_u32 v243, 256, v243
v_mul_u32_u24 v246, 1728, v246
v_add_u32 v243, v246, v243
v_bfe_u32 v246, v245, 0, 2
v_mul_u32_u24 v246, 272, v246
v_add_u32 v243, v246, v243
v_mov_b32 v249, s54
v_bfe_u32 v246, v245, 4, 2
v_add_u32 v249, 1136, v249
v_mul_u32_u24 v246, 1728, v246
v_add_u32 v249, v246, v249
v_bfe_u32 v246, v245, 0, 4
v_lshl_add_u32 v249, v246, 3, v249
ds_read_b64 v[32:33], v249 offset:0
ds_read_b64 v[34:35], v249 offset:6912
ds_read_b64 v[36:37], v249 offset:128
ds_read_b64 v[38:39], v249 offset:7040
ds_read_b64 v[40:41], v249 offset:256
ds_read_b64 v[42:43], v249 offset:7168
ds_read_b64 v[44:45], v249 offset:384
ds_read_b64 v[46:47], v249 offset:7296
v_mov_b32 v250, s55
v_add_u32 v250, 160960, v250
v_bfe_u32 v246, v245, 0, 4
v_lshl_add_u32 v250, v246, 4, v250
ds_read_b64 v[96:97], v250 offset:0
ds_read_b32 v102, v250 offset:8
ds_read_b64 v[100:101], v250 offset:256
ds_read_b32 v103, v250 offset:264
v_mov_b64 v[98:99], 0
v_exp_f32 v188, v188
v_exp_f32 v189, v189
v_exp_f32 v190, v190
v_exp_f32 v191, v191
v_cvt_pk_bf16_f32 v126, v188, v189
v_cvt_pk_bf16_f32 v127, v190, v191
ds_read_b128 v[188:191], v247 offset:128
v_exp_f32 v204, v204
s_waitcnt lgkmcnt(4)
v_cndmask_b32 v96, 0, v96, vcc
v_cndmask_b32 v97, 0, v97, vcc
v_exp_f32 v205, v205
v_max3_f32 v255, v255, v212, v254
v_mfma_f32_16x16x32_bf16 v[196:199], v[32:35], v[96:99], v[196:199]
s_waitcnt lgkmcnt(1)
ds_read_b128 v[212:215], v242 offset:4224
v_cvt_pk_bf16_f32 v120, v204, v205
v_mfma_f32_16x16x32_bf16 v[192:195], v[36:39], v[96:99], v[192:195]
v_exp_f32 v206, v206
v_exp_f32 v207, v207
v_mov_b32 v248, 24576
s_waitcnt lgkmcnt(1)
v_mfma_f32_16x16x32_bf16 v[188:191], v[40:43], v[96:99], v[188:191]
v_cvt_pk_bf16_f32 v121, v206, v207
ds_read_b128 v[204:207], v247 offset:192
v_exp_f32 v216, v216
v_exp_f32 v217, v217
v_exp_f32 v218, v218
v_exp_f32 v219, v219
v_cvt_pk_bf16_f32 v122, v216, v217
v_cvt_pk_bf16_f32 v123, v218, v219
ds_read_b128 v[216:219], v243 offset:0
v_exp_f32 v220, v220
v_exp_f32 v221, v221
v_exp_f32 v222, v222
v_cvt_pk_bf16_f32 v124, v220, v221
s_waitcnt lgkmcnt(1)
v_mfma_f32_16x16x32_bf16 v[204:207], v[44:47], v[96:99], v[204:207]
v_exp_f32 v223, v223
v_mov_b64 v[220:221], 0
v_cvt_pk_bf16_f32 v125, v222, v223
v_exp_f32 v224, v224
v_cndmask_b32 v100, 0, v100, vcc
v_smfmac_f32_16x16x64_bf16 v[220:223], v[184:187], v[120:127], v251
s_lshl_b32 s51, s43, 7
s_add_u32 s51, s51, s44
s_add_u32 s51, s51, 52428800
v_exp_f32 v225, v225
v_exp_f32 v226, v226
v_exp_f32 v227, v227
v_exp_f32 v228, v228
v_exp_f32 v229, v229
v_exp_f32 v230, v230
v_exp_f32 v231, v231
v_cvt_pk_bf16_f32 v128, v224, v225
v_cvt_pk_bf16_f32 v129, v226, v227
ds_read_b128 v[224:227], v247 offset:6912
v_cvt_pk_bf16_f32 v130, v228, v229
v_cvt_pk_bf16_f32 v131, v230, v231
v_cndmask_b32 v101, 0, v101, vcc
v_bfe_u32 v246, v245, 0, 2
v_smfmac_f32_16x16x64_bf16 v[220:223], v[184:187], v[128:135], v251 abid:1
s_waitcnt lgkmcnt(1)
ds_read_b128 v[228:231], v247 offset:6976
v_add_f32 v216, v216, v217
v_mfma_f32_16x16x32_bf16 v[16:19], a[192:195], v[212:215], 0
s_add_u32 s99, s51, 26214400
v_add_f32 v218, v218, v219
v_add_f32 v216, v216, v102
v_mfma_f32_16x16x32_bf16 v[16:19], a[196:199], v[232:235], v[16:19]
v_add_f32 v216, v216, v218
v_add_f32 v220, v220, v221
v_mfma_f32_16x16x32_bf16 v[16:19], a[200:203], v[208:211], v[16:19]
v_rcp_f32 v217, v216
v_mfma_f32_16x16x32_bf16 v[16:19], a[204:207], v[200:203], v[16:19]
v_rcp_f32 v254, v220
v_mfma_f32_16x16x32_bf16 v[20:23], a[220:223], v[200:203], 0
v_max3_f32 v255, v255, v216, v217
v_max3_f32 v255, v255, v220, v254
v_mfma_f32_16x16x32_bf16 v[20:23], a[216:219], v[208:211], v[20:23]
ds_read_b128 v[220:223], v247 offset:7040
v_fmac_f32 v8, v188, v217
v_mfma_f32_16x16x32_bf16 v[20:23], a[212:215], v[232:235], v[20:23]
v_fmac_f32 v9, v189, v217
v_fmac_f32 v10, v190, v217
v_mfma_f32_16x16x32_bf16 v[20:23], a[208:211], v[212:215], v[20:23]
v_fmac_f32 v11, v191, v217
v_fmac_f32 v0, v196, v217
v_mfma_f32_16x16x32_bf16 v[24:27], a[224:227], v[212:215], 0
ds_read_b128 v[188:191], v247 offset:7104
v_fmac_f32 v1, v197, v217
v_mfma_f32_16x16x32_bf16 v[24:27], a[228:231], v[232:235], v[24:27]
v_lshl_add_u32 v248, v246, 8, v248
v_fmac_f32 v2, v198, v217
v_mfma_f32_16x16x32_bf16 v[24:27], a[232:235], v[208:211], v[24:27]
s_waitcnt lgkmcnt(3)
v_fmac_f32 v3, v199, v217
v_cvt_pk_bf16_f32 v0, v0, v1
v_mfma_f32_16x16x32_bf16 v[24:27], a[236:239], v[200:203], v[24:27]
v_cvt_pk_bf16_f32 v8, v8, v9
v_fmac_f32 v4, v192, v217
v_mfma_f32_16x16x32_bf16 v[28:31], a[252:255], v[200:203], 0
s_waitcnt lgkmcnt(2)
v_fmac_f32 v5, v193, v217
v_fmac_f32 v6, v194, v217
v_mfma_f32_16x16x32_bf16 v[28:31], a[248:251], v[208:211], v[28:31]
v_fmac_f32 v7, v195, v217
v_bfe_u32 v246, v245, 2, 1
v_mfma_f32_16x16x32_bf16 v[28:31], a[244:247], v[232:235], v[28:31]
ds_read_b128 v[192:195], v243 offset:6912
v_cvt_pk_bf16_f32 v1, v2, v3
v_mfma_f32_16x16x32_bf16 v[28:31], a[240:243], v[212:215], v[28:31]
v_fmac_f32 v12, v204, v217
v_fmac_f32 v13, v205, v217
v_mfma_f32_16x16x32_bf16 v[168:171], v[48:51], v[120:123], v[168:171]
v_fmac_f32 v14, v206, v217
v_fmac_f32 v15, v207, v217
v_mfma_f32_16x16x32_bf16 v[168:171], v[64:67], v[124:127], v[168:171]
v_cvt_pk_bf16_f32 v9, v10, v11
v_mul_u32_u24 v246, 13107200, v246
v_mfma_f32_16x16x32_bf16 v[168:171], v[80:83], v[128:131], v[168:171]
s_waitcnt lgkmcnt(2)
v_cvt_pk_bf16_f32 v2, v4, v5
v_cvt_pk_bf16_f32 v3, v6, v7
v_mfma_f32_16x16x32_bf16 v[172:175], v[84:87], v[128:131], v[172:175]
v_cvt_pk_bf16_f32 v10, v12, v13
v_cvt_pk_bf16_f32 v11, v14, v15
v_mfma_f32_16x16x32_bf16 v[172:175], v[52:55], v[120:123], v[172:175]
s_waitcnt lgkmcnt(0)
v_add_u32 v248, v246, v248
v_pk_max_i16 v0, v0, 0
v_mfma_f32_16x16x32_bf16 v[172:175], v[68:71], v[124:127], v[172:175]
v_pk_max_i16 v1, v1, 0
v_pk_max_i16 v2, v2, 0
v_mfma_f32_16x16x32_bf16 v[176:179], v[72:75], v[124:127], v[176:179]
v_pk_max_i16 v3, v3, 0
v_pk_max_i16 v8, v8, 0
v_mfma_f32_16x16x32_bf16 v[176:179], v[88:91], v[128:131], v[176:179]
v_pk_max_i16 v9, v9, 0
v_pk_max_i16 v10, v10, 0
v_mfma_f32_16x16x32_bf16 v[176:179], v[56:59], v[120:123], v[176:179]
v_pk_max_i16 v11, v11, 0
v_bfe_u32 v246, v245, 3, 1
v_mfma_f32_16x16x32_bf16 v[180:183], v[60:63], v[120:123], v[180:183]
v_mov_b64 v[4:5], v[0:1]
v_mov_b64 v[6:7], v[2:3]
v_mfma_f32_16x16x32_bf16 v[180:183], v[76:79], v[124:127], v[180:183]
v_lshl_add_u32 v248, v246, 6, v248
v_bfe_u32 v246, v245, 4, 2
v_mfma_f32_16x16x32_bf16 v[180:183], v[92:95], v[128:131], v[180:183]
v_mov_b32_dpp v0, v8 row_ror:8 row_mask:0xf bank_mask:0xc
v_mov_b32_dpp v1, v9 row_ror:8 row_mask:0xf bank_mask:0xc
v_mfma_f32_16x16x32_bf16 v[224:227], v[32:35], v[98:101], v[224:227]
v_mov_b32_dpp v2, v10 row_ror:8 row_mask:0xf bank_mask:0xc
v_mov_b32_dpp v3, v11 row_ror:8 row_mask:0xf bank_mask:0xc
v_mfma_f32_16x16x32_bf16 v[228:231], v[36:39], v[98:101], v[228:231]
v_lshl_add_u32 v248, v246, 4, v248
v_mov_b32_dpp v8, v4 row_ror:8 row_mask:0xf bank_mask:0x3
v_mfma_f32_16x16x32_bf16 v[220:223], v[40:43], v[98:101], v[220:223]
v_mov_b32_dpp v9, v5 row_ror:8 row_mask:0xf bank_mask:0x3
v_mov_b32_dpp v10, v6 row_ror:8 row_mask:0xf bank_mask:0x3
v_mfma_f32_16x16x32_bf16 v[188:191], v[44:47], v[98:101], v[188:191]
v_mov_b32_dpp v11, v7 row_ror:8 row_mask:0xf bank_mask:0x3
buffer_store_dwordx4 v[0:3], v248, s[20:23], s48 offen offset:0 nt
buffer_store_dwordx4 v[8:11], v248, s[20:23], s98 offen offset:0 nt
v_fmac_f32 v152, v168, v254
v_fmac_f32 v153, v169, v254
v_fmac_f32 v160, v176, v254
v_fmac_f32 v161, v177, v254
v_fmac_f32 v154, v170, v254
v_fmac_f32 v155, v171, v254
v_cvt_pk_bf16_f32 v152, v152, v153
v_fmac_f32 v162, v178, v254
v_fmac_f32 v163, v179, v254
v_cvt_pk_bf16_f32 v160, v160, v161
v_fmac_f32 v156, v172, v254
v_fmac_f32 v157, v173, v254
v_fmac_f32 v158, v174, v254
v_fmac_f32 v159, v175, v254
v_cvt_pk_bf16_f32 v153, v154, v155
v_fmac_f32 v164, v180, v254
v_fmac_f32 v165, v181, v254
v_fmac_f32 v166, v182, v254
v_fmac_f32 v167, v183, v254
v_cvt_pk_bf16_f32 v161, v162, v163
v_cvt_pk_bf16_f32 v154, v156, v157
v_cvt_pk_bf16_f32 v155, v158, v159
v_cvt_pk_bf16_f32 v162, v164, v165
v_cvt_pk_bf16_f32 v163, v166, v167
v_pk_max_i16 v152, v152, 0
v_pk_max_i16 v153, v153, 0
v_pk_max_i16 v154, v154, 0
v_pk_max_i16 v155, v155, 0
v_pk_max_i16 v160, v160, 0
v_pk_max_i16 v161, v161, 0
v_pk_max_i16 v162, v162, 0
v_pk_max_i16 v163, v163, 0
v_mov_b64 v[156:157], v[152:153]
v_mov_b64 v[158:159], v[154:155]
v_mov_b32_dpp v152, v160 row_ror:8 row_mask:0xf bank_mask:0xc
v_mov_b32_dpp v153, v161 row_ror:8 row_mask:0xf bank_mask:0xc
v_mov_b32_dpp v154, v162 row_ror:8 row_mask:0xf bank_mask:0xc
v_mov_b32_dpp v155, v163 row_ror:8 row_mask:0xf bank_mask:0xc
v_mov_b32_dpp v160, v156 row_ror:8 row_mask:0xf bank_mask:0x3
v_mov_b32_dpp v161, v157 row_ror:8 row_mask:0xf bank_mask:0x3
v_mov_b32_dpp v162, v158 row_ror:8 row_mask:0xf bank_mask:0x3
v_mov_b32_dpp v163, v159 row_ror:8 row_mask:0xf bank_mask:0x3
buffer_store_dwordx4 v[152:155], v244, s[20:23], s53 offen offset:0 nt
buffer_store_dwordx4 v[160:163], v244, s[20:23], s53 offen offset:2048 nt
v_add_f32 v192, v192, v193
v_add_f32 v194, v194, v195
v_add_f32 v192, v192, v103
v_add_f32 v192, v192, v194
v_rcp_f32 v193, v192
s_nop 0
v_fmac_f32 v16, v224, v193
v_fmac_f32 v17, v225, v193
v_fmac_f32 v24, v220, v193
v_fmac_f32 v25, v221, v193
v_fmac_f32 v18, v226, v193
v_fmac_f32 v19, v227, v193
v_cvt_pk_bf16_f32 v16, v16, v17
v_fmac_f32 v26, v222, v193
v_fmac_f32 v27, v223, v193
v_cvt_pk_bf16_f32 v24, v24, v25
v_fmac_f32 v20, v228, v193
v_fmac_f32 v21, v229, v193
v_fmac_f32 v22, v230, v193
v_fmac_f32 v23, v231, v193
v_cvt_pk_bf16_f32 v17, v18, v19
v_fmac_f32 v28, v188, v193
v_fmac_f32 v29, v189, v193
v_fmac_f32 v30, v190, v193
v_fmac_f32 v31, v191, v193
v_cvt_pk_bf16_f32 v25, v26, v27
v_cvt_pk_bf16_f32 v18, v20, v21
v_cvt_pk_bf16_f32 v19, v22, v23
v_cvt_pk_bf16_f32 v26, v28, v29
v_cvt_pk_bf16_f32 v27, v30, v31
v_pk_max_i16 v16, v16, 0
v_pk_max_i16 v17, v17, 0
v_pk_max_i16 v18, v18, 0
v_pk_max_i16 v19, v19, 0
v_pk_max_i16 v24, v24, 0
v_pk_max_i16 v25, v25, 0
v_pk_max_i16 v26, v26, 0
v_pk_max_i16 v27, v27, 0
v_mov_b64 v[20:21], v[16:17]
v_mov_b64 v[22:23], v[18:19]
v_mov_b32_dpp v16, v24 row_ror:8 row_mask:0xf bank_mask:0xc
v_mov_b32_dpp v17, v25 row_ror:8 row_mask:0xf bank_mask:0xc
v_mov_b32_dpp v18, v26 row_ror:8 row_mask:0xf bank_mask:0xc
v_mov_b32_dpp v19, v27 row_ror:8 row_mask:0xf bank_mask:0xc
v_mov_b32_dpp v24, v20 row_ror:8 row_mask:0xf bank_mask:0x3
v_mov_b32_dpp v25, v21 row_ror:8 row_mask:0xf bank_mask:0x3
v_mov_b32_dpp v26, v22 row_ror:8 row_mask:0xf bank_mask:0x3
v_mov_b32_dpp v27, v23 row_ror:8 row_mask:0xf bank_mask:0x3
buffer_store_dwordx4 v[16:19], v248, s[20:23], s51 offen offset:0 nt
buffer_store_dwordx4 v[24:27], v248, s[20:23], s99 offen offset:0 nt
v_max3_f32 v255, v255, v192, v193
v_mov_b32 v1, 0x53800000
v_cmp_nle_f32 vcc, v255, v1
s_lshl_b32 s52, s41, 2
s_add_u32 s52, s52, 163008
s_or_b32 s3, vcc_lo, vcc_hi
v_mov_b32 v2, s52
v_mov_b32 v3, s3
ds_write_b32 v2, v3
v_mov_b32 v2, 163008
s_waitcnt lgkmcnt(0)
s_barrier
ds_read_b128 v[4:7], v2
s_waitcnt lgkmcnt(0)
v_or_b32 v4, v4, v5
v_or3_b32 v4, v4, v6, v7
s_nop 0
v_readfirstlane_b32 s3, v4
s_nop 3
s_cmp_eq_u32 s3, 0
s_cbranch_scc1 L_end
L_fast_end:
s_waitcnt vmcnt(0)
s_barrier
s_mov_b32 s45, 8
s_mov_b32 s3, 64
s_mov_b32 s46, s44
s_mov_b32 s47, 0x7ff00000
s_mov_b32 s56, 50688
v_mbcnt_lo_u32_b32 v48, -1, 0
v_mbcnt_hi_u32_b32 v48, -1, v48
v_lshlrev_b32 v53, 4, v48
s_lshl_b32 s54, s41, 13
s_add_u32 s57, s54, 4096
v_and_b32 v49, 16, v48
v_lshlrev_b32 v52, 2, v49
v_lshlrev_b32 v49, 1, v49
v_xor_b32 v50, v53, v49
s_mul_i32 s49, s42, 25344
s_mul_i32 s53, s43, 1056
s_add_u32 s49, s49, s53
s_add_u32 m0, s49, 0
s_lshl_b32 s55, s43, 10
s_add_u32 s55, s55, s44
s_add_u32 s48, s55, 0
v_mov_b32 v237, 0
v_bfe_u32 v49, v48, 0, 2
v_lshl_add_u32 v237, v49, 4, v237
v_bfe_u32 v49, v48, 4, 2
v_lshl_add_u32 v237, v49, 6, v237
v_bfe_u32 v49, v48, 2, 2
v_lshl_add_u32 v237, v49, 8, v237
v_xor_b32 v51, 64, v50
s_lshl_b32 s53, s43, 14
v_mov_b32 v248, s53
v_add_u32 v248, 50688, v248
v_bfe_u32 v49, v48, 4, 2
v_lshl_add_u32 v248, v49, 10, v248
v_bfe_u32 v49, v48, 2, 2
v_lshl_add_u32 v248, v49, 7, v248
v_bfe_u32 v49, v48, 3, 1
v_lshl_add_u32 v248, v49, 5, v248
v_bfe_u32 v49, v48, 4, 1
v_lshl_add_u32 v248, v49, 6, v248
v_bfe_u32 v49, v48, 0, 2
v_lshl_add_u32 v248, v49, 3, v248
v_mov_b32 v252, s53
v_add_u32 v252, 116224, v252
v_bfe_u32 v49, v48, 4, 2
v_lshl_add_u32 v252, v49, 10, v252
v_bfe_u32 v49, v48, 2, 2
v_lshl_add_u32 v252, v49, 7, v252
v_bfe_u32 v49, v48, 3, 1
v_lshl_add_u32 v252, v49, 6, v252
v_bfe_u32 v49, v48, 0, 2
v_lshl_add_u32 v252, v49, 4, v252
s_mul_i32 s53, s42, 25344
v_bfe_u32 v49, v48, 2, 2
v_mov_b32 v236, s53
v_mul_u32_u24 v49, 1056, v49
v_add_u32 v236, v49, v236
v_bfe_u32 v49, v48, 0, 2
s_add_u32 s53, s54, 83456
v_lshl_add_u32 v236, v49, 6, v236
v_add_u32 v104, s53, v50
v_add_u32 v105, s53, v51
v_bfe_u32 v49, v48, 4, 2
s_lshl_b32 s53, s41, 12
v_lshl_add_u32 v236, v49, 4, v236
v_mov_b32 v54, s53
v_add_u32 v54, 50688, v54
v_bfe_u32 v49, v48, 3, 1
v_lshl_add_u32 v54, v49, 14, v54
v_bfe_u32 v49, v48, 4, 2
v_lshl_add_u32 v54, v49, 7, v54
v_bfe_u32 v49, v48, 2, 1
v_lshl_add_u32 v54, v49, 6, v54
v_bfe_u32 v49, v48, 5, 1
v_lshl_add_u32 v54, v49, 5, v54
v_bfe_u32 v49, v48, 0, 2
v_lshl_add_u32 v54, v49, 3, v54
s_lshl_b32 s53, s43, 7
v_mov_b32 v239, s53
v_bfe_u32 v49, v48, 0, 4
v_lshl_add_u32 v239, v49, 8, v239
s_mul_i32 s52, s41, 12288
s_add_u32 s52, s52, 101376
v_bfe_u32 v49, v48, 4, 2
v_lshl_add_u32 v239, v49, 4, v239
v_mov_b32 v241, s52
v_add_u32 v241, 8192, v241
v_bfe_u32 v49, v48, 4, 2
v_lshl_add_u32 v241, v49, 1, v241
v_bfe_u32 v49, v48, 0, 4
v_lshl_add_u32 v241, v49, 3, v241
buffer_load_dwordx4 v[152:155], v53, s[24:27], s54 offen offset:0
v_mov_b32 v240, s52
v_bfe_u32 v49, v48, 2, 2
v_lshl_add_u32 v240, v49, 7, v240
buffer_load_dwordx4 v[156:159], v53, s[24:27], s54 offen offset:1024
v_lshlrev_b32 v49, 2, v48
v_xor_b32 v49, v49, v48
v_and_b32 v49, 48, v49
buffer_load_dwordx4 v[160:163], v53, s[24:27], s54 offen offset:2048
s_lshl_b32 s53, s41, 10
v_add_u32 v240, v49, v240
v_mov_b32 v254, s53
v_add_u32 v254, 150528, v254
buffer_load_dwordx4 v[164:167], v53, s[24:27], s54 offen offset:3072
v_bfe_u32 v49, v48, 0, 6
v_mov_b32 v40, 0
v_mov_b32 v41, 0
buffer_load_dwordx4 v[168:171], v53, s[24:27], s57 offen offset:0
v_mov_b32 v42, 0
v_mov_b32 v43, 0
v_lshl_add_u32 v254, v49, 4, v254
buffer_load_dwordx4 v[172:175], v53, s[24:27], s57 offen offset:1024
ds_write_b128 v254, v[40:43] offset:0
buffer_load_dwordx4 v[176:179], v53, s[24:27], s57 offen offset:2048
ds_write_b128 v254, v[40:43] offset:256
buffer_load_dwordx4 v[180:183], v53, s[24:27], s57 offen offset:3072
buffer_load_dwordx4 v237, s[16:19], s48 offen nt lds
s_add_u32 m0, s49, 2112
s_add_u32 s48, s55, 2048
v_mov_b32 v245, s52
v_add_u32 v245, 4096, v245
buffer_load_dwordx4 v237, s[16:19], s48 offen nt lds
s_add_u32 m0, s49, 4224
s_add_u32 s48, s55, 4096
v_bfe_u32 v49, v48, 0, 2
buffer_load_dwordx4 v237, s[16:19], s48 offen nt lds
s_add_u32 m0, s49, 6336
s_add_u32 s48, s55, 6144
s_mov_b32 vcc_lo, 0x11111111
s_mov_b32 vcc_hi, 0x11111111
buffer_load_dwordx4 v237, s[16:19], s48 offen nt lds
s_add_u32 m0, s54, 50688
v_lshl_add_u32 v245, v49, 7, v245
v_mov_b32 v254, 150528
v_lshlrev_b32 v49, 4, v48
buffer_load_dwordx4 v50, s[28:31], s54 offen offset:0 lds
v_cndmask_b32 v240, v254, v240, vcc
v_xor_b32 v49, v49, v48
v_and_b32 v49, 48, v49
buffer_load_dwordx4 v51, s[28:31], s54 offen offset:1024 lds
s_mov_b32 vcc_lo, 0xf000f
s_mov_b32 vcc_hi, 0xf000f
v_add_u32 v245, v49, v245
buffer_load_dwordx4 v50, s[28:31], s54 offen offset:2048 lds
v_cndmask_b32 v242, v254, v245, vcc
s_mov_b32 vcc_lo, 0xf000f0
s_mov_b32 vcc_hi, 0xf000f0
buffer_load_dwordx4 v51, s[28:31], s54 offen offset:3072 lds
s_add_u32 m0, s57, 50688
v_cndmask_b32 v243, v254, v245, vcc
s_mov_b32 vcc_lo, 0xf000f00
s_mov_b32 vcc_hi, 0xf000f00
buffer_load_dwordx4 v50, s[28:31], s57 offen offset:0 lds
v_cndmask_b32 v244, v254, v245, vcc
s_mov_b32 vcc_lo, 0xf000f000
s_mov_b32 vcc_hi, 0xf000f000
v_mov_b32 v246, s52
buffer_load_dwordx4 v51, s[28:31], s57 offen offset:1024 lds
v_add_u32 v246, 4096, v246
v_bfe_u32 v49, v48, 0, 2
v_cndmask_b32 v245, v254, v245, vcc
buffer_load_dwordx4 v50, s[28:31], s57 offen offset:2048 lds
v_lshl_add_u32 v246, v49, 7, v246
v_mov_b32 v254, 154880
v_bfe_u32 v49, v48, 2, 2
buffer_load_dwordx4 v51, s[28:31], s57 offen offset:3072 lds
s_add_u32 m0, s49, 16896
s_mov_b32 vcc_lo, 0xf000f
s_mov_b32 vcc_hi, 0xf000f
v_lshl_add_u32 v254, v49, 3, v254
v_cndmask_b32 v246, v254, v246, vcc
v_xor_b32 v249, 32, v248
v_xor_b32 v250, 64, v248
v_xor_b32 v251, 96, v248
s_mul_i32 s4, s43, 13107200
s_add_u32 s4, s4, s44
s_add_u32 s4, s4, 24576
s_add_u32 s5, s55, 104857600
s_sub_u32 s5, s5, s4
s_add_u32 s48, s4, 0
v_xor_b32 v52, v53, v52
v_xor_b32 v55, 96, v54
v_xor_b32 v253, 64, v252
v_lshlrev_b32 v49, 4, v48
v_xor_b32 v49, v49, v48
v_and_b32 v49, 48, v49
v_add_u32 v246, v49, v246
v_add_u32 v246, v49, v246
v_mov_b32 v50, s52
v_bfe_u32 v49, v48, 0, 4
v_lshl_add_u32 v50, v49, 7, v50
v_lshlrev_b32 v49, 4, v48
v_xor_b32 v49, v49, v48
v_and_b32 v49, 48, v49
v_add_u32 v50, v49, v50
v_mov_b32 v51, s52
v_add_u32 v51, 8192, v51
v_bfe_u32 v49, v48, 4, 2
v_lshl_add_u32 v51, v49, 9, v51
v_bfe_u32 v49, v48, 0, 4
v_lshl_add_u32 v51, v49, 3, v51
s_add_u32 s50, s55, 13107200
s_mov_b32 s51, 2048
v_xor_b32 v247, 32, v48
s_mov_b32 s52, 0x7ff00000
v_lshlrev_b32 v247, 2, v247
s_waitcnt vmcnt(19)
v_and_b32 v254, 0xffff0000, v152
buffer_load_dwordx4 v237, s[16:19], s48 offen nt lds
s_add_u32 m0, s49, 19008
s_add_u32 s48, s4, 26214400
v_and_b32 v255, 0xffff0000, v153
v_lshlrev_b32 v152, 16, v152
v_lshlrev_b32 v153, 16, v153
v_mul_f32 v254, s40, v254
v_mul_f32 v152, s40, v152
v_mul_f32 v255, s40, v255
v_mul_f32 v153, s40, v153
v_cvt_pk_bf16_f32 v152, v152, v254
v_cvt_pk_bf16_f32 v153, v153, v255
v_and_b32 v254, 0xffff0000, v154
v_and_b32 v255, 0xffff0000, v155
v_lshlrev_b32 v154, 16, v154
v_lshlrev_b32 v155, 16, v155
v_mul_f32 v254, s40, v254
v_mul_f32 v154, s40, v154
v_mul_f32 v255, s40, v255
v_mul_f32 v155, s40, v155
v_cvt_pk_bf16_f32 v154, v154, v254
v_cvt_pk_bf16_f32 v155, v155, v255
s_waitcnt vmcnt(19)
v_and_b32 v254, 0xffff0000, v156
v_and_b32 v255, 0xffff0000, v157
v_lshlrev_b32 v156, 16, v156
v_lshlrev_b32 v157, 16, v157
v_mul_f32 v254, s40, v254
v_mul_f32 v156, s40, v156
v_mul_f32 v255, s40, v255
v_mul_f32 v157, s40, v157
v_cvt_pk_bf16_f32 v156, v156, v254
buffer_load_dwordx4 v237, s[16:19], s48 offen nt lds
s_add_u32 m0, s49, 21120
s_add_u32 s48, s4, 52428800
v_cvt_pk_bf16_f32 v157, v157, v255
v_and_b32 v254, 0xffff0000, v158
v_and_b32 v255, 0xffff0000, v159
v_lshlrev_b32 v158, 16, v158
v_lshlrev_b32 v159, 16, v159
v_mul_f32 v254, s40, v254
v_mul_f32 v158, s40, v158
v_mul_f32 v255, s40, v255
v_mul_f32 v159, s40, v159
v_cvt_pk_bf16_f32 v158, v158, v254
v_cvt_pk_bf16_f32 v159, v159, v255
s_waitcnt vmcnt(19)
v_and_b32 v254, 0xffff0000, v160
v_and_b32 v255, 0xffff0000, v161
v_lshlrev_b32 v160, 16, v160
v_lshlrev_b32 v161, 16, v161
v_mul_f32 v254, s40, v254
v_mul_f32 v160, s40, v160
v_mul_f32 v255, s40, v255
v_mul_f32 v161, s40, v161
v_cvt_pk_bf16_f32 v160, v160, v254
v_cvt_pk_bf16_f32 v161, v161, v255
v_and_b32 v254, 0xffff0000, v162
v_and_b32 v255, 0xffff0000, v163
v_lshlrev_b32 v162, 16, v162
v_lshlrev_b32 v163, 16, v163
v_mul_f32 v254, s40, v254
v_mul_f32 v162, s40, v162
v_mul_f32 v255, s40, v255
v_mul_f32 v163, s40, v163
v_cvt_pk_bf16_f32 v162, v162, v254
buffer_load_dwordx4 v237, s[16:19], s48 offen nt lds
s_add_u32 m0, s49, 23232
s_add_u32 s48, s4, 78643200
ds_write_b128 v104, v[152:155] offset:0
ds_write_b128 v105, v[156:159] offset:1024
v_cvt_pk_bf16_f32 v163, v163, v255
s_waitcnt vmcnt(19)
v_and_b32 v254, 0xffff0000, v164
v_and_b32 v255, 0xffff0000, v165
v_lshlrev_b32 v164, 16, v164
v_lshlrev_b32 v165, 16, v165
v_mul_f32 v254, s40, v254
v_mul_f32 v164, s40, v164
v_mul_f32 v255, s40, v255
v_mul_f32 v165, s40, v165
v_cvt_pk_bf16_f32 v164, v164, v254
v_cvt_pk_bf16_f32 v165, v165, v255
v_and_b32 v254, 0xffff0000, v166
v_and_b32 v255, 0xffff0000, v167
v_lshlrev_b32 v166, 16, v166
v_lshlrev_b32 v167, 16, v167
v_mul_f32 v254, s40, v254
buffer_load_dwordx4 v237, s[16:19], s48 offen nt lds
s_add_u32 m0, s54, 116224
s_add_u32 s48, s55, 8192
ds_write_b128 v104, v[160:163] offset:2048
v_mul_f32 v166, s40, v166
v_mul_f32 v255, s40, v255
v_mul_f32 v167, s40, v167
v_cvt_pk_bf16_f32 v166, v166, v254
v_cvt_pk_bf16_f32 v167, v167, v255
s_waitcnt vmcnt(19)
v_and_b32 v254, 0xffff0000, v168
v_and_b32 v255, 0xffff0000, v169
v_lshlrev_b32 v168, 16, v168
v_lshlrev_b32 v169, 16, v169
v_mul_f32 v254, s40, v254
v_mul_f32 v168, s40, v168
v_mul_f32 v255, s40, v255
v_mul_f32 v169, s40, v169
v_cvt_pk_bf16_f32 v168, v168, v254
v_cvt_pk_bf16_f32 v169, v169, v255
v_and_b32 v254, 0xffff0000, v170
v_and_b32 v255, 0xffff0000, v171
v_lshlrev_b32 v170, 16, v170
v_lshlrev_b32 v171, 16, v171
v_mul_f32 v254, s40, v254
v_mul_f32 v170, s40, v170
v_mul_f32 v255, s40, v255
v_mul_f32 v171, s40, v171
buffer_load_dwordx4 v52, s[32:35], s54 offen offset:0 lds
ds_write_b128 v105, v[164:167] offset:3072
v_cvt_pk_bf16_f32 v170, v170, v254
v_cvt_pk_bf16_f32 v171, v171, v255
s_waitcnt vmcnt(19)
v_and_b32 v254, 0xffff0000, v172
v_and_b32 v255, 0xffff0000, v173
v_lshlrev_b32 v172, 16, v172
v_lshlrev_b32 v173, 16, v173
v_mul_f32 v254, s40, v254
v_mul_f32 v172, s40, v172
v_mul_f32 v255, s40, v255
v_mul_f32 v173, s40, v173
v_cvt_pk_bf16_f32 v172, v172, v254
v_cvt_pk_bf16_f32 v173, v173, v255
v_and_b32 v254, 0xffff0000, v174
v_and_b32 v255, 0xffff0000, v175
v_lshlrev_b32 v174, 16, v174
v_lshlrev_b32 v175, 16, v175
v_mul_f32 v254, s40, v254
v_mul_f32 v174, s40, v174
v_mul_f32 v255, s40, v255
v_mul_f32 v175, s40, v175
v_cvt_pk_bf16_f32 v174, v174, v254
v_cvt_pk_bf16_f32 v175, v175, v255
s_waitcnt vmcnt(18)
v_and_b32 v254, 0xffff0000, v176
v_and_b32 v255, 0xffff0000, v177
v_lshlrev_b32 v176, 16, v176
buffer_load_dwordx4 v52, s[32:35], s54 offen offset:1024 lds
ds_write_b128 v104, v[168:171] offset:4096
v_lshlrev_b32 v177, 16, v177
v_mul_f32 v254, s40, v254
v_mul_f32 v176, s40, v176
v_mul_f32 v255, s40, v255
v_mul_f32 v177, s40, v177
v_cvt_pk_bf16_f32 v176, v176, v254
v_cvt_pk_bf16_f32 v177, v177, v255
v_and_b32 v254, 0xffff0000, v178
v_and_b32 v255, 0xffff0000, v179
v_lshlrev_b32 v178, 16, v178
v_lshlrev_b32 v179, 16, v179
v_mul_f32 v254, s40, v254
v_mul_f32 v178, s40, v178
v_mul_f32 v255, s40, v255
v_mul_f32 v179, s40, v179
v_cvt_pk_bf16_f32 v178, v178, v254
v_cvt_pk_bf16_f32 v179, v179, v255
s_waitcnt vmcnt(18)
v_and_b32 v254, 0xffff0000, v180
v_and_b32 v255, 0xffff0000, v181
v_lshlrev_b32 v180, 16, v180
v_lshlrev_b32 v181, 16, v181
v_mul_f32 v254, s40, v254
v_mul_f32 v180, s40, v180
v_mul_f32 v255, s40, v255
v_mul_f32 v181, s40, v181
buffer_load_dwordx4 v52, s[32:35], s54 offen offset:2048 lds
ds_write_b128 v105, v[172:175] offset:5120
ds_write_b128 v104, v[176:179] offset:6144
v_cvt_pk_bf16_f32 v180, v180, v254
v_cvt_pk_bf16_f32 v181, v181, v255
v_and_b32 v254, 0xffff0000, v182
v_and_b32 v255, 0xffff0000, v183
v_lshlrev_b32 v182, 16, v182
v_lshlrev_b32 v183, 16, v183
v_mul_f32 v254, s40, v254
v_mul_f32 v182, s40, v182
v_mul_f32 v255, s40, v255
v_mul_f32 v183, s40, v183
v_cvt_pk_bf16_f32 v182, v182, v254
v_cvt_pk_bf16_f32 v183, v183, v255
ds_write_b128 v105, v[180:183] offset:7168
buffer_load_dwordx4 v52, s[32:35], s54 offen offset:3072 lds
s_add_u32 m0, s57, 116224
v_xor_b32 v254, 32, v54
v_xor_b32 v255, 64, v54
s_mov_b32 s53, 0x7ff00000
buffer_load_dwordx4 v52, s[32:35], s57 offen offset:0 lds
buffer_load_dwordx4 v52, s[32:35], s57 offen offset:1024 lds
s_waitcnt vmcnt(10) lgkmcnt(0)
s_barrier
ds_read_b64_tr_b16 a[64:65], v248 offset:0
ds_read_b64_tr_b16 a[66:67], v248 offset:512
ds_read_b128 v[188:191], v236 offset:0
ds_read_b64_tr_b16 a[68:69], v248 offset:4096
ds_read_b64_tr_b16 a[70:71], v248 offset:4608
buffer_load_dwordx4 v52, s[32:35], s57 offen offset:2048 lds
ds_read_b128 v[196:199], v236 offset:256
ds_read_b64_tr_b16 a[72:73], v248 offset:8192
ds_read_b64_tr_b16 a[74:75], v248 offset:8704
ds_read_b128 v[200:203], v236 offset:512
ds_read_b64_tr_b16 a[76:77], v248 offset:12288
ds_read_b64_tr_b16 a[78:79], v248 offset:12800
ds_read_b128 v[204:207], v236 offset:768
ds_read_b64_tr_b16 a[92:93], v249 offset:12288
ds_read_b64_tr_b16 a[94:95], v249 offset:12800
ds_read_b64_tr_b16 a[88:89], v249 offset:8192
ds_read_b64_tr_b16 a[90:91], v249 offset:8704
ds_read_b64_tr_b16 a[84:85], v249 offset:4096
ds_read_b64_tr_b16 a[86:87], v249 offset:4608
ds_read_b64_tr_b16 a[80:81], v249 offset:0
ds_read_b64_tr_b16 a[82:83], v249 offset:512
s_waitcnt lgkmcnt(15)
v_mfma_f32_16x16x32_bf16 v[192:195], a[64:67], v[188:191], 0
ds_read_b64_tr_b16 a[96:97], v250 offset:0
ds_read_b64_tr_b16 a[98:99], v250 offset:512
s_waitcnt lgkmcnt(15)
v_mfma_f32_16x16x32_bf16 v[192:195], a[68:71], v[196:199], v[192:195]
s_waitcnt lgkmcnt(14)
ds_read_b64_tr_b16 a[100:101], v250 offset:4096
s_waitcnt lgkmcnt(14)
v_mfma_f32_16x16x32_bf16 v[192:195], a[72:75], v[200:203], v[192:195]
s_waitcnt lgkmcnt(11)
ds_read_b64_tr_b16 a[102:103], v250 offset:4608
ds_read_b64_tr_b16 a[104:105], v250 offset:8192
v_mfma_f32_16x16x32_bf16 v[192:195], a[76:79], v[204:207], v[192:195]
s_waitcnt lgkmcnt(9)
ds_read_b64_tr_b16 a[106:107], v250 offset:8704
ds_read_b64_tr_b16 a[108:109], v250 offset:12288
v_mfma_f32_16x16x32_bf16 v[208:211], a[92:95], v[204:207], 0
s_waitcnt lgkmcnt(7)
buffer_load_dwordx4 v52, s[32:35], s57 offen offset:3072 lds
s_add_u32 m0, s49, 8448
v_mfma_f32_16x16x32_bf16 v[208:211], a[88:91], v[200:203], v[208:211]
ds_read_b64_tr_b16 a[110:111], v250 offset:12800
v_cvt_pk_bf16_f32 v0, v192, v193
v_mfma_f32_16x16x32_bf16 v[208:211], a[84:87], v[196:199], v[208:211]
s_waitcnt lgkmcnt(6)
ds_read_b64_tr_b16 a[124:125], v251 offset:12288
v_cvt_pk_bf16_f32 v1, v194, v195
v_mfma_f32_16x16x32_bf16 v[208:211], a[80:83], v[188:191], v[208:211]
s_waitcnt lgkmcnt(6)
ds_read_b64_tr_b16 a[126:127], v251 offset:12800
ds_read_b64_tr_b16 a[120:121], v251 offset:8192
v_mfma_f32_16x16x32_bf16 v[192:195], a[96:99], v[188:191], 0
s_waitcnt lgkmcnt(6)
ds_read_b64_tr_b16 a[122:123], v251 offset:8704
ds_read_b64_tr_b16 a[116:117], v251 offset:4096
v_mfma_f32_16x16x32_bf16 v[192:195], a[100:103], v[196:199], v[192:195]
s_waitcnt lgkmcnt(6)
ds_read_b64_tr_b16 a[118:119], v251 offset:4608
v_cvt_pk_bf16_f32 v2, v208, v209
v_mfma_f32_16x16x32_bf16 v[192:195], a[104:107], v[200:203], v[192:195]
ds_read_b64_tr_b16 a[112:113], v251 offset:0
s_waitcnt lgkmcnt(7)
v_mfma_f32_16x16x32_bf16 v[192:195], a[108:111], v[204:207], v[192:195]
ds_read_b64_tr_b16 a[114:115], v251 offset:512
v_cvt_pk_bf16_f32 v3, v210, v211
ds_read_b128 v[184:187], v236 offset:4992
s_waitcnt lgkmcnt(7)
v_mfma_f32_16x16x32_bf16 v[208:211], a[124:127], v[204:207], 0
s_waitcnt lgkmcnt(6)
buffer_load_dwordx4 v[120:123], v53, s[36:39], s54 offen offset:0
s_waitcnt lgkmcnt(5)
v_mfma_f32_16x16x32_bf16 v[208:211], a[120:123], v[200:203], v[208:211]
s_waitcnt lgkmcnt(4)
ds_read_b128 v[216:219], v236 offset:4736
s_waitcnt lgkmcnt(4)
v_mfma_f32_16x16x32_bf16 v[208:211], a[116:119], v[196:199], v[208:211]
ds_read_b128 v[204:207], v236 offset:4480
v_cvt_pk_bf16_f32 v5, v194, v195
v_cvt_pk_bf16_f32 v4, v192, v193
s_waitcnt lgkmcnt(3)
v_mfma_f32_16x16x32_bf16 v[208:211], a[112:115], v[188:191], v[208:211]
ds_read_b128 v[192:195], v236 offset:4224
s_waitcnt lgkmcnt(3)
v_mfma_f32_16x16x32_bf16 v[200:203], a[124:127], v[184:187], 0
ds_read_b64_tr_b16 a[0:1], v248 offset:32768
ds_read_b64_tr_b16 a[2:3], v248 offset:33280
v_mfma_f32_16x16x32_bf16 v[220:223], a[92:95], v[184:187], 0
ds_read_b64_tr_b16 a[4:5], v248 offset:36864
s_waitcnt lgkmcnt(5)
v_mfma_f32_16x16x32_bf16 v[200:203], a[120:123], v[216:219], v[200:203]
ds_read_b64_tr_b16 a[6:7], v248 offset:37376
s_waitcnt lgkmcnt(5)
v_mfma_f32_16x16x32_bf16 v[200:203], a[116:119], v[204:207], v[200:203]
ds_read_b64_tr_b16 a[8:9], v248 offset:40960
v_cvt_pk_bf16_f32 v6, v208, v209
v_mfma_f32_16x16x32_bf16 v[220:223], a[88:91], v[216:219], v[220:223]
buffer_load_dwordx4 v[124:127], v53, s[36:39], s54 offen offset:1024
s_waitcnt lgkmcnt(5)
v_mfma_f32_16x16x32_bf16 v[200:203], a[112:115], v[192:195], v[200:203]
ds_read_b64_tr_b16 a[10:11], v248 offset:41472
v_cvt_pk_bf16_f32 v7, v210, v211
v_mfma_f32_16x16x32_bf16 v[208:211], a[96:99], v[192:195], 0
s_waitcnt lgkmcnt(4)
ds_read_b64_tr_b16 a[12:13], v248 offset:45056
ds_read_b64_tr_b16 a[14:15], v248 offset:45568
v_mfma_f32_16x16x32_bf16 v[208:211], a[100:103], v[204:207], v[208:211]
s_waitcnt lgkmcnt(5)
ds_read_b64_tr_b16 a[16:17], v249 offset:32768
ds_read_b64_tr_b16 a[18:19], v249 offset:33280
v_mfma_f32_16x16x32_bf16 v[208:211], a[104:107], v[216:219], v[208:211]
s_waitcnt lgkmcnt(6)
ds_read_b64_tr_b16 a[20:21], v249 offset:36864
ds_read_b64_tr_b16 a[22:23], v249 offset:37376
v_mfma_f32_16x16x32_bf16 v[208:211], a[108:111], v[184:187], v[208:211]
s_waitcnt lgkmcnt(7)
ds_read_b64_tr_b16 a[24:25], v249 offset:40960
ds_read_b64_tr_b16 a[26:27], v249 offset:41472
v_mfma_f32_16x16x32_bf16 v[220:223], a[84:87], v[204:207], v[220:223]
ds_read_b64_tr_b16 a[28:29], v249 offset:45056
ds_read_b64_tr_b16 a[30:31], v249 offset:45568
v_mfma_f32_16x16x32_bf16 v[220:223], a[80:83], v[192:195], v[220:223]
s_waitcnt lgkmcnt(10)
ds_read_b64_tr_b16 a[32:33], v250 offset:32768
ds_read_b64_tr_b16 a[34:35], v250 offset:33280
v_mfma_f32_16x16x32_bf16 v[188:191], a[64:67], v[192:195], 0
s_waitcnt lgkmcnt(10)
ds_read_b64_tr_b16 a[36:37], v250 offset:36864
ds_read_b64_tr_b16 a[38:39], v250 offset:37376
v_mfma_f32_16x16x32_bf16 v[188:191], a[72:75], v[216:219], v[188:191]
s_waitcnt lgkmcnt(10)
buffer_load_dwordx4 v[128:131], v53, s[36:39], s54 offen offset:2048
ds_read_b64_tr_b16 a[40:41], v250 offset:40960
v_mfma_f32_16x16x32_bf16 v[188:191], a[76:79], v[184:187], v[188:191]
s_waitcnt lgkmcnt(9)
ds_read_b64_tr_b16 a[42:43], v250 offset:41472
ds_read_b64_tr_b16 a[44:45], v250 offset:45056
v_mfma_f32_16x16x32_bf16 v[188:191], a[68:71], v[204:207], v[188:191]
s_waitcnt lgkmcnt(9)
ds_read_b64_tr_b16 a[46:47], v250 offset:45568
ds_read_b64_tr_b16 a[48:49], v251 offset:32768
ds_read_b64_tr_b16 a[50:51], v251 offset:33280
ds_read_b64_tr_b16 a[52:53], v251 offset:36864
ds_read_b64_tr_b16 a[54:55], v251 offset:37376
ds_read_b64_tr_b16 a[56:57], v251 offset:40960
ds_read_b64_tr_b16 a[58:59], v251 offset:41472
s_waitcnt vmcnt(11)
s_barrier
ds_read_b128 v[56:59], v236 offset:16896
ds_read_b128 v[60:63], v236 offset:17152
ds_read_b128 v[64:67], v236 offset:17408
ds_read_b128 v[68:71], v236 offset:17664
ds_read_b128 v[72:75], v236 offset:21120
ds_read_b128 v[76:79], v236 offset:21376
ds_read_b128 v[80:83], v236 offset:21632
ds_read_b128 v[84:87], v236 offset:21888
ds_read_b64_tr_b16 a[60:61], v251 offset:45056
ds_read_b64_tr_b16 a[62:63], v251 offset:45568
v_cvt_pk_bf16_f32 v14, v200, v201
buffer_load_dwordx4 v[132:135], v53, s[36:39], s54 offen offset:3072
v_cvt_pk_bf16_f32 v15, v202, v203
v_cvt_pk_bf16_f32 v9, v190, v191
v_cvt_pk_bf16_f32 v8, v188, v189
v_cvt_pk_bf16_f32 v13, v210, v211
v_cvt_pk_bf16_f32 v12, v208, v209
v_cvt_pk_bf16_f32 v10, v220, v221
v_cvt_pk_bf16_f32 v11, v222, v223
s_waitcnt lgkmcnt(9)
v_mfma_f32_16x16x32_bf16 v[156:159], a[64:67], v[56:59], 0
s_waitcnt lgkmcnt(7)
v_mfma_f32_16x16x32_bf16 v[156:159], a[68:71], v[60:63], v[156:159]
s_waitcnt lgkmcnt(3)
v_mfma_f32_16x16x32_bf16 v[156:159], a[72:75], v[64:67], v[156:159]
s_waitcnt lgkmcnt(0)
v_mfma_f32_16x16x32_bf16 v[156:159], a[76:79], v[68:71], v[156:159]
s_nop 2
v_mfma_f32_16x16x32_bf16 v[160:163], a[92:95], v[68:71], 0
s_nop 2
v_mfma_f32_16x16x32_bf16 v[160:163], a[88:91], v[64:67], v[160:163]
s_waitcnt vmcnt(4)
s_barrier
v_mfma_f32_16x16x32_bf16 v[160:163], a[84:87], v[60:63], v[160:163]
buffer_load_dwordx4 v[136:139], v53, s[36:39], s57 offen offset:0
ds_read_b64_tr_b16 a[128:129], v252 offset:0
v_mfma_f32_16x16x32_bf16 v[160:163], a[80:83], v[56:59], v[160:163]
ds_read_b64_tr_b16 a[130:131], v252 offset:512
ds_read_b64_tr_b16 a[132:133], v252 offset:4096
v_mfma_f32_16x16x32_bf16 v[164:167], a[96:99], v[56:59], 0
ds_read_b64_tr_b16 a[134:135], v252 offset:4608
ds_read_b64_tr_b16 a[136:137], v252 offset:8192
v_mfma_f32_16x16x32_bf16 v[164:167], a[100:103], v[60:63], v[164:167]
ds_read_b64_tr_b16 a[138:139], v252 offset:8704
ds_read_b64_tr_b16 a[140:141], v252 offset:12288
v_mfma_f32_16x16x32_bf16 v[164:167], a[104:107], v[64:67], v[164:167]
ds_read_b64_tr_b16 a[142:143], v252 offset:12800
ds_read_b64_tr_b16 a[144:145], v252 offset:8
v_mfma_f32_16x16x32_bf16 v[164:167], a[108:111], v[68:71], v[164:167]
ds_read_b64_tr_b16 a[146:147], v252 offset:520
ds_read_b64_tr_b16 a[148:149], v252 offset:4104
v_mfma_f32_16x16x32_bf16 v[168:171], a[124:127], v[68:71], 0
s_waitcnt lgkmcnt(10)
ds_read_b64_tr_b16 a[150:151], v252 offset:4616
v_cvt_pk_bf16_f32 v88, v156, v157
v_mfma_f32_16x16x32_bf16 v[168:171], a[120:123], v[64:67], v[168:171]
s_waitcnt lgkmcnt(9)
ds_read_b64_tr_b16 a[152:153], v252 offset:8200
v_cvt_pk_bf16_f32 v89, v158, v159
v_mfma_f32_16x16x32_bf16 v[168:171], a[116:119], v[60:63], v[168:171]
s_waitcnt lgkmcnt(8)
ds_read_b64_tr_b16 a[154:155], v252 offset:8712
ds_read_b64_tr_b16 a[156:157], v252 offset:12296
v_mfma_f32_16x16x32_bf16 v[168:171], a[112:115], v[56:59], v[168:171]
s_waitcnt lgkmcnt(8)
buffer_load_dwordx4 v[140:143], v53, s[36:39], s57 offen offset:1024
ds_read_b64_tr_b16 a[158:159], v252 offset:12808
v_mfma_f32_16x16x32_bf16 v[172:175], a[64:67], v[72:75], 0
s_waitcnt lgkmcnt(7)
ds_read_b64_tr_b16 a[160:161], v253 offset:0
v_cvt_pk_bf16_f32 v90, v160, v161
v_mfma_f32_16x16x32_bf16 v[172:175], a[68:71], v[76:79], v[172:175]
s_waitcnt lgkmcnt(6)
ds_read_b64_tr_b16 a[162:163], v253 offset:512
v_cvt_pk_bf16_f32 v91, v162, v163
v_mfma_f32_16x16x32_bf16 v[172:175], a[72:75], v[80:83], v[172:175]
s_waitcnt lgkmcnt(6)
ds_read_b64_tr_b16 a[164:165], v253 offset:4096
ds_read_b64_tr_b16 a[166:167], v253 offset:4608
v_mfma_f32_16x16x32_bf16 v[172:175], a[76:79], v[84:87], v[172:175]
s_waitcnt lgkmcnt(7)
ds_read_b64_tr_b16 a[168:169], v253 offset:8192
ds_read_b64_tr_b16 a[170:171], v253 offset:8704
v_mfma_f32_16x16x32_bf16 v[176:179], a[92:95], v[84:87], 0
s_waitcnt lgkmcnt(7)
ds_read_b64_tr_b16 a[172:173], v253 offset:12288
v_cvt_pk_bf16_f32 v92, v164, v165
v_mfma_f32_16x16x32_bf16 v[176:179], a[88:91], v[80:83], v[176:179]
s_waitcnt lgkmcnt(7)
ds_read_b64_tr_b16 a[174:175], v253 offset:12800
v_cvt_pk_bf16_f32 v93, v166, v167
v_mfma_f32_16x16x32_bf16 v[176:179], a[84:87], v[76:79], v[176:179]
s_waitcnt lgkmcnt(7)
ds_read_b64_tr_b16 a[176:177], v253 offset:8
ds_read_b64_tr_b16 a[178:179], v253 offset:520
v_mfma_f32_16x16x32_bf16 v[176:179], a[80:83], v[72:75], v[176:179]
s_waitcnt lgkmcnt(8)
ds_read_b64_tr_b16 a[180:181], v253 offset:4104
ds_read_b64_tr_b16 a[182:183], v253 offset:4616
v_mfma_f32_16x16x32_bf16 v[180:183], a[96:99], v[72:75], 0
s_waitcnt lgkmcnt(8)
buffer_load_dwordx4 v[144:147], v53, s[36:39], s57 offen offset:2048
v_cvt_pk_bf16_f32 v94, v168, v169
v_mfma_f32_16x16x32_bf16 v[180:183], a[100:103], v[76:79], v[180:183]
s_waitcnt lgkmcnt(6)
ds_read_b64_tr_b16 a[184:185], v253 offset:8200
v_cvt_pk_bf16_f32 v95, v170, v171
v_mfma_f32_16x16x32_bf16 v[180:183], a[104:107], v[80:83], v[180:183]
s_waitcnt lgkmcnt(6)
ds_read_b64_tr_b16 a[186:187], v253 offset:8712
ds_read_b64_tr_b16 a[188:189], v253 offset:12296
v_mfma_f32_16x16x32_bf16 v[180:183], a[108:111], v[84:87], v[180:183]
s_waitcnt lgkmcnt(7)
ds_read_b64_tr_b16 a[190:191], v253 offset:12808
v_cvt_pk_bf16_f32 v96, v172, v173
v_mfma_f32_16x16x32_bf16 v[152:155], a[124:127], v[84:87], 0
s_waitcnt lgkmcnt(6)
v_cvt_pk_bf16_f32 v97, v174, v175
v_cvt_pk_bf16_f32 v98, v176, v177
v_mfma_f32_16x16x32_bf16 v[152:155], a[120:123], v[80:83], v[152:155]
s_waitcnt lgkmcnt(4)
v_cvt_pk_bf16_f32 v99, v178, v179
v_cvt_pk_bf16_f32 v100, v180, v181
v_mfma_f32_16x16x32_bf16 v[152:155], a[116:119], v[76:79], v[152:155]
v_cvt_pk_bf16_f32 v101, v182, v183
v_mov_b32 v253, 0
v_mfma_f32_16x16x32_bf16 v[152:155], a[112:115], v[72:75], v[152:155]
s_waitcnt lgkmcnt(3)
v_mov_b32 v252, 1.0
s_nop 0
v_mfma_f32_16x16x32_bf16 v[156:159], a[0:3], v[56:59], 0
s_waitcnt lgkmcnt(1)
s_nop 1
v_mfma_f32_16x16x32_bf16 v[156:159], a[4:7], v[60:63], v[156:159]
s_waitcnt lgkmcnt(0)
buffer_load_dwordx4 v[148:151], v53, s[36:39], s57 offen offset:3072
v_cvt_pk_bf16_f32 v102, v152, v153
v_mfma_f32_16x16x32_bf16 v[156:159], a[8:11], v[64:67], v[156:159]
v_cvt_pk_bf16_f32 v103, v154, v155
v_mfma_f32_16x16x32_bf16 v[156:159], a[12:15], v[68:71], v[156:159]
s_nop 2
v_mfma_f32_16x16x32_bf16 v[160:163], a[28:31], v[68:71], 0
s_nop 2
v_mfma_f32_16x16x32_bf16 v[160:163], a[24:27], v[64:67], v[160:163]
v_cvt_pk_bf16_f32 v104, v156, v157
v_cvt_pk_bf16_f32 v105, v158, v159
v_mfma_f32_16x16x32_bf16 v[160:163], a[20:23], v[60:63], v[160:163]
v_mfma_f32_16x16x32_bf16 v[160:163], a[16:19], v[56:59], v[160:163]
s_nop 2
v_mfma_f32_16x16x32_bf16 v[164:167], a[32:35], v[56:59], 0
s_nop 2
v_mfma_f32_16x16x32_bf16 v[164:167], a[36:39], v[60:63], v[164:167]
v_cvt_pk_bf16_f32 v106, v160, v161
v_cvt_pk_bf16_f32 v107, v162, v163
v_mfma_f32_16x16x32_bf16 v[164:167], a[40:43], v[64:67], v[164:167]
buffer_load_dwordx4 v237, s[16:19], s48 offen nt lds
s_add_u32 m0, s49, 10560
v_mfma_f32_16x16x32_bf16 v[164:167], a[44:47], v[68:71], v[164:167]
s_add_u32 s48, s55, 10240
s_nop 1
v_mfma_f32_16x16x32_bf16 v[168:171], a[60:63], v[68:71], 0
s_nop 2
v_mfma_f32_16x16x32_bf16 v[168:171], a[56:59], v[64:67], v[168:171]
v_cvt_pk_bf16_f32 v108, v164, v165
v_cvt_pk_bf16_f32 v109, v166, v167
v_mfma_f32_16x16x32_bf16 v[168:171], a[52:55], v[60:63], v[168:171]
v_mfma_f32_16x16x32_bf16 v[168:171], a[48:51], v[56:59], v[168:171]
s_nop 2
v_mfma_f32_16x16x32_bf16 v[172:175], a[0:3], v[72:75], 0
s_waitcnt vmcnt(8)
ds_write_b64 v54, v[120:121] offset:0
v_mfma_f32_16x16x32_bf16 v[172:175], a[4:7], v[76:79], v[172:175]
ds_write_b64 v254, v[122:123] offset:0
v_mfma_f32_16x16x32_bf16 v[172:175], a[8:11], v[80:83], v[172:175]
buffer_load_dwordx4 v237, s[16:19], s48 offen nt lds
v_mfma_f32_16x16x32_bf16 v[172:175], a[12:15], v[84:87], v[172:175]
s_add_u32 m0, s49, 12672
s_add_u32 s48, s55, 12288
v_cvt_pk_bf16_f32 v110, v168, v169
v_mfma_f32_16x16x32_bf16 v[176:179], a[28:31], v[84:87], 0
s_waitcnt vmcnt(8)
ds_write_b64 v54, v[124:125] offset:512
v_mfma_f32_16x16x32_bf16 v[176:179], a[24:27], v[80:83], v[176:179]
ds_write_b64 v254, v[126:127] offset:512
v_mfma_f32_16x16x32_bf16 v[176:179], a[20:23], v[76:79], v[176:179]
s_waitcnt vmcnt(7)
ds_write_b64 v255, v[128:129] offset:1024
v_mfma_f32_16x16x32_bf16 v[176:179], a[16:19], v[72:75], v[176:179]
ds_write_b64 v55, v[130:131] offset:1024
v_mfma_f32_16x16x32_bf16 v[180:183], a[32:35], v[72:75], 0
s_waitcnt vmcnt(6)
ds_write_b64 v255, v[132:133] offset:1536
v_mfma_f32_16x16x32_bf16 v[180:183], a[36:39], v[76:79], v[180:183]
ds_write_b64 v55, v[134:135] offset:1536
v_mfma_f32_16x16x32_bf16 v[180:183], a[40:43], v[80:83], v[180:183]
buffer_load_dwordx4 v237, s[16:19], s48 offen nt lds
s_add_u32 m0, s49, 14784
v_mfma_f32_16x16x32_bf16 v[180:183], a[44:47], v[84:87], v[180:183]
s_add_u32 s48, s55, 14336
v_cvt_pk_bf16_f32 v111, v170, v171
v_cvt_pk_bf16_f32 v112, v172, v173
v_mfma_f32_16x16x32_bf16 v[152:155], a[60:63], v[84:87], 0
s_waitcnt vmcnt(6)
ds_write_b64 v54, v[136:137] offset:2048
v_mfma_f32_16x16x32_bf16 v[152:155], a[56:59], v[80:83], v[152:155]
ds_write_b64 v254, v[138:139] offset:2048
v_mfma_f32_16x16x32_bf16 v[152:155], a[52:55], v[76:79], v[152:155]
s_waitcnt vmcnt(5)
ds_write_b64 v54, v[140:141] offset:2560
v_mfma_f32_16x16x32_bf16 v[152:155], a[48:51], v[72:75], v[152:155]
ds_write_b64 v254, v[142:143] offset:2560
v_mfma_f32_16x16x32_bf16 v[156:159], v[56:59], a[128:131], 0
s_waitcnt vmcnt(4)
ds_write_b64 v255, v[144:145] offset:3072
v_mfma_f32_16x16x32_bf16 v[156:159], v[60:63], a[132:135], v[156:159]
ds_write_b64 v55, v[146:147] offset:3072
v_mfma_f32_16x16x32_bf16 v[156:159], v[64:67], a[136:139], v[156:159]
buffer_load_dwordx4 v237, s[16:19], s48 offen nt lds
s_add_u32 m0, s49, 16896
v_mfma_f32_16x16x32_bf16 v[156:159], v[68:71], a[140:143], v[156:159]
s_add_u32 s48, s55, 16384
buffer_load_dwordx4 v237, s[16:19], s48 offen nt lds
s_add_u32 m0, s49, 19008
v_mfma_f32_16x16x32_bf16 v[160:163], v[68:71], a[156:159], 0
s_add_u32 s48, s55, 18432
buffer_load_dwordx4 v237, s[16:19], s48 offen nt lds
s_add_u32 m0, s49, 21120
v_mfma_f32_16x16x32_bf16 v[160:163], v[64:67], a[152:155], v[160:163]
s_add_u32 s48, s55, 20480
buffer_load_dwordx4 v237, s[16:19], s48 offen nt lds
s_add_u32 m0, s49, 23232
v_mfma_f32_16x16x32_bf16 v[160:163], v[60:63], a[148:151], v[160:163]
s_add_u32 s48, s55, 22528
buffer_load_dwordx4 v237, s[16:19], s48 offen nt lds
v_cvt_pk_bf16_f32 v113, v174, v175
v_mfma_f32_16x16x32_bf16 v[160:163], v[56:59], a[144:147], v[160:163]
s_add_u32 s49, s49, 50688
v_cvt_pk_bf16_f32 v114, v176, v177
v_cvt_pk_bf16_f32 v115, v178, v179
v_mfma_f32_16x16x32_bf16 v[164:167], v[56:59], a[160:163], 0
s_waitcnt vmcnt(8)
ds_write_b64 v255, v[148:149] offset:3584
v_mfma_f32_16x16x32_bf16 v[164:167], v[60:63], a[164:167], v[164:167]
ds_write_b64 v55, v[150:151] offset:3584
v_mfma_f32_16x16x32_bf16 v[164:167], v[64:67], a[168:171], v[164:167]
v_cvt_pk_bf16_f32 v116, v180, v181
v_cvt_pk_bf16_f32 v117, v182, v183
v_mfma_f32_16x16x32_bf16 v[164:167], v[68:71], a[172:175], v[164:167]
v_cvt_pk_bf16_f32 v118, v152, v153
v_cvt_pk_bf16_f32 v119, v154, v155
v_mfma_f32_16x16x32_bf16 v[168:171], v[68:71], a[188:191], 0
v_cvt_pk_bf16_f32 v156, v156, v157
v_cvt_pk_bf16_f32 v157, v158, v159
v_mfma_f32_16x16x32_bf16 v[168:171], v[64:67], a[184:187], v[168:171]
v_cvt_pk_bf16_f32 v160, v160, v161
v_cvt_pk_bf16_f32 v161, v162, v163
v_mfma_f32_16x16x32_bf16 v[168:171], v[60:63], a[180:183], v[168:171]
s_waitcnt lgkmcnt(0)
s_barrier
v_mfma_f32_16x16x32_bf16 v[168:171], v[56:59], a[176:179], v[168:171]
ds_read_b64_tr_b16 a[192:193], v248 offset:0
ds_read_b64_tr_b16 a[194:195], v248 offset:512
v_mfma_f32_16x16x32_bf16 v[172:175], v[72:75], a[128:131], 0
ds_read_b64_tr_b16 a[196:197], v248 offset:4096
ds_read_b64_tr_b16 a[198:199], v248 offset:4608
v_mfma_f32_16x16x32_bf16 v[172:175], v[76:79], a[132:135], v[172:175]
ds_read_b64_tr_b16 a[200:201], v248 offset:8192
ds_read_b64_tr_b16 a[202:203], v248 offset:8704
v_mfma_f32_16x16x32_bf16 v[172:175], v[80:83], a[136:139], v[172:175]
ds_read_b64_tr_b16 a[204:205], v248 offset:12288
ds_read_b64_tr_b16 a[206:207], v248 offset:12800
v_mfma_f32_16x16x32_bf16 v[172:175], v[84:87], a[140:143], v[172:175]
ds_read_b64_tr_b16 a[208:209], v249 offset:0
ds_read_b64_tr_b16 a[210:211], v249 offset:512
v_mfma_f32_16x16x32_bf16 v[176:179], v[84:87], a[156:159], 0
ds_read_b64_tr_b16 a[212:213], v249 offset:4096
ds_read_b64_tr_b16 a[214:215], v249 offset:4608
v_mfma_f32_16x16x32_bf16 v[176:179], v[80:83], a[152:155], v[176:179]
s_waitcnt lgkmcnt(10)
ds_read_b64_tr_b16 a[216:217], v249 offset:8192
ds_read_b64_tr_b16 a[218:219], v249 offset:8704
v_mfma_f32_16x16x32_bf16 v[176:179], v[76:79], a[148:151], v[176:179]
s_waitcnt lgkmcnt(10)
ds_read_b64_tr_b16 a[220:221], v249 offset:12288
ds_read_b64_tr_b16 a[222:223], v249 offset:12800
v_mfma_f32_16x16x32_bf16 v[176:179], v[72:75], a[144:147], v[176:179]
s_waitcnt lgkmcnt(10)
ds_read_b64_tr_b16 a[224:225], v250 offset:0
ds_read_b64_tr_b16 a[226:227], v250 offset:512
v_mfma_f32_16x16x32_bf16 v[180:183], v[72:75], a[160:163], 0
s_waitcnt lgkmcnt(10)
ds_read_b64_tr_b16 a[228:229], v250 offset:4096
ds_read_b64_tr_b16 a[230:231], v250 offset:4608
v_mfma_f32_16x16x32_bf16 v[180:183], v[76:79], a[164:167], v[180:183]
s_waitcnt lgkmcnt(10)
ds_read_b64_tr_b16 a[232:233], v250 offset:8192
ds_read_b64_tr_b16 a[234:235], v250 offset:8704
v_mfma_f32_16x16x32_bf16 v[180:183], v[80:83], a[168:171], v[180:183]
s_waitcnt lgkmcnt(10)
ds_read_b64_tr_b16 a[236:237], v250 offset:12288
ds_read_b64_tr_b16 a[238:239], v250 offset:12800
v_mfma_f32_16x16x32_bf16 v[180:183], v[84:87], a[172:175], v[180:183]
s_waitcnt lgkmcnt(10)
ds_read_b64_tr_b16 a[240:241], v251 offset:0
ds_read_b64_tr_b16 a[242:243], v251 offset:512
v_mfma_f32_16x16x32_bf16 v[152:155], v[84:87], a[188:191], 0
s_waitcnt lgkmcnt(10)
ds_read_b64_tr_b16 a[244:245], v251 offset:4096
ds_read_b64_tr_b16 a[246:247], v251 offset:4608
v_mfma_f32_16x16x32_bf16 v[152:155], v[80:83], a[184:187], v[152:155]
s_waitcnt lgkmcnt(10)
ds_read_b64_tr_b16 a[248:249], v251 offset:8192
ds_read_b64_tr_b16 a[250:251], v251 offset:8704
v_mfma_f32_16x16x32_bf16 v[152:155], v[76:79], a[180:183], v[152:155]
s_waitcnt lgkmcnt(10)
ds_read_b64_tr_b16 a[252:253], v251 offset:12288
ds_read_b64_tr_b16 a[254:255], v251 offset:12800
v_mfma_f32_16x16x32_bf16 v[152:155], v[72:75], a[176:179], v[152:155]
s_waitcnt lgkmcnt(10)
ds_write_b128 v50, v[88:91] offset:0
ds_write_b128 v50, v[104:107] offset:4096
ds_write_b64 v51, v[156:157] offset:0
ds_write_b128 v50, v[92:95] offset:64
ds_write_b128 v50, v[108:111] offset:4160
ds_write_b64 v51, v[160:161] offset:128
v_cvt_pk_bf16_f32 v164, v164, v165
v_cvt_pk_bf16_f32 v165, v166, v167
v_cvt_pk_bf16_f32 v168, v168, v169
v_cvt_pk_bf16_f32 v169, v170, v171
v_cvt_pk_bf16_f32 v172, v172, v173
v_cvt_pk_bf16_f32 v173, v174, v175
v_cvt_pk_bf16_f32 v176, v176, v177
v_cvt_pk_bf16_f32 v177, v178, v179
v_cvt_pk_bf16_f32 v180, v180, v181
v_cvt_pk_bf16_f32 v181, v182, v183
v_cvt_pk_bf16_f32 v152, v152, v153
v_cvt_pk_bf16_f32 v153, v154, v155
v_mov_b32 v105, 0
v_mov_b32 v107, 0
v_mov_b32 v109, 0
v_mov_b32 v111, 0
v_mov_b32 v133, 0
v_mov_b32 v134, 0
v_mov_b32 v135, 0
v_mov_b32 v149, 0
v_mov_b32 v150, 0
v_mov_b32 v151, 0
v_mov_b32 v248, 1.0
v_mov_b32 v249, 1.0
v_mov_b32 v251, 1.0
ds_write_b64 v51, v[164:165] offset:256
ds_write_b64 v51, v[168:169] offset:384
ds_write_b128 v50, v[96:99] offset:2048
ds_write_b128 v50, v[112:115] offset:6144
ds_write_b64 v51, v[172:173] offset:2048
ds_write_b64 v51, v[176:177] offset:2176
s_waitcnt vmcnt(4)
s_barrier
ds_read_b128 v[200:203], v236 offset:8704
ds_read_b128 v[212:215], v236 offset:8448
ds_read_b128 v[224:227], v236 offset:8960
ds_read_b128 v[228:231], v236 offset:9216
ds_read_b128 v[192:195], v236 offset:13440
ds_read_b128 v[204:207], v236 offset:12928
ds_read_b128 v[208:211], v236 offset:12672
ds_write_b128 v50, v[100:103] offset:2112
ds_write_b128 v50, v[116:119] offset:6208
s_waitcnt lgkmcnt(8)
v_mfma_f32_16x16x32_bf16 v[184:187], a[68:71], v[200:203], 0
s_waitcnt lgkmcnt(6)
ds_write_b64 v51, v[180:181] offset:2304
v_mfma_f32_16x16x32_bf16 v[184:187], a[64:67], v[212:215], v[184:187]
s_waitcnt lgkmcnt(2)
ds_write_b64 v51, v[152:153] offset:2432
v_mfma_f32_16x16x32_bf16 v[184:187], a[72:75], v[224:227], v[184:187]
v_mfma_f32_16x16x32_bf16 v[184:187], a[76:79], v[228:231], v[184:187]
s_nop 2
v_mfma_f32_16x16x32_bf16 v[188:191], a[92:95], v[228:231], 0
s_nop 2
v_mfma_f32_16x16x32_bf16 v[188:191], a[88:91], v[224:227], v[188:191]
v_cvt_pk_bf16_f32 v16, v184, v185
v_cvt_pk_bf16_f32 v17, v186, v187
v_mfma_f32_16x16x32_bf16 v[188:191], a[84:87], v[200:203], v[188:191]
ds_read_b128 v[184:187], v236 offset:13184
v_mfma_f32_16x16x32_bf16 v[188:191], a[80:83], v[212:215], v[188:191]
s_nop 2
v_mfma_f32_16x16x32_bf16 v[196:199], a[96:99], v[212:215], 0
s_nop 2
v_mfma_f32_16x16x32_bf16 v[196:199], a[100:103], v[200:203], v[196:199]
v_cvt_pk_bf16_f32 v18, v188, v189
v_cvt_pk_bf16_f32 v19, v190, v191
v_mfma_f32_16x16x32_bf16 v[196:199], a[104:107], v[224:227], v[196:199]
v_mfma_f32_16x16x32_bf16 v[196:199], a[108:111], v[228:231], v[196:199]
s_nop 2
v_mfma_f32_16x16x32_bf16 v[188:191], a[124:127], v[228:231], 0
s_waitcnt lgkmcnt(0)
s_nop 1
v_mfma_f32_16x16x32_bf16 v[188:191], a[116:119], v[200:203], v[188:191]
v_cvt_pk_bf16_f32 v21, v198, v199
v_cvt_pk_bf16_f32 v20, v196, v197
v_mfma_f32_16x16x32_bf16 v[188:191], a[112:115], v[212:215], v[188:191]
v_mfma_f32_16x16x32_bf16 v[188:191], a[120:123], v[224:227], v[188:191]
s_nop 2
v_mfma_f32_16x16x32_bf16 v[196:199], a[120:123], v[184:187], 0
s_nop 2
v_mfma_f32_16x16x32_bf16 v[196:199], a[124:127], v[192:195], v[196:199]
v_cvt_pk_bf16_f32 v23, v190, v191
v_cvt_pk_bf16_f32 v22, v188, v189
v_mfma_f32_16x16x32_bf16 v[196:199], a[116:119], v[204:207], v[196:199]
v_mfma_f32_16x16x32_bf16 v[196:199], a[112:115], v[208:211], v[196:199]
s_nop 2
v_mfma_f32_16x16x32_bf16 v[188:191], a[96:99], v[208:211], 0
s_nop 2
v_mfma_f32_16x16x32_bf16 v[188:191], a[100:103], v[204:207], v[188:191]
v_cvt_pk_bf16_f32 v30, v196, v197
v_cvt_pk_bf16_f32 v31, v198, v199
v_mfma_f32_16x16x32_bf16 v[188:191], a[104:107], v[184:187], v[188:191]
v_mfma_f32_16x16x32_bf16 v[188:191], a[108:111], v[192:195], v[188:191]
s_nop 2
v_mfma_f32_16x16x32_bf16 v[212:215], a[92:95], v[192:195], 0
s_nop 2
v_mfma_f32_16x16x32_bf16 v[212:215], a[88:91], v[184:187], v[212:215]
v_cvt_pk_bf16_f32 v29, v190, v191
v_cvt_pk_bf16_f32 v28, v188, v189
v_mfma_f32_16x16x32_bf16 v[212:215], a[84:87], v[204:207], v[212:215]
v_mfma_f32_16x16x32_bf16 v[212:215], a[80:83], v[208:211], v[212:215]
s_nop 2
v_mfma_f32_16x16x32_bf16 v[188:191], a[64:67], v[208:211], 0
s_nop 2
v_mfma_f32_16x16x32_bf16 v[188:191], a[72:75], v[184:187], v[188:191]
v_cvt_pk_bf16_f32 v27, v214, v215
v_cvt_pk_bf16_f32 v26, v212, v213
v_mfma_f32_16x16x32_bf16 v[188:191], a[76:79], v[192:195], v[188:191]
s_waitcnt vmcnt(0)
s_barrier
v_mfma_f32_16x16x32_bf16 v[188:191], a[68:71], v[204:207], v[188:191]
s_mov_b32 s48, s50
ds_read_b128 v[196:199], v236 offset:17152
ds_read_b128 v[200:203], v236 offset:16896
ds_read_b128 v[216:219], v236 offset:17408
ds_read_b128 v[220:223], v236 offset:17664
ds_read_u16 v108, v241 offset:256
ds_read_b128 v[204:207], v236 offset:21376
ds_read_b128 v[208:211], v236 offset:21120
ds_read_b128 v[52:55], v240 offset:64
v_cvt_pk_bf16_f32 v24, v188, v189
v_cvt_pk_bf16_f32 v25, v190, v191
s_add_u32 m0, s49, 0
s_add_u32 s50, s50, 13107200
buffer_load_dwordx4 v237, s[16:19], s48 offen nt lds
ds_read_b128 v[192:195], v236 offset:21888
ds_read_b128 v[48:51], v240 offset:0
ds_read_u16 v110, v241 offset:384
v_add_u32 v240, 0x200, v240
s_add_u32 s48, s48, s51
s_add_u32 m0, s49, 2112
ds_read_u16 v106, v241 offset:128
buffer_load_dwordx4 v237, s[16:19], s48 offen nt lds
s_waitcnt lgkmcnt(11)
v_mfma_f32_16x16x32_bf16 v[184:187], a[68:71], v[196:199], 0
s_waitcnt lgkmcnt(9)
ds_read_u16 v104, v241 offset:0
s_add_u32 m0, s49, 4224
v_mfma_f32_16x16x32_bf16 v[184:187], a[64:67], v[200:203], v[184:187]
s_waitcnt lgkmcnt(6)
s_add_u32 s48, s48, s51
buffer_load_dwordx4 v237, s[16:19], s48 offen nt lds
v_mfma_f32_16x16x32_bf16 v[184:187], a[72:75], v[216:219], v[184:187]
s_add_u32 m0, s49, 6336
s_add_u32 s48, s48, s51
buffer_load_dwordx4 v237, s[16:19], s48 offen nt lds
v_mfma_f32_16x16x32_bf16 v[184:187], a[76:79], v[220:223], v[184:187]
s_add_u32 m0, s49, 8448
s_add_u32 s48, s48, s51
buffer_load_dwordx4 v237, s[16:19], s48 offen nt lds
v_mfma_f32_16x16x32_bf16 v[188:191], a[92:95], v[220:223], 0
s_add_u32 m0, s49, 10560
s_mov_b32 s47, s46
s_add_u32 s48, s48, s51
v_mfma_f32_16x16x32_bf16 v[188:191], a[88:91], v[216:219], v[188:191]
s_bfe_i32 s57, s3, 0x10000
buffer_load_dwordx4 v237, s[16:19], s48 offen nt lds
v_cvt_pk_bf16_f32 v32, v184, v185
v_mfma_f32_16x16x32_bf16 v[188:191], a[84:87], v[196:199], v[188:191]
s_and_b32 s54, s57, s5
v_cvt_pk_bf16_f32 v33, v186, v187
s_sub_u32 s45, s45, 1
v_mfma_f32_16x16x32_bf16 v[188:191], a[80:83], v[200:203], v[188:191]
s_sub_u32 s50, s50, s54
s_add_u32 s52, s46, 20480
s_lshr_b32 s3, s3, 1
v_mfma_f32_16x16x32_bf16 v[184:187], a[96:99], v[200:203], 0
s_waitcnt lgkmcnt(0)
s_nop 1
v_mfma_f32_16x16x32_bf16 v[184:187], a[100:103], v[196:199], v[184:187]
v_cvt_pk_bf16_f32 v35, v190, v191
v_cvt_pk_bf16_f32 v34, v188, v189
v_mfma_f32_16x16x32_bf16 v[184:187], a[104:107], v[216:219], v[184:187]
v_mfma_f32_16x16x32_bf16 v[184:187], a[108:111], v[220:223], v[184:187]
s_nop 2
v_mfma_f32_16x16x32_bf16 v[188:191], a[124:127], v[220:223], 0
s_nop 2
v_mfma_f32_16x16x32_bf16 v[188:191], a[120:123], v[216:219], v[188:191]
v_cvt_pk_bf16_f32 v37, v186, v187
v_cvt_pk_bf16_f32 v36, v184, v185
v_mfma_f32_16x16x32_bf16 v[188:191], a[116:119], v[196:199], v[188:191]
ds_read_b128 v[196:199], v236 offset:21632
v_mfma_f32_16x16x32_bf16 v[188:191], a[112:115], v[200:203], v[188:191]
s_nop 7
v_cvt_pk_bf16_f32 v39, v190, v191
v_cvt_pk_bf16_f32 v38, v188, v189
s_nop 7
s_waitcnt lgkmcnt(0)
s_branch L_entrys
.p2align 6
L_loops:
s_waitcnt vmcnt(8)
s_barrier
v_mfma_f32_16x16x32_bf16 v[176:179], a[224:227], v[220:223], 0
s_add_u32 s52, s47, 8192
v_exp_f32 v187, v187
v_mfma_f32_16x16x32_bf16 v[176:179], a[228:231], v[224:227], v[176:179]
s_add_u32 s53, s47, 12288
v_add_f32 v248, v184, v185
v_add_f32 v248, v248, v186
v_mfma_f32_16x16x32_bf16 v[176:179], a[232:235], v[212:215], v[176:179]
s_mov_b32 s47, s46
v_add_f32 v248, v248, v187
v_cvt_pk_bf16_f32 v120, v184, v185
v_mfma_f32_16x16x32_bf16 v[176:179], a[236:239], v[216:219], v[176:179]
s_bfe_i32 s57, s3, 0x10000
v_cvt_pk_bf16_f32 v121, v186, v187
v_sub_f32 v193, v193, v254
v_mfma_f32_16x16x32_bf16 v[180:183], a[252:255], v[216:219], 0
s_and_b32 s54, s57, s5
v_exp_f32 v188, v188
v_mfma_f32_16x16x32_bf16 v[180:183], a[248:251], v[212:215], v[180:183]
s_sub_u32 s45, s45, 1
v_exp_f32 v190, v190
v_mfma_f32_16x16x32_bf16 v[180:183], a[244:247], v[224:227], v[180:183]
s_lshr_b32 s3, s3, 1
v_sub_f32 v194, v194, v254
v_add_f32 v248, v248, v188
v_mfma_f32_16x16x32_bf16 v[180:183], a[240:243], v[220:223], v[180:183]
v_exp_f32 v189, v189
v_mfma_f32_16x16x32_bf16 v[212:215], v[0:3], v[112:115], 0
v_add_f32 v248, v248, v189
v_sub_f32 v191, v191, v254
v_mfma_f32_16x16x32_bf16 v[212:215], v[4:7], v[116:119], v[212:215]
v_exp_f32 v191, v191
v_mfma_f32_16x16x32_bf16 v[216:219], v[12:15], v[116:119], 0
v_sub_f32 v195, v195, v254
v_sub_f32 v192, v192, v254
v_mfma_f32_16x16x32_bf16 v[216:219], v[8:11], v[112:115], v[216:219]
v_exp_f32 v192, v192
v_mfma_f32_16x16x32_bf16 v[220:223], v[16:19], v[112:115], 0
v_exp_f32 v194, v194
v_mfma_f32_16x16x32_bf16 v[220:223], v[20:23], v[116:119], v[220:223]
v_exp_f32 v193, v193
v_mfma_f32_16x16x32_bf16 v[224:227], v[28:31], v[116:119], 0
v_add_f32 v248, v248, v190
v_add_f32 v248, v248, v191
v_mfma_f32_16x16x32_bf16 v[224:227], v[24:27], v[112:115], v[224:227]
v_exp_f32 v195, v195
v_mfma_f32_16x16x32_bf16 v[228:231], v[32:35], v[112:115], 0
v_add_f32 v248, v248, v192
v_add_f32 v248, v248, v193
v_mfma_f32_16x16x32_bf16 v[228:231], v[36:39], v[116:119], v[228:231]
v_add_f32 v248, v248, v194
v_add_f32 v248, v248, v195
v_mfma_f32_16x16x32_bf16 v[232:235], v[44:47], v[116:119], 0
v_cvt_pk_bf16_f32 v123, v190, v191
v_cvt_pk_bf16_f32 v122, v188, v189
v_mfma_f32_16x16x32_bf16 v[232:235], v[40:43], v[112:115], v[232:235]
s_mov_b32 s48, s50
ds_read_b128 v[188:191], v236 offset:0
v_cvt_pk_bf16_f32 v125, v194, v195
v_mfma_f32_16x16x32_bf16 v[184:187], v[48:51], v[112:115], 0
s_add_u32 m0, s49, 0
ds_read_b128 v[48:51], v240 offset:0
v_cvt_pk_bf16_f32 v124, v192, v193
v_mfma_f32_16x16x32_bf16 v[184:187], v[52:55], v[116:119], v[184:187]
s_add_u32 s50, s50, 13107200
buffer_load_dwordx4 v237, s[16:19], s48 offen nt lds
v_sub_f32 v196, v196, v254
v_sub_f32 v197, v197, v254
v_sub_f32 v199, v199, v254
v_sub_f32 v198, v198, v254
v_exp_f32 v196, v196
v_exp_f32 v197, v197
v_add_f32 v248, v248, v196
v_add_f32 v248, v248, v197
v_exp_f32 v198, v198
s_waitcnt lgkmcnt(1)
v_mfma_f32_16x16x32_bf16 v[192:195], a[64:67], v[188:191], 0
s_sub_u32 s50, s50, s54
ds_read_b128 v[52:55], v240 offset:64
v_exp_f32 v199, v199
v_add_f32 v248, v248, v198
v_add_f32 v248, v248, v199
v_cvt_pk_bf16_f32 v126, v196, v197
v_cvt_pk_bf16_f32 v127, v198, v199
ds_read_b128 v[196:199], v236 offset:256
v_sub_f32 v200, v200, v254
v_sub_f32 v203, v203, v254
v_sub_f32 v201, v201, v254
v_exp_f32 v201, v201
v_sub_f32 v202, v202, v254
v_exp_f32 v202, v202
v_exp_f32 v200, v200
v_exp_f32 v203, v203
v_add_f32 v248, v248, v200
v_add_f32 v248, v248, v201
v_add_f32 v248, v248, v202
v_add_f32 v248, v248, v203
v_cvt_pk_bf16_f32 v128, v200, v201
v_cvt_pk_bf16_f32 v129, v202, v203
v_sub_f32 v204, v204, v254
v_sub_f32 v205, v205, v254
s_waitcnt lgkmcnt(0)
v_mfma_f32_16x16x32_bf16 v[192:195], a[68:71], v[196:199], v[192:195]
ds_read_b128 v[200:203], v236 offset:512
v_exp_f32 v204, v204
v_sub_f32 v206, v206, v254
v_add_f32 v248, v248, v204
v_exp_f32 v206, v206
v_sub_f32 v207, v207, v254
v_exp_f32 v205, v205
v_exp_f32 v207, v207
v_add_f32 v248, v248, v205
v_cvt_pk_bf16_f32 v130, v204, v205
v_add_f32 v248, v248, v206
v_add_f32 v248, v248, v207
v_cvt_pk_bf16_f32 v131, v206, v207
v_sub_f32 v208, v208, v254
v_exp_f32 v208, v208
v_max3_f32 v254, v212, v213, v214
s_waitcnt lgkmcnt(0)
v_mfma_f32_16x16x32_bf16 v[192:195], a[72:75], v[200:203], v[192:195]
ds_read_b128 v[204:207], v236 offset:768
v_add_f32 v248, v248, v208
v_cvt_pk_bf16_f32 v132, v208, 0
v_max3_f32 v254, v254, v215, v216
v_max3_f32 v254, v254, v217, v218
v_max3_f32 v254, v254, v219, v220
v_max3_f32 v254, v254, v221, v222
v_max3_f32 v254, v254, v223, v224
v_max3_f32 v254, v254, v225, v226
v_max3_f32 v254, v254, v227, v228
v_max3_f32 v254, v254, v229, v230
v_max3_f32 v254, v254, v231, v232
v_max3_f32 v254, v254, v233, v234
v_max3_f32 v254, v254, v235, v184
v_add_u32 v240, 0x200, v240
ds_swizzle_b32 v250, v248 offset:0x401F
ds_swizzle_b32 v255, v254 offset:0x401F
s_waitcnt lgkmcnt(2)
v_mfma_f32_16x16x32_bf16 v[192:195], a[76:79], v[204:207], v[192:195]
s_nop 2
v_mfma_f32_16x16x32_bf16 v[208:211], a[92:95], v[204:207], 0
s_nop 2
v_mfma_f32_16x16x32_bf16 v[208:211], a[88:91], v[200:203], v[208:211]
v_cvt_pk_bf16_f32 v0, v192, v193
v_cvt_pk_bf16_f32 v1, v194, v195
v_mfma_f32_16x16x32_bf16 v[208:211], a[84:87], v[196:199], v[208:211]
v_mfma_f32_16x16x32_bf16 v[208:211], a[80:83], v[188:191], v[208:211]
s_waitcnt lgkmcnt(0)
v_add_f32 v248, v248, v250
v_max_f32 v254, v254, v255
v_mfma_f32_16x16x32_bf16 v[192:195], a[96:99], v[188:191], 0
ds_bpermute_b32 v250, v247, v248
v_mfma_f32_16x16x32_bf16 v[192:195], a[100:103], v[196:199], v[192:195]
ds_bpermute_b32 v255, v247, v254
v_mfma_f32_16x16x32_bf16 v[192:195], a[104:107], v[200:203], v[192:195]
v_cvt_pk_bf16_f32 v2, v208, v209
v_cvt_pk_bf16_f32 v3, v210, v211
v_mfma_f32_16x16x32_bf16 v[192:195], a[108:111], v[204:207], v[192:195]
s_nop 2
v_mfma_f32_16x16x32_bf16 v[208:211], a[124:127], v[204:207], 0
s_nop 2
v_mfma_f32_16x16x32_bf16 v[208:211], a[120:123], v[200:203], v[208:211]
v_cvt_pk_bf16_f32 v5, v194, v195
v_cvt_pk_bf16_f32 v4, v192, v193
v_mfma_f32_16x16x32_bf16 v[208:211], a[116:119], v[196:199], v[208:211]
s_waitcnt lgkmcnt(1)
v_add_f32 v248, v248, v250
v_mfma_f32_16x16x32_bf16 v[208:211], a[112:115], v[188:191], v[208:211]
s_waitcnt lgkmcnt(0)
v_rcp_f32 v251, v248
v_mfma_f32_16x16x32_bf16 v[188:191], v[56:59], v[120:123], 0
v_max_f32 v254, v254, v255
v_sub_f32 v214, v214, v254
v_mfma_f32_16x16x32_bf16 v[188:191], v[104:107], v[132:135], v[188:191]
s_add_u32 s48, s48, s51
v_sub_f32 v215, v215, v254
v_cvt_pk_bf16_f32 v6, v208, v209
v_mfma_f32_16x16x32_bf16 v[188:191], v[72:75], v[124:127], v[188:191]
s_add_u32 m0, s49, 2112
v_cvt_pk_bf16_f32 v7, v210, v211
v_sub_f32 v212, v212, v254
v_mfma_f32_16x16x32_bf16 v[188:191], v[88:91], v[128:131], v[188:191]
buffer_load_dwordx4 v237, s[16:19], s48 offen nt lds
v_sub_f32 v213, v213, v254
v_mfma_f32_16x16x32_bf16 v[196:199], v[92:95], v[128:131], 0
v_exp_f32 v212, v212
v_mfma_f32_16x16x32_bf16 v[196:199], v[76:79], v[124:127], v[196:199]
v_exp_f32 v214, v214
v_mfma_f32_16x16x32_bf16 v[196:199], v[106:109], v[132:135], v[196:199]
v_exp_f32 v213, v213
v_mfma_f32_16x16x32_bf16 v[196:199], v[60:63], v[120:123], v[196:199]
ds_read_b128 v[204:207], v236 offset:4480
v_sub_f32 v216, v216, v254
v_mfma_f32_16x16x32_bf16 v[200:203], v[64:67], v[120:123], 0
ds_read_b128 v[192:195], v236 offset:4224
v_sub_f32 v217, v217, v254
v_mfma_f32_16x16x32_bf16 v[200:203], v[108:111], v[132:135], v[200:203]
v_exp_f32 v215, v215
v_mfma_f32_16x16x32_bf16 v[200:203], v[80:83], v[124:127], v[200:203]
v_exp_f32 v217, v217
v_mfma_f32_16x16x32_bf16 v[200:203], v[96:99], v[128:131], v[200:203]
v_sub_f32 v218, v218, v254
v_add_f32 v249, v212, v213
v_mfma_f32_16x16x32_bf16 v[208:211], v[100:103], v[128:131], 0
v_add_f32 v249, v249, v214
v_add_f32 v249, v249, v215
v_mfma_f32_16x16x32_bf16 v[208:211], v[84:87], v[124:127], v[208:211]
s_waitcnt lgkmcnt(1)
v_exp_f32 v216, v216
v_mfma_f32_16x16x32_bf16 v[208:211], v[110:113], v[132:135], v[208:211]
s_waitcnt lgkmcnt(0)
v_sub_f32 v219, v219, v254
v_sub_f32 v220, v220, v254
v_mfma_f32_16x16x32_bf16 v[208:211], v[68:71], v[120:123], v[208:211]
v_exp_f32 v218, v218
v_sub_f32 v223, v223, v254
v_add_f32 v249, v249, v216
v_add_f32 v249, v249, v217
v_exp_f32 v219, v219
v_add_f32 v249, v249, v218
v_add_f32 v249, v249, v219
v_exp_f32 v220, v220
v_sub_f32 v224, v224, v254
v_exp_f32 v223, v223
v_sub_f32 v221, v221, v254
v_exp_f32 v224, v224
v_exp_f32 v221, v221
v_sub_f32 v222, v222, v254
v_sub_f32 v225, v225, v254
v_add_f32 v249, v249, v220
v_add_f32 v249, v249, v221
v_exp_f32 v222, v222
v_exp_f32 v225, v225
v_add_f32 v249, v249, v222
v_add_f32 v249, v249, v223
v_add_f32 v249, v249, v224
v_sub_f32 v226, v226, v254
v_add_f32 v249, v249, v225
v_exp_f32 v226, v226
v_sub_f32 v227, v227, v254
v_exp_f32 v227, v227
v_sub_f32 v228, v228, v254
v_exp_f32 v228, v228
v_add_f32 v249, v249, v226
v_sub_f32 v232, v232, v254
v_sub_f32 v229, v229, v254
v_sub_f32 v230, v230, v254
v_exp_f32 v230, v230
v_exp_f32 v229, v229
v_add_f32 v249, v249, v227
v_add_f32 v249, v249, v228
v_add_f32 v249, v249, v229
v_exp_f32 v232, v232
v_sub_f32 v233, v233, v254
v_exp_f32 v233, v233
v_sub_f32 v231, v231, v254
v_exp_f32 v231, v231
v_sub_f32 v234, v234, v254
v_sub_f32 v235, v235, v254
v_add_f32 v249, v249, v230
v_add_f32 v249, v249, v231
v_add_f32 v249, v249, v232
v_exp_f32 v234, v234
v_exp_f32 v235, v235
v_sub_f32 v184, v184, v254
v_exp_f32 v184, v184
v_add_f32 v249, v249, v233
v_cvt_pk_bf16_f32 v148, v184, 0
v_add_f32 v249, v249, v234
v_add_f32 v249, v249, v235
v_add_f32 v249, v249, v184
v_fmac_f32 v161, v201, v251
v_fmac_f32 v163, v203, v251
v_fmac_f32 v160, v200, v251
v_fmac_f32 v162, v202, v251
ds_read_b128 v[184:187], v236 offset:4992
v_cvt_pk_bf16_f32 v138, v216, v217
v_cvt_pk_bf16_f32 v139, v218, v219
v_fmac_f32 v167, v211, v251
v_fmac_f32 v165, v209, v251
v_fmac_f32 v166, v210, v251
v_fmac_f32 v164, v208, v251
v_cvt_pk_bf16_f32 v140, v220, v221
v_cvt_pk_bf16_f32 v141, v222, v223
v_fmac_f32 v155, v191, v251
v_fmac_f32 v154, v190, v251
v_fmac_f32 v152, v188, v251
v_fmac_f32 v153, v189, v251
v_cvt_pk_bf16_f32 v137, v214, v215
v_cvt_pk_bf16_f32 v136, v212, v213
v_cvt_pk_bf16_f32 v143, v226, v227
v_cvt_pk_bf16_f32 v142, v224, v225
v_cvt_pk_bf16_f32 v145, v230, v231
v_cvt_pk_bf16_f32 v144, v228, v229
v_fmac_f32 v156, v196, v251
v_fmac_f32 v157, v197, v251
s_waitcnt lgkmcnt(0)
v_mfma_f32_16x16x32_bf16 v[200:203], a[124:127], v[184:187], 0
ds_read_b128 v[216:219], v236 offset:4736
v_fmac_f32 v158, v198, v251
v_fmac_f32 v159, v199, v251
v_cvt_pk_bf16_f32 v147, v234, v235
v_cvt_pk_bf16_f32 v146, v232, v233
v_cvt_pk_bf16_f32 v160, v160, v161
v_cvt_pk_bf16_f32 v161, v162, v163
v_cvt_pk_bf16_f32 v163, v166, v167
v_cvt_pk_bf16_f32 v162, v164, v165
v_cvt_pk_bf16_f32 v152, v152, v153
v_cvt_pk_bf16_f32 v153, v154, v155
v_pk_max_i16 v160, v160, 0
v_pk_max_i16 v162, v162, 0
v_pk_max_i16 v153, v153, 0
v_pk_max_i16 v161, v161, 0
v_pk_max_i16 v163, v163, 0
v_cvt_pk_bf16_f32 v155, v158, v159
v_pk_max_i16 v155, v155, 0
v_pk_max_i16 v152, v152, 0
v_cvt_pk_bf16_f32 v154, v156, v157
v_pk_max_i16 v154, v154, 0
s_waitcnt lgkmcnt(0)
v_mfma_f32_16x16x32_bf16 v[200:203], a[120:123], v[216:219], v[200:203]
ds_swizzle_b32 v250, v249 offset:0x401F
buffer_store_dwordx4 v[152:155], v239, s[20:23], s52 offen offset:0 nt
buffer_store_dwordx4 v[160:163], v239, s[20:23], s52 offen offset:64 nt
s_add_u32 s52, s46, 20480
v_mfma_f32_16x16x32_bf16 v[200:203], a[116:119], v[204:207], v[200:203]
v_mfma_f32_16x16x32_bf16 v[200:203], a[112:115], v[192:195], v[200:203]
s_nop 2
v_mfma_f32_16x16x32_bf16 v[208:211], a[96:99], v[192:195], 0
s_waitcnt lgkmcnt(0)
v_add_f32 v249, v249, v250
v_mfma_f32_16x16x32_bf16 v[208:211], a[100:103], v[204:207], v[208:211]
s_add_u32 m0, s49, 4224
ds_bpermute_b32 v250, v247, v249
v_mfma_f32_16x16x32_bf16 v[208:211], a[104:107], v[216:219], v[208:211]
s_add_u32 s48, s48, s51
buffer_load_dwordx4 v237, s[16:19], s48 offen nt lds
v_cvt_pk_bf16_f32 v14, v200, v201
v_mfma_f32_16x16x32_bf16 v[208:211], a[108:111], v[184:187], v[208:211]
ds_read_b128 v[212:215], v236 offset:8448
v_cvt_pk_bf16_f32 v15, v202, v203
v_mfma_f32_16x16x32_bf16 v[220:223], a[92:95], v[184:187], 0
ds_read_b128 v[200:203], v236 offset:8704
ds_read_b128 v[224:227], v236 offset:8960
v_mfma_f32_16x16x32_bf16 v[220:223], a[88:91], v[216:219], v[220:223]
ds_read_b128 v[228:231], v236 offset:9216
v_mfma_f32_16x16x32_bf16 v[220:223], a[84:87], v[204:207], v[220:223]
v_cvt_pk_bf16_f32 v13, v210, v211
v_cvt_pk_bf16_f32 v12, v208, v209
v_mfma_f32_16x16x32_bf16 v[220:223], a[80:83], v[192:195], v[220:223]
s_waitcnt lgkmcnt(4)
v_add_f32 v249, v249, v250
s_nop 0
v_mfma_f32_16x16x32_bf16 v[188:191], a[64:67], v[192:195], 0
v_rcp_f32 v252, v249
v_mfma_f32_16x16x32_bf16 v[188:191], a[72:75], v[216:219], v[188:191]
s_waitcnt lgkmcnt(3)
s_nop 0
v_cvt_pk_bf16_f32 v10, v220, v221
v_mfma_f32_16x16x32_bf16 v[188:191], a[76:79], v[184:187], v[188:191]
s_waitcnt lgkmcnt(1)
v_cvt_pk_bf16_f32 v11, v222, v223
v_mfma_f32_16x16x32_bf16 v[188:191], a[68:71], v[204:207], v[188:191]
s_waitcnt lgkmcnt(0)
s_nop 1
v_mfma_f32_16x16x32_bf16 v[184:187], a[68:71], v[200:203], 0
s_nop 2
v_mfma_f32_16x16x32_bf16 v[184:187], a[64:67], v[212:215], v[184:187]
v_cvt_pk_bf16_f32 v9, v190, v191
v_cvt_pk_bf16_f32 v8, v188, v189
v_mfma_f32_16x16x32_bf16 v[184:187], a[72:75], v[224:227], v[184:187]
v_mfma_f32_16x16x32_bf16 v[184:187], a[76:79], v[228:231], v[184:187]
s_nop 2
v_mfma_f32_16x16x32_bf16 v[188:191], a[92:95], v[228:231], 0
s_nop 2
v_mfma_f32_16x16x32_bf16 v[188:191], a[88:91], v[224:227], v[188:191]
v_cvt_pk_bf16_f32 v16, v184, v185
v_cvt_pk_bf16_f32 v17, v186, v187
v_mfma_f32_16x16x32_bf16 v[188:191], a[84:87], v[200:203], v[188:191]
v_mfma_f32_16x16x32_bf16 v[188:191], a[80:83], v[212:215], v[188:191]
ds_read_b128 v[184:187], v236 offset:13184
ds_read_b128 v[192:195], v236 offset:13440
v_mfma_f32_16x16x32_bf16 v[196:199], a[96:99], v[212:215], 0
ds_read_b128 v[204:207], v236 offset:12928
ds_read_b128 v[208:211], v236 offset:12672
v_mfma_f32_16x16x32_bf16 v[196:199], a[100:103], v[200:203], v[196:199]
s_add_u32 m0, s49, 6336
s_add_u32 s48, s48, s51
v_cvt_pk_bf16_f32 v18, v188, v189
v_mfma_f32_16x16x32_bf16 v[196:199], a[104:107], v[224:227], v[196:199]
buffer_load_dwordx4 v237, s[16:19], s48 offen nt lds
v_cvt_pk_bf16_f32 v19, v190, v191
v_mfma_f32_16x16x32_bf16 v[196:199], a[108:111], v[228:231], v[196:199]
s_nop 2
v_mfma_f32_16x16x32_bf16 v[188:191], a[124:127], v[228:231], 0
s_nop 2
v_mfma_f32_16x16x32_bf16 v[188:191], a[116:119], v[200:203], v[188:191]
s_waitcnt lgkmcnt(2)
v_cvt_pk_bf16_f32 v21, v198, v199
v_cvt_pk_bf16_f32 v20, v196, v197
v_mfma_f32_16x16x32_bf16 v[188:191], a[112:115], v[212:215], v[188:191]
s_waitcnt lgkmcnt(0)
v_mfma_f32_16x16x32_bf16 v[188:191], a[120:123], v[224:227], v[188:191]
s_nop 2
v_mfma_f32_16x16x32_bf16 v[196:199], a[120:123], v[184:187], 0
s_nop 2
v_mfma_f32_16x16x32_bf16 v[196:199], a[124:127], v[192:195], v[196:199]
v_cvt_pk_bf16_f32 v23, v190, v191
v_cvt_pk_bf16_f32 v22, v188, v189
v_mfma_f32_16x16x32_bf16 v[196:199], a[116:119], v[204:207], v[196:199]
v_mfma_f32_16x16x32_bf16 v[196:199], a[112:115], v[208:211], v[196:199]
s_nop 2
v_mfma_f32_16x16x32_bf16 v[188:191], a[96:99], v[208:211], 0
s_nop 2
v_mfma_f32_16x16x32_bf16 v[188:191], a[100:103], v[204:207], v[188:191]
v_cvt_pk_bf16_f32 v30, v196, v197
v_cvt_pk_bf16_f32 v31, v198, v199
v_mfma_f32_16x16x32_bf16 v[188:191], a[104:107], v[184:187], v[188:191]
v_mfma_f32_16x16x32_bf16 v[188:191], a[108:111], v[192:195], v[188:191]
ds_read_b128 v[196:199], v236 offset:17152
ds_read_b128 v[200:203], v236 offset:16896
v_mfma_f32_16x16x32_bf16 v[212:215], a[92:95], v[192:195], 0
ds_read_b128 v[216:219], v236 offset:17408
ds_read_b128 v[220:223], v236 offset:17664
v_mfma_f32_16x16x32_bf16 v[212:215], a[88:91], v[184:187], v[212:215]
s_nop 1
v_cvt_pk_bf16_f32 v29, v190, v191
v_mfma_f32_16x16x32_bf16 v[212:215], a[84:87], v[204:207], v[212:215]
v_cvt_pk_bf16_f32 v28, v188, v189
v_mfma_f32_16x16x32_bf16 v[212:215], a[80:83], v[208:211], v[212:215]
s_nop 2
v_mfma_f32_16x16x32_bf16 v[188:191], a[64:67], v[208:211], 0
s_nop 2
v_mfma_f32_16x16x32_bf16 v[188:191], a[72:75], v[184:187], v[188:191]
s_add_u32 m0, s49, 8448
v_cvt_pk_bf16_f32 v27, v214, v215
v_cvt_pk_bf16_f32 v26, v212, v213
v_mfma_f32_16x16x32_bf16 v[188:191], a[76:79], v[192:195], v[188:191]
s_add_u32 s48, s48, s51
buffer_load_dwordx4 v237, s[16:19], s48 offen nt lds
v_mfma_f32_16x16x32_bf16 v[188:191], a[68:71], v[204:207], v[188:191]
s_waitcnt lgkmcnt(0)
s_nop 1
v_mfma_f32_16x16x32_bf16 v[184:187], a[68:71], v[196:199], 0
s_nop 2
v_mfma_f32_16x16x32_bf16 v[184:187], a[64:67], v[200:203], v[184:187]
v_cvt_pk_bf16_f32 v24, v188, v189
v_cvt_pk_bf16_f32 v25, v190, v191
v_mfma_f32_16x16x32_bf16 v[184:187], a[72:75], v[216:219], v[184:187]
v_mfma_f32_16x16x32_bf16 v[184:187], a[76:79], v[220:223], v[184:187]
s_nop 2
v_mfma_f32_16x16x32_bf16 v[188:191], a[92:95], v[220:223], 0
s_nop 2
v_mfma_f32_16x16x32_bf16 v[188:191], a[88:91], v[216:219], v[188:191]
v_cvt_pk_bf16_f32 v32, v184, v185
v_cvt_pk_bf16_f32 v33, v186, v187
v_mfma_f32_16x16x32_bf16 v[188:191], a[84:87], v[196:199], v[188:191]
v_mfma_f32_16x16x32_bf16 v[188:191], a[80:83], v[200:203], v[188:191]
s_nop 2
v_mfma_f32_16x16x32_bf16 v[184:187], a[96:99], v[200:203], 0
s_nop 2
v_mfma_f32_16x16x32_bf16 v[184:187], a[100:103], v[196:199], v[184:187]
v_cvt_pk_bf16_f32 v35, v190, v191
v_cvt_pk_bf16_f32 v34, v188, v189
v_mfma_f32_16x16x32_bf16 v[184:187], a[104:107], v[216:219], v[184:187]
v_mfma_f32_16x16x32_bf16 v[184:187], a[108:111], v[220:223], v[184:187]
s_nop 2
v_mfma_f32_16x16x32_bf16 v[188:191], a[124:127], v[220:223], 0
s_nop 2
v_mfma_f32_16x16x32_bf16 v[188:191], a[120:123], v[216:219], v[188:191]
v_cvt_pk_bf16_f32 v37, v186, v187
v_cvt_pk_bf16_f32 v36, v184, v185
v_mfma_f32_16x16x32_bf16 v[188:191], a[116:119], v[196:199], v[188:191]
v_mfma_f32_16x16x32_bf16 v[188:191], a[112:115], v[200:203], v[188:191]
s_nop 2
v_mfma_f32_16x16x32_bf16 v[184:187], v[56:59], v[136:139], 0
s_nop 2
v_mfma_f32_16x16x32_bf16 v[184:187], v[104:107], v[148:151], v[184:187]
s_add_u32 m0, s49, 10560
ds_read_u16 v104, v241 offset:0
v_cvt_pk_bf16_f32 v39, v190, v191
v_mfma_f32_16x16x32_bf16 v[184:187], v[72:75], v[140:143], v[184:187]
s_add_u32 s48, s48, s51
buffer_load_dwordx4 v237, s[16:19], s48 offen nt lds
v_cvt_pk_bf16_f32 v38, v188, v189
v_mfma_f32_16x16x32_bf16 v[184:187], v[88:91], v[144:147], v[184:187]
s_nop 2
v_mfma_f32_16x16x32_bf16 v[188:191], v[92:95], v[144:147], 0
s_nop 2
v_mfma_f32_16x16x32_bf16 v[188:191], v[76:79], v[140:143], v[188:191]
v_fmac_f32 v170, v186, v252
v_fmac_f32 v168, v184, v252
v_mfma_f32_16x16x32_bf16 v[188:191], v[106:109], v[148:151], v[188:191]
ds_read_u16 v106, v241 offset:128
v_fmac_f32 v171, v187, v252
v_mfma_f32_16x16x32_bf16 v[188:191], v[60:63], v[136:139], v[188:191]
s_waitcnt lgkmcnt(1)
ds_read_b128 v[192:195], v236 offset:21888
v_fmac_f32 v169, v185, v252
v_mfma_f32_16x16x32_bf16 v[200:203], v[64:67], v[136:139], 0
ds_read_b128 v[196:199], v236 offset:21632
ds_read_b128 v[204:207], v236 offset:21376
v_mfma_f32_16x16x32_bf16 v[200:203], v[108:111], v[148:151], v[200:203]
ds_read_b128 v[208:211], v236 offset:21120
v_fmac_f32 v174, v190, v252
v_mfma_f32_16x16x32_bf16 v[200:203], v[80:83], v[140:143], v[200:203]
ds_read_u16 v108, v241 offset:256
v_fmac_f32 v175, v191, v252
v_mfma_f32_16x16x32_bf16 v[200:203], v[96:99], v[144:147], v[200:203]
v_fmac_f32 v172, v188, v252
v_fmac_f32 v173, v189, v252
v_mfma_f32_16x16x32_bf16 v[184:187], v[100:103], v[144:147], 0
s_waitcnt lgkmcnt(5)
v_cvt_pk_bf16_f32 v168, v168, v169
v_cvt_pk_bf16_f32 v169, v170, v171
v_mfma_f32_16x16x32_bf16 v[184:187], v[84:87], v[140:143], v[184:187]
s_waitcnt lgkmcnt(4)
v_fmac_f32 v178, v202, v252
v_fmac_f32 v176, v200, v252
v_mfma_f32_16x16x32_bf16 v[184:187], v[110:113], v[148:151], v[184:187]
s_waitcnt lgkmcnt(2)
ds_read_u16 v110, v241 offset:384
v_fmac_f32 v177, v201, v252
v_mfma_f32_16x16x32_bf16 v[184:187], v[68:71], v[136:139], v[184:187]
L_entrys:
s_waitcnt lgkmcnt(2)
v_fmac_f32 v179, v203, v252
v_cvt_pk_bf16_f32 v176, v176, v177
v_mfma_f32_16x16x32_bf16 v[188:191], a[124:127], v[192:195], 0
s_waitcnt lgkmcnt(1)
v_cvt_pk_bf16_f32 v177, v178, v179
v_cvt_pk_bf16_f32 v171, v174, v175
v_mfma_f32_16x16x32_bf16 v[188:191], a[120:123], v[196:199], v[188:191]
v_fmac_f32 v180, v184, v252
v_fmac_f32 v181, v185, v252
v_mfma_f32_16x16x32_bf16 v[188:191], a[116:119], v[204:207], v[188:191]
v_fmac_f32 v183, v187, v252
v_fmac_f32 v182, v186, v252
v_mfma_f32_16x16x32_bf16 v[188:191], a[112:115], v[208:211], v[188:191]
v_cvt_pk_bf16_f32 v178, v180, v181
v_cvt_pk_bf16_f32 v170, v172, v173
v_mfma_f32_16x16x32_bf16 v[184:187], a[96:99], v[208:211], 0
s_waitcnt lgkmcnt(0)
v_cvt_pk_bf16_f32 v179, v182, v183
v_pk_max_i16 v168, v168, 0
v_mfma_f32_16x16x32_bf16 v[184:187], a[100:103], v[204:207], v[184:187]
s_add_u32 s48, s48, s51
v_cvt_pk_bf16_f32 v46, v188, v189
v_cvt_pk_bf16_f32 v47, v190, v191
v_mfma_f32_16x16x32_bf16 v[184:187], a[104:107], v[196:199], v[184:187]
s_add_u32 m0, s49, 12672
v_pk_max_i16 v176, v176, 0
v_pk_max_i16 v170, v170, 0
v_mfma_f32_16x16x32_bf16 v[184:187], a[108:111], v[192:195], v[184:187]
buffer_load_dwordx4 v237, s[16:19], s48 offen nt lds
v_pk_max_i16 v179, v179, 0
v_mfma_f32_16x16x32_bf16 v[188:191], a[92:95], v[192:195], 0
v_pk_max_i16 v178, v178, 0
v_pk_max_i16 v169, v169, 0
v_mfma_f32_16x16x32_bf16 v[188:191], a[88:91], v[196:199], v[188:191]
v_pk_max_i16 v177, v177, 0
v_pk_max_i16 v171, v171, 0
v_mfma_f32_16x16x32_bf16 v[188:191], a[84:87], v[204:207], v[188:191]
buffer_store_dwordx4 v[168:171], v239, s[20:23], s53 offen offset:0 nt
buffer_store_dwordx4 v[176:179], v239, s[20:23], s53 offen offset:64 nt
v_cvt_pk_bf16_f32 v44, v184, v185
v_cvt_pk_bf16_f32 v45, v186, v187
v_add_u32 v241, 0x200, v241
s_add_u32 s53, s46, 0
v_mfma_f32_16x16x32_bf16 v[188:191], a[80:83], v[208:211], v[188:191]
s_nop 2
v_mfma_f32_16x16x32_bf16 v[184:187], a[64:67], v[208:211], 0
s_nop 2
v_mfma_f32_16x16x32_bf16 v[184:187], a[72:75], v[196:199], v[184:187]
v_cvt_pk_bf16_f32 v42, v188, v189
v_cvt_pk_bf16_f32 v43, v190, v191
v_mfma_f32_16x16x32_bf16 v[184:187], a[76:79], v[192:195], v[184:187]
v_mfma_f32_16x16x32_bf16 v[184:187], a[68:71], v[204:207], v[184:187]
s_nop 2
v_mfma_f32_16x16x32_bf16 v[188:191], a[4:7], v[204:207], 0
s_nop 2
v_mfma_f32_16x16x32_bf16 v[188:191], a[0:3], v[208:211], v[188:191]
v_cvt_pk_bf16_f32 v41, v186, v187
v_cvt_pk_bf16_f32 v40, v184, v185
v_mfma_f32_16x16x32_bf16 v[188:191], a[8:11], v[196:199], v[188:191]
v_mfma_f32_16x16x32_bf16 v[188:191], a[12:15], v[192:195], v[188:191]
s_nop 2
v_mfma_f32_16x16x32_bf16 v[184:187], a[28:31], v[192:195], 0
s_nop 2
v_mfma_f32_16x16x32_bf16 v[184:187], a[24:27], v[196:199], v[184:187]
v_cvt_pk_bf16_f32 v112, v188, v189
v_cvt_pk_bf16_f32 v113, v190, v191
v_mfma_f32_16x16x32_bf16 v[184:187], a[20:23], v[204:207], v[184:187]
v_mfma_f32_16x16x32_bf16 v[184:187], a[16:19], v[208:211], v[184:187]
s_nop 2
v_mfma_f32_16x16x32_bf16 v[188:191], a[32:35], v[208:211], 0
s_nop 2
v_mfma_f32_16x16x32_bf16 v[188:191], a[36:39], v[204:207], v[188:191]
s_add_u32 m0, s49, 14784
v_cvt_pk_bf16_f32 v114, v184, v185
v_cvt_pk_bf16_f32 v115, v186, v187
v_mfma_f32_16x16x32_bf16 v[188:191], a[40:43], v[196:199], v[188:191]
s_add_u32 s48, s48, s51
buffer_load_dwordx4 v237, s[16:19], s48 offen nt lds
v_mfma_f32_16x16x32_bf16 v[188:191], a[44:47], v[192:195], v[188:191]
s_nop 2
v_mfma_f32_16x16x32_bf16 v[184:187], a[60:63], v[192:195], 0
s_nop 2
v_mfma_f32_16x16x32_bf16 v[184:187], a[56:59], v[196:199], v[184:187]
v_cvt_pk_bf16_f32 v116, v188, v189
v_cvt_pk_bf16_f32 v117, v190, v191
v_mfma_f32_16x16x32_bf16 v[184:187], a[52:55], v[204:207], v[184:187]
v_mfma_f32_16x16x32_bf16 v[184:187], a[48:51], v[208:211], v[184:187]
s_nop 2
v_mfma_f32_16x16x32_bf16 v[152:155], a[192:195], v[208:211], 0
s_nop 2
v_mfma_f32_16x16x32_bf16 v[152:155], a[196:199], v[204:207], v[152:155]
v_cvt_pk_bf16_f32 v118, v184, v185
v_cvt_pk_bf16_f32 v119, v186, v187
v_mfma_f32_16x16x32_bf16 v[152:155], a[200:203], v[196:199], v[152:155]
v_mfma_f32_16x16x32_bf16 v[152:155], a[204:207], v[192:195], v[152:155]
v_mfma_f32_16x16x32_bf16 v[156:159], a[220:223], v[192:195], 0
v_mfma_f32_16x16x32_bf16 v[156:159], a[216:219], v[196:199], v[156:159]
v_mfma_f32_16x16x32_bf16 v[156:159], a[212:215], v[204:207], v[156:159]
v_mfma_f32_16x16x32_bf16 v[156:159], a[208:211], v[208:211], v[156:159]
v_mfma_f32_16x16x32_bf16 v[160:163], a[224:227], v[208:211], 0
v_mfma_f32_16x16x32_bf16 v[160:163], a[228:231], v[204:207], v[160:163]
v_mfma_f32_16x16x32_bf16 v[160:163], a[232:235], v[196:199], v[160:163]
v_mfma_f32_16x16x32_bf16 v[160:163], a[236:239], v[192:195], v[160:163]
v_mfma_f32_16x16x32_bf16 v[164:167], a[252:255], v[192:195], 0
v_mfma_f32_16x16x32_bf16 v[164:167], a[248:251], v[196:199], v[164:167]
s_add_u32 s48, s48, s51
s_add_u32 m0, s49, 16896
v_mfma_f32_16x16x32_bf16 v[164:167], a[244:247], v[204:207], v[164:167]
buffer_load_dwordx4 v237, s[16:19], s48 offen nt lds
v_mfma_f32_16x16x32_bf16 v[164:167], a[240:243], v[208:211], v[164:167]
v_mfma_f32_16x16x32_bf16 v[184:187], v[0:3], v[112:115], 0
v_mfma_f32_16x16x32_bf16 v[184:187], v[4:7], v[116:119], v[184:187]
s_nop 2
v_mfma_f32_16x16x32_bf16 v[188:191], v[12:15], v[116:119], 0
s_nop 2
v_mfma_f32_16x16x32_bf16 v[188:191], v[8:11], v[112:115], v[188:191]
v_max3_f32 v254, v184, v185, v186
s_nop 0
v_mfma_f32_16x16x32_bf16 v[200:203], v[16:19], v[112:115], 0
s_nop 2
v_mfma_f32_16x16x32_bf16 v[200:203], v[20:23], v[116:119], v[200:203]
s_nop 0
v_max3_f32 v254, v254, v187, v188
v_max3_f32 v254, v254, v189, v190
v_mfma_f32_16x16x32_bf16 v[212:215], v[28:31], v[116:119], 0
s_nop 2
v_mfma_f32_16x16x32_bf16 v[212:215], v[24:27], v[112:115], v[212:215]
v_max3_f32 v254, v254, v191, v200
v_max3_f32 v254, v254, v201, v202
v_mfma_f32_16x16x32_bf16 v[216:219], v[32:35], v[112:115], 0
s_nop 2
v_mfma_f32_16x16x32_bf16 v[216:219], v[36:39], v[116:119], v[216:219]
s_nop 0
v_max3_f32 v254, v254, v203, v212
v_max3_f32 v254, v254, v213, v214
v_mfma_f32_16x16x32_bf16 v[220:223], v[44:47], v[116:119], 0
s_nop 2
v_mfma_f32_16x16x32_bf16 v[220:223], v[40:43], v[112:115], v[220:223]
v_max3_f32 v254, v254, v215, v216
v_max3_f32 v254, v254, v217, v218
v_mfma_f32_16x16x32_bf16 v[224:227], v[48:51], v[112:115], 0
s_nop 2
v_mfma_f32_16x16x32_bf16 v[224:227], v[52:55], v[116:119], v[224:227]
s_nop 0
v_max3_f32 v254, v254, v219, v220
v_max3_f32 v254, v254, v221, v222
v_mfma_f32_16x16x32_bf16 v[228:231], v[208:211], a[128:131], 0
s_nop 2
v_mfma_f32_16x16x32_bf16 v[228:231], v[204:207], a[132:135], v[228:231]
v_max3_f32 v254, v254, v223, v224
v_mfma_f32_16x16x32_bf16 v[228:231], v[196:199], a[136:139], v[228:231]
ds_swizzle_b32 v255, v254 offset:0x401F
v_mfma_f32_16x16x32_bf16 v[228:231], v[192:195], a[140:143], v[228:231]
s_add_u32 m0, s49, 19008
s_add_u32 s48, s48, s51
buffer_load_dwordx4 v237, s[16:19], s48 offen nt lds
v_mfma_f32_16x16x32_bf16 v[232:235], v[192:195], a[156:159], 0
s_nop 2
v_mfma_f32_16x16x32_bf16 v[232:235], v[196:199], a[152:155], v[232:235]
v_cvt_pk_bf16_f32 v91, v230, v231
v_cvt_pk_bf16_f32 v90, v228, v229
v_mfma_f32_16x16x32_bf16 v[232:235], v[204:207], a[148:151], v[232:235]
v_mfma_f32_16x16x32_bf16 v[232:235], v[208:211], a[144:147], v[232:235]
s_nop 2
v_mfma_f32_16x16x32_bf16 v[228:231], v[208:211], a[160:163], 0
s_waitcnt lgkmcnt(0)
v_max_f32 v254, v254, v255
s_nop 0
v_mfma_f32_16x16x32_bf16 v[228:231], v[204:207], a[164:167], v[228:231]
ds_bpermute_b32 v255, v247, v254
v_mfma_f32_16x16x32_bf16 v[228:231], v[196:199], a[168:171], v[228:231]
v_cvt_pk_bf16_f32 v95, v234, v235
v_cvt_pk_bf16_f32 v94, v232, v233
v_mfma_f32_16x16x32_bf16 v[228:231], v[192:195], a[172:175], v[228:231]
s_nop 2
v_mfma_f32_16x16x32_bf16 v[232:235], v[192:195], a[188:191], 0
ds_read_b128 v[192:195], v236 offset:4224
s_nop 0
v_mfma_f32_16x16x32_bf16 v[232:235], v[204:207], a[180:183], v[232:235]
ds_read_b128 v[204:207], v236 offset:4480
v_cvt_pk_bf16_f32 v99, v230, v231
v_mfma_f32_16x16x32_bf16 v[232:235], v[208:211], a[176:179], v[232:235]
ds_read_b128 v[208:211], v236 offset:4736
v_cvt_pk_bf16_f32 v98, v228, v229
v_mfma_f32_16x16x32_bf16 v[232:235], v[196:199], a[184:187], v[232:235]
s_waitcnt lgkmcnt(3)
ds_read_b128 v[196:199], v236 offset:4992
v_max_f32 v254, v254, v255
v_sub_f32 v184, v184, v254
v_sub_f32 v185, v185, v254
v_exp_f32 v184, v184
v_exp_f32 v185, v185
v_sub_f32 v187, v187, v254
v_cvt_pk_bf16_f32 v103, v234, v235
v_cvt_pk_bf16_f32 v102, v232, v233
v_add_f32 v248, v184, v185
v_sub_f32 v186, v186, v254
v_exp_f32 v186, v186
v_cvt_pk_bf16_f32 v120, v184, v185
v_add_f32 v248, v248, v186
s_waitcnt lgkmcnt(1)
v_mfma_f32_16x16x32_bf16 v[228:231], v[208:211], a[184:187], 0
v_sub_f32 v188, v188, v254
s_waitcnt lgkmcnt(0)
v_mfma_f32_16x16x32_bf16 v[228:231], v[196:199], a[188:191], v[228:231]
v_exp_f32 v187, v187
v_mfma_f32_16x16x32_bf16 v[228:231], v[204:207], a[180:183], v[228:231]
v_cvt_pk_bf16_f32 v121, v186, v187
v_add_f32 v248, v248, v187
v_mfma_f32_16x16x32_bf16 v[228:231], v[192:195], a[176:179], v[228:231]
v_sub_f32 v189, v189, v254
v_sub_f32 v190, v190, v254
v_mfma_f32_16x16x32_bf16 v[232:235], v[192:195], a[160:163], 0
v_exp_f32 v189, v189
v_mfma_f32_16x16x32_bf16 v[232:235], v[204:207], a[164:167], v[232:235]
v_exp_f32 v190, v190
v_mfma_f32_16x16x32_bf16 v[232:235], v[208:211], a[168:171], v[232:235]
s_nop 0
v_cvt_pk_bf16_f32 v71, v230, v231
v_cvt_pk_bf16_f32 v70, v228, v229
v_mfma_f32_16x16x32_bf16 v[232:235], v[196:199], a[172:175], v[232:235]
s_add_u32 s48, s48, s51
v_exp_f32 v188, v188
v_mfma_f32_16x16x32_bf16 v[228:231], v[196:199], a[156:159], 0
s_add_u32 m0, s49, 21120
v_add_f32 v248, v248, v188
v_sub_f32 v191, v191, v254
v_mfma_f32_16x16x32_bf16 v[228:231], v[208:211], a[152:155], v[228:231]
buffer_load_dwordx4 v237, s[16:19], s48 offen nt lds
v_cvt_pk_bf16_f32 v66, v232, v233
v_mfma_f32_16x16x32_bf16 v[228:231], v[204:207], a[148:151], v[228:231]
v_cvt_pk_bf16_f32 v67, v234, v235
v_add_f32 v248, v248, v189
v_mfma_f32_16x16x32_bf16 v[228:231], v[192:195], a[144:147], v[228:231]
v_exp_f32 v191, v191
v_mfma_f32_16x16x32_bf16 v[232:235], v[192:195], a[128:131], 0
ds_read_b128 v[192:195], v236 offset:0
v_cvt_pk_bf16_f32 v122, v188, v189
v_mfma_f32_16x16x32_bf16 v[232:235], v[208:211], a[136:139], v[232:235]
ds_read_b128 v[208:211], v236 offset:256
v_add_f32 v248, v248, v190
v_mfma_f32_16x16x32_bf16 v[232:235], v[196:199], a[140:143], v[232:235]
ds_read_b128 v[196:199], v236 offset:512
v_cvt_pk_bf16_f32 v62, v228, v229
v_mfma_f32_16x16x32_bf16 v[232:235], v[204:207], a[132:135], v[232:235]
ds_read_b128 v[204:207], v236 offset:768
v_cvt_pk_bf16_f32 v63, v230, v231
v_add_f32 v248, v248, v191
v_cvt_pk_bf16_f32 v123, v190, v191
v_sub_f32 v200, v200, v254
v_exp_f32 v200, v200
v_sub_f32 v201, v201, v254
v_exp_f32 v201, v201
v_cvt_pk_bf16_f32 v59, v234, v235
v_cvt_pk_bf16_f32 v58, v232, v233
v_sub_f32 v203, v203, v254
s_waitcnt lgkmcnt(2)
v_mfma_f32_16x16x32_bf16 v[228:231], v[208:211], a[132:135], 0
ds_read_b128 v[188:191], v242 offset:64
v_sub_f32 v202, v202, v254
v_mfma_f32_16x16x32_bf16 v[228:231], v[192:195], a[128:131], v[228:231]
s_waitcnt lgkmcnt(2)
v_exp_f32 v203, v203
v_mfma_f32_16x16x32_bf16 v[228:231], v[196:199], a[136:139], v[228:231]
s_waitcnt lgkmcnt(1)
v_exp_f32 v202, v202
v_mfma_f32_16x16x32_bf16 v[228:231], v[204:207], a[140:143], v[228:231]
v_add_f32 v248, v248, v200
v_add_f32 v248, v248, v201
v_mfma_f32_16x16x32_bf16 v[184:187], v[204:207], a[156:159], 0
v_add_f32 v248, v248, v202
v_add_f32 v248, v248, v203
v_mfma_f32_16x16x32_bf16 v[184:187], v[196:199], a[152:155], v[184:187]
v_cvt_pk_bf16_f32 v124, v200, v201
v_cvt_pk_bf16_f32 v125, v202, v203
v_mfma_f32_16x16x32_bf16 v[184:187], v[208:211], a[148:151], v[184:187]
s_waitcnt lgkmcnt(0)
v_cvt_pk_bf16_f32 v56, v228, v229
v_cvt_pk_bf16_f32 v57, v230, v231
v_mfma_f32_16x16x32_bf16 v[184:187], v[192:195], a[144:147], v[184:187]
v_sub_f32 v212, v212, v254
v_sub_f32 v213, v213, v254
v_mfma_f32_16x16x32_bf16 v[228:231], v[192:195], a[160:163], 0
v_exp_f32 v212, v212
v_mfma_f32_16x16x32_bf16 v[228:231], v[208:211], a[164:167], v[228:231]
v_sub_f32 v214, v214, v254
v_add_f32 v248, v248, v212
v_mfma_f32_16x16x32_bf16 v[228:231], v[196:199], a[168:171], v[228:231]
v_cvt_pk_bf16_f32 v60, v184, v185
v_cvt_pk_bf16_f32 v61, v186, v187
v_mfma_f32_16x16x32_bf16 v[228:231], v[204:207], a[172:175], v[228:231]
s_add_u32 m0, s49, 23232
ds_read_b128 v[184:187], v242 offset:0
v_sub_f32 v215, v215, v254
v_mfma_f32_16x16x32_bf16 v[232:235], v[204:207], a[188:191], 0
s_add_u32 s48, s48, s51
buffer_load_dwordx4 v237, s[16:19], s48 offen nt lds
v_sub_f32 v216, v216, v254
v_mfma_f32_16x16x32_bf16 v[232:235], v[196:199], a[184:187], v[232:235]
s_sub_u32 s49, s49, s56
v_exp_f32 v213, v213
v_mfma_f32_16x16x32_bf16 v[232:235], v[208:211], a[180:183], v[232:235]
s_and_b32 s51, s57, 26212352
v_exp_f32 v214, v214
v_mfma_f32_16x16x32_bf16 v[232:235], v[192:195], a[176:179], v[232:235]
s_add_u32 s51, s51, 2048
v_cvt_pk_bf16_f32 v126, v212, v213
v_add_f32 v248, v248, v213
v_mfma_f32_16x16x32_bf16 v[200:203], v[4:7], v[188:191], 0
v_add_f32 v248, v248, v214
s_waitcnt lgkmcnt(0)
v_mfma_f32_16x16x32_bf16 v[200:203], v[0:3], v[184:187], v[200:203]
s_nop 0
v_cvt_pk_bf16_f32 v69, v234, v235
v_cvt_pk_bf16_f32 v68, v232, v233
v_mfma_f32_16x16x32_bf16 v[232:235], v[32:35], v[184:187], 0
ds_read_b128 v[184:187], v245 offset:64
v_sub_f32 v218, v218, v254
v_mfma_f32_16x16x32_bf16 v[232:235], v[36:39], v[188:191], v[232:235]
ds_read_b128 v[188:191], v243 offset:0
v_exp_f32 v215, v215
s_nop 0
v_add_f32 v248, v248, v215
v_cvt_pk_bf16_f32 v127, v214, v215
ds_read_b128 v[212:215], v243 offset:64
v_exp_f32 v216, v216
v_sub_f32 v217, v217, v254
v_add_f32 v248, v248, v216
v_exp_f32 v218, v218
v_sub_f32 v219, v219, v254
v_exp_f32 v217, v217
v_exp_f32 v219, v219
v_cvt_pk_bf16_f32 v128, v216, v217
v_cvt_pk_bf16_f32 v129, v218, v219
v_add_f32 v248, v248, v217
v_add_f32 v248, v248, v218
v_add_f32 v248, v248, v219
v_cvt_pk_bf16_f32 v64, v228, v229
v_cvt_pk_bf16_f32 v65, v230, v231
v_sub_f32 v220, v220, v254
v_sub_f32 v221, v221, v254
s_waitcnt lgkmcnt(0)
v_mfma_f32_16x16x32_bf16 v[200:203], v[12:15], v[212:215], v[200:203]
ds_read_b128 v[216:219], v244 offset:0
ds_read_b128 v[228:231], v245 offset:0
v_mfma_f32_16x16x32_bf16 v[200:203], v[8:11], v[188:191], v[200:203]
v_exp_f32 v220, v220
v_mfma_f32_16x16x32_bf16 v[232:235], v[40:43], v[188:191], v[232:235]
ds_read_b128 v[188:191], v244 offset:64
v_add_f32 v248, v248, v220
v_mfma_f32_16x16x32_bf16 v[232:235], v[44:47], v[212:215], v[232:235]
v_exp_f32 v221, v221
v_sub_f32 v223, v223, v254
v_add_f32 v248, v248, v221
v_exp_f32 v223, v223
v_sub_f32 v222, v222, v254
v_exp_f32 v222, v222
v_cvt_pk_bf16_f32 v130, v220, v221
v_mov_b32 v221, 0xff800000
v_add_f32 v248, v248, v222
v_cvt_pk_bf16_f32 v131, v222, v223
v_add_f32 v248, v248, v223
v_sub_f32 v224, v224, v254
v_exp_f32 v224, v224
s_waitcnt lgkmcnt(0)
v_mfma_f32_16x16x32_bf16 v[200:203], v[20:23], v[188:191], v[200:203]
v_cvt_pk_bf16_f32 v132, v224, 0
v_add_f32 v248, v248, v224
v_mfma_f32_16x16x32_bf16 v[200:203], v[16:19], v[216:219], v[200:203]
ds_swizzle_b32 v250, v248 offset:0x401F
v_add_u32 v245, 0x200, v245
v_mfma_f32_16x16x32_bf16 v[232:235], v[48:51], v[216:219], v[232:235]
v_add_u32 v244, 0x200, v244
v_add_u32 v243, 0x200, v243
v_mfma_f32_16x16x32_bf16 v[232:235], v[52:55], v[188:191], v[232:235]
v_add_u32 v242, 0x200, v242
s_nop 0
v_mfma_f32_16x16x32_bf16 v[200:203], v[24:27], v[228:231], v[200:203]
s_nop 2
v_mfma_f32_16x16x32_bf16 v[200:203], v[28:31], v[184:187], v[200:203]
s_nop 0
v_mov_b32_dpp v233, v221 quad_perm:[0,1,2,3] row_mask:0xf bank_mask:0xc
v_mov_b32_dpp v232, v221 quad_perm:[0,1,2,3] row_mask:0xf bank_mask:0x8
v_mfma_f32_16x16x32_bf16 v[184:187], a[0:3], v[192:195], 0
v_mov_b32_dpp v234, v221 quad_perm:[0,1,2,3] row_mask:0xf bank_mask:0xc
v_mov_b32_dpp v235, v221 quad_perm:[0,1,2,3] row_mask:0xf bank_mask:0xc
v_mfma_f32_16x16x32_bf16 v[184:187], a[4:7], v[208:211], v[184:187]
s_waitcnt lgkmcnt(0)
v_max3_f32 v223, v200, v201, v202
v_max3_f32 v223, v223, v203, v232
v_mfma_f32_16x16x32_bf16 v[184:187], a[8:11], v[196:199], v[184:187]
v_max3_f32 v223, v223, v233, v234
v_max_f32 v223, v223, v235
v_mfma_f32_16x16x32_bf16 v[184:187], a[12:15], v[204:207], v[184:187]
s_nop 0
v_max_f32_dpp v223, v223, v223 row_ror:8 row_mask:0xf bank_mask:0xf
v_add_f32 v248, v248, v250
v_mfma_f32_16x16x32_bf16 v[188:191], a[28:31], v[204:207], 0
ds_bpermute_b32 v250, v247, v248
v_mfma_f32_16x16x32_bf16 v[188:191], a[24:27], v[196:199], v[188:191]
v_max_f32_dpp v223, v223, v223 row_ror:4 row_mask:0xf bank_mask:0xf
v_mfma_f32_16x16x32_bf16 v[188:191], a[20:23], v[208:211], v[188:191]
ds_swizzle_b32 v221, v223 offset:0x401F
v_cvt_pk_bf16_f32 v113, v186, v187
v_mfma_f32_16x16x32_bf16 v[188:191], a[16:19], v[192:195], v[188:191]
v_cvt_pk_bf16_f32 v112, v184, v185
s_nop 0
v_mfma_f32_16x16x32_bf16 v[184:187], a[32:35], v[192:195], 0
s_nop 2
v_mfma_f32_16x16x32_bf16 v[184:187], a[36:39], v[208:211], v[184:187]
s_nop 0
v_cvt_pk_bf16_f32 v115, v190, v191
v_cvt_pk_bf16_f32 v114, v188, v189
v_mfma_f32_16x16x32_bf16 v[184:187], a[40:43], v[196:199], v[184:187]
s_waitcnt lgkmcnt(1)
v_add_f32 v248, v248, v250
v_mfma_f32_16x16x32_bf16 v[184:187], a[44:47], v[204:207], v[184:187]
v_rcp_f32 v251, v248
v_mfma_f32_16x16x32_bf16 v[188:191], a[60:63], v[204:207], 0
s_waitcnt lgkmcnt(0)
v_max_f32 v223, v223, v221
s_nop 0
v_mfma_f32_16x16x32_bf16 v[188:191], a[56:59], v[196:199], v[188:191]
ds_bpermute_b32 v221, v247, v223
v_mfma_f32_16x16x32_bf16 v[188:191], a[52:55], v[208:211], v[188:191]
v_cvt_pk_bf16_f32 v117, v186, v187
v_cvt_pk_bf16_f32 v116, v184, v185
v_mfma_f32_16x16x32_bf16 v[188:191], a[48:51], v[192:195], v[188:191]
s_nop 2
v_mfma_f32_16x16x32_bf16 v[168:171], a[192:195], v[192:195], 0
s_nop 2
v_mfma_f32_16x16x32_bf16 v[168:171], a[196:199], v[208:211], v[168:171]
v_cvt_pk_bf16_f32 v119, v190, v191
v_cvt_pk_bf16_f32 v118, v188, v189
v_mfma_f32_16x16x32_bf16 v[168:171], a[200:203], v[196:199], v[168:171]
v_mfma_f32_16x16x32_bf16 v[168:171], a[204:207], v[204:207], v[168:171]
s_waitcnt lgkmcnt(0)
v_max_f32 v223, v223, v221
v_sub_f32 v200, v200, v223
v_mfma_f32_16x16x32_bf16 v[172:175], a[220:223], v[204:207], 0
v_exp_f32 v200, v200
v_mfma_f32_16x16x32_bf16 v[172:175], a[216:219], v[196:199], v[172:175]
v_sub_f32 v201, v201, v223
v_sub_f32 v202, v202, v223
v_mfma_f32_16x16x32_bf16 v[172:175], a[212:215], v[208:211], v[172:175]
v_exp_f32 v202, v202
v_mfma_f32_16x16x32_bf16 v[172:175], a[208:211], v[192:195], v[172:175]
v_exp_f32 v201, v201
v_mfma_f32_16x16x32_bf16 v[176:179], a[224:227], v[192:195], 0
v_add_f32 v220, v200, v201
v_add_f32 v220, v220, v202
v_mfma_f32_16x16x32_bf16 v[176:179], a[228:231], v[208:211], v[176:179]
v_sub_f32 v203, v203, v223
v_sub_f32 v233, v233, v223
v_mfma_f32_16x16x32_bf16 v[176:179], a[232:235], v[196:199], v[176:179]
v_exp_f32 v233, v233
v_mfma_f32_16x16x32_bf16 v[176:179], a[236:239], v[204:207], v[176:179]
v_exp_f32 v203, v203
v_mfma_f32_16x16x32_bf16 v[180:183], a[252:255], v[204:207], 0
v_sub_f32 v232, v232, v223
v_sub_f32 v234, v234, v223
v_mfma_f32_16x16x32_bf16 v[180:183], a[248:251], v[196:199], v[180:183]
v_exp_f32 v232, v232
v_mfma_f32_16x16x32_bf16 v[180:183], a[244:247], v[208:211], v[180:183]
v_exp_f32 v234, v234
v_mfma_f32_16x16x32_bf16 v[180:183], a[240:243], v[192:195], v[180:183]
v_add_f32 v220, v220, v203
v_add_f32 v220, v220, v232
v_mfma_f32_16x16x32_bf16 v[184:187], v[0:3], v[112:115], 0
v_add_f32 v220, v220, v233
v_add_f32 v220, v220, v234
v_mfma_f32_16x16x32_bf16 v[184:187], v[4:7], v[116:119], v[184:187]
v_sub_f32 v235, v235, v223
v_cvt_pk_bf16_f32 v200, v200, v201
v_mfma_f32_16x16x32_bf16 v[188:191], v[12:15], v[116:119], 0
v_exp_f32 v235, v235
v_mfma_f32_16x16x32_bf16 v[188:191], v[8:11], v[112:115], v[188:191]
v_add_f32 v220, v220, v235
v_cvt_pk_bf16_f32 v201, v202, v203
v_mfma_f32_16x16x32_bf16 v[192:195], v[16:19], v[112:115], 0
v_cvt_pk_bf16_f32 v202, v232, v233
v_cvt_pk_bf16_f32 v203, v234, v235
v_mfma_f32_16x16x32_bf16 v[192:195], v[20:23], v[116:119], v[192:195]
ds_read_b128 v[196:199], v236 offset:8448
v_add_f32_dpp v220, v220, v220 row_ror:8 row_mask:0xf bank_mask:0xf
v_mfma_f32_16x16x32_bf16 v[208:211], v[28:31], v[116:119], 0
ds_read_b128 v[204:207], v236 offset:8704
v_add_f32_dpp v220, v220, v220 row_ror:4 row_mask:0xf bank_mask:0xf
v_mfma_f32_16x16x32_bf16 v[208:211], v[24:27], v[112:115], v[208:211]
ds_write_b32 v246, v220 offset:4096
ds_read_b128 v[212:215], v236 offset:8960
v_mfma_f32_16x16x32_bf16 v[216:219], v[32:35], v[112:115], 0
ds_read_b128 v[224:227], v236 offset:9216
v_max3_f32 v254, v184, v185, v186
v_mfma_f32_16x16x32_bf16 v[216:219], v[36:39], v[116:119], v[216:219]
v_max3_f32 v254, v254, v187, v188
v_max3_f32 v254, v254, v189, v190
v_mfma_f32_16x16x32_bf16 v[228:231], v[44:47], v[116:119], 0
v_max3_f32 v254, v254, v191, v192
v_max3_f32 v254, v254, v193, v194
v_mfma_f32_16x16x32_bf16 v[228:231], v[40:43], v[112:115], v[228:231]
s_waitcnt lgkmcnt(4)
v_max3_f32 v254, v254, v195, v208
v_max3_f32 v254, v254, v209, v210
v_mfma_f32_16x16x32_bf16 v[232:235], v[48:51], v[112:115], 0
s_waitcnt lgkmcnt(3)
v_max3_f32 v254, v254, v211, v216
v_max3_f32 v254, v254, v217, v218
v_mfma_f32_16x16x32_bf16 v[232:235], v[52:55], v[116:119], v[232:235]
s_waitcnt lgkmcnt(1)
v_max3_f32 v254, v254, v219, v228
v_max3_f32 v254, v254, v229, v230
v_mfma_f32_16x16x32_bf16 v[220:223], v[196:199], a[128:131], 0
s_waitcnt lgkmcnt(0)
s_nop 1
v_mfma_f32_16x16x32_bf16 v[220:223], v[204:207], a[132:135], v[220:223]
v_max3_f32 v254, v254, v231, v232
v_mfma_f32_16x16x32_bf16 v[220:223], v[212:215], a[136:139], v[220:223]
ds_swizzle_b32 v255, v254 offset:0x401F
v_mfma_f32_16x16x32_bf16 v[220:223], v[224:227], a[140:143], v[220:223]
s_nop 7
v_cvt_pk_bf16_f32 v73, v222, v223
v_cvt_pk_bf16_f32 v72, v220, v221
v_mfma_f32_16x16x32_bf16 v[220:223], v[224:227], a[156:159], 0
v_mfma_f32_16x16x32_bf16 v[220:223], v[212:215], a[152:155], v[220:223]
v_mfma_f32_16x16x32_bf16 v[220:223], v[204:207], a[148:151], v[220:223]
s_waitcnt lgkmcnt(0)
v_max_f32 v254, v254, v255
v_mfma_f32_16x16x32_bf16 v[220:223], v[196:199], a[144:147], v[220:223]
ds_bpermute_b32 v255, v247, v254
s_nop 6
v_cvt_pk_bf16_f32 v76, v220, v221
v_cvt_pk_bf16_f32 v77, v222, v223
v_mfma_f32_16x16x32_bf16 v[220:223], v[196:199], a[160:163], 0
v_mfma_f32_16x16x32_bf16 v[220:223], v[204:207], a[164:167], v[220:223]
v_mfma_f32_16x16x32_bf16 v[220:223], v[212:215], a[168:171], v[220:223]
s_waitcnt lgkmcnt(0)
v_max_f32 v254, v254, v255
v_mfma_f32_16x16x32_bf16 v[220:223], v[224:227], a[172:175], v[220:223]
v_sub_f32 v184, v184, v254
v_exp_f32 v184, v184
v_sub_f32 v185, v185, v254
v_sub_f32 v187, v187, v254
v_exp_f32 v185, v185
s_nop 2
v_cvt_pk_bf16_f32 v81, v222, v223
v_cvt_pk_bf16_f32 v80, v220, v221
v_mfma_f32_16x16x32_bf16 v[220:223], v[224:227], a[188:191], 0
ds_read_b128 v[224:227], v236 offset:12672
v_add_f32 v249, v184, v185
v_mfma_f32_16x16x32_bf16 v[220:223], v[204:207], a[180:183], v[220:223]
ds_read_b128 v[204:207], v236 offset:12928
v_sub_f32 v186, v186, v254
v_mfma_f32_16x16x32_bf16 v[220:223], v[196:199], a[176:179], v[220:223]
ds_read_b128 v[196:199], v236 offset:13184
v_cvt_pk_bf16_f32 v136, v184, v185
v_mfma_f32_16x16x32_bf16 v[220:223], v[212:215], a[184:187], v[220:223]
ds_read_b128 v[212:215], v236 offset:13440
v_exp_f32 v186, v186
v_exp_f32 v187, v187
v_add_f32 v249, v249, v186
v_add_f32 v249, v249, v187
v_cvt_pk_bf16_f32 v137, v186, v187
v_sub_f32 v189, v189, v254
v_sub_f32 v188, v188, v254
v_cvt_pk_bf16_f32 v84, v220, v221
v_cvt_pk_bf16_f32 v85, v222, v223
v_exp_f32 v188, v188
v_exp_f32 v189, v189
v_sub_f32 v191, v191, v254
s_waitcnt lgkmcnt(1)
v_mfma_f32_16x16x32_bf16 v[184:187], v[196:199], a[184:187], 0
v_sub_f32 v190, v190, v254
s_waitcnt lgkmcnt(0)
v_mfma_f32_16x16x32_bf16 v[184:187], v[212:215], a[188:191], v[184:187]
v_exp_f32 v190, v190
v_mfma_f32_16x16x32_bf16 v[184:187], v[204:207], a[180:183], v[184:187]
v_exp_f32 v191, v191
v_mfma_f32_16x16x32_bf16 v[184:187], v[224:227], a[176:179], v[184:187]
v_add_f32 v249, v249, v188
v_add_f32 v249, v249, v189
v_mfma_f32_16x16x32_bf16 v[220:223], v[224:227], a[160:163], 0
v_add_f32 v249, v249, v190
v_cvt_pk_bf16_f32 v139, v190, v191
v_mfma_f32_16x16x32_bf16 v[220:223], v[204:207], a[164:167], v[220:223]
v_cvt_pk_bf16_f32 v138, v188, v189
v_add_f32 v249, v249, v191
v_mfma_f32_16x16x32_bf16 v[220:223], v[196:199], a[168:171], v[220:223]
v_cvt_pk_bf16_f32 v86, v184, v185
v_cvt_pk_bf16_f32 v87, v186, v187
v_mfma_f32_16x16x32_bf16 v[220:223], v[212:215], a[172:175], v[220:223]
v_sub_f32 v192, v192, v254
v_sub_f32 v194, v194, v254
v_mfma_f32_16x16x32_bf16 v[184:187], v[212:215], a[156:159], 0
v_exp_f32 v192, v192
v_mfma_f32_16x16x32_bf16 v[184:187], v[196:199], a[152:155], v[184:187]
v_add_f32 v249, v249, v192
v_sub_f32 v193, v193, v254
v_mfma_f32_16x16x32_bf16 v[184:187], v[204:207], a[148:151], v[184:187]
v_cvt_pk_bf16_f32 v83, v222, v223
v_cvt_pk_bf16_f32 v82, v220, v221
v_mfma_f32_16x16x32_bf16 v[184:187], v[224:227], a[144:147], v[184:187]
v_exp_f32 v193, v193
v_mfma_f32_16x16x32_bf16 v[220:223], v[224:227], a[128:131], 0
ds_read_b128 v[224:227], v236 offset:16896
v_sub_f32 v209, v209, v254
v_mfma_f32_16x16x32_bf16 v[220:223], v[196:199], a[136:139], v[220:223]
ds_read_b128 v[196:199], v236 offset:17152
v_sub_f32 v208, v208, v254
v_mfma_f32_16x16x32_bf16 v[220:223], v[212:215], a[140:143], v[220:223]
ds_read_b128 v[212:215], v236 offset:17408
v_cvt_pk_bf16_f32 v79, v186, v187
v_mfma_f32_16x16x32_bf16 v[220:223], v[204:207], a[132:135], v[220:223]
ds_read_b128 v[204:207], v236 offset:17664
v_cvt_pk_bf16_f32 v78, v184, v185
v_exp_f32 v208, v208
v_exp_f32 v209, v209
v_exp_f32 v194, v194
v_add_f32 v249, v249, v193
v_add_f32 v249, v249, v194
v_sub_f32 v195, v195, v254
v_cvt_pk_bf16_f32 v74, v220, v221
v_cvt_pk_bf16_f32 v75, v222, v223
s_waitcnt lgkmcnt(2)
v_mfma_f32_16x16x32_bf16 v[184:187], v[196:199], a[132:135], 0
v_exp_f32 v195, v195
v_mfma_f32_16x16x32_bf16 v[184:187], v[224:227], a[128:131], v[184:187]
s_waitcnt lgkmcnt(1)
v_sub_f32 v216, v216, v254
v_sub_f32 v211, v211, v254
v_mfma_f32_16x16x32_bf16 v[184:187], v[212:215], a[136:139], v[184:187]
s_waitcnt lgkmcnt(0)
v_sub_f32 v210, v210, v254
v_add_f32 v249, v249, v195
v_mfma_f32_16x16x32_bf16 v[184:187], v[204:207], a[140:143], v[184:187]
v_exp_f32 v211, v211
v_mfma_f32_16x16x32_bf16 v[220:223], v[204:207], a[156:159], 0
v_exp_f32 v210, v210
v_mfma_f32_16x16x32_bf16 v[220:223], v[212:215], a[152:155], v[220:223]
v_add_f32 v249, v249, v208
v_sub_f32 v219, v219, v254
v_mfma_f32_16x16x32_bf16 v[220:223], v[196:199], a[148:151], v[220:223]
s_nop 0
v_cvt_pk_bf16_f32 v89, v186, v187
v_cvt_pk_bf16_f32 v88, v184, v185
v_mfma_f32_16x16x32_bf16 v[220:223], v[224:227], a[144:147], v[220:223]
v_exp_f32 v216, v216
v_mfma_f32_16x16x32_bf16 v[184:187], v[224:227], a[160:163], 0
v_sub_f32 v217, v217, v254
v_add_f32 v249, v249, v209
v_mfma_f32_16x16x32_bf16 v[184:187], v[196:199], a[164:167], v[184:187]
v_sub_f32 v228, v228, v254
v_add_f32 v249, v249, v210
v_mfma_f32_16x16x32_bf16 v[184:187], v[212:215], a[168:171], v[184:187]
v_exp_f32 v217, v217
v_mfma_f32_16x16x32_bf16 v[184:187], v[204:207], a[172:175], v[184:187]
v_sub_f32 v229, v229, v254
v_sub_f32 v218, v218, v254
v_mfma_f32_16x16x32_bf16 v[188:191], v[204:207], a[188:191], 0
v_exp_f32 v218, v218
v_mfma_f32_16x16x32_bf16 v[188:191], v[212:215], a[184:187], v[188:191]
v_add_f32 v249, v249, v211
v_add_f32 v249, v249, v216
v_mfma_f32_16x16x32_bf16 v[188:191], v[196:199], a[180:183], v[188:191]
v_cvt_pk_bf16_f32 v96, v184, v185
v_cvt_pk_bf16_f32 v97, v186, v187
v_mfma_f32_16x16x32_bf16 v[188:191], v[224:227], a[176:179], v[188:191]
v_exp_f32 v219, v219
v_mfma_f32_16x16x32_bf16 v[184:187], a[0:3], v[224:227], 0
v_add_f32 v249, v249, v217
v_add_f32 v249, v249, v218
v_mfma_f32_16x16x32_bf16 v[184:187], a[4:7], v[196:199], v[184:187]
v_add_f32 v249, v249, v219
v_cvt_pk_bf16_f32 v144, v216, v217
v_mfma_f32_16x16x32_bf16 v[184:187], a[8:11], v[212:215], v[184:187]
v_cvt_pk_bf16_f32 v100, v188, v189
v_cvt_pk_bf16_f32 v101, v190, v191
v_mfma_f32_16x16x32_bf16 v[184:187], a[12:15], v[204:207], v[184:187]
v_cvt_pk_bf16_f32 v145, v218, v219
v_cvt_pk_bf16_f32 v92, v220, v221
v_mfma_f32_16x16x32_bf16 v[188:191], a[28:31], v[204:207], 0
v_cvt_pk_bf16_f32 v93, v222, v223
v_sub_f32 v232, v232, v254
v_mfma_f32_16x16x32_bf16 v[188:191], a[24:27], v[212:215], v[188:191]
v_exp_f32 v228, v228
v_mfma_f32_16x16x32_bf16 v[188:191], a[20:23], v[196:199], v[188:191]
v_cvt_pk_bf16_f32 v112, v184, v185
v_cvt_pk_bf16_f32 v113, v186, v187
v_mfma_f32_16x16x32_bf16 v[188:191], a[16:19], v[224:227], v[188:191]
v_exp_f32 v229, v229
v_mfma_f32_16x16x32_bf16 v[184:187], a[32:35], v[224:227], 0
v_add_f32 v249, v249, v228
v_sub_f32 v231, v231, v254
v_mfma_f32_16x16x32_bf16 v[184:187], a[36:39], v[196:199], v[184:187]
v_exp_f32 v232, v232
v_mfma_f32_16x16x32_bf16 v[184:187], a[40:43], v[212:215], v[184:187]
s_nop 0
v_cvt_pk_bf16_f32 v115, v190, v191
v_cvt_pk_bf16_f32 v114, v188, v189
v_mfma_f32_16x16x32_bf16 v[184:187], a[44:47], v[204:207], v[184:187]
v_sub_f32 v230, v230, v254
v_add_f32 v249, v249, v229
v_mfma_f32_16x16x32_bf16 v[188:191], a[60:63], v[204:207], 0
v_cvt_pk_bf16_f32 v140, v192, v193
v_mov_b32 v192, v202
v_mfma_f32_16x16x32_bf16 v[188:191], a[56:59], v[212:215], v[188:191]
v_cvt_pk_bf16_f32 v142, v208, v209
v_mov_b32_dpp v209, v201 row_ror:8 row_mask:0xf bank_mask:0xf
v_mfma_f32_16x16x32_bf16 v[188:191], a[52:55], v[196:199], v[188:191]
v_cvt_pk_bf16_f32 v116, v184, v185
v_cvt_pk_bf16_f32 v117, v186, v187
v_mfma_f32_16x16x32_bf16 v[188:191], a[48:51], v[224:227], v[188:191]
v_mov_b32_dpp v208, v200 row_ror:8 row_mask:0xf bank_mask:0xf
v_cvt_pk_bf16_f32 v143, v210, v211
v_mfma_f32_16x16x32_bf16 v[216:219], v[56:59], v[120:123], 0
v_mov_b32_dpp v211, v201 row_ror:4 row_mask:0xf bank_mask:0xf
v_mov_b32_dpp v210, v200 row_ror:4 row_mask:0xf bank_mask:0xf
v_mfma_f32_16x16x32_bf16 v[216:219], v[104:107], v[132:135], v[216:219]
v_cvt_pk_bf16_f32 v141, v194, v195
v_mov_b32_dpp v194, v202 row_ror:12 row_mask:0xf bank_mask:0xf
v_mfma_f32_16x16x32_bf16 v[216:219], v[72:75], v[124:127], v[216:219]
v_cvt_pk_bf16_f32 v118, v188, v189
v_cvt_pk_bf16_f32 v119, v190, v191
v_mfma_f32_16x16x32_bf16 v[216:219], v[88:91], v[128:131], v[216:219]
v_mov_b32_dpp v195, v203 row_ror:12 row_mask:0xf bank_mask:0xf
v_mov_b32 v193, v203
v_mfma_f32_16x16x32_bf16 v[220:223], v[92:95], v[128:131], 0
v_mov_b32_dpp v203, v201 row_ror:12 row_mask:0xf bank_mask:0xf
v_mov_b32_dpp v202, v200 row_ror:12 row_mask:0xf bank_mask:0xf
v_mfma_f32_16x16x32_bf16 v[220:223], v[76:79], v[124:127], v[220:223]
v_exp_f32 v230, v230
v_mfma_f32_16x16x32_bf16 v[220:223], v[106:109], v[132:135], v[220:223]
v_fmac_f32 v154, v218, v251
v_fmac_f32 v152, v216, v251
v_mfma_f32_16x16x32_bf16 v[220:223], v[60:63], v[120:123], v[220:223]
v_fmac_f32 v155, v219, v251
v_fmac_f32 v153, v217, v251
v_mfma_f32_16x16x32_bf16 v[188:191], v[64:67], v[120:123], 0
v_exp_f32 v231, v231
v_mfma_f32_16x16x32_bf16 v[188:191], v[108:111], v[132:135], v[188:191]
v_add_f32 v249, v249, v230
v_add_f32 v249, v249, v231
v_mfma_f32_16x16x32_bf16 v[188:191], v[80:83], v[124:127], v[188:191]
v_cvt_pk_bf16_f32 v146, v228, v229
v_cvt_pk_bf16_f32 v147, v230, v231
v_mfma_f32_16x16x32_bf16 v[188:191], v[96:99], v[128:131], v[188:191]
v_add_f32 v249, v249, v232
v_fmac_f32 v156, v220, v251
v_mfma_f32_16x16x32_bf16 v[184:187], v[100:103], v[128:131], 0
ds_swizzle_b32 v250, v249 offset:0x401F
v_fmac_f32 v158, v222, v251
v_mfma_f32_16x16x32_bf16 v[184:187], v[84:87], v[124:127], v[184:187]
v_fmac_f32 v157, v221, v251
v_fmac_f32 v159, v223, v251
v_mfma_f32_16x16x32_bf16 v[184:187], v[68:71], v[120:123], v[184:187]
v_fmac_f32 v161, v189, v251
v_fmac_f32 v160, v188, v251
v_mfma_f32_16x16x32_bf16 v[184:187], v[110:113], v[132:135], v[184:187]
v_mov_b32_dpp v132, v192 row_ror:8 row_mask:0xf bank_mask:0xf
v_fmac_f32 v163, v191, v251
v_fmac_f32 v162, v190, v251
v_mfma_f32_16x16x32_bf16 v[216:219], v[110:113], v[132:135], 0
v_cvt_pk_bf16_f32 v152, v152, v153
v_cvt_pk_bf16_f32 v153, v154, v155
v_mfma_f32_16x16x32_bf16 v[216:219], v[84:87], v[208:211], v[216:219]
s_nop 0
v_fmac_f32 v167, v187, v251
v_fmac_f32 v164, v184, v251
v_mfma_f32_16x16x32_bf16 v[216:219], v[100:103], v[192:195], v[216:219]
s_waitcnt lgkmcnt(0)
v_fmac_f32 v165, v185, v251
v_fmac_f32 v166, v186, v251
v_mfma_f32_16x16x32_bf16 v[216:219], v[68:71], v[200:203], v[216:219]
v_add_f32 v249, v249, v250
v_pk_max_i16 v153, v153, 0
v_mfma_f32_16x16x32_bf16 v[188:191], v[64:67], v[200:203], 0
ds_bpermute_b32 v250, v247, v249
v_mfma_f32_16x16x32_bf16 v[188:191], v[80:83], v[208:211], v[188:191]
v_cvt_pk_bf16_f32 v160, v160, v161
v_cvt_pk_bf16_f32 v161, v162, v163
v_mfma_f32_16x16x32_bf16 v[188:191], v[96:99], v[192:195], v[188:191]
v_cvt_pk_bf16_f32 v216, v216, v217
v_cvt_pk_bf16_f32 v217, v218, v219
v_mfma_f32_16x16x32_bf16 v[188:191], v[108:111], v[132:135], v[188:191]
ds_write_b64 v246, v[216:217] offset:24
v_mfma_f32_16x16x32_bf16 v[228:231], v[106:109], v[132:135], 0
v_cvt_pk_bf16_f32 v162, v164, v165
v_pk_max_i16 v160, v160, 0
v_mfma_f32_16x16x32_bf16 v[228:231], v[76:79], v[208:211], v[228:231]
v_pk_max_i16 v161, v161, 0
v_cvt_pk_bf16_f32 v163, v166, v167
v_mfma_f32_16x16x32_bf16 v[228:231], v[92:95], v[192:195], v[228:231]
s_waitcnt lgkmcnt(1)
v_cvt_pk_bf16_f32 v188, v188, v189
v_cvt_pk_bf16_f32 v189, v190, v191
v_mfma_f32_16x16x32_bf16 v[228:231], v[60:63], v[200:203], v[228:231]
ds_write_b64 v246, v[188:189] offset:16
v_mfma_f32_16x16x32_bf16 v[184:187], v[56:59], v[200:203], 0
v_pk_max_i16 v163, v163, 0
v_cvt_pk_bf16_f32 v155, v158, v159
v_mfma_f32_16x16x32_bf16 v[184:187], v[72:75], v[208:211], v[184:187]
v_pk_max_i16 v162, v162, 0
v_cvt_pk_bf16_f32 v154, v156, v157
v_mfma_f32_16x16x32_bf16 v[184:187], v[88:91], v[192:195], v[184:187]
v_cvt_pk_bf16_f32 v228, v228, v229
v_cvt_pk_bf16_f32 v229, v230, v231
v_mfma_f32_16x16x32_bf16 v[184:187], v[104:107], v[132:135], v[184:187]
ds_write_b64 v246, v[228:229] offset:8
v_mfma_f32_16x16x32_bf16 v[188:191], v[0:3], v[112:115], 0
v_pk_max_i16 v154, v154, 0
v_pk_max_i16 v152, v152, 0
v_mfma_f32_16x16x32_bf16 v[188:191], v[4:7], v[116:119], v[188:191]
v_pk_max_i16 v155, v155, 0
v_add_f32 v249, v249, v250
v_mfma_f32_16x16x32_bf16 v[192:195], v[12:15], v[116:119], 0
buffer_store_dwordx4 v[152:155], v239, s[20:23], s52 offen offset:0 nt
buffer_store_dwordx4 v[160:163], v239, s[20:23], s52 offen offset:64 nt
v_cvt_pk_bf16_f32 v184, v184, v185
v_cvt_pk_bf16_f32 v185, v186, v187
v_rcp_f32 v252, v249
v_max3_f32 v254, v188, v189, v190
v_cvt_pk_bf16_f32 v148, v232, 0
s_add_u32 s52, s46, 16384
v_mfma_f32_16x16x32_bf16 v[192:195], v[8:11], v[112:115], v[192:195]
ds_write_b64 v246, v[184:185] offset:0
v_mfma_f32_16x16x32_bf16 v[200:203], v[16:19], v[112:115], 0
s_nop 0
v_add_u32 v246, 0x200, v246
s_nop 0
v_mfma_f32_16x16x32_bf16 v[200:203], v[20:23], v[116:119], v[200:203]
s_nop 1
v_max3_f32 v254, v254, v191, v192
v_mfma_f32_16x16x32_bf16 v[184:187], v[28:31], v[116:119], 0
v_max3_f32 v254, v254, v193, v194
s_nop 0
v_mfma_f32_16x16x32_bf16 v[184:187], v[24:27], v[112:115], v[184:187]
s_nop 0
v_max3_f32 v254, v254, v195, v200
v_max3_f32 v254, v254, v201, v202
v_mfma_f32_16x16x32_bf16 v[208:211], v[32:35], v[112:115], 0
s_nop 2
v_mfma_f32_16x16x32_bf16 v[208:211], v[36:39], v[116:119], v[208:211]
v_max3_f32 v254, v254, v203, v184
v_max3_f32 v254, v254, v185, v186
v_mfma_f32_16x16x32_bf16 v[216:219], v[44:47], v[116:119], 0
s_nop 2
v_mfma_f32_16x16x32_bf16 v[216:219], v[40:43], v[112:115], v[216:219]
s_nop 0
v_max3_f32 v254, v254, v187, v208
v_max3_f32 v254, v254, v209, v210
v_mfma_f32_16x16x32_bf16 v[220:223], v[48:51], v[112:115], 0
s_nop 2
v_mfma_f32_16x16x32_bf16 v[220:223], v[52:55], v[116:119], v[220:223]
v_max3_f32 v254, v254, v211, v216
v_max3_f32 v254, v254, v217, v218
v_mfma_f32_16x16x32_bf16 v[152:155], a[192:195], v[224:227], 0
s_nop 2
v_mfma_f32_16x16x32_bf16 v[152:155], a[196:199], v[196:199], v[152:155]
s_nop 0
v_max3_f32 v254, v254, v219, v220
v_mfma_f32_16x16x32_bf16 v[152:155], a[200:203], v[212:215], v[152:155]
ds_swizzle_b32 v255, v254 offset:0x401F
v_mfma_f32_16x16x32_bf16 v[152:155], a[204:207], v[204:207], v[152:155]
v_mfma_f32_16x16x32_bf16 v[156:159], a[220:223], v[204:207], 0
v_mfma_f32_16x16x32_bf16 v[156:159], a[216:219], v[212:215], v[156:159]
v_mfma_f32_16x16x32_bf16 v[156:159], a[212:215], v[196:199], v[156:159]
v_mfma_f32_16x16x32_bf16 v[156:159], a[208:211], v[224:227], v[156:159]
v_mfma_f32_16x16x32_bf16 v[160:163], a[224:227], v[224:227], 0
s_waitcnt lgkmcnt(0)
v_max_f32 v254, v254, v255
v_mfma_f32_16x16x32_bf16 v[160:163], a[228:231], v[196:199], v[160:163]
ds_bpermute_b32 v255, v247, v254
v_mfma_f32_16x16x32_bf16 v[160:163], a[232:235], v[212:215], v[160:163]
v_mfma_f32_16x16x32_bf16 v[160:163], a[236:239], v[204:207], v[160:163]
v_mfma_f32_16x16x32_bf16 v[164:167], a[252:255], v[204:207], 0
v_mfma_f32_16x16x32_bf16 v[164:167], a[248:251], v[212:215], v[164:167]
v_mfma_f32_16x16x32_bf16 v[164:167], a[244:247], v[196:199], v[164:167]
v_mfma_f32_16x16x32_bf16 v[164:167], a[240:243], v[224:227], v[164:167]
s_waitcnt lgkmcnt(0)
v_max_f32 v254, v254, v255
v_sub_f32 v188, v188, v254
v_mfma_f32_16x16x32_bf16 v[196:199], v[56:59], v[136:139], 0
v_sub_f32 v190, v190, v254
v_sub_f32 v189, v189, v254
v_mfma_f32_16x16x32_bf16 v[196:199], v[104:107], v[148:151], v[196:199]
v_exp_f32 v189, v189
v_mfma_f32_16x16x32_bf16 v[196:199], v[72:75], v[140:143], v[196:199]
v_exp_f32 v188, v188
v_mfma_f32_16x16x32_bf16 v[196:199], v[88:91], v[144:147], v[196:199]
v_add_f32 v248, v188, v189
v_sub_f32 v191, v191, v254
v_mfma_f32_16x16x32_bf16 v[204:207], v[92:95], v[144:147], 0
v_exp_f32 v191, v191
v_mfma_f32_16x16x32_bf16 v[204:207], v[76:79], v[140:143], v[204:207]
v_exp_f32 v190, v190
v_mfma_f32_16x16x32_bf16 v[204:207], v[106:109], v[148:151], v[204:207]
v_cvt_pk_bf16_f32 v120, v188, v189
v_add_f32 v248, v248, v190
v_mfma_f32_16x16x32_bf16 v[204:207], v[60:63], v[136:139], v[204:207]
ds_read_b128 v[212:215], v236 offset:4224
v_add_f32 v248, v248, v191
v_mfma_f32_16x16x32_bf16 v[228:231], v[64:67], v[136:139], 0
ds_read_b128 v[224:227], v236 offset:4480
v_cvt_pk_bf16_f32 v121, v190, v191
v_mfma_f32_16x16x32_bf16 v[228:231], v[108:111], v[148:151], v[228:231]
v_fmac_f32 v170, v198, v252
v_fmac_f32 v171, v199, v252
v_mfma_f32_16x16x32_bf16 v[228:231], v[80:83], v[140:143], v[228:231]
v_fmac_f32 v168, v196, v252
v_fmac_f32 v169, v197, v252
v_mfma_f32_16x16x32_bf16 v[228:231], v[96:99], v[144:147], v[228:231]
ds_read_b128 v[196:199], v236 offset:4736
v_fmac_f32 v175, v207, v252
v_mfma_f32_16x16x32_bf16 v[232:235], v[100:103], v[144:147], 0
v_fmac_f32 v172, v204, v252
v_fmac_f32 v174, v206, v252
v_mfma_f32_16x16x32_bf16 v[232:235], v[84:87], v[140:143], v[232:235]
s_waitcnt lgkmcnt(2)
v_fmac_f32 v173, v205, v252
v_fmac_f32 v177, v229, v252
v_mfma_f32_16x16x32_bf16 v[232:235], v[110:113], v[148:151], v[232:235]
s_waitcnt lgkmcnt(1)
ds_read_b128 v[204:207], v236 offset:4992
v_fmac_f32 v176, v228, v252
v_mfma_f32_16x16x32_bf16 v[232:235], v[68:71], v[136:139], v[232:235]
v_fmac_f32 v178, v230, v252
v_fmac_f32 v179, v231, v252
v_mfma_f32_16x16x32_bf16 v[188:191], a[0:3], v[212:215], 0
v_cvt_pk_bf16_f32 v176, v176, v177
v_cvt_pk_bf16_f32 v168, v168, v169
v_mfma_f32_16x16x32_bf16 v[188:191], a[4:7], v[224:227], v[188:191]
s_waitcnt lgkmcnt(1)
v_cvt_pk_bf16_f32 v169, v170, v171
v_fmac_f32 v181, v233, v252
v_mfma_f32_16x16x32_bf16 v[188:191], a[8:11], v[196:199], v[188:191]
v_fmac_f32 v182, v234, v252
v_fmac_f32 v180, v232, v252
v_fmac_f32 v183, v235, v252
v_cvt_pk_bf16_f32 v170, v172, v173
v_pk_max_i16 v170, v170, 0
s_waitcnt lgkmcnt(0)
v_mfma_f32_16x16x32_bf16 v[188:191], a[12:15], v[204:207], v[188:191]
v_cvt_pk_bf16_f32 v171, v174, v175
v_pk_max_i16 v176, v176, 0
v_mfma_f32_16x16x32_bf16 v[232:235], a[28:31], v[204:207], 0
v_pk_max_i16 v171, v171, 0
v_cvt_pk_bf16_f32 v177, v178, v179
v_mfma_f32_16x16x32_bf16 v[232:235], a[24:27], v[196:199], v[232:235]
v_cvt_pk_bf16_f32 v178, v180, v181
v_pk_max_i16 v177, v177, 0
v_mfma_f32_16x16x32_bf16 v[232:235], a[20:23], v[224:227], v[232:235]
v_cvt_pk_bf16_f32 v112, v188, v189
v_cvt_pk_bf16_f32 v113, v190, v191
v_mfma_f32_16x16x32_bf16 v[232:235], a[16:19], v[212:215], v[232:235]
v_pk_max_i16 v168, v168, 0
v_cvt_pk_bf16_f32 v179, v182, v183
v_mfma_f32_16x16x32_bf16 v[188:191], a[32:35], v[212:215], 0
v_pk_max_i16 v179, v179, 0
v_pk_max_i16 v169, v169, 0
v_mfma_f32_16x16x32_bf16 v[188:191], a[36:39], v[224:227], v[188:191]
v_pk_max_i16 v178, v178, 0
v_sub_f32 v192, v192, v254
v_mfma_f32_16x16x32_bf16 v[188:191], a[40:43], v[196:199], v[188:191]
buffer_store_dwordx4 v[168:171], v239, s[20:23], s53 offen offset:0 nt
buffer_store_dwordx4 v[176:179], v239, s[20:23], s53 offen offset:64 nt
v_sub_f32 v193, v193, v254
v_exp_f32 v192, v192
v_exp_f32 v193, v193
v_sub_f32 v195, v195, v254
v_exp_f32 v195, v195
v_mfma_f32_16x16x32_bf16 v[188:191], a[44:47], v[204:207], v[188:191]
s_add_u32 s53, s46, 4096
v_add_f32 v248, v248, v192
v_sub_f32 v194, v194, v254
v_mfma_f32_16x16x32_bf16 v[228:231], a[60:63], v[204:207], 0
s_add_u32 s46, s46, 13107200
v_cvt_pk_bf16_f32 v114, v232, v233
v_cvt_pk_bf16_f32 v115, v234, v235
v_mfma_f32_16x16x32_bf16 v[228:231], a[56:59], v[196:199], v[228:231]
v_cvt_pk_bf16_f32 v117, v190, v191
v_cvt_pk_bf16_f32 v116, v188, v189
v_mfma_f32_16x16x32_bf16 v[228:231], a[52:55], v[224:227], v[228:231]
v_exp_f32 v194, v194
v_mfma_f32_16x16x32_bf16 v[228:231], a[48:51], v[212:215], v[228:231]
v_add_f32 v248, v248, v193
v_add_f32 v248, v248, v194
v_mfma_f32_16x16x32_bf16 v[168:171], a[192:195], v[212:215], 0
v_add_f32 v248, v248, v195
v_cvt_pk_bf16_f32 v122, v192, v193
v_mfma_f32_16x16x32_bf16 v[168:171], a[196:199], v[224:227], v[168:171]
v_cvt_pk_bf16_f32 v123, v194, v195
v_sub_f32 v201, v201, v254
v_mfma_f32_16x16x32_bf16 v[168:171], a[200:203], v[196:199], v[168:171]
v_cvt_pk_bf16_f32 v119, v230, v231
v_cvt_pk_bf16_f32 v118, v228, v229
v_mfma_f32_16x16x32_bf16 v[168:171], a[204:207], v[204:207], v[168:171]
v_sub_f32 v202, v202, v254
v_sub_f32 v200, v200, v254
v_mfma_f32_16x16x32_bf16 v[172:175], a[220:223], v[204:207], 0
v_exp_f32 v200, v200
v_mfma_f32_16x16x32_bf16 v[172:175], a[216:219], v[196:199], v[172:175]
v_exp_f32 v202, v202
v_mfma_f32_16x16x32_bf16 v[172:175], a[212:215], v[224:227], v[172:175]
v_exp_f32 v201, v201
v_mfma_f32_16x16x32_bf16 v[172:175], a[208:211], v[212:215], v[172:175]
v_sub_f32 v203, v203, v254
v_add_f32 v248, v248, v200
v_mfma_f32_16x16x32_bf16 v[176:179], a[224:227], v[212:215], 0
v_exp_f32 v203, v203
v_mfma_f32_16x16x32_bf16 v[176:179], a[228:231], v[224:227], v[176:179]
v_cvt_pk_bf16_f32 v125, v202, v203
v_add_f32 v248, v248, v201
v_mfma_f32_16x16x32_bf16 v[176:179], a[232:235], v[196:199], v[176:179]
v_add_f32 v248, v248, v202
v_cvt_pk_bf16_f32 v124, v200, v201
v_mfma_f32_16x16x32_bf16 v[176:179], a[236:239], v[204:207], v[176:179]
v_add_f32 v248, v248, v203
v_sub_f32 v184, v184, v254
v_mfma_f32_16x16x32_bf16 v[180:183], a[252:255], v[204:207], 0
v_sub_f32 v185, v185, v254
v_sub_f32 v187, v187, v254
v_mfma_f32_16x16x32_bf16 v[180:183], a[248:251], v[196:199], v[180:183]
v_sub_f32 v186, v186, v254
v_sub_f32 v220, v220, v254
v_mfma_f32_16x16x32_bf16 v[180:183], a[244:247], v[224:227], v[180:183]
v_exp_f32 v184, v184
v_mfma_f32_16x16x32_bf16 v[180:183], a[240:243], v[212:215], v[180:183]
v_add_f32 v248, v248, v184
v_sub_f32 v216, v216, v254
v_mfma_f32_16x16x32_bf16 v[188:191], v[0:3], v[112:115], 0
v_exp_f32 v187, v187
v_mfma_f32_16x16x32_bf16 v[188:191], v[4:7], v[116:119], v[188:191]
v_exp_f32 v186, v186
v_mfma_f32_16x16x32_bf16 v[192:195], v[12:15], v[116:119], 0
v_exp_f32 v185, v185
v_mfma_f32_16x16x32_bf16 v[192:195], v[8:11], v[112:115], v[192:195]
v_add_f32 v248, v248, v185
v_add_f32 v248, v248, v186
v_mfma_f32_16x16x32_bf16 v[196:199], v[16:19], v[112:115], 0
v_add_f32 v248, v248, v187
v_cvt_pk_bf16_f32 v127, v186, v187
v_mfma_f32_16x16x32_bf16 v[196:199], v[20:23], v[116:119], v[196:199]
v_cvt_pk_bf16_f32 v126, v184, v185
v_sub_f32 v218, v218, v254
v_mfma_f32_16x16x32_bf16 v[200:203], v[28:31], v[116:119], 0
v_exp_f32 v220, v220
v_mfma_f32_16x16x32_bf16 v[200:203], v[24:27], v[112:115], v[200:203]
v_cvt_pk_bf16_f32 v132, v220, 0
v_sub_f32 v217, v217, v254
v_mfma_f32_16x16x32_bf16 v[204:207], v[32:35], v[112:115], 0
v_sub_f32 v211, v211, v254
v_sub_f32 v210, v210, v254
v_mfma_f32_16x16x32_bf16 v[204:207], v[36:39], v[116:119], v[204:207]
v_sub_f32 v219, v219, v254
v_sub_f32 v208, v208, v254
v_mfma_f32_16x16x32_bf16 v[212:215], v[44:47], v[116:119], 0
v_sub_f32 v209, v209, v254
v_max3_f32 v254, v188, v189, v190
v_mfma_f32_16x16x32_bf16 v[212:215], v[40:43], v[112:115], v[212:215]
v_exp_f32 v209, v209
v_mfma_f32_16x16x32_bf16 v[224:227], v[48:51], v[112:115], 0
v_exp_f32 v208, v208
v_mfma_f32_16x16x32_bf16 v[224:227], v[52:55], v[116:119], v[224:227]
v_exp_f32 v217, v217
v_mfma_f32_16x16x32_bf16 v[184:187], v[56:59], v[120:123], 0
v_exp_f32 v210, v210
v_mfma_f32_16x16x32_bf16 v[184:187], v[104:107], v[132:135], v[184:187]
v_exp_f32 v218, v218
v_mfma_f32_16x16x32_bf16 v[184:187], v[72:75], v[124:127], v[184:187]
v_exp_f32 v211, v211
v_exp_f32 v216, v216
v_exp_f32 v219, v219
v_cvt_pk_bf16_f32 v129, v210, v211
v_cvt_pk_bf16_f32 v131, v218, v219
v_cvt_pk_bf16_f32 v130, v216, v217
v_cvt_pk_bf16_f32 v128, v208, v209
v_add_f32 v248, v248, v208
v_add_f32 v248, v248, v209
v_mfma_f32_16x16x32_bf16 v[184:187], v[88:91], v[128:131], v[184:187]
v_add_f32 v248, v248, v210
v_add_f32 v248, v248, v211
v_mfma_f32_16x16x32_bf16 v[208:211], v[92:95], v[128:131], 0
v_max3_f32 v254, v254, v191, v192
v_max3_f32 v254, v254, v193, v194
v_mfma_f32_16x16x32_bf16 v[208:211], v[76:79], v[124:127], v[208:211]
v_max3_f32 v254, v254, v195, v196
v_max3_f32 v254, v254, v197, v198
v_mfma_f32_16x16x32_bf16 v[208:211], v[106:109], v[132:135], v[208:211]
v_max3_f32 v254, v254, v199, v200
v_max3_f32 v254, v254, v201, v202
v_mfma_f32_16x16x32_bf16 v[208:211], v[60:63], v[120:123], v[208:211]
v_max3_f32 v254, v254, v203, v204
v_max3_f32 v254, v254, v205, v206
v_mfma_f32_16x16x32_bf16 v[228:231], v[64:67], v[120:123], 0
v_max3_f32 v254, v254, v207, v212
v_max3_f32 v254, v254, v213, v214
v_mfma_f32_16x16x32_bf16 v[228:231], v[108:111], v[132:135], v[228:231]
v_max3_f32 v254, v254, v215, v224
v_add_f32 v248, v248, v216
v_mfma_f32_16x16x32_bf16 v[228:231], v[80:83], v[124:127], v[228:231]
ds_swizzle_b32 v255, v254 offset:0x401F
v_add_f32 v248, v248, v217
v_mfma_f32_16x16x32_bf16 v[228:231], v[96:99], v[128:131], v[228:231]
v_add_f32 v248, v248, v218
v_add_f32 v248, v248, v219
v_mfma_f32_16x16x32_bf16 v[232:235], v[100:103], v[128:131], 0
ds_read_b128 v[216:219], v236 offset:8448
v_add_f32 v248, v248, v220
v_mfma_f32_16x16x32_bf16 v[232:235], v[84:87], v[124:127], v[232:235]
ds_read_b128 v[220:223], v236 offset:8704
ds_swizzle_b32 v250, v248 offset:0x401F
v_mfma_f32_16x16x32_bf16 v[232:235], v[110:113], v[132:135], v[232:235]
v_mfma_f32_16x16x32_bf16 v[232:235], v[68:71], v[120:123], v[232:235]
s_waitcnt lgkmcnt(3)
v_max_f32 v254, v254, v255
ds_bpermute_b32 v255, v247, v254
s_waitcnt lgkmcnt(1)
v_add_f32 v248, v248, v250
ds_bpermute_b32 v250, v247, v248
s_waitcnt lgkmcnt(1)
v_max_f32 v254, v254, v255
v_sub_f32 v188, v188, v254
v_exp_f32 v188, v188
v_sub_f32 v189, v189, v254
v_sub_f32 v190, v190, v254
v_sub_f32 v191, v191, v254
v_exp_f32 v189, v189
v_exp_f32 v191, v191
v_exp_f32 v190, v190
v_add_f32 v249, v188, v189
v_add_f32 v249, v249, v190
v_add_f32 v249, v249, v191
v_cvt_pk_bf16_f32 v137, v190, v191
v_cvt_pk_bf16_f32 v136, v188, v189
v_mfma_f32_16x16x32_bf16 v[188:191], a[0:3], v[216:219], 0
s_waitcnt lgkmcnt(0)
v_sub_f32 v192, v192, v254
v_sub_f32 v195, v195, v254
v_mfma_f32_16x16x32_bf16 v[188:191], a[4:7], v[220:223], v[188:191]
v_exp_f32 v192, v192
v_sub_f32 v193, v193, v254
v_sub_f32 v194, v194, v254
v_exp_f32 v195, v195
v_exp_f32 v193, v193
v_exp_f32 v194, v194
v_add_f32 v249, v249, v192
v_add_f32 v249, v249, v193
v_add_f32 v249, v249, v194
v_add_f32 v249, v249, v195
v_cvt_pk_bf16_f32 v139, v194, v195
v_cvt_pk_bf16_f32 v138, v192, v193
ds_read_b128 v[192:195], v236 offset:8960
v_sub_f32 v198, v198, v254
v_sub_f32 v197, v197, v254
v_sub_f32 v196, v196, v254
v_exp_f32 v196, v196
v_exp_f32 v198, v198
v_sub_f32 v202, v202, v254
v_sub_f32 v200, v200, v254
v_exp_f32 v197, v197
v_sub_f32 v201, v201, v254
v_sub_f32 v199, v199, v254
v_exp_f32 v199, v199
v_exp_f32 v200, v200
v_add_f32 v249, v249, v196
v_add_f32 v249, v249, v197
v_add_f32 v249, v249, v198
s_waitcnt lgkmcnt(0)
v_mfma_f32_16x16x32_bf16 v[188:191], a[8:11], v[192:195], v[188:191]
v_sub_f32 v203, v203, v254
v_add_f32 v249, v249, v199
v_add_f32 v249, v249, v200
v_exp_f32 v201, v201
v_exp_f32 v202, v202
v_exp_f32 v203, v203
v_sub_f32 v204, v204, v254
v_exp_f32 v204, v204
v_add_f32 v249, v249, v201
v_add_f32 v249, v249, v202
v_add_f32 v249, v249, v203
v_sub_f32 v205, v205, v254
v_sub_f32 v206, v206, v254
v_exp_f32 v205, v205
v_exp_f32 v206, v206
v_add_f32 v249, v249, v204
v_add_f32 v249, v249, v205
v_sub_f32 v207, v207, v254
v_exp_f32 v207, v207
v_add_f32 v249, v249, v206
v_add_f32 v249, v249, v207
v_cvt_pk_bf16_f32 v145, v206, v207
v_cvt_pk_bf16_f32 v144, v204, v205
ds_read_b128 v[204:207], v236 offset:9216
v_add_f32 v248, v248, v250
v_rcp_f32 v251, v248
v_sub_f32 v212, v212, v254
v_fmac_f32 v152, v184, v251
v_fmac_f32 v153, v185, v251
v_fmac_f32 v155, v187, v251
v_fmac_f32 v154, v186, v251
v_fmac_f32 v157, v209, v251
v_fmac_f32 v159, v211, v251
v_fmac_f32 v158, v210, v251
v_fmac_f32 v156, v208, v251
v_exp_f32 v212, v212
v_sub_f32 v213, v213, v254
v_exp_f32 v213, v213
v_sub_f32 v214, v214, v254
v_exp_f32 v214, v214
s_waitcnt lgkmcnt(0)
v_mfma_f32_16x16x32_bf16 v[188:191], a[12:15], v[204:207], v[188:191]
v_sub_f32 v215, v215, v254
v_add_f32 v249, v249, v212
v_mfma_f32_16x16x32_bf16 v[184:187], a[28:31], v[204:207], 0
v_exp_f32 v215, v215
v_mfma_f32_16x16x32_bf16 v[184:187], a[24:27], v[192:195], v[184:187]
v_add_f32 v249, v249, v213
v_add_f32 v249, v249, v214
v_mfma_f32_16x16x32_bf16 v[184:187], a[20:23], v[220:223], v[184:187]
v_add_f32 v249, v249, v215
v_cvt_pk_bf16_f32 v147, v214, v215
v_mfma_f32_16x16x32_bf16 v[184:187], a[16:19], v[216:219], v[184:187]
v_cvt_pk_bf16_f32 v146, v212, v213
v_fmac_f32 v163, v231, v251
v_mfma_f32_16x16x32_bf16 v[208:211], a[32:35], v[216:219], 0
v_fmac_f32 v161, v229, v251
v_cvt_pk_bf16_f32 v152, v152, v153
v_mfma_f32_16x16x32_bf16 v[208:211], a[36:39], v[220:223], v[208:211]
v_fmac_f32 v167, v235, v251
v_fmac_f32 v160, v228, v251
v_mfma_f32_16x16x32_bf16 v[208:211], a[40:43], v[192:195], v[208:211]
v_fmac_f32 v164, v232, v251
v_cvt_pk_bf16_f32 v160, v160, v161
v_mfma_f32_16x16x32_bf16 v[208:211], a[44:47], v[204:207], v[208:211]
v_cvt_pk_bf16_f32 v153, v154, v155
v_cvt_pk_bf16_f32 v154, v156, v157
v_mfma_f32_16x16x32_bf16 v[212:215], a[60:63], v[204:207], 0
v_fmac_f32 v166, v234, v251
v_fmac_f32 v162, v230, v251
v_mfma_f32_16x16x32_bf16 v[212:215], a[56:59], v[192:195], v[212:215]
v_fmac_f32 v165, v233, v251
v_cvt_pk_bf16_f32 v155, v158, v159
v_mfma_f32_16x16x32_bf16 v[212:215], a[52:55], v[220:223], v[212:215]
v_cvt_pk_bf16_f32 v161, v162, v163
v_cvt_pk_bf16_f32 v162, v164, v165
v_mfma_f32_16x16x32_bf16 v[212:215], a[48:51], v[216:219], v[212:215]
v_cvt_pk_bf16_f32 v163, v166, v167
v_pk_max_i16 v162, v162, 0
v_pk_max_i16 v161, v161, 0
v_pk_max_i16 v163, v163, 0
v_pk_max_i16 v153, v153, 0
v_pk_max_i16 v155, v155, 0
v_pk_max_i16 v152, v152, 0
v_pk_max_i16 v160, v160, 0
v_pk_max_i16 v154, v154, 0
buffer_store_dwordx4 v[152:155], v239, s[20:23], s52 offen offset:0 nt
buffer_store_dwordx4 v[160:163], v239, s[20:23], s52 offen offset:64 nt
v_cvt_pk_bf16_f32 v112, v188, v189
v_cvt_pk_bf16_f32 v113, v190, v191
v_cvt_pk_bf16_f32 v114, v184, v185
v_cvt_pk_bf16_f32 v115, v186, v187
v_cvt_pk_bf16_f32 v118, v212, v213
v_cvt_pk_bf16_f32 v119, v214, v215
v_cvt_pk_bf16_f32 v116, v208, v209
v_cvt_pk_bf16_f32 v117, v210, v211
v_mfma_f32_16x16x32_bf16 v[152:155], a[192:195], v[216:219], 0
v_sub_f32 v224, v224, v254
v_cvt_pk_bf16_f32 v142, v200, v201
v_mfma_f32_16x16x32_bf16 v[152:155], a[196:199], v[220:223], v[152:155]
v_exp_f32 v224, v224
v_mfma_f32_16x16x32_bf16 v[152:155], a[200:203], v[192:195], v[152:155]
v_cvt_pk_bf16_f32 v141, v198, v199
v_cvt_pk_bf16_f32 v140, v196, v197
v_mfma_f32_16x16x32_bf16 v[152:155], a[204:207], v[204:207], v[152:155]
v_add_f32 v249, v249, v224
v_cvt_pk_bf16_f32 v143, v202, v203
v_mfma_f32_16x16x32_bf16 v[156:159], a[220:223], v[204:207], 0
ds_swizzle_b32 v250, v249 offset:0x401F
v_cvt_pk_bf16_f32 v148, v224, 0
v_mfma_f32_16x16x32_bf16 v[156:159], a[216:219], v[192:195], v[156:159]
v_mfma_f32_16x16x32_bf16 v[156:159], a[212:215], v[220:223], v[156:159]
v_mfma_f32_16x16x32_bf16 v[156:159], a[208:211], v[216:219], v[156:159]
v_mfma_f32_16x16x32_bf16 v[160:163], a[224:227], v[216:219], 0
v_mfma_f32_16x16x32_bf16 v[160:163], a[228:231], v[220:223], v[160:163]
v_mfma_f32_16x16x32_bf16 v[160:163], a[232:235], v[192:195], v[160:163]
s_waitcnt lgkmcnt(0)
v_add_f32 v249, v249, v250
v_mfma_f32_16x16x32_bf16 v[160:163], a[236:239], v[204:207], v[160:163]
ds_bpermute_b32 v250, v247, v249
v_mfma_f32_16x16x32_bf16 v[164:167], a[252:255], v[204:207], 0
v_mfma_f32_16x16x32_bf16 v[164:167], a[248:251], v[192:195], v[164:167]
v_mfma_f32_16x16x32_bf16 v[164:167], a[244:247], v[220:223], v[164:167]
v_mfma_f32_16x16x32_bf16 v[164:167], a[240:243], v[216:219], v[164:167]
v_mfma_f32_16x16x32_bf16 v[184:187], v[0:3], v[112:115], 0
v_mfma_f32_16x16x32_bf16 v[184:187], v[4:7], v[116:119], v[184:187]
s_waitcnt lgkmcnt(0)
v_add_f32 v249, v249, v250
s_nop 0
v_mfma_f32_16x16x32_bf16 v[188:191], v[12:15], v[116:119], 0
v_rcp_f32 v252, v249
v_mfma_f32_16x16x32_bf16 v[188:191], v[8:11], v[112:115], v[188:191]
s_nop 1
v_max3_f32 v254, v184, v185, v186
v_mfma_f32_16x16x32_bf16 v[192:195], v[16:19], v[112:115], 0
s_nop 2
v_mfma_f32_16x16x32_bf16 v[192:195], v[20:23], v[116:119], v[192:195]
v_max3_f32 v254, v254, v187, v188
v_max3_f32 v254, v254, v189, v190
v_mfma_f32_16x16x32_bf16 v[196:199], v[28:31], v[116:119], 0
s_nop 2
v_mfma_f32_16x16x32_bf16 v[196:199], v[24:27], v[112:115], v[196:199]
s_nop 0
v_max3_f32 v254, v254, v191, v192
v_max3_f32 v254, v254, v193, v194
v_mfma_f32_16x16x32_bf16 v[200:203], v[32:35], v[112:115], 0
s_nop 2
v_mfma_f32_16x16x32_bf16 v[200:203], v[36:39], v[116:119], v[200:203]
v_max3_f32 v254, v254, v195, v196
v_max3_f32 v254, v254, v197, v198
v_mfma_f32_16x16x32_bf16 v[204:207], v[44:47], v[116:119], 0
s_nop 2
v_mfma_f32_16x16x32_bf16 v[204:207], v[40:43], v[112:115], v[204:207]
s_nop 0
v_max3_f32 v254, v254, v199, v200
v_max3_f32 v254, v254, v201, v202
v_mfma_f32_16x16x32_bf16 v[208:211], v[48:51], v[112:115], 0
s_nop 2
v_mfma_f32_16x16x32_bf16 v[208:211], v[52:55], v[116:119], v[208:211]
v_max3_f32 v254, v254, v203, v204
v_max3_f32 v254, v254, v205, v206
v_mfma_f32_16x16x32_bf16 v[212:215], v[56:59], v[136:139], 0
s_nop 2
v_mfma_f32_16x16x32_bf16 v[212:215], v[104:107], v[148:151], v[212:215]
s_nop 0
v_max3_f32 v254, v254, v207, v208
v_mfma_f32_16x16x32_bf16 v[212:215], v[72:75], v[140:143], v[212:215]
ds_swizzle_b32 v255, v254 offset:0x401F
v_mfma_f32_16x16x32_bf16 v[212:215], v[88:91], v[144:147], v[212:215]
s_nop 2
v_mfma_f32_16x16x32_bf16 v[216:219], v[92:95], v[144:147], 0
s_nop 2
v_mfma_f32_16x16x32_bf16 v[216:219], v[76:79], v[140:143], v[216:219]
v_fmac_f32 v169, v213, v252
v_fmac_f32 v168, v212, v252
v_mfma_f32_16x16x32_bf16 v[216:219], v[106:109], v[148:151], v[216:219]
v_fmac_f32 v171, v215, v252
v_fmac_f32 v170, v214, v252
v_mfma_f32_16x16x32_bf16 v[216:219], v[60:63], v[136:139], v[216:219]
ds_read_b128 v[220:223], v236 offset:12672
ds_read_b128 v[224:227], v236 offset:12928
v_mfma_f32_16x16x32_bf16 v[228:231], v[64:67], v[136:139], 0
s_waitcnt lgkmcnt(2)
ds_read_b128 v[212:215], v236 offset:13184
v_cvt_pk_bf16_f32 v168, v168, v169
v_mfma_f32_16x16x32_bf16 v[228:231], v[108:111], v[148:151], v[228:231]
s_nop 0
v_fmac_f32 v172, v216, v252
v_fmac_f32 v174, v218, v252
v_mfma_f32_16x16x32_bf16 v[228:231], v[80:83], v[140:143], v[228:231]
v_fmac_f32 v173, v217, v252
v_fmac_f32 v175, v219, v252
v_mfma_f32_16x16x32_bf16 v[228:231], v[96:99], v[144:147], v[228:231]
ds_read_b128 v[216:219], v236 offset:13440
v_cvt_pk_bf16_f32 v169, v170, v171
v_mfma_f32_16x16x32_bf16 v[232:235], v[100:103], v[144:147], 0
v_cvt_pk_bf16_f32 v170, v172, v173
v_cvt_pk_bf16_f32 v171, v174, v175
v_mfma_f32_16x16x32_bf16 v[232:235], v[84:87], v[140:143], v[232:235]
s_waitcnt lgkmcnt(2)
v_pk_max_i16 v170, v170, 0
v_fmac_f32 v178, v230, v252
v_mfma_f32_16x16x32_bf16 v[232:235], v[110:113], v[148:151], v[232:235]
s_waitcnt lgkmcnt(1)
v_fmac_f32 v179, v231, v252
v_fmac_f32 v176, v228, v252
v_mfma_f32_16x16x32_bf16 v[232:235], v[68:71], v[136:139], v[232:235]
v_fmac_f32 v177, v229, v252
v_cvt_pk_bf16_f32 v176, v176, v177
v_mfma_f32_16x16x32_bf16 v[228:231], a[0:3], v[220:223], 0
v_cvt_pk_bf16_f32 v177, v178, v179
v_pk_max_i16 v169, v169, 0
v_mfma_f32_16x16x32_bf16 v[228:231], a[4:7], v[224:227], v[228:231]
s_waitcnt lgkmcnt(0)
v_pk_max_i16 v171, v171, 0
v_fmac_f32 v182, v234, v252
v_mfma_f32_16x16x32_bf16 v[228:231], a[8:11], v[212:215], v[228:231]
v_fmac_f32 v181, v233, v252
v_fmac_f32 v183, v235, v252
v_mfma_f32_16x16x32_bf16 v[228:231], a[12:15], v[216:219], v[228:231]
v_fmac_f32 v180, v232, v252
v_cvt_pk_bf16_f32 v179, v182, v183
v_mfma_f32_16x16x32_bf16 v[232:235], a[28:31], v[216:219], 0
v_cvt_pk_bf16_f32 v178, v180, v181
v_pk_max_i16 v178, v178, 0
v_mfma_f32_16x16x32_bf16 v[232:235], a[24:27], v[212:215], v[232:235]
v_pk_max_i16 v179, v179, 0
v_pk_max_i16 v176, v176, 0
v_mfma_f32_16x16x32_bf16 v[232:235], a[20:23], v[224:227], v[232:235]
v_cvt_pk_bf16_f32 v113, v230, v231
v_cvt_pk_bf16_f32 v112, v228, v229
v_mfma_f32_16x16x32_bf16 v[232:235], a[16:19], v[220:223], v[232:235]
v_pk_max_i16 v168, v168, 0
v_pk_max_i16 v177, v177, 0
v_mfma_f32_16x16x32_bf16 v[228:231], a[32:35], v[220:223], 0
buffer_store_dwordx4 v[168:171], v239, s[20:23], s53 offen offset:0 nt
buffer_store_dwordx4 v[176:179], v239, s[20:23], s53 offen offset:64 nt
v_add_u32 v236, s56, v236
v_max_f32 v254, v254, v255
s_sub_u32 s56, 0, s56
v_cvt_pk_bf16_f32 v115, v234, v235
v_cvt_pk_bf16_f32 v114, v232, v233
v_mfma_f32_16x16x32_bf16 v[228:231], a[36:39], v[224:227], v[228:231]
ds_bpermute_b32 v255, v247, v254
v_mfma_f32_16x16x32_bf16 v[228:231], a[40:43], v[212:215], v[228:231]
v_mfma_f32_16x16x32_bf16 v[228:231], a[44:47], v[216:219], v[228:231]
s_nop 2
v_mfma_f32_16x16x32_bf16 v[232:235], a[60:63], v[216:219], 0
s_nop 2
v_mfma_f32_16x16x32_bf16 v[232:235], a[56:59], v[212:215], v[232:235]
v_cvt_pk_bf16_f32 v116, v228, v229
v_cvt_pk_bf16_f32 v117, v230, v231
v_mfma_f32_16x16x32_bf16 v[232:235], a[52:55], v[224:227], v[232:235]
v_mfma_f32_16x16x32_bf16 v[232:235], a[48:51], v[220:223], v[232:235]
s_waitcnt lgkmcnt(0)
v_max_f32 v254, v254, v255
v_sub_f32 v184, v184, v254
v_mfma_f32_16x16x32_bf16 v[168:171], a[192:195], v[220:223], 0
v_exp_f32 v184, v184
v_mfma_f32_16x16x32_bf16 v[168:171], a[196:199], v[224:227], v[168:171]
v_sub_f32 v185, v185, v254
v_sub_f32 v186, v186, v254
v_mfma_f32_16x16x32_bf16 v[168:171], a[200:203], v[212:215], v[168:171]
v_cvt_pk_bf16_f32 v119, v234, v235
v_cvt_pk_bf16_f32 v118, v232, v233
v_mfma_f32_16x16x32_bf16 v[168:171], a[204:207], v[216:219], v[168:171]
v_exp_f32 v186, v186
v_mfma_f32_16x16x32_bf16 v[172:175], a[220:223], v[216:219], 0
v_exp_f32 v185, v185
v_mfma_f32_16x16x32_bf16 v[172:175], a[216:219], v[212:215], v[172:175]
v_sub_f32 v189, v189, v254
v_sub_f32 v187, v187, v254
v_mfma_f32_16x16x32_bf16 v[172:175], a[212:215], v[224:227], v[172:175]
v_sub_f32 v188, v188, v254
v_sub_f32 v190, v190, v254
v_mfma_f32_16x16x32_bf16 v[172:175], a[208:211], v[220:223], v[172:175]
s_cmp_lg_u32 s45, 0
s_cbranch_scc1 L_loops
v_mfma_f32_16x16x32_bf16 v[176:179], a[224:227], v[220:223], 0
s_waitcnt vmcnt(8)
s_barrier
v_mfma_f32_16x16x32_bf16 v[176:179], a[228:231], v[224:227], v[176:179]
s_add_u32 s52, s47, 8192
ds_read_b128 v[232:235], v236 offset:0
v_add_f32 v248, v184, v185
v_mfma_f32_16x16x32_bf16 v[176:179], a[232:235], v[212:215], v[176:179]
s_add_u32 s53, s47, 12288
v_exp_f32 v188, v188
v_mfma_f32_16x16x32_bf16 v[176:179], a[236:239], v[216:219], v[176:179]
v_add_f32 v248, v248, v186
v_sub_f32 v191, v191, v254
v_mfma_f32_16x16x32_bf16 v[180:183], a[252:255], v[216:219], 0
v_exp_f32 v187, v187
v_mfma_f32_16x16x32_bf16 v[180:183], a[248:251], v[212:215], v[180:183]
v_exp_f32 v190, v190
v_mfma_f32_16x16x32_bf16 v[180:183], a[244:247], v[224:227], v[180:183]
v_add_f32 v248, v248, v187
v_add_f32 v248, v248, v188
v_mfma_f32_16x16x32_bf16 v[180:183], a[240:243], v[220:223], v[180:183]
s_waitcnt lgkmcnt(0)
v_exp_f32 v189, v189
v_mfma_f32_16x16x32_bf16 v[228:231], v[0:3], v[112:115], 0
v_add_f32 v248, v248, v189
v_add_f32 v248, v248, v190
v_mfma_f32_16x16x32_bf16 v[228:231], v[4:7], v[116:119], v[228:231]
v_exp_f32 v191, v191
v_cvt_pk_bf16_f32 v122, v188, v189
v_add_f32 v248, v248, v191
v_cvt_pk_bf16_f32 v123, v190, v191
v_mfma_f32_16x16x32_bf16 v[188:191], v[12:15], v[116:119], 0
v_sub_f32 v193, v193, v254
v_sub_f32 v194, v194, v254
v_mfma_f32_16x16x32_bf16 v[188:191], v[8:11], v[112:115], v[188:191]
v_sub_f32 v195, v195, v254
v_exp_f32 v194, v194
v_sub_f32 v192, v192, v254
v_exp_f32 v192, v192
v_sub_f32 v196, v196, v254
v_exp_f32 v193, v193
v_sub_f32 v197, v197, v254
v_sub_f32 v199, v199, v254
v_sub_f32 v198, v198, v254
v_exp_f32 v195, v195
v_add_f32 v248, v248, v192
v_add_f32 v248, v248, v193
v_exp_f32 v196, v196
v_exp_f32 v197, v197
v_add_f32 v248, v248, v194
v_add_f32 v248, v248, v195
v_add_f32 v248, v248, v196
v_add_f32 v248, v248, v197
v_exp_f32 v198, v198
v_sub_f32 v200, v200, v254
v_sub_f32 v203, v203, v254
v_exp_f32 v199, v199
v_sub_f32 v201, v201, v254
v_exp_f32 v201, v201
v_sub_f32 v202, v202, v254
v_exp_f32 v202, v202
v_add_f32 v248, v248, v198
v_exp_f32 v200, v200
v_add_f32 v248, v248, v199
v_add_f32 v248, v248, v200
v_add_f32 v248, v248, v201
v_exp_f32 v203, v203
v_add_f32 v248, v248, v202
v_add_f32 v248, v248, v203
v_cvt_pk_bf16_f32 v128, v200, v201
v_cvt_pk_bf16_f32 v129, v202, v203
v_mfma_f32_16x16x32_bf16 v[200:203], v[16:19], v[112:115], 0
v_sub_f32 v204, v204, v254
v_sub_f32 v205, v205, v254
v_mfma_f32_16x16x32_bf16 v[200:203], v[20:23], v[116:119], v[200:203]
v_exp_f32 v204, v204
v_sub_f32 v206, v206, v254
v_add_f32 v248, v248, v204
v_exp_f32 v206, v206
v_sub_f32 v207, v207, v254
v_exp_f32 v205, v205
v_exp_f32 v207, v207
v_add_f32 v248, v248, v205
v_add_f32 v248, v248, v206
v_add_f32 v248, v248, v207
v_cvt_pk_bf16_f32 v130, v204, v205
v_cvt_pk_bf16_f32 v131, v206, v207
v_mfma_f32_16x16x32_bf16 v[204:207], v[28:31], v[116:119], 0
v_sub_f32 v208, v208, v254
v_cvt_pk_bf16_f32 v120, v184, v185
v_mfma_f32_16x16x32_bf16 v[204:207], v[24:27], v[112:115], v[204:207]
v_exp_f32 v208, v208
s_nop 0
v_add_f32 v248, v248, v208
v_cvt_pk_bf16_f32 v132, v208, 0
v_mfma_f32_16x16x32_bf16 v[208:211], v[32:35], v[112:115], 0
ds_swizzle_b32 v250, v248 offset:0x401F
v_cvt_pk_bf16_f32 v121, v186, v187
v_mfma_f32_16x16x32_bf16 v[208:211], v[36:39], v[116:119], v[208:211]
ds_read_b128 v[184:187], v236 offset:256
v_cvt_pk_bf16_f32 v126, v196, v197
v_mfma_f32_16x16x32_bf16 v[212:215], v[44:47], v[116:119], 0
v_cvt_pk_bf16_f32 v125, v194, v195
v_cvt_pk_bf16_f32 v127, v198, v199
v_mfma_f32_16x16x32_bf16 v[212:215], v[40:43], v[112:115], v[212:215]
ds_read_b128 v[196:199], v236 offset:768
v_cvt_pk_bf16_f32 v124, v192, v193
v_mfma_f32_16x16x32_bf16 v[216:219], v[48:51], v[112:115], 0
ds_read_b128 v[192:195], v236 offset:512
v_max3_f32 v254, v228, v229, v230
v_mfma_f32_16x16x32_bf16 v[216:219], v[52:55], v[116:119], v[216:219]
v_max3_f32 v254, v254, v231, v188
v_max3_f32 v254, v254, v189, v190
v_mfma_f32_16x16x32_bf16 v[220:223], v[56:59], v[120:123], 0
s_waitcnt lgkmcnt(3)
v_add_f32 v248, v248, v250
v_max3_f32 v254, v254, v191, v200
v_mfma_f32_16x16x32_bf16 v[220:223], v[104:107], v[132:135], v[220:223]
s_waitcnt lgkmcnt(2)
ds_bpermute_b32 v250, v247, v248
v_mfma_f32_16x16x32_bf16 v[220:223], v[72:75], v[124:127], v[220:223]
v_max3_f32 v254, v254, v201, v202
v_max3_f32 v254, v254, v203, v204
v_mfma_f32_16x16x32_bf16 v[220:223], v[88:91], v[128:131], v[220:223]
s_waitcnt lgkmcnt(2)
v_max3_f32 v254, v254, v205, v206
v_max3_f32 v254, v254, v207, v208
v_mfma_f32_16x16x32_bf16 v[224:227], v[92:95], v[128:131], 0
s_waitcnt lgkmcnt(1)
v_max3_f32 v254, v254, v209, v210
v_max3_f32 v254, v254, v211, v212
v_mfma_f32_16x16x32_bf16 v[224:227], v[76:79], v[124:127], v[224:227]
v_max3_f32 v254, v254, v213, v214
v_max3_f32 v254, v254, v215, v216
v_mfma_f32_16x16x32_bf16 v[224:227], v[106:109], v[132:135], v[224:227]
ds_swizzle_b32 v255, v254 offset:0x401F
v_mbcnt_lo_u32_b32 v242, -1, 0
v_mfma_f32_16x16x32_bf16 v[224:227], v[60:63], v[120:123], v[224:227]
s_waitcnt lgkmcnt(1)
v_add_f32 v248, v248, v250
v_rcp_f32 v251, v248
s_nop 0
v_fmac_f32 v152, v220, v251
v_fmac_f32 v153, v221, v251
v_fmac_f32 v154, v222, v251
v_fmac_f32 v155, v223, v251
v_mfma_f32_16x16x32_bf16 v[220:223], v[64:67], v[120:123], 0
v_fmac_f32 v156, v224, v251
v_fmac_f32 v157, v225, v251
v_mfma_f32_16x16x32_bf16 v[220:223], v[108:111], v[132:135], v[220:223]
v_fmac_f32 v158, v226, v251
v_fmac_f32 v159, v227, v251
v_mfma_f32_16x16x32_bf16 v[220:223], v[80:83], v[124:127], v[220:223]
s_waitcnt lgkmcnt(0)
v_cvt_pk_bf16_f32 v152, v152, v153
v_cvt_pk_bf16_f32 v153, v154, v155
v_mfma_f32_16x16x32_bf16 v[220:223], v[96:99], v[128:131], v[220:223]
v_cvt_pk_bf16_f32 v154, v156, v157
v_cvt_pk_bf16_f32 v155, v158, v159
v_mfma_f32_16x16x32_bf16 v[224:227], v[100:103], v[128:131], 0
v_pk_max_i16 v152, v152, 0
v_pk_max_i16 v153, v153, 0
v_mfma_f32_16x16x32_bf16 v[224:227], v[84:87], v[124:127], v[224:227]
v_max_f32 v254, v254, v255
v_pk_max_i16 v154, v154, 0
v_mfma_f32_16x16x32_bf16 v[224:227], v[110:113], v[132:135], v[224:227]
ds_bpermute_b32 v255, v247, v254
v_mfma_f32_16x16x32_bf16 v[224:227], v[68:71], v[120:123], v[224:227]
v_fmac_f32 v160, v220, v251
v_fmac_f32 v161, v221, v251
v_mfma_f32_16x16x32_bf16 v[0:3], a[192:195], v[232:235], 0
v_fmac_f32 v162, v222, v251
v_fmac_f32 v163, v223, v251
v_mfma_f32_16x16x32_bf16 v[0:3], a[196:199], v[184:187], v[0:3]
v_cvt_pk_bf16_f32 v160, v160, v161
v_cvt_pk_bf16_f32 v161, v162, v163
v_mfma_f32_16x16x32_bf16 v[0:3], a[200:203], v[192:195], v[0:3]
v_fmac_f32 v164, v224, v251
v_fmac_f32 v165, v225, v251
v_mfma_f32_16x16x32_bf16 v[0:3], a[204:207], v[196:199], v[0:3]
v_fmac_f32 v166, v226, v251
v_fmac_f32 v167, v227, v251
v_mfma_f32_16x16x32_bf16 v[4:7], a[220:223], v[196:199], 0
s_waitcnt lgkmcnt(0)
v_max_f32 v254, v254, v255
v_sub_f32 v228, v228, v254
v_mfma_f32_16x16x32_bf16 v[4:7], a[216:219], v[192:195], v[4:7]
v_sub_f32 v229, v229, v254
v_sub_f32 v230, v230, v254
v_mfma_f32_16x16x32_bf16 v[4:7], a[212:215], v[184:187], v[4:7]
v_exp_f32 v228, v228
v_mfma_f32_16x16x32_bf16 v[4:7], a[208:211], v[232:235], v[4:7]
ds_read_b128 v[220:223], v236 offset:4224
v_sub_f32 v231, v231, v254
v_mfma_f32_16x16x32_bf16 v[8:11], a[224:227], v[232:235], 0
v_exp_f32 v229, v229
v_mfma_f32_16x16x32_bf16 v[8:11], a[228:231], v[184:187], v[8:11]
v_exp_f32 v230, v230
v_mfma_f32_16x16x32_bf16 v[8:11], a[232:235], v[192:195], v[8:11]
v_exp_f32 v231, v231
v_mfma_f32_16x16x32_bf16 v[8:11], a[236:239], v[196:199], v[8:11]
v_add_f32 v249, v228, v229
v_add_f32 v249, v249, v230
v_mfma_f32_16x16x32_bf16 v[12:15], a[252:255], v[196:199], 0
ds_read_b128 v[196:199], v236 offset:4736
v_add_f32 v249, v249, v231
v_mfma_f32_16x16x32_bf16 v[12:15], a[248:251], v[192:195], v[12:15]
s_waitcnt lgkmcnt(1)
ds_read_b128 v[192:195], v236 offset:4992
v_cvt_pk_bf16_f32 v136, v228, v229
v_mfma_f32_16x16x32_bf16 v[12:15], a[244:247], v[184:187], v[12:15]
v_cvt_pk_bf16_f32 v137, v230, v231
v_sub_f32 v188, v188, v254
v_mfma_f32_16x16x32_bf16 v[12:15], a[240:243], v[232:235], v[12:15]
ds_read_b128 v[228:231], v236 offset:4480
v_sub_f32 v189, v189, v254
v_mfma_f32_16x16x32_bf16 v[16:19], a[192:195], v[220:223], 0
v_exp_f32 v188, v188
v_exp_f32 v189, v189
v_sub_f32 v190, v190, v254
v_cvt_pk_bf16_f32 v138, v188, v189
v_sub_f32 v191, v191, v254
v_exp_f32 v190, v190
v_exp_f32 v191, v191
v_sub_f32 v216, v216, v254
v_cvt_pk_bf16_f32 v139, v190, v191
v_exp_f32 v216, v216
v_sub_f32 v200, v200, v254
v_cvt_pk_bf16_f32 v148, v216, 0
s_waitcnt lgkmcnt(0)
v_mfma_f32_16x16x32_bf16 v[16:19], a[196:199], v[228:231], v[16:19]
v_sub_f32 v201, v201, v254
v_sub_f32 v202, v202, v254
v_mfma_f32_16x16x32_bf16 v[16:19], a[200:203], v[196:199], v[16:19]
v_exp_f32 v200, v200
v_mfma_f32_16x16x32_bf16 v[16:19], a[204:207], v[192:195], v[16:19]
v_exp_f32 v201, v201
v_mfma_f32_16x16x32_bf16 v[20:23], a[220:223], v[192:195], 0
v_exp_f32 v202, v202
v_mfma_f32_16x16x32_bf16 v[20:23], a[216:219], v[196:199], v[20:23]
v_sub_f32 v203, v203, v254
v_sub_f32 v204, v204, v254
v_mfma_f32_16x16x32_bf16 v[20:23], a[212:215], v[228:231], v[20:23]
v_exp_f32 v203, v203
v_mfma_f32_16x16x32_bf16 v[20:23], a[208:211], v[220:223], v[20:23]
v_exp_f32 v204, v204
v_mfma_f32_16x16x32_bf16 v[24:27], a[224:227], v[220:223], 0
v_sub_f32 v205, v205, v254
v_sub_f32 v206, v206, v254
v_mfma_f32_16x16x32_bf16 v[24:27], a[228:231], v[228:231], v[24:27]
v_exp_f32 v205, v205
v_mfma_f32_16x16x32_bf16 v[24:27], a[232:235], v[196:199], v[24:27]
v_exp_f32 v206, v206
v_mfma_f32_16x16x32_bf16 v[24:27], a[236:239], v[192:195], v[24:27]
v_sub_f32 v207, v207, v254
v_cvt_pk_bf16_f32 v140, v200, v201
v_mfma_f32_16x16x32_bf16 v[28:31], a[252:255], v[192:195], 0
v_exp_f32 v207, v207
v_mfma_f32_16x16x32_bf16 v[28:31], a[248:251], v[196:199], v[28:31]
v_cvt_pk_bf16_f32 v141, v202, v203
v_cvt_pk_bf16_f32 v142, v204, v205
v_mfma_f32_16x16x32_bf16 v[28:31], a[244:247], v[228:231], v[28:31]
v_cvt_pk_bf16_f32 v143, v206, v207
v_sub_f32 v208, v208, v254
v_mfma_f32_16x16x32_bf16 v[28:31], a[240:243], v[220:223], v[28:31]
v_sub_f32 v209, v209, v254
v_sub_f32 v210, v210, v254
v_mfma_f32_16x16x32_bf16 v[228:231], v[56:59], v[136:139], 0
v_exp_f32 v208, v208
v_mfma_f32_16x16x32_bf16 v[228:231], v[104:107], v[148:151], v[228:231]
v_exp_f32 v209, v209
v_mfma_f32_16x16x32_bf16 v[228:231], v[72:75], v[140:143], v[228:231]
v_exp_f32 v210, v210
v_sub_f32 v211, v211, v254
v_exp_f32 v211, v211
v_sub_f32 v212, v212, v254
v_exp_f32 v212, v212
v_sub_f32 v213, v213, v254
v_exp_f32 v213, v213
v_sub_f32 v214, v214, v254
v_exp_f32 v214, v214
v_sub_f32 v215, v215, v254
v_exp_f32 v215, v215
v_cvt_pk_bf16_f32 v144, v208, v209
v_cvt_pk_bf16_f32 v145, v210, v211
v_cvt_pk_bf16_f32 v146, v212, v213
v_cvt_pk_bf16_f32 v147, v214, v215
v_cvt_pk_bf16_f32 v162, v164, v165
v_cvt_pk_bf16_f32 v163, v166, v167
v_mfma_f32_16x16x32_bf16 v[228:231], v[88:91], v[144:147], v[228:231]
v_pk_max_i16 v155, v155, 0
v_pk_max_i16 v160, v160, 0
v_mfma_f32_16x16x32_bf16 v[192:195], v[92:95], v[144:147], 0
v_pk_max_i16 v161, v161, 0
v_pk_max_i16 v162, v162, 0
v_mfma_f32_16x16x32_bf16 v[192:195], v[76:79], v[140:143], v[192:195]
v_pk_max_i16 v163, v163, 0
v_mbcnt_hi_u32_b32 v242, -1, v242
v_mfma_f32_16x16x32_bf16 v[192:195], v[106:109], v[148:151], v[192:195]
buffer_store_dwordx4 v[152:155], v239, s[20:23], s52 offen offset:0 nt
buffer_store_dwordx4 v[160:163], v239, s[20:23], s52 offen offset:64 nt
s_mul_i32 s54, s41, 12288
s_add_u32 s54, s54, 105472
v_mov_b32 v244, s54
v_bfe_u32 v243, v242, 0, 4
v_lshl_add_u32 v244, v243, 7, v244
v_lshlrev_b32 v243, 4, v242
v_xor_b32 v243, v243, v242
v_and_b32 v243, 48, v243
v_mfma_f32_16x16x32_bf16 v[192:195], v[60:63], v[136:139], v[192:195]
v_add_u32 v244, v243, v244
v_add_u32 v244, v243, v244
v_mfma_f32_16x16x32_bf16 v[220:223], v[64:67], v[136:139], 0
ds_read_b128 v[184:187], v244 offset:0
ds_read_b128 v[232:235], v244 offset:16
v_mfma_f32_16x16x32_bf16 v[220:223], v[108:111], v[148:151], v[220:223]
ds_read_b128 v[196:199], v244 offset:2048
v_add_f32 v249, v249, v188
v_mfma_f32_16x16x32_bf16 v[220:223], v[80:83], v[140:143], v[220:223]
ds_read_b32 v188, v244 offset:4096
v_add_f32 v249, v249, v189
v_mfma_f32_16x16x32_bf16 v[220:223], v[96:99], v[144:147], v[220:223]
v_add_f32 v249, v249, v190
v_add_f32 v249, v249, v191
v_mfma_f32_16x16x32_bf16 v[224:227], v[100:103], v[144:147], 0
v_mov_b32 v245, 24576
v_bfe_u32 v243, v242, 0, 2
v_mfma_f32_16x16x32_bf16 v[224:227], v[84:87], v[140:143], v[224:227]
v_lshl_add_u32 v245, v243, 8, v245
v_bfe_u32 v243, v242, 2, 2
v_mfma_f32_16x16x32_bf16 v[224:227], v[110:113], v[148:151], v[224:227]
s_waitcnt lgkmcnt(2)
v_lshlrev_b32 v190, 16, v184
v_lshlrev_b32 v191, 16, v185
v_mfma_f32_16x16x32_bf16 v[224:227], v[68:71], v[136:139], v[224:227]
s_waitcnt lgkmcnt(1)
s_waitcnt lgkmcnt(0)
ds_swizzle_b32 v189, v188 offset:0x401F
v_and_b32 v184, 0xffff0000, v184
v_and_b32 v185, 0xffff0000, v185
v_mul_u32_u24 v243, 13107200, v243
v_add_u32 v245, v243, v245
s_lshl_b32 s48, s43, 7
s_add_u32 s48, s48, s44
s_add_u32 s48, s48, 0
v_bfe_u32 v243, v242, 4, 2
v_lshl_add_u32 v245, v243, 4, v245
v_add_f32 v249, v249, v200
v_add_f32 v249, v249, v201
v_add_f32 v249, v249, v202
v_add_f32 v249, v249, v203
ds_read_b128 v[200:203], v244 offset:2064
v_add_f32 v249, v249, v204
ds_read_b32 v204, v244 offset:6144
v_add_f32 v249, v249, v205
v_add_f32 v249, v249, v206
v_add_f32 v249, v249, v207
v_add_f32 v249, v249, v208
v_add_f32 v249, v249, v209
v_add_f32 v249, v249, v210
v_add_f32 v249, v249, v211
v_add_f32 v249, v249, v212
v_add_f32 v249, v249, v213
v_add_f32 v249, v249, v214
v_add_f32 v249, v249, v215
v_add_f32 v249, v249, v216
ds_swizzle_b32 v250, v249 offset:0x401F
v_lshlrev_b32 v206, 16, v196
v_lshlrev_b32 v207, 16, v197
v_and_b32 v196, 0xffff0000, v196
v_and_b32 v197, 0xffff0000, v197
s_waitcnt lgkmcnt(1)
ds_swizzle_b32 v205, v204 offset:0x401F
v_add_f32 v188, v188, v189
ds_bpermute_b32 v189, v247, v188
s_lshl_b32 s51, s43, 7
s_add_u32 s51, s51, s44
s_add_u32 s51, s51, 52428800
s_waitcnt lgkmcnt(2)
v_add_f32 v249, v249, v250
ds_bpermute_b32 v250, v247, v249
s_waitcnt lgkmcnt(2)
v_add_f32 v204, v204, v205
ds_bpermute_b32 v205, v247, v204
s_waitcnt lgkmcnt(2)
v_add_f32 v188, v188, v189
v_rcp_f32 v189, v188
s_nop 0
v_fmac_f32 v0, v190, v189
v_fmac_f32 v2, v191, v189
v_lshlrev_b32 v190, 16, v186
v_lshlrev_b32 v191, 16, v187
v_fmac_f32 v4, v190, v189
v_fmac_f32 v6, v191, v189
v_lshlrev_b32 v190, 16, v232
v_lshlrev_b32 v191, 16, v233
v_and_b32 v232, 0xffff0000, v232
v_fmac_f32 v8, v190, v189
v_fmac_f32 v10, v191, v189
v_fmac_f32 v1, v184, v189
v_fmac_f32 v9, v232, v189
v_and_b32 v233, 0xffff0000, v233
v_lshlrev_b32 v190, 16, v234
v_lshlrev_b32 v191, 16, v235
v_fmac_f32 v3, v185, v189
v_and_b32 v186, 0xffff0000, v186
v_and_b32 v187, 0xffff0000, v187
v_fmac_f32 v11, v233, v189
v_and_b32 v234, 0xffff0000, v234
v_and_b32 v235, 0xffff0000, v235
v_cvt_pk_bf16_f32 v0, v0, v1
v_cvt_pk_bf16_f32 v8, v8, v9
v_fmac_f32 v5, v186, v189
v_fmac_f32 v7, v187, v189
v_fmac_f32 v12, v190, v189
v_fmac_f32 v13, v234, v189
v_fmac_f32 v14, v191, v189
v_fmac_f32 v15, v235, v189
v_cvt_pk_bf16_f32 v1, v2, v3
v_cvt_pk_bf16_f32 v9, v10, v11
v_cvt_pk_bf16_f32 v2, v4, v5
v_cvt_pk_bf16_f32 v3, v6, v7
v_cvt_pk_bf16_f32 v10, v12, v13
v_cvt_pk_bf16_f32 v11, v14, v15
v_pk_max_i16 v0, v0, 0
v_pk_max_i16 v1, v1, 0
v_pk_max_i16 v2, v2, 0
v_pk_max_i16 v3, v3, 0
v_pk_max_i16 v8, v8, 0
v_pk_max_i16 v9, v9, 0
v_pk_max_i16 v10, v10, 0
v_pk_max_i16 v11, v11, 0
buffer_store_dwordx4 v[0:3], v245, s[20:23], s48 offen offset:0 nt
buffer_store_dwordx4 v[8:11], v245, s[20:23], s48 offen offset:64 nt
s_waitcnt lgkmcnt(1)
v_add_f32 v249, v249, v250
v_rcp_f32 v252, v249
s_nop 0
v_fmac_f32 v168, v228, v252
v_fmac_f32 v169, v229, v252
v_fmac_f32 v176, v220, v252
v_fmac_f32 v177, v221, v252
v_fmac_f32 v170, v230, v252
v_fmac_f32 v171, v231, v252
v_cvt_pk_bf16_f32 v168, v168, v169
v_fmac_f32 v178, v222, v252
v_fmac_f32 v179, v223, v252
v_cvt_pk_bf16_f32 v176, v176, v177
v_fmac_f32 v172, v192, v252
v_fmac_f32 v173, v193, v252
v_fmac_f32 v174, v194, v252
v_fmac_f32 v175, v195, v252
v_cvt_pk_bf16_f32 v169, v170, v171
v_fmac_f32 v180, v224, v252
v_fmac_f32 v181, v225, v252
v_fmac_f32 v182, v226, v252
v_fmac_f32 v183, v227, v252
v_cvt_pk_bf16_f32 v177, v178, v179
v_cvt_pk_bf16_f32 v170, v172, v173
v_cvt_pk_bf16_f32 v171, v174, v175
v_cvt_pk_bf16_f32 v178, v180, v181
v_cvt_pk_bf16_f32 v179, v182, v183
v_pk_max_i16 v168, v168, 0
v_pk_max_i16 v169, v169, 0
v_pk_max_i16 v170, v170, 0
v_pk_max_i16 v171, v171, 0
v_pk_max_i16 v176, v176, 0
v_pk_max_i16 v177, v177, 0
v_pk_max_i16 v178, v178, 0
v_pk_max_i16 v179, v179, 0
buffer_store_dwordx4 v[168:171], v239, s[20:23], s53 offen offset:0 nt
buffer_store_dwordx4 v[176:179], v239, s[20:23], s53 offen offset:64 nt
s_waitcnt lgkmcnt(0)
v_add_f32 v204, v204, v205
v_rcp_f32 v205, v204
s_nop 0
v_fmac_f32 v16, v206, v205
v_fmac_f32 v18, v207, v205
v_lshlrev_b32 v206, 16, v198
v_lshlrev_b32 v207, 16, v199
v_fmac_f32 v20, v206, v205
v_fmac_f32 v22, v207, v205
v_lshlrev_b32 v206, 16, v200
v_lshlrev_b32 v207, 16, v201
v_and_b32 v200, 0xffff0000, v200
v_fmac_f32 v24, v206, v205
v_fmac_f32 v26, v207, v205
v_fmac_f32 v17, v196, v205
v_fmac_f32 v25, v200, v205
v_and_b32 v201, 0xffff0000, v201
v_lshlrev_b32 v206, 16, v202
v_lshlrev_b32 v207, 16, v203
v_fmac_f32 v19, v197, v205
v_and_b32 v198, 0xffff0000, v198
v_and_b32 v199, 0xffff0000, v199
v_fmac_f32 v27, v201, v205
v_and_b32 v202, 0xffff0000, v202
v_and_b32 v203, 0xffff0000, v203
v_cvt_pk_bf16_f32 v16, v16, v17
v_cvt_pk_bf16_f32 v24, v24, v25
v_fmac_f32 v21, v198, v205
v_fmac_f32 v23, v199, v205
v_fmac_f32 v28, v206, v205
v_fmac_f32 v29, v202, v205
v_fmac_f32 v30, v207, v205
v_fmac_f32 v31, v203, v205
v_cvt_pk_bf16_f32 v17, v18, v19
v_cvt_pk_bf16_f32 v25, v26, v27
v_cvt_pk_bf16_f32 v18, v20, v21
v_cvt_pk_bf16_f32 v19, v22, v23
v_cvt_pk_bf16_f32 v26, v28, v29
v_cvt_pk_bf16_f32 v27, v30, v31
v_pk_max_i16 v16, v16, 0
v_pk_max_i16 v17, v17, 0
v_pk_max_i16 v18, v18, 0
v_pk_max_i16 v19, v19, 0
v_pk_max_i16 v24, v24, 0
v_pk_max_i16 v25, v25, 0
v_pk_max_i16 v26, v26, 0
v_pk_max_i16 v27, v27, 0
buffer_store_dwordx4 v[16:19], v245, s[20:23], s51 offen offset:0 nt
buffer_store_dwordx4 v[24:27], v245, s[20:23], s51 offen offset:64 nt
L_end:
s_endpgm
.section .rodata,"a"
.p2align 6
.amdhsa_kernel standalone__attention_interact_autoint__recsys_kernel
  .amdhsa_next_free_vgpr 512
  .amdhsa_next_free_sgpr 102
  .amdhsa_accum_offset 256
  .amdhsa_group_segment_fixed_size 0
  .amdhsa_kernarg_size 64
  .amdhsa_user_sgpr_count 2
  .amdhsa_user_sgpr_kernarg_segment_ptr 1
  .amdhsa_system_sgpr_workgroup_id_x 1
.end_amdhsa_kernel
```

```asm
; @launch grid=(256,1,1) block=(256,1,1) lds=163840
.amdgcn_target "amdgcn-amd-amdhsa--gfx950"
.text
.globl standalone__attention_interact_autoint__recsys_kernel
.p2align 8
.type standalone__attention_interact_autoint__recsys_kernel,@function
standalone__attention_interact_autoint__recsys_kernel:
s_cmp_ge_u32 s2, 256
s_cbranch_scc1 L_end
s_load_dwordx2 s[24:25], s[0:1], 8
s_load_dwordx2 s[16:17], s[0:1], 0
s_load_dwordx2 s[28:29], s[0:1], 16
s_load_dwordx2 s[32:33], s[0:1], 24
s_load_dwordx2 s[36:37], s[0:1], 32
s_load_dwordx2 s[20:21], s[0:1], 40
s_getpc_b64 s[58:59]
L_pc:
s_lshl_b32 s3, s2, 8
s_and_b32 s3, s3, 0x7800
v_lshrrev_b32 v2, 4, v0
v_lshl_add_u32 v2, v2, 7, s3
v_min_u32 v2, L_fast_end-L_pc-4, v2
global_load_dword v96, v2, s[58:59]
v_lshrrev_b32 v1, 6, v0
s_mov_b32 s19, 0x20000
v_readfirstlane_b32 s41, v1
s_mov_b32 s18, 104857600
s_mov_b32 s26, 32768
s_mov_b32 s27, s19
s_lshr_b32 s42, s41, 1
s_and_b32 s43, s41, 1
s_lshl1_add_u32 s44, s2, s42
s_mul_i32 s44, s44, 25600
s_mov_b64 s[30:31], s[26:27]
s_mov_b64 s[34:35], s[26:27]
s_mov_b64 s[38:39], s[26:27]
s_lshl_b32 s54, s41, 13
s_mul_i32 s49, s42, 25344
s_mul_i32 s53, s43, 1056
s_add_u32 s49, s49, s53
s_lshl_b32 s55, s43, 10
s_add_u32 s55, s55, s44
s_lshl_b32 s6, s2, 7
s_and_b32 s6, s6, 0x7c00
s_add_u32 s57, s54, 4096
s_add_u32 m0, s49, 21120
s_add_u32 s48, s55, 20480
v_and_b32 v168, 63, v0
v_lshlrev_b32 v175, 4, v168
v_and_b32 v243, 48, v175
v_and_b32 v169, 48, v168
v_lshl_add_u32 v243, v169, 2, v243
v_and_b32 v169, 12, v168
v_lshl_add_u32 v243, v169, 6, v243
v_lshrrev_b32 v169, 5, v0
v_lshlrev_b32 v169, 7, v169
s_waitcnt lgkmcnt(0)
buffer_load_dword v97, v169, s[24:27], s6 offen
buffer_load_dword v98, v169, s[28:31], s6 offen
buffer_load_dword v99, v169, s[32:35], s6 offen
buffer_load_dword v100, v169, s[36:39], s6 offen
buffer_load_dwordx4 v[104:107], v175, s[24:27], s54 offen offset:0
buffer_load_dwordx4 v[108:111], v175, s[24:27], s54 offen offset:1024
buffer_load_dwordx4 v[112:115], v175, s[24:27], s54 offen offset:2048
buffer_load_dwordx4 v[116:119], v175, s[24:27], s54 offen offset:3072
buffer_load_dwordx4 v[120:123], v175, s[24:27], s57 offen offset:0
buffer_load_dwordx4 v[124:127], v175, s[24:27], s57 offen offset:1024
buffer_load_dwordx4 v[128:131], v175, s[24:27], s57 offen offset:2048
buffer_load_dwordx4 v[132:135], v175, s[24:27], s57 offen offset:3072
s_mov_b32 s40, 0x3e38aa3b
s_mov_b32 s22, s18
s_mov_b32 s23, s19
s_mov_b32 s45, 8
s_mov_b32 s3, 64
s_mov_b32 s46, s44
s_mov_b32 s47, 0x7ff00000
s_mov_b32 s56, 50688
s_mov_b32 s96, 0x3b8265d9
s_mov_b32 s97, 0
s_mul_i32 s98, s42, 25344
s_lshl_b32 s53, s43, 13
s_add_u32 s98, s98, s53
s_add_u32 s53, s98, 4224
v_and_b32 v169, 16, v168
v_lshlrev_b32 v180, 2, v169
v_lshlrev_b32 v169, 1, v169
v_xor_b32 v170, v175, v169
v_add_u32 v172, s53, v170
v_xor_b32 v171, 64, v170
v_add_u32 v173, s53, v171
s_mul_i32 s4, s43, 13107200
s_add_u32 s4, s4, s44
s_add_u32 s4, s4, 24576
s_mul_i32 s5, s43, -52424704
s_add_u32 s5, s5, 104833024
s_add_u32 s99, s4, 0
s_add_u32 s100, s4, 26212288
s_mul_i32 s53, s43, 25344
s_add_u32 s7, s53, 4224
v_lshrrev_b32 v82, 4, v168
v_lshl_add_u32 v176, v82, 10, s7
v_bfe_u32 v83, v168, 2, 2
v_lshl_add_u32 v176, v83, 7, v176
v_bfe_u32 v84, v168, 3, 1
v_lshl_add_u32 v176, v84, 5, v176
v_bfe_u32 v85, v168, 4, 1
v_lshl_add_u32 v176, v85, 6, v176
v_and_b32 v86, 3, v168
v_lshl_add_u32 v176, v86, 3, v176
v_xor_b32 v177, 32, v176
v_xor_b32 v178, 64, v176
s_mul_i32 s53, s42, 25344
v_lshl_add_u32 v242, v86, 6, s53
v_lshl_add_u32 v242, v82, 4, v242
s_mov_b32 s6, 1056
v_mad_u32_u24 v242, v83, s6, v242
v_xor_b32 v179, 96, v176
v_lshrrev_b32 v80, 3, v168
v_lshlrev_b32 v174, 8, v80
v_and_b32 v81, 7, v168
v_lshl_add_u32 v174, v81, 4, v174
v_xor_b32 v174, v174, v180
v_xor_b32 v180, v175, v180
s_mul_i32 s53, s41, 816
s_add_u32 s53, s53, 157696
v_and_b32 v88, 1, v168
v_lshl_add_u32 v249, v83, 6, s53
v_lshl_add_u32 v249, v88, 5, v249
s_add_u32 s8, s53, 256
s_mov_b32 vcc_lo, 0x33333333
s_mov_b32 vcc_hi, 0xcccccccc
v_lshl_add_u32 v249, v85, 4, v249
v_mov_b32 v166, s8
v_cndmask_b32 v249, v166, v249, vcc
s_add_u32 s9, s53, 256
v_lshl_add_u32 v166, v83, 2, s9
s_mov_b32 s8, 272
v_lshl_add_u32 v248, v82, 6, s53
v_mov_b32 v236, 0
v_mad_u32_u24 v166, v86, s8, v166
s_lshl_b32 s53, s41, 8
s_add_u32 s10, s53, 101376
ds_write_b32 v166, v236 offset:0
s_add_u32 s58, s53, 36096
s_xor_b32 s59, s53, 256
s_add_u32 s59, s59, 36096
v_lshl_add_u32 v166, v168, 2, s10
v_bfe_u32 v87, v168, 1, 1
v_lshl_add_u32 v248, v87, 5, v248
v_lshl_add_u32 v248, v83, 3, v248
v_lshl_add_u32 v248, v88, 1, v248
ds_write_b32 v166, v166 offset:0
s_mov_b64 exec, 0
s_cmp_eq_u32 s41, 0
s_cbranch_scc1 L_h0
s_cmp_eq_u32 s41, 1
s_cbranch_scc1 L_h1
s_cmp_eq_u32 s41, 2
s_cbranch_scc1 L_h2
s_branch L_h3
L_ret:
s_mov_b64 exec, -1
buffer_load_dwordx4 v243, s[16:19], s48 offen nt lds
s_add_u32 m0, s49, 23232
s_add_u32 s48, s55, 22528
buffer_load_dwordx4 v243, s[16:19], s48 offen nt lds
s_add_u32 m0, s49, 0
s_add_u32 s48, s55, 0
buffer_load_dwordx4 v243, s[16:19], s48 offen nt lds
s_add_u32 m0, s49, 2112
s_add_u32 s48, s55, 2048
buffer_load_dwordx4 v243, s[16:19], s48 offen nt lds
s_add_u32 m0, s98, 102400
s_waitcnt vmcnt(11)
v_and_b32 v160, 0xffff0000, v104
v_and_b32 v161, 0xffff0000, v105
v_and_b32 v162, 0xffff0000, v106
v_and_b32 v163, 0xffff0000, v107
v_lshlrev_b32 v104, 16, v104
v_lshlrev_b32 v105, 16, v105
v_lshlrev_b32 v106, 16, v106
v_lshlrev_b32 v107, 16, v107
v_mul_f32 v160, s40, v160
v_mul_f32 v104, s40, v104
v_mul_f32 v161, s40, v161
v_mul_f32 v105, s40, v105
v_mul_f32 v162, s40, v162
v_mul_f32 v106, s40, v106
v_mul_f32 v163, s40, v163
v_mul_f32 v107, s40, v107
v_cvt_pk_bf16_f32 v104, v104, v160
v_cvt_pk_bf16_f32 v105, v105, v161
v_cvt_pk_bf16_f32 v106, v106, v162
v_cvt_pk_bf16_f32 v107, v107, v163
ds_write_b128 v172, v[104:107] offset:0
buffer_load_dwordx4 v170, s[28:31], s54 offen offset:0 lds
buffer_load_dwordx4 v171, s[28:31], s54 offen offset:1024 lds
s_waitcnt vmcnt(12)
v_and_b32 v160, 0xffff0000, v108
v_and_b32 v161, 0xffff0000, v109
v_and_b32 v162, 0xffff0000, v110
v_and_b32 v163, 0xffff0000, v111
v_lshlrev_b32 v108, 16, v108
v_lshlrev_b32 v109, 16, v109
v_lshlrev_b32 v110, 16, v110
v_lshlrev_b32 v111, 16, v111
v_mul_f32 v160, s40, v160
v_mul_f32 v108, s40, v108
v_mul_f32 v161, s40, v161
v_mul_f32 v109, s40, v109
v_mul_f32 v162, s40, v162
v_mul_f32 v110, s40, v110
v_mul_f32 v163, s40, v163
v_mul_f32 v111, s40, v111
v_cvt_pk_bf16_f32 v108, v108, v160
v_cvt_pk_bf16_f32 v109, v109, v161
v_cvt_pk_bf16_f32 v110, v110, v162
v_cvt_pk_bf16_f32 v111, v111, v163
ds_write_b128 v173, v[108:111] offset:1024
buffer_load_dwordx4 v170, s[28:31], s54 offen offset:2048 lds
buffer_load_dwordx4 v171, s[28:31], s54 offen offset:3072 lds
s_add_u32 m0, s98, 106496
s_waitcnt vmcnt(13)
v_and_b32 v160, 0xffff0000, v112
v_and_b32 v161, 0xffff0000, v113
v_and_b32 v162, 0xffff0000, v114
v_and_b32 v163, 0xffff0000, v115
v_lshlrev_b32 v112, 16, v112
v_lshlrev_b32 v113, 16, v113
v_lshlrev_b32 v114, 16, v114
v_lshlrev_b32 v115, 16, v115
v_mul_f32 v160, s40, v160
v_mul_f32 v112, s40, v112
v_mul_f32 v161, s40, v161
v_mul_f32 v113, s40, v113
v_mul_f32 v162, s40, v162
v_mul_f32 v114, s40, v114
v_mul_f32 v163, s40, v163
v_mul_f32 v115, s40, v115
v_cvt_pk_bf16_f32 v112, v112, v160
v_cvt_pk_bf16_f32 v113, v113, v161
v_cvt_pk_bf16_f32 v114, v114, v162
v_cvt_pk_bf16_f32 v115, v115, v163
ds_write_b128 v172, v[112:115] offset:2048
buffer_load_dwordx4 v170, s[28:31], s57 offen offset:0 lds
buffer_load_dwordx4 v171, s[28:31], s57 offen offset:1024 lds
s_waitcnt vmcnt(14)
v_and_b32 v160, 0xffff0000, v116
v_and_b32 v161, 0xffff0000, v117
v_and_b32 v162, 0xffff0000, v118
v_and_b32 v163, 0xffff0000, v119
v_lshlrev_b32 v116, 16, v116
v_lshlrev_b32 v117, 16, v117
v_lshlrev_b32 v118, 16, v118
v_lshlrev_b32 v119, 16, v119
v_mul_f32 v160, s40, v160
v_mul_f32 v116, s40, v116
v_mul_f32 v161, s40, v161
v_mul_f32 v117, s40, v117
v_mul_f32 v162, s40, v162
v_mul_f32 v118, s40, v118
v_mul_f32 v163, s40, v163
v_mul_f32 v119, s40, v119
v_cvt_pk_bf16_f32 v116, v116, v160
v_cvt_pk_bf16_f32 v117, v117, v161
v_cvt_pk_bf16_f32 v118, v118, v162
v_cvt_pk_bf16_f32 v119, v119, v163
ds_write_b128 v173, v[116:119] offset:3072
buffer_load_dwordx4 v170, s[28:31], s57 offen offset:2048 lds
buffer_load_dwordx4 v171, s[28:31], s57 offen offset:3072 lds
s_add_u32 m0, s49, 50688
s_waitcnt vmcnt(15)
v_and_b32 v160, 0xffff0000, v120
v_and_b32 v161, 0xffff0000, v121
v_and_b32 v162, 0xffff0000, v122
v_and_b32 v163, 0xffff0000, v123
v_lshlrev_b32 v120, 16, v120
v_lshlrev_b32 v121, 16, v121
v_lshlrev_b32 v122, 16, v122
v_lshlrev_b32 v123, 16, v123
v_mul_f32 v160, s40, v160
v_mul_f32 v120, s40, v120
v_mul_f32 v161, s40, v161
v_mul_f32 v121, s40, v121
v_mul_f32 v162, s40, v162
v_mul_f32 v122, s40, v122
v_mul_f32 v163, s40, v163
v_mul_f32 v123, s40, v123
v_cvt_pk_bf16_f32 v120, v120, v160
v_cvt_pk_bf16_f32 v121, v121, v161
v_cvt_pk_bf16_f32 v122, v122, v162
v_cvt_pk_bf16_f32 v123, v123, v163
ds_write_b128 v172, v[120:123] offset:4096
s_waitcnt vmcnt(14)
v_and_b32 v160, 0xffff0000, v124
v_and_b32 v161, 0xffff0000, v125
v_and_b32 v162, 0xffff0000, v126
v_and_b32 v163, 0xffff0000, v127
v_lshlrev_b32 v124, 16, v124
v_lshlrev_b32 v125, 16, v125
v_lshlrev_b32 v126, 16, v126
v_lshlrev_b32 v127, 16, v127
v_mul_f32 v160, s40, v160
v_mul_f32 v124, s40, v124
v_mul_f32 v161, s40, v161
v_mul_f32 v125, s40, v125
v_mul_f32 v162, s40, v162
v_mul_f32 v126, s40, v126
v_mul_f32 v163, s40, v163
v_mul_f32 v127, s40, v127
v_cvt_pk_bf16_f32 v124, v124, v160
v_cvt_pk_bf16_f32 v125, v125, v161
v_cvt_pk_bf16_f32 v126, v126, v162
v_cvt_pk_bf16_f32 v127, v127, v163
ds_write_b128 v173, v[124:127] offset:5120
s_waitcnt vmcnt(13)
v_and_b32 v160, 0xffff0000, v128
v_and_b32 v161, 0xffff0000, v129
v_and_b32 v162, 0xffff0000, v130
v_and_b32 v163, 0xffff0000, v131
v_lshlrev_b32 v128, 16, v128
v_lshlrev_b32 v129, 16, v129
v_lshlrev_b32 v130, 16, v130
v_lshlrev_b32 v131, 16, v131
v_mul_f32 v160, s40, v160
v_mul_f32 v128, s40, v128
v_mul_f32 v161, s40, v161
v_mul_f32 v129, s40, v129
v_mul_f32 v162, s40, v162
v_mul_f32 v130, s40, v130
v_mul_f32 v163, s40, v163
v_mul_f32 v131, s40, v131
v_cvt_pk_bf16_f32 v128, v128, v160
v_cvt_pk_bf16_f32 v129, v129, v161
v_cvt_pk_bf16_f32 v130, v130, v162
v_cvt_pk_bf16_f32 v131, v131, v163
ds_write_b128 v172, v[128:131] offset:6144
s_waitcnt vmcnt(12)
v_and_b32 v160, 0xffff0000, v132
v_and_b32 v161, 0xffff0000, v133
v_and_b32 v162, 0xffff0000, v134
v_and_b32 v163, 0xffff0000, v135
v_lshlrev_b32 v132, 16, v132
v_lshlrev_b32 v133, 16, v133
v_lshlrev_b32 v134, 16, v134
v_lshlrev_b32 v135, 16, v135
v_mul_f32 v160, s40, v160
v_mul_f32 v132, s40, v132
v_mul_f32 v161, s40, v161
v_mul_f32 v133, s40, v133
v_mul_f32 v162, s40, v162
v_mul_f32 v134, s40, v134
v_mul_f32 v163, s40, v163
v_mul_f32 v135, s40, v135
v_cvt_pk_bf16_f32 v132, v132, v160
v_cvt_pk_bf16_f32 v133, v133, v161
v_cvt_pk_bf16_f32 v134, v134, v162
v_cvt_pk_bf16_f32 v135, v135, v163
ds_write_b128 v173, v[132:135] offset:7168
buffer_load_dwordx4 v243, s[16:19], s99 offen offset:0 nt lds
buffer_load_dwordx4 v243, s[16:19], s100 offen offset:2112 nt lds
s_add_u32 m0, s49, 54912
s_add_u32 s99, s4, 52428800
buffer_load_dwordx4 v243, s[16:19], s99 offen offset:0 nt lds
s_add_u32 s100, s4, 78641088
buffer_load_dwordx4 v243, s[16:19], s100 offen offset:2112 nt lds
s_add_u32 m0, s98, 59648
s_add_u32 s99, s55, 4096
s_add_u32 s100, s55, 4032
s_waitcnt vmcnt(12) lgkmcnt(0)
s_barrier
ds_read_b64_tr_b16 a[4:5], v176 offset:4096
ds_read_b128 v[212:215], v242 offset:21376
ds_read_b64_tr_b16 a[6:7], v176 offset:4608
ds_read_b128 v[216:219], v242 offset:21632
ds_read_b64_tr_b16 a[8:9], v176 offset:8192
ds_read_b128 v[220:223], v242 offset:21888
ds_read_b64_tr_b16 a[10:11], v176 offset:8704
ds_read_b128 v[200:203], v242 offset:21120
ds_read_b64_tr_b16 a[12:13], v176 offset:12288
ds_read_b128 v[188:191], v242 offset:0
ds_read_b64_tr_b16 a[14:15], v176 offset:12800
ds_read_b128 v[192:195], v242 offset:256
ds_read_b64_tr_b16 a[0:1], v176 offset:0
ds_read_b128 v[196:199], v242 offset:512
ds_read_b64_tr_b16 a[2:3], v176 offset:512
ds_read_b128 v[204:207], v242 offset:768
ds_read_b64_tr_b16 a[16:17], v177 offset:0
ds_read_b64_tr_b16 a[18:19], v177 offset:512
ds_read_b64_tr_b16 a[20:21], v177 offset:4096
ds_read_b64_tr_b16 a[22:23], v177 offset:4608
ds_read_b64_tr_b16 a[24:25], v177 offset:8192
ds_read_b64_tr_b16 a[26:27], v177 offset:8704
ds_read_b64_tr_b16 a[28:29], v177 offset:12288
ds_read_b64_tr_b16 a[30:31], v177 offset:12800
ds_read_b64_tr_b16 a[32:33], v178 offset:0
ds_read_b64_tr_b16 a[34:35], v178 offset:512
ds_read_b64_tr_b16 a[36:37], v178 offset:4096
ds_read_b64_tr_b16 a[38:39], v178 offset:4608
s_waitcnt lgkmcnt(15)
v_mfma_f32_16x16x32_bf16 v[208:211], a[4:7], v[212:215], 0
s_mul_i32 s53, s43, 25344
ds_read_b64_tr_b16 a[40:41], v178 offset:8192
v_add_u32 v176, 98176, v176
v_mfma_f32_16x16x32_bf16 v[208:211], a[8:11], v[216:219], v[208:211]
s_waitcnt lgkmcnt(14)
ds_read_b64_tr_b16 a[42:43], v178 offset:8704
v_add_u32 v177, 98176, v177
v_mfma_f32_16x16x32_bf16 v[208:211], a[12:15], v[220:223], v[208:211]
s_add_u32 s11, s53, 59648
ds_read_b64_tr_b16 a[44:45], v178 offset:12288
v_lshl_add_u32 v182, v82, 10, s11
v_mfma_f32_16x16x32_bf16 v[208:211], a[0:3], v[200:203], v[208:211]
s_lshl_b32 s53, s43, 7
ds_read_b64_tr_b16 a[46:47], v178 offset:12800
v_add_u32 v178, 98176, v178
v_mfma_f32_16x16x32_bf16 v[224:227], a[0:3], v[188:191], 0
s_mov_b32 s51, -32
ds_read_b64_tr_b16 a[48:49], v179 offset:0
v_lshl_add_u32 v182, v83, 7, v182
v_mfma_f32_16x16x32_bf16 v[224:227], a[4:7], v[192:195], v[224:227]
s_waitcnt lgkmcnt(15)
ds_read_b64_tr_b16 a[50:51], v179 offset:512
v_cvt_pk_bf16_f32 v152, v208, v209
v_mfma_f32_16x16x32_bf16 v[224:227], a[8:11], v[196:199], v[224:227]
s_waitcnt lgkmcnt(10)
ds_read_b64_tr_b16 a[52:53], v179 offset:4096
v_cvt_pk_bf16_f32 v153, v210, v211
v_mfma_f32_16x16x32_bf16 v[224:227], a[12:15], v[204:207], v[224:227]
ds_read_b64_tr_b16 a[54:55], v179 offset:4608
v_lshl_add_u32 v182, v84, 6, v182
v_mfma_f32_16x16x32_bf16 v[228:231], a[28:31], v[204:207], 0
ds_read_b64_tr_b16 a[56:57], v179 offset:8192
v_lshl_add_u32 v182, v86, 4, v182
v_mfma_f32_16x16x32_bf16 v[228:231], a[24:27], v[196:199], v[228:231]
ds_read_b64_tr_b16 a[58:59], v179 offset:8704
v_xor_b32 v183, 64, v182
v_mfma_f32_16x16x32_bf16 v[228:231], a[20:23], v[192:195], v[228:231]
ds_read_b64_tr_b16 a[60:61], v179 offset:12288
v_cvt_pk_bf16_f32 v96, v224, v225
v_mfma_f32_16x16x32_bf16 v[228:231], a[16:19], v[188:191], v[228:231]
s_waitcnt lgkmcnt(13)
ds_read_b64_tr_b16 a[62:63], v179 offset:12800
v_cvt_pk_bf16_f32 v97, v226, v227
v_mfma_f32_16x16x32_bf16 v[208:211], a[16:19], v[200:203], 0
s_waitcnt vmcnt(4)
s_barrier
v_mfma_f32_16x16x32_bf16 v[208:211], a[28:31], v[220:223], v[208:211]
s_waitcnt lgkmcnt(10)
ds_read_b64_tr_b16 a[64:65], v176 offset:0
v_cvt_pk_bf16_f32 v98, v228, v229
v_mfma_f32_16x16x32_bf16 v[208:211], a[24:27], v[216:219], v[208:211]
s_waitcnt lgkmcnt(10)
ds_read_b64_tr_b16 a[66:67], v176 offset:512
v_cvt_pk_bf16_f32 v99, v230, v231
v_mfma_f32_16x16x32_bf16 v[208:211], a[20:23], v[212:215], v[208:211]
s_waitcnt lgkmcnt(10)
ds_read_b64_tr_b16 a[68:69], v176 offset:4096
v_add_u32 v179, 98176, v179
v_mfma_f32_16x16x32_bf16 v[224:227], a[36:39], v[212:215], 0
s_waitcnt lgkmcnt(10)
ds_read_b64_tr_b16 a[70:71], v176 offset:4608
v_lshl_add_u32 v244, v81, 8, s53
v_mfma_f32_16x16x32_bf16 v[224:227], a[40:43], v[216:219], v[224:227]
s_waitcnt lgkmcnt(10)
ds_read_b64_tr_b16 a[72:73], v176 offset:8192
v_cvt_pk_bf16_f32 v154, v208, v209
v_mfma_f32_16x16x32_bf16 v[224:227], a[44:47], v[220:223], v[224:227]
s_waitcnt lgkmcnt(10)
ds_read_b64_tr_b16 a[74:75], v176 offset:8704
v_cvt_pk_bf16_f32 v155, v210, v211
v_mfma_f32_16x16x32_bf16 v[224:227], a[32:35], v[200:203], v[224:227]
s_waitcnt lgkmcnt(10)
ds_read_b64_tr_b16 a[76:77], v176 offset:12288
v_lshlrev_b32 v94, 4, v83
v_mfma_f32_16x16x32_bf16 v[228:231], a[32:35], v[188:191], 0
s_waitcnt lgkmcnt(10)
ds_read_b64_tr_b16 a[78:79], v176 offset:12800
v_and_b32 v95, 15, v168
v_mfma_f32_16x16x32_bf16 v[228:231], a[36:39], v[192:195], v[228:231]
s_waitcnt lgkmcnt(10)
ds_read_b64_tr_b16 a[80:81], v177 offset:0
v_cvt_pk_bf16_f32 v156, v224, v225
v_mfma_f32_16x16x32_bf16 v[228:231], a[40:43], v[196:199], v[228:231]
s_waitcnt lgkmcnt(9)
ds_read_b64_tr_b16 a[82:83], v177 offset:512
v_cvt_pk_bf16_f32 v157, v226, v227
v_mfma_f32_16x16x32_bf16 v[228:231], a[44:47], v[204:207], v[228:231]
s_lshl_b32 s53, s41, 9
buffer_load_dwordx4 v180, s[32:35], s54 offen offset:0 lds
v_mfma_f32_16x16x32_bf16 v[208:211], a[60:63], v[204:207], 0
s_add_u32 s9, s53, 160960
buffer_load_dwordx4 v180, s[32:35], s54 offen offset:1024 lds
v_mfma_f32_16x16x32_bf16 v[208:211], a[52:55], v[192:195], v[208:211]
ds_read_b64_tr_b16 a[84:85], v177 offset:4096
v_lshl_add_u32 v167, v95, 4, s9
v_mfma_f32_16x16x32_bf16 v[208:211], a[48:51], v[188:191], v[208:211]
s_waitcnt lgkmcnt(10)
ds_read_b64_tr_b16 a[86:87], v177 offset:4608
v_cvt_pk_bf16_f32 v100, v228, v229
v_mfma_f32_16x16x32_bf16 v[208:211], a[56:59], v[196:199], v[208:211]
s_waitcnt lgkmcnt(10)
ds_read_b64_tr_b16 a[88:89], v177 offset:8192
v_cvt_pk_bf16_f32 v101, v230, v231
v_mfma_f32_16x16x32_bf16 v[224:227], a[56:59], v[216:219], 0
s_waitcnt lgkmcnt(10)
ds_read_b64_tr_b16 a[90:91], v177 offset:8704
v_mov_b32 v169, 163024
v_mfma_f32_16x16x32_bf16 v[224:227], a[60:63], v[220:223], v[224:227]
s_waitcnt lgkmcnt(10)
ds_read_b64_tr_b16 a[92:93], v177 offset:12288
v_cvt_pk_bf16_f32 v102, v208, v209
v_mfma_f32_16x16x32_bf16 v[224:227], a[52:55], v[212:215], v[224:227]
s_waitcnt lgkmcnt(10)
ds_read_b64_tr_b16 a[94:95], v177 offset:12800
v_cvt_pk_bf16_f32 v103, v210, v211
v_mfma_f32_16x16x32_bf16 v[224:227], a[48:51], v[200:203], v[224:227]
s_waitcnt lgkmcnt(10)
ds_read_b64_tr_b16 a[96:97], v178 offset:0
v_lshrrev_b32 v91, 5, v168
v_mfma_f32_16x16x32_bf16 v[208:211], a[64:67], v[200:203], 0
s_waitcnt lgkmcnt(10)
ds_read_b64_tr_b16 a[98:99], v178 offset:512
v_lshlrev_b32 v16, 4, v86
v_mfma_f32_16x16x32_bf16 v[208:211], a[68:71], v[212:215], v[208:211]
s_waitcnt lgkmcnt(10)
ds_read_b64_tr_b16 a[100:101], v178 offset:4096
v_cvt_pk_bf16_f32 v158, v224, v225
v_mfma_f32_16x16x32_bf16 v[208:211], a[72:75], v[216:219], v[208:211]
L_h0:
s_cbranch_execz L_h4
s_waitcnt lgkmcnt(10)
ds_read_b64_tr_b16 a[102:103], v178 offset:4608
v_cvt_pk_bf16_f32 v159, v226, v227
v_mfma_f32_16x16x32_bf16 v[208:211], a[76:79], v[220:223], v[208:211]
s_waitcnt lgkmcnt(10)
ds_read_b64_tr_b16 a[104:105], v178 offset:8192
v_bfe_u32 v89, v168, 3, 2
v_mfma_f32_16x16x32_bf16 v[224:227], a[76:79], v[204:207], 0
buffer_load_dwordx4 v180, s[32:35], s54 offen offset:2048 lds
v_mfma_f32_16x16x32_bf16 v[224:227], a[64:67], v[188:191], v[224:227]
buffer_load_dwordx4 v180, s[32:35], s54 offen offset:3072 lds
v_mfma_f32_16x16x32_bf16 v[224:227], a[68:71], v[192:195], v[224:227]
s_waitcnt lgkmcnt(7)
ds_read_b64_tr_b16 a[106:107], v178 offset:8704
s_add_u32 m0, s98, 63744
v_mfma_f32_16x16x32_bf16 v[224:227], a[72:75], v[196:199], v[224:227]
ds_read_b64_tr_b16 a[108:109], v178 offset:12288
v_cvt_pk_bf16_f32 v40, v208, v209
v_cvt_pk_bf16_f32 v41, v210, v211
v_mfma_f32_16x16x32_bf16 v[208:211], a[88:91], v[196:199], 0
ds_read_b64_tr_b16 a[110:111], v178 offset:12800
v_bfe_u32 v90, v168, 2, 1
v_mfma_f32_16x16x32_bf16 v[208:211], a[84:87], v[192:195], v[208:211]
s_waitcnt lgkmcnt(8)
ds_read_b64_tr_b16 a[112:113], v179 offset:0
v_cvt_pk_bf16_f32 v0, v224, v225
v_mfma_f32_16x16x32_bf16 v[208:211], a[80:83], v[188:191], v[208:211]
ds_read_b64_tr_b16 a[114:115], v179 offset:512
v_cvt_pk_bf16_f32 v1, v226, v227
v_mfma_f32_16x16x32_bf16 v[208:211], a[92:95], v[204:207], v[208:211]
ds_read_b64_tr_b16 a[116:117], v179 offset:4096
v_lshlrev_b32 v93, 4, v87
v_mfma_f32_16x16x32_bf16 v[224:227], a[92:95], v[220:223], 0
s_waitcnt lgkmcnt(10)
ds_read_b64_tr_b16 a[118:119], v179 offset:4608
v_lshlrev_b32 v92, 5, v84
v_mfma_f32_16x16x32_bf16 v[224:227], a[88:91], v[216:219], v[224:227]
s_waitcnt lgkmcnt(10)
ds_read_b64_tr_b16 a[120:121], v179 offset:8192
v_cvt_pk_bf16_f32 v2, v208, v209
v_mfma_f32_16x16x32_bf16 v[224:227], a[84:87], v[212:215], v[224:227]
s_waitcnt lgkmcnt(10)
ds_read_b64_tr_b16 a[122:123], v179 offset:8704
v_cvt_pk_bf16_f32 v3, v210, v211
v_mfma_f32_16x16x32_bf16 v[224:227], a[80:83], v[200:203], v[224:227]
s_waitcnt lgkmcnt(10)
ds_read_b64_tr_b16 a[124:125], v179 offset:12288
v_mov_b32 v184, 0
v_mfma_f32_16x16x32_bf16 v[208:211], a[96:99], v[200:203], 0
s_waitcnt lgkmcnt(9)
ds_read_b64_tr_b16 a[126:127], v179 offset:12800
v_mov_b32 v251, 0x44444444
v_mfma_f32_16x16x32_bf16 v[208:211], a[100:103], v[212:215], v[208:211]
s_waitcnt lgkmcnt(8)
buffer_load_dwordx4 v180, s[32:35], s57 offen offset:0 lds
v_mfma_f32_16x16x32_bf16 v[208:211], a[104:107], v[216:219], v[208:211]
buffer_load_dwordx4 v180, s[32:35], s57 offen offset:1024 lds
v_mfma_f32_16x16x32_bf16 v[208:211], a[108:111], v[220:223], v[208:211]
v_cvt_pk_bf16_f32 v42, v224, v225
v_cvt_pk_bf16_f32 v43, v226, v227
v_mfma_f32_16x16x32_bf16 v[224:227], a[108:111], v[204:207], 0
s_mul_i32 s52, s41, 13824
s_add_u32 s52, s52, 102400
v_lshl_add_u32 v164, v86, 7, s52
v_mfma_f32_16x16x32_bf16 v[224:227], a[96:99], v[188:191], v[224:227]
s_add_u32 s13, s52, 512
v_cvt_pk_bf16_f32 v44, v208, v209
v_cvt_pk_bf16_f32 v45, v210, v211
v_mfma_f32_16x16x32_bf16 v[224:227], a[100:103], v[192:195], v[224:227]
s_waitcnt lgkmcnt(2)
v_lshl_add_u32 v247, v83, 7, s13
v_lshl_add_u32 v247, v88, 6, v247
v_mfma_f32_16x16x32_bf16 v[224:227], a[104:107], v[196:199], v[224:227]
s_add_u32 s14, s52, 1072
v_lshl_add_u32 v247, v82, 4, v247
v_mov_b32 v166, s14
v_mfma_f32_16x16x32_bf16 v[208:211], a[120:123], v[196:199], 0
s_mov_b32 s14, 1728
s_mov_b32 vcc_lo, 0x33333333
s_mov_b32 vcc_hi, 0x33333333
v_mfma_f32_16x16x32_bf16 v[208:211], a[116:119], v[192:195], v[208:211]
s_waitcnt lgkmcnt(0)
v_cvt_pk_bf16_f32 v4, v224, v225
v_cvt_pk_bf16_f32 v5, v226, v227
v_mfma_f32_16x16x32_bf16 v[208:211], a[112:115], v[188:191], v[208:211]
s_add_u32 s7, s52, 1136
v_xor_b32 v247, v94, v247
v_cndmask_b32 v247, v166, v247, vcc
v_mfma_f32_16x16x32_bf16 v[208:211], a[124:127], v[204:207], v[208:211]
s_add_u32 s12, s52, 1136
s_mov_b32 vcc_lo, 0xf0000f
s_mov_b32 vcc_hi, 0xf0000f00
v_mfma_f32_16x16x32_bf16 v[188:191], a[124:127], v[220:223], 0
s_add_u32 s15, s52, 1072
v_cndmask_b32 v167, v169, v167, vcc
v_lshl_add_u32 v164, v91, 4, v164
v_mfma_f32_16x16x32_bf16 v[188:191], a[120:123], v[216:219], v[188:191]
v_cvt_pk_bf16_f32 v6, v208, v209
v_cvt_pk_bf16_f32 v7, v210, v211
v_mfma_f32_16x16x32_bf16 v[188:191], a[116:119], v[212:215], v[188:191]
buffer_load_dwordx4 v180, s[32:35], s57 offen offset:2048 lds
v_mfma_f32_16x16x32_bf16 v[188:191], a[112:115], v[200:203], v[188:191]
buffer_load_dwordx4 v180, s[32:35], s57 offen offset:3072 lds
v_mfma_f32_16x16x32_bf16 v[192:195], v[4:7], v[156:159], 0
s_add_u32 m0, s49, 4224
s_lshl_b32 s57, s43, 14
s_lshl_b32 s53, s42, 7
s_add_u32 s57, s57, s53
v_mfma_f32_16x16x32_bf16 v[192:195], v[0:3], v[152:155], v[192:195]
s_nop 0
v_cvt_pk_bf16_f32 v46, v188, v189
v_cvt_pk_bf16_f32 v47, v190, v191
v_mfma_f32_16x16x32_bf16 v[188:191], v[40:43], v[152:155], 0
v_lshl_add_u32 v164, v85, 3, v164
v_mad_u32_u24 v164, v83, s14, v164
v_mfma_f32_16x16x32_bf16 v[188:191], v[44:47], v[156:159], v[188:191]
s_nop 0
v_exp_f32 v192, v192
v_mfma_f32_16x16x32_bf16 v[196:199], v[0:3], v[96:99], 0
v_exp_f32 v193, v193
v_mfma_f32_16x16x32_bf16 v[196:199], v[4:7], v[100:103], v[196:199]
v_exp_f32 v194, v194
s_nop 1
v_exp_f32 v188, v188
v_exp_f32 v189, v189
v_exp_f32 v190, v190
v_exp_f32 v191, v191
v_cvt_pk_bf16_f32 v114, v188, v189
v_cvt_pk_bf16_f32 v115, v190, v191
v_exp_f32 v195, v195
v_cvt_pk_bf16_f32 v104, v192, v193
v_cvt_pk_bf16_f32 v105, v194, v195
v_exp_f32 v196, v196
v_exp_f32 v197, v197
v_exp_f32 v198, v198
v_exp_f32 v199, v199
v_cvt_pk_bf16_f32 v120, v196, v197
v_cvt_pk_bf16_f32 v121, v198, v199
v_xor_b32 v164, v16, v164
v_lshl_add_u32 v181, v95, 3, s7
v_lshl_add_u32 v250, v95, 2, s52
v_lshl_add_u32 v246, v89, 7, s12
v_lshl_add_u32 v245, v84, 8, s52
v_lshl_add_u32 v246, v90, 6, v246
v_lshl_add_u32 v245, v87, 7, v245
v_lshl_add_u32 v246, v86, 3, v246
v_xor_b32 v165, 32, v164
v_lshl_add_u32 v245, v88, 6, v245
v_lshl_add_u32 v245, v82, 4, v245
v_xor_b32 v245, v92, v245
v_xor_b32 v245, v93, v245
s_mov_b32 vcc_lo, 0x33333333
s_mov_b32 vcc_hi, 0x33333333
v_mov_b32 v169, 0x3f803f80
v_cndmask_b32 v184, v184, v169, vcc
s_waitcnt vmcnt(8)
s_barrier
ds_read_b128 v[48:51], v242 offset:50688
ds_read_b128 v[52:55], v242 offset:50944
ds_read_b128 v[56:59], v242 offset:51200
ds_read_b128 v[60:63], v242 offset:51456
ds_read_b128 v[64:67], v242 offset:54912
ds_read_b128 v[68:71], v242 offset:55168
ds_read_b128 v[72:75], v242 offset:55424
ds_read_b128 v[76:79], v242 offset:55680
s_mov_b32 vcc_lo, 0xaaaaaaaa
s_mov_b32 vcc_hi, 0xaaaaaaaa
v_mov_b32 v169, 0xeeeeeeee
v_cndmask_b32 v251, v251, v169, vcc
s_mov_b32 vcc_lo, 0x0
s_mov_b32 vcc_hi, 0xaaaaaaaa
v_mov_b32 v169, 0xe4eeeeee
v_cndmask_b32 v251, v251, v169, vcc
s_mov_b32 vcc_lo, 0xffff
s_mov_b32 vcc_hi, 0xffff
v_mov_b32 v252, 0x0c0c0c0c
v_mov_b32 v169, 0x07060302
v_cndmask_b32 v252, v252, v169, vcc
s_waitcnt lgkmcnt(7)
v_mfma_f32_16x16x32_bf16 v[188:191], a[64:67], v[48:51], 0
s_waitcnt lgkmcnt(5)
buffer_load_dwordx4 v243, s[16:19], s99 offen offset:0 nt lds
v_mfma_f32_16x16x32_bf16 v[188:191], a[68:71], v[52:55], v[188:191]
s_waitcnt lgkmcnt(4)
buffer_load_dwordx4 v243, s[16:19], s100 offen offset:2112 nt lds
v_mfma_f32_16x16x32_bf16 v[188:191], a[72:75], v[56:59], v[188:191]
s_add_u32 m0, s49, 8448
s_add_u32 s99, s55, 8192
s_add_u32 s100, s55, 8128
v_mfma_f32_16x16x32_bf16 v[188:191], a[76:79], v[60:63], v[188:191]
s_mov_b32 vcc_lo, 0xffff0000
s_mov_b32 vcc_hi, 0xffff0000
v_mov_b32 v253, 0x0c0c0c0c
v_mfma_f32_16x16x32_bf16 v[192:195], a[92:95], v[60:63], 0
v_mov_b32 v169, 0x07060302
v_cndmask_b32 v253, v253, v169, vcc
v_mfma_f32_16x16x32_bf16 v[192:195], a[88:91], v[56:59], v[192:195]
s_nop 0
v_cvt_pk_bf16_f32 v136, v188, v189
v_cvt_pk_bf16_f32 v138, v190, v191
v_mfma_f32_16x16x32_bf16 v[192:195], a[84:87], v[52:55], v[192:195]
v_lshl_add_u32 v244, v84, 6, v244
v_mad_u32_u24 v181, v82, s14, v181
v_mfma_f32_16x16x32_bf16 v[192:195], a[80:83], v[48:51], v[192:195]
buffer_load_dwordx4 v243, s[16:19], s99 offen offset:0 nt lds
v_mfma_f32_16x16x32_bf16 v[188:191], a[96:99], v[48:51], 0
s_add_u32 s99, s55, 12288
buffer_load_dwordx4 v243, s[16:19], s100 offen offset:2112 nt lds
v_mfma_f32_16x16x32_bf16 v[188:191], a[100:103], v[52:55], v[188:191]
s_add_u32 m0, s49, 12672
s_add_u32 s100, s55, 12224
v_mad_u32_u24 v250, v82, s8, v250
v_mfma_f32_16x16x32_bf16 v[188:191], a[104:107], v[56:59], v[188:191]
s_waitcnt lgkmcnt(0)
v_cvt_pk_bf16_f32 v137, v192, v193
v_cvt_pk_bf16_f32 v139, v194, v195
v_mfma_f32_16x16x32_bf16 v[188:191], a[108:111], v[60:63], v[188:191]
v_lshl_add_u32 v244, v82, 4, v244
v_lshl_add_u32 v246, v91, 2, v246
v_mfma_f32_16x16x32_bf16 v[192:195], a[124:127], v[60:63], 0
s_lshl_b32 s50, s43, 12
s_add_u32 s50, s50, s44
s_add_u32 s50, s50, 13107200
v_mfma_f32_16x16x32_bf16 v[192:195], a[116:119], v[52:55], v[192:195]
s_nop 0
v_cvt_pk_bf16_f32 v140, v188, v189
v_cvt_pk_bf16_f32 v142, v190, v191
v_mfma_f32_16x16x32_bf16 v[192:195], a[112:115], v[48:51], v[192:195]
buffer_load_dwordx4 v243, s[16:19], s99 offen offset:0 nt lds
v_mfma_f32_16x16x32_bf16 v[192:195], a[120:123], v[56:59], v[192:195]
s_add_u32 s99, s55, 16384
buffer_load_dwordx4 v243, s[16:19], s100 offen offset:2112 nt lds
v_mfma_f32_16x16x32_bf16 v[196:199], a[56:59], v[56:59], 0
s_add_u32 m0, s49, 16896
s_add_u32 s100, s55, 16320
v_lshl_add_u32 v166, v89, 2, s15
v_mfma_f32_16x16x32_bf16 v[196:199], a[60:63], v[60:63], v[196:199]
s_nop 0
v_cvt_pk_bf16_f32 v141, v192, v193
v_cvt_pk_bf16_f32 v143, v194, v195
v_mfma_f32_16x16x32_bf16 v[196:199], a[52:55], v[52:55], v[196:199]
s_mul_i32 s48, s43, 3168
s_add_u32 s49, s49, s48
s_add_u32 s49, s49, 50688
s_mov_b32 s48, 8192
v_mfma_f32_16x16x32_bf16 v[196:199], a[48:51], v[48:51], v[196:199]
v_mad_u32_u24 v166, v81, s14, v166
v_mov_b32 v185, v184
v_mfma_f32_16x16x32_bf16 v[188:191], a[32:35], v[48:51], 0
ds_write_b32 v166, v236 offset:0
v_mfma_f32_16x16x32_bf16 v[188:191], a[36:39], v[52:55], v[188:191]
buffer_load_dwordx4 v243, s[16:19], s99 offen offset:0 nt lds
v_mfma_f32_16x16x32_bf16 v[188:191], a[40:43], v[56:59], v[188:191]
s_add_u32 s99, s57, 0
buffer_load_dwordx4 v243, s[16:19], s100 offen offset:2112 nt lds
v_mfma_f32_16x16x32_bf16 v[188:191], a[44:47], v[60:63], v[188:191]
s_add_u32 m0, s98, 59648
s_add_u32 s100, s57, 1024
v_cvt_pk_bf16_f32 v149, v196, v197
v_mfma_f32_16x16x32_bf16 v[192:195], a[28:31], v[60:63], 0
v_cvt_pk_bf16_f32 v151, v198, v199
v_mov_b32 v186, v184
v_mfma_f32_16x16x32_bf16 v[192:195], a[24:27], v[56:59], v[192:195]
s_waitcnt vmcnt(8)
s_barrier
v_mfma_f32_16x16x32_bf16 v[192:195], a[20:23], v[52:55], v[192:195]
ds_read_b64_tr_b16 a[176:177], v183 offset:8
v_cvt_pk_bf16_f32 v148, v188, v189
v_mfma_f32_16x16x32_bf16 v[192:195], a[16:19], v[48:51], v[192:195]
ds_read_b64_tr_b16 a[178:179], v183 offset:520
v_cvt_pk_bf16_f32 v150, v190, v191
v_mfma_f32_16x16x32_bf16 v[188:191], a[0:3], v[48:51], 0
ds_read_b64_tr_b16 a[180:181], v183 offset:4104
v_mov_b32 v187, v184
v_mfma_f32_16x16x32_bf16 v[188:191], a[8:11], v[56:59], v[188:191]
ds_read_b64_tr_b16 a[182:183], v183 offset:4616
v_mov_b32 v118, 0
v_mfma_f32_16x16x32_bf16 v[188:191], a[12:15], v[60:63], v[188:191]
ds_read_b64_tr_b16 a[184:185], v183 offset:8200
v_cvt_pk_bf16_f32 v145, v192, v193
v_mfma_f32_16x16x32_bf16 v[188:191], a[4:7], v[52:55], v[188:191]
ds_read_b64_tr_b16 a[186:187], v183 offset:8712
v_cvt_pk_bf16_f32 v147, v194, v195
v_mfma_f32_16x16x32_bf16 v[192:195], a[4:7], v[68:71], 0
ds_read_b64_tr_b16 a[188:189], v183 offset:12296
v_mov_b32 v119, 0
v_mfma_f32_16x16x32_bf16 v[192:195], a[0:3], v[64:67], v[192:195]
ds_read_b64_tr_b16 a[190:191], v183 offset:12808
v_mov_b32 v255, 0
v_mfma_f32_16x16x32_bf16 v[192:195], a[8:11], v[72:75], v[192:195]
ds_read_b64_tr_b16 a[160:161], v183 offset:0
v_cvt_pk_bf16_f32 v144, v188, v189
v_mfma_f32_16x16x32_bf16 v[192:195], a[12:15], v[76:79], v[192:195]
ds_read_b64_tr_b16 a[162:163], v183 offset:512
v_cvt_pk_bf16_f32 v146, v190, v191
v_mov_b32 v134, 0
v_mov_b32 v135, 0
v_mfma_f32_16x16x32_bf16 v[188:191], v[136:139], v[144:147], 0
ds_read_b64_tr_b16 a[164:165], v183 offset:4096
s_nop 0
v_mfma_f32_16x16x32_bf16 v[188:191], v[140:143], v[148:151], v[188:191]
ds_read_b64_tr_b16 a[166:167], v183 offset:4608
v_cvt_pk_bf16_f32 v32, v192, v193
v_mfma_f32_16x16x32_bf16 v[196:199], a[28:31], v[76:79], 0
ds_read_b64_tr_b16 a[168:169], v183 offset:8192
v_cvt_pk_bf16_f32 v34, v194, v195
v_mfma_f32_16x16x32_bf16 v[196:199], a[24:27], v[72:75], v[196:199]
s_waitcnt lgkmcnt(12)
ds_read_b64_tr_b16 a[170:171], v183 offset:8704
v_mfma_f32_16x16x32_bf16 v[196:199], a[20:23], v[68:71], v[196:199]
s_waitcnt lgkmcnt(12)
ds_read_b64_tr_b16 a[172:173], v183 offset:12288
v_mfma_f32_16x16x32_bf16 v[196:199], a[16:19], v[64:67], v[196:199]
s_waitcnt lgkmcnt(12)
ds_read_b64_tr_b16 a[174:175], v183 offset:12800
s_nop 0
v_mfma_f32_16x16x32_bf16 v[192:195], a[32:35], v[64:67], 0
s_waitcnt lgkmcnt(12)
ds_read_b64_tr_b16 a[144:145], v182 offset:8
s_nop 0
v_mfma_f32_16x16x32_bf16 v[192:195], a[36:39], v[68:71], v[192:195]
s_waitcnt lgkmcnt(12)
ds_read_b64_tr_b16 a[146:147], v182 offset:520
v_cvt_pk_bf16_f32 v33, v196, v197
v_mfma_f32_16x16x32_bf16 v[192:195], a[40:43], v[72:75], v[192:195]
s_waitcnt lgkmcnt(12)
ds_read_b64_tr_b16 a[148:149], v182 offset:4104
v_cvt_pk_bf16_f32 v35, v198, v199
v_mfma_f32_16x16x32_bf16 v[192:195], a[44:47], v[76:79], v[192:195]
s_waitcnt lgkmcnt(12)
ds_read_b64_tr_b16 a[150:151], v182 offset:4616
s_nop 0
v_mfma_f32_16x16x32_bf16 v[196:199], a[60:63], v[76:79], 0
s_waitcnt lgkmcnt(12)
ds_read_b64_tr_b16 a[152:153], v182 offset:8200
s_nop 0
v_mfma_f32_16x16x32_bf16 v[196:199], a[52:55], v[68:71], v[196:199]
s_waitcnt lgkmcnt(12)
ds_read_b64_tr_b16 a[154:155], v182 offset:8712
v_cvt_pk_bf16_f32 v36, v192, v193
v_mfma_f32_16x16x32_bf16 v[196:199], a[48:51], v[64:67], v[196:199]
s_waitcnt lgkmcnt(12)
ds_read_b64_tr_b16 a[156:157], v182 offset:12296
v_cvt_pk_bf16_f32 v38, v194, v195
v_mfma_f32_16x16x32_bf16 v[196:199], a[56:59], v[72:75], v[196:199]
s_waitcnt lgkmcnt(12)
ds_read_b64_tr_b16 a[158:159], v182 offset:12808
s_nop 0
v_mfma_f32_16x16x32_bf16 v[192:195], a[120:123], v[72:75], 0
s_waitcnt lgkmcnt(12)
ds_read_b64_tr_b16 a[128:129], v182 offset:0
s_nop 0
v_mfma_f32_16x16x32_bf16 v[192:195], a[124:127], v[76:79], v[192:195]
s_waitcnt lgkmcnt(12)
ds_read_b64_tr_b16 a[130:131], v182 offset:512
v_cvt_pk_bf16_f32 v37, v196, v197
v_mfma_f32_16x16x32_bf16 v[192:195], a[116:119], v[68:71], v[192:195]
s_waitcnt lgkmcnt(12)
ds_read_b64_tr_b16 a[132:133], v182 offset:4096
v_cvt_pk_bf16_f32 v39, v198, v199
v_mfma_f32_16x16x32_bf16 v[192:195], a[112:115], v[64:67], v[192:195]
s_waitcnt lgkmcnt(12)
ds_read_b64_tr_b16 a[134:135], v182 offset:4608
s_nop 0
v_mfma_f32_16x16x32_bf16 v[196:199], a[96:99], v[64:67], 0
s_waitcnt lgkmcnt(12)
ds_read_b64_tr_b16 a[136:137], v182 offset:8192
s_nop 0
v_mfma_f32_16x16x32_bf16 v[196:199], a[100:103], v[68:71], v[196:199]
s_waitcnt lgkmcnt(12)
ds_read_b64_tr_b16 a[138:139], v182 offset:8704
v_cvt_pk_bf16_f32 v29, v192, v193
v_mfma_f32_16x16x32_bf16 v[196:199], a[104:107], v[72:75], v[196:199]
s_waitcnt lgkmcnt(12)
ds_read_b64_tr_b16 a[140:141], v182 offset:12288
v_cvt_pk_bf16_f32 v31, v194, v195
v_mfma_f32_16x16x32_bf16 v[196:199], a[108:111], v[76:79], v[196:199]
s_waitcnt lgkmcnt(12)
ds_read_b64_tr_b16 a[142:143], v182 offset:12800
s_nop 0
v_mfma_f32_16x16x32_bf16 v[192:195], a[92:95], v[76:79], 0
s_waitcnt lgkmcnt(12)
v_exp_f32 v188, v188
v_mfma_f32_16x16x32_bf16 v[192:195], a[88:91], v[72:75], v[192:195]
s_waitcnt lgkmcnt(11)
v_cvt_pk_bf16_f32 v28, v196, v197
v_cvt_pk_bf16_f32 v30, v198, v199
v_mfma_f32_16x16x32_bf16 v[192:195], a[84:87], v[68:71], v[192:195]
s_waitcnt lgkmcnt(10)
v_exp_f32 v189, v189
v_mfma_f32_16x16x32_bf16 v[192:195], a[80:83], v[64:67], v[192:195]
s_waitcnt lgkmcnt(9)
v_add_f32 v160, v188, v189
v_cvt_pk_bf16_f32 v188, v188, v189
v_mfma_f32_16x16x32_bf16 v[196:199], a[64:67], v[64:67], 0
s_waitcnt lgkmcnt(8)
ds_write_b32 v167, v188 offset:0
v_mfma_f32_16x16x32_bf16 v[196:199], a[68:71], v[68:71], v[196:199]
s_waitcnt lgkmcnt(8)
v_cvt_pk_bf16_f32 v25, v192, v193
v_cvt_pk_bf16_f32 v27, v194, v195
v_mfma_f32_16x16x32_bf16 v[196:199], a[72:75], v[72:75], v[196:199]
s_waitcnt lgkmcnt(7)
v_exp_f32 v190, v190
v_mfma_f32_16x16x32_bf16 v[196:199], a[76:79], v[76:79], v[196:199]
s_waitcnt lgkmcnt(6)
v_exp_f32 v191, v191
v_mfma_f32_16x16x32_bf16 v[192:195], v[76:79], a[188:191], 0
s_waitcnt lgkmcnt(5)
v_cvt_pk_bf16_f32 v189, v190, v191
v_add_f32 v161, v190, v191
v_mfma_f32_16x16x32_bf16 v[192:195], v[72:75], a[184:187], v[192:195]
s_waitcnt lgkmcnt(4)
ds_write_b32 v167, v189 offset:4
v_mfma_f32_16x16x32_bf16 v[192:195], v[68:71], a[180:183], v[192:195]
s_waitcnt lgkmcnt(4)
ds_write_b32 v164, v136 offset:0
v_mfma_f32_16x16x32_bf16 v[192:195], v[64:67], a[176:179], v[192:195]
s_waitcnt lgkmcnt(4)
ds_write_b32 v164, v137 offset:4
v_mfma_f32_16x16x32_bf16 v[204:207], v[64:67], a[160:163], 0
s_waitcnt lgkmcnt(4)
ds_write_b32 v164, v138 offset:64
v_mfma_f32_16x16x32_bf16 v[204:207], v[68:71], a[164:167], v[204:207]
ds_write_b32 v164, v139 offset:68
v_mfma_f32_16x16x32_bf16 v[204:207], v[72:75], a[168:171], v[204:207]
ds_write_b32 v165, v140 offset:0
v_mfma_f32_16x16x32_bf16 v[204:207], v[76:79], a[172:175], v[204:207]
ds_write_b32 v165, v141 offset:4
v_cvt_pk_bf16_f32 v24, v196, v197
v_cvt_pk_bf16_f32 v26, v198, v199
v_cvt_pk_bf16_f32 v14, v192, v193
v_cvt_pk_bf16_f32 v15, v194, v195
v_mfma_f32_16x16x32_bf16 v[192:195], v[24:27], v[32:35], 0
ds_write_b32 v165, v142 offset:64
v_mfma_f32_16x16x32_bf16 v[192:195], v[28:31], v[36:39], v[192:195]
ds_write_b32 v165, v143 offset:68
v_mfma_f32_16x16x32_bf16 v[196:199], v[76:79], a[156:159], 0
ds_read_b128 v[238:241], v245 offset:0
v_add_f32 v190, v160, v161
v_mfma_f32_16x16x32_bf16 v[196:199], v[72:75], a[152:155], v[196:199]
ds_write_b32 v167, v190 offset:8
v_mfma_f32_16x16x32_bf16 v[196:199], v[68:71], a[148:151], v[196:199]
s_nop 0
v_exp_f32 v192, v192
v_mfma_f32_16x16x32_bf16 v[196:199], v[64:67], a[144:147], v[196:199]
v_exp_f32 v193, v193
v_mfma_f32_16x16x32_bf16 v[188:191], v[64:67], a[128:131], 0
v_add_f32 v160, v192, v193
v_cvt_pk_bf16_f32 v192, v192, v193
v_mfma_f32_16x16x32_bf16 v[188:191], v[72:75], a[136:139], v[188:191]
ds_write_b32 v167, v192 offset:256
v_mfma_f32_16x16x32_bf16 v[188:191], v[76:79], a[140:143], v[188:191]
s_nop 0
v_cvt_pk_bf16_f32 v10, v196, v197
v_cvt_pk_bf16_f32 v11, v198, v199
v_mfma_f32_16x16x32_bf16 v[188:191], v[68:71], a[132:135], v[188:191]
v_exp_f32 v194, v194
v_mfma_f32_16x16x32_bf16 v[196:199], v[52:55], a[132:135], 0
v_exp_f32 v195, v195
v_mfma_f32_16x16x32_bf16 v[196:199], v[48:51], a[128:131], v[196:199]
v_cvt_pk_bf16_f32 v193, v194, v195
v_add_f32 v161, v194, v195
v_mfma_f32_16x16x32_bf16 v[196:199], v[56:59], a[136:139], v[196:199]
ds_write_b32 v167, v193 offset:260
v_mfma_f32_16x16x32_bf16 v[196:199], v[60:63], a[140:143], v[196:199]
v_cvt_pk_bf16_f32 v8, v188, v189
v_cvt_pk_bf16_f32 v9, v190, v191
v_mfma_f32_16x16x32_bf16 v[188:191], v[60:63], a[156:159], 0
v_add_f32 v194, v160, v161
v_cvt_pk_bf16_f32 v12, v204, v205
v_mfma_f32_16x16x32_bf16 v[188:191], v[56:59], a[152:155], v[188:191]
s_waitcnt lgkmcnt(3)
ds_write_b32 v167, v194 offset:264
v_mfma_f32_16x16x32_bf16 v[188:191], v[52:55], a[148:151], v[188:191]
v_cvt_pk_bf16_f32 v16, v196, v197
v_cvt_pk_bf16_f32 v17, v198, v199
v_mfma_f32_16x16x32_bf16 v[188:191], v[48:51], a[144:147], v[188:191]
v_cvt_pk_bf16_f32 v13, v206, v207
s_nop 0
v_mfma_f32_16x16x32_bf16 v[192:195], v[48:51], a[160:163], 0
ds_write_b32 v181, v14 offset:7296
v_mfma_f32_16x16x32_bf16 v[192:195], v[52:55], a[164:167], v[192:195]
ds_read_b128 v[196:199], v242 offset:256
ds_read_b128 v[204:207], v242 offset:0
v_mfma_f32_16x16x32_bf16 v[192:195], v[56:59], a[168:171], v[192:195]
ds_read_b128 v[208:211], v242 offset:512
v_cvt_pk_bf16_f32 v18, v188, v189
v_mfma_f32_16x16x32_bf16 v[192:195], v[60:63], a[172:175], v[192:195]
ds_read_b128 v[232:235], v242 offset:768
v_mov_b64 v[224:225], s[96:97]
v_mfma_f32_16x16x32_bf16 v[228:231], v[60:63], a[188:191], 0
v_mov_b64 v[226:227], s[96:97]
v_cvt_pk_bf16_f32 v19, v190, v191
v_mfma_f32_16x16x32_bf16 v[228:231], v[56:59], a[184:187], v[228:231]
v_mov_b64 v[188:189], s[96:97]
v_mov_b64 v[190:191], s[96:97]
v_mfma_f32_16x16x32_bf16 v[228:231], v[52:55], a[180:183], v[228:231]
v_cvt_pk_bf16_f32 v20, v192, v193
v_cvt_pk_bf16_f32 v21, v194, v195
v_mfma_f32_16x16x32_bf16 v[228:231], v[48:51], a[176:179], v[228:231]
ds_write_b32 v181, v15 offset:7300
v_smfmac_f32_16x16x64_bf16 v[224:227], v[238:241], v[152:159], v251
ds_write_b32 v181, v12 offset:7168
v_smfmac_f32_16x16x64_bf16 v[188:191], v[238:241], v[96:103], v251
ds_write_b32 v181, v13 offset:7172
v_mfma_f32_16x16x32_bf16 v[192:195], v[220:223], a[188:191], 0
s_nop 1
v_cvt_pk_bf16_f32 v22, v228, v229
v_mfma_f32_16x16x32_bf16 v[192:195], v[216:219], a[184:187], v[192:195]
v_cvt_pk_bf16_f32 v23, v230, v231
v_add_f32 v224, v224, v225
v_mfma_f32_16x16x32_bf16 v[192:195], v[212:215], a[180:183], v[192:195]
v_add_f32 v188, v188, v189
v_add_f32 v190, v190, v191
v_mfma_f32_16x16x32_bf16 v[192:195], v[200:203], a[176:179], v[192:195]
v_exp_f32 v188, v188
v_mfma_f32_16x16x32_bf16 v[228:231], v[200:203], a[160:163], 0
s_waitcnt lgkmcnt(5)
v_exp_f32 v190, v190
v_mfma_f32_16x16x32_bf16 v[228:231], v[212:215], a[164:167], v[228:231]
s_waitcnt lgkmcnt(4)
v_perm_b32 v132, v190, v188, v252
v_perm_b32 v133, v190, v188, v253
v_mfma_f32_16x16x32_bf16 v[228:231], v[216:219], a[168:171], v[228:231]
s_waitcnt lgkmcnt(3)
v_cvt_pk_bf16_f32 v94, v192, v193
v_cvt_pk_bf16_f32 v95, v194, v195
v_mfma_f32_16x16x32_bf16 v[228:231], v[220:223], a[172:175], v[228:231]
v_add_f32 v226, v226, v227
s_nop 0
v_mfma_f32_16x16x32_bf16 v[192:195], v[220:223], a[156:159], 0
ds_write_b32 v181, v10 offset:7040
v_mfma_f32_16x16x32_bf16 v[192:195], v[216:219], a[152:155], v[192:195]
ds_write_b32 v181, v11 offset:7044
v_mfma_f32_16x16x32_bf16 v[192:195], v[212:215], a[148:151], v[192:195]
ds_write_b32 v181, v8 offset:6912
v_mfma_f32_16x16x32_bf16 v[192:195], v[200:203], a[144:147], v[192:195]
ds_write_b32 v181, v9 offset:6916
v_mfma_f32_16x16x32_bf16 v[188:191], v[200:203], a[128:131], 0
v_exp_f32 v224, v224
v_mfma_f32_16x16x32_bf16 v[188:191], v[216:219], a[136:139], v[188:191]
v_exp_f32 v226, v226
v_mfma_f32_16x16x32_bf16 v[188:191], v[220:223], a[140:143], v[188:191]
v_perm_b32 v116, v226, v224, v252
v_perm_b32 v117, v226, v224, v253
v_mfma_f32_16x16x32_bf16 v[188:191], v[212:215], a[132:135], v[188:191]
v_cvt_pk_bf16_f32 v86, v192, v193
v_cvt_pk_bf16_f32 v87, v194, v195
v_mfma_f32_16x16x32_bf16 v[192:195], v[196:199], a[132:135], 0
v_cvt_pk_bf16_f32 v90, v228, v229
v_cvt_pk_bf16_f32 v91, v230, v231
v_mfma_f32_16x16x32_bf16 v[192:195], v[204:207], a[128:131], v[192:195]
s_nop 1
v_cvt_pk_bf16_f32 v82, v188, v189
v_mfma_f32_16x16x32_bf16 v[192:195], v[208:211], a[136:139], v[192:195]
s_waitcnt vmcnt(4)
s_barrier
v_mfma_f32_16x16x32_bf16 v[192:195], v[232:235], a[140:143], v[192:195]
ds_read_b128 v[200:203], v242 offset:4224
v_cvt_pk_bf16_f32 v83, v190, v191
v_mfma_f32_16x16x32_bf16 v[224:227], v[232:235], a[156:159], 0
ds_read_b128 v[212:215], v242 offset:4480
ds_read_b128 v[216:219], v242 offset:4736
v_mfma_f32_16x16x32_bf16 v[224:227], v[208:211], a[152:155], v[224:227]
ds_read_b128 v[220:223], v242 offset:4992
v_mfma_f32_16x16x32_bf16 v[224:227], v[196:199], a[148:151], v[224:227]
v_cvt_pk_bf16_f32 v48, v192, v193
v_cvt_pk_bf16_f32 v49, v194, v195
v_mfma_f32_16x16x32_bf16 v[224:227], v[204:207], a[144:147], v[224:227]
ds_write_b32 v181, v16 offset:0
v_mfma_f32_16x16x32_bf16 v[188:191], v[204:207], a[160:163], 0
buffer_load_dwordx4 v174, s[36:39], s99 offen offset:0 lds
v_mfma_f32_16x16x32_bf16 v[188:191], v[196:199], a[164:167], v[188:191]
s_add_u32 s99, s57, 2048
buffer_load_dwordx4 v174, s[36:39], s100 offen offset:1024 lds
v_mfma_f32_16x16x32_bf16 v[188:191], v[208:211], a[168:171], v[188:191]
s_add_u32 s100, s57, 3072
v_cvt_pk_bf16_f32 v52, v224, v225
v_cvt_pk_bf16_f32 v53, v226, v227
v_mfma_f32_16x16x32_bf16 v[188:191], v[232:235], a[172:175], v[188:191]
ds_write_b32 v181, v17 offset:4
v_mfma_f32_16x16x32_bf16 v[192:195], v[232:235], a[188:191], 0
ds_write_b32 v181, v18 offset:128
v_mfma_f32_16x16x32_bf16 v[192:195], v[208:211], a[184:187], v[192:195]
ds_write_b32 v181, v19 offset:132
v_mfma_f32_16x16x32_bf16 v[192:195], v[196:199], a[180:183], v[192:195]
L_h1:
s_cbranch_execz L_h5
s_waitcnt lgkmcnt(7)
s_nop 0
v_cvt_pk_bf16_f32 v56, v188, v189
v_mfma_f32_16x16x32_bf16 v[192:195], v[204:207], a[176:179], v[192:195]
s_waitcnt lgkmcnt(6)
v_cvt_pk_bf16_f32 v57, v190, v191
s_nop 0
v_mfma_f32_16x16x32_bf16 v[188:191], a[64:67], v[200:203], 0
s_waitcnt lgkmcnt(5)
ds_write_b32 v181, v20 offset:256
v_mfma_f32_16x16x32_bf16 v[188:191], a[68:71], v[212:215], v[188:191]
s_waitcnt lgkmcnt(5)
v_cvt_pk_bf16_f32 v60, v192, v193
v_cvt_pk_bf16_f32 v61, v194, v195
v_mfma_f32_16x16x32_bf16 v[188:191], a[72:75], v[216:219], v[188:191]
buffer_load_dwordx4 v174, s[36:39], s99 offen offset:2048 lds
v_mfma_f32_16x16x32_bf16 v[188:191], a[76:79], v[220:223], v[188:191]
s_add_u32 s99, s57, 8192
buffer_load_dwordx4 v174, s[36:39], s100 offen offset:3072 lds
v_mfma_f32_16x16x32_bf16 v[192:195], a[92:95], v[220:223], 0
s_add_u32 m0, s98, 63744
s_add_u32 s100, s57, 9216
s_mov_b32 s98, s50
v_mfma_f32_16x16x32_bf16 v[192:195], a[88:91], v[216:219], v[192:195]
s_nop 0
v_cvt_pk_bf16_f32 v8, v188, v189
v_cvt_pk_bf16_f32 v9, v190, v191
v_mfma_f32_16x16x32_bf16 v[192:195], a[84:87], v[212:215], v[192:195]
ds_write_b32 v181, v21 offset:260
v_mfma_f32_16x16x32_bf16 v[192:195], a[80:83], v[200:203], v[192:195]
ds_write_b32 v181, v22 offset:384
v_mfma_f32_16x16x32_bf16 v[188:191], a[96:99], v[200:203], 0
ds_write_b32 v181, v23 offset:388
v_mfma_f32_16x16x32_bf16 v[188:191], a[100:103], v[212:215], v[188:191]
ds_read2_b32 v[236:237], v246 offset0:0 offset1:8
s_nop 0
v_mfma_f32_16x16x32_bf16 v[188:191], a[104:107], v[216:219], v[188:191]
s_nop 0
v_cvt_pk_bf16_f32 v10, v192, v193
v_cvt_pk_bf16_f32 v11, v194, v195
v_mfma_f32_16x16x32_bf16 v[188:191], a[108:111], v[220:223], v[188:191]
ds_write_b32 v164, v144 offset:512
v_mfma_f32_16x16x32_bf16 v[192:195], a[124:127], v[220:223], 0
buffer_load_dwordx4 v174, s[36:39], s99 offen offset:0 lds
v_mfma_f32_16x16x32_bf16 v[192:195], a[120:123], v[216:219], v[192:195]
s_add_u32 s99, s57, 10240
buffer_load_dwordx4 v174, s[36:39], s100 offen offset:1024 lds
v_mfma_f32_16x16x32_bf16 v[192:195], a[116:119], v[212:215], v[192:195]
s_add_u32 s100, s57, 11264
v_cvt_pk_bf16_f32 v12, v188, v189
v_cvt_pk_bf16_f32 v13, v190, v191
v_mfma_f32_16x16x32_bf16 v[192:195], a[112:115], v[200:203], v[192:195]
ds_write_b32 v164, v145 offset:516
v_mfma_f32_16x16x32_bf16 v[188:191], v[200:203], a[128:131], 0
ds_write_b32 v164, v146 offset:576
v_mfma_f32_16x16x32_bf16 v[188:191], v[212:215], a[132:135], v[188:191]
ds_write_b32 v164, v147 offset:580
v_mfma_f32_16x16x32_bf16 v[188:191], v[216:219], a[136:139], v[188:191]
s_nop 1
v_cvt_pk_bf16_f32 v14, v192, v193
v_mfma_f32_16x16x32_bf16 v[188:191], v[220:223], a[140:143], v[188:191]
v_cvt_pk_bf16_f32 v15, v194, v195
s_nop 1
v_mfma_f32_16x16x32_bf16 v[192:195], v[12:15], v[156:159], 0
ds_write_b32 v165, v148 offset:512
v_mfma_f32_16x16x32_bf16 v[192:195], v[8:11], v[152:155], v[192:195]
s_nop 1
v_cvt_pk_bf16_f32 v50, v188, v189
v_mfma_f32_16x16x32_bf16 v[196:199], v[8:11], v[96:99], 0
s_waitcnt lgkmcnt(5)
buffer_load_dwordx4 v174, s[36:39], s99 offen offset:2048 lds
v_mfma_f32_16x16x32_bf16 v[196:199], v[12:15], v[100:103], v[196:199]
s_add_u32 s99, s98, s51
buffer_load_dwordx4 v174, s[36:39], s100 offen offset:3072 lds
v_mfma_f32_16x16x32_bf16 v[204:207], v[220:223], a[156:159], 0
s_add_u32 s100, s99, s51
ds_read_b128 v[208:211], v242 offset:8448
ds_read_b128 v[224:227], v242 offset:8704
v_mfma_f32_16x16x32_bf16 v[204:207], v[216:219], a[152:155], v[204:207]
s_add_u32 m0, s49, 0
ds_read_b128 v[228:231], v242 offset:8960
v_cvt_pk_bf16_f32 v51, v190, v191
v_mfma_f32_16x16x32_bf16 v[204:207], v[212:215], a[148:151], v[204:207]
s_add_u32 s101, s100, s51
ds_read_b128 v[188:191], v242 offset:9216
v_mfma_f32_16x16x32_bf16 v[204:207], v[200:203], a[144:147], v[204:207]
v_exp_f32 v192, v192
v_mfma_f32_16x16x32_bf16 v[232:235], v[200:203], a[160:163], 0
v_exp_f32 v193, v193
v_mfma_f32_16x16x32_bf16 v[232:235], v[212:215], a[164:167], v[232:235]
v_exp_f32 v194, v194
v_mfma_f32_16x16x32_bf16 v[232:235], v[216:219], a[168:171], v[232:235]
v_exp_f32 v195, v195
v_mfma_f32_16x16x32_bf16 v[232:235], v[220:223], a[172:175], v[232:235]
v_cvt_pk_bf16_f32 v54, v204, v205
v_cvt_pk_bf16_f32 v55, v206, v207
v_mfma_f32_16x16x32_bf16 v[204:207], v[220:223], a[188:191], 0
v_cvt_pk_bf16_f32 v106, v192, v193
v_cvt_pk_bf16_f32 v107, v194, v195
v_mfma_f32_16x16x32_bf16 v[204:207], v[216:219], a[184:187], v[204:207]
v_exp_f32 v196, v196
v_mfma_f32_16x16x32_bf16 v[204:207], v[212:215], a[180:183], v[204:207]
s_waitcnt lgkmcnt(3)
v_cvt_pk_bf16_f32 v58, v232, v233
v_cvt_pk_bf16_f32 v59, v234, v235
v_mfma_f32_16x16x32_bf16 v[204:207], v[200:203], a[176:179], v[204:207]
buffer_load_dwordx4 v243, s[16:19], s98 offen offset:0 nt lds
v_mfma_f32_16x16x32_bf16 v[192:195], a[64:67], v[208:211], 0
s_waitcnt lgkmcnt(1)
v_exp_f32 v197, v197
v_mfma_f32_16x16x32_bf16 v[192:195], a[68:71], v[224:227], v[192:195]
s_waitcnt lgkmcnt(0)
v_exp_f32 v198, v198
v_mfma_f32_16x16x32_bf16 v[192:195], a[72:75], v[228:231], v[192:195]
v_cvt_pk_bf16_f32 v62, v204, v205
v_cvt_pk_bf16_f32 v63, v206, v207
v_mfma_f32_16x16x32_bf16 v[192:195], a[76:79], v[188:191], v[192:195]
v_exp_f32 v199, v199
v_mfma_f32_16x16x32_bf16 v[204:207], a[92:95], v[188:191], 0
v_cvt_pk_bf16_f32 v122, v196, v197
v_cvt_pk_bf16_f32 v123, v198, v199
v_mfma_f32_16x16x32_bf16 v[204:207], a[88:91], v[228:231], v[204:207]
ds_write_b32 v165, v149 offset:516
v_mfma_f32_16x16x32_bf16 v[204:207], a[84:87], v[224:227], v[204:207]
s_nop 0
v_cvt_pk_bf16_f32 v16, v192, v193
v_cvt_pk_bf16_f32 v17, v194, v195
v_mfma_f32_16x16x32_bf16 v[204:207], a[80:83], v[208:211], v[204:207]
buffer_load_dwordx4 v243, s[16:19], s99 offen offset:1056 nt lds
v_mfma_f32_16x16x32_bf16 v[232:235], a[96:99], v[208:211], 0
ds_write_b32 v165, v150 offset:576
v_mfma_f32_16x16x32_bf16 v[232:235], a[100:103], v[224:227], v[232:235]
ds_write_b32 v165, v151 offset:580
v_mfma_f32_16x16x32_bf16 v[232:235], a[104:107], v[228:231], v[232:235]
s_nop 1
v_cvt_pk_bf16_f32 v18, v204, v205
v_mfma_f32_16x16x32_bf16 v[232:235], a[108:111], v[188:191], v[232:235]
v_cvt_pk_bf16_f32 v19, v206, v207
s_nop 0
v_mfma_f32_16x16x32_bf16 v[192:195], a[124:127], v[188:191], 0
ds_write_b32 v164, v32 offset:7424
v_mfma_f32_16x16x32_bf16 v[192:195], a[120:123], v[228:231], v[192:195]
ds_write_b32 v164, v33 offset:7428
v_mfma_f32_16x16x32_bf16 v[192:195], a[116:119], v[224:227], v[192:195]
s_nop 0
v_cvt_pk_bf16_f32 v20, v232, v233
v_cvt_pk_bf16_f32 v21, v234, v235
v_mfma_f32_16x16x32_bf16 v[192:195], a[112:115], v[208:211], v[192:195]
buffer_load_dwordx4 v243, s[16:19], s100 offen offset:2112 nt lds
v_mfma_f32_16x16x32_bf16 v[196:199], v[208:211], a[128:131], 0
ds_write_b32 v164, v34 offset:7488
v_mfma_f32_16x16x32_bf16 v[196:199], v[224:227], a[132:135], v[196:199]
ds_write_b32 v164, v35 offset:7492
v_mfma_f32_16x16x32_bf16 v[196:199], v[228:231], a[136:139], v[196:199]
s_nop 1
v_cvt_pk_bf16_f32 v22, v192, v193
v_mfma_f32_16x16x32_bf16 v[196:199], v[188:191], a[140:143], v[196:199]
v_cvt_pk_bf16_f32 v23, v194, v195
s_nop 1
v_mfma_f32_16x16x32_bf16 v[192:195], v[20:23], v[156:159], 0
ds_write_b32 v165, v36 offset:7424
v_mfma_f32_16x16x32_bf16 v[192:195], v[16:19], v[152:155], v[192:195]
ds_write_b32 v165, v37 offset:7428
v_mfma_f32_16x16x32_bf16 v[204:207], v[16:19], v[96:99], 0
v_cvt_pk_bf16_f32 v64, v196, v197
v_cvt_pk_bf16_f32 v65, v198, v199
v_mfma_f32_16x16x32_bf16 v[204:207], v[20:23], v[100:103], v[204:207]
buffer_load_dwordx4 v243, s[16:19], s101 offen offset:3168 nt lds
v_mfma_f32_16x16x32_bf16 v[196:199], v[188:191], a[156:159], 0
ds_write_b32 v165, v38 offset:7488
v_mfma_f32_16x16x32_bf16 v[196:199], v[228:231], a[152:155], v[196:199]
ds_write_b32 v165, v39 offset:7492
v_mfma_f32_16x16x32_bf16 v[196:199], v[224:227], a[148:151], v[196:199]
v_exp_f32 v192, v192
v_mfma_f32_16x16x32_bf16 v[196:199], v[208:211], a[144:147], v[196:199]
s_waitcnt vmcnt(4)
s_barrier
v_mfma_f32_16x16x32_bf16 v[232:235], v[208:211], a[160:163], 0
ds_read_b128 v[200:203], v242 offset:16896
ds_read_b128 v[212:215], v242 offset:17152
v_mfma_f32_16x16x32_bf16 v[232:235], v[224:227], a[164:167], v[232:235]
ds_read_b128 v[216:219], v242 offset:17408
ds_read_b128 v[220:223], v242 offset:17664
v_mfma_f32_16x16x32_bf16 v[232:235], v[228:231], a[168:171], v[232:235]
v_cvt_pk_bf16_f32 v68, v196, v197
v_cvt_pk_bf16_f32 v69, v198, v199
v_mfma_f32_16x16x32_bf16 v[232:235], v[188:191], a[172:175], v[232:235]
v_exp_f32 v193, v193
v_mfma_f32_16x16x32_bf16 v[196:199], v[188:191], a[188:191], 0
ds_read_b64_tr_b16 a[192:193], v182 offset:0
v_cvt_pk_bf16_f32 v108, v192, v193
v_mfma_f32_16x16x32_bf16 v[196:199], v[228:231], a[184:187], v[196:199]
ds_read_b64_tr_b16 a[194:195], v182 offset:512
s_nop 0
v_mfma_f32_16x16x32_bf16 v[196:199], v[224:227], a[180:183], v[196:199]
s_waitcnt lgkmcnt(5)
ds_read_b64_tr_b16 a[196:197], v182 offset:4096
v_cvt_pk_bf16_f32 v72, v232, v233
v_mfma_f32_16x16x32_bf16 v[196:199], v[208:211], a[176:179], v[196:199]
s_waitcnt lgkmcnt(5)
ds_read_b64_tr_b16 a[198:199], v182 offset:4608
v_cvt_pk_bf16_f32 v73, v234, v235
v_mfma_f32_16x16x32_bf16 v[188:191], a[64:67], v[200:203], 0
s_waitcnt lgkmcnt(5)
ds_read_b64_tr_b16 a[200:201], v182 offset:8192
s_nop 0
v_mfma_f32_16x16x32_bf16 v[188:191], a[68:71], v[212:215], v[188:191]
s_waitcnt lgkmcnt(5)
ds_read_b64_tr_b16 a[202:203], v182 offset:8704
v_cvt_pk_bf16_f32 v76, v196, v197
v_mfma_f32_16x16x32_bf16 v[188:191], a[72:75], v[216:219], v[188:191]
ds_read_b64_tr_b16 a[204:205], v182 offset:12288
v_cvt_pk_bf16_f32 v77, v198, v199
v_mfma_f32_16x16x32_bf16 v[188:191], a[76:79], v[220:223], v[188:191]
ds_read_b64_tr_b16 a[206:207], v182 offset:12800
v_exp_f32 v194, v194
v_exp_f32 v195, v195
s_nop 0
v_cvt_pk_bf16_f32 v109, v194, v195
v_mfma_f32_16x16x32_bf16 v[192:195], a[92:95], v[220:223], 0
ds_read_b64_tr_b16 a[208:209], v182 offset:8
v_mfma_f32_16x16x32_bf16 v[192:195], a[88:91], v[216:219], v[192:195]
ds_read_b64_tr_b16 a[210:211], v182 offset:520
v_cvt_pk_bf16_f32 v32, v188, v189
v_mfma_f32_16x16x32_bf16 v[192:195], a[84:87], v[212:215], v[192:195]
ds_read_b64_tr_b16 a[212:213], v182 offset:4104
v_cvt_pk_bf16_f32 v33, v190, v191
v_mfma_f32_16x16x32_bf16 v[192:195], a[80:83], v[200:203], v[192:195]
ds_read_b64_tr_b16 a[214:215], v182 offset:4616
s_nop 0
v_mfma_f32_16x16x32_bf16 v[188:191], a[96:99], v[200:203], 0
s_waitcnt lgkmcnt(11)
ds_read_b64_tr_b16 a[216:217], v182 offset:8200
s_nop 0
v_mfma_f32_16x16x32_bf16 v[188:191], a[100:103], v[212:215], v[188:191]
s_waitcnt lgkmcnt(11)
ds_read_b64_tr_b16 a[218:219], v182 offset:8712
v_cvt_pk_bf16_f32 v34, v192, v193
v_mfma_f32_16x16x32_bf16 v[188:191], a[104:107], v[216:219], v[188:191]
s_waitcnt lgkmcnt(11)
ds_read_b64_tr_b16 a[220:221], v182 offset:12296
v_cvt_pk_bf16_f32 v35, v194, v195
v_mfma_f32_16x16x32_bf16 v[188:191], a[108:111], v[220:223], v[188:191]
s_waitcnt lgkmcnt(11)
ds_read_b64_tr_b16 a[222:223], v182 offset:12808
s_nop 0
v_mfma_f32_16x16x32_bf16 v[192:195], a[124:127], v[220:223], 0
s_waitcnt lgkmcnt(11)
ds_read_b64_tr_b16 a[224:225], v183 offset:0
s_nop 0
v_mfma_f32_16x16x32_bf16 v[192:195], a[120:123], v[216:219], v[192:195]
s_waitcnt lgkmcnt(11)
ds_read_b64_tr_b16 a[226:227], v183 offset:512
v_cvt_pk_bf16_f32 v36, v188, v189
v_mfma_f32_16x16x32_bf16 v[192:195], a[116:119], v[212:215], v[192:195]
s_waitcnt lgkmcnt(11)
ds_read_b64_tr_b16 a[228:229], v183 offset:4096
v_cvt_pk_bf16_f32 v37, v190, v191
v_mfma_f32_16x16x32_bf16 v[192:195], a[112:115], v[200:203], v[192:195]
s_waitcnt lgkmcnt(11)
ds_read_b64_tr_b16 a[230:231], v183 offset:4608
s_nop 0
v_mfma_f32_16x16x32_bf16 v[188:191], v[200:203], a[128:131], 0
ds_read_b64_tr_b16 a[232:233], v183 offset:8192
s_nop 0
v_mfma_f32_16x16x32_bf16 v[188:191], v[212:215], a[132:135], v[188:191]
s_waitcnt lgkmcnt(12)
ds_read_b64_tr_b16 a[234:235], v183 offset:8704
v_cvt_pk_bf16_f32 v38, v192, v193
v_mfma_f32_16x16x32_bf16 v[188:191], v[216:219], a[136:139], v[188:191]
s_waitcnt lgkmcnt(12)
ds_read_b64_tr_b16 a[236:237], v183 offset:12288
v_cvt_pk_bf16_f32 v39, v194, v195
v_mfma_f32_16x16x32_bf16 v[188:191], v[220:223], a[140:143], v[188:191]
s_waitcnt lgkmcnt(12)
ds_read_b64_tr_b16 a[238:239], v183 offset:12800
s_nop 0
v_mfma_f32_16x16x32_bf16 v[192:195], v[36:39], v[156:159], 0
s_waitcnt lgkmcnt(12)
ds_read_b64_tr_b16 a[240:241], v183 offset:8
s_nop 0
v_mfma_f32_16x16x32_bf16 v[192:195], v[32:35], v[152:155], v[192:195]
s_waitcnt lgkmcnt(12)
ds_read_b64_tr_b16 a[242:243], v183 offset:520
v_cvt_pk_bf16_f32 v80, v188, v189
v_mfma_f32_16x16x32_bf16 v[196:199], v[32:35], v[96:99], 0
s_waitcnt lgkmcnt(12)
ds_write_b32 v164, v24 offset:6912
v_mfma_f32_16x16x32_bf16 v[196:199], v[36:39], v[100:103], v[196:199]
s_waitcnt lgkmcnt(12)
ds_read_b128 v[208:211], v242 offset:12672
ds_read_b128 v[224:227], v242 offset:12928
v_mfma_f32_16x16x32_bf16 v[228:231], v[220:223], a[156:159], 0
s_waitcnt lgkmcnt(13)
ds_write_b32 v164, v25 offset:6916
v_mfma_f32_16x16x32_bf16 v[228:231], v[216:219], a[152:155], v[228:231]
s_waitcnt lgkmcnt(13)
ds_write_b32 v164, v26 offset:6976
v_mfma_f32_16x16x32_bf16 v[228:231], v[212:215], a[148:151], v[228:231]
s_waitcnt lgkmcnt(13)
ds_write_b32 v164, v27 offset:6980
v_mfma_f32_16x16x32_bf16 v[228:231], v[200:203], a[144:147], v[228:231]
s_waitcnt lgkmcnt(13)
ds_write_b32 v165, v28 offset:6912
v_mfma_f32_16x16x32_bf16 v[232:235], v[200:203], a[160:163], 0
s_waitcnt lgkmcnt(13)
ds_write_b32 v165, v29 offset:6916
v_mfma_f32_16x16x32_bf16 v[232:235], v[212:215], a[164:167], v[232:235]
s_waitcnt lgkmcnt(13)
ds_write_b32 v165, v30 offset:6976
v_mfma_f32_16x16x32_bf16 v[232:235], v[216:219], a[168:171], v[232:235]
s_waitcnt lgkmcnt(13)
ds_read_b64_tr_b16 a[244:245], v183 offset:4104
v_cvt_pk_bf16_f32 v81, v190, v191
v_mfma_f32_16x16x32_bf16 v[232:235], v[220:223], a[172:175], v[232:235]
s_waitcnt lgkmcnt(13)
ds_read_b64_tr_b16 a[246:247], v183 offset:4616
v_exp_f32 v192, v192
v_exp_f32 v193, v193
v_exp_f32 v194, v194
v_exp_f32 v195, v195
v_cvt_pk_bf16_f32 v112, v192, v193
v_cvt_pk_bf16_f32 v113, v194, v195
v_mfma_f32_16x16x32_bf16 v[192:195], v[220:223], a[188:191], 0
s_waitcnt lgkmcnt(11)
ds_read_b64_tr_b16 a[248:249], v183 offset:8200
v_cvt_pk_bf16_f32 v88, v232, v233
v_mfma_f32_16x16x32_bf16 v[192:195], v[216:219], a[184:187], v[192:195]
ds_read_b64_tr_b16 a[250:251], v183 offset:8712
v_cvt_pk_bf16_f32 v89, v234, v235
v_mfma_f32_16x16x32_bf16 v[192:195], v[212:215], a[180:183], v[192:195]
s_waitcnt lgkmcnt(10)
ds_read_b64_tr_b16 a[252:253], v183 offset:12296
ds_read_b128 v[188:191], v242 offset:13184
v_mfma_f32_16x16x32_bf16 v[192:195], v[200:203], a[176:179], v[192:195]
ds_read_b64_tr_b16 a[254:255], v183 offset:12808
v_cvt_pk_bf16_f32 v84, v228, v229
v_mfma_f32_16x16x32_bf16 v[232:235], a[64:67], v[208:211], 0
ds_write_b32 v165, v31 offset:6980
v_mfma_f32_16x16x32_bf16 v[232:235], a[68:71], v[224:227], v[232:235]
v_cvt_pk_bf16_f32 v85, v230, v231
v_exp_f32 v204, v204
v_exp_f32 v205, v205
v_cvt_pk_bf16_f32 v92, v192, v193
v_cvt_pk_bf16_f32 v93, v194, v195
v_exp_f32 v206, v206
v_cvt_pk_bf16_f32 v124, v204, v205
s_waitcnt lgkmcnt(2)
v_mfma_f32_16x16x32_bf16 v[232:235], a[72:75], v[188:191], v[232:235]
ds_read_b128 v[228:231], v242 offset:13440
v_exp_f32 v207, v207
v_exp_f32 v196, v196
v_cvt_pk_bf16_f32 v125, v206, v207
v_exp_f32 v197, v197
v_exp_f32 v198, v198
v_exp_f32 v199, v199
v_cvt_pk_bf16_f32 v128, v196, v197
v_cvt_pk_bf16_f32 v129, v198, v199
s_waitcnt lgkmcnt(0)
v_mfma_f32_16x16x32_bf16 v[232:235], a[76:79], v[228:231], v[232:235]
s_barrier
v_mfma_f32_16x16x32_bf16 v[192:195], a[92:95], v[228:231], 0
s_add_u32 s98, s98, s48
v_add_u32 v245, 1728, v245
v_add_u32 v246, 1728, v246
v_mfma_f32_16x16x32_bf16 v[192:195], a[88:91], v[188:191], v[192:195]
s_add_u32 s99, s98, s51
s_add_u32 s100, s99, s51
v_cvt_pk_bf16_f32 v24, v232, v233
v_mfma_f32_16x16x32_bf16 v[192:195], a[84:87], v[224:227], v[192:195]
s_add_u32 m0, s49, 8448
s_add_u32 s101, s100, s51
v_cvt_pk_bf16_f32 v25, v234, v235
v_mfma_f32_16x16x32_bf16 v[192:195], a[80:83], v[208:211], v[192:195]
buffer_load_dwordx4 v243, s[16:19], s98 offen offset:0 nt lds
v_mfma_f32_16x16x32_bf16 v[204:207], a[96:99], v[208:211], 0
s_add_u32 s98, s98, s48
ds_read_b128 v[232:235], v247 offset:0
v_add_u32 v247, 1728, v247
v_mfma_f32_16x16x32_bf16 v[204:207], a[100:103], v[224:227], v[204:207]
s_bfe_i32 s57, s3, 0x10000
s_and_b32 s54, s57, s5
v_cvt_pk_bf16_f32 v26, v192, v193
v_mfma_f32_16x16x32_bf16 v[204:207], a[104:107], v[188:191], v[204:207]
s_add_u32 s50, s50, 13107200
v_cvt_pk_bf16_f32 v27, v194, v195
s_mov_b32 s47, s46
v_mfma_f32_16x16x32_bf16 v[204:207], a[108:111], v[228:231], v[204:207]
s_lshr_b32 s3, s3, 1
s_sub_u32 s45, s45, 1
s_sub_u32 s50, s50, s54
v_mfma_f32_16x16x32_bf16 v[192:195], a[124:127], v[228:231], 0
s_add_u32 s52, s46, 20480
s_add_u32 s53, s46, 0
s_nop 0
v_mfma_f32_16x16x32_bf16 v[192:195], a[120:123], v[188:191], v[192:195]
v_cvt_pk_bf16_f32 v28, v204, v205
v_cvt_pk_bf16_f32 v29, v206, v207
v_mfma_f32_16x16x32_bf16 v[192:195], a[116:119], v[224:227], v[192:195]
v_mfma_f32_16x16x32_bf16 v[192:195], a[112:115], v[208:211], v[192:195]
buffer_load_dwordx4 v243, s[16:19], s99 offen offset:1056 nt lds
v_mfma_f32_16x16x32_bf16 v[204:207], v[208:211], a[128:131], 0
s_add_u32 s99, s98, s51
s_nop 1
v_mfma_f32_16x16x32_bf16 v[204:207], v[224:227], a[132:135], v[204:207]
s_nop 1
v_cvt_pk_bf16_f32 v30, v192, v193
v_mfma_f32_16x16x32_bf16 v[204:207], v[188:191], a[136:139], v[204:207]
v_cvt_pk_bf16_f32 v31, v194, v195
v_mfma_f32_16x16x32_bf16 v[204:207], v[228:231], a[140:143], v[204:207]
v_mov_b64 v[168:169], 0
v_mov_b64 v[170:171], 0
v_mfma_f32_16x16x32_bf16 v[192:195], v[28:31], v[156:159], 0
v_mov_b64 v[172:173], 0
v_mov_b64 v[174:175], 0
v_mfma_f32_16x16x32_bf16 v[192:195], v[24:27], v[152:155], v[192:195]
s_waitcnt lgkmcnt(0)
v_mov_b64 v[176:177], 0
v_mov_b64 v[178:179], 0
v_mfma_f32_16x16x32_bf16 v[196:199], v[24:27], v[96:99], 0
ds_read_b128 v[152:155], v242 offset:21120
v_cvt_pk_bf16_f32 v66, v204, v205
v_mfma_f32_16x16x32_bf16 v[196:199], v[28:31], v[100:103], v[196:199]
ds_read_b128 v[156:159], v242 offset:21376
v_cvt_pk_bf16_f32 v67, v206, v207
v_smfmac_f32_16x16x64_bf16 v[168:171], v[232:235], v[0:7], v251
ds_read_b128 v[160:163], v242 offset:21632
ds_read_b128 v[164:167], v242 offset:21888
v_smfmac_f32_16x16x64_bf16 v[172:175], v[232:235], v[16:23], v251
s_nop 2
v_smfmac_f32_16x16x64_bf16 v[176:179], v[232:235], v[32:39], v251
s_nop 0
v_add_f32 v168, v168, v169
v_mfma_f32_16x16x32_bf16 v[204:207], v[228:231], a[156:159], 0
v_exp_f32 v192, v192
v_mfma_f32_16x16x32_bf16 v[204:207], v[188:191], a[152:155], v[204:207]
v_exp_f32 v193, v193
v_mfma_f32_16x16x32_bf16 v[204:207], v[224:227], a[148:151], v[204:207]
v_exp_f32 v194, v194
v_mfma_f32_16x16x32_bf16 v[204:207], v[208:211], a[144:147], v[204:207]
v_exp_f32 v195, v195
v_smfmac_f32_16x16x64_bf16 v[170:173], v[232:235], v[8:15], v251
v_cvt_pk_bf16_f32 v110, v192, v193
v_smfmac_f32_16x16x64_bf16 v[174:177], v[232:235], v[24:31], v251
v_cvt_pk_bf16_f32 v111, v194, v195
v_smfmac_f32_16x16x64_bf16 v[178:181], v[232:235], v[40:47], v251
s_nop 1
v_cvt_pk_bf16_f32 v70, v204, v205
v_mfma_f32_16x16x32_bf16 v[192:195], v[208:211], a[160:163], 0
v_cvt_pk_bf16_f32 v71, v206, v207
v_add_f32 v170, v170, v171
v_mfma_f32_16x16x32_bf16 v[192:195], v[224:227], a[164:167], v[192:195]
s_waitcnt lgkmcnt(3)
v_exp_f32 v196, v196
v_mfma_f32_16x16x32_bf16 v[192:195], v[188:191], a[168:171], v[192:195]
s_waitcnt lgkmcnt(2)
v_exp_f32 v168, v168
v_mfma_f32_16x16x32_bf16 v[192:195], v[228:231], a[172:175], v[192:195]
buffer_load_dwordx4 v243, s[16:19], s100 offen offset:2112 nt lds
v_mfma_f32_16x16x32_bf16 v[204:207], v[228:231], a[188:191], 0
s_waitcnt lgkmcnt(0)
ds_read_b128 v[228:231], v242 offset:0
v_mov_b64 v[232:233], 0
v_mfma_f32_16x16x32_bf16 v[204:207], v[188:191], a[184:187], v[204:207]
s_add_u32 s100, s99, s51
ds_read_b128 v[188:191], v242 offset:256
v_cvt_pk_bf16_f32 v74, v192, v193
v_mfma_f32_16x16x32_bf16 v[204:207], v[224:227], a[180:183], v[204:207]
ds_read_b128 v[224:227], v242 offset:512
v_cvt_pk_bf16_f32 v75, v194, v195
v_mfma_f32_16x16x32_bf16 v[204:207], v[208:211], a[176:179], v[204:207]
ds_read_b128 v[192:195], v242 offset:768
v_add_f32 v172, v172, v173
v_smfmac_f32_16x16x64_bf16 v[232:235], v[184:187], v[104:111], v251
v_add_f32 v174, v174, v175
v_smfmac_f32_16x16x64_bf16 v[232:235], v[184:187], v[112:119], v251 abid:1
v_add_f32 v176, v176, v177
v_mfma_f32_16x16x32_bf16 v[136:139], a[192:195], v[152:155], 0
v_exp_f32 v170, v170
v_mfma_f32_16x16x32_bf16 v[136:139], a[196:199], v[156:159], v[136:139]
v_exp_f32 v172, v172
v_mfma_f32_16x16x32_bf16 v[136:139], a[200:203], v[160:163], v[136:139]
v_exp_f32 v174, v174
v_mfma_f32_16x16x32_bf16 v[136:139], a[204:207], v[164:167], v[136:139]
buffer_load_dwordx4 v243, s[16:19], s101 offen offset:3168 nt lds
v_mfma_f32_16x16x32_bf16 v[140:143], a[220:223], v[164:167], 0
s_add_u32 m0, s49, 16896
v_exp_f32 v176, v176
v_mfma_f32_16x16x32_bf16 v[140:143], a[216:219], v[160:163], v[140:143]
s_add_u32 s101, s100, s51
v_add_f32 v178, v178, v179
v_add_f32 v180, v168, v170
v_mfma_f32_16x16x32_bf16 v[140:143], a[212:215], v[156:159], v[140:143]
s_and_b32 s51, s57, 13106176
v_cvt_pk_bf16_f32 v169, v168, v170
v_add_f32 v180, v180, v172
v_mfma_f32_16x16x32_bf16 v[140:143], a[208:211], v[152:155], v[140:143]
s_waitcnt lgkmcnt(3)
ds_write_b16 v248, v169 offset:0
v_mfma_f32_16x16x32_bf16 v[144:147], a[224:227], v[152:155], 0
s_waitcnt lgkmcnt(3)
ds_write_b16_d16_hi v248, v169 offset:4
v_mfma_f32_16x16x32_bf16 v[144:147], a[228:231], v[156:159], v[144:147]
s_waitcnt lgkmcnt(3)
v_exp_f32 v178, v178
v_mfma_f32_16x16x32_bf16 v[144:147], a[232:235], v[160:163], v[144:147]
s_waitcnt lgkmcnt(2)
v_add_f32 v180, v180, v174
v_add_f32 v180, v180, v176
v_mfma_f32_16x16x32_bf16 v[144:147], a[236:239], v[164:167], v[144:147]
buffer_load_dwordx4 v243, s[16:19], s98 offen offset:0 nt lds
v_mfma_f32_16x16x32_bf16 v[148:151], a[252:255], v[164:167], 0
s_lshl3_add_u32 s48, s51, 8192
v_add_f32 v180, v180, v178
v_cvt_pk_bf16_f32 v173, v172, v174
v_mfma_f32_16x16x32_bf16 v[148:151], a[244:247], v[156:159], v[148:151]
s_sub_u32 s49, s49, s56
ds_write_b16 v248, v173 offset:272
v_mfma_f32_16x16x32_bf16 v[148:151], a[240:243], v[152:155], v[148:151]
s_sub_u32 s51, s51, 32
ds_write_b16_d16_hi v248, v173 offset:276
v_mfma_f32_16x16x32_bf16 v[148:151], a[248:251], v[160:163], v[148:151]
v_add_f32_dpp v180, v180, v180 row_ror:8 row_mask:0xf bank_mask:0xf
v_cvt_pk_bf16_f32 v177, v176, v178
v_mfma_f32_16x16x32_bf16 v[164:167], a[248:251], v[224:227], 0
ds_write_b16 v248, v177 offset:544
v_mfma_f32_16x16x32_bf16 v[164:167], a[252:255], v[192:195], v[164:167]
ds_write_b16_d16_hi v248, v177 offset:548
v_mfma_f32_16x16x32_bf16 v[164:167], a[244:247], v[188:191], v[164:167]
v_add_f32_dpp v180, v180, v180 row_ror:4 row_mask:0xf bank_mask:0xf
v_add_f32 v232, v232, v233
v_mfma_f32_16x16x32_bf16 v[164:167], a[240:243], v[228:231], v[164:167]
buffer_load_dwordx4 v243, s[16:19], s99 offen offset:1056 nt lds
v_mfma_f32_16x16x32_bf16 v[160:163], a[224:227], v[228:231], 0
ds_write_b32 v250, v180 offset:256
v_mfma_f32_16x16x32_bf16 v[160:163], a[228:231], v[188:191], v[160:163]
v_exp_f32 v197, v197
v_mfma_f32_16x16x32_bf16 v[160:163], a[232:235], v[224:227], v[160:163]
v_exp_f32 v198, v198
v_mfma_f32_16x16x32_bf16 v[160:163], a[236:239], v[192:195], v[160:163]
v_exp_f32 v199, v199
v_mfma_f32_32x32x16_bf16 v[168:183], v[236:239], v[116:119], 0
v_cvt_pk_bf16_f32 v126, v196, v197
v_cvt_pk_bf16_f32 v127, v198, v199
v_rcp_f32 v254, v232
v_cvt_pk_bf16_f32 v78, v204, v205
v_cvt_pk_bf16_f32 v79, v206, v207
v_mfma_f32_16x16x32_bf16 v[156:159], a[220:223], v[192:195], 0
v_max3_f32 v255, v255, v232, v254
v_mfma_f32_16x16x32_bf16 v[156:159], a[216:219], v[224:227], v[156:159]
v_mfma_f32_16x16x32_bf16 v[156:159], a[212:215], v[188:191], v[156:159]
v_mfma_f32_16x16x32_bf16 v[156:159], a[208:211], v[228:231], v[156:159]
buffer_load_dwordx4 v243, s[16:19], s100 offen offset:2112 nt lds
v_mfma_f32_16x16x32_bf16 v[152:155], a[192:195], v[228:231], 0
v_mfma_f32_16x16x32_bf16 v[152:155], a[196:199], v[188:191], v[152:155]
v_mfma_f32_16x16x32_bf16 v[152:155], a[200:203], v[224:227], v[152:155]
v_mfma_f32_16x16x32_bf16 v[152:155], a[204:207], v[192:195], v[152:155]
buffer_load_dwordx4 v243, s[16:19], s101 offen offset:3168 nt lds
v_mfma_f32_16x16x32_bf16 v[192:195], v[40:43], v[96:99], 0
s_mov_b32 m0, s58
v_mfma_f32_16x16x32_bf16 v[192:195], v[44:47], v[100:103], v[192:195]
v_mfma_f32_16x16x32_bf16 v[168:171], v[48:51], v[104:107], v[168:171]
s_nop 7
s_waitcnt lgkmcnt(0)
s_branch L_entryf
L_spin:
ds_read_addtid_b32 v192 offset:65280
s_waitcnt lgkmcnt(0)
v_cmp_lt_u32 vcc, s45, v192
s_nop 1
s_cbranch_vccnz L_spin
s_branch L_back
L_spine:
ds_read_addtid_b32 v200 offset:65280
s_waitcnt lgkmcnt(0)
v_cmp_lt_u32 vcc, s45, v200
s_nop 1
s_cbranch_vccnz L_spine
s_branch L_backe
.p2align 12
.fill 479, 4, 0xbf800000
L_h3:
s_cbranch_execz L_ret
L_loopf:
v_mfma_f32_16x16x32_bf16 v[152:155], a[192:195], v[204:207], 0
s_mov_b32 m0, s59
s_nop 0
ds_read_addtid_b32 v192 offset:65280
v_mfma_f32_16x16x32_bf16 v[152:155], a[196:199], v[208:211], v[152:155]
s_add_u32 s52, s47, 8192
v_cvt_pk_bf16_f32 v102, v232, v233
v_cvt_pk_bf16_f32 v103, v234, v235
v_mfma_f32_16x16x32_bf16 v[152:155], a[200:203], v[212:215], v[152:155]
s_add_u32 s53, s47, 12288
v_exp_f32 v196, v196
v_mfma_f32_16x16x32_bf16 v[152:155], a[204:207], v[216:219], v[152:155]
s_bfe_i32 s57, s3, 0x10000
v_exp_f32 v197, v197
v_mfma_f32_16x16x32_bf16 v[156:159], a[220:223], v[216:219], 0
s_mov_b32 s47, s46
v_exp_f32 v198, v198
v_mfma_f32_16x16x32_bf16 v[156:159], a[216:219], v[212:215], v[156:159]
s_and_b32 s54, s57, s5
v_exp_f32 v199, v199
v_mfma_f32_16x16x32_bf16 v[156:159], a[212:215], v[208:211], v[156:159]
s_waitcnt lgkmcnt(0)
v_cmp_lt_u32 vcc, s45, v192
v_cvt_pk_bf16_f32 v106, v196, v197
v_mfma_f32_16x16x32_bf16 v[156:159], a[208:211], v[204:207], v[156:159]
s_lshr_b32 s3, s3, 1
v_cvt_pk_bf16_f32 v107, v198, v199
v_mfma_f32_16x16x32_bf16 v[160:163], a[224:227], v[204:207], 0
v_exp_f32 v188, v188
v_mfma_f32_16x16x32_bf16 v[160:163], a[228:231], v[208:211], v[160:163]
s_cbranch_vccnz L_spin
L_back:
v_exp_f32 v189, v189
v_mfma_f32_16x16x32_bf16 v[160:163], a[232:235], v[212:215], v[160:163]
s_mov_b32 s98, s50
ds_read_b128 v[192:195], v242 offset:0
ds_read_b128 v[196:199], v242 offset:256
v_mfma_f32_16x16x32_bf16 v[160:163], a[236:239], v[216:219], v[160:163]
s_add_u32 s99, s98, s51
v_exp_f32 v190, v190
v_mfma_f32_16x16x32_bf16 v[164:167], a[252:255], v[216:219], 0
s_add_u32 s100, s99, s51
ds_read_b128 v[216:219], v242 offset:512
v_cvt_pk_bf16_f32 v108, v188, v189
v_mfma_f32_16x16x32_bf16 v[164:167], a[248:251], v[212:215], v[164:167]
s_add_u32 m0, s49, 0
v_mov_b64 v[212:213], s[96:97]
v_mov_b64 v[214:215], s[96:97]
v_mfma_f32_16x16x32_bf16 v[164:167], a[244:247], v[208:211], v[164:167]
s_add_u32 s101, s100, s51
v_exp_f32 v191, v191
v_mfma_f32_16x16x32_bf16 v[164:167], a[240:243], v[204:207], v[164:167]
s_sub_u32 s45, s45, 1
v_cvt_pk_bf16_f32 v109, v190, v191
s_add_u32 s50, s50, 13107200
v_smfmac_f32_16x16x64_bf16 v[212:215], v[238:241], v[96:103], v251
s_waitcnt lgkmcnt(2)
ds_read_b128 v[188:191], v242 offset:768
s_sub_u32 s50, s50, s54
v_mfma_f32_16x16x32_bf16 v[200:203], v[0:3], v[96:99], 0
v_exp_f32 v220, v220
v_mfma_f32_16x16x32_bf16 v[200:203], v[4:7], v[100:103], v[200:203]
v_exp_f32 v221, v221
v_mfma_f32_16x16x32_bf16 v[204:207], v[12:15], v[100:103], 0
v_exp_f32 v222, v222
v_mfma_f32_16x16x32_bf16 v[204:207], v[8:11], v[96:99], v[204:207]
s_waitcnt lgkmcnt(2)
v_exp_f32 v223, v223
v_mfma_f32_16x16x32_bf16 v[208:211], a[64:67], v[192:195], 0
s_waitcnt lgkmcnt(1)
v_cvt_pk_bf16_f32 v110, v220, v221
v_cvt_pk_bf16_f32 v111, v222, v223
v_mfma_f32_16x16x32_bf16 v[208:211], a[68:71], v[196:199], v[208:211]
s_waitcnt lgkmcnt(0)
v_exp_f32 v224, v224
v_mfma_f32_16x16x32_bf16 v[208:211], a[72:75], v[216:219], v[208:211]
v_exp_f32 v225, v225
v_mfma_f32_16x16x32_bf16 v[208:211], a[76:79], v[188:191], v[208:211]
v_exp_f32 v226, v226
v_mfma_f32_16x16x32_bf16 v[220:223], a[92:95], v[188:191], 0
v_exp_f32 v227, v227
v_mfma_f32_16x16x32_bf16 v[220:223], a[88:91], v[216:219], v[220:223]
v_exp_f32 v228, v228
v_mfma_f32_16x16x32_bf16 v[220:223], a[84:87], v[196:199], v[220:223]
v_exp_f32 v229, v229
v_mfma_f32_16x16x32_bf16 v[220:223], a[80:83], v[192:195], v[220:223]
buffer_load_dwordx4 v243, s[16:19], s98 offen offset:0 nt lds
v_mfma_f32_16x16x32_bf16 v[232:235], a[96:99], v[192:195], 0
s_add_u32 s98, s98, s48
v_cvt_pk_bf16_f32 v0, v208, v209
v_cvt_pk_bf16_f32 v1, v210, v211
v_mfma_f32_16x16x32_bf16 v[232:235], a[100:103], v[196:199], v[232:235]
v_exp_f32 v230, v230
v_mfma_f32_16x16x32_bf16 v[232:235], a[104:107], v[216:219], v[232:235]
v_cvt_pk_bf16_f32 v2, v220, v221
v_cvt_pk_bf16_f32 v3, v222, v223
v_mfma_f32_16x16x32_bf16 v[232:235], a[108:111], v[188:191], v[232:235]
v_mov_b64 v[208:209], 0
v_cvt_pk_bf16_f32 v112, v224, v225
v_mfma_f32_16x16x32_bf16 v[220:223], a[124:127], v[188:191], 0
v_exp_f32 v231, v231
v_mfma_f32_16x16x32_bf16 v[220:223], a[120:123], v[216:219], v[220:223]
v_cvt_pk_bf16_f32 v113, v226, v227
v_cvt_pk_bf16_f32 v114, v228, v229
v_mfma_f32_16x16x32_bf16 v[220:223], a[116:119], v[196:199], v[220:223]
v_cvt_pk_bf16_f32 v115, v230, v231
v_add_f32 v212, v212, v213
v_mfma_f32_16x16x32_bf16 v[220:223], a[112:115], v[192:195], v[220:223]
ds_read_b128 v[188:191], v242 offset:4992
v_add_f32 v214, v214, v215
v_smfmac_f32_16x16x64_bf16 v[208:211], v[184:187], v[104:111], v251
ds_read_b128 v[192:195], v242 offset:4736
ds_read_b128 v[196:199], v242 offset:4480
v_smfmac_f32_16x16x64_bf16 v[208:211], v[184:187], v[112:119], v251 abid:1
ds_read_b128 v[216:219], v242 offset:4224
v_cvt_pk_bf16_f32 v4, v232, v233
v_mfma_f32_16x16x32_bf16 v[168:171], v[80:83], v[112:115], v[168:171]
v_exp_f32 v200, v200
v_mfma_f32_16x16x32_bf16 v[168:171], v[64:67], v[108:111], v[168:171]
v_exp_f32 v201, v201
v_mfma_f32_16x16x32_bf16 v[168:171], v[48:51], v[104:107], v[168:171]
v_exp_f32 v202, v202
v_mfma_f32_16x16x32_bf16 v[172:175], v[52:55], v[104:107], v[172:175]
s_waitcnt lgkmcnt(3)
v_exp_f32 v203, v203
v_mfma_f32_16x16x32_bf16 v[172:175], v[68:71], v[108:111], v[172:175]
s_waitcnt lgkmcnt(2)
v_cvt_pk_bf16_f32 v120, v200, v201
v_cvt_pk_bf16_f32 v121, v202, v203
v_mfma_f32_16x16x32_bf16 v[172:175], v[84:87], v[112:115], v[172:175]
v_exp_f32 v204, v204
v_mfma_f32_16x16x32_bf16 v[176:179], v[88:91], v[112:115], v[176:179]
v_exp_f32 v205, v205
v_mfma_f32_16x16x32_bf16 v[176:179], v[72:75], v[108:111], v[176:179]
v_exp_f32 v206, v206
v_mfma_f32_16x16x32_bf16 v[176:179], v[56:59], v[104:107], v[176:179]
v_exp_f32 v207, v207
v_mfma_f32_16x16x32_bf16 v[180:183], v[60:63], v[104:107], v[180:183]
v_cvt_pk_bf16_f32 v122, v204, v205
v_cvt_pk_bf16_f32 v123, v206, v207
v_mfma_f32_16x16x32_bf16 v[180:183], v[76:79], v[108:111], v[180:183]
v_exp_f32 v212, v212
v_mfma_f32_16x16x32_bf16 v[180:183], v[92:95], v[112:115], v[180:183]
s_waitcnt lgkmcnt(1)
v_exp_f32 v214, v214
v_mfma_f32_16x16x32_bf16 v[200:203], v[20:23], v[100:103], 0
s_waitcnt lgkmcnt(0)
v_perm_b32 v132, v214, v212, v252
v_perm_b32 v133, v214, v212, v253
v_mfma_f32_16x16x32_bf16 v[200:203], v[16:19], v[96:99], v[200:203]
v_add_f32 v208, v208, v209
v_cvt_pk_bf16_f32 v6, v220, v221
v_mfma_f32_16x16x32_bf16 v[204:207], v[40:43], v[96:99], 0
v_rcp_f32 v254, v208
v_mfma_f32_16x16x32_bf16 v[204:207], v[44:47], v[100:103], v[204:207]
v_max3_f32 v255, v255, v208, v254
v_cvt_pk_bf16_f32 v7, v222, v223
v_mfma_f32_16x16x32_bf16 v[212:215], a[124:127], v[188:191], 0
v_exp_f32 v200, v200
v_mfma_f32_16x16x32_bf16 v[212:215], a[120:123], v[192:195], v[212:215]
v_exp_f32 v201, v201
v_mfma_f32_16x16x32_bf16 v[212:215], a[116:119], v[196:199], v[212:215]
s_nop 0
v_exp_f32 v204, v204
v_mfma_f32_16x16x32_bf16 v[212:215], a[112:115], v[216:219], v[212:215]
buffer_load_dwordx4 v243, s[16:19], s99 offen offset:1056 nt lds
v_mfma_f32_16x16x32_bf16 v[224:227], a[96:99], v[216:219], 0
s_add_u32 s99, s98, s51
v_exp_f32 v205, v205
v_mfma_f32_16x16x32_bf16 v[224:227], a[100:103], v[196:199], v[224:227]
ds_read_b128 v[220:223], v242 offset:17408
v_cvt_pk_bf16_f32 v130, v204, v205
v_mfma_f32_16x16x32_bf16 v[224:227], a[104:107], v[192:195], v[224:227]
v_exp_f32 v206, v206
v_mfma_f32_16x16x32_bf16 v[224:227], a[108:111], v[188:191], v[224:227]
v_exp_f32 v207, v207
v_mfma_f32_16x16x32_bf16 v[208:211], a[92:95], v[188:191], 0
v_cvt_pk_bf16_f32 v131, v206, v207
v_cvt_pk_bf16_f32 v124, v200, v201
v_mfma_f32_16x16x32_bf16 v[208:211], a[88:91], v[192:195], v[208:211]
v_exp_f32 v202, v202
v_mfma_f32_16x16x32_bf16 v[208:211], a[84:87], v[196:199], v[208:211]
s_nop 0
v_cvt_pk_bf16_f32 v12, v224, v225
v_cvt_pk_bf16_f32 v13, v226, v227
v_mfma_f32_16x16x32_bf16 v[208:211], a[80:83], v[216:219], v[208:211]
v_exp_f32 v203, v203
v_mfma_f32_16x16x32_bf16 v[228:231], v[32:35], v[96:99], 0
v_cvt_pk_bf16_f32 v125, v202, v203
v_cvt_pk_bf16_f32 v14, v212, v213
v_mfma_f32_16x16x32_bf16 v[228:231], v[36:39], v[100:103], v[228:231]
ds_read_b128 v[200:203], v242 offset:16896
v_cvt_pk_bf16_f32 v15, v214, v215
v_mfma_f32_16x16x32_bf16 v[204:207], a[64:67], v[216:219], 0
ds_read_b128 v[212:215], v242 offset:17152
v_cvt_pk_bf16_f32 v10, v208, v209
v_mfma_f32_16x16x32_bf16 v[204:207], a[68:71], v[196:199], v[204:207]
ds_read_b128 v[216:219], v242 offset:9216
v_cvt_pk_bf16_f32 v11, v210, v211
v_mfma_f32_16x16x32_bf16 v[204:207], a[72:75], v[192:195], v[204:207]
ds_read_b128 v[208:211], v242 offset:17664
v_cvt_pk_bf16_f32 v5, v234, v235
v_mfma_f32_16x16x32_bf16 v[204:207], a[76:79], v[188:191], v[204:207]
ds_read_b128 v[192:195], v242 offset:8960
ds_read_b128 v[196:199], v242 offset:8704
v_mfma_f32_16x16x32_bf16 v[224:227], v[24:27], v[96:99], 0
s_waitcnt lgkmcnt(6)
ds_read_b128 v[188:191], v242 offset:8448
v_fmac_f32 v136, v168, v254
v_mfma_f32_16x16x32_bf16 v[224:227], v[28:31], v[100:103], v[224:227]
s_waitcnt lgkmcnt(6)
v_cvt_pk_bf16_f32 v8, v204, v205
v_cvt_pk_bf16_f32 v9, v206, v207
v_mfma_f32_16x16x32_bf16 v[204:207], a[64:67], v[200:203], 0
s_waitcnt lgkmcnt(5)
v_exp_f32 v228, v228
v_mfma_f32_16x16x32_bf16 v[204:207], a[68:71], v[212:215], v[204:207]
v_exp_f32 v229, v229
v_mfma_f32_16x16x32_bf16 v[204:207], a[72:75], v[220:223], v[204:207]
s_waitcnt lgkmcnt(3)
v_exp_f32 v230, v230
v_mfma_f32_16x16x32_bf16 v[204:207], a[76:79], v[208:211], v[204:207]
buffer_load_dwordx4 v243, s[16:19], s100 offen offset:2112 nt lds
v_mfma_f32_16x16x32_bf16 v[232:235], a[92:95], v[208:211], 0
s_waitcnt lgkmcnt(0)
v_exp_f32 v231, v231
v_mfma_f32_16x16x32_bf16 v[232:235], a[88:91], v[220:223], v[232:235]
s_add_u32 s100, s99, s51
v_cvt_pk_bf16_f32 v128, v228, v229
v_cvt_pk_bf16_f32 v129, v230, v231
v_mfma_f32_16x16x32_bf16 v[232:235], a[84:87], v[212:215], v[232:235]
v_cvt_pk_bf16_f32 v32, v204, v205
v_cvt_pk_bf16_f32 v33, v206, v207
v_mfma_f32_16x16x32_bf16 v[232:235], a[80:83], v[200:203], v[232:235]
v_fmac_f32 v137, v169, v254
v_fmac_f32 v144, v176, v254
v_mfma_f32_16x16x32_bf16 v[204:207], a[96:99], v[200:203], 0
v_fmac_f32 v145, v177, v254
v_fmac_f32 v138, v170, v254
v_mfma_f32_16x16x32_bf16 v[204:207], a[100:103], v[212:215], v[204:207]
v_fmac_f32 v139, v171, v254
v_cvt_pk_bf16_f32 v136, v136, v137
v_mfma_f32_16x16x32_bf16 v[204:207], a[104:107], v[220:223], v[204:207]
v_fmac_f32 v146, v178, v254
v_fmac_f32 v147, v179, v254
v_mfma_f32_16x16x32_bf16 v[204:207], a[108:111], v[208:211], v[204:207]
v_cvt_pk_bf16_f32 v144, v144, v145
v_fmac_f32 v140, v172, v254
v_mfma_f32_16x16x32_bf16 v[228:231], a[124:127], v[208:211], 0
v_fmac_f32 v141, v173, v254
v_fmac_f32 v142, v174, v254
v_mfma_f32_16x16x32_bf16 v[228:231], a[116:119], v[212:215], v[228:231]
v_fmac_f32 v143, v175, v254
v_cvt_pk_bf16_f32 v137, v138, v139
v_mfma_f32_16x16x32_bf16 v[228:231], a[112:115], v[200:203], v[228:231]
v_fmac_f32 v148, v180, v254
v_fmac_f32 v149, v181, v254
v_mfma_f32_16x16x32_bf16 v[228:231], a[120:123], v[220:223], v[228:231]
v_fmac_f32 v150, v182, v254
v_fmac_f32 v151, v183, v254
v_mfma_f32_16x16x32_bf16 v[200:203], a[120:123], v[192:195], 0
v_cvt_pk_bf16_f32 v145, v146, v147
v_cvt_pk_bf16_f32 v138, v140, v141
v_mfma_f32_16x16x32_bf16 v[200:203], a[124:127], v[216:219], v[200:203]
v_cvt_pk_bf16_f32 v139, v142, v143
v_cvt_pk_bf16_f32 v146, v148, v149
v_mfma_f32_16x16x32_bf16 v[200:203], a[116:119], v[196:199], v[200:203]
v_cvt_pk_bf16_f32 v147, v150, v151
v_pk_max_i16 v136, v136, 0
v_mfma_f32_16x16x32_bf16 v[200:203], a[112:115], v[188:191], v[200:203]
v_pk_max_i16 v137, v137, 0
v_pk_max_i16 v138, v138, 0
v_mfma_f32_16x16x32_bf16 v[208:211], a[96:99], v[188:191], 0
v_pk_max_i16 v139, v139, 0
v_pk_max_i16 v144, v144, 0
v_mfma_f32_16x16x32_bf16 v[208:211], a[100:103], v[196:199], v[208:211]
v_pk_max_i16 v145, v145, 0
v_pk_max_i16 v146, v146, 0
v_mfma_f32_16x16x32_bf16 v[208:211], a[104:107], v[192:195], v[208:211]
v_pk_max_i16 v147, v147, 0
v_mov_b64 v[140:141], v[136:137]
v_mfma_f32_16x16x32_bf16 v[208:211], a[108:111], v[216:219], v[208:211]
v_mov_b64 v[142:143], v[138:139]
v_mov_b32_dpp v136, v144 row_ror:8 row_mask:0xf bank_mask:0xc
v_mfma_f32_16x16x32_bf16 v[212:215], a[92:95], v[216:219], 0
v_mov_b32_dpp v137, v145 row_ror:8 row_mask:0xf bank_mask:0xc
v_mov_b32_dpp v138, v146 row_ror:8 row_mask:0xf bank_mask:0xc
v_mfma_f32_16x16x32_bf16 v[212:215], a[88:91], v[192:195], v[212:215]
v_mov_b32_dpp v139, v147 row_ror:8 row_mask:0xf bank_mask:0xc
v_mov_b32_dpp v144, v140 row_ror:8 row_mask:0xf bank_mask:0x3
v_mfma_f32_16x16x32_bf16 v[212:215], a[84:87], v[196:199], v[212:215]
v_mov_b32_dpp v145, v141 row_ror:8 row_mask:0xf bank_mask:0x3
v_mov_b32_dpp v146, v142 row_ror:8 row_mask:0xf bank_mask:0x3
v_mfma_f32_16x16x32_bf16 v[212:215], a[80:83], v[188:191], v[212:215]
v_mov_b32_dpp v147, v143 row_ror:8 row_mask:0xf bank_mask:0x3
v_cvt_pk_bf16_f32 v22, v200, v201
v_mfma_f32_16x16x32_bf16 v[220:223], a[64:67], v[188:191], 0
v_exp_f32 v224, v224
v_mfma_f32_16x16x32_bf16 v[220:223], a[68:71], v[196:199], v[220:223]
v_exp_f32 v225, v225
v_mfma_f32_16x16x32_bf16 v[220:223], a[72:75], v[192:195], v[220:223]
v_exp_f32 v226, v226
v_mfma_f32_16x16x32_bf16 v[220:223], a[76:79], v[216:219], v[220:223]
v_exp_f32 v227, v227
v_mfma_f32_32x32x16_bf16 v[168:183], v[236:239], v[132:135], 0
buffer_store_dwordx4 v[136:139], v244, s[20:23], s52 offen offset:0 nt
buffer_store_dwordx4 v[144:147], v244, s[20:23], s52 offen offset:2048 nt
v_cvt_pk_bf16_f32 v126, v224, v225
v_cvt_pk_bf16_f32 v127, v226, v227
v_mov_b64 v[224:225], 0
v_cvt_pk_bf16_f32 v23, v202, v203
v_cvt_pk_bf16_f32 v18, v212, v213
v_smfmac_f32_16x16x64_bf16 v[224:227], v[184:187], v[120:127], v251
s_add_u32 s52, s46, 20480
v_cvt_pk_bf16_f32 v19, v214, v215
v_smfmac_f32_16x16x64_bf16 v[224:227], v[184:187], v[128:135], v251 abid:1
v_cvt_pk_bf16_f32 v38, v228, v229
v_mfma_f32_16x16x32_bf16 v[168:171], v[80:83], v[128:131], v[168:171]
v_cvt_pk_bf16_f32 v39, v230, v231
v_cvt_pk_bf16_f32 v36, v204, v205
v_mfma_f32_16x16x32_bf16 v[168:171], v[64:67], v[124:127], v[168:171]
v_cvt_pk_bf16_f32 v37, v206, v207
v_cvt_pk_bf16_f32 v20, v208, v209
v_mfma_f32_16x16x32_bf16 v[168:171], v[48:51], v[120:123], v[168:171]
v_cvt_pk_bf16_f32 v21, v210, v211
v_cvt_pk_bf16_f32 v16, v220, v221
v_mfma_f32_16x16x32_bf16 v[172:175], v[52:55], v[120:123], v[172:175]
v_cvt_pk_bf16_f32 v17, v222, v223
v_add_f32 v224, v224, v225
v_mfma_f32_16x16x32_bf16 v[172:175], v[68:71], v[124:127], v[172:175]
L_h4:
s_cbranch_execz L_ret
v_rcp_f32 v254, v224
v_mfma_f32_16x16x32_bf16 v[172:175], v[84:87], v[128:131], v[172:175]
v_max3_f32 v255, v255, v224, v254
v_cvt_pk_bf16_f32 v34, v232, v233
v_mfma_f32_16x16x32_bf16 v[176:179], v[88:91], v[128:131], v[176:179]
v_cvt_pk_bf16_f32 v35, v234, v235
v_fmac_f32 v152, v168, v254
v_mfma_f32_16x16x32_bf16 v[176:179], v[72:75], v[124:127], v[176:179]
v_fmac_f32 v153, v169, v254
v_fmac_f32 v154, v170, v254
v_mfma_f32_16x16x32_bf16 v[176:179], v[56:59], v[120:123], v[176:179]
v_fmac_f32 v155, v171, v254
v_fmac_f32 v156, v172, v254
v_mfma_f32_16x16x32_bf16 v[180:183], v[60:63], v[120:123], v[180:183]
v_fmac_f32 v157, v173, v254
v_fmac_f32 v158, v174, v254
v_mfma_f32_16x16x32_bf16 v[180:183], v[76:79], v[124:127], v[180:183]
v_fmac_f32 v159, v175, v254
v_cvt_pk_bf16_f32 v152, v152, v153
v_mfma_f32_16x16x32_bf16 v[180:183], v[92:95], v[128:131], v[180:183]
v_fmac_f32 v160, v176, v254
v_fmac_f32 v161, v177, v254
v_mfma_f32_16x16x32_bf16 v[200:203], v[188:191], a[128:131], 0
v_fmac_f32 v162, v178, v254
v_fmac_f32 v163, v179, v254
v_mfma_f32_16x16x32_bf16 v[200:203], v[196:199], a[132:135], v[200:203]
v_cvt_pk_bf16_f32 v160, v160, v161
v_cvt_pk_bf16_f32 v153, v154, v155
v_mfma_f32_16x16x32_bf16 v[200:203], v[192:195], a[136:139], v[200:203]
v_fmac_f32 v164, v180, v254
v_fmac_f32 v165, v181, v254
v_mfma_f32_16x16x32_bf16 v[200:203], v[216:219], a[140:143], v[200:203]
ds_read_b128 v[204:207], v242 offset:12672
ds_read_b128 v[208:211], v242 offset:12928
v_mfma_f32_16x16x32_bf16 v[212:215], v[216:219], a[156:159], 0
ds_read_b128 v[220:223], v242 offset:13184
ds_read_b128 v[224:227], v242 offset:13440
v_mfma_f32_16x16x32_bf16 v[212:215], v[192:195], a[152:155], v[212:215]
v_cvt_pk_bf16_f32 v161, v162, v163
v_fmac_f32 v166, v182, v254
v_mfma_f32_16x16x32_bf16 v[212:215], v[196:199], a[148:151], v[212:215]
v_cvt_pk_bf16_f32 v64, v200, v201
v_cvt_pk_bf16_f32 v65, v202, v203
v_mfma_f32_16x16x32_bf16 v[212:215], v[188:191], a[144:147], v[212:215]
v_fmac_f32 v167, v183, v254
v_cvt_pk_bf16_f32 v154, v156, v157
v_mfma_f32_16x16x32_bf16 v[228:231], v[188:191], a[160:163], 0
v_cvt_pk_bf16_f32 v155, v158, v159
v_cvt_pk_bf16_f32 v162, v164, v165
v_mfma_f32_16x16x32_bf16 v[228:231], v[196:199], a[164:167], v[228:231]
v_cvt_pk_bf16_f32 v163, v166, v167
v_pk_max_i16 v152, v152, 0
v_mfma_f32_16x16x32_bf16 v[228:231], v[192:195], a[168:171], v[228:231]
v_cvt_pk_bf16_f32 v68, v212, v213
v_cvt_pk_bf16_f32 v69, v214, v215
v_mfma_f32_16x16x32_bf16 v[228:231], v[216:219], a[172:175], v[228:231]
v_pk_max_i16 v153, v153, 0
v_pk_max_i16 v154, v154, 0
v_mfma_f32_16x16x32_bf16 v[200:203], v[216:219], a[188:191], 0
v_pk_max_i16 v155, v155, 0
v_pk_max_i16 v160, v160, 0
v_mfma_f32_16x16x32_bf16 v[200:203], v[192:195], a[184:187], v[200:203]
v_pk_max_i16 v161, v161, 0
v_pk_max_i16 v162, v162, 0
v_mfma_f32_16x16x32_bf16 v[200:203], v[196:199], a[180:183], v[200:203]
s_waitcnt lgkmcnt(3)
v_pk_max_i16 v163, v163, 0
v_mov_b64 v[156:157], v[152:153]
v_mfma_f32_16x16x32_bf16 v[200:203], v[188:191], a[176:179], v[200:203]
buffer_load_dwordx4 v243, s[16:19], s101 offen offset:3168 nt lds
v_mfma_f32_16x16x32_bf16 v[188:191], a[64:67], v[204:207], 0
s_add_u32 m0, s49, 8448
ds_read_b128 v[192:195], v242 offset:21120
s_waitcnt lgkmcnt(3)
v_mfma_f32_16x16x32_bf16 v[188:191], a[68:71], v[208:211], v[188:191]
s_add_u32 s101, s100, s51
ds_read_b128 v[196:199], v242 offset:21376
s_waitcnt lgkmcnt(3)
v_mfma_f32_16x16x32_bf16 v[188:191], a[72:75], v[220:223], v[188:191]
s_waitcnt lgkmcnt(2)
ds_read_b128 v[216:219], v242 offset:21632
v_cvt_pk_bf16_f32 v76, v200, v201
v_mfma_f32_16x16x32_bf16 v[188:191], a[76:79], v[224:227], v[188:191]
ds_read_b128 v[232:235], v242 offset:21888
v_cvt_pk_bf16_f32 v77, v202, v203
v_mfma_f32_16x16x32_bf16 v[200:203], a[92:95], v[224:227], 0
v_mov_b64 v[158:159], v[154:155]
v_mov_b32_dpp v152, v160 row_ror:8 row_mask:0xf bank_mask:0xc
v_mfma_f32_16x16x32_bf16 v[200:203], a[88:91], v[220:223], v[200:203]
v_mov_b32_dpp v153, v161 row_ror:8 row_mask:0xf bank_mask:0xc
v_mov_b32_dpp v154, v162 row_ror:8 row_mask:0xf bank_mask:0xc
v_mfma_f32_16x16x32_bf16 v[200:203], a[84:87], v[208:211], v[200:203]
s_waitcnt lgkmcnt(3)
v_cvt_pk_bf16_f32 v24, v188, v189
v_cvt_pk_bf16_f32 v25, v190, v191
v_mfma_f32_16x16x32_bf16 v[200:203], a[80:83], v[204:207], v[200:203]
v_mov_b32_dpp v155, v163 row_ror:8 row_mask:0xf bank_mask:0xc
v_mov_b32_dpp v160, v156 row_ror:8 row_mask:0xf bank_mask:0x3
v_mfma_f32_16x16x32_bf16 v[188:191], a[96:99], v[204:207], 0
v_mov_b32_dpp v161, v157 row_ror:8 row_mask:0xf bank_mask:0x3
v_mov_b32_dpp v162, v158 row_ror:8 row_mask:0xf bank_mask:0x3
v_mfma_f32_16x16x32_bf16 v[188:191], a[100:103], v[208:211], v[188:191]
v_mov_b32_dpp v163, v159 row_ror:8 row_mask:0xf bank_mask:0x3
v_cvt_pk_bf16_f32 v72, v228, v229
v_mfma_f32_16x16x32_bf16 v[188:191], a[104:107], v[220:223], v[188:191]
v_cvt_pk_bf16_f32 v26, v200, v201
v_cvt_pk_bf16_f32 v27, v202, v203
v_mfma_f32_16x16x32_bf16 v[188:191], a[108:111], v[224:227], v[188:191]
ds_read_b128 v[200:203], v247 offset:0
v_cvt_pk_bf16_f32 v73, v230, v231
v_mfma_f32_16x16x32_bf16 v[212:215], a[124:127], v[224:227], 0
v_add_u32 v247, 1728, v247
s_nop 0
v_mfma_f32_16x16x32_bf16 v[212:215], a[120:123], v[220:223], v[212:215]
s_nop 1
v_cvt_pk_bf16_f32 v28, v188, v189
v_mfma_f32_16x16x32_bf16 v[212:215], a[116:119], v[208:211], v[212:215]
s_waitcnt lgkmcnt(3)
v_cvt_pk_bf16_f32 v29, v190, v191
v_mfma_f32_16x16x32_bf16 v[212:215], a[112:115], v[204:207], v[212:215]
s_waitcnt lgkmcnt(2)
s_nop 1
v_mfma_f32_16x16x32_bf16 v[188:191], v[204:207], a[128:131], 0
s_waitcnt lgkmcnt(1)
s_nop 1
v_mfma_f32_16x16x32_bf16 v[188:191], v[208:211], a[132:135], v[188:191]
v_cvt_pk_bf16_f32 v30, v212, v213
v_cvt_pk_bf16_f32 v31, v214, v215
v_mfma_f32_16x16x32_bf16 v[188:191], v[220:223], a[136:139], v[188:191]
v_mfma_f32_16x16x32_bf16 v[188:191], v[224:227], a[140:143], v[188:191]
s_nop 2
v_mfma_f32_16x16x32_bf16 v[212:215], v[224:227], a[156:159], 0
s_nop 2
v_mfma_f32_16x16x32_bf16 v[212:215], v[220:223], a[152:155], v[212:215]
v_cvt_pk_bf16_f32 v66, v188, v189
v_cvt_pk_bf16_f32 v67, v190, v191
v_mfma_f32_16x16x32_bf16 v[212:215], v[208:211], a[148:151], v[212:215]
v_mfma_f32_16x16x32_bf16 v[212:215], v[204:207], a[144:147], v[212:215]
buffer_load_dwordx4 v243, s[16:19], s98 offen offset:0 nt lds
v_mfma_f32_16x16x32_bf16 v[188:191], v[204:207], a[160:163], 0
s_add_u32 s98, s98, s48
s_nop 1
v_mfma_f32_16x16x32_bf16 v[188:191], v[208:211], a[164:167], v[188:191]
s_waitcnt lgkmcnt(0)
s_nop 0
v_cvt_pk_bf16_f32 v70, v212, v213
v_mfma_f32_16x16x32_bf16 v[188:191], v[220:223], a[168:171], v[188:191]
v_cvt_pk_bf16_f32 v71, v214, v215
v_mfma_f32_16x16x32_bf16 v[188:191], v[224:227], a[172:175], v[188:191]
s_nop 2
v_mfma_f32_16x16x32_bf16 v[212:215], v[224:227], a[188:191], 0
s_nop 2
v_mfma_f32_16x16x32_bf16 v[212:215], v[220:223], a[184:187], v[212:215]
v_cvt_pk_bf16_f32 v74, v188, v189
v_cvt_pk_bf16_f32 v75, v190, v191
v_mfma_f32_16x16x32_bf16 v[212:215], v[208:211], a[180:183], v[212:215]
v_mfma_f32_16x16x32_bf16 v[212:215], v[204:207], a[176:179], v[212:215]
s_nop 2
v_mfma_f32_16x16x32_bf16 v[188:191], a[64:67], v[192:195], 0
s_nop 2
v_mfma_f32_16x16x32_bf16 v[188:191], a[68:71], v[196:199], v[188:191]
v_cvt_pk_bf16_f32 v78, v212, v213
v_cvt_pk_bf16_f32 v79, v214, v215
v_mfma_f32_16x16x32_bf16 v[188:191], a[72:75], v[216:219], v[188:191]
v_mfma_f32_16x16x32_bf16 v[188:191], a[76:79], v[232:235], v[188:191]
ds_read_b128 v[238:241], v245 offset:0
ds_read2_b32 v[236:237], v246 offset0:0 offset1:8
v_mfma_f32_16x16x32_bf16 v[204:207], a[92:95], v[232:235], 0
v_add_u32 v245, 1728, v245
v_add_u32 v246, 1728, v246
v_mfma_f32_16x16x32_bf16 v[204:207], a[88:91], v[216:219], v[204:207]
s_nop 1
v_cvt_pk_bf16_f32 v40, v188, v189
v_mfma_f32_16x16x32_bf16 v[204:207], a[84:87], v[196:199], v[204:207]
v_cvt_pk_bf16_f32 v41, v190, v191
v_mfma_f32_16x16x32_bf16 v[204:207], a[80:83], v[192:195], v[204:207]
buffer_load_dwordx4 v243, s[16:19], s99 offen offset:1056 nt lds
v_mfma_f32_16x16x32_bf16 v[188:191], a[96:99], v[192:195], 0
s_add_u32 s99, s98, s51
s_nop 1
v_mfma_f32_16x16x32_bf16 v[188:191], a[100:103], v[196:199], v[188:191]
s_nop 1
v_cvt_pk_bf16_f32 v42, v204, v205
v_mfma_f32_16x16x32_bf16 v[188:191], a[104:107], v[216:219], v[188:191]
v_cvt_pk_bf16_f32 v43, v206, v207
v_mfma_f32_16x16x32_bf16 v[188:191], a[108:111], v[232:235], v[188:191]
s_nop 2
v_mfma_f32_16x16x32_bf16 v[204:207], a[124:127], v[232:235], 0
s_nop 2
v_mfma_f32_16x16x32_bf16 v[204:207], a[120:123], v[216:219], v[204:207]
v_cvt_pk_bf16_f32 v44, v188, v189
v_cvt_pk_bf16_f32 v45, v190, v191
v_mfma_f32_16x16x32_bf16 v[204:207], a[116:119], v[196:199], v[204:207]
v_mfma_f32_16x16x32_bf16 v[204:207], a[112:115], v[192:195], v[204:207]
s_nop 2
v_mfma_f32_16x16x32_bf16 v[188:191], a[0:3], v[192:195], 0
s_waitcnt lgkmcnt(0)
s_nop 1
v_mfma_f32_16x16x32_bf16 v[188:191], a[4:7], v[196:199], v[188:191]
v_cvt_pk_bf16_f32 v46, v204, v205
v_cvt_pk_bf16_f32 v47, v206, v207
v_mfma_f32_16x16x32_bf16 v[188:191], a[8:11], v[216:219], v[188:191]
v_mfma_f32_16x16x32_bf16 v[188:191], a[12:15], v[232:235], v[188:191]
v_mov_b64 v[168:169], 0
v_mov_b64 v[170:171], 0
v_mfma_f32_16x16x32_bf16 v[204:207], a[28:31], v[232:235], 0
v_mov_b64 v[172:173], 0
v_mov_b64 v[174:175], 0
v_mfma_f32_16x16x32_bf16 v[204:207], a[24:27], v[216:219], v[204:207]
v_mov_b64 v[176:177], 0
v_mov_b64 v[178:179], 0
v_mfma_f32_16x16x32_bf16 v[204:207], a[20:23], v[196:199], v[204:207]
v_cvt_pk_bf16_f32 v96, v188, v189
v_cvt_pk_bf16_f32 v97, v190, v191
v_mfma_f32_16x16x32_bf16 v[204:207], a[16:19], v[192:195], v[204:207]
s_nop 2
v_smfmac_f32_16x16x64_bf16 v[168:171], v[200:203], v[0:7], v251
s_nop 2
v_smfmac_f32_16x16x64_bf16 v[172:175], v[200:203], v[16:23], v251
v_cvt_pk_bf16_f32 v98, v204, v205
v_smfmac_f32_16x16x64_bf16 v[176:179], v[200:203], v[32:39], v251
v_cvt_pk_bf16_f32 v99, v206, v207
v_mfma_f32_16x16x32_bf16 v[188:191], a[32:35], v[192:195], 0
v_add_f32 v168, v168, v169
v_mfma_f32_16x16x32_bf16 v[188:191], a[36:39], v[196:199], v[188:191]
v_exp_f32 v168, v168
v_mfma_f32_16x16x32_bf16 v[188:191], a[40:43], v[216:219], v[188:191]
v_mfma_f32_16x16x32_bf16 v[188:191], a[44:47], v[232:235], v[188:191]
buffer_load_dwordx4 v243, s[16:19], s100 offen offset:2112 nt lds
v_mfma_f32_16x16x32_bf16 v[204:207], a[60:63], v[232:235], 0
s_add_u32 s100, s99, s51
s_nop 1
v_mfma_f32_16x16x32_bf16 v[204:207], a[56:59], v[216:219], v[204:207]
s_nop 1
v_cvt_pk_bf16_f32 v100, v188, v189
v_mfma_f32_16x16x32_bf16 v[204:207], a[52:55], v[196:199], v[204:207]
v_cvt_pk_bf16_f32 v101, v190, v191
v_mfma_f32_16x16x32_bf16 v[204:207], a[48:51], v[192:195], v[204:207]
s_nop 2
v_mfma_f32_16x16x32_bf16 v[136:139], a[192:195], v[192:195], 0
s_nop 2
v_mfma_f32_16x16x32_bf16 v[136:139], a[196:199], v[196:199], v[136:139]
v_cvt_pk_bf16_f32 v102, v204, v205
v_cvt_pk_bf16_f32 v103, v206, v207
v_mfma_f32_16x16x32_bf16 v[136:139], a[200:203], v[216:219], v[136:139]
v_mfma_f32_16x16x32_bf16 v[136:139], a[204:207], v[232:235], v[136:139]
v_smfmac_f32_16x16x64_bf16 v[170:173], v[200:203], v[8:15], v251
s_nop 2
v_smfmac_f32_16x16x64_bf16 v[174:177], v[200:203], v[24:31], v251
s_nop 2
v_smfmac_f32_16x16x64_bf16 v[178:181], v[200:203], v[40:47], v251
v_add_f32 v170, v170, v171
v_mfma_f32_16x16x32_bf16 v[140:143], a[220:223], v[232:235], 0
v_exp_f32 v170, v170
v_mfma_f32_16x16x32_bf16 v[140:143], a[216:219], v[216:219], v[140:143]
v_add_f32 v172, v172, v173
v_add_f32 v174, v174, v175
v_mfma_f32_16x16x32_bf16 v[140:143], a[212:215], v[196:199], v[140:143]
v_exp_f32 v172, v172
v_mfma_f32_16x16x32_bf16 v[140:143], a[208:211], v[192:195], v[140:143]
v_exp_f32 v174, v174
v_mfma_f32_16x16x32_bf16 v[144:147], a[224:227], v[192:195], 0
v_add_f32 v176, v176, v177
v_add_f32 v178, v178, v179
v_mfma_f32_16x16x32_bf16 v[144:147], a[228:231], v[196:199], v[144:147]
v_exp_f32 v176, v176
v_mfma_f32_16x16x32_bf16 v[144:147], a[232:235], v[216:219], v[144:147]
v_add_f32 v180, v168, v170
v_cvt_pk_bf16_f32 v169, v168, v170
v_mfma_f32_16x16x32_bf16 v[144:147], a[236:239], v[232:235], v[144:147]
ds_write_b16 v248, v169 offset:0
v_mfma_f32_16x16x32_bf16 v[148:151], a[252:255], v[232:235], 0
ds_write_b16_d16_hi v248, v169 offset:4
v_mfma_f32_16x16x32_bf16 v[148:151], a[248:251], v[216:219], v[148:151]
v_mov_b64 v[188:189], s[96:97]
v_mov_b64 v[190:191], s[96:97]
v_mfma_f32_16x16x32_bf16 v[148:151], a[244:247], v[196:199], v[148:151]
v_exp_f32 v178, v178
v_mfma_f32_16x16x32_bf16 v[148:151], a[240:243], v[192:195], v[148:151]
v_add_f32 v180, v180, v172
v_add_f32 v180, v180, v174
v_smfmac_f32_16x16x64_bf16 v[188:191], v[238:241], v[96:103], v251
v_add_f32 v180, v180, v176
v_mfma_f32_16x16x32_bf16 v[200:203], v[192:195], a[128:131], 0
v_add_f32 v180, v180, v178
v_cvt_pk_bf16_f32 v173, v172, v174
v_mfma_f32_16x16x32_bf16 v[200:203], v[196:199], a[132:135], v[200:203]
ds_write_b16 v248, v173 offset:272
v_mfma_f32_16x16x32_bf16 v[200:203], v[216:219], a[136:139], v[200:203]
ds_write_b16_d16_hi v248, v173 offset:276
v_mfma_f32_16x16x32_bf16 v[200:203], v[232:235], a[140:143], v[200:203]
buffer_load_dwordx4 v243, s[16:19], s101 offen offset:3168 nt lds
v_mfma_f32_16x16x32_bf16 v[204:207], v[232:235], a[156:159], 0
s_add_u32 m0, s49, 16896
v_add_f32 v188, v188, v189
v_add_f32 v190, v190, v191
v_mfma_f32_16x16x32_bf16 v[204:207], v[216:219], a[152:155], v[204:207]
s_add_u32 s101, s100, s51
v_exp_f32 v188, v188
v_mfma_f32_16x16x32_bf16 v[204:207], v[196:199], a[148:151], v[204:207]
s_and_b32 s51, s57, 13106176
v_exp_f32 v190, v190
v_mfma_f32_16x16x32_bf16 v[204:207], v[192:195], a[144:147], v[204:207]
s_sub_u32 s49, s49, s56
v_perm_b32 v116, v190, v188, v252
v_perm_b32 v117, v190, v188, v253
v_mfma_f32_16x16x32_bf16 v[208:211], v[192:195], a[160:163], 0
s_lshl3_add_u32 s48, s51, 8192
v_add_f32_dpp v180, v180, v180 row_ror:8 row_mask:0xf bank_mask:0xf
v_cvt_pk_bf16_f32 v177, v176, v178
v_mfma_f32_16x16x32_bf16 v[208:211], v[196:199], a[164:167], v[208:211]
s_sub_u32 s51, s51, 32
ds_write_b16 v248, v177 offset:544
v_mfma_f32_16x16x32_bf16 v[208:211], v[216:219], a[168:171], v[208:211]
ds_write_b16_d16_hi v248, v177 offset:548
v_mfma_f32_16x16x32_bf16 v[208:211], v[232:235], a[172:175], v[208:211]
v_add_f32_dpp v180, v180, v180 row_ror:4 row_mask:0xf bank_mask:0xf
v_cvt_pk_bf16_f32 v82, v200, v201
v_mfma_f32_16x16x32_bf16 v[212:215], v[232:235], a[188:191], 0
ds_write_b32 v250, v180 offset:256
v_mfma_f32_16x16x32_bf16 v[212:215], v[216:219], a[184:187], v[212:215]
v_cvt_pk_bf16_f32 v83, v202, v203
v_cvt_pk_bf16_f32 v86, v204, v205
v_mfma_f32_16x16x32_bf16 v[212:215], v[196:199], a[180:183], v[212:215]
ds_read_b128 v[188:191], v242 offset:768
v_cvt_pk_bf16_f32 v90, v208, v209
v_mfma_f32_16x16x32_bf16 v[212:215], v[192:195], a[176:179], v[212:215]
ds_read_b128 v[196:199], v242 offset:512
v_cvt_pk_bf16_f32 v91, v210, v211
v_mfma_f32_32x32x16_bf16 v[168:183], v[236:239], v[116:119], 0
buffer_store_dwordx4 v[152:155], v244, s[20:23], s53 offen offset:0 nt
buffer_store_dwordx4 v[160:163], v244, s[20:23], s53 offen offset:2048 nt
ds_read_b128 v[192:195], v242 offset:256
v_cvt_pk_bf16_f32 v87, v206, v207
s_add_u32 s53, s46, 0
v_cvt_pk_bf16_f32 v94, v212, v213
v_mfma_f32_16x16x32_bf16 v[200:203], v[12:15], v[100:103], 0
ds_read_b128 v[204:207], v242 offset:0
v_cvt_pk_bf16_f32 v95, v214, v215
v_mfma_f32_16x16x32_bf16 v[200:203], v[8:11], v[96:99], v[200:203]
s_waitcnt lgkmcnt(3)
s_nop 1
v_mfma_f32_16x16x32_bf16 v[208:211], v[32:35], v[96:99], 0
s_nop 2
v_mfma_f32_16x16x32_bf16 v[208:211], v[36:39], v[100:103], v[208:211]
v_exp_f32 v200, v200
v_mfma_f32_16x16x32_bf16 v[212:215], v[4:7], v[100:103], 0
s_waitcnt lgkmcnt(1)
v_exp_f32 v201, v201
v_mfma_f32_16x16x32_bf16 v[212:215], v[0:3], v[96:99], v[212:215]
v_exp_f32 v202, v202
v_mfma_f32_16x16x32_bf16 v[216:219], v[24:27], v[96:99], 0
v_exp_f32 v203, v203
v_mfma_f32_16x16x32_bf16 v[216:219], v[28:31], v[100:103], v[216:219]
v_cvt_pk_bf16_f32 v106, v200, v201
v_cvt_pk_bf16_f32 v107, v202, v203
v_mfma_f32_16x16x32_bf16 v[200:203], v[20:23], v[100:103], 0
s_nop 0
v_exp_f32 v212, v212
v_mfma_f32_16x16x32_bf16 v[200:203], v[16:19], v[96:99], v[200:203]
v_exp_f32 v213, v213
v_mfma_f32_16x16x32_bf16 v[220:223], v[40:43], v[96:99], 0
v_exp_f32 v214, v214
v_mfma_f32_16x16x32_bf16 v[220:223], v[44:47], v[100:103], v[220:223]
v_exp_f32 v215, v215
v_mfma_f32_16x16x32_bf16 v[224:227], v[188:191], a[188:191], 0
v_cvt_pk_bf16_f32 v104, v212, v213
v_cvt_pk_bf16_f32 v105, v214, v215
v_mfma_f32_16x16x32_bf16 v[224:227], v[196:199], a[184:187], v[224:227]
s_waitcnt lgkmcnt(0)
v_exp_f32 v200, v200
v_mfma_f32_16x16x32_bf16 v[224:227], v[192:195], a[180:183], v[224:227]
v_exp_f32 v201, v201
v_mfma_f32_16x16x32_bf16 v[224:227], v[204:207], a[176:179], v[224:227]
v_exp_f32 v202, v202
v_mfma_f32_16x16x32_bf16 v[228:231], v[204:207], a[160:163], 0
v_exp_f32 v203, v203
v_mfma_f32_16x16x32_bf16 v[228:231], v[192:195], a[164:167], v[228:231]
v_cvt_pk_bf16_f32 v108, v200, v201
v_cvt_pk_bf16_f32 v109, v202, v203
v_mfma_f32_16x16x32_bf16 v[228:231], v[196:199], a[168:171], v[228:231]
v_exp_f32 v216, v216
v_mfma_f32_16x16x32_bf16 v[228:231], v[188:191], a[172:175], v[228:231]
v_exp_f32 v217, v217
v_mfma_f32_16x16x32_bf16 v[212:215], v[188:191], a[156:159], 0
v_exp_f32 v218, v218
v_mfma_f32_16x16x32_bf16 v[212:215], v[196:199], a[152:155], v[212:215]
v_exp_f32 v219, v219
v_mfma_f32_16x16x32_bf16 v[212:215], v[192:195], a[148:151], v[212:215]
v_cvt_pk_bf16_f32 v110, v216, v217
v_cvt_pk_bf16_f32 v111, v218, v219
v_mfma_f32_16x16x32_bf16 v[212:215], v[204:207], a[144:147], v[212:215]
v_exp_f32 v208, v208
v_mfma_f32_16x16x32_bf16 v[200:203], v[204:207], a[128:131], 0
v_exp_f32 v209, v209
v_mfma_f32_16x16x32_bf16 v[200:203], v[192:195], a[132:135], v[200:203]
v_exp_f32 v210, v210
v_mfma_f32_16x16x32_bf16 v[200:203], v[196:199], a[136:139], v[200:203]
v_exp_f32 v211, v211
v_mfma_f32_16x16x32_bf16 v[200:203], v[188:191], a[140:143], v[200:203]
v_cvt_pk_bf16_f32 v112, v208, v209
v_cvt_pk_bf16_f32 v113, v210, v211
v_mfma_f32_16x16x32_bf16 v[216:219], a[0:3], v[204:207], 0
v_cvt_pk_bf16_f32 v60, v224, v225
v_cvt_pk_bf16_f32 v61, v226, v227
v_mfma_f32_16x16x32_bf16 v[216:219], a[4:7], v[192:195], v[216:219]
v_cvt_pk_bf16_f32 v56, v228, v229
v_cvt_pk_bf16_f32 v57, v230, v231
v_mfma_f32_16x16x32_bf16 v[216:219], a[8:11], v[196:199], v[216:219]
v_exp_f32 v220, v220
v_mfma_f32_16x16x32_bf16 v[216:219], a[12:15], v[188:191], v[216:219]
buffer_load_dwordx4 v243, s[16:19], s98 offen offset:0 nt lds
v_mfma_f32_16x16x32_bf16 v[232:235], a[28:31], v[188:191], 0
v_exp_f32 v221, v221
v_mfma_f32_16x16x32_bf16 v[232:235], a[24:27], v[196:199], v[232:235]
v_exp_f32 v222, v222
v_mfma_f32_16x16x32_bf16 v[232:235], a[20:23], v[192:195], v[232:235]
v_exp_f32 v223, v223
v_mfma_f32_16x16x32_bf16 v[232:235], a[16:19], v[204:207], v[232:235]
v_cvt_pk_bf16_f32 v96, v216, v217
v_cvt_pk_bf16_f32 v97, v218, v219
v_mfma_f32_16x16x32_bf16 v[208:211], a[32:35], v[204:207], 0
ds_read_b128 v[216:219], v242 offset:17408
v_cvt_pk_bf16_f32 v114, v220, v221
v_mfma_f32_16x16x32_bf16 v[208:211], a[36:39], v[192:195], v[208:211]
v_cvt_pk_bf16_f32 v115, v222, v223
v_cvt_pk_bf16_f32 v48, v200, v201
v_mfma_f32_16x16x32_bf16 v[208:211], a[40:43], v[196:199], v[208:211]
ds_read_b128 v[220:223], v242 offset:17664
v_cvt_pk_bf16_f32 v98, v232, v233
v_mfma_f32_16x16x32_bf16 v[208:211], a[44:47], v[188:191], v[208:211]
v_cvt_pk_bf16_f32 v99, v234, v235
v_cvt_pk_bf16_f32 v49, v202, v203
v_mfma_f32_16x16x32_bf16 v[224:227], a[60:63], v[188:191], 0
ds_read_b128 v[200:203], v242 offset:16896
v_cvt_pk_bf16_f32 v52, v212, v213
v_mfma_f32_16x16x32_bf16 v[224:227], a[56:59], v[196:199], v[224:227]
v_cvt_pk_bf16_f32 v53, v214, v215
v_mfma_f32_16x16x32_bf16 v[224:227], a[52:55], v[192:195], v[224:227]
ds_read_b128 v[212:215], v242 offset:17152
v_cvt_pk_bf16_f32 v100, v208, v209
v_mfma_f32_16x16x32_bf16 v[224:227], a[48:51], v[204:207], v[224:227]
ds_read_b128 v[228:231], v242 offset:4480
v_cvt_pk_bf16_f32 v101, v210, v211
v_mfma_f32_16x16x32_bf16 v[152:155], a[192:195], v[204:207], 0
ds_read_b128 v[208:211], v242 offset:4224
ds_read_b128 v[232:235], v242 offset:4736
v_mfma_f32_16x16x32_bf16 v[152:155], a[196:199], v[192:195], v[152:155]
s_nop 1
v_cvt_pk_bf16_f32 v102, v224, v225
v_mfma_f32_16x16x32_bf16 v[152:155], a[200:203], v[196:199], v[152:155]
v_cvt_pk_bf16_f32 v103, v226, v227
v_mfma_f32_16x16x32_bf16 v[152:155], a[204:207], v[188:191], v[152:155]
ds_read_b128 v[224:227], v242 offset:4992
v_mfma_f32_16x16x32_bf16 v[156:159], a[220:223], v[188:191], 0
v_mfma_f32_16x16x32_bf16 v[156:159], a[216:219], v[196:199], v[156:159]
s_waitcnt lgkmcnt(7)
v_mfma_f32_16x16x32_bf16 v[156:159], a[212:215], v[192:195], v[156:159]
v_mfma_f32_16x16x32_bf16 v[156:159], a[208:211], v[204:207], v[156:159]
s_waitcnt lgkmcnt(6)
v_mfma_f32_16x16x32_bf16 v[160:163], a[224:227], v[204:207], 0
v_mfma_f32_16x16x32_bf16 v[160:163], a[228:231], v[192:195], v[160:163]
s_waitcnt lgkmcnt(5)
v_mfma_f32_16x16x32_bf16 v[160:163], a[232:235], v[196:199], v[160:163]
v_mfma_f32_16x16x32_bf16 v[160:163], a[236:239], v[188:191], v[160:163]
buffer_load_dwordx4 v243, s[16:19], s99 offen offset:1056 nt lds
v_mfma_f32_16x16x32_bf16 v[164:167], a[252:255], v[188:191], 0
s_waitcnt lgkmcnt(3)
v_mov_b64 v[188:189], s[96:97]
v_mov_b64 v[190:191], s[96:97]
v_mfma_f32_16x16x32_bf16 v[164:167], a[248:251], v[196:199], v[164:167]
s_waitcnt lgkmcnt(1)
v_mfma_f32_16x16x32_bf16 v[164:167], a[244:247], v[192:195], v[164:167]
v_mfma_f32_16x16x32_bf16 v[164:167], a[240:243], v[204:207], v[164:167]
v_smfmac_f32_16x16x64_bf16 v[188:191], v[238:241], v[96:103], v251
s_waitcnt lgkmcnt(0)
s_nop 1
v_mfma_f32_16x16x32_bf16 v[192:195], v[0:3], v[96:99], 0
s_nop 2
v_mfma_f32_16x16x32_bf16 v[192:195], v[4:7], v[100:103], v[192:195]
v_add_f32 v188, v188, v189
v_add_f32 v190, v190, v191
v_mfma_f32_16x16x32_bf16 v[196:199], v[12:15], v[100:103], 0
v_exp_f32 v188, v188
v_mfma_f32_16x16x32_bf16 v[196:199], v[8:11], v[96:99], v[196:199]
v_exp_f32 v190, v190
v_mfma_f32_16x16x32_bf16 v[204:207], v[208:211], a[128:131], 0
v_perm_b32 v132, v190, v188, v252
v_perm_b32 v133, v190, v188, v253
v_mfma_f32_16x16x32_bf16 v[204:207], v[228:231], a[132:135], v[204:207]
v_exp_f32 v192, v192
v_mfma_f32_16x16x32_bf16 v[204:207], v[232:235], a[136:139], v[204:207]
v_exp_f32 v193, v193
v_mfma_f32_16x16x32_bf16 v[204:207], v[224:227], a[140:143], v[204:207]
v_exp_f32 v194, v194
v_mfma_f32_16x16x32_bf16 v[188:191], v[224:227], a[156:159], 0
v_exp_f32 v195, v195
v_mfma_f32_16x16x32_bf16 v[188:191], v[232:235], a[152:155], v[188:191]
v_cvt_pk_bf16_f32 v120, v192, v193
v_cvt_pk_bf16_f32 v121, v194, v195
v_mfma_f32_16x16x32_bf16 v[188:191], v[228:231], a[148:151], v[188:191]
s_nop 0
v_cvt_pk_bf16_f32 v50, v204, v205
v_cvt_pk_bf16_f32 v51, v206, v207
v_mfma_f32_16x16x32_bf16 v[188:191], v[208:211], a[144:147], v[188:191]
v_exp_f32 v196, v196
v_mfma_f32_16x16x32_bf16 v[192:195], v[208:211], a[160:163], 0
v_exp_f32 v197, v197
v_mfma_f32_16x16x32_bf16 v[192:195], v[228:231], a[164:167], v[192:195]
v_exp_f32 v198, v198
v_mfma_f32_16x16x32_bf16 v[192:195], v[232:235], a[168:171], v[192:195]
v_exp_f32 v199, v199
v_mfma_f32_16x16x32_bf16 v[192:195], v[224:227], a[172:175], v[192:195]
buffer_load_dwordx4 v243, s[16:19], s100 offen offset:2112 nt lds
v_mfma_f32_16x16x32_bf16 v[204:207], v[224:227], a[188:191], 0
v_cvt_pk_bf16_f32 v54, v188, v189
v_cvt_pk_bf16_f32 v55, v190, v191
v_mfma_f32_16x16x32_bf16 v[204:207], v[232:235], a[184:187], v[204:207]
v_mov_b64 v[188:189], 0
v_cvt_pk_bf16_f32 v122, v196, v197
v_mfma_f32_16x16x32_bf16 v[204:207], v[228:231], a[180:183], v[204:207]
v_cvt_pk_bf16_f32 v58, v192, v193
v_cvt_pk_bf16_f32 v59, v194, v195
v_mfma_f32_16x16x32_bf16 v[204:207], v[208:211], a[176:179], v[204:207]
v_cvt_pk_bf16_f32 v123, v198, v199
s_nop 0
v_mfma_f32_16x16x32_bf16 v[192:195], v[16:19], v[96:99], 0
s_nop 2
v_mfma_f32_16x16x32_bf16 v[192:195], v[20:23], v[100:103], v[192:195]
s_nop 0
v_cvt_pk_bf16_f32 v62, v204, v205
v_cvt_pk_bf16_f32 v63, v206, v207
v_smfmac_f32_16x16x64_bf16 v[188:191], v[184:187], v[104:111], v251
s_nop 2
v_smfmac_f32_16x16x64_bf16 v[188:191], v[184:187], v[112:119], v251 abid:1
s_nop 2
v_mfma_f32_16x16x32_bf16 v[196:199], v[220:223], a[188:191], 0
v_exp_f32 v192, v192
v_mfma_f32_16x16x32_bf16 v[196:199], v[216:219], a[184:187], v[196:199]
v_exp_f32 v193, v193
v_mfma_f32_16x16x32_bf16 v[196:199], v[212:215], a[180:183], v[196:199]
v_add_f32 v188, v188, v189
v_cvt_pk_bf16_f32 v124, v192, v193
v_mfma_f32_16x16x32_bf16 v[196:199], v[200:203], a[176:179], v[196:199]
v_rcp_f32 v254, v188
v_mfma_f32_16x16x32_bf16 v[204:207], v[36:39], v[100:103], 0
v_max3_f32 v255, v255, v188, v254
s_nop 0
v_mfma_f32_16x16x32_bf16 v[204:207], v[32:35], v[96:99], v[204:207]
v_exp_f32 v194, v194
v_mfma_f32_16x16x32_bf16 v[208:211], v[24:27], v[96:99], 0
v_exp_f32 v195, v195
v_mfma_f32_16x16x32_bf16 v[208:211], v[28:31], v[100:103], v[208:211]
v_cvt_pk_bf16_f32 v125, v194, v195
v_cvt_pk_bf16_f32 v92, v196, v197
v_mfma_f32_16x16x32_bf16 v[188:191], v[200:203], a[160:163], 0
v_cvt_pk_bf16_f32 v93, v198, v199
s_nop 0
v_mfma_f32_16x16x32_bf16 v[188:191], v[212:215], a[164:167], v[188:191]
v_exp_f32 v204, v204
v_mfma_f32_16x16x32_bf16 v[188:191], v[216:219], a[168:171], v[188:191]
v_exp_f32 v208, v208
v_mfma_f32_16x16x32_bf16 v[188:191], v[220:223], a[172:175], v[188:191]
buffer_load_dwordx4 v243, s[16:19], s101 offen offset:3168 nt lds
v_mfma_f32_16x16x32_bf16 v[192:195], v[220:223], a[156:159], 0
s_mov_b32 m0, s58
v_exp_f32 v209, v209
v_mfma_f32_16x16x32_bf16 v[192:195], v[216:219], a[152:155], v[192:195]
v_exp_f32 v210, v210
v_mfma_f32_16x16x32_bf16 v[192:195], v[212:215], a[148:151], v[192:195]
s_nop 0
v_cvt_pk_bf16_f32 v88, v188, v189
v_cvt_pk_bf16_f32 v89, v190, v191
v_mfma_f32_16x16x32_bf16 v[192:195], v[200:203], a[144:147], v[192:195]
v_exp_f32 v211, v211
v_mfma_f32_16x16x32_bf16 v[188:191], v[200:203], a[128:131], 0
v_cvt_pk_bf16_f32 v126, v208, v209
v_cvt_pk_bf16_f32 v127, v210, v211
v_mfma_f32_16x16x32_bf16 v[188:191], v[212:215], a[132:135], v[188:191]
v_exp_f32 v205, v205
v_mfma_f32_16x16x32_bf16 v[188:191], v[216:219], a[136:139], v[188:191]
s_nop 0
v_cvt_pk_bf16_f32 v84, v192, v193
v_cvt_pk_bf16_f32 v85, v194, v195
v_mfma_f32_16x16x32_bf16 v[188:191], v[220:223], a[140:143], v[188:191]
v_exp_f32 v206, v206
v_mfma_f32_16x16x32_bf16 v[192:195], v[40:43], v[96:99], 0
v_exp_f32 v207, v207
v_mfma_f32_16x16x32_bf16 v[192:195], v[44:47], v[100:103], v[192:195]
v_cvt_pk_bf16_f32 v128, v204, v205
v_cvt_pk_bf16_f32 v129, v206, v207
v_mfma_f32_16x16x32_bf16 v[168:171], v[48:51], v[104:107], v[168:171]
s_nop 0
v_cvt_pk_bf16_f32 v80, v188, v189
v_cvt_pk_bf16_f32 v81, v190, v191
L_entryf:
v_mfma_f32_16x16x32_bf16 v[168:171], v[64:67], v[108:111], v[168:171]
s_nop 0
v_exp_f32 v192, v192
v_mfma_f32_16x16x32_bf16 v[168:171], v[80:83], v[112:115], v[168:171]
L_h2:
s_cbranch_execz L_ret
v_exp_f32 v193, v193
v_mfma_f32_16x16x32_bf16 v[172:175], v[84:87], v[112:115], v[172:175]
v_exp_f32 v194, v194
v_mfma_f32_16x16x32_bf16 v[172:175], v[52:55], v[104:107], v[172:175]
ds_read_b128 v[188:191], v249 offset:0
v_cvt_pk_bf16_f32 v130, v192, v193
v_mfma_f32_16x16x32_bf16 v[172:175], v[68:71], v[108:111], v[172:175]
ds_read_b128 v[196:199], v249 offset:272
ds_read_b128 v[204:207], v249 offset:544
v_mfma_f32_16x16x32_bf16 v[176:179], v[72:75], v[108:111], v[176:179]
v_exp_f32 v195, v195
v_mfma_f32_16x16x32_bf16 v[176:179], v[88:91], v[112:115], v[176:179]
v_cvt_pk_bf16_f32 v131, v194, v195
v_fmac_f32 v136, v168, v254
v_mfma_f32_16x16x32_bf16 v[176:179], v[56:59], v[104:107], v[176:179]
v_fmac_f32 v137, v169, v254
v_fmac_f32 v138, v170, v254
v_mfma_f32_16x16x32_bf16 v[180:183], v[60:63], v[104:107], v[180:183]
v_fmac_f32 v139, v171, v254
v_cvt_pk_bf16_f32 v136, v136, v137
v_mfma_f32_16x16x32_bf16 v[180:183], v[76:79], v[108:111], v[180:183]
v_fmac_f32 v140, v172, v254
v_fmac_f32 v141, v173, v254
v_mfma_f32_16x16x32_bf16 v[180:183], v[92:95], v[112:115], v[180:183]
v_fmac_f32 v144, v176, v254
v_fmac_f32 v145, v177, v254
v_mfma_f32_16x16x32_bf16 v[192:195], a[0:3], v[200:203], 0
v_fmac_f32 v146, v178, v254
v_fmac_f32 v147, v179, v254
v_mfma_f32_16x16x32_bf16 v[192:195], a[4:7], v[212:215], v[192:195]
v_cvt_pk_bf16_f32 v144, v144, v145
v_fmac_f32 v142, v174, v254
v_mfma_f32_16x16x32_bf16 v[192:195], a[8:11], v[216:219], v[192:195]
v_fmac_f32 v143, v175, v254
v_cvt_pk_bf16_f32 v137, v138, v139
v_mfma_f32_16x16x32_bf16 v[192:195], a[12:15], v[220:223], v[192:195]
v_fmac_f32 v148, v180, v254
v_fmac_f32 v149, v181, v254
v_mfma_f32_16x16x32_bf16 v[208:211], a[28:31], v[220:223], 0
v_fmac_f32 v150, v182, v254
v_fmac_f32 v151, v183, v254
v_mfma_f32_16x16x32_bf16 v[208:211], a[24:27], v[216:219], v[208:211]
s_waitcnt lgkmcnt(2)
v_cvt_pk_bf16_f32 v145, v146, v147
v_cvt_pk_bf16_f32 v96, v192, v193
v_mfma_f32_16x16x32_bf16 v[208:211], a[20:23], v[212:215], v[208:211]
s_waitcnt lgkmcnt(0)
v_cvt_pk_bf16_f32 v97, v194, v195
v_cvt_pk_bf16_f32 v138, v140, v141
v_mfma_f32_16x16x32_bf16 v[208:211], a[16:19], v[200:203], v[208:211]
v_cvt_pk_bf16_f32 v139, v142, v143
v_cvt_pk_bf16_f32 v146, v148, v149
v_mfma_f32_16x16x32_bf16 v[192:195], a[32:35], v[200:203], 0
v_cvt_pk_bf16_f32 v147, v150, v151
v_pk_max_i16 v136, v136, 0
v_mfma_f32_16x16x32_bf16 v[192:195], a[36:39], v[212:215], v[192:195]
v_pk_max_i16 v137, v137, 0
v_pk_max_i16 v138, v138, 0
v_mfma_f32_16x16x32_bf16 v[192:195], a[40:43], v[216:219], v[192:195]
v_cvt_pk_bf16_f32 v98, v208, v209
v_cvt_pk_bf16_f32 v99, v210, v211
v_mfma_f32_16x16x32_bf16 v[192:195], a[44:47], v[220:223], v[192:195]
v_mov_b64 v[208:209], 0
v_mov_b64 v[210:211], 0
v_mfma_f32_16x16x32_bf16 v[224:227], a[60:63], v[220:223], 0
v_pk_max_i16 v139, v139, 0
v_pk_max_i16 v144, v144, 0
v_mfma_f32_16x16x32_bf16 v[224:227], a[56:59], v[216:219], v[224:227]
v_pk_max_i16 v145, v145, 0
v_pk_max_i16 v146, v146, 0
v_mfma_f32_16x16x32_bf16 v[224:227], a[52:55], v[212:215], v[224:227]
v_mov_b64 v[228:229], 0
v_mov_b64 v[230:231], 0
v_mfma_f32_16x16x32_bf16 v[224:227], a[48:51], v[200:203], v[224:227]
v_cvt_pk_bf16_f32 v100, v192, v193
v_cvt_pk_bf16_f32 v101, v194, v195
v_smfmac_f32_16x16x64_bf16 v[208:211], v[188:191], v[48:55], v251
v_pk_max_i16 v147, v147, 0
v_smfmac_f32_16x16x64_bf16 v[208:211], v[196:199], v[64:71], v251
v_mov_b64 v[140:141], v[136:137]
v_smfmac_f32_16x16x64_bf16 v[208:211], v[204:207], v[80:87], v251
s_nop 0
v_cvt_pk_bf16_f32 v102, v224, v225
v_smfmac_f32_16x16x64_bf16 v[228:231], v[204:207], v[88:95], v251
v_cvt_pk_bf16_f32 v103, v226, v227
v_smfmac_f32_16x16x64_bf16 v[228:231], v[196:199], v[72:79], v251
v_mov_b64 v[142:143], v[138:139]
v_smfmac_f32_16x16x64_bf16 v[228:231], v[188:191], v[56:63], v251
v_mov_b32_dpp v136, v144 row_ror:8 row_mask:0xf bank_mask:0xc
v_mfma_f32_16x16x32_bf16 v[188:191], v[28:31], v[100:103], 0
v_mov_b32_dpp v137, v145 row_ror:8 row_mask:0xf bank_mask:0xc
v_mov_b32_dpp v138, v146 row_ror:8 row_mask:0xf bank_mask:0xc
v_mfma_f32_16x16x32_bf16 v[188:191], v[24:27], v[96:99], v[188:191]
v_mov_b64 v[192:193], s[96:97]
v_mov_b64 v[194:195], s[96:97]
v_mfma_f32_16x16x32_bf16 v[196:199], v[8:11], v[96:99], 0
v_mov_b32_dpp v139, v147 row_ror:8 row_mask:0xf bank_mask:0xc
v_mov_b32_dpp v144, v140 row_ror:8 row_mask:0xf bank_mask:0x3
v_mfma_f32_16x16x32_bf16 v[196:199], v[12:15], v[100:103], v[196:199]
v_mov_b32_dpp v145, v141 row_ror:8 row_mask:0xf bank_mask:0x3
v_mov_b32_dpp v146, v142 row_ror:8 row_mask:0xf bank_mask:0x3
v_mfma_f32_16x16x32_bf16 v[204:207], v[4:7], v[100:103], 0
v_mov_b32_dpp v147, v143 row_ror:8 row_mask:0xf bank_mask:0x3
v_add_f32 v208, v208, v209
v_mfma_f32_16x16x32_bf16 v[204:207], v[0:3], v[96:99], v[204:207]
ds_write_b32 v250, v208 offset:0
v_smfmac_f32_16x16x64_bf16 v[192:195], v[238:241], v[96:103], v251
v_add_f32 v210, v210, v211
v_mfma_f32_16x16x32_bf16 v[224:227], v[16:19], v[96:99], 0
ds_write_b32 v250, v210 offset:64
v_mfma_f32_16x16x32_bf16 v[224:227], v[20:23], v[100:103], v[224:227]
v_exp_f32 v188, v188
v_mfma_f32_32x32x16_bf16 v[168:183], v[236:239], v[132:135], 0
buffer_store_dwordx4 v[136:139], v244, s[20:23], s52 offen offset:0 nt
buffer_store_dwordx4 v[144:147], v244, s[20:23], s52 offen offset:2048 nt
v_add_f32 v192, v192, v193
v_add_f32 v194, v194, v195
v_exp_f32 v192, v192
v_mfma_f32_16x16x32_bf16 v[136:139], a[192:195], v[200:203], 0
s_add_u32 s52, s46, 16384
v_exp_f32 v194, v194
v_mfma_f32_16x16x32_bf16 v[136:139], a[196:199], v[212:215], v[136:139]
v_perm_b32 v116, v194, v192, v252
v_perm_b32 v117, v194, v192, v253
v_mfma_f32_16x16x32_bf16 v[136:139], a[200:203], v[216:219], v[136:139]
v_exp_f32 v196, v196
v_mfma_f32_16x16x32_bf16 v[136:139], a[204:207], v[220:223], v[136:139]
v_exp_f32 v197, v197
v_mfma_f32_16x16x32_bf16 v[140:143], a[220:223], v[220:223], 0
v_exp_f32 v198, v198
v_mfma_f32_16x16x32_bf16 v[140:143], a[216:219], v[216:219], v[140:143]
v_exp_f32 v199, v199
v_mfma_f32_16x16x32_bf16 v[140:143], a[212:215], v[212:215], v[140:143]
v_cvt_pk_bf16_f32 v106, v196, v197
v_cvt_pk_bf16_f32 v107, v198, v199
v_mfma_f32_16x16x32_bf16 v[140:143], a[208:211], v[200:203], v[140:143]
v_exp_f32 v189, v189
v_mfma_f32_16x16x32_bf16 v[144:147], a[224:227], v[200:203], 0
v_exp_f32 v190, v190
v_mfma_f32_16x16x32_bf16 v[144:147], a[228:231], v[212:215], v[144:147]
v_exp_f32 v191, v191
v_mfma_f32_16x16x32_bf16 v[144:147], a[232:235], v[216:219], v[144:147]
v_cvt_pk_bf16_f32 v110, v188, v189
v_cvt_pk_bf16_f32 v111, v190, v191
v_mfma_f32_16x16x32_bf16 v[144:147], a[236:239], v[220:223], v[144:147]
v_exp_f32 v204, v204
v_mfma_f32_16x16x32_bf16 v[192:195], v[40:43], v[96:99], 0
v_exp_f32 v205, v205
v_mfma_f32_16x16x32_bf16 v[192:195], v[44:47], v[100:103], v[192:195]
v_mov_b64 v[208:209], 0
v_cvt_pk_bf16_f32 v104, v204, v205
v_mfma_f32_16x16x32_bf16 v[148:151], a[252:255], v[220:223], 0
ds_read_b128 v[220:223], v242 offset:4224
ds_read_b128 v[188:191], v242 offset:4480
v_mfma_f32_16x16x32_bf16 v[148:151], a[248:251], v[216:219], v[148:151]
ds_read_b128 v[216:219], v242 offset:4736
v_add_f32 v228, v228, v229
v_mfma_f32_16x16x32_bf16 v[148:151], a[244:247], v[212:215], v[148:151]
ds_read_b128 v[212:215], v242 offset:4992
v_add_f32 v230, v230, v231
v_mfma_f32_16x16x32_bf16 v[148:151], a[240:243], v[200:203], v[148:151]
ds_write_b32 v250, v228 offset:128
v_smfmac_f32_16x16x64_bf16 v[208:211], v[184:187], v[120:127], v251
ds_write_b32 v250, v230 offset:192
v_smfmac_f32_16x16x64_bf16 v[208:211], v[184:187], v[128:135], v251 abid:1
s_nop 0
v_add_u32 v250, 1728, v250
v_mfma_f32_16x16x32_bf16 v[168:171], v[80:83], v[128:131], v[168:171]
s_waitcnt lgkmcnt(4)
v_exp_f32 v206, v206
v_mfma_f32_16x16x32_bf16 v[168:171], v[64:67], v[124:127], v[168:171]
v_exp_f32 v207, v207
v_mfma_f32_16x16x32_bf16 v[168:171], v[48:51], v[120:123], v[168:171]
v_cvt_pk_bf16_f32 v105, v206, v207
v_add_f32 v208, v208, v209
v_mfma_f32_16x16x32_bf16 v[172:175], v[52:55], v[120:123], v[172:175]
v_rcp_f32 v254, v208
v_mfma_f32_16x16x32_bf16 v[172:175], v[68:71], v[124:127], v[172:175]
v_max3_f32 v255, v255, v208, v254
s_nop 0
v_mfma_f32_16x16x32_bf16 v[172:175], v[84:87], v[128:131], v[172:175]
v_fmac_f32 v152, v168, v254
v_fmac_f32 v153, v169, v254
v_mfma_f32_16x16x32_bf16 v[176:179], v[88:91], v[128:131], v[176:179]
v_fmac_f32 v154, v170, v254
v_fmac_f32 v155, v171, v254
v_mfma_f32_16x16x32_bf16 v[176:179], v[72:75], v[124:127], v[176:179]
v_cvt_pk_bf16_f32 v152, v152, v153
v_cvt_pk_bf16_f32 v153, v154, v155
v_mfma_f32_16x16x32_bf16 v[176:179], v[56:59], v[120:123], v[176:179]
s_waitcnt lgkmcnt(3)
v_fmac_f32 v156, v172, v254
v_fmac_f32 v157, v173, v254
v_mfma_f32_16x16x32_bf16 v[180:183], v[60:63], v[120:123], v[180:183]
s_waitcnt lgkmcnt(2)
v_fmac_f32 v158, v174, v254
v_fmac_f32 v159, v175, v254
v_mfma_f32_16x16x32_bf16 v[180:183], v[76:79], v[124:127], v[180:183]
v_fmac_f32 v160, v176, v254
v_fmac_f32 v161, v177, v254
v_mfma_f32_16x16x32_bf16 v[180:183], v[92:95], v[128:131], v[180:183]
v_fmac_f32 v162, v178, v254
v_fmac_f32 v163, v179, v254
v_mfma_f32_16x16x32_bf16 v[196:199], v[32:35], v[96:99], 0
v_cvt_pk_bf16_f32 v160, v160, v161
v_cvt_pk_bf16_f32 v161, v162, v163
v_mfma_f32_16x16x32_bf16 v[196:199], v[36:39], v[100:103], v[196:199]
v_cvt_pk_bf16_f32 v154, v156, v157
v_cvt_pk_bf16_f32 v155, v158, v159
v_mfma_f32_16x16x32_bf16 v[200:203], a[0:3], v[220:223], 0
v_fmac_f32 v164, v180, v254
v_fmac_f32 v165, v181, v254
v_mfma_f32_16x16x32_bf16 v[200:203], a[4:7], v[188:191], v[200:203]
v_fmac_f32 v166, v182, v254
v_fmac_f32 v167, v183, v254
v_mfma_f32_16x16x32_bf16 v[200:203], a[8:11], v[216:219], v[200:203]
v_cvt_pk_bf16_f32 v162, v164, v165
v_cvt_pk_bf16_f32 v163, v166, v167
v_mfma_f32_16x16x32_bf16 v[200:203], a[12:15], v[212:215], v[200:203]
v_pk_max_i16 v152, v152, 0
v_pk_max_i16 v153, v153, 0
v_mfma_f32_16x16x32_bf16 v[204:207], a[28:31], v[212:215], 0
v_pk_max_i16 v154, v154, 0
v_pk_max_i16 v155, v155, 0
v_mfma_f32_16x16x32_bf16 v[204:207], a[24:27], v[216:219], v[204:207]
v_pk_max_i16 v160, v160, 0
v_pk_max_i16 v161, v161, 0
v_mfma_f32_16x16x32_bf16 v[204:207], a[20:23], v[188:191], v[204:207]
v_pk_max_i16 v162, v162, 0
v_pk_max_i16 v163, v163, 0
v_mfma_f32_16x16x32_bf16 v[204:207], a[16:19], v[220:223], v[204:207]
v_mov_b64 v[156:157], v[152:153]
v_mov_b64 v[158:159], v[154:155]
v_mfma_f32_16x16x32_bf16 v[208:211], a[32:35], v[220:223], 0
v_mov_b32_dpp v152, v160 row_ror:8 row_mask:0xf bank_mask:0xc
v_mov_b32_dpp v153, v161 row_ror:8 row_mask:0xf bank_mask:0xc
v_mfma_f32_16x16x32_bf16 v[208:211], a[36:39], v[188:191], v[208:211]
v_mov_b32_dpp v154, v162 row_ror:8 row_mask:0xf bank_mask:0xc
v_mov_b32_dpp v155, v163 row_ror:8 row_mask:0xf bank_mask:0xc
v_mfma_f32_16x16x32_bf16 v[208:211], a[40:43], v[216:219], v[208:211]
v_mov_b32_dpp v160, v156 row_ror:8 row_mask:0xf bank_mask:0x3
v_mov_b32_dpp v161, v157 row_ror:8 row_mask:0xf bank_mask:0x3
v_mfma_f32_16x16x32_bf16 v[208:211], a[44:47], v[212:215], v[208:211]
v_mov_b32_dpp v162, v158 row_ror:8 row_mask:0xf bank_mask:0x3
v_mov_b32_dpp v163, v159 row_ror:8 row_mask:0xf bank_mask:0x3
v_mfma_f32_32x32x16_bf16 v[168:183], v[236:239], v[116:119], 0
buffer_store_dwordx4 v[152:155], v244, s[20:23], s53 offen offset:0 nt
buffer_store_dwordx4 v[160:163], v244, s[20:23], s53 offen offset:2048 nt
v_cvt_pk_bf16_f32 v96, v200, v201
v_cvt_pk_bf16_f32 v97, v202, v203
v_exp_f32 v192, v192
v_mfma_f32_16x16x32_bf16 v[200:203], a[60:63], v[212:215], 0
s_add_u32 s53, s46, 4096
v_exp_f32 v193, v193
v_mfma_f32_16x16x32_bf16 v[200:203], a[56:59], v[216:219], v[200:203]
s_add_u32 s46, s46, 13107200
v_exp_f32 v194, v194
v_mfma_f32_16x16x32_bf16 v[200:203], a[52:55], v[188:191], v[200:203]
v_exp_f32 v195, v195
v_mfma_f32_16x16x32_bf16 v[200:203], a[48:51], v[220:223], v[200:203]
v_cvt_pk_bf16_f32 v114, v192, v193
v_cvt_pk_bf16_f32 v115, v194, v195
v_mfma_f32_16x16x32_bf16 v[152:155], a[192:195], v[220:223], 0
v_cvt_pk_bf16_f32 v98, v204, v205
v_cvt_pk_bf16_f32 v99, v206, v207
v_mfma_f32_16x16x32_bf16 v[152:155], a[196:199], v[188:191], v[152:155]
v_cvt_pk_bf16_f32 v100, v208, v209
v_cvt_pk_bf16_f32 v101, v210, v211
v_mfma_f32_16x16x32_bf16 v[152:155], a[200:203], v[216:219], v[152:155]
v_cvt_pk_bf16_f32 v102, v200, v201
v_cvt_pk_bf16_f32 v103, v202, v203
v_mfma_f32_16x16x32_bf16 v[152:155], a[204:207], v[212:215], v[152:155]
ds_read_b128 v[204:207], v242 offset:8448
ds_read_b128 v[232:235], v242 offset:9216
v_mfma_f32_16x16x32_bf16 v[156:159], a[220:223], v[212:215], 0
ds_read_b128 v[208:211], v242 offset:8704
v_mfma_f32_16x16x32_bf16 v[156:159], a[216:219], v[216:219], v[156:159]
v_exp_f32 v196, v196
v_mfma_f32_16x16x32_bf16 v[156:159], a[212:215], v[188:191], v[156:159]
v_exp_f32 v197, v197
v_mfma_f32_16x16x32_bf16 v[156:159], a[208:211], v[220:223], v[156:159]
v_exp_f32 v198, v198
v_mfma_f32_16x16x32_bf16 v[160:163], a[224:227], v[220:223], 0
v_exp_f32 v199, v199
v_mfma_f32_16x16x32_bf16 v[160:163], a[228:231], v[188:191], v[160:163]
v_cvt_pk_bf16_f32 v112, v196, v197
v_cvt_pk_bf16_f32 v113, v198, v199
v_mfma_f32_16x16x32_bf16 v[160:163], a[232:235], v[216:219], v[160:163]
v_exp_f32 v224, v224
v_mfma_f32_16x16x32_bf16 v[160:163], a[236:239], v[212:215], v[160:163]
v_mov_b64 v[192:193], s[96:97]
v_mov_b64 v[194:195], s[96:97]
v_mfma_f32_16x16x32_bf16 v[164:167], a[252:255], v[212:215], 0
v_exp_f32 v225, v225
v_mfma_f32_16x16x32_bf16 v[164:167], a[248:251], v[216:219], v[164:167]
v_exp_f32 v226, v226
v_mfma_f32_16x16x32_bf16 v[164:167], a[244:247], v[188:191], v[164:167]
v_exp_f32 v227, v227
v_mfma_f32_16x16x32_bf16 v[164:167], a[240:243], v[220:223], v[164:167]
v_cvt_pk_bf16_f32 v108, v224, v225
v_cvt_pk_bf16_f32 v109, v226, v227
v_smfmac_f32_16x16x64_bf16 v[192:195], v[238:241], v[96:103], v251
s_waitcnt lgkmcnt(1)
ds_read_b128 v[224:227], v242 offset:8960
v_mov_b64 v[188:189], 0
v_mfma_f32_16x16x32_bf16 v[196:199], v[16:19], v[96:99], 0
s_waitcnt lgkmcnt(1)
s_nop 1
v_mfma_f32_16x16x32_bf16 v[196:199], v[20:23], v[100:103], v[196:199]
v_add_f32 v192, v192, v193
v_add_f32 v194, v194, v195
v_mfma_f32_16x16x32_bf16 v[200:203], v[12:15], v[100:103], 0
v_exp_f32 v192, v192
v_mfma_f32_16x16x32_bf16 v[200:203], v[8:11], v[96:99], v[200:203]
v_exp_f32 v194, v194
v_smfmac_f32_16x16x64_bf16 v[188:191], v[184:187], v[104:111], v251
v_perm_b32 v132, v194, v192, v252
v_smfmac_f32_16x16x64_bf16 v[188:191], v[184:187], v[112:119], v251 abid:1
v_perm_b32 v133, v194, v192, v253
v_mfma_f32_16x16x32_bf16 v[168:171], v[80:83], v[112:115], v[168:171]
v_exp_f32 v196, v196
v_mfma_f32_16x16x32_bf16 v[168:171], v[64:67], v[108:111], v[168:171]
v_exp_f32 v200, v200
v_mfma_f32_16x16x32_bf16 v[168:171], v[48:51], v[104:107], v[168:171]
v_exp_f32 v201, v201
v_mfma_f32_16x16x32_bf16 v[172:175], v[52:55], v[104:107], v[172:175]
v_add_f32 v188, v188, v189
v_cvt_pk_bf16_f32 v122, v200, v201
v_mfma_f32_16x16x32_bf16 v[172:175], v[68:71], v[108:111], v[172:175]
v_rcp_f32 v254, v188
v_mfma_f32_16x16x32_bf16 v[172:175], v[84:87], v[112:115], v[172:175]
v_max3_f32 v255, v255, v188, v254
v_fmac_f32 v136, v168, v254
v_mfma_f32_16x16x32_bf16 v[176:179], v[88:91], v[112:115], v[176:179]
s_waitcnt lgkmcnt(0)
v_exp_f32 v202, v202
v_mfma_f32_16x16x32_bf16 v[176:179], v[72:75], v[108:111], v[176:179]
v_exp_f32 v203, v203
v_mfma_f32_16x16x32_bf16 v[176:179], v[56:59], v[104:107], v[176:179]
v_cvt_pk_bf16_f32 v123, v202, v203
v_fmac_f32 v137, v169, v254
v_mfma_f32_16x16x32_bf16 v[180:183], v[60:63], v[104:107], v[180:183]
v_fmac_f32 v138, v170, v254
v_fmac_f32 v139, v171, v254
v_mfma_f32_16x16x32_bf16 v[180:183], v[76:79], v[108:111], v[180:183]
v_cvt_pk_bf16_f32 v136, v136, v137
v_fmac_f32 v140, v172, v254
v_mfma_f32_16x16x32_bf16 v[180:183], v[92:95], v[112:115], v[180:183]
v_fmac_f32 v144, v176, v254
v_fmac_f32 v145, v177, v254
v_mfma_f32_16x16x32_bf16 v[192:195], v[28:31], v[100:103], 0
v_fmac_f32 v146, v178, v254
v_fmac_f32 v147, v179, v254
v_mfma_f32_16x16x32_bf16 v[192:195], v[24:27], v[96:99], v[192:195]
v_cvt_pk_bf16_f32 v144, v144, v145
v_fmac_f32 v141, v173, v254
v_mfma_f32_16x16x32_bf16 v[212:215], v[40:43], v[96:99], 0
v_fmac_f32 v142, v174, v254
v_fmac_f32 v143, v175, v254
v_mfma_f32_16x16x32_bf16 v[212:215], v[44:47], v[100:103], v[212:215]
v_cvt_pk_bf16_f32 v137, v138, v139
v_cvt_pk_bf16_f32 v145, v146, v147
v_mfma_f32_16x16x32_bf16 v[216:219], v[36:39], v[100:103], 0
v_fmac_f32 v148, v180, v254
v_fmac_f32 v149, v181, v254
v_mfma_f32_16x16x32_bf16 v[216:219], v[32:35], v[96:99], v[216:219]
v_fmac_f32 v150, v182, v254
v_fmac_f32 v151, v183, v254
v_mfma_f32_16x16x32_bf16 v[220:223], v[0:3], v[96:99], 0
v_cvt_pk_bf16_f32 v138, v140, v141
v_cvt_pk_bf16_f32 v139, v142, v143
v_mfma_f32_16x16x32_bf16 v[220:223], v[4:7], v[100:103], v[220:223]
v_cvt_pk_bf16_f32 v146, v148, v149
v_cvt_pk_bf16_f32 v147, v150, v151
v_mfma_f32_16x16x32_bf16 v[188:191], a[0:3], v[204:207], 0
v_pk_max_i16 v136, v136, 0
v_pk_max_i16 v137, v137, 0
v_mfma_f32_16x16x32_bf16 v[188:191], a[4:7], v[208:211], v[188:191]
v_pk_max_i16 v138, v138, 0
v_pk_max_i16 v139, v139, 0
v_mfma_f32_16x16x32_bf16 v[188:191], a[8:11], v[224:227], v[188:191]
v_pk_max_i16 v144, v144, 0
v_pk_max_i16 v145, v145, 0
v_mfma_f32_16x16x32_bf16 v[188:191], a[12:15], v[232:235], v[188:191]
v_pk_max_i16 v146, v146, 0
v_pk_max_i16 v147, v147, 0
v_mfma_f32_16x16x32_bf16 v[200:203], a[28:31], v[232:235], 0
v_mov_b64 v[140:141], v[136:137]
v_mov_b64 v[142:143], v[138:139]
v_mfma_f32_16x16x32_bf16 v[200:203], a[24:27], v[224:227], v[200:203]
v_mov_b32_dpp v136, v144 row_ror:8 row_mask:0xf bank_mask:0xc
v_mov_b32_dpp v137, v145 row_ror:8 row_mask:0xf bank_mask:0xc
v_mfma_f32_16x16x32_bf16 v[200:203], a[20:23], v[208:211], v[200:203]
v_cvt_pk_bf16_f32 v96, v188, v189
v_cvt_pk_bf16_f32 v97, v190, v191
v_mfma_f32_16x16x32_bf16 v[200:203], a[16:19], v[204:207], v[200:203]
v_mov_b32_dpp v138, v146 row_ror:8 row_mask:0xf bank_mask:0xc
v_mov_b32_dpp v139, v147 row_ror:8 row_mask:0xf bank_mask:0xc
v_mfma_f32_16x16x32_bf16 v[188:191], a[32:35], v[204:207], 0
v_mov_b32_dpp v144, v140 row_ror:8 row_mask:0xf bank_mask:0x3
v_mov_b32_dpp v145, v141 row_ror:8 row_mask:0xf bank_mask:0x3
v_mfma_f32_16x16x32_bf16 v[188:191], a[36:39], v[208:211], v[188:191]
v_mov_b32_dpp v146, v142 row_ror:8 row_mask:0xf bank_mask:0x3
v_mov_b32_dpp v147, v143 row_ror:8 row_mask:0xf bank_mask:0x3
v_mfma_f32_16x16x32_bf16 v[188:191], a[40:43], v[224:227], v[188:191]
v_cvt_pk_bf16_f32 v98, v200, v201
v_cvt_pk_bf16_f32 v99, v202, v203
v_mfma_f32_16x16x32_bf16 v[188:191], a[44:47], v[232:235], v[188:191]
v_exp_f32 v197, v197
v_mfma_f32_16x16x32_bf16 v[200:203], a[60:63], v[232:235], 0
v_exp_f32 v198, v198
v_mfma_f32_16x16x32_bf16 v[200:203], a[56:59], v[224:227], v[200:203]
v_exp_f32 v199, v199
v_mfma_f32_16x16x32_bf16 v[200:203], a[52:55], v[208:211], v[200:203]
v_cvt_pk_bf16_f32 v124, v196, v197
v_cvt_pk_bf16_f32 v125, v198, v199
v_mfma_f32_16x16x32_bf16 v[200:203], a[48:51], v[204:207], v[200:203]
v_cvt_pk_bf16_f32 v100, v188, v189
v_cvt_pk_bf16_f32 v101, v190, v191
v_mfma_f32_32x32x16_bf16 v[168:183], v[236:239], v[132:135], 0
buffer_store_dwordx4 v[136:139], v244, s[20:23], s52 offen offset:0 nt
buffer_store_dwordx4 v[144:147], v244, s[20:23], s52 offen offset:2048 nt
v_exp_f32 v220, v220
v_exp_f32 v221, v221
v_mfma_f32_16x16x32_bf16 v[136:139], a[192:195], v[204:207], 0
v_cvt_pk_bf16_f32 v102, v200, v201
v_cvt_pk_bf16_f32 v103, v202, v203
v_mfma_f32_16x16x32_bf16 v[136:139], a[196:199], v[208:211], v[136:139]
v_exp_f32 v222, v222
v_mfma_f32_16x16x32_bf16 v[136:139], a[200:203], v[224:227], v[136:139]
v_exp_f32 v223, v223
v_mfma_f32_16x16x32_bf16 v[136:139], a[204:207], v[232:235], v[136:139]
v_cvt_pk_bf16_f32 v120, v220, v221
v_cvt_pk_bf16_f32 v121, v222, v223
v_mfma_f32_16x16x32_bf16 v[140:143], a[220:223], v[232:235], 0
v_exp_f32 v192, v192
v_mfma_f32_16x16x32_bf16 v[140:143], a[216:219], v[224:227], v[140:143]
v_exp_f32 v193, v193
v_mfma_f32_16x16x32_bf16 v[140:143], a[212:215], v[208:211], v[140:143]
v_exp_f32 v194, v194
v_mfma_f32_16x16x32_bf16 v[140:143], a[208:211], v[204:207], v[140:143]
v_exp_f32 v195, v195
v_mfma_f32_16x16x32_bf16 v[144:147], a[224:227], v[204:207], 0
v_cvt_pk_bf16_f32 v126, v192, v193
v_cvt_pk_bf16_f32 v127, v194, v195
v_mfma_f32_16x16x32_bf16 v[144:147], a[228:231], v[208:211], v[144:147]
v_exp_f32 v212, v212
v_mfma_f32_16x16x32_bf16 v[144:147], a[232:235], v[224:227], v[144:147]
v_exp_f32 v213, v213
v_mfma_f32_16x16x32_bf16 v[144:147], a[236:239], v[232:235], v[144:147]
v_mov_b64 v[188:189], s[96:97]
v_mov_b64 v[190:191], s[96:97]
v_mfma_f32_16x16x32_bf16 v[148:151], a[252:255], v[232:235], 0
v_exp_f32 v214, v214
v_mfma_f32_16x16x32_bf16 v[148:151], a[248:251], v[224:227], v[148:151]
v_exp_f32 v215, v215
v_mfma_f32_16x16x32_bf16 v[148:151], a[244:247], v[208:211], v[148:151]
v_exp_f32 v216, v216
v_mfma_f32_16x16x32_bf16 v[148:151], a[240:243], v[204:207], v[148:151]
v_exp_f32 v217, v217
v_smfmac_f32_16x16x64_bf16 v[188:191], v[238:241], v[96:103], v251
v_mov_b64 v[192:193], 0
v_mfma_f32_16x16x32_bf16 v[196:199], v[8:11], v[96:99], 0
v_exp_f32 v218, v218
v_mfma_f32_16x16x32_bf16 v[196:199], v[12:15], v[100:103], v[196:199]
v_exp_f32 v219, v219
v_mfma_f32_16x16x32_bf16 v[200:203], v[4:7], v[100:103], 0
v_cvt_pk_bf16_f32 v130, v212, v213
v_cvt_pk_bf16_f32 v131, v214, v215
v_mfma_f32_16x16x32_bf16 v[200:203], v[0:3], v[96:99], v[200:203]
ds_read_b128 v[204:207], v242 offset:12672
v_cvt_pk_bf16_f32 v128, v216, v217
v_smfmac_f32_16x16x64_bf16 v[192:195], v[184:187], v[120:127], v251
ds_read_b128 v[208:211], v242 offset:12928
v_cvt_pk_bf16_f32 v129, v218, v219
v_add_f32 v188, v188, v189
v_add_f32 v190, v190, v191
v_smfmac_f32_16x16x64_bf16 v[192:195], v[184:187], v[128:135], v251 abid:1
ds_read_b128 v[212:215], v242 offset:13184
ds_read_b128 v[216:219], v242 offset:13440
v_mfma_f32_16x16x32_bf16 v[168:171], v[80:83], v[128:131], v[168:171]
v_exp_f32 v188, v188
v_mfma_f32_16x16x32_bf16 v[168:171], v[48:51], v[120:123], v[168:171]
v_exp_f32 v190, v190
v_mfma_f32_16x16x32_bf16 v[168:171], v[64:67], v[124:127], v[168:171]
v_perm_b32 v116, v190, v188, v252
v_perm_b32 v117, v190, v188, v253
v_mfma_f32_16x16x32_bf16 v[172:175], v[68:71], v[124:127], v[172:175]
v_add_f32 v192, v192, v193
v_add_u32 v242, s56, v242
v_mfma_f32_16x16x32_bf16 v[172:175], v[84:87], v[128:131], v[172:175]
s_sub_u32 s56, 0, s56
v_rcp_f32 v254, v192
v_mfma_f32_16x16x32_bf16 v[172:175], v[52:55], v[120:123], v[172:175]
v_max3_f32 v255, v255, v192, v254
v_fmac_f32 v152, v168, v254
v_mfma_f32_16x16x32_bf16 v[176:179], v[56:59], v[120:123], v[176:179]
v_mov_b32 v188, s45
v_fmac_f32 v153, v169, v254
v_mfma_f32_16x16x32_bf16 v[176:179], v[72:75], v[124:127], v[176:179]
s_waitcnt vmcnt(6)
ds_write_addtid_b32 v188 offset:65280
v_mfma_f32_16x16x32_bf16 v[176:179], v[88:91], v[128:131], v[176:179]
v_fmac_f32 v154, v170, v254
v_fmac_f32 v155, v171, v254
v_mfma_f32_16x16x32_bf16 v[188:191], v[20:23], v[100:103], 0
v_cvt_pk_bf16_f32 v152, v152, v153
v_fmac_f32 v156, v172, v254
v_mfma_f32_16x16x32_bf16 v[188:191], v[16:19], v[96:99], v[188:191]
s_waitcnt lgkmcnt(4)
v_fmac_f32 v157, v173, v254
v_fmac_f32 v160, v176, v254
v_mfma_f32_16x16x32_bf16 v[220:223], v[24:27], v[96:99], 0
s_waitcnt lgkmcnt(3)
v_fmac_f32 v161, v177, v254
v_fmac_f32 v162, v178, v254
v_mfma_f32_16x16x32_bf16 v[220:223], v[28:31], v[100:103], v[220:223]
s_waitcnt lgkmcnt(1)
v_fmac_f32 v163, v179, v254
v_cvt_pk_bf16_f32 v160, v160, v161
v_mfma_f32_16x16x32_bf16 v[224:227], v[36:39], v[100:103], 0
v_fmac_f32 v158, v174, v254
v_fmac_f32 v159, v175, v254
v_mfma_f32_16x16x32_bf16 v[224:227], v[32:35], v[96:99], v[224:227]
v_cvt_pk_bf16_f32 v153, v154, v155
v_cvt_pk_bf16_f32 v161, v162, v163
v_mfma_f32_16x16x32_bf16 v[228:231], v[40:43], v[96:99], 0
v_cvt_pk_bf16_f32 v154, v156, v157
v_cvt_pk_bf16_f32 v155, v158, v159
v_mfma_f32_16x16x32_bf16 v[228:231], v[44:47], v[100:103], v[228:231]
v_pk_max_i16 v152, v152, 0
v_pk_max_i16 v153, v153, 0
v_mfma_f32_16x16x32_bf16 v[180:183], v[60:63], v[120:123], v[180:183]
v_pk_max_i16 v154, v154, 0
v_pk_max_i16 v155, v155, 0
v_mfma_f32_16x16x32_bf16 v[180:183], v[76:79], v[124:127], v[180:183]
v_pk_max_i16 v160, v160, 0
v_pk_max_i16 v161, v161, 0
v_mfma_f32_16x16x32_bf16 v[180:183], v[92:95], v[128:131], v[180:183]
v_mov_b64 v[156:157], v[152:153]
v_mov_b64 v[158:159], v[154:155]
v_mfma_f32_16x16x32_bf16 v[192:195], a[0:3], v[204:207], 0
v_mov_b32_dpp v152, v160 row_ror:8 row_mask:0xf bank_mask:0xc
v_mov_b32_dpp v153, v161 row_ror:8 row_mask:0xf bank_mask:0xc
v_mfma_f32_16x16x32_bf16 v[192:195], a[4:7], v[208:211], v[192:195]
v_mov_b32_dpp v160, v156 row_ror:8 row_mask:0xf bank_mask:0x3
v_mov_b32_dpp v161, v157 row_ror:8 row_mask:0xf bank_mask:0x3
v_mfma_f32_16x16x32_bf16 v[192:195], a[8:11], v[212:215], v[192:195]
v_fmac_f32 v164, v180, v254
v_fmac_f32 v165, v181, v254
v_mfma_f32_16x16x32_bf16 v[192:195], a[12:15], v[216:219], v[192:195]
v_fmac_f32 v166, v182, v254
v_fmac_f32 v167, v183, v254
v_mfma_f32_16x16x32_bf16 v[232:235], a[28:31], v[216:219], 0
v_cvt_pk_bf16_f32 v162, v164, v165
v_cvt_pk_bf16_f32 v163, v166, v167
v_mfma_f32_16x16x32_bf16 v[232:235], a[24:27], v[212:215], v[232:235]
v_pk_max_i16 v162, v162, 0
v_pk_max_i16 v163, v163, 0
v_mfma_f32_16x16x32_bf16 v[232:235], a[20:23], v[208:211], v[232:235]
v_cvt_pk_bf16_f32 v96, v192, v193
v_cvt_pk_bf16_f32 v97, v194, v195
v_mfma_f32_16x16x32_bf16 v[232:235], a[16:19], v[204:207], v[232:235]
v_mov_b32_dpp v154, v162 row_ror:8 row_mask:0xf bank_mask:0xc
v_mov_b32_dpp v155, v163 row_ror:8 row_mask:0xf bank_mask:0xc
v_mfma_f32_16x16x32_bf16 v[192:195], a[32:35], v[204:207], 0
v_mov_b32_dpp v162, v158 row_ror:8 row_mask:0xf bank_mask:0x3
v_mov_b32_dpp v163, v159 row_ror:8 row_mask:0xf bank_mask:0x3
v_mfma_f32_16x16x32_bf16 v[192:195], a[36:39], v[208:211], v[192:195]
v_exp_f32 v200, v200
v_mfma_f32_16x16x32_bf16 v[192:195], a[40:43], v[212:215], v[192:195]
v_cvt_pk_bf16_f32 v98, v232, v233
v_cvt_pk_bf16_f32 v99, v234, v235
v_mfma_f32_16x16x32_bf16 v[192:195], a[44:47], v[216:219], v[192:195]
v_exp_f32 v201, v201
v_mfma_f32_16x16x32_bf16 v[232:235], a[60:63], v[216:219], 0
v_exp_f32 v202, v202
v_mfma_f32_16x16x32_bf16 v[232:235], a[56:59], v[212:215], v[232:235]
v_exp_f32 v203, v203
v_mfma_f32_16x16x32_bf16 v[232:235], a[52:55], v[208:211], v[232:235]
v_cvt_pk_bf16_f32 v104, v200, v201
v_cvt_pk_bf16_f32 v105, v202, v203
v_mfma_f32_16x16x32_bf16 v[232:235], a[48:51], v[204:207], v[232:235]
v_cvt_pk_bf16_f32 v100, v192, v193
v_cvt_pk_bf16_f32 v101, v194, v195
v_mfma_f32_32x32x16_bf16 v[168:183], v[236:239], v[116:119], 0
s_cmp_lg_u32 s45, 0
buffer_store_dwordx4 v[152:155], v244, s[20:23], s53 offen offset:0 nt
buffer_store_dwordx4 v[160:163], v244, s[20:23], s53 offen offset:2048 nt
s_cbranch_scc1 L_loopf
v_mfma_f32_16x16x32_bf16 v[152:155], a[192:195], v[204:207], 0
s_mov_b32 m0, s59
v_cvt_pk_bf16_f32 v102, v232, v233
v_cvt_pk_bf16_f32 v103, v234, v235
v_mfma_f32_16x16x32_bf16 v[152:155], a[196:199], v[208:211], v[152:155]
s_mul_i32 s54, s41, 13824
ds_read_addtid_b32 v200 offset:65280
v_mov_b64 v[192:193], s[96:97]
v_mfma_f32_16x16x32_bf16 v[152:155], a[200:203], v[212:215], v[152:155]
s_lshl_b32 s55, s41, 9
v_mov_b64 v[194:195], s[96:97]
v_mbcnt_lo_u32_b32 v245, -1, 0
v_mfma_f32_16x16x32_bf16 v[152:155], a[204:207], v[216:219], v[152:155]
L_h5:
s_cbranch_execz L_ret
s_add_u32 s7, s54, 102400
v_exp_f32 v188, v188
v_mfma_f32_16x16x32_bf16 v[156:159], a[220:223], v[216:219], 0
s_add_u32 s9, s55, 160960
v_exp_f32 v189, v189
v_mfma_f32_16x16x32_bf16 v[156:159], a[216:219], v[212:215], v[156:159]
s_mov_b32 s6, 1728
v_exp_f32 v190, v190
v_mfma_f32_16x16x32_bf16 v[156:159], a[212:215], v[208:211], v[156:159]
s_mov_b32 s15, 272
v_exp_f32 v191, v191
v_mfma_f32_16x16x32_bf16 v[156:159], a[208:211], v[204:207], v[156:159]
s_waitcnt lgkmcnt(0)
v_cvt_pk_bf16_f32 v108, v188, v189
v_cvt_pk_bf16_f32 v109, v190, v191
v_mfma_f32_16x16x32_bf16 v[160:163], a[224:227], v[204:207], 0
s_add_u32 s8, s54, 103536
v_exp_f32 v224, v224
v_mfma_f32_16x16x32_bf16 v[160:163], a[228:231], v[208:211], v[160:163]
s_mov_b32 s57, 13106176
v_exp_f32 v225, v225
v_mfma_f32_16x16x32_bf16 v[160:163], a[232:235], v[212:215], v[160:163]
s_add_u32 s52, s47, 8192
v_exp_f32 v226, v226
v_mfma_f32_16x16x32_bf16 v[160:163], a[236:239], v[216:219], v[160:163]
s_add_u32 s98, s44, 24576
v_exp_f32 v227, v227
v_mfma_f32_16x16x32_bf16 v[164:167], a[252:255], v[216:219], 0
s_add_u32 s100, s44, 52453376
v_cvt_pk_bf16_f32 v112, v224, v225
v_cvt_pk_bf16_f32 v113, v226, v227
v_mfma_f32_16x16x32_bf16 v[164:167], a[248:251], v[212:215], v[164:167]
s_add_u32 s53, s47, 12288
v_exp_f32 v196, v196
v_mfma_f32_16x16x32_bf16 v[164:167], a[244:247], v[208:211], v[164:167]
s_add_u32 s99, s44, 26238976
v_exp_f32 v197, v197
v_mfma_f32_16x16x32_bf16 v[164:167], a[240:243], v[204:207], v[164:167]
s_add_u32 s101, s44, 78667776
v_exp_f32 v198, v198
v_smfmac_f32_16x16x64_bf16 v[192:195], v[238:241], v[96:103], v251
v_cvt_pk_bf16_f32 v106, v196, v197
v_mfma_f32_16x16x32_bf16 v[188:191], v[0:3], v[96:99], 0
v_exp_f32 v199, v199
v_mfma_f32_16x16x32_bf16 v[188:191], v[4:7], v[100:103], v[188:191]
v_exp_f32 v220, v220
v_mfma_f32_16x16x32_bf16 v[204:207], v[12:15], v[100:103], 0
v_exp_f32 v221, v221
v_mfma_f32_16x16x32_bf16 v[204:207], v[8:11], v[96:99], v[204:207]
v_add_f32 v192, v192, v193
v_add_f32 v194, v194, v195
v_mfma_f32_16x16x32_bf16 v[208:211], v[16:19], v[96:99], 0
v_exp_f32 v192, v192
v_mfma_f32_16x16x32_bf16 v[208:211], v[20:23], v[100:103], v[208:211]
v_exp_f32 v194, v194
v_mfma_f32_16x16x32_bf16 v[212:215], v[28:31], v[100:103], 0
v_exp_f32 v222, v222
v_mfma_f32_16x16x32_bf16 v[212:215], v[24:27], v[96:99], v[212:215]
v_exp_f32 v223, v223
v_mfma_f32_16x16x32_bf16 v[216:219], v[32:35], v[96:99], 0
v_perm_b32 v132, v194, v192, v252
v_perm_b32 v133, v194, v192, v253
v_mfma_f32_16x16x32_bf16 v[216:219], v[36:39], v[100:103], v[216:219]
v_cvt_pk_bf16_f32 v107, v198, v199
v_cvt_pk_bf16_f32 v110, v220, v221
v_mfma_f32_16x16x32_bf16 v[224:227], v[44:47], v[100:103], 0
v_cvt_pk_bf16_f32 v111, v222, v223
v_mov_b64 v[192:193], 0
v_mfma_f32_16x16x32_bf16 v[224:227], v[40:43], v[96:99], v[224:227]
v_exp_f32 v228, v228
v_smfmac_f32_16x16x64_bf16 v[192:195], v[184:187], v[104:111], v251
v_exp_f32 v229, v229
v_exp_f32 v230, v230
v_exp_f32 v231, v231
v_cvt_pk_bf16_f32 v114, v228, v229
v_cvt_pk_bf16_f32 v115, v230, v231
v_cmp_lt_u32 vcc, s45, v200
v_mbcnt_hi_u32_b32 v245, -1, v245
v_smfmac_f32_16x16x64_bf16 v[192:195], v[184:187], v[112:119], v251 abid:1
v_and_b32 v198, 15, v245
v_mfma_f32_16x16x32_bf16 v[168:171], v[80:83], v[112:115], v[168:171]
v_exp_f32 v188, v188
v_mfma_f32_16x16x32_bf16 v[168:171], v[64:67], v[108:111], v[168:171]
s_cbranch_vccnz L_spine
L_backe:
v_exp_f32 v189, v189
v_mfma_f32_16x16x32_bf16 v[168:171], v[48:51], v[104:107], v[168:171]
s_mov_b32 vcc_lo, 0xf0000f
ds_read_b128 v[200:203], v242 offset:0
ds_read_b128 v[220:223], v242 offset:256
v_mfma_f32_16x16x32_bf16 v[172:175], v[52:55], v[104:107], v[172:175]
s_mov_b32 vcc_hi, 0xf0000f00
ds_read_b128 v[228:231], v242 offset:512
ds_read_b128 v[232:235], v242 offset:768
v_mfma_f32_16x16x32_bf16 v[172:175], v[68:71], v[108:111], v[172:175]
v_exp_f32 v190, v190
v_mfma_f32_16x16x32_bf16 v[172:175], v[84:87], v[112:115], v[172:175]
v_exp_f32 v191, v191
v_mfma_f32_16x16x32_bf16 v[176:179], v[88:91], v[112:115], v[176:179]
v_cvt_pk_bf16_f32 v120, v188, v189
v_cvt_pk_bf16_f32 v121, v190, v191
v_mfma_f32_16x16x32_bf16 v[176:179], v[72:75], v[108:111], v[176:179]
v_add_f32 v192, v192, v193
v_mov_b32 v243, s7
v_mfma_f32_16x16x32_bf16 v[176:179], v[56:59], v[104:107], v[176:179]
v_rcp_f32 v254, v192
v_mfma_f32_16x16x32_bf16 v[180:183], v[60:63], v[104:107], v[180:183]
v_max3_f32 v255, v255, v192, v254
v_bfe_u32 v246, v245, 2, 2
v_mfma_f32_16x16x32_bf16 v[180:183], v[76:79], v[108:111], v[180:183]
s_waitcnt lgkmcnt(3)
v_lshl_add_u32 v250, v198, 4, s9
v_and_b32 v196, 3, v245
v_mfma_f32_16x16x32_bf16 v[180:183], v[92:95], v[112:115], v[180:183]
s_waitcnt lgkmcnt(2)
ds_read_b64 v[96:97], v250 offset:0
v_mad_u32_u24 v243, v246, s6, v243
v_mfma_f32_16x16x32_bf16 v[0:3], a[192:195], v[200:203], 0
s_waitcnt lgkmcnt(2)
ds_read_b32 v102, v250 offset:8
v_lshrrev_b32 v197, 4, v245
v_mfma_f32_16x16x32_bf16 v[0:3], a[196:199], v[220:223], v[0:3]
s_waitcnt lgkmcnt(2)
ds_read_b64 v[100:101], v250 offset:256
v_mad_u32_u24 v243, v196, s15, v243
v_mfma_f32_16x16x32_bf16 v[0:3], a[200:203], v[228:231], v[0:3]
ds_read_b32 v103, v250 offset:264
v_lshl_add_u32 v247, v197, 4, v243
v_mfma_f32_16x16x32_bf16 v[0:3], a[204:207], v[232:235], v[0:3]
ds_read_b128 v[188:191], v242 offset:4736
ds_read_b128 v[192:195], v242 offset:4480
v_mfma_f32_16x16x32_bf16 v[4:7], a[220:223], v[232:235], 0
v_lshl_add_u32 v249, v198, 3, s8
v_mad_u32_u24 v249, v197, s6, v249
v_mfma_f32_16x16x32_bf16 v[4:7], a[216:219], v[228:231], v[4:7]
s_waitcnt lgkmcnt(5)
ds_read_b64 v[32:33], v249 offset:0
v_bfe_u32 v199, v245, 2, 1
v_mfma_f32_16x16x32_bf16 v[4:7], a[212:215], v[220:223], v[4:7]
s_waitcnt lgkmcnt(5)
ds_read_b64 v[34:35], v249 offset:6912
v_mad_u32_u24 v248, v199, s57, v244
v_mfma_f32_16x16x32_bf16 v[4:7], a[208:211], v[200:203], v[4:7]
s_waitcnt lgkmcnt(5)
ds_read_b128 v[196:199], v242 offset:4224
v_cndmask_b32 v96, 0, v96, vcc
v_mfma_f32_16x16x32_bf16 v[8:11], a[224:227], v[200:203], 0
s_waitcnt lgkmcnt(5)
ds_read_b64 v[36:37], v249 offset:128
v_cndmask_b32 v97, 0, v97, vcc
v_mfma_f32_16x16x32_bf16 v[8:11], a[228:231], v[220:223], v[8:11]
ds_read_b128 v[104:107], v247 offset:0
v_mov_b64 v[98:99], 0
v_mfma_f32_16x16x32_bf16 v[8:11], a[232:235], v[228:231], v[8:11]
ds_read_b128 v[108:111], v247 offset:64
ds_read_b64 v[38:39], v249 offset:7040
v_mfma_f32_16x16x32_bf16 v[8:11], a[236:239], v[232:235], v[8:11]
ds_read_b128 v[112:115], v247 offset:128
ds_read_b64 v[40:41], v249 offset:256
v_mfma_f32_16x16x32_bf16 v[12:15], a[252:255], v[232:235], 0
ds_read_b128 v[232:235], v242 offset:4992
ds_read_b64 v[42:43], v249 offset:7168
v_mfma_f32_16x16x32_bf16 v[12:15], a[244:247], v[220:223], v[12:15]
ds_read_b128 v[116:119], v247 offset:192
ds_read_b64 v[44:45], v249 offset:384
v_mfma_f32_16x16x32_bf16 v[12:15], a[240:243], v[200:203], v[12:15]
s_waitcnt lgkmcnt(14)
ds_read_b64 v[46:47], v249 offset:7296
v_fmac_f32 v136, v168, v254
v_mfma_f32_16x16x32_bf16 v[12:15], a[248:251], v[228:231], v[12:15]
ds_read_b128 v[220:223], v243 offset:256
v_fmac_f32 v137, v169, v254
v_mfma_f32_16x16x32_bf16 v[28:31], a[248:251], v[188:191], 0
s_waitcnt lgkmcnt(15)
v_fmac_f32 v144, v176, v254
v_fmac_f32 v145, v177, v254
v_fmac_f32 v138, v170, v254
v_fmac_f32 v139, v171, v254
v_cvt_pk_bf16_f32 v136, v136, v137
s_waitcnt lgkmcnt(5)
v_mfma_f32_16x16x32_bf16 v[28:31], a[252:255], v[232:235], v[28:31]
v_fmac_f32 v146, v178, v254
v_fmac_f32 v147, v179, v254
v_mfma_f32_16x16x32_bf16 v[28:31], a[244:247], v[192:195], v[28:31]
v_cvt_pk_bf16_f32 v144, v144, v145
v_fmac_f32 v140, v172, v254
v_mfma_f32_16x16x32_bf16 v[28:31], a[240:243], v[196:199], v[28:31]
v_fmac_f32 v141, v173, v254
v_fmac_f32 v142, v174, v254
v_mfma_f32_16x16x32_bf16 v[104:107], v[32:35], v[96:99], v[104:107]
s_waitcnt lgkmcnt(0)
v_fmac_f32 v143, v175, v254
v_cvt_pk_bf16_f32 v137, v138, v139
v_mfma_f32_16x16x32_bf16 v[108:111], v[36:39], v[96:99], v[108:111]
v_fmac_f32 v148, v180, v254
v_fmac_f32 v149, v181, v254
v_mfma_f32_16x16x32_bf16 v[112:115], v[40:43], v[96:99], v[112:115]
v_fmac_f32 v150, v182, v254
v_fmac_f32 v151, v183, v254
v_mfma_f32_16x16x32_bf16 v[116:119], v[44:47], v[96:99], v[116:119]
v_cvt_pk_bf16_f32 v145, v146, v147
v_cvt_pk_bf16_f32 v138, v140, v141
v_mfma_f32_16x16x32_bf16 v[24:27], a[224:227], v[196:199], 0
v_cvt_pk_bf16_f32 v139, v142, v143
v_cvt_pk_bf16_f32 v146, v148, v149
v_mfma_f32_16x16x32_bf16 v[24:27], a[228:231], v[192:195], v[24:27]
v_cvt_pk_bf16_f32 v147, v150, v151
v_pk_max_i16 v136, v136, 0
v_mfma_f32_16x16x32_bf16 v[24:27], a[232:235], v[188:191], v[24:27]
v_pk_max_i16 v137, v137, 0
v_pk_max_i16 v138, v138, 0
v_mfma_f32_16x16x32_bf16 v[24:27], a[236:239], v[232:235], v[24:27]
v_pk_max_i16 v139, v139, 0
v_pk_max_i16 v144, v144, 0
v_pk_max_i16 v145, v145, 0
v_pk_max_i16 v146, v146, 0
v_pk_max_i16 v147, v147, 0
v_mov_b64 v[140:141], v[136:137]
v_mov_b64 v[142:143], v[138:139]
v_mov_b32_dpp v136, v144 row_ror:8 row_mask:0xf bank_mask:0xc
v_mov_b32_dpp v137, v145 row_ror:8 row_mask:0xf bank_mask:0xc
v_mov_b32_dpp v138, v146 row_ror:8 row_mask:0xf bank_mask:0xc
v_mov_b32_dpp v139, v147 row_ror:8 row_mask:0xf bank_mask:0xc
v_mov_b32_dpp v144, v140 row_ror:8 row_mask:0xf bank_mask:0x3
v_mov_b32_dpp v145, v141 row_ror:8 row_mask:0xf bank_mask:0x3
v_mov_b32_dpp v146, v142 row_ror:8 row_mask:0xf bank_mask:0x3
v_mov_b32_dpp v147, v143 row_ror:8 row_mask:0xf bank_mask:0x3
v_mfma_f32_32x32x16_bf16 v[168:183], v[236:239], v[132:135], 0
buffer_store_dwordx4 v[136:139], v244, s[20:23], s52 offen offset:0 nt
buffer_store_dwordx4 v[144:147], v244, s[20:23], s52 offen offset:2048 nt
v_exp_f32 v204, v204
v_exp_f32 v205, v205
v_mfma_f32_16x16x32_bf16 v[20:23], a[220:223], v[232:235], 0
v_exp_f32 v206, v206
v_mfma_f32_16x16x32_bf16 v[20:23], a[216:219], v[188:191], v[20:23]
v_exp_f32 v207, v207
v_mfma_f32_16x16x32_bf16 v[20:23], a[212:215], v[192:195], v[20:23]
v_exp_f32 v208, v208
v_mfma_f32_16x16x32_bf16 v[20:23], a[208:211], v[196:199], v[20:23]
v_exp_f32 v209, v209
v_mfma_f32_16x16x32_bf16 v[16:19], a[192:195], v[196:199], 0
v_exp_f32 v210, v210
v_mfma_f32_16x16x32_bf16 v[16:19], a[196:199], v[192:195], v[16:19]
ds_read_b128 v[192:195], v247 offset:6912
v_cvt_pk_bf16_f32 v122, v204, v205
v_mfma_f32_16x16x32_bf16 v[16:19], a[200:203], v[188:191], v[16:19]
ds_read_b128 v[200:203], v247 offset:6976
v_cvt_pk_bf16_f32 v123, v206, v207
v_mfma_f32_16x16x32_bf16 v[16:19], a[204:207], v[232:235], v[16:19]
ds_read_b128 v[188:191], v247 offset:7040
v_exp_f32 v211, v211
v_cvt_pk_bf16_f32 v124, v208, v209
v_cvt_pk_bf16_f32 v125, v210, v211
v_exp_f32 v212, v212
v_exp_f32 v213, v213
v_exp_f32 v214, v214
v_exp_f32 v215, v215
v_cvt_pk_bf16_f32 v126, v212, v213
v_cvt_pk_bf16_f32 v127, v214, v215
v_mov_b64 v[196:197], 0
v_exp_f32 v216, v216
v_cndmask_b32 v100, 0, v100, vcc
v_smfmac_f32_16x16x64_bf16 v[196:199], v[184:187], v[120:127], v251
ds_read_b128 v[204:207], v247 offset:7104
v_exp_f32 v217, v217
v_exp_f32 v218, v218
v_exp_f32 v219, v219
v_exp_f32 v224, v224
v_exp_f32 v225, v225
v_exp_f32 v226, v226
v_exp_f32 v227, v227
v_cvt_pk_bf16_f32 v128, v216, v217
v_cvt_pk_bf16_f32 v129, v218, v219
v_cvt_pk_bf16_f32 v130, v224, v225
v_cvt_pk_bf16_f32 v131, v226, v227
v_cndmask_b32 v101, 0, v101, vcc
v_add_f32 v220, v220, v221
v_smfmac_f32_16x16x64_bf16 v[196:199], v[184:187], v[128:135], v251 abid:1
s_waitcnt lgkmcnt(3)
ds_read_b128 v[208:211], v243 offset:7168
v_add_f32 v222, v222, v223
v_mfma_f32_16x16x32_bf16 v[168:171], v[80:83], v[128:131], v[168:171]
s_waitcnt lgkmcnt(3)
v_add_f32 v220, v220, v102
v_add_f32 v220, v220, v222
v_mfma_f32_16x16x32_bf16 v[168:171], v[64:67], v[124:127], v[168:171]
s_waitcnt lgkmcnt(2)
v_rcp_f32 v252, v220
v_mfma_f32_16x16x32_bf16 v[168:171], v[48:51], v[120:123], v[168:171]
v_fmac_f32 v0, v104, v252
v_fmac_f32 v1, v105, v252
v_mfma_f32_16x16x32_bf16 v[172:175], v[52:55], v[120:123], v[172:175]
v_fmac_f32 v8, v112, v252
v_fmac_f32 v9, v113, v252
v_mfma_f32_16x16x32_bf16 v[172:175], v[68:71], v[124:127], v[172:175]
v_fmac_f32 v2, v106, v252
v_fmac_f32 v3, v107, v252
v_mfma_f32_16x16x32_bf16 v[172:175], v[84:87], v[128:131], v[172:175]
s_waitcnt lgkmcnt(0)
v_cvt_pk_bf16_f32 v0, v0, v1
v_fmac_f32 v10, v114, v252
v_mfma_f32_16x16x32_bf16 v[192:195], v[32:35], v[98:101], v[192:195]
v_fmac_f32 v11, v115, v252
v_cvt_pk_bf16_f32 v8, v8, v9
v_mfma_f32_16x16x32_bf16 v[200:203], v[36:39], v[98:101], v[200:203]
v_fmac_f32 v4, v108, v252
v_fmac_f32 v5, v109, v252
v_mfma_f32_16x16x32_bf16 v[188:191], v[40:43], v[98:101], v[188:191]
v_fmac_f32 v6, v110, v252
v_fmac_f32 v7, v111, v252
v_mfma_f32_16x16x32_bf16 v[204:207], v[44:47], v[98:101], v[204:207]
v_cvt_pk_bf16_f32 v1, v2, v3
v_fmac_f32 v12, v116, v252
v_mfma_f32_16x16x32_bf16 v[176:179], v[72:75], v[124:127], v[176:179]
v_fmac_f32 v13, v117, v252
v_fmac_f32 v14, v118, v252
v_mfma_f32_16x16x32_bf16 v[176:179], v[88:91], v[128:131], v[176:179]
v_fmac_f32 v15, v119, v252
v_cvt_pk_bf16_f32 v9, v10, v11
v_mfma_f32_16x16x32_bf16 v[176:179], v[56:59], v[120:123], v[176:179]
v_cvt_pk_bf16_f32 v2, v4, v5
v_cvt_pk_bf16_f32 v3, v6, v7
v_mfma_f32_16x16x32_bf16 v[180:183], v[60:63], v[120:123], v[180:183]
v_cvt_pk_bf16_f32 v10, v12, v13
v_cvt_pk_bf16_f32 v11, v14, v15
v_mfma_f32_16x16x32_bf16 v[180:183], v[76:79], v[124:127], v[180:183]
v_pk_max_i16 v0, v0, 0
v_pk_max_i16 v1, v1, 0
v_mfma_f32_16x16x32_bf16 v[180:183], v[92:95], v[128:131], v[180:183]
v_pk_max_i16 v2, v2, 0
v_pk_max_i16 v3, v3, 0
v_pk_max_i16 v8, v8, 0
v_pk_max_i16 v9, v9, 0
v_pk_max_i16 v10, v10, 0
v_pk_max_i16 v11, v11, 0
v_mov_b64 v[4:5], v[0:1]
v_mov_b64 v[6:7], v[2:3]
v_mov_b32_dpp v0, v8 row_ror:8 row_mask:0xf bank_mask:0xc
v_mov_b32_dpp v1, v9 row_ror:8 row_mask:0xf bank_mask:0xc
v_mov_b32_dpp v2, v10 row_ror:8 row_mask:0xf bank_mask:0xc
v_mov_b32_dpp v3, v11 row_ror:8 row_mask:0xf bank_mask:0xc
v_mov_b32_dpp v8, v4 row_ror:8 row_mask:0xf bank_mask:0x3
v_mov_b32_dpp v9, v5 row_ror:8 row_mask:0xf bank_mask:0x3
v_mov_b32_dpp v10, v6 row_ror:8 row_mask:0xf bank_mask:0x3
v_mov_b32_dpp v11, v7 row_ror:8 row_mask:0xf bank_mask:0x3
buffer_store_dwordx4 v[0:3], v248, s[20:23], s98 offen offset:0 nt
buffer_store_dwordx4 v[8:11], v248, s[20:23], s99 offen offset:0 nt
v_add_f32 v208, v208, v209
v_add_f32 v210, v210, v211
v_add_f32 v208, v208, v103
v_add_f32 v208, v208, v210
v_rcp_f32 v240, v208
v_add_f32 v196, v196, v197
v_pk_fma_f32 v[16:17], v[192:193], v[240:241], v[16:17] op_sel_hi:[1,0,1]
v_pk_fma_f32 v[24:25], v[188:189], v[240:241], v[24:25] op_sel_hi:[1,0,1]
v_pk_fma_f32 v[18:19], v[194:195], v[240:241], v[18:19] op_sel_hi:[1,0,1]
v_cvt_pk_bf16_f32 v16, v16, v17
v_pk_fma_f32 v[26:27], v[190:191], v[240:241], v[26:27] op_sel_hi:[1,0,1]
v_cvt_pk_bf16_f32 v24, v24, v25
v_pk_fma_f32 v[20:21], v[200:201], v[240:241], v[20:21] op_sel_hi:[1,0,1]
v_pk_fma_f32 v[22:23], v[202:203], v[240:241], v[22:23] op_sel_hi:[1,0,1]
v_cvt_pk_bf16_f32 v17, v18, v19
v_pk_fma_f32 v[28:29], v[204:205], v[240:241], v[28:29] op_sel_hi:[1,0,1]
v_pk_fma_f32 v[30:31], v[206:207], v[240:241], v[30:31] op_sel_hi:[1,0,1]
v_cvt_pk_bf16_f32 v25, v26, v27
v_cvt_pk_bf16_f32 v18, v20, v21
v_cvt_pk_bf16_f32 v19, v22, v23
v_cvt_pk_bf16_f32 v26, v28, v29
v_cvt_pk_bf16_f32 v27, v30, v31
v_pk_max_i16 v16, v16, 0
v_pk_max_i16 v17, v17, 0
v_pk_max_i16 v18, v18, 0
v_pk_max_i16 v19, v19, 0
v_pk_max_i16 v24, v24, 0
v_pk_max_i16 v25, v25, 0
v_pk_max_i16 v26, v26, 0
v_pk_max_i16 v27, v27, 0
v_mov_b64 v[20:21], v[16:17]
v_mov_b64 v[22:23], v[18:19]
v_mov_b32_dpp v16, v24 row_ror:8 row_mask:0xf bank_mask:0xc
v_mov_b32_dpp v17, v25 row_ror:8 row_mask:0xf bank_mask:0xc
v_mov_b32_dpp v18, v26 row_ror:8 row_mask:0xf bank_mask:0xc
v_mov_b32_dpp v19, v27 row_ror:8 row_mask:0xf bank_mask:0xc
v_mov_b32_dpp v24, v20 row_ror:8 row_mask:0xf bank_mask:0x3
v_mov_b32_dpp v25, v21 row_ror:8 row_mask:0xf bank_mask:0x3
v_mov_b32_dpp v26, v22 row_ror:8 row_mask:0xf bank_mask:0x3
v_mov_b32_dpp v27, v23 row_ror:8 row_mask:0xf bank_mask:0x3
buffer_store_dwordx4 v[16:19], v248, s[20:23], s100 offen offset:0 nt
buffer_store_dwordx4 v[24:27], v248, s[20:23], s101 offen offset:0 nt
v_rcp_f32 v254, v196
v_max3_f32 v255, v255, v220, v252
v_pk_fma_f32 v[152:153], v[168:169], v[254:255], v[152:153] op_sel_hi:[1,0,1]
v_pk_fma_f32 v[160:161], v[176:177], v[254:255], v[160:161] op_sel_hi:[1,0,1]
v_pk_fma_f32 v[154:155], v[170:171], v[254:255], v[154:155] op_sel_hi:[1,0,1]
v_cvt_pk_bf16_f32 v152, v152, v153
v_pk_fma_f32 v[162:163], v[178:179], v[254:255], v[162:163] op_sel_hi:[1,0,1]
v_cvt_pk_bf16_f32 v160, v160, v161
v_pk_fma_f32 v[156:157], v[172:173], v[254:255], v[156:157] op_sel_hi:[1,0,1]
v_pk_fma_f32 v[158:159], v[174:175], v[254:255], v[158:159] op_sel_hi:[1,0,1]
v_cvt_pk_bf16_f32 v153, v154, v155
v_pk_fma_f32 v[164:165], v[180:181], v[254:255], v[164:165] op_sel_hi:[1,0,1]
v_pk_fma_f32 v[166:167], v[182:183], v[254:255], v[166:167] op_sel_hi:[1,0,1]
v_cvt_pk_bf16_f32 v161, v162, v163
v_cvt_pk_bf16_f32 v154, v156, v157
v_cvt_pk_bf16_f32 v155, v158, v159
v_cvt_pk_bf16_f32 v162, v164, v165
v_cvt_pk_bf16_f32 v163, v166, v167
v_pk_max_i16 v152, v152, 0
v_pk_max_i16 v153, v153, 0
v_pk_max_i16 v154, v154, 0
v_pk_max_i16 v155, v155, 0
v_pk_max_i16 v160, v160, 0
v_pk_max_i16 v161, v161, 0
v_pk_max_i16 v162, v162, 0
v_pk_max_i16 v163, v163, 0
v_mov_b64 v[156:157], v[152:153]
v_mov_b64 v[158:159], v[154:155]
v_mov_b32_dpp v152, v160 row_ror:8 row_mask:0xf bank_mask:0xc
v_mov_b32_dpp v153, v161 row_ror:8 row_mask:0xf bank_mask:0xc
v_mov_b32_dpp v154, v162 row_ror:8 row_mask:0xf bank_mask:0xc
v_mov_b32_dpp v155, v163 row_ror:8 row_mask:0xf bank_mask:0xc
v_mov_b32_dpp v160, v156 row_ror:8 row_mask:0xf bank_mask:0x3
v_mov_b32_dpp v161, v157 row_ror:8 row_mask:0xf bank_mask:0x3
v_mov_b32_dpp v162, v158 row_ror:8 row_mask:0xf bank_mask:0x3
v_mov_b32_dpp v163, v159 row_ror:8 row_mask:0xf bank_mask:0x3
buffer_store_dwordx4 v[152:155], v244, s[20:23], s53 offen offset:0 nt
buffer_store_dwordx4 v[160:163], v244, s[20:23], s53 offen offset:2048 nt
v_max3_f32 v255, v255, v196, v254
v_max3_f32 v255, v255, v208, v240
v_mov_b32 v1, 0x53800000
v_cmp_nle_f32 vcc, v255, v1
s_lshl_b32 s52, s41, 2
s_add_u32 s52, s52, 163008
s_or_b32 s3, vcc_lo, vcc_hi
v_mov_b32 v2, s52
v_mov_b32 v3, s3
ds_write_b32 v2, v3
v_mov_b32 v2, 163008
s_waitcnt lgkmcnt(0)
s_barrier
ds_read_b128 v[4:7], v2
s_waitcnt lgkmcnt(0)
v_or_b32 v4, v4, v5
v_or3_b32 v4, v4, v6, v7
s_nop 0
v_readfirstlane_b32 s3, v4
s_nop 3
s_cmp_eq_u32 s3, 0
s_cbranch_scc0 L_fast_end
s_endpgm
L_fast_end:
s_waitcnt vmcnt(0)
s_barrier
s_mov_b32 s45, 8
s_mov_b32 s3, 64
s_mov_b32 s46, s44
s_mov_b32 s47, 0x7ff00000
s_mov_b32 s56, 50688
v_mbcnt_lo_u32_b32 v48, -1, 0
v_mbcnt_hi_u32_b32 v48, -1, v48
v_lshlrev_b32 v53, 4, v48
s_lshl_b32 s54, s41, 13
s_add_u32 s57, s54, 4096
v_and_b32 v49, 16, v48
v_lshlrev_b32 v52, 2, v49
v_lshlrev_b32 v49, 1, v49
v_xor_b32 v50, v53, v49
s_mul_i32 s49, s42, 25344
s_mul_i32 s53, s43, 1056
s_add_u32 s49, s49, s53
s_add_u32 m0, s49, 0
s_lshl_b32 s55, s43, 10
s_add_u32 s55, s55, s44
s_add_u32 s48, s55, 0
v_mov_b32 v237, 0
v_bfe_u32 v49, v48, 0, 2
v_lshl_add_u32 v237, v49, 4, v237
v_bfe_u32 v49, v48, 4, 2
v_lshl_add_u32 v237, v49, 6, v237
v_bfe_u32 v49, v48, 2, 2
v_lshl_add_u32 v237, v49, 8, v237
v_xor_b32 v51, 64, v50
s_lshl_b32 s53, s43, 14
v_mov_b32 v248, s53
v_add_u32 v248, 50688, v248
v_bfe_u32 v49, v48, 4, 2
v_lshl_add_u32 v248, v49, 10, v248
v_bfe_u32 v49, v48, 2, 2
v_lshl_add_u32 v248, v49, 7, v248
v_bfe_u32 v49, v48, 3, 1
v_lshl_add_u32 v248, v49, 5, v248
v_bfe_u32 v49, v48, 4, 1
v_lshl_add_u32 v248, v49, 6, v248
v_bfe_u32 v49, v48, 0, 2
v_lshl_add_u32 v248, v49, 3, v248
v_mov_b32 v252, s53
v_add_u32 v252, 116224, v252
v_bfe_u32 v49, v48, 4, 2
v_lshl_add_u32 v252, v49, 10, v252
v_bfe_u32 v49, v48, 2, 2
v_lshl_add_u32 v252, v49, 7, v252
v_bfe_u32 v49, v48, 3, 1
v_lshl_add_u32 v252, v49, 6, v252
v_bfe_u32 v49, v48, 0, 2
v_lshl_add_u32 v252, v49, 4, v252
s_mul_i32 s53, s42, 25344
v_bfe_u32 v49, v48, 2, 2
v_mov_b32 v236, s53
v_mul_u32_u24 v49, 1056, v49
v_add_u32 v236, v49, v236
v_bfe_u32 v49, v48, 0, 2
s_add_u32 s53, s54, 83456
v_lshl_add_u32 v236, v49, 6, v236
v_add_u32 v104, s53, v50
v_add_u32 v105, s53, v51
v_bfe_u32 v49, v48, 4, 2
s_lshl_b32 s53, s41, 12
v_lshl_add_u32 v236, v49, 4, v236
v_mov_b32 v54, s53
v_add_u32 v54, 50688, v54
v_bfe_u32 v49, v48, 3, 1
v_lshl_add_u32 v54, v49, 14, v54
v_bfe_u32 v49, v48, 4, 2
v_lshl_add_u32 v54, v49, 7, v54
v_bfe_u32 v49, v48, 2, 1
v_lshl_add_u32 v54, v49, 6, v54
v_bfe_u32 v49, v48, 5, 1
v_lshl_add_u32 v54, v49, 5, v54
v_bfe_u32 v49, v48, 0, 2
v_lshl_add_u32 v54, v49, 3, v54
s_lshl_b32 s53, s43, 7
v_mov_b32 v239, s53
v_bfe_u32 v49, v48, 0, 4
v_lshl_add_u32 v239, v49, 8, v239
s_mul_i32 s52, s41, 12288
s_add_u32 s52, s52, 101376
v_bfe_u32 v49, v48, 4, 2
v_lshl_add_u32 v239, v49, 4, v239
v_mov_b32 v241, s52
v_add_u32 v241, 8192, v241
v_bfe_u32 v49, v48, 4, 2
v_lshl_add_u32 v241, v49, 1, v241
v_bfe_u32 v49, v48, 0, 4
v_lshl_add_u32 v241, v49, 3, v241
buffer_load_dwordx4 v[152:155], v53, s[24:27], s54 offen offset:0
v_mov_b32 v240, s52
v_bfe_u32 v49, v48, 2, 2
v_lshl_add_u32 v240, v49, 7, v240
buffer_load_dwordx4 v[156:159], v53, s[24:27], s54 offen offset:1024
v_lshlrev_b32 v49, 2, v48
v_xor_b32 v49, v49, v48
v_and_b32 v49, 48, v49
buffer_load_dwordx4 v[160:163], v53, s[24:27], s54 offen offset:2048
s_lshl_b32 s53, s41, 10
v_add_u32 v240, v49, v240
v_mov_b32 v254, s53
v_add_u32 v254, 150528, v254
buffer_load_dwordx4 v[164:167], v53, s[24:27], s54 offen offset:3072
v_bfe_u32 v49, v48, 0, 6
v_mov_b32 v40, 0
v_mov_b32 v41, 0
buffer_load_dwordx4 v[168:171], v53, s[24:27], s57 offen offset:0
v_mov_b32 v42, 0
v_mov_b32 v43, 0
v_lshl_add_u32 v254, v49, 4, v254
buffer_load_dwordx4 v[172:175], v53, s[24:27], s57 offen offset:1024
ds_write_b128 v254, v[40:43] offset:0
buffer_load_dwordx4 v[176:179], v53, s[24:27], s57 offen offset:2048
ds_write_b128 v254, v[40:43] offset:256
buffer_load_dwordx4 v[180:183], v53, s[24:27], s57 offen offset:3072
buffer_load_dwordx4 v237, s[16:19], s48 offen nt lds
s_add_u32 m0, s49, 2112
s_add_u32 s48, s55, 2048
v_mov_b32 v245, s52
v_add_u32 v245, 4096, v245
buffer_load_dwordx4 v237, s[16:19], s48 offen nt lds
s_add_u32 m0, s49, 4224
s_add_u32 s48, s55, 4096
v_bfe_u32 v49, v48, 0, 2
buffer_load_dwordx4 v237, s[16:19], s48 offen nt lds
s_add_u32 m0, s49, 6336
s_add_u32 s48, s55, 6144
s_mov_b32 vcc_lo, 0x11111111
s_mov_b32 vcc_hi, 0x11111111
buffer_load_dwordx4 v237, s[16:19], s48 offen nt lds
s_add_u32 m0, s54, 50688
v_lshl_add_u32 v245, v49, 7, v245
v_mov_b32 v254, 150528
v_lshlrev_b32 v49, 4, v48
buffer_load_dwordx4 v50, s[28:31], s54 offen offset:0 lds
v_cndmask_b32 v240, v254, v240, vcc
v_xor_b32 v49, v49, v48
v_and_b32 v49, 48, v49
buffer_load_dwordx4 v51, s[28:31], s54 offen offset:1024 lds
s_mov_b32 vcc_lo, 0xf000f
s_mov_b32 vcc_hi, 0xf000f
v_add_u32 v245, v49, v245
buffer_load_dwordx4 v50, s[28:31], s54 offen offset:2048 lds
v_cndmask_b32 v242, v254, v245, vcc
s_mov_b32 vcc_lo, 0xf000f0
s_mov_b32 vcc_hi, 0xf000f0
buffer_load_dwordx4 v51, s[28:31], s54 offen offset:3072 lds
s_add_u32 m0, s57, 50688
v_cndmask_b32 v243, v254, v245, vcc
s_mov_b32 vcc_lo, 0xf000f00
s_mov_b32 vcc_hi, 0xf000f00
buffer_load_dwordx4 v50, s[28:31], s57 offen offset:0 lds
v_cndmask_b32 v244, v254, v245, vcc
s_mov_b32 vcc_lo, 0xf000f000
s_mov_b32 vcc_hi, 0xf000f000
v_mov_b32 v246, s52
buffer_load_dwordx4 v51, s[28:31], s57 offen offset:1024 lds
v_add_u32 v246, 4096, v246
v_bfe_u32 v49, v48, 0, 2
v_cndmask_b32 v245, v254, v245, vcc
buffer_load_dwordx4 v50, s[28:31], s57 offen offset:2048 lds
v_lshl_add_u32 v246, v49, 7, v246
v_mov_b32 v254, 154880
v_bfe_u32 v49, v48, 2, 2
buffer_load_dwordx4 v51, s[28:31], s57 offen offset:3072 lds
s_add_u32 m0, s49, 16896
s_mov_b32 vcc_lo, 0xf000f
s_mov_b32 vcc_hi, 0xf000f
v_lshl_add_u32 v254, v49, 3, v254
v_cndmask_b32 v246, v254, v246, vcc
v_xor_b32 v249, 32, v248
v_xor_b32 v250, 64, v248
v_xor_b32 v251, 96, v248
s_mul_i32 s4, s43, 13107200
s_add_u32 s4, s4, s44
s_add_u32 s4, s4, 24576
s_add_u32 s5, s55, 104857600
s_sub_u32 s5, s5, s4
s_add_u32 s48, s4, 0
v_xor_b32 v52, v53, v52
v_xor_b32 v55, 96, v54
v_xor_b32 v253, 64, v252
v_lshlrev_b32 v49, 4, v48
v_xor_b32 v49, v49, v48
v_and_b32 v49, 48, v49
v_add_u32 v246, v49, v246
v_add_u32 v246, v49, v246
v_mov_b32 v50, s52
v_bfe_u32 v49, v48, 0, 4
v_lshl_add_u32 v50, v49, 7, v50
v_lshlrev_b32 v49, 4, v48
v_xor_b32 v49, v49, v48
v_and_b32 v49, 48, v49
v_add_u32 v50, v49, v50
v_mov_b32 v51, s52
v_add_u32 v51, 8192, v51
v_bfe_u32 v49, v48, 4, 2
v_lshl_add_u32 v51, v49, 9, v51
v_bfe_u32 v49, v48, 0, 4
v_lshl_add_u32 v51, v49, 3, v51
s_add_u32 s50, s55, 13107200
s_mov_b32 s51, 2048
v_xor_b32 v247, 32, v48
s_mov_b32 s52, 0x7ff00000
v_lshlrev_b32 v247, 2, v247
s_waitcnt vmcnt(19)
v_and_b32 v254, 0xffff0000, v152
buffer_load_dwordx4 v237, s[16:19], s48 offen nt lds
s_add_u32 m0, s49, 19008
s_add_u32 s48, s4, 26214400
v_and_b32 v255, 0xffff0000, v153
v_lshlrev_b32 v152, 16, v152
v_lshlrev_b32 v153, 16, v153
v_mul_f32 v254, s40, v254
v_mul_f32 v152, s40, v152
v_mul_f32 v255, s40, v255
v_mul_f32 v153, s40, v153
v_cvt_pk_bf16_f32 v152, v152, v254
v_cvt_pk_bf16_f32 v153, v153, v255
v_and_b32 v254, 0xffff0000, v154
v_and_b32 v255, 0xffff0000, v155
v_lshlrev_b32 v154, 16, v154
v_lshlrev_b32 v155, 16, v155
v_mul_f32 v254, s40, v254
v_mul_f32 v154, s40, v154
v_mul_f32 v255, s40, v255
v_mul_f32 v155, s40, v155
v_cvt_pk_bf16_f32 v154, v154, v254
v_cvt_pk_bf16_f32 v155, v155, v255
s_waitcnt vmcnt(19)
v_and_b32 v254, 0xffff0000, v156
v_and_b32 v255, 0xffff0000, v157
v_lshlrev_b32 v156, 16, v156
v_lshlrev_b32 v157, 16, v157
v_mul_f32 v254, s40, v254
v_mul_f32 v156, s40, v156
v_mul_f32 v255, s40, v255
v_mul_f32 v157, s40, v157
v_cvt_pk_bf16_f32 v156, v156, v254
buffer_load_dwordx4 v237, s[16:19], s48 offen nt lds
s_add_u32 m0, s49, 21120
s_add_u32 s48, s4, 52428800
v_cvt_pk_bf16_f32 v157, v157, v255
v_and_b32 v254, 0xffff0000, v158
v_and_b32 v255, 0xffff0000, v159
v_lshlrev_b32 v158, 16, v158
v_lshlrev_b32 v159, 16, v159
v_mul_f32 v254, s40, v254
v_mul_f32 v158, s40, v158
v_mul_f32 v255, s40, v255
v_mul_f32 v159, s40, v159
v_cvt_pk_bf16_f32 v158, v158, v254
v_cvt_pk_bf16_f32 v159, v159, v255
s_waitcnt vmcnt(19)
v_and_b32 v254, 0xffff0000, v160
v_and_b32 v255, 0xffff0000, v161
v_lshlrev_b32 v160, 16, v160
v_lshlrev_b32 v161, 16, v161
v_mul_f32 v254, s40, v254
v_mul_f32 v160, s40, v160
v_mul_f32 v255, s40, v255
v_mul_f32 v161, s40, v161
v_cvt_pk_bf16_f32 v160, v160, v254
v_cvt_pk_bf16_f32 v161, v161, v255
v_and_b32 v254, 0xffff0000, v162
v_and_b32 v255, 0xffff0000, v163
v_lshlrev_b32 v162, 16, v162
v_lshlrev_b32 v163, 16, v163
v_mul_f32 v254, s40, v254
v_mul_f32 v162, s40, v162
v_mul_f32 v255, s40, v255
v_mul_f32 v163, s40, v163
v_cvt_pk_bf16_f32 v162, v162, v254
buffer_load_dwordx4 v237, s[16:19], s48 offen nt lds
s_add_u32 m0, s49, 23232
s_add_u32 s48, s4, 78643200
ds_write_b128 v104, v[152:155] offset:0
ds_write_b128 v105, v[156:159] offset:1024
v_cvt_pk_bf16_f32 v163, v163, v255
s_waitcnt vmcnt(19)
v_and_b32 v254, 0xffff0000, v164
v_and_b32 v255, 0xffff0000, v165
v_lshlrev_b32 v164, 16, v164
v_lshlrev_b32 v165, 16, v165
v_mul_f32 v254, s40, v254
v_mul_f32 v164, s40, v164
v_mul_f32 v255, s40, v255
v_mul_f32 v165, s40, v165
v_cvt_pk_bf16_f32 v164, v164, v254
v_cvt_pk_bf16_f32 v165, v165, v255
v_and_b32 v254, 0xffff0000, v166
v_and_b32 v255, 0xffff0000, v167
v_lshlrev_b32 v166, 16, v166
v_lshlrev_b32 v167, 16, v167
v_mul_f32 v254, s40, v254
buffer_load_dwordx4 v237, s[16:19], s48 offen nt lds
s_add_u32 m0, s54, 116224
s_add_u32 s48, s55, 8192
ds_write_b128 v104, v[160:163] offset:2048
v_mul_f32 v166, s40, v166
v_mul_f32 v255, s40, v255
v_mul_f32 v167, s40, v167
v_cvt_pk_bf16_f32 v166, v166, v254
v_cvt_pk_bf16_f32 v167, v167, v255
s_waitcnt vmcnt(19)
v_and_b32 v254, 0xffff0000, v168
v_and_b32 v255, 0xffff0000, v169
v_lshlrev_b32 v168, 16, v168
v_lshlrev_b32 v169, 16, v169
v_mul_f32 v254, s40, v254
v_mul_f32 v168, s40, v168
v_mul_f32 v255, s40, v255
v_mul_f32 v169, s40, v169
v_cvt_pk_bf16_f32 v168, v168, v254
v_cvt_pk_bf16_f32 v169, v169, v255
v_and_b32 v254, 0xffff0000, v170
v_and_b32 v255, 0xffff0000, v171
v_lshlrev_b32 v170, 16, v170
v_lshlrev_b32 v171, 16, v171
v_mul_f32 v254, s40, v254
v_mul_f32 v170, s40, v170
v_mul_f32 v255, s40, v255
v_mul_f32 v171, s40, v171
buffer_load_dwordx4 v52, s[32:35], s54 offen offset:0 lds
ds_write_b128 v105, v[164:167] offset:3072
v_cvt_pk_bf16_f32 v170, v170, v254
v_cvt_pk_bf16_f32 v171, v171, v255
s_waitcnt vmcnt(19)
v_and_b32 v254, 0xffff0000, v172
v_and_b32 v255, 0xffff0000, v173
v_lshlrev_b32 v172, 16, v172
v_lshlrev_b32 v173, 16, v173
v_mul_f32 v254, s40, v254
v_mul_f32 v172, s40, v172
v_mul_f32 v255, s40, v255
v_mul_f32 v173, s40, v173
v_cvt_pk_bf16_f32 v172, v172, v254
v_cvt_pk_bf16_f32 v173, v173, v255
v_and_b32 v254, 0xffff0000, v174
v_and_b32 v255, 0xffff0000, v175
v_lshlrev_b32 v174, 16, v174
v_lshlrev_b32 v175, 16, v175
v_mul_f32 v254, s40, v254
v_mul_f32 v174, s40, v174
v_mul_f32 v255, s40, v255
v_mul_f32 v175, s40, v175
v_cvt_pk_bf16_f32 v174, v174, v254
v_cvt_pk_bf16_f32 v175, v175, v255
s_waitcnt vmcnt(18)
v_and_b32 v254, 0xffff0000, v176
v_and_b32 v255, 0xffff0000, v177
v_lshlrev_b32 v176, 16, v176
buffer_load_dwordx4 v52, s[32:35], s54 offen offset:1024 lds
ds_write_b128 v104, v[168:171] offset:4096
v_lshlrev_b32 v177, 16, v177
v_mul_f32 v254, s40, v254
v_mul_f32 v176, s40, v176
v_mul_f32 v255, s40, v255
v_mul_f32 v177, s40, v177
v_cvt_pk_bf16_f32 v176, v176, v254
v_cvt_pk_bf16_f32 v177, v177, v255
v_and_b32 v254, 0xffff0000, v178
v_and_b32 v255, 0xffff0000, v179
v_lshlrev_b32 v178, 16, v178
v_lshlrev_b32 v179, 16, v179
v_mul_f32 v254, s40, v254
v_mul_f32 v178, s40, v178
v_mul_f32 v255, s40, v255
v_mul_f32 v179, s40, v179
v_cvt_pk_bf16_f32 v178, v178, v254
v_cvt_pk_bf16_f32 v179, v179, v255
s_waitcnt vmcnt(18)
v_and_b32 v254, 0xffff0000, v180
v_and_b32 v255, 0xffff0000, v181
v_lshlrev_b32 v180, 16, v180
v_lshlrev_b32 v181, 16, v181
v_mul_f32 v254, s40, v254
v_mul_f32 v180, s40, v180
v_mul_f32 v255, s40, v255
v_mul_f32 v181, s40, v181
buffer_load_dwordx4 v52, s[32:35], s54 offen offset:2048 lds
ds_write_b128 v105, v[172:175] offset:5120
ds_write_b128 v104, v[176:179] offset:6144
v_cvt_pk_bf16_f32 v180, v180, v254
v_cvt_pk_bf16_f32 v181, v181, v255
v_and_b32 v254, 0xffff0000, v182
v_and_b32 v255, 0xffff0000, v183
v_lshlrev_b32 v182, 16, v182
v_lshlrev_b32 v183, 16, v183
v_mul_f32 v254, s40, v254
v_mul_f32 v182, s40, v182
v_mul_f32 v255, s40, v255
v_mul_f32 v183, s40, v183
v_cvt_pk_bf16_f32 v182, v182, v254
v_cvt_pk_bf16_f32 v183, v183, v255
ds_write_b128 v105, v[180:183] offset:7168
buffer_load_dwordx4 v52, s[32:35], s54 offen offset:3072 lds
s_add_u32 m0, s57, 116224
v_xor_b32 v254, 32, v54
v_xor_b32 v255, 64, v54
s_mov_b32 s53, 0x7ff00000
buffer_load_dwordx4 v52, s[32:35], s57 offen offset:0 lds
buffer_load_dwordx4 v52, s[32:35], s57 offen offset:1024 lds
s_waitcnt vmcnt(10) lgkmcnt(0)
s_barrier
ds_read_b64_tr_b16 a[64:65], v248 offset:0
ds_read_b64_tr_b16 a[66:67], v248 offset:512
ds_read_b128 v[188:191], v236 offset:0
ds_read_b64_tr_b16 a[68:69], v248 offset:4096
ds_read_b64_tr_b16 a[70:71], v248 offset:4608
buffer_load_dwordx4 v52, s[32:35], s57 offen offset:2048 lds
ds_read_b128 v[196:199], v236 offset:256
ds_read_b64_tr_b16 a[72:73], v248 offset:8192
ds_read_b64_tr_b16 a[74:75], v248 offset:8704
ds_read_b128 v[200:203], v236 offset:512
ds_read_b64_tr_b16 a[76:77], v248 offset:12288
ds_read_b64_tr_b16 a[78:79], v248 offset:12800
ds_read_b128 v[204:207], v236 offset:768
ds_read_b64_tr_b16 a[92:93], v249 offset:12288
ds_read_b64_tr_b16 a[94:95], v249 offset:12800
ds_read_b64_tr_b16 a[88:89], v249 offset:8192
ds_read_b64_tr_b16 a[90:91], v249 offset:8704
ds_read_b64_tr_b16 a[84:85], v249 offset:4096
ds_read_b64_tr_b16 a[86:87], v249 offset:4608
ds_read_b64_tr_b16 a[80:81], v249 offset:0
ds_read_b64_tr_b16 a[82:83], v249 offset:512
s_waitcnt lgkmcnt(15)
v_mfma_f32_16x16x32_bf16 v[192:195], a[64:67], v[188:191], 0
ds_read_b64_tr_b16 a[96:97], v250 offset:0
ds_read_b64_tr_b16 a[98:99], v250 offset:512
s_waitcnt lgkmcnt(15)
v_mfma_f32_16x16x32_bf16 v[192:195], a[68:71], v[196:199], v[192:195]
s_waitcnt lgkmcnt(14)
ds_read_b64_tr_b16 a[100:101], v250 offset:4096
s_waitcnt lgkmcnt(14)
v_mfma_f32_16x16x32_bf16 v[192:195], a[72:75], v[200:203], v[192:195]
s_waitcnt lgkmcnt(11)
ds_read_b64_tr_b16 a[102:103], v250 offset:4608
ds_read_b64_tr_b16 a[104:105], v250 offset:8192
v_mfma_f32_16x16x32_bf16 v[192:195], a[76:79], v[204:207], v[192:195]
s_waitcnt lgkmcnt(9)
ds_read_b64_tr_b16 a[106:107], v250 offset:8704
ds_read_b64_tr_b16 a[108:109], v250 offset:12288
v_mfma_f32_16x16x32_bf16 v[208:211], a[92:95], v[204:207], 0
s_waitcnt lgkmcnt(7)
buffer_load_dwordx4 v52, s[32:35], s57 offen offset:3072 lds
s_add_u32 m0, s49, 8448
v_mfma_f32_16x16x32_bf16 v[208:211], a[88:91], v[200:203], v[208:211]
ds_read_b64_tr_b16 a[110:111], v250 offset:12800
v_cvt_pk_bf16_f32 v0, v192, v193
v_mfma_f32_16x16x32_bf16 v[208:211], a[84:87], v[196:199], v[208:211]
s_waitcnt lgkmcnt(6)
ds_read_b64_tr_b16 a[124:125], v251 offset:12288
v_cvt_pk_bf16_f32 v1, v194, v195
v_mfma_f32_16x16x32_bf16 v[208:211], a[80:83], v[188:191], v[208:211]
s_waitcnt lgkmcnt(6)
ds_read_b64_tr_b16 a[126:127], v251 offset:12800
ds_read_b64_tr_b16 a[120:121], v251 offset:8192
v_mfma_f32_16x16x32_bf16 v[192:195], a[96:99], v[188:191], 0
s_waitcnt lgkmcnt(6)
ds_read_b64_tr_b16 a[122:123], v251 offset:8704
ds_read_b64_tr_b16 a[116:117], v251 offset:4096
v_mfma_f32_16x16x32_bf16 v[192:195], a[100:103], v[196:199], v[192:195]
s_waitcnt lgkmcnt(6)
ds_read_b64_tr_b16 a[118:119], v251 offset:4608
v_cvt_pk_bf16_f32 v2, v208, v209
v_mfma_f32_16x16x32_bf16 v[192:195], a[104:107], v[200:203], v[192:195]
ds_read_b64_tr_b16 a[112:113], v251 offset:0
s_waitcnt lgkmcnt(7)
v_mfma_f32_16x16x32_bf16 v[192:195], a[108:111], v[204:207], v[192:195]
ds_read_b64_tr_b16 a[114:115], v251 offset:512
v_cvt_pk_bf16_f32 v3, v210, v211
ds_read_b128 v[184:187], v236 offset:4992
s_waitcnt lgkmcnt(7)
v_mfma_f32_16x16x32_bf16 v[208:211], a[124:127], v[204:207], 0
s_waitcnt lgkmcnt(6)
buffer_load_dwordx4 v[120:123], v53, s[36:39], s54 offen offset:0
s_waitcnt lgkmcnt(5)
v_mfma_f32_16x16x32_bf16 v[208:211], a[120:123], v[200:203], v[208:211]
s_waitcnt lgkmcnt(4)
ds_read_b128 v[216:219], v236 offset:4736
s_waitcnt lgkmcnt(4)
v_mfma_f32_16x16x32_bf16 v[208:211], a[116:119], v[196:199], v[208:211]
ds_read_b128 v[204:207], v236 offset:4480
v_cvt_pk_bf16_f32 v5, v194, v195
v_cvt_pk_bf16_f32 v4, v192, v193
s_waitcnt lgkmcnt(3)
v_mfma_f32_16x16x32_bf16 v[208:211], a[112:115], v[188:191], v[208:211]
ds_read_b128 v[192:195], v236 offset:4224
s_waitcnt lgkmcnt(3)
v_mfma_f32_16x16x32_bf16 v[200:203], a[124:127], v[184:187], 0
ds_read_b64_tr_b16 a[0:1], v248 offset:32768
ds_read_b64_tr_b16 a[2:3], v248 offset:33280
v_mfma_f32_16x16x32_bf16 v[220:223], a[92:95], v[184:187], 0
ds_read_b64_tr_b16 a[4:5], v248 offset:36864
s_waitcnt lgkmcnt(5)
v_mfma_f32_16x16x32_bf16 v[200:203], a[120:123], v[216:219], v[200:203]
ds_read_b64_tr_b16 a[6:7], v248 offset:37376
s_waitcnt lgkmcnt(5)
v_mfma_f32_16x16x32_bf16 v[200:203], a[116:119], v[204:207], v[200:203]
ds_read_b64_tr_b16 a[8:9], v248 offset:40960
v_cvt_pk_bf16_f32 v6, v208, v209
v_mfma_f32_16x16x32_bf16 v[220:223], a[88:91], v[216:219], v[220:223]
buffer_load_dwordx4 v[124:127], v53, s[36:39], s54 offen offset:1024
s_waitcnt lgkmcnt(5)
v_mfma_f32_16x16x32_bf16 v[200:203], a[112:115], v[192:195], v[200:203]
ds_read_b64_tr_b16 a[10:11], v248 offset:41472
v_cvt_pk_bf16_f32 v7, v210, v211
v_mfma_f32_16x16x32_bf16 v[208:211], a[96:99], v[192:195], 0
s_waitcnt lgkmcnt(4)
ds_read_b64_tr_b16 a[12:13], v248 offset:45056
ds_read_b64_tr_b16 a[14:15], v248 offset:45568
v_mfma_f32_16x16x32_bf16 v[208:211], a[100:103], v[204:207], v[208:211]
s_waitcnt lgkmcnt(5)
ds_read_b64_tr_b16 a[16:17], v249 offset:32768
ds_read_b64_tr_b16 a[18:19], v249 offset:33280
v_mfma_f32_16x16x32_bf16 v[208:211], a[104:107], v[216:219], v[208:211]
s_waitcnt lgkmcnt(6)
ds_read_b64_tr_b16 a[20:21], v249 offset:36864
ds_read_b64_tr_b16 a[22:23], v249 offset:37376
v_mfma_f32_16x16x32_bf16 v[208:211], a[108:111], v[184:187], v[208:211]
s_waitcnt lgkmcnt(7)
ds_read_b64_tr_b16 a[24:25], v249 offset:40960
ds_read_b64_tr_b16 a[26:27], v249 offset:41472
v_mfma_f32_16x16x32_bf16 v[220:223], a[84:87], v[204:207], v[220:223]
ds_read_b64_tr_b16 a[28:29], v249 offset:45056
ds_read_b64_tr_b16 a[30:31], v249 offset:45568
v_mfma_f32_16x16x32_bf16 v[220:223], a[80:83], v[192:195], v[220:223]
s_waitcnt lgkmcnt(10)
ds_read_b64_tr_b16 a[32:33], v250 offset:32768
ds_read_b64_tr_b16 a[34:35], v250 offset:33280
v_mfma_f32_16x16x32_bf16 v[188:191], a[64:67], v[192:195], 0
s_waitcnt lgkmcnt(10)
ds_read_b64_tr_b16 a[36:37], v250 offset:36864
ds_read_b64_tr_b16 a[38:39], v250 offset:37376
v_mfma_f32_16x16x32_bf16 v[188:191], a[72:75], v[216:219], v[188:191]
s_waitcnt lgkmcnt(10)
buffer_load_dwordx4 v[128:131], v53, s[36:39], s54 offen offset:2048
ds_read_b64_tr_b16 a[40:41], v250 offset:40960
v_mfma_f32_16x16x32_bf16 v[188:191], a[76:79], v[184:187], v[188:191]
s_waitcnt lgkmcnt(9)
ds_read_b64_tr_b16 a[42:43], v250 offset:41472
ds_read_b64_tr_b16 a[44:45], v250 offset:45056
v_mfma_f32_16x16x32_bf16 v[188:191], a[68:71], v[204:207], v[188:191]
s_waitcnt lgkmcnt(9)
ds_read_b64_tr_b16 a[46:47], v250 offset:45568
ds_read_b64_tr_b16 a[48:49], v251 offset:32768
ds_read_b64_tr_b16 a[50:51], v251 offset:33280
ds_read_b64_tr_b16 a[52:53], v251 offset:36864
ds_read_b64_tr_b16 a[54:55], v251 offset:37376
ds_read_b64_tr_b16 a[56:57], v251 offset:40960
ds_read_b64_tr_b16 a[58:59], v251 offset:41472
s_waitcnt vmcnt(11)
s_barrier
ds_read_b128 v[56:59], v236 offset:16896
ds_read_b128 v[60:63], v236 offset:17152
ds_read_b128 v[64:67], v236 offset:17408
ds_read_b128 v[68:71], v236 offset:17664
ds_read_b128 v[72:75], v236 offset:21120
ds_read_b128 v[76:79], v236 offset:21376
ds_read_b128 v[80:83], v236 offset:21632
ds_read_b128 v[84:87], v236 offset:21888
ds_read_b64_tr_b16 a[60:61], v251 offset:45056
ds_read_b64_tr_b16 a[62:63], v251 offset:45568
v_cvt_pk_bf16_f32 v14, v200, v201
buffer_load_dwordx4 v[132:135], v53, s[36:39], s54 offen offset:3072
v_cvt_pk_bf16_f32 v15, v202, v203
v_cvt_pk_bf16_f32 v9, v190, v191
v_cvt_pk_bf16_f32 v8, v188, v189
v_cvt_pk_bf16_f32 v13, v210, v211
v_cvt_pk_bf16_f32 v12, v208, v209
v_cvt_pk_bf16_f32 v10, v220, v221
v_cvt_pk_bf16_f32 v11, v222, v223
s_waitcnt lgkmcnt(9)
v_mfma_f32_16x16x32_bf16 v[156:159], a[64:67], v[56:59], 0
s_waitcnt lgkmcnt(7)
v_mfma_f32_16x16x32_bf16 v[156:159], a[68:71], v[60:63], v[156:159]
s_waitcnt lgkmcnt(3)
v_mfma_f32_16x16x32_bf16 v[156:159], a[72:75], v[64:67], v[156:159]
s_waitcnt lgkmcnt(0)
v_mfma_f32_16x16x32_bf16 v[156:159], a[76:79], v[68:71], v[156:159]
s_nop 2
v_mfma_f32_16x16x32_bf16 v[160:163], a[92:95], v[68:71], 0
s_nop 2
v_mfma_f32_16x16x32_bf16 v[160:163], a[88:91], v[64:67], v[160:163]
s_waitcnt vmcnt(4)
s_barrier
v_mfma_f32_16x16x32_bf16 v[160:163], a[84:87], v[60:63], v[160:163]
buffer_load_dwordx4 v[136:139], v53, s[36:39], s57 offen offset:0
ds_read_b64_tr_b16 a[128:129], v252 offset:0
v_mfma_f32_16x16x32_bf16 v[160:163], a[80:83], v[56:59], v[160:163]
ds_read_b64_tr_b16 a[130:131], v252 offset:512
ds_read_b64_tr_b16 a[132:133], v252 offset:4096
v_mfma_f32_16x16x32_bf16 v[164:167], a[96:99], v[56:59], 0
ds_read_b64_tr_b16 a[134:135], v252 offset:4608
ds_read_b64_tr_b16 a[136:137], v252 offset:8192
v_mfma_f32_16x16x32_bf16 v[164:167], a[100:103], v[60:63], v[164:167]
ds_read_b64_tr_b16 a[138:139], v252 offset:8704
ds_read_b64_tr_b16 a[140:141], v252 offset:12288
v_mfma_f32_16x16x32_bf16 v[164:167], a[104:107], v[64:67], v[164:167]
ds_read_b64_tr_b16 a[142:143], v252 offset:12800
ds_read_b64_tr_b16 a[144:145], v252 offset:8
v_mfma_f32_16x16x32_bf16 v[164:167], a[108:111], v[68:71], v[164:167]
ds_read_b64_tr_b16 a[146:147], v252 offset:520
ds_read_b64_tr_b16 a[148:149], v252 offset:4104
v_mfma_f32_16x16x32_bf16 v[168:171], a[124:127], v[68:71], 0
s_waitcnt lgkmcnt(10)
ds_read_b64_tr_b16 a[150:151], v252 offset:4616
v_cvt_pk_bf16_f32 v88, v156, v157
v_mfma_f32_16x16x32_bf16 v[168:171], a[120:123], v[64:67], v[168:171]
s_waitcnt lgkmcnt(9)
ds_read_b64_tr_b16 a[152:153], v252 offset:8200
v_cvt_pk_bf16_f32 v89, v158, v159
v_mfma_f32_16x16x32_bf16 v[168:171], a[116:119], v[60:63], v[168:171]
s_waitcnt lgkmcnt(8)
ds_read_b64_tr_b16 a[154:155], v252 offset:8712
ds_read_b64_tr_b16 a[156:157], v252 offset:12296
v_mfma_f32_16x16x32_bf16 v[168:171], a[112:115], v[56:59], v[168:171]
s_waitcnt lgkmcnt(8)
buffer_load_dwordx4 v[140:143], v53, s[36:39], s57 offen offset:1024
ds_read_b64_tr_b16 a[158:159], v252 offset:12808
v_mfma_f32_16x16x32_bf16 v[172:175], a[64:67], v[72:75], 0
s_waitcnt lgkmcnt(7)
ds_read_b64_tr_b16 a[160:161], v253 offset:0
v_cvt_pk_bf16_f32 v90, v160, v161
v_mfma_f32_16x16x32_bf16 v[172:175], a[68:71], v[76:79], v[172:175]
s_waitcnt lgkmcnt(6)
ds_read_b64_tr_b16 a[162:163], v253 offset:512
v_cvt_pk_bf16_f32 v91, v162, v163
v_mfma_f32_16x16x32_bf16 v[172:175], a[72:75], v[80:83], v[172:175]
s_waitcnt lgkmcnt(6)
ds_read_b64_tr_b16 a[164:165], v253 offset:4096
ds_read_b64_tr_b16 a[166:167], v253 offset:4608
v_mfma_f32_16x16x32_bf16 v[172:175], a[76:79], v[84:87], v[172:175]
s_waitcnt lgkmcnt(7)
ds_read_b64_tr_b16 a[168:169], v253 offset:8192
ds_read_b64_tr_b16 a[170:171], v253 offset:8704
v_mfma_f32_16x16x32_bf16 v[176:179], a[92:95], v[84:87], 0
s_waitcnt lgkmcnt(7)
ds_read_b64_tr_b16 a[172:173], v253 offset:12288
v_cvt_pk_bf16_f32 v92, v164, v165
v_mfma_f32_16x16x32_bf16 v[176:179], a[88:91], v[80:83], v[176:179]
s_waitcnt lgkmcnt(7)
ds_read_b64_tr_b16 a[174:175], v253 offset:12800
v_cvt_pk_bf16_f32 v93, v166, v167
v_mfma_f32_16x16x32_bf16 v[176:179], a[84:87], v[76:79], v[176:179]
s_waitcnt lgkmcnt(7)
ds_read_b64_tr_b16 a[176:177], v253 offset:8
ds_read_b64_tr_b16 a[178:179], v253 offset:520
v_mfma_f32_16x16x32_bf16 v[176:179], a[80:83], v[72:75], v[176:179]
s_waitcnt lgkmcnt(8)
ds_read_b64_tr_b16 a[180:181], v253 offset:4104
ds_read_b64_tr_b16 a[182:183], v253 offset:4616
v_mfma_f32_16x16x32_bf16 v[180:183], a[96:99], v[72:75], 0
s_waitcnt lgkmcnt(8)
buffer_load_dwordx4 v[144:147], v53, s[36:39], s57 offen offset:2048
v_cvt_pk_bf16_f32 v94, v168, v169
v_mfma_f32_16x16x32_bf16 v[180:183], a[100:103], v[76:79], v[180:183]
s_waitcnt lgkmcnt(6)
ds_read_b64_tr_b16 a[184:185], v253 offset:8200
v_cvt_pk_bf16_f32 v95, v170, v171
v_mfma_f32_16x16x32_bf16 v[180:183], a[104:107], v[80:83], v[180:183]
s_waitcnt lgkmcnt(6)
ds_read_b64_tr_b16 a[186:187], v253 offset:8712
ds_read_b64_tr_b16 a[188:189], v253 offset:12296
v_mfma_f32_16x16x32_bf16 v[180:183], a[108:111], v[84:87], v[180:183]
s_waitcnt lgkmcnt(7)
ds_read_b64_tr_b16 a[190:191], v253 offset:12808
v_cvt_pk_bf16_f32 v96, v172, v173
v_mfma_f32_16x16x32_bf16 v[152:155], a[124:127], v[84:87], 0
s_waitcnt lgkmcnt(6)
v_cvt_pk_bf16_f32 v97, v174, v175
v_cvt_pk_bf16_f32 v98, v176, v177
v_mfma_f32_16x16x32_bf16 v[152:155], a[120:123], v[80:83], v[152:155]
s_waitcnt lgkmcnt(4)
v_cvt_pk_bf16_f32 v99, v178, v179
v_cvt_pk_bf16_f32 v100, v180, v181
v_mfma_f32_16x16x32_bf16 v[152:155], a[116:119], v[76:79], v[152:155]
v_cvt_pk_bf16_f32 v101, v182, v183
v_mov_b32 v253, 0
v_mfma_f32_16x16x32_bf16 v[152:155], a[112:115], v[72:75], v[152:155]
s_waitcnt lgkmcnt(3)
v_mov_b32 v252, 1.0
s_nop 0
v_mfma_f32_16x16x32_bf16 v[156:159], a[0:3], v[56:59], 0
s_waitcnt lgkmcnt(1)
s_nop 1
v_mfma_f32_16x16x32_bf16 v[156:159], a[4:7], v[60:63], v[156:159]
s_waitcnt lgkmcnt(0)
buffer_load_dwordx4 v[148:151], v53, s[36:39], s57 offen offset:3072
v_cvt_pk_bf16_f32 v102, v152, v153
v_mfma_f32_16x16x32_bf16 v[156:159], a[8:11], v[64:67], v[156:159]
v_cvt_pk_bf16_f32 v103, v154, v155
v_mfma_f32_16x16x32_bf16 v[156:159], a[12:15], v[68:71], v[156:159]
s_nop 2
v_mfma_f32_16x16x32_bf16 v[160:163], a[28:31], v[68:71], 0
s_nop 2
v_mfma_f32_16x16x32_bf16 v[160:163], a[24:27], v[64:67], v[160:163]
v_cvt_pk_bf16_f32 v104, v156, v157
v_cvt_pk_bf16_f32 v105, v158, v159
v_mfma_f32_16x16x32_bf16 v[160:163], a[20:23], v[60:63], v[160:163]
v_mfma_f32_16x16x32_bf16 v[160:163], a[16:19], v[56:59], v[160:163]
s_nop 2
v_mfma_f32_16x16x32_bf16 v[164:167], a[32:35], v[56:59], 0
s_nop 2
v_mfma_f32_16x16x32_bf16 v[164:167], a[36:39], v[60:63], v[164:167]
v_cvt_pk_bf16_f32 v106, v160, v161
v_cvt_pk_bf16_f32 v107, v162, v163
v_mfma_f32_16x16x32_bf16 v[164:167], a[40:43], v[64:67], v[164:167]
buffer_load_dwordx4 v237, s[16:19], s48 offen nt lds
s_add_u32 m0, s49, 10560
v_mfma_f32_16x16x32_bf16 v[164:167], a[44:47], v[68:71], v[164:167]
s_add_u32 s48, s55, 10240
s_nop 1
v_mfma_f32_16x16x32_bf16 v[168:171], a[60:63], v[68:71], 0
s_nop 2
v_mfma_f32_16x16x32_bf16 v[168:171], a[56:59], v[64:67], v[168:171]
v_cvt_pk_bf16_f32 v108, v164, v165
v_cvt_pk_bf16_f32 v109, v166, v167
v_mfma_f32_16x16x32_bf16 v[168:171], a[52:55], v[60:63], v[168:171]
v_mfma_f32_16x16x32_bf16 v[168:171], a[48:51], v[56:59], v[168:171]
s_nop 2
v_mfma_f32_16x16x32_bf16 v[172:175], a[0:3], v[72:75], 0
s_waitcnt vmcnt(8)
ds_write_b64 v54, v[120:121] offset:0
v_mfma_f32_16x16x32_bf16 v[172:175], a[4:7], v[76:79], v[172:175]
ds_write_b64 v254, v[122:123] offset:0
v_mfma_f32_16x16x32_bf16 v[172:175], a[8:11], v[80:83], v[172:175]
buffer_load_dwordx4 v237, s[16:19], s48 offen nt lds
v_mfma_f32_16x16x32_bf16 v[172:175], a[12:15], v[84:87], v[172:175]
s_add_u32 m0, s49, 12672
s_add_u32 s48, s55, 12288
v_cvt_pk_bf16_f32 v110, v168, v169
v_mfma_f32_16x16x32_bf16 v[176:179], a[28:31], v[84:87], 0
s_waitcnt vmcnt(8)
ds_write_b64 v54, v[124:125] offset:512
v_mfma_f32_16x16x32_bf16 v[176:179], a[24:27], v[80:83], v[176:179]
ds_write_b64 v254, v[126:127] offset:512
v_mfma_f32_16x16x32_bf16 v[176:179], a[20:23], v[76:79], v[176:179]
s_waitcnt vmcnt(7)
ds_write_b64 v255, v[128:129] offset:1024
v_mfma_f32_16x16x32_bf16 v[176:179], a[16:19], v[72:75], v[176:179]
ds_write_b64 v55, v[130:131] offset:1024
v_mfma_f32_16x16x32_bf16 v[180:183], a[32:35], v[72:75], 0
s_waitcnt vmcnt(6)
ds_write_b64 v255, v[132:133] offset:1536
v_mfma_f32_16x16x32_bf16 v[180:183], a[36:39], v[76:79], v[180:183]
ds_write_b64 v55, v[134:135] offset:1536
v_mfma_f32_16x16x32_bf16 v[180:183], a[40:43], v[80:83], v[180:183]
buffer_load_dwordx4 v237, s[16:19], s48 offen nt lds
s_add_u32 m0, s49, 14784
v_mfma_f32_16x16x32_bf16 v[180:183], a[44:47], v[84:87], v[180:183]
s_add_u32 s48, s55, 14336
v_cvt_pk_bf16_f32 v111, v170, v171
v_cvt_pk_bf16_f32 v112, v172, v173
v_mfma_f32_16x16x32_bf16 v[152:155], a[60:63], v[84:87], 0
s_waitcnt vmcnt(6)
ds_write_b64 v54, v[136:137] offset:2048
v_mfma_f32_16x16x32_bf16 v[152:155], a[56:59], v[80:83], v[152:155]
ds_write_b64 v254, v[138:139] offset:2048
v_mfma_f32_16x16x32_bf16 v[152:155], a[52:55], v[76:79], v[152:155]
s_waitcnt vmcnt(5)
ds_write_b64 v54, v[140:141] offset:2560
v_mfma_f32_16x16x32_bf16 v[152:155], a[48:51], v[72:75], v[152:155]
ds_write_b64 v254, v[142:143] offset:2560
v_mfma_f32_16x16x32_bf16 v[156:159], v[56:59], a[128:131], 0
s_waitcnt vmcnt(4)
ds_write_b64 v255, v[144:145] offset:3072
v_mfma_f32_16x16x32_bf16 v[156:159], v[60:63], a[132:135], v[156:159]
ds_write_b64 v55, v[146:147] offset:3072
v_mfma_f32_16x16x32_bf16 v[156:159], v[64:67], a[136:139], v[156:159]
buffer_load_dwordx4 v237, s[16:19], s48 offen nt lds
s_add_u32 m0, s49, 16896
v_mfma_f32_16x16x32_bf16 v[156:159], v[68:71], a[140:143], v[156:159]
s_add_u32 s48, s55, 16384
buffer_load_dwordx4 v237, s[16:19], s48 offen nt lds
s_add_u32 m0, s49, 19008
v_mfma_f32_16x16x32_bf16 v[160:163], v[68:71], a[156:159], 0
s_add_u32 s48, s55, 18432
buffer_load_dwordx4 v237, s[16:19], s48 offen nt lds
s_add_u32 m0, s49, 21120
v_mfma_f32_16x16x32_bf16 v[160:163], v[64:67], a[152:155], v[160:163]
s_add_u32 s48, s55, 20480
buffer_load_dwordx4 v237, s[16:19], s48 offen nt lds
s_add_u32 m0, s49, 23232
v_mfma_f32_16x16x32_bf16 v[160:163], v[60:63], a[148:151], v[160:163]
s_add_u32 s48, s55, 22528
buffer_load_dwordx4 v237, s[16:19], s48 offen nt lds
v_cvt_pk_bf16_f32 v113, v174, v175
v_mfma_f32_16x16x32_bf16 v[160:163], v[56:59], a[144:147], v[160:163]
s_add_u32 s49, s49, 50688
v_cvt_pk_bf16_f32 v114, v176, v177
v_cvt_pk_bf16_f32 v115, v178, v179
v_mfma_f32_16x16x32_bf16 v[164:167], v[56:59], a[160:163], 0
s_waitcnt vmcnt(8)
ds_write_b64 v255, v[148:149] offset:3584
v_mfma_f32_16x16x32_bf16 v[164:167], v[60:63], a[164:167], v[164:167]
ds_write_b64 v55, v[150:151] offset:3584
v_mfma_f32_16x16x32_bf16 v[164:167], v[64:67], a[168:171], v[164:167]
v_cvt_pk_bf16_f32 v116, v180, v181
v_cvt_pk_bf16_f32 v117, v182, v183
v_mfma_f32_16x16x32_bf16 v[164:167], v[68:71], a[172:175], v[164:167]
v_cvt_pk_bf16_f32 v118, v152, v153
v_cvt_pk_bf16_f32 v119, v154, v155
v_mfma_f32_16x16x32_bf16 v[168:171], v[68:71], a[188:191], 0
v_cvt_pk_bf16_f32 v156, v156, v157
v_cvt_pk_bf16_f32 v157, v158, v159
v_mfma_f32_16x16x32_bf16 v[168:171], v[64:67], a[184:187], v[168:171]
v_cvt_pk_bf16_f32 v160, v160, v161
v_cvt_pk_bf16_f32 v161, v162, v163
v_mfma_f32_16x16x32_bf16 v[168:171], v[60:63], a[180:183], v[168:171]
s_waitcnt lgkmcnt(0)
s_barrier
v_mfma_f32_16x16x32_bf16 v[168:171], v[56:59], a[176:179], v[168:171]
ds_read_b64_tr_b16 a[192:193], v248 offset:0
ds_read_b64_tr_b16 a[194:195], v248 offset:512
v_mfma_f32_16x16x32_bf16 v[172:175], v[72:75], a[128:131], 0
ds_read_b64_tr_b16 a[196:197], v248 offset:4096
ds_read_b64_tr_b16 a[198:199], v248 offset:4608
v_mfma_f32_16x16x32_bf16 v[172:175], v[76:79], a[132:135], v[172:175]
ds_read_b64_tr_b16 a[200:201], v248 offset:8192
ds_read_b64_tr_b16 a[202:203], v248 offset:8704
v_mfma_f32_16x16x32_bf16 v[172:175], v[80:83], a[136:139], v[172:175]
ds_read_b64_tr_b16 a[204:205], v248 offset:12288
ds_read_b64_tr_b16 a[206:207], v248 offset:12800
v_mfma_f32_16x16x32_bf16 v[172:175], v[84:87], a[140:143], v[172:175]
ds_read_b64_tr_b16 a[208:209], v249 offset:0
ds_read_b64_tr_b16 a[210:211], v249 offset:512
v_mfma_f32_16x16x32_bf16 v[176:179], v[84:87], a[156:159], 0
ds_read_b64_tr_b16 a[212:213], v249 offset:4096
ds_read_b64_tr_b16 a[214:215], v249 offset:4608
v_mfma_f32_16x16x32_bf16 v[176:179], v[80:83], a[152:155], v[176:179]
s_waitcnt lgkmcnt(10)
ds_read_b64_tr_b16 a[216:217], v249 offset:8192
ds_read_b64_tr_b16 a[218:219], v249 offset:8704
v_mfma_f32_16x16x32_bf16 v[176:179], v[76:79], a[148:151], v[176:179]
s_waitcnt lgkmcnt(10)
ds_read_b64_tr_b16 a[220:221], v249 offset:12288
ds_read_b64_tr_b16 a[222:223], v249 offset:12800
v_mfma_f32_16x16x32_bf16 v[176:179], v[72:75], a[144:147], v[176:179]
s_waitcnt lgkmcnt(10)
ds_read_b64_tr_b16 a[224:225], v250 offset:0
ds_read_b64_tr_b16 a[226:227], v250 offset:512
v_mfma_f32_16x16x32_bf16 v[180:183], v[72:75], a[160:163], 0
s_waitcnt lgkmcnt(10)
ds_read_b64_tr_b16 a[228:229], v250 offset:4096
ds_read_b64_tr_b16 a[230:231], v250 offset:4608
v_mfma_f32_16x16x32_bf16 v[180:183], v[76:79], a[164:167], v[180:183]
s_waitcnt lgkmcnt(10)
ds_read_b64_tr_b16 a[232:233], v250 offset:8192
ds_read_b64_tr_b16 a[234:235], v250 offset:8704
v_mfma_f32_16x16x32_bf16 v[180:183], v[80:83], a[168:171], v[180:183]
s_waitcnt lgkmcnt(10)
ds_read_b64_tr_b16 a[236:237], v250 offset:12288
ds_read_b64_tr_b16 a[238:239], v250 offset:12800
v_mfma_f32_16x16x32_bf16 v[180:183], v[84:87], a[172:175], v[180:183]
s_waitcnt lgkmcnt(10)
ds_read_b64_tr_b16 a[240:241], v251 offset:0
ds_read_b64_tr_b16 a[242:243], v251 offset:512
v_mfma_f32_16x16x32_bf16 v[152:155], v[84:87], a[188:191], 0
s_waitcnt lgkmcnt(10)
ds_read_b64_tr_b16 a[244:245], v251 offset:4096
ds_read_b64_tr_b16 a[246:247], v251 offset:4608
v_mfma_f32_16x16x32_bf16 v[152:155], v[80:83], a[184:187], v[152:155]
s_waitcnt lgkmcnt(10)
ds_read_b64_tr_b16 a[248:249], v251 offset:8192
ds_read_b64_tr_b16 a[250:251], v251 offset:8704
v_mfma_f32_16x16x32_bf16 v[152:155], v[76:79], a[180:183], v[152:155]
s_waitcnt lgkmcnt(10)
ds_read_b64_tr_b16 a[252:253], v251 offset:12288
ds_read_b64_tr_b16 a[254:255], v251 offset:12800
v_mfma_f32_16x16x32_bf16 v[152:155], v[72:75], a[176:179], v[152:155]
s_waitcnt lgkmcnt(10)
ds_write_b128 v50, v[88:91] offset:0
ds_write_b128 v50, v[104:107] offset:4096
ds_write_b64 v51, v[156:157] offset:0
ds_write_b128 v50, v[92:95] offset:64
ds_write_b128 v50, v[108:111] offset:4160
ds_write_b64 v51, v[160:161] offset:128
v_cvt_pk_bf16_f32 v164, v164, v165
v_cvt_pk_bf16_f32 v165, v166, v167
v_cvt_pk_bf16_f32 v168, v168, v169
v_cvt_pk_bf16_f32 v169, v170, v171
v_cvt_pk_bf16_f32 v172, v172, v173
v_cvt_pk_bf16_f32 v173, v174, v175
v_cvt_pk_bf16_f32 v176, v176, v177
v_cvt_pk_bf16_f32 v177, v178, v179
v_cvt_pk_bf16_f32 v180, v180, v181
v_cvt_pk_bf16_f32 v181, v182, v183
v_cvt_pk_bf16_f32 v152, v152, v153
v_cvt_pk_bf16_f32 v153, v154, v155
v_mov_b32 v105, 0
v_mov_b32 v107, 0
v_mov_b32 v109, 0
v_mov_b32 v111, 0
v_mov_b32 v133, 0
v_mov_b32 v134, 0
v_mov_b32 v135, 0
v_mov_b32 v149, 0
v_mov_b32 v150, 0
v_mov_b32 v151, 0
v_mov_b32 v248, 1.0
v_mov_b32 v249, 1.0
v_mov_b32 v251, 1.0
ds_write_b64 v51, v[164:165] offset:256
ds_write_b64 v51, v[168:169] offset:384
ds_write_b128 v50, v[96:99] offset:2048
ds_write_b128 v50, v[112:115] offset:6144
ds_write_b64 v51, v[172:173] offset:2048
ds_write_b64 v51, v[176:177] offset:2176
s_waitcnt vmcnt(4)
s_barrier
ds_read_b128 v[200:203], v236 offset:8704
ds_read_b128 v[212:215], v236 offset:8448
ds_read_b128 v[224:227], v236 offset:8960
ds_read_b128 v[228:231], v236 offset:9216
ds_read_b128 v[192:195], v236 offset:13440
ds_read_b128 v[204:207], v236 offset:12928
ds_read_b128 v[208:211], v236 offset:12672
ds_write_b128 v50, v[100:103] offset:2112
ds_write_b128 v50, v[116:119] offset:6208
s_waitcnt lgkmcnt(8)
v_mfma_f32_16x16x32_bf16 v[184:187], a[68:71], v[200:203], 0
s_waitcnt lgkmcnt(6)
ds_write_b64 v51, v[180:181] offset:2304
v_mfma_f32_16x16x32_bf16 v[184:187], a[64:67], v[212:215], v[184:187]
s_waitcnt lgkmcnt(2)
ds_write_b64 v51, v[152:153] offset:2432
v_mfma_f32_16x16x32_bf16 v[184:187], a[72:75], v[224:227], v[184:187]
v_mfma_f32_16x16x32_bf16 v[184:187], a[76:79], v[228:231], v[184:187]
s_nop 2
v_mfma_f32_16x16x32_bf16 v[188:191], a[92:95], v[228:231], 0
s_nop 2
v_mfma_f32_16x16x32_bf16 v[188:191], a[88:91], v[224:227], v[188:191]
v_cvt_pk_bf16_f32 v16, v184, v185
v_cvt_pk_bf16_f32 v17, v186, v187
v_mfma_f32_16x16x32_bf16 v[188:191], a[84:87], v[200:203], v[188:191]
ds_read_b128 v[184:187], v236 offset:13184
v_mfma_f32_16x16x32_bf16 v[188:191], a[80:83], v[212:215], v[188:191]
s_nop 2
v_mfma_f32_16x16x32_bf16 v[196:199], a[96:99], v[212:215], 0
s_nop 2
v_mfma_f32_16x16x32_bf16 v[196:199], a[100:103], v[200:203], v[196:199]
v_cvt_pk_bf16_f32 v18, v188, v189
v_cvt_pk_bf16_f32 v19, v190, v191
v_mfma_f32_16x16x32_bf16 v[196:199], a[104:107], v[224:227], v[196:199]
v_mfma_f32_16x16x32_bf16 v[196:199], a[108:111], v[228:231], v[196:199]
s_nop 2
v_mfma_f32_16x16x32_bf16 v[188:191], a[124:127], v[228:231], 0
s_waitcnt lgkmcnt(0)
s_nop 1
v_mfma_f32_16x16x32_bf16 v[188:191], a[116:119], v[200:203], v[188:191]
v_cvt_pk_bf16_f32 v21, v198, v199
v_cvt_pk_bf16_f32 v20, v196, v197
v_mfma_f32_16x16x32_bf16 v[188:191], a[112:115], v[212:215], v[188:191]
v_mfma_f32_16x16x32_bf16 v[188:191], a[120:123], v[224:227], v[188:191]
s_nop 2
v_mfma_f32_16x16x32_bf16 v[196:199], a[120:123], v[184:187], 0
s_nop 2
v_mfma_f32_16x16x32_bf16 v[196:199], a[124:127], v[192:195], v[196:199]
v_cvt_pk_bf16_f32 v23, v190, v191
v_cvt_pk_bf16_f32 v22, v188, v189
v_mfma_f32_16x16x32_bf16 v[196:199], a[116:119], v[204:207], v[196:199]
v_mfma_f32_16x16x32_bf16 v[196:199], a[112:115], v[208:211], v[196:199]
s_nop 2
v_mfma_f32_16x16x32_bf16 v[188:191], a[96:99], v[208:211], 0
s_nop 2
v_mfma_f32_16x16x32_bf16 v[188:191], a[100:103], v[204:207], v[188:191]
v_cvt_pk_bf16_f32 v30, v196, v197
v_cvt_pk_bf16_f32 v31, v198, v199
v_mfma_f32_16x16x32_bf16 v[188:191], a[104:107], v[184:187], v[188:191]
v_mfma_f32_16x16x32_bf16 v[188:191], a[108:111], v[192:195], v[188:191]
s_nop 2
v_mfma_f32_16x16x32_bf16 v[212:215], a[92:95], v[192:195], 0
s_nop 2
v_mfma_f32_16x16x32_bf16 v[212:215], a[88:91], v[184:187], v[212:215]
v_cvt_pk_bf16_f32 v29, v190, v191
v_cvt_pk_bf16_f32 v28, v188, v189
v_mfma_f32_16x16x32_bf16 v[212:215], a[84:87], v[204:207], v[212:215]
v_mfma_f32_16x16x32_bf16 v[212:215], a[80:83], v[208:211], v[212:215]
s_nop 2
v_mfma_f32_16x16x32_bf16 v[188:191], a[64:67], v[208:211], 0
s_nop 2
v_mfma_f32_16x16x32_bf16 v[188:191], a[72:75], v[184:187], v[188:191]
v_cvt_pk_bf16_f32 v27, v214, v215
v_cvt_pk_bf16_f32 v26, v212, v213
v_mfma_f32_16x16x32_bf16 v[188:191], a[76:79], v[192:195], v[188:191]
s_waitcnt vmcnt(0)
s_barrier
v_mfma_f32_16x16x32_bf16 v[188:191], a[68:71], v[204:207], v[188:191]
s_mov_b32 s48, s50
ds_read_b128 v[196:199], v236 offset:17152
ds_read_b128 v[200:203], v236 offset:16896
ds_read_b128 v[216:219], v236 offset:17408
ds_read_b128 v[220:223], v236 offset:17664
ds_read_u16 v108, v241 offset:256
ds_read_b128 v[204:207], v236 offset:21376
ds_read_b128 v[208:211], v236 offset:21120
ds_read_b128 v[52:55], v240 offset:64
v_cvt_pk_bf16_f32 v24, v188, v189
v_cvt_pk_bf16_f32 v25, v190, v191
s_add_u32 m0, s49, 0
s_add_u32 s50, s50, 13107200
buffer_load_dwordx4 v237, s[16:19], s48 offen nt lds
ds_read_b128 v[192:195], v236 offset:21888
ds_read_b128 v[48:51], v240 offset:0
ds_read_u16 v110, v241 offset:384
v_add_u32 v240, 0x200, v240
s_add_u32 s48, s48, s51
s_add_u32 m0, s49, 2112
ds_read_u16 v106, v241 offset:128
buffer_load_dwordx4 v237, s[16:19], s48 offen nt lds
s_waitcnt lgkmcnt(11)
v_mfma_f32_16x16x32_bf16 v[184:187], a[68:71], v[196:199], 0
s_waitcnt lgkmcnt(9)
ds_read_u16 v104, v241 offset:0
s_add_u32 m0, s49, 4224
v_mfma_f32_16x16x32_bf16 v[184:187], a[64:67], v[200:203], v[184:187]
s_waitcnt lgkmcnt(6)
s_add_u32 s48, s48, s51
buffer_load_dwordx4 v237, s[16:19], s48 offen nt lds
v_mfma_f32_16x16x32_bf16 v[184:187], a[72:75], v[216:219], v[184:187]
s_add_u32 m0, s49, 6336
s_add_u32 s48, s48, s51
buffer_load_dwordx4 v237, s[16:19], s48 offen nt lds
v_mfma_f32_16x16x32_bf16 v[184:187], a[76:79], v[220:223], v[184:187]
s_add_u32 m0, s49, 8448
s_add_u32 s48, s48, s51
buffer_load_dwordx4 v237, s[16:19], s48 offen nt lds
v_mfma_f32_16x16x32_bf16 v[188:191], a[92:95], v[220:223], 0
s_add_u32 m0, s49, 10560
s_mov_b32 s47, s46
s_add_u32 s48, s48, s51
v_mfma_f32_16x16x32_bf16 v[188:191], a[88:91], v[216:219], v[188:191]
s_bfe_i32 s57, s3, 0x10000
buffer_load_dwordx4 v237, s[16:19], s48 offen nt lds
v_cvt_pk_bf16_f32 v32, v184, v185
v_mfma_f32_16x16x32_bf16 v[188:191], a[84:87], v[196:199], v[188:191]
s_and_b32 s54, s57, s5
v_cvt_pk_bf16_f32 v33, v186, v187
s_sub_u32 s45, s45, 1
v_mfma_f32_16x16x32_bf16 v[188:191], a[80:83], v[200:203], v[188:191]
s_sub_u32 s50, s50, s54
s_add_u32 s52, s46, 20480
s_lshr_b32 s3, s3, 1
v_mfma_f32_16x16x32_bf16 v[184:187], a[96:99], v[200:203], 0
s_waitcnt lgkmcnt(0)
s_nop 1
v_mfma_f32_16x16x32_bf16 v[184:187], a[100:103], v[196:199], v[184:187]
v_cvt_pk_bf16_f32 v35, v190, v191
v_cvt_pk_bf16_f32 v34, v188, v189
v_mfma_f32_16x16x32_bf16 v[184:187], a[104:107], v[216:219], v[184:187]
v_mfma_f32_16x16x32_bf16 v[184:187], a[108:111], v[220:223], v[184:187]
s_nop 2
v_mfma_f32_16x16x32_bf16 v[188:191], a[124:127], v[220:223], 0
s_nop 2
v_mfma_f32_16x16x32_bf16 v[188:191], a[120:123], v[216:219], v[188:191]
v_cvt_pk_bf16_f32 v37, v186, v187
v_cvt_pk_bf16_f32 v36, v184, v185
v_mfma_f32_16x16x32_bf16 v[188:191], a[116:119], v[196:199], v[188:191]
ds_read_b128 v[196:199], v236 offset:21632
v_mfma_f32_16x16x32_bf16 v[188:191], a[112:115], v[200:203], v[188:191]
s_nop 7
v_cvt_pk_bf16_f32 v39, v190, v191
v_cvt_pk_bf16_f32 v38, v188, v189
s_nop 7
s_waitcnt lgkmcnt(0)
s_branch L_entrys
.p2align 6
L_loops:
s_waitcnt vmcnt(8)
s_barrier
v_mfma_f32_16x16x32_bf16 v[176:179], a[224:227], v[220:223], 0
s_add_u32 s52, s47, 8192
v_exp_f32 v187, v187
v_mfma_f32_16x16x32_bf16 v[176:179], a[228:231], v[224:227], v[176:179]
s_add_u32 s53, s47, 12288
v_add_f32 v248, v184, v185
v_add_f32 v248, v248, v186
v_mfma_f32_16x16x32_bf16 v[176:179], a[232:235], v[212:215], v[176:179]
s_mov_b32 s47, s46
v_add_f32 v248, v248, v187
v_cvt_pk_bf16_f32 v120, v184, v185
v_mfma_f32_16x16x32_bf16 v[176:179], a[236:239], v[216:219], v[176:179]
s_bfe_i32 s57, s3, 0x10000
v_cvt_pk_bf16_f32 v121, v186, v187
v_sub_f32 v193, v193, v254
v_mfma_f32_16x16x32_bf16 v[180:183], a[252:255], v[216:219], 0
s_and_b32 s54, s57, s5
v_exp_f32 v188, v188
v_mfma_f32_16x16x32_bf16 v[180:183], a[248:251], v[212:215], v[180:183]
s_sub_u32 s45, s45, 1
v_exp_f32 v190, v190
v_mfma_f32_16x16x32_bf16 v[180:183], a[244:247], v[224:227], v[180:183]
s_lshr_b32 s3, s3, 1
v_sub_f32 v194, v194, v254
v_add_f32 v248, v248, v188
v_mfma_f32_16x16x32_bf16 v[180:183], a[240:243], v[220:223], v[180:183]
v_exp_f32 v189, v189
v_mfma_f32_16x16x32_bf16 v[212:215], v[0:3], v[112:115], 0
v_add_f32 v248, v248, v189
v_sub_f32 v191, v191, v254
v_mfma_f32_16x16x32_bf16 v[212:215], v[4:7], v[116:119], v[212:215]
v_exp_f32 v191, v191
v_mfma_f32_16x16x32_bf16 v[216:219], v[12:15], v[116:119], 0
v_sub_f32 v195, v195, v254
v_sub_f32 v192, v192, v254
v_mfma_f32_16x16x32_bf16 v[216:219], v[8:11], v[112:115], v[216:219]
v_exp_f32 v192, v192
v_mfma_f32_16x16x32_bf16 v[220:223], v[16:19], v[112:115], 0
v_exp_f32 v194, v194
v_mfma_f32_16x16x32_bf16 v[220:223], v[20:23], v[116:119], v[220:223]
v_exp_f32 v193, v193
v_mfma_f32_16x16x32_bf16 v[224:227], v[28:31], v[116:119], 0
v_add_f32 v248, v248, v190
v_add_f32 v248, v248, v191
v_mfma_f32_16x16x32_bf16 v[224:227], v[24:27], v[112:115], v[224:227]
v_exp_f32 v195, v195
v_mfma_f32_16x16x32_bf16 v[228:231], v[32:35], v[112:115], 0
v_add_f32 v248, v248, v192
v_add_f32 v248, v248, v193
v_mfma_f32_16x16x32_bf16 v[228:231], v[36:39], v[116:119], v[228:231]
v_add_f32 v248, v248, v194
v_add_f32 v248, v248, v195
v_mfma_f32_16x16x32_bf16 v[232:235], v[44:47], v[116:119], 0
v_cvt_pk_bf16_f32 v123, v190, v191
v_cvt_pk_bf16_f32 v122, v188, v189
v_mfma_f32_16x16x32_bf16 v[232:235], v[40:43], v[112:115], v[232:235]
s_mov_b32 s48, s50
ds_read_b128 v[188:191], v236 offset:0
v_cvt_pk_bf16_f32 v125, v194, v195
v_mfma_f32_16x16x32_bf16 v[184:187], v[48:51], v[112:115], 0
s_add_u32 m0, s49, 0
ds_read_b128 v[48:51], v240 offset:0
v_cvt_pk_bf16_f32 v124, v192, v193
v_mfma_f32_16x16x32_bf16 v[184:187], v[52:55], v[116:119], v[184:187]
s_add_u32 s50, s50, 13107200
buffer_load_dwordx4 v237, s[16:19], s48 offen nt lds
v_sub_f32 v196, v196, v254
v_sub_f32 v197, v197, v254
v_sub_f32 v199, v199, v254
v_sub_f32 v198, v198, v254
v_exp_f32 v196, v196
v_exp_f32 v197, v197
v_add_f32 v248, v248, v196
v_add_f32 v248, v248, v197
v_exp_f32 v198, v198
s_waitcnt lgkmcnt(1)
v_mfma_f32_16x16x32_bf16 v[192:195], a[64:67], v[188:191], 0
s_sub_u32 s50, s50, s54
ds_read_b128 v[52:55], v240 offset:64
v_exp_f32 v199, v199
v_add_f32 v248, v248, v198
v_add_f32 v248, v248, v199
v_cvt_pk_bf16_f32 v126, v196, v197
v_cvt_pk_bf16_f32 v127, v198, v199
ds_read_b128 v[196:199], v236 offset:256
v_sub_f32 v200, v200, v254
v_sub_f32 v203, v203, v254
v_sub_f32 v201, v201, v254
v_exp_f32 v201, v201
v_sub_f32 v202, v202, v254
v_exp_f32 v202, v202
v_exp_f32 v200, v200
v_exp_f32 v203, v203
v_add_f32 v248, v248, v200
v_add_f32 v248, v248, v201
v_add_f32 v248, v248, v202
v_add_f32 v248, v248, v203
v_cvt_pk_bf16_f32 v128, v200, v201
v_cvt_pk_bf16_f32 v129, v202, v203
v_sub_f32 v204, v204, v254
v_sub_f32 v205, v205, v254
s_waitcnt lgkmcnt(0)
v_mfma_f32_16x16x32_bf16 v[192:195], a[68:71], v[196:199], v[192:195]
ds_read_b128 v[200:203], v236 offset:512
v_exp_f32 v204, v204
v_sub_f32 v206, v206, v254
v_add_f32 v248, v248, v204
v_exp_f32 v206, v206
v_sub_f32 v207, v207, v254
v_exp_f32 v205, v205
v_exp_f32 v207, v207
v_add_f32 v248, v248, v205
v_cvt_pk_bf16_f32 v130, v204, v205
v_add_f32 v248, v248, v206
v_add_f32 v248, v248, v207
v_cvt_pk_bf16_f32 v131, v206, v207
v_sub_f32 v208, v208, v254
v_exp_f32 v208, v208
v_max3_f32 v254, v212, v213, v214
s_waitcnt lgkmcnt(0)
v_mfma_f32_16x16x32_bf16 v[192:195], a[72:75], v[200:203], v[192:195]
ds_read_b128 v[204:207], v236 offset:768
v_add_f32 v248, v248, v208
v_cvt_pk_bf16_f32 v132, v208, 0
v_max3_f32 v254, v254, v215, v216
v_max3_f32 v254, v254, v217, v218
v_max3_f32 v254, v254, v219, v220
v_max3_f32 v254, v254, v221, v222
v_max3_f32 v254, v254, v223, v224
v_max3_f32 v254, v254, v225, v226
v_max3_f32 v254, v254, v227, v228
v_max3_f32 v254, v254, v229, v230
v_max3_f32 v254, v254, v231, v232
v_max3_f32 v254, v254, v233, v234
v_max3_f32 v254, v254, v235, v184
v_add_u32 v240, 0x200, v240
ds_swizzle_b32 v250, v248 offset:0x401F
ds_swizzle_b32 v255, v254 offset:0x401F
s_waitcnt lgkmcnt(2)
v_mfma_f32_16x16x32_bf16 v[192:195], a[76:79], v[204:207], v[192:195]
s_nop 2
v_mfma_f32_16x16x32_bf16 v[208:211], a[92:95], v[204:207], 0
s_nop 2
v_mfma_f32_16x16x32_bf16 v[208:211], a[88:91], v[200:203], v[208:211]
v_cvt_pk_bf16_f32 v0, v192, v193
v_cvt_pk_bf16_f32 v1, v194, v195
v_mfma_f32_16x16x32_bf16 v[208:211], a[84:87], v[196:199], v[208:211]
v_mfma_f32_16x16x32_bf16 v[208:211], a[80:83], v[188:191], v[208:211]
s_waitcnt lgkmcnt(0)
v_add_f32 v248, v248, v250
v_max_f32 v254, v254, v255
v_mfma_f32_16x16x32_bf16 v[192:195], a[96:99], v[188:191], 0
ds_bpermute_b32 v250, v247, v248
v_mfma_f32_16x16x32_bf16 v[192:195], a[100:103], v[196:199], v[192:195]
ds_bpermute_b32 v255, v247, v254
v_mfma_f32_16x16x32_bf16 v[192:195], a[104:107], v[200:203], v[192:195]
v_cvt_pk_bf16_f32 v2, v208, v209
v_cvt_pk_bf16_f32 v3, v210, v211
v_mfma_f32_16x16x32_bf16 v[192:195], a[108:111], v[204:207], v[192:195]
s_nop 2
v_mfma_f32_16x16x32_bf16 v[208:211], a[124:127], v[204:207], 0
s_nop 2
v_mfma_f32_16x16x32_bf16 v[208:211], a[120:123], v[200:203], v[208:211]
v_cvt_pk_bf16_f32 v5, v194, v195
v_cvt_pk_bf16_f32 v4, v192, v193
v_mfma_f32_16x16x32_bf16 v[208:211], a[116:119], v[196:199], v[208:211]
s_waitcnt lgkmcnt(1)
v_add_f32 v248, v248, v250
v_mfma_f32_16x16x32_bf16 v[208:211], a[112:115], v[188:191], v[208:211]
s_waitcnt lgkmcnt(0)
v_rcp_f32 v251, v248
v_mfma_f32_16x16x32_bf16 v[188:191], v[56:59], v[120:123], 0
v_max_f32 v254, v254, v255
v_sub_f32 v214, v214, v254
v_mfma_f32_16x16x32_bf16 v[188:191], v[104:107], v[132:135], v[188:191]
s_add_u32 s48, s48, s51
v_sub_f32 v215, v215, v254
v_cvt_pk_bf16_f32 v6, v208, v209
v_mfma_f32_16x16x32_bf16 v[188:191], v[72:75], v[124:127], v[188:191]
s_add_u32 m0, s49, 2112
v_cvt_pk_bf16_f32 v7, v210, v211
v_sub_f32 v212, v212, v254
v_mfma_f32_16x16x32_bf16 v[188:191], v[88:91], v[128:131], v[188:191]
buffer_load_dwordx4 v237, s[16:19], s48 offen nt lds
v_sub_f32 v213, v213, v254
v_mfma_f32_16x16x32_bf16 v[196:199], v[92:95], v[128:131], 0
v_exp_f32 v212, v212
v_mfma_f32_16x16x32_bf16 v[196:199], v[76:79], v[124:127], v[196:199]
v_exp_f32 v214, v214
v_mfma_f32_16x16x32_bf16 v[196:199], v[106:109], v[132:135], v[196:199]
v_exp_f32 v213, v213
v_mfma_f32_16x16x32_bf16 v[196:199], v[60:63], v[120:123], v[196:199]
ds_read_b128 v[204:207], v236 offset:4480
v_sub_f32 v216, v216, v254
v_mfma_f32_16x16x32_bf16 v[200:203], v[64:67], v[120:123], 0
ds_read_b128 v[192:195], v236 offset:4224
v_sub_f32 v217, v217, v254
v_mfma_f32_16x16x32_bf16 v[200:203], v[108:111], v[132:135], v[200:203]
v_exp_f32 v215, v215
v_mfma_f32_16x16x32_bf16 v[200:203], v[80:83], v[124:127], v[200:203]
v_exp_f32 v217, v217
v_mfma_f32_16x16x32_bf16 v[200:203], v[96:99], v[128:131], v[200:203]
v_sub_f32 v218, v218, v254
v_add_f32 v249, v212, v213
v_mfma_f32_16x16x32_bf16 v[208:211], v[100:103], v[128:131], 0
v_add_f32 v249, v249, v214
v_add_f32 v249, v249, v215
v_mfma_f32_16x16x32_bf16 v[208:211], v[84:87], v[124:127], v[208:211]
s_waitcnt lgkmcnt(1)
v_exp_f32 v216, v216
v_mfma_f32_16x16x32_bf16 v[208:211], v[110:113], v[132:135], v[208:211]
s_waitcnt lgkmcnt(0)
v_sub_f32 v219, v219, v254
v_sub_f32 v220, v220, v254
v_mfma_f32_16x16x32_bf16 v[208:211], v[68:71], v[120:123], v[208:211]
v_exp_f32 v218, v218
v_sub_f32 v223, v223, v254
v_add_f32 v249, v249, v216
v_add_f32 v249, v249, v217
v_exp_f32 v219, v219
v_add_f32 v249, v249, v218
v_add_f32 v249, v249, v219
v_exp_f32 v220, v220
v_sub_f32 v224, v224, v254
v_exp_f32 v223, v223
v_sub_f32 v221, v221, v254
v_exp_f32 v224, v224
v_exp_f32 v221, v221
v_sub_f32 v222, v222, v254
v_sub_f32 v225, v225, v254
v_add_f32 v249, v249, v220
v_add_f32 v249, v249, v221
v_exp_f32 v222, v222
v_exp_f32 v225, v225
v_add_f32 v249, v249, v222
v_add_f32 v249, v249, v223
v_add_f32 v249, v249, v224
v_sub_f32 v226, v226, v254
v_add_f32 v249, v249, v225
v_exp_f32 v226, v226
v_sub_f32 v227, v227, v254
v_exp_f32 v227, v227
v_sub_f32 v228, v228, v254
v_exp_f32 v228, v228
v_add_f32 v249, v249, v226
v_sub_f32 v232, v232, v254
v_sub_f32 v229, v229, v254
v_sub_f32 v230, v230, v254
v_exp_f32 v230, v230
v_exp_f32 v229, v229
v_add_f32 v249, v249, v227
v_add_f32 v249, v249, v228
v_add_f32 v249, v249, v229
v_exp_f32 v232, v232
v_sub_f32 v233, v233, v254
v_exp_f32 v233, v233
v_sub_f32 v231, v231, v254
v_exp_f32 v231, v231
v_sub_f32 v234, v234, v254
v_sub_f32 v235, v235, v254
v_add_f32 v249, v249, v230
v_add_f32 v249, v249, v231
v_add_f32 v249, v249, v232
v_exp_f32 v234, v234
v_exp_f32 v235, v235
v_sub_f32 v184, v184, v254
v_exp_f32 v184, v184
v_add_f32 v249, v249, v233
v_cvt_pk_bf16_f32 v148, v184, 0
v_add_f32 v249, v249, v234
v_add_f32 v249, v249, v235
v_add_f32 v249, v249, v184
v_fmac_f32 v161, v201, v251
v_fmac_f32 v163, v203, v251
v_fmac_f32 v160, v200, v251
v_fmac_f32 v162, v202, v251
ds_read_b128 v[184:187], v236 offset:4992
v_cvt_pk_bf16_f32 v138, v216, v217
v_cvt_pk_bf16_f32 v139, v218, v219
v_fmac_f32 v167, v211, v251
v_fmac_f32 v165, v209, v251
v_fmac_f32 v166, v210, v251
v_fmac_f32 v164, v208, v251
v_cvt_pk_bf16_f32 v140, v220, v221
v_cvt_pk_bf16_f32 v141, v222, v223
v_fmac_f32 v155, v191, v251
v_fmac_f32 v154, v190, v251
v_fmac_f32 v152, v188, v251
v_fmac_f32 v153, v189, v251
v_cvt_pk_bf16_f32 v137, v214, v215
v_cvt_pk_bf16_f32 v136, v212, v213
v_cvt_pk_bf16_f32 v143, v226, v227
v_cvt_pk_bf16_f32 v142, v224, v225
v_cvt_pk_bf16_f32 v145, v230, v231
v_cvt_pk_bf16_f32 v144, v228, v229
v_fmac_f32 v156, v196, v251
v_fmac_f32 v157, v197, v251
s_waitcnt lgkmcnt(0)
v_mfma_f32_16x16x32_bf16 v[200:203], a[124:127], v[184:187], 0
ds_read_b128 v[216:219], v236 offset:4736
v_fmac_f32 v158, v198, v251
v_fmac_f32 v159, v199, v251
v_cvt_pk_bf16_f32 v147, v234, v235
v_cvt_pk_bf16_f32 v146, v232, v233
v_cvt_pk_bf16_f32 v160, v160, v161
v_cvt_pk_bf16_f32 v161, v162, v163
v_cvt_pk_bf16_f32 v163, v166, v167
v_cvt_pk_bf16_f32 v162, v164, v165
v_cvt_pk_bf16_f32 v152, v152, v153
v_cvt_pk_bf16_f32 v153, v154, v155
v_pk_max_i16 v160, v160, 0
v_pk_max_i16 v162, v162, 0
v_pk_max_i16 v153, v153, 0
v_pk_max_i16 v161, v161, 0
v_pk_max_i16 v163, v163, 0
v_cvt_pk_bf16_f32 v155, v158, v159
v_pk_max_i16 v155, v155, 0
v_pk_max_i16 v152, v152, 0
v_cvt_pk_bf16_f32 v154, v156, v157
v_pk_max_i16 v154, v154, 0
s_waitcnt lgkmcnt(0)
v_mfma_f32_16x16x32_bf16 v[200:203], a[120:123], v[216:219], v[200:203]
ds_swizzle_b32 v250, v249 offset:0x401F
buffer_store_dwordx4 v[152:155], v239, s[20:23], s52 offen offset:0 nt
buffer_store_dwordx4 v[160:163], v239, s[20:23], s52 offen offset:64 nt
s_add_u32 s52, s46, 20480
v_mfma_f32_16x16x32_bf16 v[200:203], a[116:119], v[204:207], v[200:203]
v_mfma_f32_16x16x32_bf16 v[200:203], a[112:115], v[192:195], v[200:203]
s_nop 2
v_mfma_f32_16x16x32_bf16 v[208:211], a[96:99], v[192:195], 0
s_waitcnt lgkmcnt(0)
v_add_f32 v249, v249, v250
v_mfma_f32_16x16x32_bf16 v[208:211], a[100:103], v[204:207], v[208:211]
s_add_u32 m0, s49, 4224
ds_bpermute_b32 v250, v247, v249
v_mfma_f32_16x16x32_bf16 v[208:211], a[104:107], v[216:219], v[208:211]
s_add_u32 s48, s48, s51
buffer_load_dwordx4 v237, s[16:19], s48 offen nt lds
v_cvt_pk_bf16_f32 v14, v200, v201
v_mfma_f32_16x16x32_bf16 v[208:211], a[108:111], v[184:187], v[208:211]
ds_read_b128 v[212:215], v236 offset:8448
v_cvt_pk_bf16_f32 v15, v202, v203
v_mfma_f32_16x16x32_bf16 v[220:223], a[92:95], v[184:187], 0
ds_read_b128 v[200:203], v236 offset:8704
ds_read_b128 v[224:227], v236 offset:8960
v_mfma_f32_16x16x32_bf16 v[220:223], a[88:91], v[216:219], v[220:223]
ds_read_b128 v[228:231], v236 offset:9216
v_mfma_f32_16x16x32_bf16 v[220:223], a[84:87], v[204:207], v[220:223]
v_cvt_pk_bf16_f32 v13, v210, v211
v_cvt_pk_bf16_f32 v12, v208, v209
v_mfma_f32_16x16x32_bf16 v[220:223], a[80:83], v[192:195], v[220:223]
s_waitcnt lgkmcnt(4)
v_add_f32 v249, v249, v250
s_nop 0
v_mfma_f32_16x16x32_bf16 v[188:191], a[64:67], v[192:195], 0
v_rcp_f32 v252, v249
v_mfma_f32_16x16x32_bf16 v[188:191], a[72:75], v[216:219], v[188:191]
s_waitcnt lgkmcnt(3)
s_nop 0
v_cvt_pk_bf16_f32 v10, v220, v221
v_mfma_f32_16x16x32_bf16 v[188:191], a[76:79], v[184:187], v[188:191]
s_waitcnt lgkmcnt(1)
v_cvt_pk_bf16_f32 v11, v222, v223
v_mfma_f32_16x16x32_bf16 v[188:191], a[68:71], v[204:207], v[188:191]
s_waitcnt lgkmcnt(0)
s_nop 1
v_mfma_f32_16x16x32_bf16 v[184:187], a[68:71], v[200:203], 0
s_nop 2
v_mfma_f32_16x16x32_bf16 v[184:187], a[64:67], v[212:215], v[184:187]
v_cvt_pk_bf16_f32 v9, v190, v191
v_cvt_pk_bf16_f32 v8, v188, v189
v_mfma_f32_16x16x32_bf16 v[184:187], a[72:75], v[224:227], v[184:187]
v_mfma_f32_16x16x32_bf16 v[184:187], a[76:79], v[228:231], v[184:187]
s_nop 2
v_mfma_f32_16x16x32_bf16 v[188:191], a[92:95], v[228:231], 0
s_nop 2
v_mfma_f32_16x16x32_bf16 v[188:191], a[88:91], v[224:227], v[188:191]
v_cvt_pk_bf16_f32 v16, v184, v185
v_cvt_pk_bf16_f32 v17, v186, v187
v_mfma_f32_16x16x32_bf16 v[188:191], a[84:87], v[200:203], v[188:191]
v_mfma_f32_16x16x32_bf16 v[188:191], a[80:83], v[212:215], v[188:191]
ds_read_b128 v[184:187], v236 offset:13184
ds_read_b128 v[192:195], v236 offset:13440
v_mfma_f32_16x16x32_bf16 v[196:199], a[96:99], v[212:215], 0
ds_read_b128 v[204:207], v236 offset:12928
ds_read_b128 v[208:211], v236 offset:12672
v_mfma_f32_16x16x32_bf16 v[196:199], a[100:103], v[200:203], v[196:199]
s_add_u32 m0, s49, 6336
s_add_u32 s48, s48, s51
v_cvt_pk_bf16_f32 v18, v188, v189
v_mfma_f32_16x16x32_bf16 v[196:199], a[104:107], v[224:227], v[196:199]
buffer_load_dwordx4 v237, s[16:19], s48 offen nt lds
v_cvt_pk_bf16_f32 v19, v190, v191
v_mfma_f32_16x16x32_bf16 v[196:199], a[108:111], v[228:231], v[196:199]
s_nop 2
v_mfma_f32_16x16x32_bf16 v[188:191], a[124:127], v[228:231], 0
s_nop 2
v_mfma_f32_16x16x32_bf16 v[188:191], a[116:119], v[200:203], v[188:191]
s_waitcnt lgkmcnt(2)
v_cvt_pk_bf16_f32 v21, v198, v199
v_cvt_pk_bf16_f32 v20, v196, v197
v_mfma_f32_16x16x32_bf16 v[188:191], a[112:115], v[212:215], v[188:191]
s_waitcnt lgkmcnt(0)
v_mfma_f32_16x16x32_bf16 v[188:191], a[120:123], v[224:227], v[188:191]
s_nop 2
v_mfma_f32_16x16x32_bf16 v[196:199], a[120:123], v[184:187], 0
s_nop 2
v_mfma_f32_16x16x32_bf16 v[196:199], a[124:127], v[192:195], v[196:199]
v_cvt_pk_bf16_f32 v23, v190, v191
v_cvt_pk_bf16_f32 v22, v188, v189
v_mfma_f32_16x16x32_bf16 v[196:199], a[116:119], v[204:207], v[196:199]
v_mfma_f32_16x16x32_bf16 v[196:199], a[112:115], v[208:211], v[196:199]
s_nop 2
v_mfma_f32_16x16x32_bf16 v[188:191], a[96:99], v[208:211], 0
s_nop 2
v_mfma_f32_16x16x32_bf16 v[188:191], a[100:103], v[204:207], v[188:191]
v_cvt_pk_bf16_f32 v30, v196, v197
v_cvt_pk_bf16_f32 v31, v198, v199
v_mfma_f32_16x16x32_bf16 v[188:191], a[104:107], v[184:187], v[188:191]
v_mfma_f32_16x16x32_bf16 v[188:191], a[108:111], v[192:195], v[188:191]
ds_read_b128 v[196:199], v236 offset:17152
ds_read_b128 v[200:203], v236 offset:16896
v_mfma_f32_16x16x32_bf16 v[212:215], a[92:95], v[192:195], 0
ds_read_b128 v[216:219], v236 offset:17408
ds_read_b128 v[220:223], v236 offset:17664
v_mfma_f32_16x16x32_bf16 v[212:215], a[88:91], v[184:187], v[212:215]
s_nop 1
v_cvt_pk_bf16_f32 v29, v190, v191
v_mfma_f32_16x16x32_bf16 v[212:215], a[84:87], v[204:207], v[212:215]
v_cvt_pk_bf16_f32 v28, v188, v189
v_mfma_f32_16x16x32_bf16 v[212:215], a[80:83], v[208:211], v[212:215]
s_nop 2
v_mfma_f32_16x16x32_bf16 v[188:191], a[64:67], v[208:211], 0
s_nop 2
v_mfma_f32_16x16x32_bf16 v[188:191], a[72:75], v[184:187], v[188:191]
s_add_u32 m0, s49, 8448
v_cvt_pk_bf16_f32 v27, v214, v215
v_cvt_pk_bf16_f32 v26, v212, v213
v_mfma_f32_16x16x32_bf16 v[188:191], a[76:79], v[192:195], v[188:191]
s_add_u32 s48, s48, s51
buffer_load_dwordx4 v237, s[16:19], s48 offen nt lds
v_mfma_f32_16x16x32_bf16 v[188:191], a[68:71], v[204:207], v[188:191]
s_waitcnt lgkmcnt(0)
s_nop 1
v_mfma_f32_16x16x32_bf16 v[184:187], a[68:71], v[196:199], 0
s_nop 2
v_mfma_f32_16x16x32_bf16 v[184:187], a[64:67], v[200:203], v[184:187]
v_cvt_pk_bf16_f32 v24, v188, v189
v_cvt_pk_bf16_f32 v25, v190, v191
v_mfma_f32_16x16x32_bf16 v[184:187], a[72:75], v[216:219], v[184:187]
v_mfma_f32_16x16x32_bf16 v[184:187], a[76:79], v[220:223], v[184:187]
s_nop 2
v_mfma_f32_16x16x32_bf16 v[188:191], a[92:95], v[220:223], 0
s_nop 2
v_mfma_f32_16x16x32_bf16 v[188:191], a[88:91], v[216:219], v[188:191]
v_cvt_pk_bf16_f32 v32, v184, v185
v_cvt_pk_bf16_f32 v33, v186, v187
v_mfma_f32_16x16x32_bf16 v[188:191], a[84:87], v[196:199], v[188:191]
v_mfma_f32_16x16x32_bf16 v[188:191], a[80:83], v[200:203], v[188:191]
s_nop 2
v_mfma_f32_16x16x32_bf16 v[184:187], a[96:99], v[200:203], 0
s_nop 2
v_mfma_f32_16x16x32_bf16 v[184:187], a[100:103], v[196:199], v[184:187]
v_cvt_pk_bf16_f32 v35, v190, v191
v_cvt_pk_bf16_f32 v34, v188, v189
v_mfma_f32_16x16x32_bf16 v[184:187], a[104:107], v[216:219], v[184:187]
v_mfma_f32_16x16x32_bf16 v[184:187], a[108:111], v[220:223], v[184:187]
s_nop 2
v_mfma_f32_16x16x32_bf16 v[188:191], a[124:127], v[220:223], 0
s_nop 2
v_mfma_f32_16x16x32_bf16 v[188:191], a[120:123], v[216:219], v[188:191]
v_cvt_pk_bf16_f32 v37, v186, v187
v_cvt_pk_bf16_f32 v36, v184, v185
v_mfma_f32_16x16x32_bf16 v[188:191], a[116:119], v[196:199], v[188:191]
v_mfma_f32_16x16x32_bf16 v[188:191], a[112:115], v[200:203], v[188:191]
s_nop 2
v_mfma_f32_16x16x32_bf16 v[184:187], v[56:59], v[136:139], 0
s_nop 2
v_mfma_f32_16x16x32_bf16 v[184:187], v[104:107], v[148:151], v[184:187]
s_add_u32 m0, s49, 10560
ds_read_u16 v104, v241 offset:0
v_cvt_pk_bf16_f32 v39, v190, v191
v_mfma_f32_16x16x32_bf16 v[184:187], v[72:75], v[140:143], v[184:187]
s_add_u32 s48, s48, s51
buffer_load_dwordx4 v237, s[16:19], s48 offen nt lds
v_cvt_pk_bf16_f32 v38, v188, v189
v_mfma_f32_16x16x32_bf16 v[184:187], v[88:91], v[144:147], v[184:187]
s_nop 2
v_mfma_f32_16x16x32_bf16 v[188:191], v[92:95], v[144:147], 0
s_nop 2
v_mfma_f32_16x16x32_bf16 v[188:191], v[76:79], v[140:143], v[188:191]
v_fmac_f32 v170, v186, v252
v_fmac_f32 v168, v184, v252
v_mfma_f32_16x16x32_bf16 v[188:191], v[106:109], v[148:151], v[188:191]
ds_read_u16 v106, v241 offset:128
v_fmac_f32 v171, v187, v252
v_mfma_f32_16x16x32_bf16 v[188:191], v[60:63], v[136:139], v[188:191]
s_waitcnt lgkmcnt(1)
ds_read_b128 v[192:195], v236 offset:21888
v_fmac_f32 v169, v185, v252
v_mfma_f32_16x16x32_bf16 v[200:203], v[64:67], v[136:139], 0
ds_read_b128 v[196:199], v236 offset:21632
ds_read_b128 v[204:207], v236 offset:21376
v_mfma_f32_16x16x32_bf16 v[200:203], v[108:111], v[148:151], v[200:203]
ds_read_b128 v[208:211], v236 offset:21120
v_fmac_f32 v174, v190, v252
v_mfma_f32_16x16x32_bf16 v[200:203], v[80:83], v[140:143], v[200:203]
ds_read_u16 v108, v241 offset:256
v_fmac_f32 v175, v191, v252
v_mfma_f32_16x16x32_bf16 v[200:203], v[96:99], v[144:147], v[200:203]
v_fmac_f32 v172, v188, v252
v_fmac_f32 v173, v189, v252
v_mfma_f32_16x16x32_bf16 v[184:187], v[100:103], v[144:147], 0
s_waitcnt lgkmcnt(5)
v_cvt_pk_bf16_f32 v168, v168, v169
v_cvt_pk_bf16_f32 v169, v170, v171
v_mfma_f32_16x16x32_bf16 v[184:187], v[84:87], v[140:143], v[184:187]
s_waitcnt lgkmcnt(4)
v_fmac_f32 v178, v202, v252
v_fmac_f32 v176, v200, v252
v_mfma_f32_16x16x32_bf16 v[184:187], v[110:113], v[148:151], v[184:187]
s_waitcnt lgkmcnt(2)
ds_read_u16 v110, v241 offset:384
v_fmac_f32 v177, v201, v252
v_mfma_f32_16x16x32_bf16 v[184:187], v[68:71], v[136:139], v[184:187]
L_entrys:
s_waitcnt lgkmcnt(2)
v_fmac_f32 v179, v203, v252
v_cvt_pk_bf16_f32 v176, v176, v177
v_mfma_f32_16x16x32_bf16 v[188:191], a[124:127], v[192:195], 0
s_waitcnt lgkmcnt(1)
v_cvt_pk_bf16_f32 v177, v178, v179
v_cvt_pk_bf16_f32 v171, v174, v175
v_mfma_f32_16x16x32_bf16 v[188:191], a[120:123], v[196:199], v[188:191]
v_fmac_f32 v180, v184, v252
v_fmac_f32 v181, v185, v252
v_mfma_f32_16x16x32_bf16 v[188:191], a[116:119], v[204:207], v[188:191]
v_fmac_f32 v183, v187, v252
v_fmac_f32 v182, v186, v252
v_mfma_f32_16x16x32_bf16 v[188:191], a[112:115], v[208:211], v[188:191]
v_cvt_pk_bf16_f32 v178, v180, v181
v_cvt_pk_bf16_f32 v170, v172, v173
v_mfma_f32_16x16x32_bf16 v[184:187], a[96:99], v[208:211], 0
s_waitcnt lgkmcnt(0)
v_cvt_pk_bf16_f32 v179, v182, v183
v_pk_max_i16 v168, v168, 0
v_mfma_f32_16x16x32_bf16 v[184:187], a[100:103], v[204:207], v[184:187]
s_add_u32 s48, s48, s51
v_cvt_pk_bf16_f32 v46, v188, v189
v_cvt_pk_bf16_f32 v47, v190, v191
v_mfma_f32_16x16x32_bf16 v[184:187], a[104:107], v[196:199], v[184:187]
s_add_u32 m0, s49, 12672
v_pk_max_i16 v176, v176, 0
v_pk_max_i16 v170, v170, 0
v_mfma_f32_16x16x32_bf16 v[184:187], a[108:111], v[192:195], v[184:187]
buffer_load_dwordx4 v237, s[16:19], s48 offen nt lds
v_pk_max_i16 v179, v179, 0
v_mfma_f32_16x16x32_bf16 v[188:191], a[92:95], v[192:195], 0
v_pk_max_i16 v178, v178, 0
v_pk_max_i16 v169, v169, 0
v_mfma_f32_16x16x32_bf16 v[188:191], a[88:91], v[196:199], v[188:191]
v_pk_max_i16 v177, v177, 0
v_pk_max_i16 v171, v171, 0
v_mfma_f32_16x16x32_bf16 v[188:191], a[84:87], v[204:207], v[188:191]
buffer_store_dwordx4 v[168:171], v239, s[20:23], s53 offen offset:0 nt
buffer_store_dwordx4 v[176:179], v239, s[20:23], s53 offen offset:64 nt
v_cvt_pk_bf16_f32 v44, v184, v185
v_cvt_pk_bf16_f32 v45, v186, v187
v_add_u32 v241, 0x200, v241
s_add_u32 s53, s46, 0
v_mfma_f32_16x16x32_bf16 v[188:191], a[80:83], v[208:211], v[188:191]
s_nop 2
v_mfma_f32_16x16x32_bf16 v[184:187], a[64:67], v[208:211], 0
s_nop 2
v_mfma_f32_16x16x32_bf16 v[184:187], a[72:75], v[196:199], v[184:187]
v_cvt_pk_bf16_f32 v42, v188, v189
v_cvt_pk_bf16_f32 v43, v190, v191
v_mfma_f32_16x16x32_bf16 v[184:187], a[76:79], v[192:195], v[184:187]
v_mfma_f32_16x16x32_bf16 v[184:187], a[68:71], v[204:207], v[184:187]
s_nop 2
v_mfma_f32_16x16x32_bf16 v[188:191], a[4:7], v[204:207], 0
s_nop 2
v_mfma_f32_16x16x32_bf16 v[188:191], a[0:3], v[208:211], v[188:191]
v_cvt_pk_bf16_f32 v41, v186, v187
v_cvt_pk_bf16_f32 v40, v184, v185
v_mfma_f32_16x16x32_bf16 v[188:191], a[8:11], v[196:199], v[188:191]
v_mfma_f32_16x16x32_bf16 v[188:191], a[12:15], v[192:195], v[188:191]
s_nop 2
v_mfma_f32_16x16x32_bf16 v[184:187], a[28:31], v[192:195], 0
s_nop 2
v_mfma_f32_16x16x32_bf16 v[184:187], a[24:27], v[196:199], v[184:187]
v_cvt_pk_bf16_f32 v112, v188, v189
v_cvt_pk_bf16_f32 v113, v190, v191
v_mfma_f32_16x16x32_bf16 v[184:187], a[20:23], v[204:207], v[184:187]
v_mfma_f32_16x16x32_bf16 v[184:187], a[16:19], v[208:211], v[184:187]
s_nop 2
v_mfma_f32_16x16x32_bf16 v[188:191], a[32:35], v[208:211], 0
s_nop 2
v_mfma_f32_16x16x32_bf16 v[188:191], a[36:39], v[204:207], v[188:191]
s_add_u32 m0, s49, 14784
v_cvt_pk_bf16_f32 v114, v184, v185
v_cvt_pk_bf16_f32 v115, v186, v187
v_mfma_f32_16x16x32_bf16 v[188:191], a[40:43], v[196:199], v[188:191]
s_add_u32 s48, s48, s51
buffer_load_dwordx4 v237, s[16:19], s48 offen nt lds
v_mfma_f32_16x16x32_bf16 v[188:191], a[44:47], v[192:195], v[188:191]
s_nop 2
v_mfma_f32_16x16x32_bf16 v[184:187], a[60:63], v[192:195], 0
s_nop 2
v_mfma_f32_16x16x32_bf16 v[184:187], a[56:59], v[196:199], v[184:187]
v_cvt_pk_bf16_f32 v116, v188, v189
v_cvt_pk_bf16_f32 v117, v190, v191
v_mfma_f32_16x16x32_bf16 v[184:187], a[52:55], v[204:207], v[184:187]
v_mfma_f32_16x16x32_bf16 v[184:187], a[48:51], v[208:211], v[184:187]
s_nop 2
v_mfma_f32_16x16x32_bf16 v[152:155], a[192:195], v[208:211], 0
s_nop 2
v_mfma_f32_16x16x32_bf16 v[152:155], a[196:199], v[204:207], v[152:155]
v_cvt_pk_bf16_f32 v118, v184, v185
v_cvt_pk_bf16_f32 v119, v186, v187
v_mfma_f32_16x16x32_bf16 v[152:155], a[200:203], v[196:199], v[152:155]
v_mfma_f32_16x16x32_bf16 v[152:155], a[204:207], v[192:195], v[152:155]
v_mfma_f32_16x16x32_bf16 v[156:159], a[220:223], v[192:195], 0
v_mfma_f32_16x16x32_bf16 v[156:159], a[216:219], v[196:199], v[156:159]
v_mfma_f32_16x16x32_bf16 v[156:159], a[212:215], v[204:207], v[156:159]
v_mfma_f32_16x16x32_bf16 v[156:159], a[208:211], v[208:211], v[156:159]
v_mfma_f32_16x16x32_bf16 v[160:163], a[224:227], v[208:211], 0
v_mfma_f32_16x16x32_bf16 v[160:163], a[228:231], v[204:207], v[160:163]
v_mfma_f32_16x16x32_bf16 v[160:163], a[232:235], v[196:199], v[160:163]
v_mfma_f32_16x16x32_bf16 v[160:163], a[236:239], v[192:195], v[160:163]
v_mfma_f32_16x16x32_bf16 v[164:167], a[252:255], v[192:195], 0
v_mfma_f32_16x16x32_bf16 v[164:167], a[248:251], v[196:199], v[164:167]
s_add_u32 s48, s48, s51
s_add_u32 m0, s49, 16896
v_mfma_f32_16x16x32_bf16 v[164:167], a[244:247], v[204:207], v[164:167]
buffer_load_dwordx4 v237, s[16:19], s48 offen nt lds
v_mfma_f32_16x16x32_bf16 v[164:167], a[240:243], v[208:211], v[164:167]
v_mfma_f32_16x16x32_bf16 v[184:187], v[0:3], v[112:115], 0
v_mfma_f32_16x16x32_bf16 v[184:187], v[4:7], v[116:119], v[184:187]
s_nop 2
v_mfma_f32_16x16x32_bf16 v[188:191], v[12:15], v[116:119], 0
s_nop 2
v_mfma_f32_16x16x32_bf16 v[188:191], v[8:11], v[112:115], v[188:191]
v_max3_f32 v254, v184, v185, v186
s_nop 0
v_mfma_f32_16x16x32_bf16 v[200:203], v[16:19], v[112:115], 0
s_nop 2
v_mfma_f32_16x16x32_bf16 v[200:203], v[20:23], v[116:119], v[200:203]
s_nop 0
v_max3_f32 v254, v254, v187, v188
v_max3_f32 v254, v254, v189, v190
v_mfma_f32_16x16x32_bf16 v[212:215], v[28:31], v[116:119], 0
s_nop 2
v_mfma_f32_16x16x32_bf16 v[212:215], v[24:27], v[112:115], v[212:215]
v_max3_f32 v254, v254, v191, v200
v_max3_f32 v254, v254, v201, v202
v_mfma_f32_16x16x32_bf16 v[216:219], v[32:35], v[112:115], 0
s_nop 2
v_mfma_f32_16x16x32_bf16 v[216:219], v[36:39], v[116:119], v[216:219]
s_nop 0
v_max3_f32 v254, v254, v203, v212
v_max3_f32 v254, v254, v213, v214
v_mfma_f32_16x16x32_bf16 v[220:223], v[44:47], v[116:119], 0
s_nop 2
v_mfma_f32_16x16x32_bf16 v[220:223], v[40:43], v[112:115], v[220:223]
v_max3_f32 v254, v254, v215, v216
v_max3_f32 v254, v254, v217, v218
v_mfma_f32_16x16x32_bf16 v[224:227], v[48:51], v[112:115], 0
s_nop 2
v_mfma_f32_16x16x32_bf16 v[224:227], v[52:55], v[116:119], v[224:227]
s_nop 0
v_max3_f32 v254, v254, v219, v220
v_max3_f32 v254, v254, v221, v222
v_mfma_f32_16x16x32_bf16 v[228:231], v[208:211], a[128:131], 0
s_nop 2
v_mfma_f32_16x16x32_bf16 v[228:231], v[204:207], a[132:135], v[228:231]
v_max3_f32 v254, v254, v223, v224
v_mfma_f32_16x16x32_bf16 v[228:231], v[196:199], a[136:139], v[228:231]
ds_swizzle_b32 v255, v254 offset:0x401F
v_mfma_f32_16x16x32_bf16 v[228:231], v[192:195], a[140:143], v[228:231]
s_add_u32 m0, s49, 19008
s_add_u32 s48, s48, s51
buffer_load_dwordx4 v237, s[16:19], s48 offen nt lds
v_mfma_f32_16x16x32_bf16 v[232:235], v[192:195], a[156:159], 0
s_nop 2
v_mfma_f32_16x16x32_bf16 v[232:235], v[196:199], a[152:155], v[232:235]
v_cvt_pk_bf16_f32 v91, v230, v231
v_cvt_pk_bf16_f32 v90, v228, v229
v_mfma_f32_16x16x32_bf16 v[232:235], v[204:207], a[148:151], v[232:235]
v_mfma_f32_16x16x32_bf16 v[232:235], v[208:211], a[144:147], v[232:235]
s_nop 2
v_mfma_f32_16x16x32_bf16 v[228:231], v[208:211], a[160:163], 0
s_waitcnt lgkmcnt(0)
v_max_f32 v254, v254, v255
s_nop 0
v_mfma_f32_16x16x32_bf16 v[228:231], v[204:207], a[164:167], v[228:231]
ds_bpermute_b32 v255, v247, v254
v_mfma_f32_16x16x32_bf16 v[228:231], v[196:199], a[168:171], v[228:231]
v_cvt_pk_bf16_f32 v95, v234, v235
v_cvt_pk_bf16_f32 v94, v232, v233
v_mfma_f32_16x16x32_bf16 v[228:231], v[192:195], a[172:175], v[228:231]
s_nop 2
v_mfma_f32_16x16x32_bf16 v[232:235], v[192:195], a[188:191], 0
ds_read_b128 v[192:195], v236 offset:4224
s_nop 0
v_mfma_f32_16x16x32_bf16 v[232:235], v[204:207], a[180:183], v[232:235]
ds_read_b128 v[204:207], v236 offset:4480
v_cvt_pk_bf16_f32 v99, v230, v231
v_mfma_f32_16x16x32_bf16 v[232:235], v[208:211], a[176:179], v[232:235]
ds_read_b128 v[208:211], v236 offset:4736
v_cvt_pk_bf16_f32 v98, v228, v229
v_mfma_f32_16x16x32_bf16 v[232:235], v[196:199], a[184:187], v[232:235]
s_waitcnt lgkmcnt(3)
ds_read_b128 v[196:199], v236 offset:4992
v_max_f32 v254, v254, v255
v_sub_f32 v184, v184, v254
v_sub_f32 v185, v185, v254
v_exp_f32 v184, v184
v_exp_f32 v185, v185
v_sub_f32 v187, v187, v254
v_cvt_pk_bf16_f32 v103, v234, v235
v_cvt_pk_bf16_f32 v102, v232, v233
v_add_f32 v248, v184, v185
v_sub_f32 v186, v186, v254
v_exp_f32 v186, v186
v_cvt_pk_bf16_f32 v120, v184, v185
v_add_f32 v248, v248, v186
s_waitcnt lgkmcnt(1)
v_mfma_f32_16x16x32_bf16 v[228:231], v[208:211], a[184:187], 0
v_sub_f32 v188, v188, v254
s_waitcnt lgkmcnt(0)
v_mfma_f32_16x16x32_bf16 v[228:231], v[196:199], a[188:191], v[228:231]
v_exp_f32 v187, v187
v_mfma_f32_16x16x32_bf16 v[228:231], v[204:207], a[180:183], v[228:231]
v_cvt_pk_bf16_f32 v121, v186, v187
v_add_f32 v248, v248, v187
v_mfma_f32_16x16x32_bf16 v[228:231], v[192:195], a[176:179], v[228:231]
v_sub_f32 v189, v189, v254
v_sub_f32 v190, v190, v254
v_mfma_f32_16x16x32_bf16 v[232:235], v[192:195], a[160:163], 0
v_exp_f32 v189, v189
v_mfma_f32_16x16x32_bf16 v[232:235], v[204:207], a[164:167], v[232:235]
v_exp_f32 v190, v190
v_mfma_f32_16x16x32_bf16 v[232:235], v[208:211], a[168:171], v[232:235]
s_nop 0
v_cvt_pk_bf16_f32 v71, v230, v231
v_cvt_pk_bf16_f32 v70, v228, v229
v_mfma_f32_16x16x32_bf16 v[232:235], v[196:199], a[172:175], v[232:235]
s_add_u32 s48, s48, s51
v_exp_f32 v188, v188
v_mfma_f32_16x16x32_bf16 v[228:231], v[196:199], a[156:159], 0
s_add_u32 m0, s49, 21120
v_add_f32 v248, v248, v188
v_sub_f32 v191, v191, v254
v_mfma_f32_16x16x32_bf16 v[228:231], v[208:211], a[152:155], v[228:231]
buffer_load_dwordx4 v237, s[16:19], s48 offen nt lds
v_cvt_pk_bf16_f32 v66, v232, v233
v_mfma_f32_16x16x32_bf16 v[228:231], v[204:207], a[148:151], v[228:231]
v_cvt_pk_bf16_f32 v67, v234, v235
v_add_f32 v248, v248, v189
v_mfma_f32_16x16x32_bf16 v[228:231], v[192:195], a[144:147], v[228:231]
v_exp_f32 v191, v191
v_mfma_f32_16x16x32_bf16 v[232:235], v[192:195], a[128:131], 0
ds_read_b128 v[192:195], v236 offset:0
v_cvt_pk_bf16_f32 v122, v188, v189
v_mfma_f32_16x16x32_bf16 v[232:235], v[208:211], a[136:139], v[232:235]
ds_read_b128 v[208:211], v236 offset:256
v_add_f32 v248, v248, v190
v_mfma_f32_16x16x32_bf16 v[232:235], v[196:199], a[140:143], v[232:235]
ds_read_b128 v[196:199], v236 offset:512
v_cvt_pk_bf16_f32 v62, v228, v229
v_mfma_f32_16x16x32_bf16 v[232:235], v[204:207], a[132:135], v[232:235]
ds_read_b128 v[204:207], v236 offset:768
v_cvt_pk_bf16_f32 v63, v230, v231
v_add_f32 v248, v248, v191
v_cvt_pk_bf16_f32 v123, v190, v191
v_sub_f32 v200, v200, v254
v_exp_f32 v200, v200
v_sub_f32 v201, v201, v254
v_exp_f32 v201, v201
v_cvt_pk_bf16_f32 v59, v234, v235
v_cvt_pk_bf16_f32 v58, v232, v233
v_sub_f32 v203, v203, v254
s_waitcnt lgkmcnt(2)
v_mfma_f32_16x16x32_bf16 v[228:231], v[208:211], a[132:135], 0
ds_read_b128 v[188:191], v242 offset:64
v_sub_f32 v202, v202, v254
v_mfma_f32_16x16x32_bf16 v[228:231], v[192:195], a[128:131], v[228:231]
s_waitcnt lgkmcnt(2)
v_exp_f32 v203, v203
v_mfma_f32_16x16x32_bf16 v[228:231], v[196:199], a[136:139], v[228:231]
s_waitcnt lgkmcnt(1)
v_exp_f32 v202, v202
v_mfma_f32_16x16x32_bf16 v[228:231], v[204:207], a[140:143], v[228:231]
v_add_f32 v248, v248, v200
v_add_f32 v248, v248, v201
v_mfma_f32_16x16x32_bf16 v[184:187], v[204:207], a[156:159], 0
v_add_f32 v248, v248, v202
v_add_f32 v248, v248, v203
v_mfma_f32_16x16x32_bf16 v[184:187], v[196:199], a[152:155], v[184:187]
v_cvt_pk_bf16_f32 v124, v200, v201
v_cvt_pk_bf16_f32 v125, v202, v203
v_mfma_f32_16x16x32_bf16 v[184:187], v[208:211], a[148:151], v[184:187]
s_waitcnt lgkmcnt(0)
v_cvt_pk_bf16_f32 v56, v228, v229
v_cvt_pk_bf16_f32 v57, v230, v231
v_mfma_f32_16x16x32_bf16 v[184:187], v[192:195], a[144:147], v[184:187]
v_sub_f32 v212, v212, v254
v_sub_f32 v213, v213, v254
v_mfma_f32_16x16x32_bf16 v[228:231], v[192:195], a[160:163], 0
v_exp_f32 v212, v212
v_mfma_f32_16x16x32_bf16 v[228:231], v[208:211], a[164:167], v[228:231]
v_sub_f32 v214, v214, v254
v_add_f32 v248, v248, v212
v_mfma_f32_16x16x32_bf16 v[228:231], v[196:199], a[168:171], v[228:231]
v_cvt_pk_bf16_f32 v60, v184, v185
v_cvt_pk_bf16_f32 v61, v186, v187
v_mfma_f32_16x16x32_bf16 v[228:231], v[204:207], a[172:175], v[228:231]
s_add_u32 m0, s49, 23232
ds_read_b128 v[184:187], v242 offset:0
v_sub_f32 v215, v215, v254
v_mfma_f32_16x16x32_bf16 v[232:235], v[204:207], a[188:191], 0
s_add_u32 s48, s48, s51
buffer_load_dwordx4 v237, s[16:19], s48 offen nt lds
v_sub_f32 v216, v216, v254
v_mfma_f32_16x16x32_bf16 v[232:235], v[196:199], a[184:187], v[232:235]
s_sub_u32 s49, s49, s56
v_exp_f32 v213, v213
v_mfma_f32_16x16x32_bf16 v[232:235], v[208:211], a[180:183], v[232:235]
s_and_b32 s51, s57, 26212352
v_exp_f32 v214, v214
v_mfma_f32_16x16x32_bf16 v[232:235], v[192:195], a[176:179], v[232:235]
s_add_u32 s51, s51, 2048
v_cvt_pk_bf16_f32 v126, v212, v213
v_add_f32 v248, v248, v213
v_mfma_f32_16x16x32_bf16 v[200:203], v[4:7], v[188:191], 0
v_add_f32 v248, v248, v214
s_waitcnt lgkmcnt(0)
v_mfma_f32_16x16x32_bf16 v[200:203], v[0:3], v[184:187], v[200:203]
s_nop 0
v_cvt_pk_bf16_f32 v69, v234, v235
v_cvt_pk_bf16_f32 v68, v232, v233
v_mfma_f32_16x16x32_bf16 v[232:235], v[32:35], v[184:187], 0
ds_read_b128 v[184:187], v245 offset:64
v_sub_f32 v218, v218, v254
v_mfma_f32_16x16x32_bf16 v[232:235], v[36:39], v[188:191], v[232:235]
ds_read_b128 v[188:191], v243 offset:0
v_exp_f32 v215, v215
s_nop 0
v_add_f32 v248, v248, v215
v_cvt_pk_bf16_f32 v127, v214, v215
ds_read_b128 v[212:215], v243 offset:64
v_exp_f32 v216, v216
v_sub_f32 v217, v217, v254
v_add_f32 v248, v248, v216
v_exp_f32 v218, v218
v_sub_f32 v219, v219, v254
v_exp_f32 v217, v217
v_exp_f32 v219, v219
v_cvt_pk_bf16_f32 v128, v216, v217
v_cvt_pk_bf16_f32 v129, v218, v219
v_add_f32 v248, v248, v217
v_add_f32 v248, v248, v218
v_add_f32 v248, v248, v219
v_cvt_pk_bf16_f32 v64, v228, v229
v_cvt_pk_bf16_f32 v65, v230, v231
v_sub_f32 v220, v220, v254
v_sub_f32 v221, v221, v254
s_waitcnt lgkmcnt(0)
v_mfma_f32_16x16x32_bf16 v[200:203], v[12:15], v[212:215], v[200:203]
ds_read_b128 v[216:219], v244 offset:0
ds_read_b128 v[228:231], v245 offset:0
v_mfma_f32_16x16x32_bf16 v[200:203], v[8:11], v[188:191], v[200:203]
v_exp_f32 v220, v220
v_mfma_f32_16x16x32_bf16 v[232:235], v[40:43], v[188:191], v[232:235]
ds_read_b128 v[188:191], v244 offset:64
v_add_f32 v248, v248, v220
v_mfma_f32_16x16x32_bf16 v[232:235], v[44:47], v[212:215], v[232:235]
v_exp_f32 v221, v221
v_sub_f32 v223, v223, v254
v_add_f32 v248, v248, v221
v_exp_f32 v223, v223
v_sub_f32 v222, v222, v254
v_exp_f32 v222, v222
v_cvt_pk_bf16_f32 v130, v220, v221
v_mov_b32 v221, 0xff800000
v_add_f32 v248, v248, v222
v_cvt_pk_bf16_f32 v131, v222, v223
v_add_f32 v248, v248, v223
v_sub_f32 v224, v224, v254
v_exp_f32 v224, v224
s_waitcnt lgkmcnt(0)
v_mfma_f32_16x16x32_bf16 v[200:203], v[20:23], v[188:191], v[200:203]
v_cvt_pk_bf16_f32 v132, v224, 0
v_add_f32 v248, v248, v224
v_mfma_f32_16x16x32_bf16 v[200:203], v[16:19], v[216:219], v[200:203]
ds_swizzle_b32 v250, v248 offset:0x401F
v_add_u32 v245, 0x200, v245
v_mfma_f32_16x16x32_bf16 v[232:235], v[48:51], v[216:219], v[232:235]
v_add_u32 v244, 0x200, v244
v_add_u32 v243, 0x200, v243
v_mfma_f32_16x16x32_bf16 v[232:235], v[52:55], v[188:191], v[232:235]
v_add_u32 v242, 0x200, v242
s_nop 0
v_mfma_f32_16x16x32_bf16 v[200:203], v[24:27], v[228:231], v[200:203]
s_nop 2
v_mfma_f32_16x16x32_bf16 v[200:203], v[28:31], v[184:187], v[200:203]
s_nop 0
v_mov_b32_dpp v233, v221 quad_perm:[0,1,2,3] row_mask:0xf bank_mask:0xc
v_mov_b32_dpp v232, v221 quad_perm:[0,1,2,3] row_mask:0xf bank_mask:0x8
v_mfma_f32_16x16x32_bf16 v[184:187], a[0:3], v[192:195], 0
v_mov_b32_dpp v234, v221 quad_perm:[0,1,2,3] row_mask:0xf bank_mask:0xc
v_mov_b32_dpp v235, v221 quad_perm:[0,1,2,3] row_mask:0xf bank_mask:0xc
v_mfma_f32_16x16x32_bf16 v[184:187], a[4:7], v[208:211], v[184:187]
s_waitcnt lgkmcnt(0)
v_max3_f32 v223, v200, v201, v202
v_max3_f32 v223, v223, v203, v232
v_mfma_f32_16x16x32_bf16 v[184:187], a[8:11], v[196:199], v[184:187]
v_max3_f32 v223, v223, v233, v234
v_max_f32 v223, v223, v235
v_mfma_f32_16x16x32_bf16 v[184:187], a[12:15], v[204:207], v[184:187]
s_nop 0
v_max_f32_dpp v223, v223, v223 row_ror:8 row_mask:0xf bank_mask:0xf
v_add_f32 v248, v248, v250
v_mfma_f32_16x16x32_bf16 v[188:191], a[28:31], v[204:207], 0
ds_bpermute_b32 v250, v247, v248
v_mfma_f32_16x16x32_bf16 v[188:191], a[24:27], v[196:199], v[188:191]
v_max_f32_dpp v223, v223, v223 row_ror:4 row_mask:0xf bank_mask:0xf
v_mfma_f32_16x16x32_bf16 v[188:191], a[20:23], v[208:211], v[188:191]
ds_swizzle_b32 v221, v223 offset:0x401F
v_cvt_pk_bf16_f32 v113, v186, v187
v_mfma_f32_16x16x32_bf16 v[188:191], a[16:19], v[192:195], v[188:191]
v_cvt_pk_bf16_f32 v112, v184, v185
s_nop 0
v_mfma_f32_16x16x32_bf16 v[184:187], a[32:35], v[192:195], 0
s_nop 2
v_mfma_f32_16x16x32_bf16 v[184:187], a[36:39], v[208:211], v[184:187]
s_nop 0
v_cvt_pk_bf16_f32 v115, v190, v191
v_cvt_pk_bf16_f32 v114, v188, v189
v_mfma_f32_16x16x32_bf16 v[184:187], a[40:43], v[196:199], v[184:187]
s_waitcnt lgkmcnt(1)
v_add_f32 v248, v248, v250
v_mfma_f32_16x16x32_bf16 v[184:187], a[44:47], v[204:207], v[184:187]
v_rcp_f32 v251, v248
v_mfma_f32_16x16x32_bf16 v[188:191], a[60:63], v[204:207], 0
s_waitcnt lgkmcnt(0)
v_max_f32 v223, v223, v221
s_nop 0
v_mfma_f32_16x16x32_bf16 v[188:191], a[56:59], v[196:199], v[188:191]
ds_bpermute_b32 v221, v247, v223
v_mfma_f32_16x16x32_bf16 v[188:191], a[52:55], v[208:211], v[188:191]
v_cvt_pk_bf16_f32 v117, v186, v187
v_cvt_pk_bf16_f32 v116, v184, v185
v_mfma_f32_16x16x32_bf16 v[188:191], a[48:51], v[192:195], v[188:191]
s_nop 2
v_mfma_f32_16x16x32_bf16 v[168:171], a[192:195], v[192:195], 0
s_nop 2
v_mfma_f32_16x16x32_bf16 v[168:171], a[196:199], v[208:211], v[168:171]
v_cvt_pk_bf16_f32 v119, v190, v191
v_cvt_pk_bf16_f32 v118, v188, v189
v_mfma_f32_16x16x32_bf16 v[168:171], a[200:203], v[196:199], v[168:171]
v_mfma_f32_16x16x32_bf16 v[168:171], a[204:207], v[204:207], v[168:171]
s_waitcnt lgkmcnt(0)
v_max_f32 v223, v223, v221
v_sub_f32 v200, v200, v223
v_mfma_f32_16x16x32_bf16 v[172:175], a[220:223], v[204:207], 0
v_exp_f32 v200, v200
v_mfma_f32_16x16x32_bf16 v[172:175], a[216:219], v[196:199], v[172:175]
v_sub_f32 v201, v201, v223
v_sub_f32 v202, v202, v223
v_mfma_f32_16x16x32_bf16 v[172:175], a[212:215], v[208:211], v[172:175]
v_exp_f32 v202, v202
v_mfma_f32_16x16x32_bf16 v[172:175], a[208:211], v[192:195], v[172:175]
v_exp_f32 v201, v201
v_mfma_f32_16x16x32_bf16 v[176:179], a[224:227], v[192:195], 0
v_add_f32 v220, v200, v201
v_add_f32 v220, v220, v202
v_mfma_f32_16x16x32_bf16 v[176:179], a[228:231], v[208:211], v[176:179]
v_sub_f32 v203, v203, v223
v_sub_f32 v233, v233, v223
v_mfma_f32_16x16x32_bf16 v[176:179], a[232:235], v[196:199], v[176:179]
v_exp_f32 v233, v233
v_mfma_f32_16x16x32_bf16 v[176:179], a[236:239], v[204:207], v[176:179]
v_exp_f32 v203, v203
v_mfma_f32_16x16x32_bf16 v[180:183], a[252:255], v[204:207], 0
v_sub_f32 v232, v232, v223
v_sub_f32 v234, v234, v223
v_mfma_f32_16x16x32_bf16 v[180:183], a[248:251], v[196:199], v[180:183]
v_exp_f32 v232, v232
v_mfma_f32_16x16x32_bf16 v[180:183], a[244:247], v[208:211], v[180:183]
v_exp_f32 v234, v234
v_mfma_f32_16x16x32_bf16 v[180:183], a[240:243], v[192:195], v[180:183]
v_add_f32 v220, v220, v203
v_add_f32 v220, v220, v232
v_mfma_f32_16x16x32_bf16 v[184:187], v[0:3], v[112:115], 0
v_add_f32 v220, v220, v233
v_add_f32 v220, v220, v234
v_mfma_f32_16x16x32_bf16 v[184:187], v[4:7], v[116:119], v[184:187]
v_sub_f32 v235, v235, v223
v_cvt_pk_bf16_f32 v200, v200, v201
v_mfma_f32_16x16x32_bf16 v[188:191], v[12:15], v[116:119], 0
v_exp_f32 v235, v235
v_mfma_f32_16x16x32_bf16 v[188:191], v[8:11], v[112:115], v[188:191]
v_add_f32 v220, v220, v235
v_cvt_pk_bf16_f32 v201, v202, v203
v_mfma_f32_16x16x32_bf16 v[192:195], v[16:19], v[112:115], 0
v_cvt_pk_bf16_f32 v202, v232, v233
v_cvt_pk_bf16_f32 v203, v234, v235
v_mfma_f32_16x16x32_bf16 v[192:195], v[20:23], v[116:119], v[192:195]
ds_read_b128 v[196:199], v236 offset:8448
v_add_f32_dpp v220, v220, v220 row_ror:8 row_mask:0xf bank_mask:0xf
v_mfma_f32_16x16x32_bf16 v[208:211], v[28:31], v[116:119], 0
ds_read_b128 v[204:207], v236 offset:8704
v_add_f32_dpp v220, v220, v220 row_ror:4 row_mask:0xf bank_mask:0xf
v_mfma_f32_16x16x32_bf16 v[208:211], v[24:27], v[112:115], v[208:211]
ds_write_b32 v246, v220 offset:4096
ds_read_b128 v[212:215], v236 offset:8960
v_mfma_f32_16x16x32_bf16 v[216:219], v[32:35], v[112:115], 0
ds_read_b128 v[224:227], v236 offset:9216
v_max3_f32 v254, v184, v185, v186
v_mfma_f32_16x16x32_bf16 v[216:219], v[36:39], v[116:119], v[216:219]
v_max3_f32 v254, v254, v187, v188
v_max3_f32 v254, v254, v189, v190
v_mfma_f32_16x16x32_bf16 v[228:231], v[44:47], v[116:119], 0
v_max3_f32 v254, v254, v191, v192
v_max3_f32 v254, v254, v193, v194
v_mfma_f32_16x16x32_bf16 v[228:231], v[40:43], v[112:115], v[228:231]
s_waitcnt lgkmcnt(4)
v_max3_f32 v254, v254, v195, v208
v_max3_f32 v254, v254, v209, v210
v_mfma_f32_16x16x32_bf16 v[232:235], v[48:51], v[112:115], 0
s_waitcnt lgkmcnt(3)
v_max3_f32 v254, v254, v211, v216
v_max3_f32 v254, v254, v217, v218
v_mfma_f32_16x16x32_bf16 v[232:235], v[52:55], v[116:119], v[232:235]
s_waitcnt lgkmcnt(1)
v_max3_f32 v254, v254, v219, v228
v_max3_f32 v254, v254, v229, v230
v_mfma_f32_16x16x32_bf16 v[220:223], v[196:199], a[128:131], 0
s_waitcnt lgkmcnt(0)
s_nop 1
v_mfma_f32_16x16x32_bf16 v[220:223], v[204:207], a[132:135], v[220:223]
v_max3_f32 v254, v254, v231, v232
v_mfma_f32_16x16x32_bf16 v[220:223], v[212:215], a[136:139], v[220:223]
ds_swizzle_b32 v255, v254 offset:0x401F
v_mfma_f32_16x16x32_bf16 v[220:223], v[224:227], a[140:143], v[220:223]
s_nop 7
v_cvt_pk_bf16_f32 v73, v222, v223
v_cvt_pk_bf16_f32 v72, v220, v221
v_mfma_f32_16x16x32_bf16 v[220:223], v[224:227], a[156:159], 0
v_mfma_f32_16x16x32_bf16 v[220:223], v[212:215], a[152:155], v[220:223]
v_mfma_f32_16x16x32_bf16 v[220:223], v[204:207], a[148:151], v[220:223]
s_waitcnt lgkmcnt(0)
v_max_f32 v254, v254, v255
v_mfma_f32_16x16x32_bf16 v[220:223], v[196:199], a[144:147], v[220:223]
ds_bpermute_b32 v255, v247, v254
s_nop 6
v_cvt_pk_bf16_f32 v76, v220, v221
v_cvt_pk_bf16_f32 v77, v222, v223
v_mfma_f32_16x16x32_bf16 v[220:223], v[196:199], a[160:163], 0
v_mfma_f32_16x16x32_bf16 v[220:223], v[204:207], a[164:167], v[220:223]
v_mfma_f32_16x16x32_bf16 v[220:223], v[212:215], a[168:171], v[220:223]
s_waitcnt lgkmcnt(0)
v_max_f32 v254, v254, v255
v_mfma_f32_16x16x32_bf16 v[220:223], v[224:227], a[172:175], v[220:223]
v_sub_f32 v184, v184, v254
v_exp_f32 v184, v184
v_sub_f32 v185, v185, v254
v_sub_f32 v187, v187, v254
v_exp_f32 v185, v185
s_nop 2
v_cvt_pk_bf16_f32 v81, v222, v223
v_cvt_pk_bf16_f32 v80, v220, v221
v_mfma_f32_16x16x32_bf16 v[220:223], v[224:227], a[188:191], 0
ds_read_b128 v[224:227], v236 offset:12672
v_add_f32 v249, v184, v185
v_mfma_f32_16x16x32_bf16 v[220:223], v[204:207], a[180:183], v[220:223]
ds_read_b128 v[204:207], v236 offset:12928
v_sub_f32 v186, v186, v254
v_mfma_f32_16x16x32_bf16 v[220:223], v[196:199], a[176:179], v[220:223]
ds_read_b128 v[196:199], v236 offset:13184
v_cvt_pk_bf16_f32 v136, v184, v185
v_mfma_f32_16x16x32_bf16 v[220:223], v[212:215], a[184:187], v[220:223]
ds_read_b128 v[212:215], v236 offset:13440
v_exp_f32 v186, v186
v_exp_f32 v187, v187
v_add_f32 v249, v249, v186
v_add_f32 v249, v249, v187
v_cvt_pk_bf16_f32 v137, v186, v187
v_sub_f32 v189, v189, v254
v_sub_f32 v188, v188, v254
v_cvt_pk_bf16_f32 v84, v220, v221
v_cvt_pk_bf16_f32 v85, v222, v223
v_exp_f32 v188, v188
v_exp_f32 v189, v189
v_sub_f32 v191, v191, v254
s_waitcnt lgkmcnt(1)
v_mfma_f32_16x16x32_bf16 v[184:187], v[196:199], a[184:187], 0
v_sub_f32 v190, v190, v254
s_waitcnt lgkmcnt(0)
v_mfma_f32_16x16x32_bf16 v[184:187], v[212:215], a[188:191], v[184:187]
v_exp_f32 v190, v190
v_mfma_f32_16x16x32_bf16 v[184:187], v[204:207], a[180:183], v[184:187]
v_exp_f32 v191, v191
v_mfma_f32_16x16x32_bf16 v[184:187], v[224:227], a[176:179], v[184:187]
v_add_f32 v249, v249, v188
v_add_f32 v249, v249, v189
v_mfma_f32_16x16x32_bf16 v[220:223], v[224:227], a[160:163], 0
v_add_f32 v249, v249, v190
v_cvt_pk_bf16_f32 v139, v190, v191
v_mfma_f32_16x16x32_bf16 v[220:223], v[204:207], a[164:167], v[220:223]
v_cvt_pk_bf16_f32 v138, v188, v189
v_add_f32 v249, v249, v191
v_mfma_f32_16x16x32_bf16 v[220:223], v[196:199], a[168:171], v[220:223]
v_cvt_pk_bf16_f32 v86, v184, v185
v_cvt_pk_bf16_f32 v87, v186, v187
v_mfma_f32_16x16x32_bf16 v[220:223], v[212:215], a[172:175], v[220:223]
v_sub_f32 v192, v192, v254
v_sub_f32 v194, v194, v254
v_mfma_f32_16x16x32_bf16 v[184:187], v[212:215], a[156:159], 0
v_exp_f32 v192, v192
v_mfma_f32_16x16x32_bf16 v[184:187], v[196:199], a[152:155], v[184:187]
v_add_f32 v249, v249, v192
v_sub_f32 v193, v193, v254
v_mfma_f32_16x16x32_bf16 v[184:187], v[204:207], a[148:151], v[184:187]
v_cvt_pk_bf16_f32 v83, v222, v223
v_cvt_pk_bf16_f32 v82, v220, v221
v_mfma_f32_16x16x32_bf16 v[184:187], v[224:227], a[144:147], v[184:187]
v_exp_f32 v193, v193
v_mfma_f32_16x16x32_bf16 v[220:223], v[224:227], a[128:131], 0
ds_read_b128 v[224:227], v236 offset:16896
v_sub_f32 v209, v209, v254
v_mfma_f32_16x16x32_bf16 v[220:223], v[196:199], a[136:139], v[220:223]
ds_read_b128 v[196:199], v236 offset:17152
v_sub_f32 v208, v208, v254
v_mfma_f32_16x16x32_bf16 v[220:223], v[212:215], a[140:143], v[220:223]
ds_read_b128 v[212:215], v236 offset:17408
v_cvt_pk_bf16_f32 v79, v186, v187
v_mfma_f32_16x16x32_bf16 v[220:223], v[204:207], a[132:135], v[220:223]
ds_read_b128 v[204:207], v236 offset:17664
v_cvt_pk_bf16_f32 v78, v184, v185
v_exp_f32 v208, v208
v_exp_f32 v209, v209
v_exp_f32 v194, v194
v_add_f32 v249, v249, v193
v_add_f32 v249, v249, v194
v_sub_f32 v195, v195, v254
v_cvt_pk_bf16_f32 v74, v220, v221
v_cvt_pk_bf16_f32 v75, v222, v223
s_waitcnt lgkmcnt(2)
v_mfma_f32_16x16x32_bf16 v[184:187], v[196:199], a[132:135], 0
v_exp_f32 v195, v195
v_mfma_f32_16x16x32_bf16 v[184:187], v[224:227], a[128:131], v[184:187]
s_waitcnt lgkmcnt(1)
v_sub_f32 v216, v216, v254
v_sub_f32 v211, v211, v254
v_mfma_f32_16x16x32_bf16 v[184:187], v[212:215], a[136:139], v[184:187]
s_waitcnt lgkmcnt(0)
v_sub_f32 v210, v210, v254
v_add_f32 v249, v249, v195
v_mfma_f32_16x16x32_bf16 v[184:187], v[204:207], a[140:143], v[184:187]
v_exp_f32 v211, v211
v_mfma_f32_16x16x32_bf16 v[220:223], v[204:207], a[156:159], 0
v_exp_f32 v210, v210
v_mfma_f32_16x16x32_bf16 v[220:223], v[212:215], a[152:155], v[220:223]
v_add_f32 v249, v249, v208
v_sub_f32 v219, v219, v254
v_mfma_f32_16x16x32_bf16 v[220:223], v[196:199], a[148:151], v[220:223]
s_nop 0
v_cvt_pk_bf16_f32 v89, v186, v187
v_cvt_pk_bf16_f32 v88, v184, v185
v_mfma_f32_16x16x32_bf16 v[220:223], v[224:227], a[144:147], v[220:223]
v_exp_f32 v216, v216
v_mfma_f32_16x16x32_bf16 v[184:187], v[224:227], a[160:163], 0
v_sub_f32 v217, v217, v254
v_add_f32 v249, v249, v209
v_mfma_f32_16x16x32_bf16 v[184:187], v[196:199], a[164:167], v[184:187]
v_sub_f32 v228, v228, v254
v_add_f32 v249, v249, v210
v_mfma_f32_16x16x32_bf16 v[184:187], v[212:215], a[168:171], v[184:187]
v_exp_f32 v217, v217
v_mfma_f32_16x16x32_bf16 v[184:187], v[204:207], a[172:175], v[184:187]
v_sub_f32 v229, v229, v254
v_sub_f32 v218, v218, v254
v_mfma_f32_16x16x32_bf16 v[188:191], v[204:207], a[188:191], 0
v_exp_f32 v218, v218
v_mfma_f32_16x16x32_bf16 v[188:191], v[212:215], a[184:187], v[188:191]
v_add_f32 v249, v249, v211
v_add_f32 v249, v249, v216
v_mfma_f32_16x16x32_bf16 v[188:191], v[196:199], a[180:183], v[188:191]
v_cvt_pk_bf16_f32 v96, v184, v185
v_cvt_pk_bf16_f32 v97, v186, v187
v_mfma_f32_16x16x32_bf16 v[188:191], v[224:227], a[176:179], v[188:191]
v_exp_f32 v219, v219
v_mfma_f32_16x16x32_bf16 v[184:187], a[0:3], v[224:227], 0
v_add_f32 v249, v249, v217
v_add_f32 v249, v249, v218
v_mfma_f32_16x16x32_bf16 v[184:187], a[4:7], v[196:199], v[184:187]
v_add_f32 v249, v249, v219
v_cvt_pk_bf16_f32 v144, v216, v217
v_mfma_f32_16x16x32_bf16 v[184:187], a[8:11], v[212:215], v[184:187]
v_cvt_pk_bf16_f32 v100, v188, v189
v_cvt_pk_bf16_f32 v101, v190, v191
v_mfma_f32_16x16x32_bf16 v[184:187], a[12:15], v[204:207], v[184:187]
v_cvt_pk_bf16_f32 v145, v218, v219
v_cvt_pk_bf16_f32 v92, v220, v221
v_mfma_f32_16x16x32_bf16 v[188:191], a[28:31], v[204:207], 0
v_cvt_pk_bf16_f32 v93, v222, v223
v_sub_f32 v232, v232, v254
v_mfma_f32_16x16x32_bf16 v[188:191], a[24:27], v[212:215], v[188:191]
v_exp_f32 v228, v228
v_mfma_f32_16x16x32_bf16 v[188:191], a[20:23], v[196:199], v[188:191]
v_cvt_pk_bf16_f32 v112, v184, v185
v_cvt_pk_bf16_f32 v113, v186, v187
v_mfma_f32_16x16x32_bf16 v[188:191], a[16:19], v[224:227], v[188:191]
v_exp_f32 v229, v229
v_mfma_f32_16x16x32_bf16 v[184:187], a[32:35], v[224:227], 0
v_add_f32 v249, v249, v228
v_sub_f32 v231, v231, v254
v_mfma_f32_16x16x32_bf16 v[184:187], a[36:39], v[196:199], v[184:187]
v_exp_f32 v232, v232
v_mfma_f32_16x16x32_bf16 v[184:187], a[40:43], v[212:215], v[184:187]
s_nop 0
v_cvt_pk_bf16_f32 v115, v190, v191
v_cvt_pk_bf16_f32 v114, v188, v189
v_mfma_f32_16x16x32_bf16 v[184:187], a[44:47], v[204:207], v[184:187]
v_sub_f32 v230, v230, v254
v_add_f32 v249, v249, v229
v_mfma_f32_16x16x32_bf16 v[188:191], a[60:63], v[204:207], 0
v_cvt_pk_bf16_f32 v140, v192, v193
v_mov_b32 v192, v202
v_mfma_f32_16x16x32_bf16 v[188:191], a[56:59], v[212:215], v[188:191]
v_cvt_pk_bf16_f32 v142, v208, v209
v_mov_b32_dpp v209, v201 row_ror:8 row_mask:0xf bank_mask:0xf
v_mfma_f32_16x16x32_bf16 v[188:191], a[52:55], v[196:199], v[188:191]
v_cvt_pk_bf16_f32 v116, v184, v185
v_cvt_pk_bf16_f32 v117, v186, v187
v_mfma_f32_16x16x32_bf16 v[188:191], a[48:51], v[224:227], v[188:191]
v_mov_b32_dpp v208, v200 row_ror:8 row_mask:0xf bank_mask:0xf
v_cvt_pk_bf16_f32 v143, v210, v211
v_mfma_f32_16x16x32_bf16 v[216:219], v[56:59], v[120:123], 0
v_mov_b32_dpp v211, v201 row_ror:4 row_mask:0xf bank_mask:0xf
v_mov_b32_dpp v210, v200 row_ror:4 row_mask:0xf bank_mask:0xf
v_mfma_f32_16x16x32_bf16 v[216:219], v[104:107], v[132:135], v[216:219]
v_cvt_pk_bf16_f32 v141, v194, v195
v_mov_b32_dpp v194, v202 row_ror:12 row_mask:0xf bank_mask:0xf
v_mfma_f32_16x16x32_bf16 v[216:219], v[72:75], v[124:127], v[216:219]
v_cvt_pk_bf16_f32 v118, v188, v189
v_cvt_pk_bf16_f32 v119, v190, v191
v_mfma_f32_16x16x32_bf16 v[216:219], v[88:91], v[128:131], v[216:219]
v_mov_b32_dpp v195, v203 row_ror:12 row_mask:0xf bank_mask:0xf
v_mov_b32 v193, v203
v_mfma_f32_16x16x32_bf16 v[220:223], v[92:95], v[128:131], 0
v_mov_b32_dpp v203, v201 row_ror:12 row_mask:0xf bank_mask:0xf
v_mov_b32_dpp v202, v200 row_ror:12 row_mask:0xf bank_mask:0xf
v_mfma_f32_16x16x32_bf16 v[220:223], v[76:79], v[124:127], v[220:223]
v_exp_f32 v230, v230
v_mfma_f32_16x16x32_bf16 v[220:223], v[106:109], v[132:135], v[220:223]
v_fmac_f32 v154, v218, v251
v_fmac_f32 v152, v216, v251
v_mfma_f32_16x16x32_bf16 v[220:223], v[60:63], v[120:123], v[220:223]
v_fmac_f32 v155, v219, v251
v_fmac_f32 v153, v217, v251
v_mfma_f32_16x16x32_bf16 v[188:191], v[64:67], v[120:123], 0
v_exp_f32 v231, v231
v_mfma_f32_16x16x32_bf16 v[188:191], v[108:111], v[132:135], v[188:191]
v_add_f32 v249, v249, v230
v_add_f32 v249, v249, v231
v_mfma_f32_16x16x32_bf16 v[188:191], v[80:83], v[124:127], v[188:191]
v_cvt_pk_bf16_f32 v146, v228, v229
v_cvt_pk_bf16_f32 v147, v230, v231
v_mfma_f32_16x16x32_bf16 v[188:191], v[96:99], v[128:131], v[188:191]
v_add_f32 v249, v249, v232
v_fmac_f32 v156, v220, v251
v_mfma_f32_16x16x32_bf16 v[184:187], v[100:103], v[128:131], 0
ds_swizzle_b32 v250, v249 offset:0x401F
v_fmac_f32 v158, v222, v251
v_mfma_f32_16x16x32_bf16 v[184:187], v[84:87], v[124:127], v[184:187]
v_fmac_f32 v157, v221, v251
v_fmac_f32 v159, v223, v251
v_mfma_f32_16x16x32_bf16 v[184:187], v[68:71], v[120:123], v[184:187]
v_fmac_f32 v161, v189, v251
v_fmac_f32 v160, v188, v251
v_mfma_f32_16x16x32_bf16 v[184:187], v[110:113], v[132:135], v[184:187]
v_mov_b32_dpp v132, v192 row_ror:8 row_mask:0xf bank_mask:0xf
v_fmac_f32 v163, v191, v251
v_fmac_f32 v162, v190, v251
v_mfma_f32_16x16x32_bf16 v[216:219], v[110:113], v[132:135], 0
v_cvt_pk_bf16_f32 v152, v152, v153
v_cvt_pk_bf16_f32 v153, v154, v155
v_mfma_f32_16x16x32_bf16 v[216:219], v[84:87], v[208:211], v[216:219]
s_nop 0
v_fmac_f32 v167, v187, v251
v_fmac_f32 v164, v184, v251
v_mfma_f32_16x16x32_bf16 v[216:219], v[100:103], v[192:195], v[216:219]
s_waitcnt lgkmcnt(0)
v_fmac_f32 v165, v185, v251
v_fmac_f32 v166, v186, v251
v_mfma_f32_16x16x32_bf16 v[216:219], v[68:71], v[200:203], v[216:219]
v_add_f32 v249, v249, v250
v_pk_max_i16 v153, v153, 0
v_mfma_f32_16x16x32_bf16 v[188:191], v[64:67], v[200:203], 0
ds_bpermute_b32 v250, v247, v249
v_mfma_f32_16x16x32_bf16 v[188:191], v[80:83], v[208:211], v[188:191]
v_cvt_pk_bf16_f32 v160, v160, v161
v_cvt_pk_bf16_f32 v161, v162, v163
v_mfma_f32_16x16x32_bf16 v[188:191], v[96:99], v[192:195], v[188:191]
v_cvt_pk_bf16_f32 v216, v216, v217
v_cvt_pk_bf16_f32 v217, v218, v219
v_mfma_f32_16x16x32_bf16 v[188:191], v[108:111], v[132:135], v[188:191]
ds_write_b64 v246, v[216:217] offset:24
v_mfma_f32_16x16x32_bf16 v[228:231], v[106:109], v[132:135], 0
v_cvt_pk_bf16_f32 v162, v164, v165
v_pk_max_i16 v160, v160, 0
v_mfma_f32_16x16x32_bf16 v[228:231], v[76:79], v[208:211], v[228:231]
v_pk_max_i16 v161, v161, 0
v_cvt_pk_bf16_f32 v163, v166, v167
v_mfma_f32_16x16x32_bf16 v[228:231], v[92:95], v[192:195], v[228:231]
s_waitcnt lgkmcnt(1)
v_cvt_pk_bf16_f32 v188, v188, v189
v_cvt_pk_bf16_f32 v189, v190, v191
v_mfma_f32_16x16x32_bf16 v[228:231], v[60:63], v[200:203], v[228:231]
ds_write_b64 v246, v[188:189] offset:16
v_mfma_f32_16x16x32_bf16 v[184:187], v[56:59], v[200:203], 0
v_pk_max_i16 v163, v163, 0
v_cvt_pk_bf16_f32 v155, v158, v159
v_mfma_f32_16x16x32_bf16 v[184:187], v[72:75], v[208:211], v[184:187]
v_pk_max_i16 v162, v162, 0
v_cvt_pk_bf16_f32 v154, v156, v157
v_mfma_f32_16x16x32_bf16 v[184:187], v[88:91], v[192:195], v[184:187]
v_cvt_pk_bf16_f32 v228, v228, v229
v_cvt_pk_bf16_f32 v229, v230, v231
v_mfma_f32_16x16x32_bf16 v[184:187], v[104:107], v[132:135], v[184:187]
ds_write_b64 v246, v[228:229] offset:8
v_mfma_f32_16x16x32_bf16 v[188:191], v[0:3], v[112:115], 0
v_pk_max_i16 v154, v154, 0
v_pk_max_i16 v152, v152, 0
v_mfma_f32_16x16x32_bf16 v[188:191], v[4:7], v[116:119], v[188:191]
v_pk_max_i16 v155, v155, 0
v_add_f32 v249, v249, v250
v_mfma_f32_16x16x32_bf16 v[192:195], v[12:15], v[116:119], 0
buffer_store_dwordx4 v[152:155], v239, s[20:23], s52 offen offset:0 nt
buffer_store_dwordx4 v[160:163], v239, s[20:23], s52 offen offset:64 nt
v_cvt_pk_bf16_f32 v184, v184, v185
v_cvt_pk_bf16_f32 v185, v186, v187
v_rcp_f32 v252, v249
v_max3_f32 v254, v188, v189, v190
v_cvt_pk_bf16_f32 v148, v232, 0
s_add_u32 s52, s46, 16384
v_mfma_f32_16x16x32_bf16 v[192:195], v[8:11], v[112:115], v[192:195]
ds_write_b64 v246, v[184:185] offset:0
v_mfma_f32_16x16x32_bf16 v[200:203], v[16:19], v[112:115], 0
s_nop 0
v_add_u32 v246, 0x200, v246
s_nop 0
v_mfma_f32_16x16x32_bf16 v[200:203], v[20:23], v[116:119], v[200:203]
s_nop 1
v_max3_f32 v254, v254, v191, v192
v_mfma_f32_16x16x32_bf16 v[184:187], v[28:31], v[116:119], 0
v_max3_f32 v254, v254, v193, v194
s_nop 0
v_mfma_f32_16x16x32_bf16 v[184:187], v[24:27], v[112:115], v[184:187]
s_nop 0
v_max3_f32 v254, v254, v195, v200
v_max3_f32 v254, v254, v201, v202
v_mfma_f32_16x16x32_bf16 v[208:211], v[32:35], v[112:115], 0
s_nop 2
v_mfma_f32_16x16x32_bf16 v[208:211], v[36:39], v[116:119], v[208:211]
v_max3_f32 v254, v254, v203, v184
v_max3_f32 v254, v254, v185, v186
v_mfma_f32_16x16x32_bf16 v[216:219], v[44:47], v[116:119], 0
s_nop 2
v_mfma_f32_16x16x32_bf16 v[216:219], v[40:43], v[112:115], v[216:219]
s_nop 0
v_max3_f32 v254, v254, v187, v208
v_max3_f32 v254, v254, v209, v210
v_mfma_f32_16x16x32_bf16 v[220:223], v[48:51], v[112:115], 0
s_nop 2
v_mfma_f32_16x16x32_bf16 v[220:223], v[52:55], v[116:119], v[220:223]
v_max3_f32 v254, v254, v211, v216
v_max3_f32 v254, v254, v217, v218
v_mfma_f32_16x16x32_bf16 v[152:155], a[192:195], v[224:227], 0
s_nop 2
v_mfma_f32_16x16x32_bf16 v[152:155], a[196:199], v[196:199], v[152:155]
s_nop 0
v_max3_f32 v254, v254, v219, v220
v_mfma_f32_16x16x32_bf16 v[152:155], a[200:203], v[212:215], v[152:155]
ds_swizzle_b32 v255, v254 offset:0x401F
v_mfma_f32_16x16x32_bf16 v[152:155], a[204:207], v[204:207], v[152:155]
v_mfma_f32_16x16x32_bf16 v[156:159], a[220:223], v[204:207], 0
v_mfma_f32_16x16x32_bf16 v[156:159], a[216:219], v[212:215], v[156:159]
v_mfma_f32_16x16x32_bf16 v[156:159], a[212:215], v[196:199], v[156:159]
v_mfma_f32_16x16x32_bf16 v[156:159], a[208:211], v[224:227], v[156:159]
v_mfma_f32_16x16x32_bf16 v[160:163], a[224:227], v[224:227], 0
s_waitcnt lgkmcnt(0)
v_max_f32 v254, v254, v255
v_mfma_f32_16x16x32_bf16 v[160:163], a[228:231], v[196:199], v[160:163]
ds_bpermute_b32 v255, v247, v254
v_mfma_f32_16x16x32_bf16 v[160:163], a[232:235], v[212:215], v[160:163]
v_mfma_f32_16x16x32_bf16 v[160:163], a[236:239], v[204:207], v[160:163]
v_mfma_f32_16x16x32_bf16 v[164:167], a[252:255], v[204:207], 0
v_mfma_f32_16x16x32_bf16 v[164:167], a[248:251], v[212:215], v[164:167]
v_mfma_f32_16x16x32_bf16 v[164:167], a[244:247], v[196:199], v[164:167]
v_mfma_f32_16x16x32_bf16 v[164:167], a[240:243], v[224:227], v[164:167]
s_waitcnt lgkmcnt(0)
v_max_f32 v254, v254, v255
v_sub_f32 v188, v188, v254
v_mfma_f32_16x16x32_bf16 v[196:199], v[56:59], v[136:139], 0
v_sub_f32 v190, v190, v254
v_sub_f32 v189, v189, v254
v_mfma_f32_16x16x32_bf16 v[196:199], v[104:107], v[148:151], v[196:199]
v_exp_f32 v189, v189
v_mfma_f32_16x16x32_bf16 v[196:199], v[72:75], v[140:143], v[196:199]
v_exp_f32 v188, v188
v_mfma_f32_16x16x32_bf16 v[196:199], v[88:91], v[144:147], v[196:199]
v_add_f32 v248, v188, v189
v_sub_f32 v191, v191, v254
v_mfma_f32_16x16x32_bf16 v[204:207], v[92:95], v[144:147], 0
v_exp_f32 v191, v191
v_mfma_f32_16x16x32_bf16 v[204:207], v[76:79], v[140:143], v[204:207]
v_exp_f32 v190, v190
v_mfma_f32_16x16x32_bf16 v[204:207], v[106:109], v[148:151], v[204:207]
v_cvt_pk_bf16_f32 v120, v188, v189
v_add_f32 v248, v248, v190
v_mfma_f32_16x16x32_bf16 v[204:207], v[60:63], v[136:139], v[204:207]
ds_read_b128 v[212:215], v236 offset:4224
v_add_f32 v248, v248, v191
v_mfma_f32_16x16x32_bf16 v[228:231], v[64:67], v[136:139], 0
ds_read_b128 v[224:227], v236 offset:4480
v_cvt_pk_bf16_f32 v121, v190, v191
v_mfma_f32_16x16x32_bf16 v[228:231], v[108:111], v[148:151], v[228:231]
v_fmac_f32 v170, v198, v252
v_fmac_f32 v171, v199, v252
v_mfma_f32_16x16x32_bf16 v[228:231], v[80:83], v[140:143], v[228:231]
v_fmac_f32 v168, v196, v252
v_fmac_f32 v169, v197, v252
v_mfma_f32_16x16x32_bf16 v[228:231], v[96:99], v[144:147], v[228:231]
ds_read_b128 v[196:199], v236 offset:4736
v_fmac_f32 v175, v207, v252
v_mfma_f32_16x16x32_bf16 v[232:235], v[100:103], v[144:147], 0
v_fmac_f32 v172, v204, v252
v_fmac_f32 v174, v206, v252
v_mfma_f32_16x16x32_bf16 v[232:235], v[84:87], v[140:143], v[232:235]
s_waitcnt lgkmcnt(2)
v_fmac_f32 v173, v205, v252
v_fmac_f32 v177, v229, v252
v_mfma_f32_16x16x32_bf16 v[232:235], v[110:113], v[148:151], v[232:235]
s_waitcnt lgkmcnt(1)
ds_read_b128 v[204:207], v236 offset:4992
v_fmac_f32 v176, v228, v252
v_mfma_f32_16x16x32_bf16 v[232:235], v[68:71], v[136:139], v[232:235]
v_fmac_f32 v178, v230, v252
v_fmac_f32 v179, v231, v252
v_mfma_f32_16x16x32_bf16 v[188:191], a[0:3], v[212:215], 0
v_cvt_pk_bf16_f32 v176, v176, v177
v_cvt_pk_bf16_f32 v168, v168, v169
v_mfma_f32_16x16x32_bf16 v[188:191], a[4:7], v[224:227], v[188:191]
s_waitcnt lgkmcnt(1)
v_cvt_pk_bf16_f32 v169, v170, v171
v_fmac_f32 v181, v233, v252
v_mfma_f32_16x16x32_bf16 v[188:191], a[8:11], v[196:199], v[188:191]
v_fmac_f32 v182, v234, v252
v_fmac_f32 v180, v232, v252
v_fmac_f32 v183, v235, v252
v_cvt_pk_bf16_f32 v170, v172, v173
v_pk_max_i16 v170, v170, 0
s_waitcnt lgkmcnt(0)
v_mfma_f32_16x16x32_bf16 v[188:191], a[12:15], v[204:207], v[188:191]
v_cvt_pk_bf16_f32 v171, v174, v175
v_pk_max_i16 v176, v176, 0
v_mfma_f32_16x16x32_bf16 v[232:235], a[28:31], v[204:207], 0
v_pk_max_i16 v171, v171, 0
v_cvt_pk_bf16_f32 v177, v178, v179
v_mfma_f32_16x16x32_bf16 v[232:235], a[24:27], v[196:199], v[232:235]
v_cvt_pk_bf16_f32 v178, v180, v181
v_pk_max_i16 v177, v177, 0
v_mfma_f32_16x16x32_bf16 v[232:235], a[20:23], v[224:227], v[232:235]
v_cvt_pk_bf16_f32 v112, v188, v189
v_cvt_pk_bf16_f32 v113, v190, v191
v_mfma_f32_16x16x32_bf16 v[232:235], a[16:19], v[212:215], v[232:235]
v_pk_max_i16 v168, v168, 0
v_cvt_pk_bf16_f32 v179, v182, v183
v_mfma_f32_16x16x32_bf16 v[188:191], a[32:35], v[212:215], 0
v_pk_max_i16 v179, v179, 0
v_pk_max_i16 v169, v169, 0
v_mfma_f32_16x16x32_bf16 v[188:191], a[36:39], v[224:227], v[188:191]
v_pk_max_i16 v178, v178, 0
v_sub_f32 v192, v192, v254
v_mfma_f32_16x16x32_bf16 v[188:191], a[40:43], v[196:199], v[188:191]
buffer_store_dwordx4 v[168:171], v239, s[20:23], s53 offen offset:0 nt
buffer_store_dwordx4 v[176:179], v239, s[20:23], s53 offen offset:64 nt
v_sub_f32 v193, v193, v254
v_exp_f32 v192, v192
v_exp_f32 v193, v193
v_sub_f32 v195, v195, v254
v_exp_f32 v195, v195
v_mfma_f32_16x16x32_bf16 v[188:191], a[44:47], v[204:207], v[188:191]
s_add_u32 s53, s46, 4096
v_add_f32 v248, v248, v192
v_sub_f32 v194, v194, v254
v_mfma_f32_16x16x32_bf16 v[228:231], a[60:63], v[204:207], 0
s_add_u32 s46, s46, 13107200
v_cvt_pk_bf16_f32 v114, v232, v233
v_cvt_pk_bf16_f32 v115, v234, v235
v_mfma_f32_16x16x32_bf16 v[228:231], a[56:59], v[196:199], v[228:231]
v_cvt_pk_bf16_f32 v117, v190, v191
v_cvt_pk_bf16_f32 v116, v188, v189
v_mfma_f32_16x16x32_bf16 v[228:231], a[52:55], v[224:227], v[228:231]
v_exp_f32 v194, v194
v_mfma_f32_16x16x32_bf16 v[228:231], a[48:51], v[212:215], v[228:231]
v_add_f32 v248, v248, v193
v_add_f32 v248, v248, v194
v_mfma_f32_16x16x32_bf16 v[168:171], a[192:195], v[212:215], 0
v_add_f32 v248, v248, v195
v_cvt_pk_bf16_f32 v122, v192, v193
v_mfma_f32_16x16x32_bf16 v[168:171], a[196:199], v[224:227], v[168:171]
v_cvt_pk_bf16_f32 v123, v194, v195
v_sub_f32 v201, v201, v254
v_mfma_f32_16x16x32_bf16 v[168:171], a[200:203], v[196:199], v[168:171]
v_cvt_pk_bf16_f32 v119, v230, v231
v_cvt_pk_bf16_f32 v118, v228, v229
v_mfma_f32_16x16x32_bf16 v[168:171], a[204:207], v[204:207], v[168:171]
v_sub_f32 v202, v202, v254
v_sub_f32 v200, v200, v254
v_mfma_f32_16x16x32_bf16 v[172:175], a[220:223], v[204:207], 0
v_exp_f32 v200, v200
v_mfma_f32_16x16x32_bf16 v[172:175], a[216:219], v[196:199], v[172:175]
v_exp_f32 v202, v202
v_mfma_f32_16x16x32_bf16 v[172:175], a[212:215], v[224:227], v[172:175]
v_exp_f32 v201, v201
v_mfma_f32_16x16x32_bf16 v[172:175], a[208:211], v[212:215], v[172:175]
v_sub_f32 v203, v203, v254
v_add_f32 v248, v248, v200
v_mfma_f32_16x16x32_bf16 v[176:179], a[224:227], v[212:215], 0
v_exp_f32 v203, v203
v_mfma_f32_16x16x32_bf16 v[176:179], a[228:231], v[224:227], v[176:179]
v_cvt_pk_bf16_f32 v125, v202, v203
v_add_f32 v248, v248, v201
v_mfma_f32_16x16x32_bf16 v[176:179], a[232:235], v[196:199], v[176:179]
v_add_f32 v248, v248, v202
v_cvt_pk_bf16_f32 v124, v200, v201
v_mfma_f32_16x16x32_bf16 v[176:179], a[236:239], v[204:207], v[176:179]
v_add_f32 v248, v248, v203
v_sub_f32 v184, v184, v254
v_mfma_f32_16x16x32_bf16 v[180:183], a[252:255], v[204:207], 0
v_sub_f32 v185, v185, v254
v_sub_f32 v187, v187, v254
v_mfma_f32_16x16x32_bf16 v[180:183], a[248:251], v[196:199], v[180:183]
v_sub_f32 v186, v186, v254
v_sub_f32 v220, v220, v254
v_mfma_f32_16x16x32_bf16 v[180:183], a[244:247], v[224:227], v[180:183]
v_exp_f32 v184, v184
v_mfma_f32_16x16x32_bf16 v[180:183], a[240:243], v[212:215], v[180:183]
v_add_f32 v248, v248, v184
v_sub_f32 v216, v216, v254
v_mfma_f32_16x16x32_bf16 v[188:191], v[0:3], v[112:115], 0
v_exp_f32 v187, v187
v_mfma_f32_16x16x32_bf16 v[188:191], v[4:7], v[116:119], v[188:191]
v_exp_f32 v186, v186
v_mfma_f32_16x16x32_bf16 v[192:195], v[12:15], v[116:119], 0
v_exp_f32 v185, v185
v_mfma_f32_16x16x32_bf16 v[192:195], v[8:11], v[112:115], v[192:195]
v_add_f32 v248, v248, v185
v_add_f32 v248, v248, v186
v_mfma_f32_16x16x32_bf16 v[196:199], v[16:19], v[112:115], 0
v_add_f32 v248, v248, v187
v_cvt_pk_bf16_f32 v127, v186, v187
v_mfma_f32_16x16x32_bf16 v[196:199], v[20:23], v[116:119], v[196:199]
v_cvt_pk_bf16_f32 v126, v184, v185
v_sub_f32 v218, v218, v254
v_mfma_f32_16x16x32_bf16 v[200:203], v[28:31], v[116:119], 0
v_exp_f32 v220, v220
v_mfma_f32_16x16x32_bf16 v[200:203], v[24:27], v[112:115], v[200:203]
v_cvt_pk_bf16_f32 v132, v220, 0
v_sub_f32 v217, v217, v254
v_mfma_f32_16x16x32_bf16 v[204:207], v[32:35], v[112:115], 0
v_sub_f32 v211, v211, v254
v_sub_f32 v210, v210, v254
v_mfma_f32_16x16x32_bf16 v[204:207], v[36:39], v[116:119], v[204:207]
v_sub_f32 v219, v219, v254
v_sub_f32 v208, v208, v254
v_mfma_f32_16x16x32_bf16 v[212:215], v[44:47], v[116:119], 0
v_sub_f32 v209, v209, v254
v_max3_f32 v254, v188, v189, v190
v_mfma_f32_16x16x32_bf16 v[212:215], v[40:43], v[112:115], v[212:215]
v_exp_f32 v209, v209
v_mfma_f32_16x16x32_bf16 v[224:227], v[48:51], v[112:115], 0
v_exp_f32 v208, v208
v_mfma_f32_16x16x32_bf16 v[224:227], v[52:55], v[116:119], v[224:227]
v_exp_f32 v217, v217
v_mfma_f32_16x16x32_bf16 v[184:187], v[56:59], v[120:123], 0
v_exp_f32 v210, v210
v_mfma_f32_16x16x32_bf16 v[184:187], v[104:107], v[132:135], v[184:187]
v_exp_f32 v218, v218
v_mfma_f32_16x16x32_bf16 v[184:187], v[72:75], v[124:127], v[184:187]
v_exp_f32 v211, v211
v_exp_f32 v216, v216
v_exp_f32 v219, v219
v_cvt_pk_bf16_f32 v129, v210, v211
v_cvt_pk_bf16_f32 v131, v218, v219
v_cvt_pk_bf16_f32 v130, v216, v217
v_cvt_pk_bf16_f32 v128, v208, v209
v_add_f32 v248, v248, v208
v_add_f32 v248, v248, v209
v_mfma_f32_16x16x32_bf16 v[184:187], v[88:91], v[128:131], v[184:187]
v_add_f32 v248, v248, v210
v_add_f32 v248, v248, v211
v_mfma_f32_16x16x32_bf16 v[208:211], v[92:95], v[128:131], 0
v_max3_f32 v254, v254, v191, v192
v_max3_f32 v254, v254, v193, v194
v_mfma_f32_16x16x32_bf16 v[208:211], v[76:79], v[124:127], v[208:211]
v_max3_f32 v254, v254, v195, v196
v_max3_f32 v254, v254, v197, v198
v_mfma_f32_16x16x32_bf16 v[208:211], v[106:109], v[132:135], v[208:211]
v_max3_f32 v254, v254, v199, v200
v_max3_f32 v254, v254, v201, v202
v_mfma_f32_16x16x32_bf16 v[208:211], v[60:63], v[120:123], v[208:211]
v_max3_f32 v254, v254, v203, v204
v_max3_f32 v254, v254, v205, v206
v_mfma_f32_16x16x32_bf16 v[228:231], v[64:67], v[120:123], 0
v_max3_f32 v254, v254, v207, v212
v_max3_f32 v254, v254, v213, v214
v_mfma_f32_16x16x32_bf16 v[228:231], v[108:111], v[132:135], v[228:231]
v_max3_f32 v254, v254, v215, v224
v_add_f32 v248, v248, v216
v_mfma_f32_16x16x32_bf16 v[228:231], v[80:83], v[124:127], v[228:231]
ds_swizzle_b32 v255, v254 offset:0x401F
v_add_f32 v248, v248, v217
v_mfma_f32_16x16x32_bf16 v[228:231], v[96:99], v[128:131], v[228:231]
v_add_f32 v248, v248, v218
v_add_f32 v248, v248, v219
v_mfma_f32_16x16x32_bf16 v[232:235], v[100:103], v[128:131], 0
ds_read_b128 v[216:219], v236 offset:8448
v_add_f32 v248, v248, v220
v_mfma_f32_16x16x32_bf16 v[232:235], v[84:87], v[124:127], v[232:235]
ds_read_b128 v[220:223], v236 offset:8704
ds_swizzle_b32 v250, v248 offset:0x401F
v_mfma_f32_16x16x32_bf16 v[232:235], v[110:113], v[132:135], v[232:235]
v_mfma_f32_16x16x32_bf16 v[232:235], v[68:71], v[120:123], v[232:235]
s_waitcnt lgkmcnt(3)
v_max_f32 v254, v254, v255
ds_bpermute_b32 v255, v247, v254
s_waitcnt lgkmcnt(1)
v_add_f32 v248, v248, v250
ds_bpermute_b32 v250, v247, v248
s_waitcnt lgkmcnt(1)
v_max_f32 v254, v254, v255
v_sub_f32 v188, v188, v254
v_exp_f32 v188, v188
v_sub_f32 v189, v189, v254
v_sub_f32 v190, v190, v254
v_sub_f32 v191, v191, v254
v_exp_f32 v189, v189
v_exp_f32 v191, v191
v_exp_f32 v190, v190
v_add_f32 v249, v188, v189
v_add_f32 v249, v249, v190
v_add_f32 v249, v249, v191
v_cvt_pk_bf16_f32 v137, v190, v191
v_cvt_pk_bf16_f32 v136, v188, v189
v_mfma_f32_16x16x32_bf16 v[188:191], a[0:3], v[216:219], 0
s_waitcnt lgkmcnt(0)
v_sub_f32 v192, v192, v254
v_sub_f32 v195, v195, v254
v_mfma_f32_16x16x32_bf16 v[188:191], a[4:7], v[220:223], v[188:191]
v_exp_f32 v192, v192
v_sub_f32 v193, v193, v254
v_sub_f32 v194, v194, v254
v_exp_f32 v195, v195
v_exp_f32 v193, v193
v_exp_f32 v194, v194
v_add_f32 v249, v249, v192
v_add_f32 v249, v249, v193
v_add_f32 v249, v249, v194
v_add_f32 v249, v249, v195
v_cvt_pk_bf16_f32 v139, v194, v195
v_cvt_pk_bf16_f32 v138, v192, v193
ds_read_b128 v[192:195], v236 offset:8960
v_sub_f32 v198, v198, v254
v_sub_f32 v197, v197, v254
v_sub_f32 v196, v196, v254
v_exp_f32 v196, v196
v_exp_f32 v198, v198
v_sub_f32 v202, v202, v254
v_sub_f32 v200, v200, v254
v_exp_f32 v197, v197
v_sub_f32 v201, v201, v254
v_sub_f32 v199, v199, v254
v_exp_f32 v199, v199
v_exp_f32 v200, v200
v_add_f32 v249, v249, v196
v_add_f32 v249, v249, v197
v_add_f32 v249, v249, v198
s_waitcnt lgkmcnt(0)
v_mfma_f32_16x16x32_bf16 v[188:191], a[8:11], v[192:195], v[188:191]
v_sub_f32 v203, v203, v254
v_add_f32 v249, v249, v199
v_add_f32 v249, v249, v200
v_exp_f32 v201, v201
v_exp_f32 v202, v202
v_exp_f32 v203, v203
v_sub_f32 v204, v204, v254
v_exp_f32 v204, v204
v_add_f32 v249, v249, v201
v_add_f32 v249, v249, v202
v_add_f32 v249, v249, v203
v_sub_f32 v205, v205, v254
v_sub_f32 v206, v206, v254
v_exp_f32 v205, v205
v_exp_f32 v206, v206
v_add_f32 v249, v249, v204
v_add_f32 v249, v249, v205
v_sub_f32 v207, v207, v254
v_exp_f32 v207, v207
v_add_f32 v249, v249, v206
v_add_f32 v249, v249, v207
v_cvt_pk_bf16_f32 v145, v206, v207
v_cvt_pk_bf16_f32 v144, v204, v205
ds_read_b128 v[204:207], v236 offset:9216
v_add_f32 v248, v248, v250
v_rcp_f32 v251, v248
v_sub_f32 v212, v212, v254
v_fmac_f32 v152, v184, v251
v_fmac_f32 v153, v185, v251
v_fmac_f32 v155, v187, v251
v_fmac_f32 v154, v186, v251
v_fmac_f32 v157, v209, v251
v_fmac_f32 v159, v211, v251
v_fmac_f32 v158, v210, v251
v_fmac_f32 v156, v208, v251
v_exp_f32 v212, v212
v_sub_f32 v213, v213, v254
v_exp_f32 v213, v213
v_sub_f32 v214, v214, v254
v_exp_f32 v214, v214
s_waitcnt lgkmcnt(0)
v_mfma_f32_16x16x32_bf16 v[188:191], a[12:15], v[204:207], v[188:191]
v_sub_f32 v215, v215, v254
v_add_f32 v249, v249, v212
v_mfma_f32_16x16x32_bf16 v[184:187], a[28:31], v[204:207], 0
v_exp_f32 v215, v215
v_mfma_f32_16x16x32_bf16 v[184:187], a[24:27], v[192:195], v[184:187]
v_add_f32 v249, v249, v213
v_add_f32 v249, v249, v214
v_mfma_f32_16x16x32_bf16 v[184:187], a[20:23], v[220:223], v[184:187]
v_add_f32 v249, v249, v215
v_cvt_pk_bf16_f32 v147, v214, v215
v_mfma_f32_16x16x32_bf16 v[184:187], a[16:19], v[216:219], v[184:187]
v_cvt_pk_bf16_f32 v146, v212, v213
v_fmac_f32 v163, v231, v251
v_mfma_f32_16x16x32_bf16 v[208:211], a[32:35], v[216:219], 0
v_fmac_f32 v161, v229, v251
v_cvt_pk_bf16_f32 v152, v152, v153
v_mfma_f32_16x16x32_bf16 v[208:211], a[36:39], v[220:223], v[208:211]
v_fmac_f32 v167, v235, v251
v_fmac_f32 v160, v228, v251
v_mfma_f32_16x16x32_bf16 v[208:211], a[40:43], v[192:195], v[208:211]
v_fmac_f32 v164, v232, v251
v_cvt_pk_bf16_f32 v160, v160, v161
v_mfma_f32_16x16x32_bf16 v[208:211], a[44:47], v[204:207], v[208:211]
v_cvt_pk_bf16_f32 v153, v154, v155
v_cvt_pk_bf16_f32 v154, v156, v157
v_mfma_f32_16x16x32_bf16 v[212:215], a[60:63], v[204:207], 0
v_fmac_f32 v166, v234, v251
v_fmac_f32 v162, v230, v251
v_mfma_f32_16x16x32_bf16 v[212:215], a[56:59], v[192:195], v[212:215]
v_fmac_f32 v165, v233, v251
v_cvt_pk_bf16_f32 v155, v158, v159
v_mfma_f32_16x16x32_bf16 v[212:215], a[52:55], v[220:223], v[212:215]
v_cvt_pk_bf16_f32 v161, v162, v163
v_cvt_pk_bf16_f32 v162, v164, v165
v_mfma_f32_16x16x32_bf16 v[212:215], a[48:51], v[216:219], v[212:215]
v_cvt_pk_bf16_f32 v163, v166, v167
v_pk_max_i16 v162, v162, 0
v_pk_max_i16 v161, v161, 0
v_pk_max_i16 v163, v163, 0
v_pk_max_i16 v153, v153, 0
v_pk_max_i16 v155, v155, 0
v_pk_max_i16 v152, v152, 0
v_pk_max_i16 v160, v160, 0
v_pk_max_i16 v154, v154, 0
buffer_store_dwordx4 v[152:155], v239, s[20:23], s52 offen offset:0 nt
buffer_store_dwordx4 v[160:163], v239, s[20:23], s52 offen offset:64 nt
v_cvt_pk_bf16_f32 v112, v188, v189
v_cvt_pk_bf16_f32 v113, v190, v191
v_cvt_pk_bf16_f32 v114, v184, v185
v_cvt_pk_bf16_f32 v115, v186, v187
v_cvt_pk_bf16_f32 v118, v212, v213
v_cvt_pk_bf16_f32 v119, v214, v215
v_cvt_pk_bf16_f32 v116, v208, v209
v_cvt_pk_bf16_f32 v117, v210, v211
v_mfma_f32_16x16x32_bf16 v[152:155], a[192:195], v[216:219], 0
v_sub_f32 v224, v224, v254
v_cvt_pk_bf16_f32 v142, v200, v201
v_mfma_f32_16x16x32_bf16 v[152:155], a[196:199], v[220:223], v[152:155]
v_exp_f32 v224, v224
v_mfma_f32_16x16x32_bf16 v[152:155], a[200:203], v[192:195], v[152:155]
v_cvt_pk_bf16_f32 v141, v198, v199
v_cvt_pk_bf16_f32 v140, v196, v197
v_mfma_f32_16x16x32_bf16 v[152:155], a[204:207], v[204:207], v[152:155]
v_add_f32 v249, v249, v224
v_cvt_pk_bf16_f32 v143, v202, v203
v_mfma_f32_16x16x32_bf16 v[156:159], a[220:223], v[204:207], 0
ds_swizzle_b32 v250, v249 offset:0x401F
v_cvt_pk_bf16_f32 v148, v224, 0
v_mfma_f32_16x16x32_bf16 v[156:159], a[216:219], v[192:195], v[156:159]
v_mfma_f32_16x16x32_bf16 v[156:159], a[212:215], v[220:223], v[156:159]
v_mfma_f32_16x16x32_bf16 v[156:159], a[208:211], v[216:219], v[156:159]
v_mfma_f32_16x16x32_bf16 v[160:163], a[224:227], v[216:219], 0
v_mfma_f32_16x16x32_bf16 v[160:163], a[228:231], v[220:223], v[160:163]
v_mfma_f32_16x16x32_bf16 v[160:163], a[232:235], v[192:195], v[160:163]
s_waitcnt lgkmcnt(0)
v_add_f32 v249, v249, v250
v_mfma_f32_16x16x32_bf16 v[160:163], a[236:239], v[204:207], v[160:163]
ds_bpermute_b32 v250, v247, v249
v_mfma_f32_16x16x32_bf16 v[164:167], a[252:255], v[204:207], 0
v_mfma_f32_16x16x32_bf16 v[164:167], a[248:251], v[192:195], v[164:167]
v_mfma_f32_16x16x32_bf16 v[164:167], a[244:247], v[220:223], v[164:167]
v_mfma_f32_16x16x32_bf16 v[164:167], a[240:243], v[216:219], v[164:167]
v_mfma_f32_16x16x32_bf16 v[184:187], v[0:3], v[112:115], 0
v_mfma_f32_16x16x32_bf16 v[184:187], v[4:7], v[116:119], v[184:187]
s_waitcnt lgkmcnt(0)
v_add_f32 v249, v249, v250
s_nop 0
v_mfma_f32_16x16x32_bf16 v[188:191], v[12:15], v[116:119], 0
v_rcp_f32 v252, v249
v_mfma_f32_16x16x32_bf16 v[188:191], v[8:11], v[112:115], v[188:191]
s_nop 1
v_max3_f32 v254, v184, v185, v186
v_mfma_f32_16x16x32_bf16 v[192:195], v[16:19], v[112:115], 0
s_nop 2
v_mfma_f32_16x16x32_bf16 v[192:195], v[20:23], v[116:119], v[192:195]
v_max3_f32 v254, v254, v187, v188
v_max3_f32 v254, v254, v189, v190
v_mfma_f32_16x16x32_bf16 v[196:199], v[28:31], v[116:119], 0
s_nop 2
v_mfma_f32_16x16x32_bf16 v[196:199], v[24:27], v[112:115], v[196:199]
s_nop 0
v_max3_f32 v254, v254, v191, v192
v_max3_f32 v254, v254, v193, v194
v_mfma_f32_16x16x32_bf16 v[200:203], v[32:35], v[112:115], 0
s_nop 2
v_mfma_f32_16x16x32_bf16 v[200:203], v[36:39], v[116:119], v[200:203]
v_max3_f32 v254, v254, v195, v196
v_max3_f32 v254, v254, v197, v198
v_mfma_f32_16x16x32_bf16 v[204:207], v[44:47], v[116:119], 0
s_nop 2
v_mfma_f32_16x16x32_bf16 v[204:207], v[40:43], v[112:115], v[204:207]
s_nop 0
v_max3_f32 v254, v254, v199, v200
v_max3_f32 v254, v254, v201, v202
v_mfma_f32_16x16x32_bf16 v[208:211], v[48:51], v[112:115], 0
s_nop 2
v_mfma_f32_16x16x32_bf16 v[208:211], v[52:55], v[116:119], v[208:211]
v_max3_f32 v254, v254, v203, v204
v_max3_f32 v254, v254, v205, v206
v_mfma_f32_16x16x32_bf16 v[212:215], v[56:59], v[136:139], 0
s_nop 2
v_mfma_f32_16x16x32_bf16 v[212:215], v[104:107], v[148:151], v[212:215]
s_nop 0
v_max3_f32 v254, v254, v207, v208
v_mfma_f32_16x16x32_bf16 v[212:215], v[72:75], v[140:143], v[212:215]
ds_swizzle_b32 v255, v254 offset:0x401F
v_mfma_f32_16x16x32_bf16 v[212:215], v[88:91], v[144:147], v[212:215]
s_nop 2
v_mfma_f32_16x16x32_bf16 v[216:219], v[92:95], v[144:147], 0
s_nop 2
v_mfma_f32_16x16x32_bf16 v[216:219], v[76:79], v[140:143], v[216:219]
v_fmac_f32 v169, v213, v252
v_fmac_f32 v168, v212, v252
v_mfma_f32_16x16x32_bf16 v[216:219], v[106:109], v[148:151], v[216:219]
v_fmac_f32 v171, v215, v252
v_fmac_f32 v170, v214, v252
v_mfma_f32_16x16x32_bf16 v[216:219], v[60:63], v[136:139], v[216:219]
ds_read_b128 v[220:223], v236 offset:12672
ds_read_b128 v[224:227], v236 offset:12928
v_mfma_f32_16x16x32_bf16 v[228:231], v[64:67], v[136:139], 0
s_waitcnt lgkmcnt(2)
ds_read_b128 v[212:215], v236 offset:13184
v_cvt_pk_bf16_f32 v168, v168, v169
v_mfma_f32_16x16x32_bf16 v[228:231], v[108:111], v[148:151], v[228:231]
s_nop 0
v_fmac_f32 v172, v216, v252
v_fmac_f32 v174, v218, v252
v_mfma_f32_16x16x32_bf16 v[228:231], v[80:83], v[140:143], v[228:231]
v_fmac_f32 v173, v217, v252
v_fmac_f32 v175, v219, v252
v_mfma_f32_16x16x32_bf16 v[228:231], v[96:99], v[144:147], v[228:231]
ds_read_b128 v[216:219], v236 offset:13440
v_cvt_pk_bf16_f32 v169, v170, v171
v_mfma_f32_16x16x32_bf16 v[232:235], v[100:103], v[144:147], 0
v_cvt_pk_bf16_f32 v170, v172, v173
v_cvt_pk_bf16_f32 v171, v174, v175
v_mfma_f32_16x16x32_bf16 v[232:235], v[84:87], v[140:143], v[232:235]
s_waitcnt lgkmcnt(2)
v_pk_max_i16 v170, v170, 0
v_fmac_f32 v178, v230, v252
v_mfma_f32_16x16x32_bf16 v[232:235], v[110:113], v[148:151], v[232:235]
s_waitcnt lgkmcnt(1)
v_fmac_f32 v179, v231, v252
v_fmac_f32 v176, v228, v252
v_mfma_f32_16x16x32_bf16 v[232:235], v[68:71], v[136:139], v[232:235]
v_fmac_f32 v177, v229, v252
v_cvt_pk_bf16_f32 v176, v176, v177
v_mfma_f32_16x16x32_bf16 v[228:231], a[0:3], v[220:223], 0
v_cvt_pk_bf16_f32 v177, v178, v179
v_pk_max_i16 v169, v169, 0
v_mfma_f32_16x16x32_bf16 v[228:231], a[4:7], v[224:227], v[228:231]
s_waitcnt lgkmcnt(0)
v_pk_max_i16 v171, v171, 0
v_fmac_f32 v182, v234, v252
v_mfma_f32_16x16x32_bf16 v[228:231], a[8:11], v[212:215], v[228:231]
v_fmac_f32 v181, v233, v252
v_fmac_f32 v183, v235, v252
v_mfma_f32_16x16x32_bf16 v[228:231], a[12:15], v[216:219], v[228:231]
v_fmac_f32 v180, v232, v252
v_cvt_pk_bf16_f32 v179, v182, v183
v_mfma_f32_16x16x32_bf16 v[232:235], a[28:31], v[216:219], 0
v_cvt_pk_bf16_f32 v178, v180, v181
v_pk_max_i16 v178, v178, 0
v_mfma_f32_16x16x32_bf16 v[232:235], a[24:27], v[212:215], v[232:235]
v_pk_max_i16 v179, v179, 0
v_pk_max_i16 v176, v176, 0
v_mfma_f32_16x16x32_bf16 v[232:235], a[20:23], v[224:227], v[232:235]
v_cvt_pk_bf16_f32 v113, v230, v231
v_cvt_pk_bf16_f32 v112, v228, v229
v_mfma_f32_16x16x32_bf16 v[232:235], a[16:19], v[220:223], v[232:235]
v_pk_max_i16 v168, v168, 0
v_pk_max_i16 v177, v177, 0
v_mfma_f32_16x16x32_bf16 v[228:231], a[32:35], v[220:223], 0
buffer_store_dwordx4 v[168:171], v239, s[20:23], s53 offen offset:0 nt
buffer_store_dwordx4 v[176:179], v239, s[20:23], s53 offen offset:64 nt
v_add_u32 v236, s56, v236
v_max_f32 v254, v254, v255
s_sub_u32 s56, 0, s56
v_cvt_pk_bf16_f32 v115, v234, v235
v_cvt_pk_bf16_f32 v114, v232, v233
v_mfma_f32_16x16x32_bf16 v[228:231], a[36:39], v[224:227], v[228:231]
ds_bpermute_b32 v255, v247, v254
v_mfma_f32_16x16x32_bf16 v[228:231], a[40:43], v[212:215], v[228:231]
v_mfma_f32_16x16x32_bf16 v[228:231], a[44:47], v[216:219], v[228:231]
s_nop 2
v_mfma_f32_16x16x32_bf16 v[232:235], a[60:63], v[216:219], 0
s_nop 2
v_mfma_f32_16x16x32_bf16 v[232:235], a[56:59], v[212:215], v[232:235]
v_cvt_pk_bf16_f32 v116, v228, v229
v_cvt_pk_bf16_f32 v117, v230, v231
v_mfma_f32_16x16x32_bf16 v[232:235], a[52:55], v[224:227], v[232:235]
v_mfma_f32_16x16x32_bf16 v[232:235], a[48:51], v[220:223], v[232:235]
s_waitcnt lgkmcnt(0)
v_max_f32 v254, v254, v255
v_sub_f32 v184, v184, v254
v_mfma_f32_16x16x32_bf16 v[168:171], a[192:195], v[220:223], 0
v_exp_f32 v184, v184
v_mfma_f32_16x16x32_bf16 v[168:171], a[196:199], v[224:227], v[168:171]
v_sub_f32 v185, v185, v254
v_sub_f32 v186, v186, v254
v_mfma_f32_16x16x32_bf16 v[168:171], a[200:203], v[212:215], v[168:171]
v_cvt_pk_bf16_f32 v119, v234, v235
v_cvt_pk_bf16_f32 v118, v232, v233
v_mfma_f32_16x16x32_bf16 v[168:171], a[204:207], v[216:219], v[168:171]
v_exp_f32 v186, v186
v_mfma_f32_16x16x32_bf16 v[172:175], a[220:223], v[216:219], 0
v_exp_f32 v185, v185
v_mfma_f32_16x16x32_bf16 v[172:175], a[216:219], v[212:215], v[172:175]
v_sub_f32 v189, v189, v254
v_sub_f32 v187, v187, v254
v_mfma_f32_16x16x32_bf16 v[172:175], a[212:215], v[224:227], v[172:175]
v_sub_f32 v188, v188, v254
v_sub_f32 v190, v190, v254
v_mfma_f32_16x16x32_bf16 v[172:175], a[208:211], v[220:223], v[172:175]
s_cmp_lg_u32 s45, 0
s_cbranch_scc1 L_loops
v_mfma_f32_16x16x32_bf16 v[176:179], a[224:227], v[220:223], 0
s_waitcnt vmcnt(8)
s_barrier
v_mfma_f32_16x16x32_bf16 v[176:179], a[228:231], v[224:227], v[176:179]
s_add_u32 s52, s47, 8192
ds_read_b128 v[232:235], v236 offset:0
v_add_f32 v248, v184, v185
v_mfma_f32_16x16x32_bf16 v[176:179], a[232:235], v[212:215], v[176:179]
s_add_u32 s53, s47, 12288
v_exp_f32 v188, v188
v_mfma_f32_16x16x32_bf16 v[176:179], a[236:239], v[216:219], v[176:179]
v_add_f32 v248, v248, v186
v_sub_f32 v191, v191, v254
v_mfma_f32_16x16x32_bf16 v[180:183], a[252:255], v[216:219], 0
v_exp_f32 v187, v187
v_mfma_f32_16x16x32_bf16 v[180:183], a[248:251], v[212:215], v[180:183]
v_exp_f32 v190, v190
v_mfma_f32_16x16x32_bf16 v[180:183], a[244:247], v[224:227], v[180:183]
v_add_f32 v248, v248, v187
v_add_f32 v248, v248, v188
v_mfma_f32_16x16x32_bf16 v[180:183], a[240:243], v[220:223], v[180:183]
s_waitcnt lgkmcnt(0)
v_exp_f32 v189, v189
v_mfma_f32_16x16x32_bf16 v[228:231], v[0:3], v[112:115], 0
v_add_f32 v248, v248, v189
v_add_f32 v248, v248, v190
v_mfma_f32_16x16x32_bf16 v[228:231], v[4:7], v[116:119], v[228:231]
v_exp_f32 v191, v191
v_cvt_pk_bf16_f32 v122, v188, v189
v_add_f32 v248, v248, v191
v_cvt_pk_bf16_f32 v123, v190, v191
v_mfma_f32_16x16x32_bf16 v[188:191], v[12:15], v[116:119], 0
v_sub_f32 v193, v193, v254
v_sub_f32 v194, v194, v254
v_mfma_f32_16x16x32_bf16 v[188:191], v[8:11], v[112:115], v[188:191]
v_sub_f32 v195, v195, v254
v_exp_f32 v194, v194
v_sub_f32 v192, v192, v254
v_exp_f32 v192, v192
v_sub_f32 v196, v196, v254
v_exp_f32 v193, v193
v_sub_f32 v197, v197, v254
v_sub_f32 v199, v199, v254
v_sub_f32 v198, v198, v254
v_exp_f32 v195, v195
v_add_f32 v248, v248, v192
v_add_f32 v248, v248, v193
v_exp_f32 v196, v196
v_exp_f32 v197, v197
v_add_f32 v248, v248, v194
v_add_f32 v248, v248, v195
v_add_f32 v248, v248, v196
v_add_f32 v248, v248, v197
v_exp_f32 v198, v198
v_sub_f32 v200, v200, v254
v_sub_f32 v203, v203, v254
v_exp_f32 v199, v199
v_sub_f32 v201, v201, v254
v_exp_f32 v201, v201
v_sub_f32 v202, v202, v254
v_exp_f32 v202, v202
v_add_f32 v248, v248, v198
v_exp_f32 v200, v200
v_add_f32 v248, v248, v199
v_add_f32 v248, v248, v200
v_add_f32 v248, v248, v201
v_exp_f32 v203, v203
v_add_f32 v248, v248, v202
v_add_f32 v248, v248, v203
v_cvt_pk_bf16_f32 v128, v200, v201
v_cvt_pk_bf16_f32 v129, v202, v203
v_mfma_f32_16x16x32_bf16 v[200:203], v[16:19], v[112:115], 0
v_sub_f32 v204, v204, v254
v_sub_f32 v205, v205, v254
v_mfma_f32_16x16x32_bf16 v[200:203], v[20:23], v[116:119], v[200:203]
v_exp_f32 v204, v204
v_sub_f32 v206, v206, v254
v_add_f32 v248, v248, v204
v_exp_f32 v206, v206
v_sub_f32 v207, v207, v254
v_exp_f32 v205, v205
v_exp_f32 v207, v207
v_add_f32 v248, v248, v205
v_add_f32 v248, v248, v206
v_add_f32 v248, v248, v207
v_cvt_pk_bf16_f32 v130, v204, v205
v_cvt_pk_bf16_f32 v131, v206, v207
v_mfma_f32_16x16x32_bf16 v[204:207], v[28:31], v[116:119], 0
v_sub_f32 v208, v208, v254
v_cvt_pk_bf16_f32 v120, v184, v185
v_mfma_f32_16x16x32_bf16 v[204:207], v[24:27], v[112:115], v[204:207]
v_exp_f32 v208, v208
s_nop 0
v_add_f32 v248, v248, v208
v_cvt_pk_bf16_f32 v132, v208, 0
v_mfma_f32_16x16x32_bf16 v[208:211], v[32:35], v[112:115], 0
ds_swizzle_b32 v250, v248 offset:0x401F
v_cvt_pk_bf16_f32 v121, v186, v187
v_mfma_f32_16x16x32_bf16 v[208:211], v[36:39], v[116:119], v[208:211]
ds_read_b128 v[184:187], v236 offset:256
v_cvt_pk_bf16_f32 v126, v196, v197
v_mfma_f32_16x16x32_bf16 v[212:215], v[44:47], v[116:119], 0
v_cvt_pk_bf16_f32 v125, v194, v195
v_cvt_pk_bf16_f32 v127, v198, v199
v_mfma_f32_16x16x32_bf16 v[212:215], v[40:43], v[112:115], v[212:215]
ds_read_b128 v[196:199], v236 offset:768
v_cvt_pk_bf16_f32 v124, v192, v193
v_mfma_f32_16x16x32_bf16 v[216:219], v[48:51], v[112:115], 0
ds_read_b128 v[192:195], v236 offset:512
v_max3_f32 v254, v228, v229, v230
v_mfma_f32_16x16x32_bf16 v[216:219], v[52:55], v[116:119], v[216:219]
v_max3_f32 v254, v254, v231, v188
v_max3_f32 v254, v254, v189, v190
v_mfma_f32_16x16x32_bf16 v[220:223], v[56:59], v[120:123], 0
s_waitcnt lgkmcnt(3)
v_add_f32 v248, v248, v250
v_max3_f32 v254, v254, v191, v200
v_mfma_f32_16x16x32_bf16 v[220:223], v[104:107], v[132:135], v[220:223]
s_waitcnt lgkmcnt(2)
ds_bpermute_b32 v250, v247, v248
v_mfma_f32_16x16x32_bf16 v[220:223], v[72:75], v[124:127], v[220:223]
v_max3_f32 v254, v254, v201, v202
v_max3_f32 v254, v254, v203, v204
v_mfma_f32_16x16x32_bf16 v[220:223], v[88:91], v[128:131], v[220:223]
s_waitcnt lgkmcnt(2)
v_max3_f32 v254, v254, v205, v206
v_max3_f32 v254, v254, v207, v208
v_mfma_f32_16x16x32_bf16 v[224:227], v[92:95], v[128:131], 0
s_waitcnt lgkmcnt(1)
v_max3_f32 v254, v254, v209, v210
v_max3_f32 v254, v254, v211, v212
v_mfma_f32_16x16x32_bf16 v[224:227], v[76:79], v[124:127], v[224:227]
v_max3_f32 v254, v254, v213, v214
v_max3_f32 v254, v254, v215, v216
v_mfma_f32_16x16x32_bf16 v[224:227], v[106:109], v[132:135], v[224:227]
ds_swizzle_b32 v255, v254 offset:0x401F
v_mbcnt_lo_u32_b32 v242, -1, 0
v_mfma_f32_16x16x32_bf16 v[224:227], v[60:63], v[120:123], v[224:227]
s_waitcnt lgkmcnt(1)
v_add_f32 v248, v248, v250
v_rcp_f32 v251, v248
s_nop 0
v_fmac_f32 v152, v220, v251
v_fmac_f32 v153, v221, v251
v_fmac_f32 v154, v222, v251
v_fmac_f32 v155, v223, v251
v_mfma_f32_16x16x32_bf16 v[220:223], v[64:67], v[120:123], 0
v_fmac_f32 v156, v224, v251
v_fmac_f32 v157, v225, v251
v_mfma_f32_16x16x32_bf16 v[220:223], v[108:111], v[132:135], v[220:223]
v_fmac_f32 v158, v226, v251
v_fmac_f32 v159, v227, v251
v_mfma_f32_16x16x32_bf16 v[220:223], v[80:83], v[124:127], v[220:223]
s_waitcnt lgkmcnt(0)
v_cvt_pk_bf16_f32 v152, v152, v153
v_cvt_pk_bf16_f32 v153, v154, v155
v_mfma_f32_16x16x32_bf16 v[220:223], v[96:99], v[128:131], v[220:223]
v_cvt_pk_bf16_f32 v154, v156, v157
v_cvt_pk_bf16_f32 v155, v158, v159
v_mfma_f32_16x16x32_bf16 v[224:227], v[100:103], v[128:131], 0
v_pk_max_i16 v152, v152, 0
v_pk_max_i16 v153, v153, 0
v_mfma_f32_16x16x32_bf16 v[224:227], v[84:87], v[124:127], v[224:227]
v_max_f32 v254, v254, v255
v_pk_max_i16 v154, v154, 0
v_mfma_f32_16x16x32_bf16 v[224:227], v[110:113], v[132:135], v[224:227]
ds_bpermute_b32 v255, v247, v254
v_mfma_f32_16x16x32_bf16 v[224:227], v[68:71], v[120:123], v[224:227]
v_fmac_f32 v160, v220, v251
v_fmac_f32 v161, v221, v251
v_mfma_f32_16x16x32_bf16 v[0:3], a[192:195], v[232:235], 0
v_fmac_f32 v162, v222, v251
v_fmac_f32 v163, v223, v251
v_mfma_f32_16x16x32_bf16 v[0:3], a[196:199], v[184:187], v[0:3]
v_cvt_pk_bf16_f32 v160, v160, v161
v_cvt_pk_bf16_f32 v161, v162, v163
v_mfma_f32_16x16x32_bf16 v[0:3], a[200:203], v[192:195], v[0:3]
v_fmac_f32 v164, v224, v251
v_fmac_f32 v165, v225, v251
v_mfma_f32_16x16x32_bf16 v[0:3], a[204:207], v[196:199], v[0:3]
v_fmac_f32 v166, v226, v251
v_fmac_f32 v167, v227, v251
v_mfma_f32_16x16x32_bf16 v[4:7], a[220:223], v[196:199], 0
s_waitcnt lgkmcnt(0)
v_max_f32 v254, v254, v255
v_sub_f32 v228, v228, v254
v_mfma_f32_16x16x32_bf16 v[4:7], a[216:219], v[192:195], v[4:7]
v_sub_f32 v229, v229, v254
v_sub_f32 v230, v230, v254
v_mfma_f32_16x16x32_bf16 v[4:7], a[212:215], v[184:187], v[4:7]
v_exp_f32 v228, v228
v_mfma_f32_16x16x32_bf16 v[4:7], a[208:211], v[232:235], v[4:7]
ds_read_b128 v[220:223], v236 offset:4224
v_sub_f32 v231, v231, v254
v_mfma_f32_16x16x32_bf16 v[8:11], a[224:227], v[232:235], 0
v_exp_f32 v229, v229
v_mfma_f32_16x16x32_bf16 v[8:11], a[228:231], v[184:187], v[8:11]
v_exp_f32 v230, v230
v_mfma_f32_16x16x32_bf16 v[8:11], a[232:235], v[192:195], v[8:11]
v_exp_f32 v231, v231
v_mfma_f32_16x16x32_bf16 v[8:11], a[236:239], v[196:199], v[8:11]
v_add_f32 v249, v228, v229
v_add_f32 v249, v249, v230
v_mfma_f32_16x16x32_bf16 v[12:15], a[252:255], v[196:199], 0
ds_read_b128 v[196:199], v236 offset:4736
v_add_f32 v249, v249, v231
v_mfma_f32_16x16x32_bf16 v[12:15], a[248:251], v[192:195], v[12:15]
s_waitcnt lgkmcnt(1)
ds_read_b128 v[192:195], v236 offset:4992
v_cvt_pk_bf16_f32 v136, v228, v229
v_mfma_f32_16x16x32_bf16 v[12:15], a[244:247], v[184:187], v[12:15]
v_cvt_pk_bf16_f32 v137, v230, v231
v_sub_f32 v188, v188, v254
v_mfma_f32_16x16x32_bf16 v[12:15], a[240:243], v[232:235], v[12:15]
ds_read_b128 v[228:231], v236 offset:4480
v_sub_f32 v189, v189, v254
v_mfma_f32_16x16x32_bf16 v[16:19], a[192:195], v[220:223], 0
v_exp_f32 v188, v188
v_exp_f32 v189, v189
v_sub_f32 v190, v190, v254
v_cvt_pk_bf16_f32 v138, v188, v189
v_sub_f32 v191, v191, v254
v_exp_f32 v190, v190
v_exp_f32 v191, v191
v_sub_f32 v216, v216, v254
v_cvt_pk_bf16_f32 v139, v190, v191
v_exp_f32 v216, v216
v_sub_f32 v200, v200, v254
v_cvt_pk_bf16_f32 v148, v216, 0
s_waitcnt lgkmcnt(0)
v_mfma_f32_16x16x32_bf16 v[16:19], a[196:199], v[228:231], v[16:19]
v_sub_f32 v201, v201, v254
v_sub_f32 v202, v202, v254
v_mfma_f32_16x16x32_bf16 v[16:19], a[200:203], v[196:199], v[16:19]
v_exp_f32 v200, v200
v_mfma_f32_16x16x32_bf16 v[16:19], a[204:207], v[192:195], v[16:19]
v_exp_f32 v201, v201
v_mfma_f32_16x16x32_bf16 v[20:23], a[220:223], v[192:195], 0
v_exp_f32 v202, v202
v_mfma_f32_16x16x32_bf16 v[20:23], a[216:219], v[196:199], v[20:23]
v_sub_f32 v203, v203, v254
v_sub_f32 v204, v204, v254
v_mfma_f32_16x16x32_bf16 v[20:23], a[212:215], v[228:231], v[20:23]
v_exp_f32 v203, v203
v_mfma_f32_16x16x32_bf16 v[20:23], a[208:211], v[220:223], v[20:23]
v_exp_f32 v204, v204
v_mfma_f32_16x16x32_bf16 v[24:27], a[224:227], v[220:223], 0
v_sub_f32 v205, v205, v254
v_sub_f32 v206, v206, v254
v_mfma_f32_16x16x32_bf16 v[24:27], a[228:231], v[228:231], v[24:27]
v_exp_f32 v205, v205
v_mfma_f32_16x16x32_bf16 v[24:27], a[232:235], v[196:199], v[24:27]
v_exp_f32 v206, v206
v_mfma_f32_16x16x32_bf16 v[24:27], a[236:239], v[192:195], v[24:27]
v_sub_f32 v207, v207, v254
v_cvt_pk_bf16_f32 v140, v200, v201
v_mfma_f32_16x16x32_bf16 v[28:31], a[252:255], v[192:195], 0
v_exp_f32 v207, v207
v_mfma_f32_16x16x32_bf16 v[28:31], a[248:251], v[196:199], v[28:31]
v_cvt_pk_bf16_f32 v141, v202, v203
v_cvt_pk_bf16_f32 v142, v204, v205
v_mfma_f32_16x16x32_bf16 v[28:31], a[244:247], v[228:231], v[28:31]
v_cvt_pk_bf16_f32 v143, v206, v207
v_sub_f32 v208, v208, v254
v_mfma_f32_16x16x32_bf16 v[28:31], a[240:243], v[220:223], v[28:31]
v_sub_f32 v209, v209, v254
v_sub_f32 v210, v210, v254
v_mfma_f32_16x16x32_bf16 v[228:231], v[56:59], v[136:139], 0
v_exp_f32 v208, v208
v_mfma_f32_16x16x32_bf16 v[228:231], v[104:107], v[148:151], v[228:231]
v_exp_f32 v209, v209
v_mfma_f32_16x16x32_bf16 v[228:231], v[72:75], v[140:143], v[228:231]
v_exp_f32 v210, v210
v_sub_f32 v211, v211, v254
v_exp_f32 v211, v211
v_sub_f32 v212, v212, v254
v_exp_f32 v212, v212
v_sub_f32 v213, v213, v254
v_exp_f32 v213, v213
v_sub_f32 v214, v214, v254
v_exp_f32 v214, v214
v_sub_f32 v215, v215, v254
v_exp_f32 v215, v215
v_cvt_pk_bf16_f32 v144, v208, v209
v_cvt_pk_bf16_f32 v145, v210, v211
v_cvt_pk_bf16_f32 v146, v212, v213
v_cvt_pk_bf16_f32 v147, v214, v215
v_cvt_pk_bf16_f32 v162, v164, v165
v_cvt_pk_bf16_f32 v163, v166, v167
v_mfma_f32_16x16x32_bf16 v[228:231], v[88:91], v[144:147], v[228:231]
v_pk_max_i16 v155, v155, 0
v_pk_max_i16 v160, v160, 0
v_mfma_f32_16x16x32_bf16 v[192:195], v[92:95], v[144:147], 0
v_pk_max_i16 v161, v161, 0
v_pk_max_i16 v162, v162, 0
v_mfma_f32_16x16x32_bf16 v[192:195], v[76:79], v[140:143], v[192:195]
v_pk_max_i16 v163, v163, 0
v_mbcnt_hi_u32_b32 v242, -1, v242
v_mfma_f32_16x16x32_bf16 v[192:195], v[106:109], v[148:151], v[192:195]
buffer_store_dwordx4 v[152:155], v239, s[20:23], s52 offen offset:0 nt
buffer_store_dwordx4 v[160:163], v239, s[20:23], s52 offen offset:64 nt
s_mul_i32 s54, s41, 12288
s_add_u32 s54, s54, 105472
v_mov_b32 v244, s54
v_bfe_u32 v243, v242, 0, 4
v_lshl_add_u32 v244, v243, 7, v244
v_lshlrev_b32 v243, 4, v242
v_xor_b32 v243, v243, v242
v_and_b32 v243, 48, v243
v_mfma_f32_16x16x32_bf16 v[192:195], v[60:63], v[136:139], v[192:195]
v_add_u32 v244, v243, v244
v_add_u32 v244, v243, v244
v_mfma_f32_16x16x32_bf16 v[220:223], v[64:67], v[136:139], 0
ds_read_b128 v[184:187], v244 offset:0
ds_read_b128 v[232:235], v244 offset:16
v_mfma_f32_16x16x32_bf16 v[220:223], v[108:111], v[148:151], v[220:223]
ds_read_b128 v[196:199], v244 offset:2048
v_add_f32 v249, v249, v188
v_mfma_f32_16x16x32_bf16 v[220:223], v[80:83], v[140:143], v[220:223]
ds_read_b32 v188, v244 offset:4096
v_add_f32 v249, v249, v189
v_mfma_f32_16x16x32_bf16 v[220:223], v[96:99], v[144:147], v[220:223]
v_add_f32 v249, v249, v190
v_add_f32 v249, v249, v191
v_mfma_f32_16x16x32_bf16 v[224:227], v[100:103], v[144:147], 0
v_mov_b32 v245, 24576
v_bfe_u32 v243, v242, 0, 2
v_mfma_f32_16x16x32_bf16 v[224:227], v[84:87], v[140:143], v[224:227]
v_lshl_add_u32 v245, v243, 8, v245
v_bfe_u32 v243, v242, 2, 2
v_mfma_f32_16x16x32_bf16 v[224:227], v[110:113], v[148:151], v[224:227]
s_waitcnt lgkmcnt(2)
v_lshlrev_b32 v190, 16, v184
v_lshlrev_b32 v191, 16, v185
v_mfma_f32_16x16x32_bf16 v[224:227], v[68:71], v[136:139], v[224:227]
s_waitcnt lgkmcnt(1)
s_waitcnt lgkmcnt(0)
ds_swizzle_b32 v189, v188 offset:0x401F
v_and_b32 v184, 0xffff0000, v184
v_and_b32 v185, 0xffff0000, v185
v_mul_u32_u24 v243, 13107200, v243
v_add_u32 v245, v243, v245
s_lshl_b32 s48, s43, 7
s_add_u32 s48, s48, s44
s_add_u32 s48, s48, 0
v_bfe_u32 v243, v242, 4, 2
v_lshl_add_u32 v245, v243, 4, v245
v_add_f32 v249, v249, v200
v_add_f32 v249, v249, v201
v_add_f32 v249, v249, v202
v_add_f32 v249, v249, v203
ds_read_b128 v[200:203], v244 offset:2064
v_add_f32 v249, v249, v204
ds_read_b32 v204, v244 offset:6144
v_add_f32 v249, v249, v205
v_add_f32 v249, v249, v206
v_add_f32 v249, v249, v207
v_add_f32 v249, v249, v208
v_add_f32 v249, v249, v209
v_add_f32 v249, v249, v210
v_add_f32 v249, v249, v211
v_add_f32 v249, v249, v212
v_add_f32 v249, v249, v213
v_add_f32 v249, v249, v214
v_add_f32 v249, v249, v215
v_add_f32 v249, v249, v216
ds_swizzle_b32 v250, v249 offset:0x401F
v_lshlrev_b32 v206, 16, v196
v_lshlrev_b32 v207, 16, v197
v_and_b32 v196, 0xffff0000, v196
v_and_b32 v197, 0xffff0000, v197
s_waitcnt lgkmcnt(1)
ds_swizzle_b32 v205, v204 offset:0x401F
v_add_f32 v188, v188, v189
ds_bpermute_b32 v189, v247, v188
s_lshl_b32 s51, s43, 7
s_add_u32 s51, s51, s44
s_add_u32 s51, s51, 52428800
s_waitcnt lgkmcnt(2)
v_add_f32 v249, v249, v250
ds_bpermute_b32 v250, v247, v249
s_waitcnt lgkmcnt(2)
v_add_f32 v204, v204, v205
ds_bpermute_b32 v205, v247, v204
s_waitcnt lgkmcnt(2)
v_add_f32 v188, v188, v189
v_rcp_f32 v189, v188
s_nop 0
v_fmac_f32 v0, v190, v189
v_fmac_f32 v2, v191, v189
v_lshlrev_b32 v190, 16, v186
v_lshlrev_b32 v191, 16, v187
v_fmac_f32 v4, v190, v189
v_fmac_f32 v6, v191, v189
v_lshlrev_b32 v190, 16, v232
v_lshlrev_b32 v191, 16, v233
v_and_b32 v232, 0xffff0000, v232
v_fmac_f32 v8, v190, v189
v_fmac_f32 v10, v191, v189
v_fmac_f32 v1, v184, v189
v_fmac_f32 v9, v232, v189
v_and_b32 v233, 0xffff0000, v233
v_lshlrev_b32 v190, 16, v234
v_lshlrev_b32 v191, 16, v235
v_fmac_f32 v3, v185, v189
v_and_b32 v186, 0xffff0000, v186
v_and_b32 v187, 0xffff0000, v187
v_fmac_f32 v11, v233, v189
v_and_b32 v234, 0xffff0000, v234
v_and_b32 v235, 0xffff0000, v235
v_cvt_pk_bf16_f32 v0, v0, v1
v_cvt_pk_bf16_f32 v8, v8, v9
v_fmac_f32 v5, v186, v189
v_fmac_f32 v7, v187, v189
v_fmac_f32 v12, v190, v189
v_fmac_f32 v13, v234, v189
v_fmac_f32 v14, v191, v189
v_fmac_f32 v15, v235, v189
v_cvt_pk_bf16_f32 v1, v2, v3
v_cvt_pk_bf16_f32 v9, v10, v11
v_cvt_pk_bf16_f32 v2, v4, v5
v_cvt_pk_bf16_f32 v3, v6, v7
v_cvt_pk_bf16_f32 v10, v12, v13
v_cvt_pk_bf16_f32 v11, v14, v15
v_pk_max_i16 v0, v0, 0
v_pk_max_i16 v1, v1, 0
v_pk_max_i16 v2, v2, 0
v_pk_max_i16 v3, v3, 0
v_pk_max_i16 v8, v8, 0
v_pk_max_i16 v9, v9, 0
v_pk_max_i16 v10, v10, 0
v_pk_max_i16 v11, v11, 0
buffer_store_dwordx4 v[0:3], v245, s[20:23], s48 offen offset:0 nt
buffer_store_dwordx4 v[8:11], v245, s[20:23], s48 offen offset:64 nt
s_waitcnt lgkmcnt(1)
v_add_f32 v249, v249, v250
v_rcp_f32 v252, v249
s_nop 0
v_fmac_f32 v168, v228, v252
v_fmac_f32 v169, v229, v252
v_fmac_f32 v176, v220, v252
v_fmac_f32 v177, v221, v252
v_fmac_f32 v170, v230, v252
v_fmac_f32 v171, v231, v252
v_cvt_pk_bf16_f32 v168, v168, v169
v_fmac_f32 v178, v222, v252
v_fmac_f32 v179, v223, v252
v_cvt_pk_bf16_f32 v176, v176, v177
v_fmac_f32 v172, v192, v252
v_fmac_f32 v173, v193, v252
v_fmac_f32 v174, v194, v252
v_fmac_f32 v175, v195, v252
v_cvt_pk_bf16_f32 v169, v170, v171
v_fmac_f32 v180, v224, v252
v_fmac_f32 v181, v225, v252
v_fmac_f32 v182, v226, v252
v_fmac_f32 v183, v227, v252
v_cvt_pk_bf16_f32 v177, v178, v179
v_cvt_pk_bf16_f32 v170, v172, v173
v_cvt_pk_bf16_f32 v171, v174, v175
v_cvt_pk_bf16_f32 v178, v180, v181
v_cvt_pk_bf16_f32 v179, v182, v183
v_pk_max_i16 v168, v168, 0
v_pk_max_i16 v169, v169, 0
v_pk_max_i16 v170, v170, 0
v_pk_max_i16 v171, v171, 0
v_pk_max_i16 v176, v176, 0
v_pk_max_i16 v177, v177, 0
v_pk_max_i16 v178, v178, 0
v_pk_max_i16 v179, v179, 0
buffer_store_dwordx4 v[168:171], v239, s[20:23], s53 offen offset:0 nt
buffer_store_dwordx4 v[176:179], v239, s[20:23], s53 offen offset:64 nt
s_waitcnt lgkmcnt(0)
v_add_f32 v204, v204, v205
v_rcp_f32 v205, v204
s_nop 0
v_fmac_f32 v16, v206, v205
v_fmac_f32 v18, v207, v205
v_lshlrev_b32 v206, 16, v198
v_lshlrev_b32 v207, 16, v199
v_fmac_f32 v20, v206, v205
v_fmac_f32 v22, v207, v205
v_lshlrev_b32 v206, 16, v200
v_lshlrev_b32 v207, 16, v201
v_and_b32 v200, 0xffff0000, v200
v_fmac_f32 v24, v206, v205
v_fmac_f32 v26, v207, v205
v_fmac_f32 v17, v196, v205
v_fmac_f32 v25, v200, v205
v_and_b32 v201, 0xffff0000, v201
v_lshlrev_b32 v206, 16, v202
v_lshlrev_b32 v207, 16, v203
v_fmac_f32 v19, v197, v205
v_and_b32 v198, 0xffff0000, v198
v_and_b32 v199, 0xffff0000, v199
v_fmac_f32 v27, v201, v205
v_and_b32 v202, 0xffff0000, v202
v_and_b32 v203, 0xffff0000, v203
v_cvt_pk_bf16_f32 v16, v16, v17
v_cvt_pk_bf16_f32 v24, v24, v25
v_fmac_f32 v21, v198, v205
v_fmac_f32 v23, v199, v205
v_fmac_f32 v28, v206, v205
v_fmac_f32 v29, v202, v205
v_fmac_f32 v30, v207, v205
v_fmac_f32 v31, v203, v205
v_cvt_pk_bf16_f32 v17, v18, v19
v_cvt_pk_bf16_f32 v25, v26, v27
v_cvt_pk_bf16_f32 v18, v20, v21
v_cvt_pk_bf16_f32 v19, v22, v23
v_cvt_pk_bf16_f32 v26, v28, v29
v_cvt_pk_bf16_f32 v27, v30, v31
v_pk_max_i16 v16, v16, 0
v_pk_max_i16 v17, v17, 0
v_pk_max_i16 v18, v18, 0
v_pk_max_i16 v19, v19, 0
v_pk_max_i16 v24, v24, 0
v_pk_max_i16 v25, v25, 0
v_pk_max_i16 v26, v26, 0
v_pk_max_i16 v27, v27, 0
buffer_store_dwordx4 v[16:19], v245, s[20:23], s51 offen offset:0 nt
buffer_store_dwordx4 v[24:27], v245, s[20:23], s51 offen offset:64 nt
L_end:
s_endpgm
.section .rodata,"a"
.p2align 6
.amdhsa_kernel standalone__attention_interact_autoint__recsys_kernel
  .amdhsa_next_free_vgpr 512
  .amdhsa_next_free_sgpr 102
  .amdhsa_accum_offset 256
  .amdhsa_group_segment_fixed_size 0
  .amdhsa_kernarg_size 64
  .amdhsa_user_sgpr_count 2
  .amdhsa_user_sgpr_kernarg_segment_ptr 1
  .amdhsa_system_sgpr_workgroup_id_x 1
.end_amdhsa_kernel
```

```asm
; @launch grid=(256,1,1) block=(256,1,1) lds=163840
.amdgcn_target "amdgcn-amd-amdhsa--gfx950"
.text
.globl standalone__attention_interact_autoint__recsys_kernel
.p2align 8
.type standalone__attention_interact_autoint__recsys_kernel,@function
standalone__attention_interact_autoint__recsys_kernel:
s_cmp_ge_u32 s2, 256
s_cbranch_scc1 L_end
s_load_dwordx2 s[24:25], s[0:1], 8
s_load_dwordx2 s[16:17], s[0:1], 0
s_load_dwordx2 s[28:29], s[0:1], 16
s_load_dwordx2 s[32:33], s[0:1], 24
s_load_dwordx2 s[36:37], s[0:1], 32
s_load_dwordx2 s[20:21], s[0:1], 40
s_getpc_b64 s[58:59]
L_pc:
s_lshl_b32 s3, s2, 8
s_and_b32 s3, s3, 0x7800
v_lshrrev_b32 v2, 4, v0
v_lshl_add_u32 v2, v2, 7, s3
v_min_u32 v2, L_fast_end-L_pc-4, v2
global_load_dword v96, v2, s[58:59]
v_lshrrev_b32 v1, 6, v0
s_mov_b32 s19, 0x20000
v_readfirstlane_b32 s41, v1
s_mov_b32 s18, 104857600
s_mov_b32 s26, 32768
s_mov_b32 s27, s19
s_lshr_b32 s42, s41, 1
s_and_b32 s43, s41, 1
s_lshl1_add_u32 s44, s2, s42
s_mul_i32 s44, s44, 25600
s_mov_b64 s[30:31], s[26:27]
s_mov_b64 s[34:35], s[26:27]
s_mov_b64 s[38:39], s[26:27]
s_lshl_b32 s54, s41, 13
s_mul_i32 s49, s42, 25344
s_mul_i32 s53, s43, 1056
s_add_u32 s49, s49, s53
s_lshl_b32 s55, s43, 10
s_add_u32 s55, s55, s44
s_lshl_b32 s6, s2, 7
s_and_b32 s6, s6, 0x7c00
s_add_u32 s57, s54, 4096
s_add_u32 m0, s49, 21120
s_add_u32 s48, s55, 20480
v_and_b32 v168, 63, v0
v_lshlrev_b32 v175, 4, v168
v_and_b32 v243, 48, v175
v_and_b32 v169, 48, v168
v_lshl_add_u32 v243, v169, 2, v243
v_and_b32 v169, 12, v168
v_lshl_add_u32 v243, v169, 6, v243
v_lshrrev_b32 v169, 5, v0
v_lshlrev_b32 v169, 7, v169
s_waitcnt lgkmcnt(0)
buffer_load_dword v97, v169, s[24:27], s6 offen
buffer_load_dword v98, v169, s[28:31], s6 offen
buffer_load_dword v99, v169, s[32:35], s6 offen
buffer_load_dword v100, v169, s[36:39], s6 offen
buffer_load_dwordx4 v[104:107], v175, s[24:27], s54 offen offset:0
buffer_load_dwordx4 v[108:111], v175, s[24:27], s54 offen offset:1024
buffer_load_dwordx4 v[112:115], v175, s[24:27], s54 offen offset:2048
buffer_load_dwordx4 v[116:119], v175, s[24:27], s54 offen offset:3072
buffer_load_dwordx4 v[120:123], v175, s[24:27], s57 offen offset:0
buffer_load_dwordx4 v[124:127], v175, s[24:27], s57 offen offset:1024
buffer_load_dwordx4 v[128:131], v175, s[24:27], s57 offen offset:2048
buffer_load_dwordx4 v[132:135], v175, s[24:27], s57 offen offset:3072
s_mov_b32 s40, 0x3e38aa3b
s_mov_b32 s22, s18
s_mov_b32 s23, s19
s_mov_b32 s45, 8
s_mov_b32 s3, 64
s_mov_b32 s46, s44
s_mov_b32 s47, 0x7ff00000
s_mov_b32 s56, 50688
s_mov_b32 s96, 0x3b8265d9
s_mov_b32 s97, 0
s_mul_i32 s98, s42, 25344
s_lshl_b32 s53, s43, 13
s_add_u32 s98, s98, s53
s_add_u32 s53, s98, 4224
v_and_b32 v169, 16, v168
v_lshlrev_b32 v180, 2, v169
v_lshlrev_b32 v169, 1, v169
v_xor_b32 v170, v175, v169
v_add_u32 v172, s53, v170
v_xor_b32 v171, 64, v170
v_add_u32 v173, s53, v171
s_mul_i32 s53, s43, 25344
s_add_u32 s7, s53, 4224
v_lshrrev_b32 v82, 4, v168
v_lshl_add_u32 v176, v82, 10, s7
v_bfe_u32 v83, v168, 2, 2
v_lshl_add_u32 v176, v83, 7, v176
v_bfe_u32 v84, v168, 3, 1
v_lshl_add_u32 v176, v84, 5, v176
v_bfe_u32 v85, v168, 4, 1
v_lshl_add_u32 v176, v85, 6, v176
v_and_b32 v86, 3, v168
v_lshl_add_u32 v176, v86, 3, v176
v_xor_b32 v177, 32, v176
v_xor_b32 v178, 64, v176
s_mul_i32 s53, s42, 25344
v_lshl_add_u32 v242, v86, 6, s53
v_lshl_add_u32 v242, v82, 4, v242
s_mov_b32 s6, 1056
v_mad_u32_u24 v242, v83, s6, v242
v_xor_b32 v179, 96, v176
s_mul_i32 s4, s43, 13107200
s_add_u32 s4, s4, s44
s_add_u32 s4, s4, 24576
s_mul_i32 s5, s43, -52424704
s_add_u32 s5, s5, 104833024
s_add_u32 s99, s4, 0
s_add_u32 s100, s4, 26212288
v_lshrrev_b32 v80, 3, v168
v_lshlrev_b32 v174, 8, v80
v_and_b32 v81, 7, v168
v_lshl_add_u32 v174, v81, 4, v174
v_xor_b32 v174, v174, v180
v_xor_b32 v180, v175, v180
s_mul_i32 s53, s41, 816
s_add_u32 s53, s53, 157696
v_and_b32 v88, 1, v168
v_lshl_add_u32 v249, v83, 6, s53
v_lshl_add_u32 v249, v88, 5, v249
s_add_u32 s8, s53, 256
s_mov_b32 vcc_lo, 0x33333333
s_mov_b32 vcc_hi, 0xcccccccc
v_lshl_add_u32 v249, v85, 4, v249
v_mov_b32 v166, s8
v_cndmask_b32 v249, v166, v249, vcc
s_add_u32 s9, s53, 256
v_lshl_add_u32 v166, v83, 2, s9
s_mov_b32 s8, 272
v_lshl_add_u32 v248, v82, 6, s53
v_mov_b32 v236, 0
v_mad_u32_u24 v166, v86, s8, v166
s_lshl_b32 s53, s41, 8
s_add_u32 s10, s53, 101376
ds_write_b32 v166, v236 offset:0
s_add_u32 s58, s53, 36096
s_xor_b32 s59, s53, 256
s_add_u32 s59, s59, 36096
v_lshl_add_u32 v166, v168, 2, s10
v_bfe_u32 v87, v168, 1, 1
v_lshl_add_u32 v248, v87, 5, v248
v_lshl_add_u32 v248, v83, 3, v248
v_lshl_add_u32 v248, v88, 1, v248
ds_write_b32 v166, v166 offset:0
s_mov_b64 exec, 0
s_cmp_eq_u32 s41, 0
s_cbranch_scc1 L_h0
s_cmp_eq_u32 s41, 1
s_cbranch_scc1 L_h1
s_cmp_eq_u32 s41, 2
s_cbranch_scc1 L_h2
s_branch L_h3
L_ret:
s_mov_b64 exec, -1
buffer_load_dwordx4 v243, s[16:19], s48 offen nt lds
s_add_u32 m0, s49, 23232
s_add_u32 s48, s55, 22528
buffer_load_dwordx4 v243, s[16:19], s48 offen nt lds
s_add_u32 m0, s49, 0
s_add_u32 s48, s55, 0
buffer_load_dwordx4 v243, s[16:19], s48 offen nt lds
s_add_u32 m0, s49, 2112
s_add_u32 s48, s55, 2048
buffer_load_dwordx4 v243, s[16:19], s48 offen nt lds
s_add_u32 m0, s98, 102400
s_waitcnt vmcnt(11)
v_and_b32 v160, 0xffff0000, v104
v_and_b32 v161, 0xffff0000, v105
v_and_b32 v162, 0xffff0000, v106
v_and_b32 v163, 0xffff0000, v107
v_lshlrev_b32 v104, 16, v104
v_lshlrev_b32 v105, 16, v105
v_lshlrev_b32 v106, 16, v106
v_lshlrev_b32 v107, 16, v107
v_mul_f32 v160, s40, v160
v_mul_f32 v104, s40, v104
v_mul_f32 v161, s40, v161
v_mul_f32 v105, s40, v105
v_mul_f32 v162, s40, v162
v_mul_f32 v106, s40, v106
v_mul_f32 v163, s40, v163
v_mul_f32 v107, s40, v107
v_cvt_pk_bf16_f32 v104, v104, v160
v_cvt_pk_bf16_f32 v105, v105, v161
v_cvt_pk_bf16_f32 v106, v106, v162
v_cvt_pk_bf16_f32 v107, v107, v163
ds_write_b128 v172, v[104:107] offset:0
buffer_load_dwordx4 v170, s[28:31], s54 offen offset:0 lds
buffer_load_dwordx4 v171, s[28:31], s54 offen offset:1024 lds
s_waitcnt vmcnt(12)
v_and_b32 v160, 0xffff0000, v108
v_and_b32 v161, 0xffff0000, v109
v_and_b32 v162, 0xffff0000, v110
v_and_b32 v163, 0xffff0000, v111
v_lshlrev_b32 v108, 16, v108
v_lshlrev_b32 v109, 16, v109
v_lshlrev_b32 v110, 16, v110
v_lshlrev_b32 v111, 16, v111
v_mul_f32 v160, s40, v160
v_mul_f32 v108, s40, v108
v_mul_f32 v161, s40, v161
v_mul_f32 v109, s40, v109
v_mul_f32 v162, s40, v162
v_mul_f32 v110, s40, v110
v_mul_f32 v163, s40, v163
v_mul_f32 v111, s40, v111
v_cvt_pk_bf16_f32 v108, v108, v160
v_cvt_pk_bf16_f32 v109, v109, v161
v_cvt_pk_bf16_f32 v110, v110, v162
v_cvt_pk_bf16_f32 v111, v111, v163
ds_write_b128 v173, v[108:111] offset:1024
buffer_load_dwordx4 v170, s[28:31], s54 offen offset:2048 lds
buffer_load_dwordx4 v171, s[28:31], s54 offen offset:3072 lds
s_add_u32 m0, s98, 106496
s_waitcnt vmcnt(13)
v_and_b32 v160, 0xffff0000, v112
v_and_b32 v161, 0xffff0000, v113
v_and_b32 v162, 0xffff0000, v114
v_and_b32 v163, 0xffff0000, v115
v_lshlrev_b32 v112, 16, v112
v_lshlrev_b32 v113, 16, v113
v_lshlrev_b32 v114, 16, v114
v_lshlrev_b32 v115, 16, v115
v_mul_f32 v160, s40, v160
v_mul_f32 v112, s40, v112
v_mul_f32 v161, s40, v161
v_mul_f32 v113, s40, v113
v_mul_f32 v162, s40, v162
v_mul_f32 v114, s40, v114
v_mul_f32 v163, s40, v163
v_mul_f32 v115, s40, v115
v_cvt_pk_bf16_f32 v112, v112, v160
v_cvt_pk_bf16_f32 v113, v113, v161
v_cvt_pk_bf16_f32 v114, v114, v162
v_cvt_pk_bf16_f32 v115, v115, v163
ds_write_b128 v172, v[112:115] offset:2048
buffer_load_dwordx4 v170, s[28:31], s57 offen offset:0 lds
buffer_load_dwordx4 v171, s[28:31], s57 offen offset:1024 lds
s_waitcnt vmcnt(14)
v_and_b32 v160, 0xffff0000, v116
v_and_b32 v161, 0xffff0000, v117
v_and_b32 v162, 0xffff0000, v118
v_and_b32 v163, 0xffff0000, v119
v_lshlrev_b32 v116, 16, v116
v_lshlrev_b32 v117, 16, v117
v_lshlrev_b32 v118, 16, v118
v_lshlrev_b32 v119, 16, v119
v_mul_f32 v160, s40, v160
v_mul_f32 v116, s40, v116
v_mul_f32 v161, s40, v161
v_mul_f32 v117, s40, v117
v_mul_f32 v162, s40, v162
v_mul_f32 v118, s40, v118
v_mul_f32 v163, s40, v163
v_mul_f32 v119, s40, v119
v_cvt_pk_bf16_f32 v116, v116, v160
v_cvt_pk_bf16_f32 v117, v117, v161
v_cvt_pk_bf16_f32 v118, v118, v162
v_cvt_pk_bf16_f32 v119, v119, v163
ds_write_b128 v173, v[116:119] offset:3072
buffer_load_dwordx4 v170, s[28:31], s57 offen offset:2048 lds
buffer_load_dwordx4 v171, s[28:31], s57 offen offset:3072 lds
s_add_u32 m0, s49, 50688
s_waitcnt vmcnt(15)
v_and_b32 v160, 0xffff0000, v120
v_and_b32 v161, 0xffff0000, v121
v_and_b32 v162, 0xffff0000, v122
v_and_b32 v163, 0xffff0000, v123
v_lshlrev_b32 v120, 16, v120
v_lshlrev_b32 v121, 16, v121
v_lshlrev_b32 v122, 16, v122
v_lshlrev_b32 v123, 16, v123
v_mul_f32 v160, s40, v160
v_mul_f32 v120, s40, v120
v_mul_f32 v161, s40, v161
v_mul_f32 v121, s40, v121
v_mul_f32 v162, s40, v162
v_mul_f32 v122, s40, v122
v_mul_f32 v163, s40, v163
v_mul_f32 v123, s40, v123
v_cvt_pk_bf16_f32 v120, v120, v160
v_cvt_pk_bf16_f32 v121, v121, v161
v_cvt_pk_bf16_f32 v122, v122, v162
v_cvt_pk_bf16_f32 v123, v123, v163
ds_write_b128 v172, v[120:123] offset:4096
s_waitcnt vmcnt(14)
v_and_b32 v160, 0xffff0000, v124
v_and_b32 v161, 0xffff0000, v125
v_and_b32 v162, 0xffff0000, v126
v_and_b32 v163, 0xffff0000, v127
v_lshlrev_b32 v124, 16, v124
v_lshlrev_b32 v125, 16, v125
v_lshlrev_b32 v126, 16, v126
v_lshlrev_b32 v127, 16, v127
v_mul_f32 v160, s40, v160
v_mul_f32 v124, s40, v124
v_mul_f32 v161, s40, v161
v_mul_f32 v125, s40, v125
v_mul_f32 v162, s40, v162
v_mul_f32 v126, s40, v126
v_mul_f32 v163, s40, v163
v_mul_f32 v127, s40, v127
v_cvt_pk_bf16_f32 v124, v124, v160
v_cvt_pk_bf16_f32 v125, v125, v161
v_cvt_pk_bf16_f32 v126, v126, v162
v_cvt_pk_bf16_f32 v127, v127, v163
ds_write_b128 v173, v[124:127] offset:5120
s_waitcnt vmcnt(13)
v_and_b32 v160, 0xffff0000, v128
v_and_b32 v161, 0xffff0000, v129
v_and_b32 v162, 0xffff0000, v130
v_and_b32 v163, 0xffff0000, v131
v_lshlrev_b32 v128, 16, v128
v_lshlrev_b32 v129, 16, v129
v_lshlrev_b32 v130, 16, v130
v_lshlrev_b32 v131, 16, v131
v_mul_f32 v160, s40, v160
v_mul_f32 v128, s40, v128
v_mul_f32 v161, s40, v161
v_mul_f32 v129, s40, v129
v_mul_f32 v162, s40, v162
v_mul_f32 v130, s40, v130
v_mul_f32 v163, s40, v163
v_mul_f32 v131, s40, v131
v_cvt_pk_bf16_f32 v128, v128, v160
v_cvt_pk_bf16_f32 v129, v129, v161
v_cvt_pk_bf16_f32 v130, v130, v162
v_cvt_pk_bf16_f32 v131, v131, v163
ds_write_b128 v172, v[128:131] offset:6144
s_waitcnt vmcnt(12)
v_and_b32 v160, 0xffff0000, v132
v_and_b32 v161, 0xffff0000, v133
v_and_b32 v162, 0xffff0000, v134
v_and_b32 v163, 0xffff0000, v135
v_lshlrev_b32 v132, 16, v132
v_lshlrev_b32 v133, 16, v133
v_lshlrev_b32 v134, 16, v134
v_lshlrev_b32 v135, 16, v135
v_mul_f32 v160, s40, v160
v_mul_f32 v132, s40, v132
v_mul_f32 v161, s40, v161
v_mul_f32 v133, s40, v133
v_mul_f32 v162, s40, v162
v_mul_f32 v134, s40, v134
v_mul_f32 v163, s40, v163
v_mul_f32 v135, s40, v135
v_cvt_pk_bf16_f32 v132, v132, v160
v_cvt_pk_bf16_f32 v133, v133, v161
v_cvt_pk_bf16_f32 v134, v134, v162
v_cvt_pk_bf16_f32 v135, v135, v163
ds_write_b128 v173, v[132:135] offset:7168
s_waitcnt vmcnt(10) lgkmcnt(0)
s_barrier
ds_read_b64_tr_b16 a[28:29], v177 offset:12288
ds_read_b128 v[216:219], v242 offset:21120
ds_read_b64_tr_b16 a[30:31], v177 offset:12800
ds_read_b128 v[232:235], v242 offset:21376
ds_read_b64_tr_b16 a[0:1], v176 offset:0
ds_read_b128 v[192:195], v242 offset:21632
ds_read_b64_tr_b16 a[2:3], v176 offset:512
ds_read_b128 v[228:231], v242 offset:21888
ds_read_b64_tr_b16 a[24:25], v177 offset:8192
ds_read_b64_tr_b16 a[26:27], v177 offset:8704
ds_read_b64_tr_b16 a[4:5], v176 offset:4096
ds_read_b64_tr_b16 a[6:7], v176 offset:4608
ds_read_b64_tr_b16 a[20:21], v177 offset:4096
ds_read_b64_tr_b16 a[22:23], v177 offset:4608
ds_read_b64_tr_b16 a[8:9], v176 offset:8192
ds_read_b64_tr_b16 a[10:11], v176 offset:8704
ds_read_b64_tr_b16 a[16:17], v177 offset:0
ds_read_b64_tr_b16 a[18:19], v177 offset:512
ds_read_b64_tr_b16 a[12:13], v176 offset:12288
ds_read_b64_tr_b16 a[14:15], v176 offset:12800
ds_read_b64_tr_b16 a[32:33], v178 offset:0
ds_read_b64_tr_b16 a[34:35], v178 offset:512
ds_read_b64_tr_b16 a[36:37], v178 offset:4096
ds_read_b64_tr_b16 a[38:39], v178 offset:4608
ds_read_b64_tr_b16 a[40:41], v178 offset:8192
ds_read_b64_tr_b16 a[42:43], v178 offset:8704
ds_read_b64_tr_b16 a[44:45], v178 offset:12288
ds_read_b64_tr_b16 a[46:47], v178 offset:12800
s_waitcnt lgkmcnt(15)
v_mfma_f32_16x16x32_bf16 v[188:191], a[0:3], v[216:219], 0
s_waitcnt lgkmcnt(12)
ds_read_b64_tr_b16 a[48:49], v179 offset:0
v_add_u32 v176, 98176, v176
v_mfma_f32_16x16x32_bf16 v[188:191], a[4:7], v[232:235], v[188:191]
s_waitcnt lgkmcnt(9)
ds_read_b64_tr_b16 a[50:51], v179 offset:512
v_add_u32 v177, 98176, v177
v_mfma_f32_16x16x32_bf16 v[188:191], a[8:11], v[192:195], v[188:191]
s_mul_i32 s53, s43, 25344
ds_read_b64_tr_b16 a[52:53], v179 offset:4096
v_add_u32 v178, 98176, v178
v_mfma_f32_16x16x32_bf16 v[188:191], a[12:15], v[228:231], v[188:191]
s_add_u32 s11, s53, 59648
ds_read_b64_tr_b16 a[54:55], v179 offset:4608
v_lshl_add_u32 v182, v82, 10, s11
v_mfma_f32_16x16x32_bf16 v[196:199], a[28:31], v[228:231], 0
s_lshl_b32 s53, s43, 7
ds_read_b64_tr_b16 a[56:57], v179 offset:8192
v_lshl_add_u32 v182, v83, 7, v182
v_mfma_f32_16x16x32_bf16 v[196:199], a[24:27], v[192:195], v[196:199]
s_mov_b32 s51, -32
ds_read_b64_tr_b16 a[58:59], v179 offset:8704
v_cvt_pk_bf16_f32 v152, v188, v189
v_mfma_f32_16x16x32_bf16 v[196:199], a[20:23], v[232:235], v[196:199]
s_waitcnt lgkmcnt(12)
ds_read_b64_tr_b16 a[60:61], v179 offset:12288
v_cvt_pk_bf16_f32 v153, v190, v191
v_mfma_f32_16x16x32_bf16 v[196:199], a[16:19], v[216:219], v[196:199]
s_waitcnt lgkmcnt(11)
ds_read_b64_tr_b16 a[62:63], v179 offset:12800
v_add_u32 v179, 98176, v179
v_mfma_f32_16x16x32_bf16 v[200:203], a[32:35], v[216:219], 0
s_waitcnt lgkmcnt(10)
buffer_load_dwordx4 v243, s[16:19], s99 offen offset:0 nt lds
v_mfma_f32_16x16x32_bf16 v[200:203], a[36:39], v[232:235], v[200:203]
s_waitcnt lgkmcnt(8)
buffer_load_dwordx4 v243, s[16:19], s100 offen offset:2112 nt lds
v_mfma_f32_16x16x32_bf16 v[200:203], a[40:43], v[192:195], v[200:203]
s_add_u32 m0, s49, 54912
s_add_u32 s99, s4, 52428800
s_add_u32 s100, s4, 78641088
v_mfma_f32_16x16x32_bf16 v[200:203], a[44:47], v[228:231], v[200:203]
s_waitcnt lgkmcnt(4)
buffer_load_dwordx4 v243, s[16:19], s99 offen offset:0 nt lds
s_add_u32 s99, s55, 4096
v_cvt_pk_bf16_f32 v154, v196, v197
v_cvt_pk_bf16_f32 v155, v198, v199
s_waitcnt lgkmcnt(0)
v_mfma_f32_16x16x32_bf16 v[204:207], a[60:63], v[228:231], 0
buffer_load_dwordx4 v243, s[16:19], s100 offen offset:2112 nt lds
v_mfma_f32_16x16x32_bf16 v[204:207], a[52:55], v[232:235], v[204:207]
s_waitcnt vmcnt(12)
s_barrier
v_mfma_f32_16x16x32_bf16 v[204:207], a[48:51], v[216:219], v[204:207]
s_add_u32 m0, s98, 59648
ds_read_b128 v[208:211], v242 offset:512
ds_read_b128 v[212:215], v242 offset:768
v_mfma_f32_16x16x32_bf16 v[204:207], a[56:59], v[192:195], v[204:207]
s_add_u32 s100, s55, 4032
ds_read_b128 v[220:223], v242 offset:256
ds_read_b128 v[224:227], v242 offset:0
v_cvt_pk_bf16_f32 v156, v200, v201
v_cvt_pk_bf16_f32 v157, v202, v203
v_lshl_add_u32 v182, v84, 6, v182
v_lshl_add_u32 v182, v86, 4, v182
v_xor_b32 v183, 64, v182
v_lshl_add_u32 v244, v81, 8, s53
v_cvt_pk_bf16_f32 v158, v204, v205
v_cvt_pk_bf16_f32 v159, v206, v207
s_mul_i32 s52, s41, 13824
s_add_u32 s52, s52, 102400
v_lshlrev_b32 v94, 4, v83
s_mov_b32 vcc_lo, 0x33333333
s_mov_b32 vcc_hi, 0x33333333
v_and_b32 v95, 15, v168
v_mov_b32 v169, 163024
s_waitcnt lgkmcnt(3)
v_mfma_f32_16x16x32_bf16 v[188:191], a[56:59], v[208:211], 0
s_waitcnt lgkmcnt(2)
v_lshrrev_b32 v91, 5, v168
v_lshl_add_u32 v164, v86, 7, s52
v_mfma_f32_16x16x32_bf16 v[188:191], a[60:63], v[212:215], v[188:191]
s_waitcnt lgkmcnt(0)
v_lshl_add_u32 v164, v91, 4, v164
v_lshl_add_u32 v164, v85, 3, v164
v_mfma_f32_16x16x32_bf16 v[188:191], a[52:55], v[220:223], v[188:191]
s_waitcnt vmcnt(4)
s_barrier
v_mfma_f32_16x16x32_bf16 v[188:191], a[48:51], v[224:227], v[188:191]
s_lshl_b32 s53, s41, 9
ds_read_b64_tr_b16 a[64:65], v176 offset:0
v_lshlrev_b32 v16, 4, v86
v_mfma_f32_16x16x32_bf16 v[196:199], a[32:35], v[224:227], 0
s_add_u32 s9, s53, 160960
ds_read_b64_tr_b16 a[66:67], v176 offset:512
v_lshl_add_u32 v167, v95, 4, s9
v_mfma_f32_16x16x32_bf16 v[196:199], a[36:39], v[220:223], v[196:199]
s_add_u32 s13, s52, 512
ds_read_b64_tr_b16 a[68:69], v176 offset:4096
v_cvt_pk_bf16_f32 v102, v188, v189
v_mfma_f32_16x16x32_bf16 v[196:199], a[40:43], v[208:211], v[196:199]
s_add_u32 s14, s52, 1072
ds_read_b64_tr_b16 a[70:71], v176 offset:4608
v_cvt_pk_bf16_f32 v103, v190, v191
v_mfma_f32_16x16x32_bf16 v[196:199], a[44:47], v[212:215], v[196:199]
s_add_u32 s7, s52, 1136
ds_read_b64_tr_b16 a[72:73], v176 offset:8192
v_lshl_add_u32 v247, v83, 7, s13
v_mfma_f32_16x16x32_bf16 v[188:191], a[28:31], v[212:215], 0
s_add_u32 s12, s52, 1136
ds_read_b64_tr_b16 a[74:75], v176 offset:8704
v_lshl_add_u32 v247, v88, 6, v247
v_mfma_f32_16x16x32_bf16 v[188:191], a[24:27], v[208:211], v[188:191]
s_add_u32 s15, s52, 1072
ds_read_b64_tr_b16 a[76:77], v176 offset:12288
v_cvt_pk_bf16_f32 v100, v196, v197
v_mfma_f32_16x16x32_bf16 v[188:191], a[20:23], v[220:223], v[188:191]
ds_read_b64_tr_b16 a[78:79], v176 offset:12800
v_cvt_pk_bf16_f32 v101, v198, v199
v_mfma_f32_16x16x32_bf16 v[188:191], a[16:19], v[224:227], v[188:191]
ds_read_b64_tr_b16 a[80:81], v177 offset:0
v_lshl_add_u32 v247, v82, 4, v247
v_mfma_f32_16x16x32_bf16 v[196:199], a[0:3], v[224:227], 0
ds_read_b64_tr_b16 a[82:83], v177 offset:512
v_mov_b32 v166, s14
v_mfma_f32_16x16x32_bf16 v[196:199], a[4:7], v[220:223], v[196:199]
s_mov_b32 s14, 1728
ds_read_b64_tr_b16 a[84:85], v177 offset:4096
v_cvt_pk_bf16_f32 v98, v188, v189
v_mfma_f32_16x16x32_bf16 v[196:199], a[8:11], v[208:211], v[196:199]
s_waitcnt lgkmcnt(9)
ds_read_b64_tr_b16 a[86:87], v177 offset:4608
v_cvt_pk_bf16_f32 v99, v190, v191
v_mfma_f32_16x16x32_bf16 v[196:199], a[12:15], v[212:215], v[196:199]
L_h0:
s_cbranch_execz L_h4
s_waitcnt lgkmcnt(8)
ds_read_b64_tr_b16 a[88:89], v177 offset:8192
v_xor_b32 v247, v94, v247
v_mfma_f32_16x16x32_bf16 v[188:191], a[64:67], v[216:219], 0
s_waitcnt lgkmcnt(7)
ds_read_b64_tr_b16 a[90:91], v177 offset:8704
v_cndmask_b32 v247, v166, v247, vcc
v_mfma_f32_16x16x32_bf16 v[188:191], a[68:71], v[232:235], v[188:191]
s_waitcnt lgkmcnt(6)
ds_read_b64_tr_b16 a[92:93], v177 offset:12288
v_cvt_pk_bf16_f32 v96, v196, v197
v_mfma_f32_16x16x32_bf16 v[188:191], a[72:75], v[192:195], v[188:191]
ds_read_b64_tr_b16 a[94:95], v177 offset:12800
v_cvt_pk_bf16_f32 v97, v198, v199
v_mfma_f32_16x16x32_bf16 v[188:191], a[76:79], v[228:231], v[188:191]
ds_read_b64_tr_b16 a[96:97], v178 offset:0
v_mad_u32_u24 v164, v83, s14, v164
v_mfma_f32_16x16x32_bf16 v[196:199], a[76:79], v[212:215], 0
ds_read_b64_tr_b16 a[98:99], v178 offset:512
v_xor_b32 v164, v16, v164
v_mfma_f32_16x16x32_bf16 v[196:199], a[64:67], v[224:227], v[196:199]
ds_read_b64_tr_b16 a[100:101], v178 offset:4096
v_lshl_add_u32 v181, v95, 3, s7
v_mfma_f32_16x16x32_bf16 v[196:199], a[68:71], v[220:223], v[196:199]
s_waitcnt lgkmcnt(5)
ds_read_b64_tr_b16 a[102:103], v178 offset:4608
v_cvt_pk_bf16_f32 v40, v188, v189
v_mfma_f32_16x16x32_bf16 v[196:199], a[72:75], v[208:211], v[196:199]
ds_read_b64_tr_b16 a[104:105], v178 offset:8192
v_cvt_pk_bf16_f32 v41, v190, v191
v_mfma_f32_16x16x32_bf16 v[188:191], a[88:91], v[208:211], 0
ds_read_b64_tr_b16 a[106:107], v178 offset:8704
v_lshl_add_u32 v250, v95, 2, s52
v_mfma_f32_16x16x32_bf16 v[188:191], a[84:87], v[220:223], v[188:191]
s_waitcnt lgkmcnt(6)
ds_read_b64_tr_b16 a[108:109], v178 offset:12288
v_cvt_pk_bf16_f32 v0, v196, v197
v_mfma_f32_16x16x32_bf16 v[188:191], a[80:83], v[224:227], v[188:191]
ds_read_b64_tr_b16 a[110:111], v178 offset:12800
v_cvt_pk_bf16_f32 v1, v198, v199
v_mfma_f32_16x16x32_bf16 v[188:191], a[92:95], v[212:215], v[188:191]
ds_read_b64_tr_b16 a[112:113], v179 offset:0
v_bfe_u32 v89, v168, 3, 2
v_mfma_f32_16x16x32_bf16 v[196:199], a[92:95], v[228:231], 0
ds_read_b64_tr_b16 a[114:115], v179 offset:512
v_bfe_u32 v90, v168, 2, 1
v_mfma_f32_16x16x32_bf16 v[196:199], a[88:91], v[192:195], v[196:199]
ds_read_b64_tr_b16 a[116:117], v179 offset:4096
v_lshl_add_u32 v246, v89, 7, s12
v_mfma_f32_16x16x32_bf16 v[196:199], a[84:87], v[232:235], v[196:199]
s_waitcnt lgkmcnt(9)
ds_read_b64_tr_b16 a[118:119], v179 offset:4608
v_cvt_pk_bf16_f32 v2, v188, v189
v_mfma_f32_16x16x32_bf16 v[196:199], a[80:83], v[216:219], v[196:199]
s_waitcnt lgkmcnt(8)
ds_read_b64_tr_b16 a[120:121], v179 offset:8192
v_cvt_pk_bf16_f32 v3, v190, v191
v_mfma_f32_16x16x32_bf16 v[188:191], a[96:99], v[216:219], 0
s_waitcnt lgkmcnt(7)
ds_read_b64_tr_b16 a[122:123], v179 offset:8704
v_lshl_add_u32 v245, v84, 8, s52
v_mfma_f32_16x16x32_bf16 v[188:191], a[100:103], v[232:235], v[188:191]
s_waitcnt lgkmcnt(6)
ds_read_b64_tr_b16 a[124:125], v179 offset:12288
v_cvt_pk_bf16_f32 v42, v196, v197
v_mfma_f32_16x16x32_bf16 v[188:191], a[104:107], v[192:195], v[188:191]
ds_read_b64_tr_b16 a[126:127], v179 offset:12800
v_cvt_pk_bf16_f32 v43, v198, v199
v_mfma_f32_16x16x32_bf16 v[188:191], a[108:111], v[228:231], v[188:191]
buffer_load_dwordx4 v180, s[32:35], s54 offen offset:0 lds
v_mfma_f32_16x16x32_bf16 v[196:199], a[108:111], v[212:215], 0
buffer_load_dwordx4 v180, s[32:35], s54 offen offset:1024 lds
v_mfma_f32_16x16x32_bf16 v[196:199], a[96:99], v[224:227], v[196:199]
s_mov_b32 vcc_lo, 0xf0000f
s_mov_b32 vcc_hi, 0xf0000f00
v_cndmask_b32 v167, v169, v167, vcc
v_mfma_f32_16x16x32_bf16 v[196:199], a[100:103], v[220:223], v[196:199]
s_waitcnt lgkmcnt(2)
buffer_load_dwordx4 v180, s[32:35], s54 offen offset:2048 lds
v_mfma_f32_16x16x32_bf16 v[196:199], a[104:107], v[208:211], v[196:199]
buffer_load_dwordx4 v180, s[32:35], s54 offen offset:3072 lds
v_mfma_f32_16x16x32_bf16 v[200:203], a[120:123], v[208:211], 0
s_add_u32 m0, s98, 63744
v_cvt_pk_bf16_f32 v44, v188, v189
v_cvt_pk_bf16_f32 v45, v190, v191
v_mfma_f32_16x16x32_bf16 v[200:203], a[116:119], v[220:223], v[200:203]
s_waitcnt lgkmcnt(0)
buffer_load_dwordx4 v180, s[32:35], s57 offen offset:0 lds
v_mfma_f32_16x16x32_bf16 v[200:203], a[112:115], v[224:227], v[200:203]
buffer_load_dwordx4 v180, s[32:35], s57 offen offset:1024 lds
v_mfma_f32_16x16x32_bf16 v[200:203], a[124:127], v[212:215], v[200:203]
v_cvt_pk_bf16_f32 v4, v196, v197
v_cvt_pk_bf16_f32 v5, v198, v199
v_mfma_f32_16x16x32_bf16 v[188:191], a[124:127], v[228:231], 0
buffer_load_dwordx4 v180, s[32:35], s57 offen offset:2048 lds
v_mfma_f32_16x16x32_bf16 v[188:191], a[120:123], v[192:195], v[188:191]
buffer_load_dwordx4 v180, s[32:35], s57 offen offset:3072 lds
v_mfma_f32_16x16x32_bf16 v[188:191], a[116:119], v[232:235], v[188:191]
s_add_u32 m0, s49, 4224
s_lshl_b32 s57, s43, 14
s_lshl_b32 s53, s42, 7
s_add_u32 s57, s57, s53
v_mfma_f32_16x16x32_bf16 v[188:191], a[112:115], v[216:219], v[188:191]
v_cvt_pk_bf16_f32 v6, v200, v201
v_cvt_pk_bf16_f32 v7, v202, v203
v_lshl_add_u32 v246, v90, 6, v246
v_lshl_add_u32 v245, v87, 7, v245
v_mfma_f32_16x16x32_bf16 v[196:199], v[4:7], v[156:159], 0
v_lshlrev_b32 v93, 4, v87
v_lshl_add_u32 v246, v86, 3, v246
v_mfma_f32_16x16x32_bf16 v[196:199], v[0:3], v[152:155], v[196:199]
v_cvt_pk_bf16_f32 v46, v188, v189
v_cvt_pk_bf16_f32 v47, v190, v191
v_mfma_f32_16x16x32_bf16 v[188:191], v[40:43], v[152:155], 0
v_xor_b32 v165, 32, v164
v_lshl_add_u32 v245, v88, 6, v245
v_mfma_f32_16x16x32_bf16 v[188:191], v[44:47], v[156:159], v[188:191]
v_lshl_add_u32 v245, v82, 4, v245
v_lshlrev_b32 v92, 5, v84
v_mfma_f32_16x16x32_bf16 v[200:203], v[0:3], v[96:99], 0
v_exp_f32 v196, v196
v_mfma_f32_16x16x32_bf16 v[200:203], v[4:7], v[100:103], v[200:203]
v_exp_f32 v197, v197
s_nop 1
v_exp_f32 v188, v188
v_exp_f32 v189, v189
v_exp_f32 v190, v190
v_exp_f32 v191, v191
v_cvt_pk_bf16_f32 v114, v188, v189
v_cvt_pk_bf16_f32 v115, v190, v191
v_exp_f32 v198, v198
v_exp_f32 v199, v199
v_cvt_pk_bf16_f32 v104, v196, v197
v_cvt_pk_bf16_f32 v105, v198, v199
v_exp_f32 v200, v200
v_exp_f32 v201, v201
v_exp_f32 v202, v202
v_exp_f32 v203, v203
v_cvt_pk_bf16_f32 v120, v200, v201
v_cvt_pk_bf16_f32 v121, v202, v203
v_xor_b32 v245, v92, v245
v_xor_b32 v245, v93, v245
s_mov_b32 vcc_lo, 0x33333333
s_mov_b32 vcc_hi, 0x33333333
v_mov_b32 v184, 0
v_mov_b32 v169, 0x3f803f80
v_cndmask_b32 v184, v184, v169, vcc
s_mov_b32 vcc_lo, 0xaaaaaaaa
s_mov_b32 vcc_hi, 0xaaaaaaaa
v_mov_b32 v251, 0x44444444
v_mov_b32 v169, 0xeeeeeeee
v_cndmask_b32 v251, v251, v169, vcc
s_mov_b32 vcc_lo, 0x0
s_mov_b32 vcc_hi, 0xaaaaaaaa
v_mov_b32 v169, 0xe4eeeeee
v_cndmask_b32 v251, v251, v169, vcc
s_mov_b32 vcc_lo, 0xffff
s_mov_b32 vcc_hi, 0xffff
v_mov_b32 v252, 0x0c0c0c0c
v_mov_b32 v169, 0x07060302
s_waitcnt vmcnt(8)
s_barrier
ds_read_b128 v[48:51], v242 offset:50688
ds_read_b128 v[52:55], v242 offset:50944
ds_read_b128 v[56:59], v242 offset:51200
ds_read_b128 v[60:63], v242 offset:51456
ds_read_b128 v[64:67], v242 offset:54912
ds_read_b128 v[68:71], v242 offset:55168
ds_read_b128 v[72:75], v242 offset:55424
ds_read_b128 v[76:79], v242 offset:55680
v_cndmask_b32 v252, v252, v169, vcc
s_mov_b32 vcc_lo, 0xffff0000
s_mov_b32 vcc_hi, 0xffff0000
v_mov_b32 v253, 0x0c0c0c0c
v_mov_b32 v169, 0x07060302
v_cndmask_b32 v253, v253, v169, vcc
v_lshl_add_u32 v244, v84, 6, v244
v_mad_u32_u24 v181, v82, s14, v181
v_mad_u32_u24 v250, v82, s8, v250
v_lshl_add_u32 v244, v82, 4, v244
v_lshl_add_u32 v246, v91, 2, v246
s_lshl_b32 s50, s43, 12
s_add_u32 s50, s50, s44
s_add_u32 s50, s50, 13107200
s_waitcnt lgkmcnt(7)
v_mfma_f32_16x16x32_bf16 v[188:191], a[64:67], v[48:51], 0
s_waitcnt lgkmcnt(5)
buffer_load_dwordx4 v243, s[16:19], s99 offen offset:0 nt lds
v_mfma_f32_16x16x32_bf16 v[188:191], a[68:71], v[52:55], v[188:191]
s_waitcnt lgkmcnt(4)
buffer_load_dwordx4 v243, s[16:19], s100 offen offset:2112 nt lds
v_mfma_f32_16x16x32_bf16 v[188:191], a[72:75], v[56:59], v[188:191]
s_add_u32 m0, s49, 8448
s_add_u32 s99, s55, 8192
s_add_u32 s100, s55, 8128
v_mfma_f32_16x16x32_bf16 v[188:191], a[76:79], v[60:63], v[188:191]
v_lshl_add_u32 v166, v89, 2, s15
v_mad_u32_u24 v166, v81, s14, v166
v_mfma_f32_16x16x32_bf16 v[196:199], a[92:95], v[60:63], 0
ds_write_b32 v166, v236 offset:0
v_mfma_f32_16x16x32_bf16 v[196:199], a[88:91], v[56:59], v[196:199]
v_mov_b32 v185, v184
v_mov_b32 v186, v184
v_mfma_f32_16x16x32_bf16 v[196:199], a[84:87], v[52:55], v[196:199]
v_cvt_pk_bf16_f32 v136, v188, v189
v_cvt_pk_bf16_f32 v138, v190, v191
v_mfma_f32_16x16x32_bf16 v[196:199], a[80:83], v[48:51], v[196:199]
buffer_load_dwordx4 v243, s[16:19], s99 offen offset:0 nt lds
v_mfma_f32_16x16x32_bf16 v[188:191], a[96:99], v[48:51], 0
s_add_u32 s99, s55, 12288
buffer_load_dwordx4 v243, s[16:19], s100 offen offset:2112 nt lds
v_mfma_f32_16x16x32_bf16 v[188:191], a[100:103], v[52:55], v[188:191]
s_add_u32 m0, s49, 12672
s_add_u32 s100, s55, 12224
v_mov_b32 v187, v184
v_mfma_f32_16x16x32_bf16 v[188:191], a[104:107], v[56:59], v[188:191]
s_waitcnt lgkmcnt(1)
v_cvt_pk_bf16_f32 v137, v196, v197
v_cvt_pk_bf16_f32 v139, v198, v199
v_mfma_f32_16x16x32_bf16 v[188:191], a[108:111], v[60:63], v[188:191]
v_mov_b32 v118, 0
v_mov_b32 v119, 0
v_mfma_f32_16x16x32_bf16 v[196:199], a[124:127], v[60:63], 0
v_mov_b32 v255, 0
v_mov_b32 v134, 0
v_mfma_f32_16x16x32_bf16 v[196:199], a[116:119], v[52:55], v[196:199]
v_mov_b32 v135, 0
v_mfma_f32_16x16x32_bf16 v[196:199], a[112:115], v[48:51], v[196:199]
buffer_load_dwordx4 v243, s[16:19], s99 offen offset:0 nt lds
v_mfma_f32_16x16x32_bf16 v[196:199], a[120:123], v[56:59], v[196:199]
s_add_u32 s99, s55, 16384
buffer_load_dwordx4 v243, s[16:19], s100 offen offset:2112 nt lds
v_mfma_f32_16x16x32_bf16 v[200:203], a[56:59], v[56:59], 0
s_add_u32 m0, s49, 16896
s_add_u32 s100, s55, 16320
v_cvt_pk_bf16_f32 v140, v188, v189
v_mfma_f32_16x16x32_bf16 v[200:203], a[60:63], v[60:63], v[200:203]
v_cvt_pk_bf16_f32 v142, v190, v191
v_cvt_pk_bf16_f32 v141, v196, v197
v_mfma_f32_16x16x32_bf16 v[200:203], a[52:55], v[52:55], v[200:203]
v_cvt_pk_bf16_f32 v143, v198, v199
v_mfma_f32_16x16x32_bf16 v[200:203], a[48:51], v[48:51], v[200:203]
s_mul_i32 s48, s43, 3168
s_add_u32 s49, s49, s48
s_add_u32 s49, s49, 50688
s_mov_b32 s48, 8192
v_mfma_f32_16x16x32_bf16 v[188:191], a[32:35], v[48:51], 0
ds_write_b32 v164, v136 offset:0
v_mfma_f32_16x16x32_bf16 v[188:191], a[36:39], v[52:55], v[188:191]
buffer_load_dwordx4 v243, s[16:19], s99 offen offset:0 nt lds
v_mfma_f32_16x16x32_bf16 v[188:191], a[40:43], v[56:59], v[188:191]
s_add_u32 s99, s57, 0
buffer_load_dwordx4 v243, s[16:19], s100 offen offset:2112 nt lds
v_mfma_f32_16x16x32_bf16 v[188:191], a[44:47], v[60:63], v[188:191]
s_add_u32 m0, s98, 59648
s_add_u32 s100, s57, 1024
v_cvt_pk_bf16_f32 v149, v200, v201
v_mfma_f32_16x16x32_bf16 v[196:199], a[28:31], v[60:63], 0
v_cvt_pk_bf16_f32 v151, v202, v203
s_nop 0
v_mfma_f32_16x16x32_bf16 v[196:199], a[24:27], v[56:59], v[196:199]
s_waitcnt vmcnt(8)
s_barrier
v_mfma_f32_16x16x32_bf16 v[196:199], a[20:23], v[52:55], v[196:199]
ds_read_b64_tr_b16 a[176:177], v183 offset:8
v_cvt_pk_bf16_f32 v148, v188, v189
v_mfma_f32_16x16x32_bf16 v[196:199], a[16:19], v[48:51], v[196:199]
ds_read_b64_tr_b16 a[178:179], v183 offset:520
v_cvt_pk_bf16_f32 v150, v190, v191
v_mfma_f32_16x16x32_bf16 v[188:191], a[0:3], v[48:51], 0
ds_read_b64_tr_b16 a[180:181], v183 offset:4104
s_nop 0
v_mfma_f32_16x16x32_bf16 v[188:191], a[8:11], v[56:59], v[188:191]
ds_read_b64_tr_b16 a[182:183], v183 offset:4616
v_mfma_f32_16x16x32_bf16 v[188:191], a[12:15], v[60:63], v[188:191]
ds_read_b64_tr_b16 a[184:185], v183 offset:8200
v_cvt_pk_bf16_f32 v145, v196, v197
v_mfma_f32_16x16x32_bf16 v[188:191], a[4:7], v[52:55], v[188:191]
ds_read_b64_tr_b16 a[186:187], v183 offset:8712
v_cvt_pk_bf16_f32 v147, v198, v199
v_mfma_f32_16x16x32_bf16 v[196:199], a[4:7], v[68:71], 0
ds_read_b64_tr_b16 a[188:189], v183 offset:12296
s_nop 0
v_mfma_f32_16x16x32_bf16 v[196:199], a[0:3], v[64:67], v[196:199]
ds_read_b64_tr_b16 a[190:191], v183 offset:12808
v_mfma_f32_16x16x32_bf16 v[196:199], a[8:11], v[72:75], v[196:199]
ds_read_b64_tr_b16 a[160:161], v183 offset:0
v_cvt_pk_bf16_f32 v144, v188, v189
v_mfma_f32_16x16x32_bf16 v[196:199], a[12:15], v[76:79], v[196:199]
ds_read_b64_tr_b16 a[162:163], v183 offset:512
v_cvt_pk_bf16_f32 v146, v190, v191
s_nop 1
v_mfma_f32_16x16x32_bf16 v[188:191], v[136:139], v[144:147], 0
ds_read_b64_tr_b16 a[164:165], v183 offset:4096
s_nop 0
v_mfma_f32_16x16x32_bf16 v[188:191], v[140:143], v[148:151], v[188:191]
ds_read_b64_tr_b16 a[166:167], v183 offset:4608
v_cvt_pk_bf16_f32 v32, v196, v197
v_mfma_f32_16x16x32_bf16 v[200:203], a[28:31], v[76:79], 0
ds_read_b64_tr_b16 a[168:169], v183 offset:8192
v_cvt_pk_bf16_f32 v34, v198, v199
v_mfma_f32_16x16x32_bf16 v[200:203], a[24:27], v[72:75], v[200:203]
s_waitcnt lgkmcnt(12)
ds_read_b64_tr_b16 a[170:171], v183 offset:8704
v_mfma_f32_16x16x32_bf16 v[200:203], a[20:23], v[68:71], v[200:203]
s_waitcnt lgkmcnt(12)
ds_read_b64_tr_b16 a[172:173], v183 offset:12288
v_mfma_f32_16x16x32_bf16 v[200:203], a[16:19], v[64:67], v[200:203]
s_waitcnt lgkmcnt(12)
ds_read_b64_tr_b16 a[174:175], v183 offset:12800
s_nop 0
v_mfma_f32_16x16x32_bf16 v[196:199], a[32:35], v[64:67], 0
s_waitcnt lgkmcnt(12)
ds_read_b64_tr_b16 a[144:145], v182 offset:8
s_nop 0
v_mfma_f32_16x16x32_bf16 v[196:199], a[36:39], v[68:71], v[196:199]
s_waitcnt lgkmcnt(12)
ds_read_b64_tr_b16 a[146:147], v182 offset:520
v_cvt_pk_bf16_f32 v33, v200, v201
v_mfma_f32_16x16x32_bf16 v[196:199], a[40:43], v[72:75], v[196:199]
s_waitcnt lgkmcnt(12)
ds_read_b64_tr_b16 a[148:149], v182 offset:4104
v_cvt_pk_bf16_f32 v35, v202, v203
v_mfma_f32_16x16x32_bf16 v[196:199], a[44:47], v[76:79], v[196:199]
s_waitcnt lgkmcnt(12)
ds_read_b64_tr_b16 a[150:151], v182 offset:4616
s_nop 0
v_mfma_f32_16x16x32_bf16 v[200:203], a[60:63], v[76:79], 0
s_waitcnt lgkmcnt(12)
ds_read_b64_tr_b16 a[152:153], v182 offset:8200
s_nop 0
v_mfma_f32_16x16x32_bf16 v[200:203], a[52:55], v[68:71], v[200:203]
s_waitcnt lgkmcnt(12)
ds_read_b64_tr_b16 a[154:155], v182 offset:8712
v_cvt_pk_bf16_f32 v36, v196, v197
v_mfma_f32_16x16x32_bf16 v[200:203], a[48:51], v[64:67], v[200:203]
s_waitcnt lgkmcnt(12)
ds_read_b64_tr_b16 a[156:157], v182 offset:12296
v_cvt_pk_bf16_f32 v38, v198, v199
v_mfma_f32_16x16x32_bf16 v[200:203], a[56:59], v[72:75], v[200:203]
s_waitcnt lgkmcnt(12)
ds_read_b64_tr_b16 a[158:159], v182 offset:12808
s_nop 0
v_mfma_f32_16x16x32_bf16 v[196:199], a[120:123], v[72:75], 0
s_waitcnt lgkmcnt(12)
ds_read_b64_tr_b16 a[128:129], v182 offset:0
s_nop 0
v_mfma_f32_16x16x32_bf16 v[196:199], a[124:127], v[76:79], v[196:199]
s_waitcnt lgkmcnt(12)
ds_read_b64_tr_b16 a[130:131], v182 offset:512
v_cvt_pk_bf16_f32 v37, v200, v201
v_mfma_f32_16x16x32_bf16 v[196:199], a[116:119], v[68:71], v[196:199]
s_waitcnt lgkmcnt(12)
ds_read_b64_tr_b16 a[132:133], v182 offset:4096
v_cvt_pk_bf16_f32 v39, v202, v203
v_mfma_f32_16x16x32_bf16 v[196:199], a[112:115], v[64:67], v[196:199]
s_waitcnt lgkmcnt(12)
ds_read_b64_tr_b16 a[134:135], v182 offset:4608
s_nop 0
v_mfma_f32_16x16x32_bf16 v[200:203], a[96:99], v[64:67], 0
s_waitcnt lgkmcnt(12)
ds_read_b64_tr_b16 a[136:137], v182 offset:8192
s_nop 0
v_mfma_f32_16x16x32_bf16 v[200:203], a[100:103], v[68:71], v[200:203]
s_waitcnt lgkmcnt(12)
ds_read_b64_tr_b16 a[138:139], v182 offset:8704
v_cvt_pk_bf16_f32 v29, v196, v197
v_mfma_f32_16x16x32_bf16 v[200:203], a[104:107], v[72:75], v[200:203]
s_waitcnt lgkmcnt(12)
ds_read_b64_tr_b16 a[140:141], v182 offset:12288
v_cvt_pk_bf16_f32 v31, v198, v199
v_mfma_f32_16x16x32_bf16 v[200:203], a[108:111], v[76:79], v[200:203]
s_waitcnt lgkmcnt(12)
ds_read_b64_tr_b16 a[142:143], v182 offset:12800
s_nop 0
v_mfma_f32_16x16x32_bf16 v[196:199], a[92:95], v[76:79], 0
s_waitcnt lgkmcnt(12)
v_exp_f32 v188, v188
v_mfma_f32_16x16x32_bf16 v[196:199], a[88:91], v[72:75], v[196:199]
s_waitcnt lgkmcnt(11)
v_cvt_pk_bf16_f32 v28, v200, v201
v_cvt_pk_bf16_f32 v30, v202, v203
v_mfma_f32_16x16x32_bf16 v[196:199], a[84:87], v[68:71], v[196:199]
s_waitcnt lgkmcnt(10)
v_exp_f32 v189, v189
v_mfma_f32_16x16x32_bf16 v[196:199], a[80:83], v[64:67], v[196:199]
s_waitcnt lgkmcnt(9)
v_add_f32 v160, v188, v189
v_cvt_pk_bf16_f32 v188, v188, v189
v_mfma_f32_16x16x32_bf16 v[200:203], a[64:67], v[64:67], 0
s_waitcnt lgkmcnt(8)
ds_write_b32 v167, v188 offset:0
v_mfma_f32_16x16x32_bf16 v[200:203], a[68:71], v[68:71], v[200:203]
s_waitcnt lgkmcnt(8)
v_cvt_pk_bf16_f32 v25, v196, v197
v_cvt_pk_bf16_f32 v27, v198, v199
v_mfma_f32_16x16x32_bf16 v[200:203], a[72:75], v[72:75], v[200:203]
s_waitcnt lgkmcnt(7)
v_exp_f32 v190, v190
v_mfma_f32_16x16x32_bf16 v[200:203], a[76:79], v[76:79], v[200:203]
s_waitcnt lgkmcnt(6)
v_exp_f32 v191, v191
v_mfma_f32_16x16x32_bf16 v[196:199], v[76:79], a[188:191], 0
s_waitcnt lgkmcnt(5)
v_cvt_pk_bf16_f32 v189, v190, v191
v_add_f32 v161, v190, v191
v_mfma_f32_16x16x32_bf16 v[196:199], v[72:75], a[184:187], v[196:199]
s_waitcnt lgkmcnt(4)
ds_write_b32 v167, v189 offset:4
v_mfma_f32_16x16x32_bf16 v[196:199], v[68:71], a[180:183], v[196:199]
s_waitcnt lgkmcnt(4)
ds_write_b32 v164, v137 offset:4
v_mfma_f32_16x16x32_bf16 v[196:199], v[64:67], a[176:179], v[196:199]
s_waitcnt lgkmcnt(4)
ds_write_b32 v164, v138 offset:64
v_mfma_f32_16x16x32_bf16 v[204:207], v[64:67], a[160:163], 0
s_waitcnt lgkmcnt(4)
ds_write_b32 v164, v139 offset:68
v_mfma_f32_16x16x32_bf16 v[204:207], v[68:71], a[164:167], v[204:207]
ds_write_b32 v165, v140 offset:0
v_mfma_f32_16x16x32_bf16 v[204:207], v[72:75], a[168:171], v[204:207]
ds_write_b32 v165, v141 offset:4
v_mfma_f32_16x16x32_bf16 v[204:207], v[76:79], a[172:175], v[204:207]
ds_write_b32 v165, v142 offset:64
v_cvt_pk_bf16_f32 v24, v200, v201
v_cvt_pk_bf16_f32 v26, v202, v203
v_cvt_pk_bf16_f32 v14, v196, v197
v_cvt_pk_bf16_f32 v15, v198, v199
v_mfma_f32_16x16x32_bf16 v[196:199], v[24:27], v[32:35], 0
ds_write_b32 v165, v143 offset:68
v_mfma_f32_16x16x32_bf16 v[196:199], v[28:31], v[36:39], v[196:199]
ds_read_b128 v[238:241], v245 offset:0
v_add_f32 v190, v160, v161
v_mfma_f32_16x16x32_bf16 v[200:203], v[76:79], a[156:159], 0
ds_write_b32 v167, v190 offset:8
v_mfma_f32_16x16x32_bf16 v[200:203], v[72:75], a[152:155], v[200:203]
v_cvt_pk_bf16_f32 v12, v204, v205
v_cvt_pk_bf16_f32 v13, v206, v207
v_mfma_f32_16x16x32_bf16 v[200:203], v[68:71], a[148:151], v[200:203]
v_exp_f32 v196, v196
v_mfma_f32_16x16x32_bf16 v[200:203], v[64:67], a[144:147], v[200:203]
v_exp_f32 v197, v197
v_mfma_f32_16x16x32_bf16 v[188:191], v[64:67], a[128:131], 0
v_add_f32 v160, v196, v197
v_cvt_pk_bf16_f32 v196, v196, v197
v_mfma_f32_16x16x32_bf16 v[188:191], v[72:75], a[136:139], v[188:191]
ds_write_b32 v167, v196 offset:256
v_mfma_f32_16x16x32_bf16 v[188:191], v[76:79], a[140:143], v[188:191]
s_nop 0
v_cvt_pk_bf16_f32 v10, v200, v201
v_cvt_pk_bf16_f32 v11, v202, v203
v_mfma_f32_16x16x32_bf16 v[188:191], v[68:71], a[132:135], v[188:191]
v_exp_f32 v198, v198
v_mfma_f32_16x16x32_bf16 v[200:203], v[52:55], a[132:135], 0
v_exp_f32 v199, v199
v_mfma_f32_16x16x32_bf16 v[200:203], v[48:51], a[128:131], v[200:203]
v_cvt_pk_bf16_f32 v197, v198, v199
v_add_f32 v161, v198, v199
v_mfma_f32_16x16x32_bf16 v[200:203], v[56:59], a[136:139], v[200:203]
ds_write_b32 v167, v197 offset:260
v_mfma_f32_16x16x32_bf16 v[200:203], v[60:63], a[140:143], v[200:203]
v_cvt_pk_bf16_f32 v8, v188, v189
v_cvt_pk_bf16_f32 v9, v190, v191
v_mfma_f32_16x16x32_bf16 v[188:191], v[60:63], a[156:159], 0
s_waitcnt lgkmcnt(3)
v_add_f32 v198, v160, v161
s_nop 0
v_mfma_f32_16x16x32_bf16 v[188:191], v[56:59], a[152:155], v[188:191]
ds_write_b32 v167, v198 offset:264
v_mfma_f32_16x16x32_bf16 v[188:191], v[52:55], a[148:151], v[188:191]
v_cvt_pk_bf16_f32 v16, v200, v201
v_cvt_pk_bf16_f32 v17, v202, v203
v_mfma_f32_16x16x32_bf16 v[188:191], v[48:51], a[144:147], v[188:191]
ds_write_b32 v181, v14 offset:7296
v_mfma_f32_16x16x32_bf16 v[196:199], v[48:51], a[160:163], 0
ds_write_b32 v181, v15 offset:7300
v_mfma_f32_16x16x32_bf16 v[196:199], v[52:55], a[164:167], v[196:199]
ds_read_b128 v[200:203], v242 offset:256
ds_read_b128 v[204:207], v242 offset:0
v_mfma_f32_16x16x32_bf16 v[196:199], v[56:59], a[168:171], v[196:199]
ds_read_b128 v[208:211], v242 offset:512
v_cvt_pk_bf16_f32 v18, v188, v189
v_mfma_f32_16x16x32_bf16 v[196:199], v[60:63], a[172:175], v[196:199]
ds_read_b128 v[224:227], v242 offset:768
v_mov_b64 v[212:213], s[96:97]
v_mfma_f32_16x16x32_bf16 v[220:223], v[60:63], a[188:191], 0
v_mov_b64 v[214:215], s[96:97]
v_cvt_pk_bf16_f32 v19, v190, v191
v_mfma_f32_16x16x32_bf16 v[220:223], v[56:59], a[184:187], v[220:223]
v_mov_b64 v[188:189], s[96:97]
v_mov_b64 v[190:191], s[96:97]
v_mfma_f32_16x16x32_bf16 v[220:223], v[52:55], a[180:183], v[220:223]
v_cvt_pk_bf16_f32 v20, v196, v197
v_cvt_pk_bf16_f32 v21, v198, v199
v_mfma_f32_16x16x32_bf16 v[220:223], v[48:51], a[176:179], v[220:223]
ds_write_b32 v181, v12 offset:7168
v_smfmac_f32_16x16x64_bf16 v[212:215], v[238:241], v[152:159], v251
ds_write_b32 v181, v13 offset:7172
v_smfmac_f32_16x16x64_bf16 v[188:191], v[238:241], v[96:103], v251
ds_write_b32 v181, v10 offset:7040
v_mfma_f32_16x16x32_bf16 v[196:199], v[228:231], a[188:191], 0
s_nop 1
v_cvt_pk_bf16_f32 v22, v220, v221
v_mfma_f32_16x16x32_bf16 v[196:199], v[192:195], a[184:187], v[196:199]
v_cvt_pk_bf16_f32 v23, v222, v223
v_add_f32 v212, v212, v213
v_mfma_f32_16x16x32_bf16 v[196:199], v[232:235], a[180:183], v[196:199]
v_add_f32 v188, v188, v189
v_add_f32 v190, v190, v191
v_mfma_f32_16x16x32_bf16 v[196:199], v[216:219], a[176:179], v[196:199]
v_exp_f32 v188, v188
v_mfma_f32_16x16x32_bf16 v[220:223], v[216:219], a[160:163], 0
s_waitcnt lgkmcnt(5)
v_exp_f32 v190, v190
v_mfma_f32_16x16x32_bf16 v[220:223], v[232:235], a[164:167], v[220:223]
s_waitcnt lgkmcnt(4)
v_perm_b32 v132, v190, v188, v252
v_perm_b32 v133, v190, v188, v253
v_mfma_f32_16x16x32_bf16 v[220:223], v[192:195], a[168:171], v[220:223]
s_waitcnt lgkmcnt(3)
v_cvt_pk_bf16_f32 v94, v196, v197
v_cvt_pk_bf16_f32 v95, v198, v199
v_mfma_f32_16x16x32_bf16 v[220:223], v[228:231], a[172:175], v[220:223]
v_add_f32 v214, v214, v215
s_nop 0
v_mfma_f32_16x16x32_bf16 v[196:199], v[228:231], a[156:159], 0
ds_write_b32 v181, v11 offset:7044
v_mfma_f32_16x16x32_bf16 v[196:199], v[192:195], a[152:155], v[196:199]
ds_write_b32 v181, v8 offset:6912
v_mfma_f32_16x16x32_bf16 v[196:199], v[232:235], a[148:151], v[196:199]
ds_write_b32 v181, v9 offset:6916
v_mfma_f32_16x16x32_bf16 v[196:199], v[216:219], a[144:147], v[196:199]
v_exp_f32 v212, v212
v_mfma_f32_16x16x32_bf16 v[188:191], v[216:219], a[128:131], 0
v_exp_f32 v214, v214
v_mfma_f32_16x16x32_bf16 v[188:191], v[192:195], a[136:139], v[188:191]
v_perm_b32 v116, v214, v212, v252
v_perm_b32 v117, v214, v212, v253
v_mfma_f32_16x16x32_bf16 v[188:191], v[228:231], a[140:143], v[188:191]
s_nop 0
v_cvt_pk_bf16_f32 v86, v196, v197
v_cvt_pk_bf16_f32 v87, v198, v199
v_mfma_f32_16x16x32_bf16 v[188:191], v[232:235], a[132:135], v[188:191]
v_cvt_pk_bf16_f32 v90, v220, v221
v_cvt_pk_bf16_f32 v91, v222, v223
v_mfma_f32_16x16x32_bf16 v[196:199], v[200:203], a[132:135], 0
ds_write_b32 v181, v16 offset:0
v_mfma_f32_16x16x32_bf16 v[196:199], v[204:207], a[128:131], v[196:199]
ds_write_b32 v181, v17 offset:4
v_mfma_f32_16x16x32_bf16 v[196:199], v[208:211], a[136:139], v[196:199]
s_waitcnt vmcnt(4)
s_barrier
v_mfma_f32_16x16x32_bf16 v[196:199], v[224:227], a[140:143], v[196:199]
ds_read_b128 v[216:219], v242 offset:4224
v_cvt_pk_bf16_f32 v82, v188, v189
v_mfma_f32_16x16x32_bf16 v[212:215], v[224:227], a[156:159], 0
ds_read_b128 v[232:235], v242 offset:4480
v_cvt_pk_bf16_f32 v83, v190, v191
v_mfma_f32_16x16x32_bf16 v[212:215], v[208:211], a[152:155], v[212:215]
ds_read_b128 v[192:195], v242 offset:4736
ds_read_b128 v[228:231], v242 offset:4992
v_mfma_f32_16x16x32_bf16 v[212:215], v[200:203], a[148:151], v[212:215]
v_cvt_pk_bf16_f32 v48, v196, v197
v_cvt_pk_bf16_f32 v49, v198, v199
v_mfma_f32_16x16x32_bf16 v[212:215], v[204:207], a[144:147], v[212:215]
ds_write_b32 v181, v18 offset:128
v_mfma_f32_16x16x32_bf16 v[188:191], v[204:207], a[160:163], 0
buffer_load_dwordx4 v174, s[36:39], s99 offen offset:0 lds
v_mfma_f32_16x16x32_bf16 v[188:191], v[200:203], a[164:167], v[188:191]
s_add_u32 s99, s57, 2048
buffer_load_dwordx4 v174, s[36:39], s100 offen offset:1024 lds
v_mfma_f32_16x16x32_bf16 v[188:191], v[208:211], a[168:171], v[188:191]
s_add_u32 s100, s57, 3072
v_cvt_pk_bf16_f32 v52, v212, v213
v_cvt_pk_bf16_f32 v53, v214, v215
v_mfma_f32_16x16x32_bf16 v[188:191], v[224:227], a[172:175], v[188:191]
ds_write_b32 v181, v19 offset:132
v_mfma_f32_16x16x32_bf16 v[196:199], v[224:227], a[188:191], 0
ds_write_b32 v181, v20 offset:256
v_mfma_f32_16x16x32_bf16 v[196:199], v[208:211], a[184:187], v[196:199]
ds_write_b32 v181, v21 offset:260
v_mfma_f32_16x16x32_bf16 v[196:199], v[200:203], a[180:183], v[196:199]
s_waitcnt lgkmcnt(7)
s_nop 0
v_cvt_pk_bf16_f32 v56, v188, v189
v_mfma_f32_16x16x32_bf16 v[196:199], v[204:207], a[176:179], v[196:199]
L_h1:
s_cbranch_execz L_h5
s_waitcnt lgkmcnt(6)
v_cvt_pk_bf16_f32 v57, v190, v191
s_nop 0
v_mfma_f32_16x16x32_bf16 v[188:191], a[64:67], v[216:219], 0
s_waitcnt lgkmcnt(5)
ds_write_b32 v181, v22 offset:384
v_mfma_f32_16x16x32_bf16 v[188:191], a[68:71], v[232:235], v[188:191]
s_waitcnt lgkmcnt(5)
v_cvt_pk_bf16_f32 v60, v196, v197
v_cvt_pk_bf16_f32 v61, v198, v199
v_mfma_f32_16x16x32_bf16 v[188:191], a[72:75], v[192:195], v[188:191]
buffer_load_dwordx4 v174, s[36:39], s99 offen offset:2048 lds
v_mfma_f32_16x16x32_bf16 v[188:191], a[76:79], v[228:231], v[188:191]
s_add_u32 s99, s57, 8192
buffer_load_dwordx4 v174, s[36:39], s100 offen offset:3072 lds
v_mfma_f32_16x16x32_bf16 v[196:199], a[92:95], v[228:231], 0
s_add_u32 m0, s98, 63744
s_add_u32 s100, s57, 9216
s_mov_b32 s98, s50
v_mfma_f32_16x16x32_bf16 v[196:199], a[88:91], v[192:195], v[196:199]
s_nop 0
v_cvt_pk_bf16_f32 v8, v188, v189
v_cvt_pk_bf16_f32 v9, v190, v191
v_mfma_f32_16x16x32_bf16 v[196:199], a[84:87], v[232:235], v[196:199]
ds_write_b32 v181, v23 offset:388
v_mfma_f32_16x16x32_bf16 v[196:199], a[80:83], v[216:219], v[196:199]
ds_read2_b32 v[236:237], v246 offset0:0 offset1:8
s_nop 0
v_mfma_f32_16x16x32_bf16 v[188:191], a[96:99], v[216:219], 0
ds_write_b32 v164, v144 offset:512
v_mfma_f32_16x16x32_bf16 v[188:191], a[100:103], v[232:235], v[188:191]
ds_write_b32 v164, v145 offset:516
v_mfma_f32_16x16x32_bf16 v[188:191], a[104:107], v[192:195], v[188:191]
s_nop 0
v_cvt_pk_bf16_f32 v10, v196, v197
v_cvt_pk_bf16_f32 v11, v198, v199
v_mfma_f32_16x16x32_bf16 v[188:191], a[108:111], v[228:231], v[188:191]
ds_write_b32 v164, v146 offset:576
v_mfma_f32_16x16x32_bf16 v[196:199], a[124:127], v[228:231], 0
buffer_load_dwordx4 v174, s[36:39], s99 offen offset:0 lds
v_mfma_f32_16x16x32_bf16 v[196:199], a[120:123], v[192:195], v[196:199]
s_add_u32 s99, s57, 10240
buffer_load_dwordx4 v174, s[36:39], s100 offen offset:1024 lds
v_mfma_f32_16x16x32_bf16 v[196:199], a[116:119], v[232:235], v[196:199]
s_add_u32 s100, s57, 11264
v_cvt_pk_bf16_f32 v12, v188, v189
v_cvt_pk_bf16_f32 v13, v190, v191
v_mfma_f32_16x16x32_bf16 v[196:199], a[112:115], v[216:219], v[196:199]
ds_write_b32 v164, v147 offset:580
v_mfma_f32_16x16x32_bf16 v[188:191], v[216:219], a[128:131], 0
ds_write_b32 v165, v148 offset:512
v_mfma_f32_16x16x32_bf16 v[188:191], v[232:235], a[132:135], v[188:191]
ds_write_b32 v165, v149 offset:516
v_mfma_f32_16x16x32_bf16 v[188:191], v[192:195], a[136:139], v[188:191]
s_nop 1
v_cvt_pk_bf16_f32 v14, v196, v197
v_mfma_f32_16x16x32_bf16 v[188:191], v[228:231], a[140:143], v[188:191]
v_cvt_pk_bf16_f32 v15, v198, v199
s_nop 1
v_mfma_f32_16x16x32_bf16 v[196:199], v[12:15], v[156:159], 0
s_waitcnt lgkmcnt(6)
ds_write_b32 v165, v150 offset:576
v_mfma_f32_16x16x32_bf16 v[196:199], v[8:11], v[152:155], v[196:199]
s_nop 0
v_cvt_pk_bf16_f32 v50, v188, v189
v_cvt_pk_bf16_f32 v51, v190, v191
v_mfma_f32_16x16x32_bf16 v[200:203], v[8:11], v[96:99], 0
buffer_load_dwordx4 v174, s[36:39], s99 offen offset:2048 lds
v_mfma_f32_16x16x32_bf16 v[200:203], v[12:15], v[100:103], v[200:203]
s_add_u32 s99, s98, s51
buffer_load_dwordx4 v174, s[36:39], s100 offen offset:3072 lds
v_mfma_f32_16x16x32_bf16 v[204:207], v[228:231], a[156:159], 0
s_add_u32 s100, s99, s51
ds_read_b128 v[208:211], v242 offset:8448
ds_read_b128 v[212:215], v242 offset:8704
v_mfma_f32_16x16x32_bf16 v[204:207], v[192:195], a[152:155], v[204:207]
s_add_u32 m0, s49, 0
ds_read_b128 v[220:223], v242 offset:8960
ds_read_b128 v[188:191], v242 offset:9216
v_mfma_f32_16x16x32_bf16 v[204:207], v[232:235], a[148:151], v[204:207]
s_add_u32 s101, s100, s51
v_exp_f32 v196, v196
v_mfma_f32_16x16x32_bf16 v[204:207], v[216:219], a[144:147], v[204:207]
v_exp_f32 v197, v197
v_mfma_f32_16x16x32_bf16 v[224:227], v[216:219], a[160:163], 0
v_exp_f32 v198, v198
v_mfma_f32_16x16x32_bf16 v[224:227], v[232:235], a[164:167], v[224:227]
v_exp_f32 v199, v199
v_mfma_f32_16x16x32_bf16 v[224:227], v[192:195], a[168:171], v[224:227]
v_cvt_pk_bf16_f32 v106, v196, v197
v_cvt_pk_bf16_f32 v107, v198, v199
v_mfma_f32_16x16x32_bf16 v[224:227], v[228:231], a[172:175], v[224:227]
v_cvt_pk_bf16_f32 v54, v204, v205
v_cvt_pk_bf16_f32 v55, v206, v207
v_mfma_f32_16x16x32_bf16 v[204:207], v[228:231], a[188:191], 0
v_exp_f32 v200, v200
v_mfma_f32_16x16x32_bf16 v[204:207], v[192:195], a[184:187], v[204:207]
v_exp_f32 v201, v201
v_mfma_f32_16x16x32_bf16 v[204:207], v[232:235], a[180:183], v[204:207]
s_waitcnt lgkmcnt(3)
v_cvt_pk_bf16_f32 v58, v224, v225
v_cvt_pk_bf16_f32 v59, v226, v227
v_mfma_f32_16x16x32_bf16 v[204:207], v[216:219], a[176:179], v[204:207]
buffer_load_dwordx4 v243, s[16:19], s98 offen offset:0 nt lds
v_mfma_f32_16x16x32_bf16 v[196:199], a[64:67], v[208:211], 0
s_waitcnt lgkmcnt(1)
v_exp_f32 v202, v202
v_mfma_f32_16x16x32_bf16 v[196:199], a[68:71], v[212:215], v[196:199]
s_waitcnt lgkmcnt(0)
v_exp_f32 v203, v203
v_mfma_f32_16x16x32_bf16 v[196:199], a[72:75], v[220:223], v[196:199]
v_cvt_pk_bf16_f32 v62, v204, v205
v_cvt_pk_bf16_f32 v63, v206, v207
v_mfma_f32_16x16x32_bf16 v[196:199], a[76:79], v[188:191], v[196:199]
v_cvt_pk_bf16_f32 v122, v200, v201
v_cvt_pk_bf16_f32 v123, v202, v203
v_mfma_f32_16x16x32_bf16 v[204:207], a[92:95], v[188:191], 0
ds_write_b32 v165, v151 offset:580
v_mfma_f32_16x16x32_bf16 v[204:207], a[88:91], v[220:223], v[204:207]
ds_write_b32 v164, v32 offset:7424
v_mfma_f32_16x16x32_bf16 v[204:207], a[84:87], v[212:215], v[204:207]
s_nop 0
v_cvt_pk_bf16_f32 v16, v196, v197
v_cvt_pk_bf16_f32 v17, v198, v199
v_mfma_f32_16x16x32_bf16 v[204:207], a[80:83], v[208:211], v[204:207]
buffer_load_dwordx4 v243, s[16:19], s99 offen offset:1056 nt lds
v_mfma_f32_16x16x32_bf16 v[224:227], a[96:99], v[208:211], 0
ds_write_b32 v164, v33 offset:7428
v_mfma_f32_16x16x32_bf16 v[224:227], a[100:103], v[212:215], v[224:227]
ds_write_b32 v164, v34 offset:7488
v_mfma_f32_16x16x32_bf16 v[224:227], a[104:107], v[220:223], v[224:227]
s_nop 1
v_cvt_pk_bf16_f32 v18, v204, v205
v_mfma_f32_16x16x32_bf16 v[224:227], a[108:111], v[188:191], v[224:227]
v_cvt_pk_bf16_f32 v19, v206, v207
s_nop 0
v_mfma_f32_16x16x32_bf16 v[196:199], a[124:127], v[188:191], 0
ds_write_b32 v164, v35 offset:7492
v_mfma_f32_16x16x32_bf16 v[196:199], a[120:123], v[220:223], v[196:199]
ds_write_b32 v165, v36 offset:7424
v_mfma_f32_16x16x32_bf16 v[196:199], a[116:119], v[212:215], v[196:199]
s_nop 0
v_cvt_pk_bf16_f32 v20, v224, v225
v_cvt_pk_bf16_f32 v21, v226, v227
v_mfma_f32_16x16x32_bf16 v[196:199], a[112:115], v[208:211], v[196:199]
buffer_load_dwordx4 v243, s[16:19], s100 offen offset:2112 nt lds
v_mfma_f32_16x16x32_bf16 v[200:203], v[208:211], a[128:131], 0
ds_write_b32 v165, v37 offset:7428
v_mfma_f32_16x16x32_bf16 v[200:203], v[212:215], a[132:135], v[200:203]
ds_write_b32 v165, v38 offset:7488
v_mfma_f32_16x16x32_bf16 v[200:203], v[220:223], a[136:139], v[200:203]
s_nop 1
v_cvt_pk_bf16_f32 v22, v196, v197
v_mfma_f32_16x16x32_bf16 v[200:203], v[188:191], a[140:143], v[200:203]
v_cvt_pk_bf16_f32 v23, v198, v199
s_nop 1
v_mfma_f32_16x16x32_bf16 v[196:199], v[20:23], v[156:159], 0
ds_write_b32 v165, v39 offset:7492
v_mfma_f32_16x16x32_bf16 v[196:199], v[16:19], v[152:155], v[196:199]
s_nop 1
v_cvt_pk_bf16_f32 v64, v200, v201
v_mfma_f32_16x16x32_bf16 v[204:207], v[16:19], v[96:99], 0
v_cvt_pk_bf16_f32 v65, v202, v203
s_nop 0
v_mfma_f32_16x16x32_bf16 v[204:207], v[20:23], v[100:103], v[204:207]
buffer_load_dwordx4 v243, s[16:19], s101 offen offset:3168 nt lds
v_mfma_f32_16x16x32_bf16 v[200:203], v[188:191], a[156:159], 0
v_exp_f32 v196, v196
v_mfma_f32_16x16x32_bf16 v[200:203], v[220:223], a[152:155], v[200:203]
v_exp_f32 v197, v197
v_mfma_f32_16x16x32_bf16 v[200:203], v[212:215], a[148:151], v[200:203]
v_exp_f32 v198, v198
v_mfma_f32_16x16x32_bf16 v[200:203], v[208:211], a[144:147], v[200:203]
s_waitcnt vmcnt(4)
s_barrier
v_mfma_f32_16x16x32_bf16 v[224:227], v[208:211], a[160:163], 0
ds_read_b128 v[216:219], v242 offset:16896
ds_read_b128 v[232:235], v242 offset:17152
v_mfma_f32_16x16x32_bf16 v[224:227], v[212:215], a[164:167], v[224:227]
ds_read_b128 v[192:195], v242 offset:17408
ds_read_b128 v[228:231], v242 offset:17664
v_mfma_f32_16x16x32_bf16 v[224:227], v[220:223], a[168:171], v[224:227]
v_cvt_pk_bf16_f32 v68, v200, v201
v_cvt_pk_bf16_f32 v69, v202, v203
v_mfma_f32_16x16x32_bf16 v[224:227], v[188:191], a[172:175], v[224:227]
v_exp_f32 v199, v199
v_mfma_f32_16x16x32_bf16 v[200:203], v[188:191], a[188:191], 0
ds_read_b64_tr_b16 a[192:193], v182 offset:0
v_cvt_pk_bf16_f32 v108, v196, v197
v_mfma_f32_16x16x32_bf16 v[200:203], v[220:223], a[184:187], v[200:203]
ds_read_b64_tr_b16 a[194:195], v182 offset:512
v_cvt_pk_bf16_f32 v109, v198, v199
v_mfma_f32_16x16x32_bf16 v[200:203], v[212:215], a[180:183], v[200:203]
s_waitcnt lgkmcnt(5)
ds_read_b64_tr_b16 a[196:197], v182 offset:4096
v_cvt_pk_bf16_f32 v72, v224, v225
v_mfma_f32_16x16x32_bf16 v[200:203], v[208:211], a[176:179], v[200:203]
s_waitcnt lgkmcnt(5)
ds_read_b64_tr_b16 a[198:199], v182 offset:4608
v_cvt_pk_bf16_f32 v73, v226, v227
v_mfma_f32_16x16x32_bf16 v[188:191], a[64:67], v[216:219], 0
s_waitcnt lgkmcnt(5)
ds_read_b64_tr_b16 a[200:201], v182 offset:8192
s_nop 0
v_mfma_f32_16x16x32_bf16 v[188:191], a[68:71], v[232:235], v[188:191]
s_waitcnt lgkmcnt(5)
ds_read_b64_tr_b16 a[202:203], v182 offset:8704
v_cvt_pk_bf16_f32 v76, v200, v201
v_mfma_f32_16x16x32_bf16 v[188:191], a[72:75], v[192:195], v[188:191]
ds_read_b64_tr_b16 a[204:205], v182 offset:12288
v_cvt_pk_bf16_f32 v77, v202, v203
v_mfma_f32_16x16x32_bf16 v[188:191], a[76:79], v[228:231], v[188:191]
ds_read_b64_tr_b16 a[206:207], v182 offset:12800
s_nop 0
v_mfma_f32_16x16x32_bf16 v[196:199], a[92:95], v[228:231], 0
ds_read_b64_tr_b16 a[208:209], v182 offset:8
s_nop 0
v_mfma_f32_16x16x32_bf16 v[196:199], a[88:91], v[192:195], v[196:199]
ds_read_b64_tr_b16 a[210:211], v182 offset:520
v_mfma_f32_16x16x32_bf16 v[196:199], a[84:87], v[232:235], v[196:199]
ds_read_b64_tr_b16 a[212:213], v182 offset:4104
v_cvt_pk_bf16_f32 v32, v188, v189
v_mfma_f32_16x16x32_bf16 v[196:199], a[80:83], v[216:219], v[196:199]
ds_read_b64_tr_b16 a[214:215], v182 offset:4616
v_cvt_pk_bf16_f32 v33, v190, v191
v_mfma_f32_16x16x32_bf16 v[188:191], a[96:99], v[216:219], 0
ds_read_b64_tr_b16 a[216:217], v182 offset:8200
s_nop 0
v_mfma_f32_16x16x32_bf16 v[188:191], a[100:103], v[232:235], v[188:191]
s_waitcnt lgkmcnt(12)
ds_read_b64_tr_b16 a[218:219], v182 offset:8712
v_cvt_pk_bf16_f32 v34, v196, v197
v_mfma_f32_16x16x32_bf16 v[188:191], a[104:107], v[192:195], v[188:191]
s_waitcnt lgkmcnt(12)
ds_read_b64_tr_b16 a[220:221], v182 offset:12296
v_cvt_pk_bf16_f32 v35, v198, v199
v_mfma_f32_16x16x32_bf16 v[188:191], a[108:111], v[228:231], v[188:191]
s_waitcnt lgkmcnt(12)
ds_read_b64_tr_b16 a[222:223], v182 offset:12808
s_nop 0
v_mfma_f32_16x16x32_bf16 v[196:199], a[124:127], v[228:231], 0
s_waitcnt lgkmcnt(12)
ds_read_b64_tr_b16 a[224:225], v183 offset:0
s_nop 0
v_mfma_f32_16x16x32_bf16 v[196:199], a[120:123], v[192:195], v[196:199]
s_waitcnt lgkmcnt(12)
ds_read_b64_tr_b16 a[226:227], v183 offset:512
v_cvt_pk_bf16_f32 v36, v188, v189
v_mfma_f32_16x16x32_bf16 v[196:199], a[116:119], v[232:235], v[196:199]
s_waitcnt lgkmcnt(12)
ds_read_b64_tr_b16 a[228:229], v183 offset:4096
v_cvt_pk_bf16_f32 v37, v190, v191
v_mfma_f32_16x16x32_bf16 v[196:199], a[112:115], v[216:219], v[196:199]
s_waitcnt lgkmcnt(12)
ds_read_b64_tr_b16 a[230:231], v183 offset:4608
s_nop 0
v_mfma_f32_16x16x32_bf16 v[188:191], v[216:219], a[128:131], 0
s_waitcnt lgkmcnt(12)
ds_read_b64_tr_b16 a[232:233], v183 offset:8192
s_nop 0
v_mfma_f32_16x16x32_bf16 v[188:191], v[232:235], a[132:135], v[188:191]
s_waitcnt lgkmcnt(12)
ds_read_b64_tr_b16 a[234:235], v183 offset:8704
v_cvt_pk_bf16_f32 v38, v196, v197
v_mfma_f32_16x16x32_bf16 v[188:191], v[192:195], a[136:139], v[188:191]
s_waitcnt lgkmcnt(12)
ds_read_b64_tr_b16 a[236:237], v183 offset:12288
v_cvt_pk_bf16_f32 v39, v198, v199
v_mfma_f32_16x16x32_bf16 v[188:191], v[228:231], a[140:143], v[188:191]
s_waitcnt lgkmcnt(12)
ds_read_b64_tr_b16 a[238:239], v183 offset:12800
s_nop 0
v_mfma_f32_16x16x32_bf16 v[196:199], v[36:39], v[156:159], 0
s_waitcnt lgkmcnt(12)
ds_read_b64_tr_b16 a[240:241], v183 offset:8
s_nop 0
v_mfma_f32_16x16x32_bf16 v[196:199], v[32:35], v[152:155], v[196:199]
s_waitcnt lgkmcnt(12)
ds_read_b64_tr_b16 a[242:243], v183 offset:520
v_cvt_pk_bf16_f32 v80, v188, v189
v_mfma_f32_16x16x32_bf16 v[200:203], v[32:35], v[96:99], 0
s_waitcnt lgkmcnt(12)
ds_write_b32 v164, v24 offset:6912
v_mfma_f32_16x16x32_bf16 v[200:203], v[36:39], v[100:103], v[200:203]
s_waitcnt lgkmcnt(12)
ds_read_b128 v[208:211], v242 offset:12672
v_cvt_pk_bf16_f32 v81, v190, v191
v_mfma_f32_16x16x32_bf16 v[220:223], v[228:231], a[156:159], 0
s_waitcnt lgkmcnt(12)
ds_read_b128 v[212:215], v242 offset:12928
ds_read_b128 v[224:227], v242 offset:13184
v_mfma_f32_16x16x32_bf16 v[220:223], v[192:195], a[152:155], v[220:223]
s_waitcnt lgkmcnt(13)
ds_write_b32 v164, v25 offset:6916
v_mfma_f32_16x16x32_bf16 v[220:223], v[232:235], a[148:151], v[220:223]
s_waitcnt lgkmcnt(13)
ds_write_b32 v164, v26 offset:6976
v_mfma_f32_16x16x32_bf16 v[220:223], v[216:219], a[144:147], v[220:223]
s_waitcnt lgkmcnt(13)
ds_write_b32 v164, v27 offset:6980
v_mfma_f32_16x16x32_bf16 v[188:191], v[216:219], a[160:163], 0
s_waitcnt lgkmcnt(13)
ds_write_b32 v165, v28 offset:6912
v_mfma_f32_16x16x32_bf16 v[188:191], v[232:235], a[164:167], v[188:191]
s_waitcnt lgkmcnt(13)
ds_write_b32 v165, v29 offset:6916
v_mfma_f32_16x16x32_bf16 v[188:191], v[192:195], a[168:171], v[188:191]
s_waitcnt lgkmcnt(13)
ds_read_b64_tr_b16 a[244:245], v183 offset:4104
v_cvt_pk_bf16_f32 v84, v220, v221
v_mfma_f32_16x16x32_bf16 v[188:191], v[228:231], a[172:175], v[188:191]
s_waitcnt lgkmcnt(13)
ds_read_b64_tr_b16 a[246:247], v183 offset:4616
v_exp_f32 v196, v196
v_exp_f32 v197, v197
v_exp_f32 v198, v198
v_exp_f32 v199, v199
v_cvt_pk_bf16_f32 v112, v196, v197
v_cvt_pk_bf16_f32 v113, v198, v199
v_mfma_f32_16x16x32_bf16 v[196:199], v[228:231], a[188:191], 0
s_waitcnt lgkmcnt(11)
ds_read_b64_tr_b16 a[248:249], v183 offset:8200
v_cvt_pk_bf16_f32 v88, v188, v189
v_mfma_f32_16x16x32_bf16 v[196:199], v[192:195], a[184:187], v[196:199]
ds_read_b64_tr_b16 a[250:251], v183 offset:8712
v_cvt_pk_bf16_f32 v89, v190, v191
v_mfma_f32_16x16x32_bf16 v[196:199], v[232:235], a[180:183], v[196:199]
s_waitcnt lgkmcnt(11)
ds_read_b64_tr_b16 a[252:253], v183 offset:12296
v_cvt_pk_bf16_f32 v85, v222, v223
v_mfma_f32_16x16x32_bf16 v[196:199], v[216:219], a[176:179], v[196:199]
s_waitcnt lgkmcnt(10)
ds_read_b64_tr_b16 a[254:255], v183 offset:12808
ds_read_b128 v[220:223], v242 offset:13440
v_mfma_f32_16x16x32_bf16 v[188:191], a[64:67], v[208:211], 0
ds_write_b32 v165, v30 offset:6976
v_mfma_f32_16x16x32_bf16 v[188:191], a[68:71], v[212:215], v[188:191]
ds_write_b32 v165, v31 offset:6980
v_mfma_f32_16x16x32_bf16 v[188:191], a[72:75], v[224:227], v[188:191]
v_cvt_pk_bf16_f32 v92, v196, v197
v_cvt_pk_bf16_f32 v93, v198, v199
v_exp_f32 v204, v204
v_exp_f32 v205, v205
v_exp_f32 v206, v206
v_exp_f32 v207, v207
s_waitcnt lgkmcnt(2)
v_mfma_f32_16x16x32_bf16 v[188:191], a[76:79], v[220:223], v[188:191]
s_barrier
v_mfma_f32_16x16x32_bf16 v[196:199], a[92:95], v[220:223], 0
s_add_u32 s98, s98, s48
v_cvt_pk_bf16_f32 v124, v204, v205
v_cvt_pk_bf16_f32 v125, v206, v207
v_mfma_f32_16x16x32_bf16 v[196:199], a[88:91], v[224:227], v[196:199]
s_add_u32 s99, s98, s51
v_exp_f32 v200, v200
v_mfma_f32_16x16x32_bf16 v[196:199], a[84:87], v[212:215], v[196:199]
s_add_u32 s100, s99, s51
s_add_u32 m0, s49, 8448
s_add_u32 s101, s100, s51
v_mfma_f32_16x16x32_bf16 v[196:199], a[80:83], v[208:211], v[196:199]
buffer_load_dwordx4 v243, s[16:19], s98 offen offset:0 nt lds
v_cvt_pk_bf16_f32 v24, v188, v189
v_cvt_pk_bf16_f32 v25, v190, v191
v_mfma_f32_16x16x32_bf16 v[188:191], a[96:99], v[208:211], 0
s_add_u32 s98, s98, s48
v_exp_f32 v201, v201
v_mfma_f32_16x16x32_bf16 v[188:191], a[100:103], v[212:215], v[188:191]
s_bfe_i32 s57, s3, 0x10000
v_exp_f32 v202, v202
v_mfma_f32_16x16x32_bf16 v[188:191], a[104:107], v[224:227], v[188:191]
s_and_b32 s54, s57, s5
v_exp_f32 v203, v203
v_mfma_f32_16x16x32_bf16 v[188:191], a[108:111], v[220:223], v[188:191]
s_add_u32 s50, s50, 13107200
v_cvt_pk_bf16_f32 v128, v200, v201
v_cvt_pk_bf16_f32 v129, v202, v203
v_mfma_f32_16x16x32_bf16 v[204:207], a[124:127], v[220:223], 0
s_mov_b32 s47, s46
v_cvt_pk_bf16_f32 v26, v196, v197
v_cvt_pk_bf16_f32 v27, v198, v199
v_mfma_f32_16x16x32_bf16 v[204:207], a[120:123], v[224:227], v[204:207]
s_lshr_b32 s3, s3, 1
ds_read_b128 v[196:199], v247 offset:0
v_cvt_pk_bf16_f32 v28, v188, v189
v_mfma_f32_16x16x32_bf16 v[204:207], a[116:119], v[212:215], v[204:207]
s_sub_u32 s45, s45, 1
v_cvt_pk_bf16_f32 v29, v190, v191
v_add_u32 v245, 1728, v245
v_mfma_f32_16x16x32_bf16 v[204:207], a[112:115], v[208:211], v[204:207]
buffer_load_dwordx4 v243, s[16:19], s99 offen offset:1056 nt lds
v_mfma_f32_16x16x32_bf16 v[200:203], v[208:211], a[128:131], 0
s_add_u32 s99, s98, s51
v_add_u32 v246, 1728, v246
v_add_u32 v247, 1728, v247
v_mfma_f32_16x16x32_bf16 v[200:203], v[212:215], a[132:135], v[200:203]
s_sub_u32 s50, s50, s54
s_add_u32 s52, s46, 20480
v_cvt_pk_bf16_f32 v30, v204, v205
v_mfma_f32_16x16x32_bf16 v[200:203], v[224:227], a[136:139], v[200:203]
s_add_u32 s53, s46, 0
v_cvt_pk_bf16_f32 v31, v206, v207
v_mfma_f32_16x16x32_bf16 v[200:203], v[220:223], a[140:143], v[200:203]
v_mov_b64 v[168:169], 0
v_mov_b64 v[170:171], 0
v_mfma_f32_16x16x32_bf16 v[188:191], v[28:31], v[156:159], 0
v_mov_b64 v[172:173], 0
v_mov_b64 v[174:175], 0
v_mfma_f32_16x16x32_bf16 v[188:191], v[24:27], v[152:155], v[188:191]
v_mov_b64 v[176:177], 0
v_mov_b64 v[178:179], 0
v_mfma_f32_16x16x32_bf16 v[204:207], v[24:27], v[96:99], 0
s_waitcnt lgkmcnt(0)
ds_read_b128 v[152:155], v242 offset:21120
v_cvt_pk_bf16_f32 v66, v200, v201
v_mfma_f32_16x16x32_bf16 v[204:207], v[28:31], v[100:103], v[204:207]
ds_read_b128 v[156:159], v242 offset:21376
v_cvt_pk_bf16_f32 v67, v202, v203
v_smfmac_f32_16x16x64_bf16 v[168:171], v[196:199], v[0:7], v251
ds_read_b128 v[160:163], v242 offset:21632
ds_read_b128 v[164:167], v242 offset:21888
v_smfmac_f32_16x16x64_bf16 v[172:175], v[196:199], v[16:23], v251
s_nop 2
v_smfmac_f32_16x16x64_bf16 v[176:179], v[196:199], v[32:39], v251
s_nop 0
v_add_f32 v168, v168, v169
v_mfma_f32_16x16x32_bf16 v[200:203], v[220:223], a[156:159], 0
v_exp_f32 v188, v188
v_mfma_f32_16x16x32_bf16 v[200:203], v[224:227], a[152:155], v[200:203]
v_exp_f32 v189, v189
v_mfma_f32_16x16x32_bf16 v[200:203], v[212:215], a[148:151], v[200:203]
v_exp_f32 v190, v190
v_mfma_f32_16x16x32_bf16 v[200:203], v[208:211], a[144:147], v[200:203]
v_exp_f32 v191, v191
v_smfmac_f32_16x16x64_bf16 v[170:173], v[196:199], v[8:15], v251
v_cvt_pk_bf16_f32 v110, v188, v189
v_smfmac_f32_16x16x64_bf16 v[174:177], v[196:199], v[24:31], v251
v_cvt_pk_bf16_f32 v111, v190, v191
v_smfmac_f32_16x16x64_bf16 v[178:181], v[196:199], v[40:47], v251
s_nop 1
v_cvt_pk_bf16_f32 v70, v200, v201
v_mfma_f32_16x16x32_bf16 v[188:191], v[208:211], a[160:163], 0
v_cvt_pk_bf16_f32 v71, v202, v203
v_add_f32 v170, v170, v171
v_mfma_f32_16x16x32_bf16 v[188:191], v[212:215], a[164:167], v[188:191]
s_waitcnt lgkmcnt(3)
ds_read_b128 v[200:203], v242 offset:0
v_add_f32 v172, v172, v173
v_mfma_f32_16x16x32_bf16 v[188:191], v[224:227], a[168:171], v[188:191]
s_waitcnt lgkmcnt(3)
v_exp_f32 v168, v168
v_mfma_f32_16x16x32_bf16 v[188:191], v[220:223], a[172:175], v[188:191]
buffer_load_dwordx4 v243, s[16:19], s100 offen offset:2112 nt lds
v_mfma_f32_16x16x32_bf16 v[196:199], v[220:223], a[188:191], 0
s_waitcnt lgkmcnt(1)
v_mov_b64 v[220:221], 0
v_add_f32 v174, v174, v175
v_mfma_f32_16x16x32_bf16 v[196:199], v[224:227], a[184:187], v[196:199]
s_add_u32 s100, s99, s51
ds_read_b128 v[224:227], v242 offset:256
v_cvt_pk_bf16_f32 v74, v188, v189
v_mfma_f32_16x16x32_bf16 v[196:199], v[212:215], a[180:183], v[196:199]
ds_read_b128 v[212:215], v242 offset:512
v_cvt_pk_bf16_f32 v75, v190, v191
v_mfma_f32_16x16x32_bf16 v[196:199], v[208:211], a[176:179], v[196:199]
ds_read_b128 v[188:191], v242 offset:768
v_add_f32 v176, v176, v177
v_smfmac_f32_16x16x64_bf16 v[220:223], v[184:187], v[104:111], v251
v_add_f32 v178, v178, v179
v_smfmac_f32_16x16x64_bf16 v[220:223], v[184:187], v[112:119], v251 abid:1
s_nop 2
v_mfma_f32_16x16x32_bf16 v[136:139], a[192:195], v[152:155], 0
v_exp_f32 v170, v170
v_mfma_f32_16x16x32_bf16 v[136:139], a[196:199], v[156:159], v[136:139]
v_exp_f32 v172, v172
v_mfma_f32_16x16x32_bf16 v[136:139], a[200:203], v[160:163], v[136:139]
v_exp_f32 v174, v174
v_mfma_f32_16x16x32_bf16 v[136:139], a[204:207], v[164:167], v[136:139]
buffer_load_dwordx4 v243, s[16:19], s101 offen offset:3168 nt lds
v_mfma_f32_16x16x32_bf16 v[140:143], a[220:223], v[164:167], 0
s_add_u32 m0, s49, 16896
v_exp_f32 v176, v176
v_mfma_f32_16x16x32_bf16 v[140:143], a[216:219], v[160:163], v[140:143]
s_add_u32 s101, s100, s51
v_add_f32 v180, v168, v170
v_cvt_pk_bf16_f32 v169, v168, v170
v_mfma_f32_16x16x32_bf16 v[140:143], a[212:215], v[156:159], v[140:143]
s_waitcnt lgkmcnt(3)
ds_write_b16 v248, v169 offset:0
v_mfma_f32_16x16x32_bf16 v[140:143], a[208:211], v[152:155], v[140:143]
s_and_b32 s51, s57, 13106176
ds_write_b16_d16_hi v248, v169 offset:4
v_mfma_f32_16x16x32_bf16 v[144:147], a[224:227], v[152:155], 0
s_waitcnt lgkmcnt(4)
v_add_f32 v180, v180, v172
v_add_f32 v180, v180, v174
v_mfma_f32_16x16x32_bf16 v[144:147], a[228:231], v[156:159], v[144:147]
s_waitcnt lgkmcnt(3)
v_exp_f32 v178, v178
v_mfma_f32_16x16x32_bf16 v[144:147], a[232:235], v[160:163], v[144:147]
s_waitcnt lgkmcnt(2)
v_add_f32 v180, v180, v176
v_add_f32 v180, v180, v178
v_mfma_f32_16x16x32_bf16 v[144:147], a[236:239], v[164:167], v[144:147]
buffer_load_dwordx4 v243, s[16:19], s98 offen offset:0 nt lds
v_mfma_f32_16x16x32_bf16 v[148:151], a[252:255], v[164:167], 0
s_lshl3_add_u32 s48, s51, 8192
v_cvt_pk_bf16_f32 v173, v172, v174
v_add_f32_dpp v180, v180, v180 row_ror:8 row_mask:0xf bank_mask:0xf
v_mfma_f32_16x16x32_bf16 v[148:151], a[244:247], v[156:159], v[148:151]
s_sub_u32 s49, s49, s56
ds_write_b16 v248, v173 offset:272
v_mfma_f32_16x16x32_bf16 v[148:151], a[240:243], v[152:155], v[148:151]
s_sub_u32 s51, s51, 32
ds_write_b16_d16_hi v248, v173 offset:276
v_mfma_f32_16x16x32_bf16 v[148:151], a[248:251], v[160:163], v[148:151]
v_cvt_pk_bf16_f32 v177, v176, v178
v_add_f32_dpp v180, v180, v180 row_ror:4 row_mask:0xf bank_mask:0xf
v_mfma_f32_16x16x32_bf16 v[164:167], a[248:251], v[212:215], 0
ds_write_b16 v248, v177 offset:544
v_mfma_f32_16x16x32_bf16 v[164:167], a[252:255], v[188:191], v[164:167]
ds_write_b16_d16_hi v248, v177 offset:548
v_mfma_f32_16x16x32_bf16 v[164:167], a[244:247], v[224:227], v[164:167]
ds_write_b32 v250, v180 offset:256
v_mfma_f32_16x16x32_bf16 v[164:167], a[240:243], v[200:203], v[164:167]
buffer_load_dwordx4 v243, s[16:19], s99 offen offset:1056 nt lds
v_mfma_f32_16x16x32_bf16 v[160:163], a[224:227], v[200:203], 0
ds_read_b128 v[208:211], v249 offset:272
v_add_f32 v220, v220, v221
v_mfma_f32_16x16x32_bf16 v[160:163], a[228:231], v[224:227], v[160:163]
v_exp_f32 v204, v204
v_mfma_f32_16x16x32_bf16 v[160:163], a[232:235], v[212:215], v[160:163]
v_exp_f32 v205, v205
v_mfma_f32_16x16x32_bf16 v[160:163], a[236:239], v[188:191], v[160:163]
v_exp_f32 v206, v206
v_mfma_f32_32x32x16_bf16 v[168:183], v[236:239], v[116:119], 0
v_exp_f32 v207, v207
v_cvt_pk_bf16_f32 v126, v204, v205
v_cvt_pk_bf16_f32 v127, v206, v207
v_rcp_f32 v254, v220
v_mfma_f32_16x16x32_bf16 v[156:159], a[220:223], v[188:191], 0
v_cvt_pk_bf16_f32 v78, v196, v197
v_cvt_pk_bf16_f32 v79, v198, v199
v_mfma_f32_16x16x32_bf16 v[156:159], a[216:219], v[212:215], v[156:159]
v_max3_f32 v255, v255, v220, v254
v_mfma_f32_16x16x32_bf16 v[156:159], a[212:215], v[224:227], v[156:159]
v_mfma_f32_16x16x32_bf16 v[156:159], a[208:211], v[200:203], v[156:159]
buffer_load_dwordx4 v243, s[16:19], s100 offen offset:2112 nt lds
v_mfma_f32_16x16x32_bf16 v[152:155], a[192:195], v[200:203], 0
v_mfma_f32_16x16x32_bf16 v[152:155], a[196:199], v[224:227], v[152:155]
v_mfma_f32_16x16x32_bf16 v[152:155], a[200:203], v[212:215], v[152:155]
ds_read_b128 v[212:215], v249 offset:544
v_mfma_f32_16x16x32_bf16 v[152:155], a[204:207], v[188:191], v[152:155]
buffer_load_dwordx4 v243, s[16:19], s101 offen offset:3168 nt lds
v_mfma_f32_16x16x32_bf16 v[188:191], v[40:43], v[96:99], 0
s_mov_b32 m0, s58
v_mfma_f32_16x16x32_bf16 v[188:191], v[44:47], v[100:103], v[188:191]
s_waitcnt lgkmcnt(1)
v_mfma_f32_16x16x32_bf16 v[168:171], v[48:51], v[104:107], v[168:171]
v_mfma_f32_16x16x32_bf16 v[168:171], v[64:67], v[108:111], v[168:171]
s_nop 7
s_waitcnt lgkmcnt(0)
s_branch L_entryf
L_spin:
ds_read_addtid_b32 v192 offset:65280
s_waitcnt lgkmcnt(0)
v_cmp_lt_u32 vcc, s45, v192
s_nop 1
s_cbranch_vccnz L_spin
s_branch L_back
L_spine:
ds_read_addtid_b32 v208 offset:65280
s_waitcnt lgkmcnt(0)
v_cmp_lt_u32 vcc, s45, v208
s_nop 1
s_cbranch_vccnz L_spine
s_branch L_backe
.p2align 12
.fill 471, 4, 0xbf800000
L_h3:
s_cbranch_execz L_ret
L_loopf:
v_mfma_f32_16x16x32_bf16 v[152:155], a[192:195], v[204:207], 0
s_mov_b32 m0, s59
s_nop 0
ds_read_addtid_b32 v192 offset:65280
v_mfma_f32_16x16x32_bf16 v[152:155], a[196:199], v[212:215], v[152:155]
s_add_u32 s52, s47, 8192
v_cvt_pk_bf16_f32 v102, v232, v233
v_cvt_pk_bf16_f32 v103, v234, v235
v_mfma_f32_16x16x32_bf16 v[152:155], a[200:203], v[188:191], v[152:155]
s_add_u32 s53, s47, 12288
v_exp_f32 v196, v196
v_mfma_f32_16x16x32_bf16 v[152:155], a[204:207], v[216:219], v[152:155]
s_bfe_i32 s57, s3, 0x10000
v_exp_f32 v197, v197
v_mfma_f32_16x16x32_bf16 v[156:159], a[220:223], v[216:219], 0
s_mov_b32 s47, s46
v_exp_f32 v198, v198
v_mfma_f32_16x16x32_bf16 v[156:159], a[216:219], v[188:191], v[156:159]
s_and_b32 s54, s57, s5
v_exp_f32 v199, v199
v_mfma_f32_16x16x32_bf16 v[156:159], a[212:215], v[212:215], v[156:159]
s_waitcnt lgkmcnt(0)
v_cmp_lt_u32 vcc, s45, v192
v_cvt_pk_bf16_f32 v104, v196, v197
v_mfma_f32_16x16x32_bf16 v[156:159], a[208:211], v[204:207], v[156:159]
s_lshr_b32 s3, s3, 1
v_cvt_pk_bf16_f32 v105, v198, v199
v_mfma_f32_16x16x32_bf16 v[160:163], a[224:227], v[204:207], 0
v_exp_f32 v200, v200
v_mfma_f32_16x16x32_bf16 v[160:163], a[228:231], v[212:215], v[160:163]
s_cbranch_vccnz L_spin
L_back:
v_exp_f32 v201, v201
v_mfma_f32_16x16x32_bf16 v[160:163], a[232:235], v[188:191], v[160:163]
s_mov_b32 s98, s50
ds_read_b128 v[192:195], v242 offset:0
ds_read_b128 v[196:199], v242 offset:256
v_mfma_f32_16x16x32_bf16 v[160:163], a[236:239], v[216:219], v[160:163]
s_add_u32 s99, s98, s51
ds_read_b128 v[232:235], v242 offset:512
v_cvt_pk_bf16_f32 v106, v200, v201
v_mfma_f32_16x16x32_bf16 v[164:167], a[252:255], v[216:219], 0
s_add_u32 s100, s99, s51
v_exp_f32 v202, v202
v_mfma_f32_16x16x32_bf16 v[164:167], a[248:251], v[188:191], v[164:167]
s_add_u32 m0, s49, 0
v_mov_b64 v[188:189], s[96:97]
v_mov_b64 v[190:191], s[96:97]
v_mfma_f32_16x16x32_bf16 v[164:167], a[244:247], v[212:215], v[164:167]
s_add_u32 s101, s100, s51
v_exp_f32 v203, v203
v_mfma_f32_16x16x32_bf16 v[164:167], a[240:243], v[204:207], v[164:167]
s_sub_u32 s45, s45, 1
v_cvt_pk_bf16_f32 v107, v202, v203
s_add_u32 s50, s50, 13107200
v_smfmac_f32_16x16x64_bf16 v[188:191], v[238:241], v[96:103], v251
s_waitcnt lgkmcnt(2)
ds_read_b128 v[200:203], v242 offset:768
s_sub_u32 s50, s50, s54
v_mfma_f32_16x16x32_bf16 v[204:207], v[0:3], v[96:99], 0
v_exp_f32 v224, v224
v_mfma_f32_16x16x32_bf16 v[204:207], v[4:7], v[100:103], v[204:207]
v_exp_f32 v225, v225
v_mfma_f32_16x16x32_bf16 v[208:211], v[12:15], v[100:103], 0
v_exp_f32 v226, v226
v_mfma_f32_16x16x32_bf16 v[208:211], v[8:11], v[96:99], v[208:211]
s_waitcnt lgkmcnt(2)
v_exp_f32 v227, v227
v_mfma_f32_16x16x32_bf16 v[212:215], a[64:67], v[192:195], 0
s_waitcnt lgkmcnt(1)
v_cvt_pk_bf16_f32 v108, v224, v225
v_cvt_pk_bf16_f32 v109, v226, v227
v_mfma_f32_16x16x32_bf16 v[212:215], a[68:71], v[196:199], v[212:215]
s_waitcnt lgkmcnt(0)
v_exp_f32 v220, v220
v_mfma_f32_16x16x32_bf16 v[212:215], a[72:75], v[232:235], v[212:215]
v_exp_f32 v221, v221
v_mfma_f32_16x16x32_bf16 v[212:215], a[76:79], v[200:203], v[212:215]
v_exp_f32 v222, v222
v_mfma_f32_16x16x32_bf16 v[216:219], a[92:95], v[200:203], 0
v_exp_f32 v223, v223
v_mfma_f32_16x16x32_bf16 v[216:219], a[88:91], v[232:235], v[216:219]
v_cvt_pk_bf16_f32 v114, v220, v221
v_cvt_pk_bf16_f32 v115, v222, v223
v_mfma_f32_16x16x32_bf16 v[216:219], a[84:87], v[196:199], v[216:219]
s_nop 0
v_cvt_pk_bf16_f32 v0, v212, v213
v_cvt_pk_bf16_f32 v1, v214, v215
v_mfma_f32_16x16x32_bf16 v[216:219], a[80:83], v[192:195], v[216:219]
buffer_load_dwordx4 v243, s[16:19], s98 offen offset:0 nt lds
v_mfma_f32_16x16x32_bf16 v[224:227], a[96:99], v[192:195], 0
s_add_u32 s98, s98, s48
v_exp_f32 v228, v228
v_mfma_f32_16x16x32_bf16 v[224:227], a[100:103], v[196:199], v[224:227]
v_exp_f32 v229, v229
v_mfma_f32_16x16x32_bf16 v[224:227], a[104:107], v[232:235], v[224:227]
s_nop 0
v_cvt_pk_bf16_f32 v2, v216, v217
v_cvt_pk_bf16_f32 v3, v218, v219
v_mfma_f32_16x16x32_bf16 v[224:227], a[108:111], v[200:203], v[224:227]
v_mov_b64 v[212:213], 0
v_cvt_pk_bf16_f32 v112, v228, v229
v_mfma_f32_16x16x32_bf16 v[216:219], a[124:127], v[200:203], 0
v_exp_f32 v230, v230
v_mfma_f32_16x16x32_bf16 v[216:219], a[120:123], v[232:235], v[216:219]
v_exp_f32 v231, v231
v_mfma_f32_16x16x32_bf16 v[216:219], a[116:119], v[196:199], v[216:219]
v_cvt_pk_bf16_f32 v113, v230, v231
v_add_f32 v188, v188, v189
v_mfma_f32_16x16x32_bf16 v[216:219], a[112:115], v[192:195], v[216:219]
ds_read_b128 v[192:195], v242 offset:4992
v_add_f32 v190, v190, v191
v_smfmac_f32_16x16x64_bf16 v[212:215], v[184:187], v[104:111], v251
ds_read_b128 v[196:199], v242 offset:4736
ds_read_b128 v[200:203], v242 offset:4480
v_smfmac_f32_16x16x64_bf16 v[212:215], v[184:187], v[112:119], v251 abid:1
ds_read_b128 v[220:223], v242 offset:4224
v_cvt_pk_bf16_f32 v4, v224, v225
v_mfma_f32_16x16x32_bf16 v[168:171], v[80:83], v[112:115], v[168:171]
v_exp_f32 v204, v204
v_mfma_f32_16x16x32_bf16 v[168:171], v[64:67], v[108:111], v[168:171]
v_exp_f32 v205, v205
v_mfma_f32_16x16x32_bf16 v[168:171], v[48:51], v[104:107], v[168:171]
v_exp_f32 v206, v206
v_mfma_f32_16x16x32_bf16 v[172:175], v[52:55], v[104:107], v[172:175]
s_waitcnt lgkmcnt(3)
v_exp_f32 v207, v207
v_mfma_f32_16x16x32_bf16 v[172:175], v[68:71], v[108:111], v[172:175]
v_cvt_pk_bf16_f32 v120, v204, v205
v_cvt_pk_bf16_f32 v121, v206, v207
v_mfma_f32_16x16x32_bf16 v[172:175], v[84:87], v[112:115], v[172:175]
s_waitcnt lgkmcnt(0)
v_exp_f32 v188, v188
v_mfma_f32_16x16x32_bf16 v[176:179], v[88:91], v[112:115], v[176:179]
v_exp_f32 v190, v190
v_mfma_f32_16x16x32_bf16 v[176:179], v[72:75], v[108:111], v[176:179]
v_perm_b32 v132, v190, v188, v252
v_perm_b32 v133, v190, v188, v253
v_mfma_f32_16x16x32_bf16 v[176:179], v[56:59], v[104:107], v[176:179]
v_exp_f32 v208, v208
v_mfma_f32_16x16x32_bf16 v[180:183], v[60:63], v[104:107], v[180:183]
v_exp_f32 v209, v209
v_mfma_f32_16x16x32_bf16 v[180:183], v[76:79], v[108:111], v[180:183]
v_exp_f32 v210, v210
v_mfma_f32_16x16x32_bf16 v[180:183], v[92:95], v[112:115], v[180:183]
v_exp_f32 v211, v211
v_mfma_f32_16x16x32_bf16 v[204:207], v[20:23], v[100:103], 0
v_cvt_pk_bf16_f32 v122, v208, v209
v_cvt_pk_bf16_f32 v123, v210, v211
v_mfma_f32_16x16x32_bf16 v[204:207], v[16:19], v[96:99], v[204:207]
v_add_f32 v212, v212, v213
v_cvt_pk_bf16_f32 v5, v226, v227
v_mfma_f32_16x16x32_bf16 v[188:191], v[40:43], v[96:99], 0
v_rcp_f32 v254, v212
v_mfma_f32_16x16x32_bf16 v[188:191], v[44:47], v[100:103], v[188:191]
v_max3_f32 v255, v255, v212, v254
v_cvt_pk_bf16_f32 v6, v216, v217
v_mfma_f32_16x16x32_bf16 v[208:211], a[124:127], v[192:195], 0
v_exp_f32 v204, v204
v_mfma_f32_16x16x32_bf16 v[208:211], a[120:123], v[196:199], v[208:211]
v_exp_f32 v205, v205
v_mfma_f32_16x16x32_bf16 v[208:211], a[116:119], v[200:203], v[208:211]
s_nop 0
v_exp_f32 v188, v188
v_mfma_f32_16x16x32_bf16 v[208:211], a[112:115], v[220:223], v[208:211]
buffer_load_dwordx4 v243, s[16:19], s99 offen offset:1056 nt lds
v_mfma_f32_16x16x32_bf16 v[228:231], a[96:99], v[220:223], 0
s_add_u32 s99, s98, s51
v_exp_f32 v189, v189
v_mfma_f32_16x16x32_bf16 v[228:231], a[100:103], v[200:203], v[228:231]
v_exp_f32 v190, v190
v_mfma_f32_16x16x32_bf16 v[228:231], a[104:107], v[196:199], v[228:231]
v_exp_f32 v191, v191
v_mfma_f32_16x16x32_bf16 v[228:231], a[108:111], v[192:195], v[228:231]
v_cvt_pk_bf16_f32 v130, v188, v189
v_cvt_pk_bf16_f32 v131, v190, v191
v_mfma_f32_16x16x32_bf16 v[212:215], a[92:95], v[192:195], 0
v_exp_f32 v206, v206
v_mfma_f32_16x16x32_bf16 v[212:215], a[88:91], v[196:199], v[212:215]
v_exp_f32 v207, v207
v_mfma_f32_16x16x32_bf16 v[212:215], a[84:87], v[200:203], v[212:215]
v_cvt_pk_bf16_f32 v124, v204, v205
v_cvt_pk_bf16_f32 v125, v206, v207
v_mfma_f32_16x16x32_bf16 v[212:215], a[80:83], v[220:223], v[212:215]
ds_read_b128 v[204:207], v242 offset:16896
v_cvt_pk_bf16_f32 v12, v228, v229
v_mfma_f32_16x16x32_bf16 v[232:235], v[36:39], v[100:103], 0
v_cvt_pk_bf16_f32 v13, v230, v231
v_cvt_pk_bf16_f32 v14, v208, v209
v_mfma_f32_16x16x32_bf16 v[232:235], v[32:35], v[96:99], v[232:235]
v_cvt_pk_bf16_f32 v15, v210, v211
v_cvt_pk_bf16_f32 v7, v218, v219
v_mfma_f32_16x16x32_bf16 v[188:191], v[24:27], v[96:99], 0
ds_read_b128 v[208:211], v242 offset:17152
ds_read_b128 v[216:219], v242 offset:17408
v_mfma_f32_16x16x32_bf16 v[188:191], v[28:31], v[100:103], v[188:191]
v_cvt_pk_bf16_f32 v10, v212, v213
v_cvt_pk_bf16_f32 v11, v214, v215
v_mfma_f32_16x16x32_bf16 v[224:227], a[68:71], v[200:203], 0
ds_read_b128 v[212:215], v242 offset:17664
ds_read_b128 v[200:203], v242 offset:8448
v_mfma_f32_16x16x32_bf16 v[224:227], a[72:75], v[196:199], v[224:227]
ds_read_b128 v[196:199], v242 offset:8704
v_fmac_f32 v136, v168, v254
v_mfma_f32_16x16x32_bf16 v[224:227], a[76:79], v[192:195], v[224:227]
s_waitcnt lgkmcnt(5)
ds_read_b128 v[192:195], v242 offset:8960
v_fmac_f32 v137, v169, v254
v_mfma_f32_16x16x32_bf16 v[224:227], a[64:67], v[220:223], v[224:227]
ds_read_b128 v[220:223], v242 offset:9216
v_fmac_f32 v144, v176, v254
v_mfma_f32_16x16x32_bf16 v[228:231], a[64:67], v[204:207], 0
s_waitcnt lgkmcnt(5)
v_exp_f32 v188, v188
v_mfma_f32_16x16x32_bf16 v[228:231], a[68:71], v[208:211], v[228:231]
v_exp_f32 v189, v189
v_mfma_f32_16x16x32_bf16 v[228:231], a[72:75], v[216:219], v[228:231]
s_waitcnt lgkmcnt(4)
v_cvt_pk_bf16_f32 v8, v224, v225
v_cvt_pk_bf16_f32 v9, v226, v227
v_mfma_f32_16x16x32_bf16 v[228:231], a[76:79], v[212:215], v[228:231]
v_exp_f32 v190, v190
v_mfma_f32_16x16x32_bf16 v[224:227], a[92:95], v[212:215], 0
s_waitcnt lgkmcnt(1)
v_exp_f32 v191, v191
v_mfma_f32_16x16x32_bf16 v[224:227], a[88:91], v[216:219], v[224:227]
s_waitcnt lgkmcnt(0)
v_cvt_pk_bf16_f32 v126, v188, v189
v_cvt_pk_bf16_f32 v127, v190, v191
v_mfma_f32_16x16x32_bf16 v[224:227], a[84:87], v[208:211], v[224:227]
v_cvt_pk_bf16_f32 v32, v228, v229
v_cvt_pk_bf16_f32 v33, v230, v231
v_mfma_f32_16x16x32_bf16 v[224:227], a[80:83], v[204:207], v[224:227]
buffer_load_dwordx4 v243, s[16:19], s100 offen offset:2112 nt lds
v_mfma_f32_16x16x32_bf16 v[228:231], a[96:99], v[204:207], 0
s_add_u32 s100, s99, s51
v_fmac_f32 v145, v177, v254
v_fmac_f32 v138, v170, v254
v_mfma_f32_16x16x32_bf16 v[228:231], a[100:103], v[208:211], v[228:231]
v_fmac_f32 v139, v171, v254
v_fmac_f32 v146, v178, v254
v_mfma_f32_16x16x32_bf16 v[228:231], a[104:107], v[216:219], v[228:231]
v_cvt_pk_bf16_f32 v34, v224, v225
v_cvt_pk_bf16_f32 v35, v226, v227
v_mfma_f32_16x16x32_bf16 v[228:231], a[108:111], v[212:215], v[228:231]
v_fmac_f32 v147, v179, v254
v_fmac_f32 v140, v172, v254
v_mfma_f32_16x16x32_bf16 v[224:227], a[124:127], v[212:215], 0
v_fmac_f32 v141, v173, v254
v_fmac_f32 v142, v174, v254
v_mfma_f32_16x16x32_bf16 v[224:227], a[116:119], v[208:211], v[224:227]
v_fmac_f32 v143, v175, v254
v_fmac_f32 v148, v180, v254
v_mfma_f32_16x16x32_bf16 v[224:227], a[112:115], v[204:207], v[224:227]
v_fmac_f32 v149, v181, v254
v_fmac_f32 v150, v182, v254
v_mfma_f32_16x16x32_bf16 v[224:227], a[120:123], v[216:219], v[224:227]
v_fmac_f32 v151, v183, v254
v_cvt_pk_bf16_f32 v136, v136, v137
v_mfma_f32_16x16x32_bf16 v[204:207], a[120:123], v[192:195], 0
v_cvt_pk_bf16_f32 v144, v144, v145
v_cvt_pk_bf16_f32 v137, v138, v139
v_mfma_f32_16x16x32_bf16 v[204:207], a[124:127], v[220:223], v[204:207]
v_cvt_pk_bf16_f32 v145, v146, v147
v_cvt_pk_bf16_f32 v138, v140, v141
v_mfma_f32_16x16x32_bf16 v[204:207], a[116:119], v[196:199], v[204:207]
v_cvt_pk_bf16_f32 v139, v142, v143
v_cvt_pk_bf16_f32 v146, v148, v149
v_mfma_f32_16x16x32_bf16 v[204:207], a[112:115], v[200:203], v[204:207]
v_cvt_pk_bf16_f32 v147, v150, v151
v_pk_max_i16 v136, v136, 0
v_mfma_f32_16x16x32_bf16 v[208:211], a[96:99], v[200:203], 0
v_pk_max_i16 v137, v137, 0
v_pk_max_i16 v138, v138, 0
v_mfma_f32_16x16x32_bf16 v[208:211], a[100:103], v[196:199], v[208:211]
v_pk_max_i16 v139, v139, 0
v_pk_max_i16 v144, v144, 0
v_mfma_f32_16x16x32_bf16 v[208:211], a[104:107], v[192:195], v[208:211]
v_pk_max_i16 v145, v145, 0
v_pk_max_i16 v146, v146, 0
v_mfma_f32_16x16x32_bf16 v[208:211], a[108:111], v[220:223], v[208:211]
v_pk_max_i16 v147, v147, 0
v_mov_b64 v[140:141], v[136:137]
v_mfma_f32_16x16x32_bf16 v[188:191], a[92:95], v[220:223], 0
v_mov_b64 v[142:143], v[138:139]
v_mov_b32_dpp v136, v144 row_ror:8 row_mask:0xf bank_mask:0xc
v_mfma_f32_16x16x32_bf16 v[188:191], a[88:91], v[192:195], v[188:191]
v_mov_b32_dpp v137, v145 row_ror:8 row_mask:0xf bank_mask:0xc
v_mov_b32_dpp v138, v146 row_ror:8 row_mask:0xf bank_mask:0xc
v_mfma_f32_16x16x32_bf16 v[188:191], a[84:87], v[196:199], v[188:191]
v_mov_b32_dpp v139, v147 row_ror:8 row_mask:0xf bank_mask:0xc
v_mov_b32_dpp v144, v140 row_ror:8 row_mask:0xf bank_mask:0x3
v_mfma_f32_16x16x32_bf16 v[188:191], a[80:83], v[200:203], v[188:191]
v_mov_b32_dpp v145, v141 row_ror:8 row_mask:0xf bank_mask:0x3
v_mov_b32_dpp v146, v142 row_ror:8 row_mask:0xf bank_mask:0x3
v_mfma_f32_16x16x32_bf16 v[212:215], a[64:67], v[200:203], 0
v_mov_b32_dpp v147, v143 row_ror:8 row_mask:0xf bank_mask:0x3
v_mov_b64 v[216:217], 0
v_mfma_f32_16x16x32_bf16 v[212:215], a[68:71], v[196:199], v[212:215]
v_exp_f32 v232, v232
v_mfma_f32_16x16x32_bf16 v[212:215], a[72:75], v[192:195], v[212:215]
v_exp_f32 v233, v233
v_mfma_f32_16x16x32_bf16 v[212:215], a[76:79], v[220:223], v[212:215]
v_exp_f32 v234, v234
v_mfma_f32_32x32x16_bf16 v[168:183], v[236:239], v[132:135], 0
buffer_store_dwordx4 v[136:139], v244, s[20:23], s52 offen offset:0 nt
buffer_store_dwordx4 v[144:147], v244, s[20:23], s52 offen offset:2048 nt
v_exp_f32 v235, v235
v_cvt_pk_bf16_f32 v128, v232, v233
v_cvt_pk_bf16_f32 v129, v234, v235
v_smfmac_f32_16x16x64_bf16 v[216:219], v[184:187], v[120:127], v251
s_add_u32 s52, s46, 20480
ds_read_b128 v[232:235], v242 offset:12672
v_cvt_pk_bf16_f32 v16, v212, v213
v_smfmac_f32_16x16x64_bf16 v[216:219], v[184:187], v[128:135], v251 abid:1
v_cvt_pk_bf16_f32 v17, v214, v215
v_mfma_f32_16x16x32_bf16 v[168:171], v[80:83], v[128:131], v[168:171]
v_cvt_pk_bf16_f32 v38, v224, v225
v_cvt_pk_bf16_f32 v39, v226, v227
v_mfma_f32_16x16x32_bf16 v[168:171], v[64:67], v[124:127], v[168:171]
v_cvt_pk_bf16_f32 v22, v204, v205
v_cvt_pk_bf16_f32 v23, v206, v207
v_mfma_f32_16x16x32_bf16 v[168:171], v[48:51], v[120:123], v[168:171]
ds_read_b128 v[204:207], v242 offset:12928
v_add_f32 v216, v216, v217
v_mfma_f32_16x16x32_bf16 v[172:175], v[52:55], v[120:123], v[172:175]
ds_read_b128 v[238:241], v245 offset:0
v_cvt_pk_bf16_f32 v18, v188, v189
v_mfma_f32_16x16x32_bf16 v[172:175], v[68:71], v[124:127], v[172:175]
ds_read2_b32 v[236:237], v246 offset0:0 offset1:8
v_cvt_pk_bf16_f32 v19, v190, v191
v_mfma_f32_16x16x32_bf16 v[172:175], v[84:87], v[128:131], v[172:175]
ds_read_b128 v[188:191], v242 offset:13184
v_cvt_pk_bf16_f32 v20, v208, v209
v_mfma_f32_16x16x32_bf16 v[176:179], v[88:91], v[128:131], v[176:179]
L_h4:
s_cbranch_execz L_ret
v_rcp_f32 v254, v216
v_mfma_f32_16x16x32_bf16 v[176:179], v[72:75], v[124:127], v[176:179]
v_max3_f32 v255, v255, v216, v254
v_cvt_pk_bf16_f32 v21, v210, v211
v_mfma_f32_16x16x32_bf16 v[176:179], v[56:59], v[120:123], v[176:179]
ds_read_b128 v[208:211], v242 offset:13440
v_fmac_f32 v152, v168, v254
v_mfma_f32_16x16x32_bf16 v[180:183], v[60:63], v[120:123], v[180:183]
v_fmac_f32 v153, v169, v254
v_fmac_f32 v154, v170, v254
v_mfma_f32_16x16x32_bf16 v[180:183], v[76:79], v[124:127], v[180:183]
v_fmac_f32 v155, v171, v254
v_fmac_f32 v156, v172, v254
v_mfma_f32_16x16x32_bf16 v[180:183], v[92:95], v[128:131], v[180:183]
s_waitcnt lgkmcnt(5)
v_fmac_f32 v157, v173, v254
v_fmac_f32 v158, v174, v254
v_mfma_f32_16x16x32_bf16 v[212:215], v[200:203], a[128:131], 0
v_fmac_f32 v159, v175, v254
v_fmac_f32 v160, v176, v254
v_mfma_f32_16x16x32_bf16 v[212:215], v[196:199], a[132:135], v[212:215]
v_fmac_f32 v161, v177, v254
v_fmac_f32 v162, v178, v254
v_mfma_f32_16x16x32_bf16 v[212:215], v[192:195], a[136:139], v[212:215]
v_fmac_f32 v163, v179, v254
v_cvt_pk_bf16_f32 v36, v228, v229
v_mfma_f32_16x16x32_bf16 v[212:215], v[220:223], a[140:143], v[212:215]
s_waitcnt lgkmcnt(4)
v_cvt_pk_bf16_f32 v37, v230, v231
v_fmac_f32 v164, v180, v254
v_mfma_f32_16x16x32_bf16 v[224:227], v[220:223], a[156:159], 0
s_waitcnt lgkmcnt(3)
v_fmac_f32 v165, v181, v254
v_cvt_pk_bf16_f32 v152, v152, v153
v_mfma_f32_16x16x32_bf16 v[224:227], v[192:195], a[152:155], v[224:227]
s_waitcnt lgkmcnt(2)
v_cvt_pk_bf16_f32 v64, v212, v213
v_cvt_pk_bf16_f32 v65, v214, v215
v_mfma_f32_16x16x32_bf16 v[224:227], v[196:199], a[148:151], v[224:227]
s_waitcnt lgkmcnt(1)
v_cvt_pk_bf16_f32 v160, v160, v161
v_cvt_pk_bf16_f32 v153, v154, v155
v_mfma_f32_16x16x32_bf16 v[224:227], v[200:203], a[144:147], v[224:227]
v_fmac_f32 v166, v182, v254
v_fmac_f32 v167, v183, v254
v_mfma_f32_16x16x32_bf16 v[216:219], v[200:203], a[160:163], 0
v_cvt_pk_bf16_f32 v161, v162, v163
v_cvt_pk_bf16_f32 v154, v156, v157
v_mfma_f32_16x16x32_bf16 v[216:219], v[196:199], a[164:167], v[216:219]
s_waitcnt lgkmcnt(0)
v_cvt_pk_bf16_f32 v155, v158, v159
v_cvt_pk_bf16_f32 v68, v224, v225
v_mfma_f32_16x16x32_bf16 v[216:219], v[192:195], a[168:171], v[216:219]
v_cvt_pk_bf16_f32 v69, v226, v227
v_cvt_pk_bf16_f32 v162, v164, v165
v_mfma_f32_16x16x32_bf16 v[216:219], v[220:223], a[172:175], v[216:219]
buffer_load_dwordx4 v243, s[16:19], s101 offen offset:3168 nt lds
v_mfma_f32_16x16x32_bf16 v[212:215], v[220:223], a[188:191], 0
s_add_u32 m0, s49, 8448
v_cvt_pk_bf16_f32 v163, v166, v167
v_pk_max_i16 v152, v152, 0
v_mfma_f32_16x16x32_bf16 v[212:215], v[192:195], a[184:187], v[212:215]
s_add_u32 s101, s100, s51
v_pk_max_i16 v153, v153, 0
v_cvt_pk_bf16_f32 v72, v216, v217
v_mfma_f32_16x16x32_bf16 v[212:215], v[196:199], a[180:183], v[212:215]
v_cvt_pk_bf16_f32 v73, v218, v219
v_pk_max_i16 v154, v154, 0
v_mfma_f32_16x16x32_bf16 v[212:215], v[200:203], a[176:179], v[212:215]
v_pk_max_i16 v155, v155, 0
v_pk_max_i16 v160, v160, 0
v_mfma_f32_16x16x32_bf16 v[192:195], a[64:67], v[232:235], 0
v_pk_max_i16 v161, v161, 0
v_pk_max_i16 v162, v162, 0
v_mfma_f32_16x16x32_bf16 v[192:195], a[68:71], v[204:207], v[192:195]
v_pk_max_i16 v163, v163, 0
v_mov_b64 v[156:157], v[152:153]
v_mfma_f32_16x16x32_bf16 v[192:195], a[72:75], v[188:191], v[192:195]
v_cvt_pk_bf16_f32 v76, v212, v213
v_cvt_pk_bf16_f32 v77, v214, v215
v_mfma_f32_16x16x32_bf16 v[192:195], a[76:79], v[208:211], v[192:195]
v_mov_b64 v[158:159], v[154:155]
v_mov_b32_dpp v152, v160 row_ror:8 row_mask:0xf bank_mask:0xc
v_mfma_f32_16x16x32_bf16 v[196:199], a[92:95], v[208:211], 0
v_mov_b32_dpp v153, v161 row_ror:8 row_mask:0xf bank_mask:0xc
v_mov_b32_dpp v154, v162 row_ror:8 row_mask:0xf bank_mask:0xc
v_mfma_f32_16x16x32_bf16 v[196:199], a[88:91], v[188:191], v[196:199]
v_mov_b32_dpp v155, v163 row_ror:8 row_mask:0xf bank_mask:0xc
v_mov_b32_dpp v160, v156 row_ror:8 row_mask:0xf bank_mask:0x3
v_mfma_f32_16x16x32_bf16 v[196:199], a[84:87], v[204:207], v[196:199]
v_cvt_pk_bf16_f32 v24, v192, v193
v_cvt_pk_bf16_f32 v25, v194, v195
v_mfma_f32_16x16x32_bf16 v[196:199], a[80:83], v[232:235], v[196:199]
v_mov_b32_dpp v161, v157 row_ror:8 row_mask:0xf bank_mask:0x3
v_mov_b32_dpp v162, v158 row_ror:8 row_mask:0xf bank_mask:0x3
v_mfma_f32_16x16x32_bf16 v[192:195], a[96:99], v[232:235], 0
v_mov_b32_dpp v163, v159 row_ror:8 row_mask:0xf bank_mask:0x3
v_add_u32 v245, 1728, v245
v_mfma_f32_16x16x32_bf16 v[192:195], a[100:103], v[204:207], v[192:195]
v_add_u32 v246, 1728, v246
v_mfma_f32_16x16x32_bf16 v[192:195], a[104:107], v[188:191], v[192:195]
v_cvt_pk_bf16_f32 v26, v196, v197
v_cvt_pk_bf16_f32 v27, v198, v199
v_mfma_f32_16x16x32_bf16 v[192:195], a[108:111], v[208:211], v[192:195]
ds_read_b128 v[196:199], v242 offset:21120
ds_read_b128 v[200:203], v242 offset:21376
v_mfma_f32_16x16x32_bf16 v[212:215], a[124:127], v[208:211], 0
ds_read_b128 v[216:219], v242 offset:21632
ds_read_b128 v[220:223], v242 offset:21888
v_mfma_f32_16x16x32_bf16 v[212:215], a[120:123], v[188:191], v[212:215]
s_nop 1
v_cvt_pk_bf16_f32 v28, v192, v193
v_mfma_f32_16x16x32_bf16 v[212:215], a[116:119], v[204:207], v[212:215]
v_cvt_pk_bf16_f32 v29, v194, v195
v_mfma_f32_16x16x32_bf16 v[212:215], a[112:115], v[232:235], v[212:215]
s_nop 2
v_mfma_f32_16x16x32_bf16 v[192:195], v[232:235], a[128:131], 0
s_nop 2
v_mfma_f32_16x16x32_bf16 v[192:195], v[204:207], a[132:135], v[192:195]
v_cvt_pk_bf16_f32 v30, v212, v213
v_cvt_pk_bf16_f32 v31, v214, v215
v_mfma_f32_16x16x32_bf16 v[192:195], v[188:191], a[136:139], v[192:195]
s_waitcnt lgkmcnt(0)
v_mfma_f32_16x16x32_bf16 v[192:195], v[208:211], a[140:143], v[192:195]
ds_read_b128 v[212:215], v247 offset:0
v_add_u32 v247, 1728, v247
v_mfma_f32_16x16x32_bf16 v[224:227], v[208:211], a[156:159], 0
s_nop 2
v_mfma_f32_16x16x32_bf16 v[224:227], v[188:191], a[152:155], v[224:227]
s_nop 0
v_cvt_pk_bf16_f32 v66, v192, v193
v_cvt_pk_bf16_f32 v67, v194, v195
v_mfma_f32_16x16x32_bf16 v[224:227], v[204:207], a[148:151], v[224:227]
v_mfma_f32_16x16x32_bf16 v[224:227], v[232:235], a[144:147], v[224:227]
buffer_load_dwordx4 v243, s[16:19], s98 offen offset:0 nt lds
v_mfma_f32_16x16x32_bf16 v[192:195], v[232:235], a[160:163], 0
s_add_u32 s98, s98, s48
s_nop 1
v_mfma_f32_16x16x32_bf16 v[192:195], v[204:207], a[164:167], v[192:195]
s_nop 1
v_cvt_pk_bf16_f32 v70, v224, v225
v_mfma_f32_16x16x32_bf16 v[192:195], v[188:191], a[168:171], v[192:195]
v_cvt_pk_bf16_f32 v71, v226, v227
v_mfma_f32_16x16x32_bf16 v[192:195], v[208:211], a[172:175], v[192:195]
s_nop 2
v_mfma_f32_16x16x32_bf16 v[224:227], v[208:211], a[188:191], 0
s_nop 2
v_mfma_f32_16x16x32_bf16 v[224:227], v[188:191], a[184:187], v[224:227]
v_cvt_pk_bf16_f32 v74, v192, v193
v_cvt_pk_bf16_f32 v75, v194, v195
v_mfma_f32_16x16x32_bf16 v[224:227], v[204:207], a[180:183], v[224:227]
v_mfma_f32_16x16x32_bf16 v[224:227], v[232:235], a[176:179], v[224:227]
s_nop 2
v_mfma_f32_16x16x32_bf16 v[188:191], a[64:67], v[196:199], 0
s_waitcnt lgkmcnt(0)
s_nop 1
v_mfma_f32_16x16x32_bf16 v[188:191], a[68:71], v[200:203], v[188:191]
v_cvt_pk_bf16_f32 v78, v224, v225
v_cvt_pk_bf16_f32 v79, v226, v227
v_mfma_f32_16x16x32_bf16 v[188:191], a[72:75], v[216:219], v[188:191]
v_mfma_f32_16x16x32_bf16 v[188:191], a[76:79], v[220:223], v[188:191]
s_nop 2
v_mfma_f32_16x16x32_bf16 v[192:195], a[92:95], v[220:223], 0
s_nop 2
v_mfma_f32_16x16x32_bf16 v[192:195], a[88:91], v[216:219], v[192:195]
v_cvt_pk_bf16_f32 v40, v188, v189
v_cvt_pk_bf16_f32 v41, v190, v191
v_mfma_f32_16x16x32_bf16 v[192:195], a[84:87], v[200:203], v[192:195]
v_mfma_f32_16x16x32_bf16 v[192:195], a[80:83], v[196:199], v[192:195]
buffer_load_dwordx4 v243, s[16:19], s99 offen offset:1056 nt lds
v_mfma_f32_16x16x32_bf16 v[188:191], a[96:99], v[196:199], 0
s_add_u32 s99, s98, s51
s_nop 1
v_mfma_f32_16x16x32_bf16 v[188:191], a[100:103], v[200:203], v[188:191]
s_nop 1
v_cvt_pk_bf16_f32 v42, v192, v193
v_mfma_f32_16x16x32_bf16 v[188:191], a[104:107], v[216:219], v[188:191]
v_cvt_pk_bf16_f32 v43, v194, v195
v_mfma_f32_16x16x32_bf16 v[188:191], a[108:111], v[220:223], v[188:191]
s_nop 2
v_mfma_f32_16x16x32_bf16 v[192:195], a[124:127], v[220:223], 0
s_nop 2
v_mfma_f32_16x16x32_bf16 v[192:195], a[120:123], v[216:219], v[192:195]
v_cvt_pk_bf16_f32 v44, v188, v189
v_cvt_pk_bf16_f32 v45, v190, v191
v_mfma_f32_16x16x32_bf16 v[192:195], a[116:119], v[200:203], v[192:195]
v_mfma_f32_16x16x32_bf16 v[192:195], a[112:115], v[196:199], v[192:195]
v_mov_b64 v[168:169], 0
v_mov_b64 v[170:171], 0
v_mfma_f32_16x16x32_bf16 v[188:191], a[0:3], v[196:199], 0
v_mov_b64 v[172:173], 0
v_mov_b64 v[174:175], 0
v_mfma_f32_16x16x32_bf16 v[188:191], a[4:7], v[200:203], v[188:191]
v_mov_b64 v[176:177], 0
v_mov_b64 v[178:179], 0
v_mfma_f32_16x16x32_bf16 v[188:191], a[8:11], v[216:219], v[188:191]
v_cvt_pk_bf16_f32 v46, v192, v193
v_cvt_pk_bf16_f32 v47, v194, v195
v_mfma_f32_16x16x32_bf16 v[188:191], a[12:15], v[220:223], v[188:191]
s_nop 2
v_smfmac_f32_16x16x64_bf16 v[168:171], v[212:215], v[0:7], v251
s_nop 2
v_smfmac_f32_16x16x64_bf16 v[172:175], v[212:215], v[16:23], v251
v_cvt_pk_bf16_f32 v96, v188, v189
v_smfmac_f32_16x16x64_bf16 v[176:179], v[212:215], v[32:39], v251
v_cvt_pk_bf16_f32 v97, v190, v191
v_mfma_f32_16x16x32_bf16 v[188:191], a[28:31], v[220:223], 0
v_add_f32 v168, v168, v169
v_mfma_f32_16x16x32_bf16 v[188:191], a[24:27], v[216:219], v[188:191]
v_exp_f32 v168, v168
v_mfma_f32_16x16x32_bf16 v[188:191], a[20:23], v[200:203], v[188:191]
v_mfma_f32_16x16x32_bf16 v[188:191], a[16:19], v[196:199], v[188:191]
s_nop 2
v_mfma_f32_16x16x32_bf16 v[192:195], a[32:35], v[196:199], 0
s_nop 2
v_mfma_f32_16x16x32_bf16 v[192:195], a[36:39], v[200:203], v[192:195]
v_cvt_pk_bf16_f32 v98, v188, v189
v_cvt_pk_bf16_f32 v99, v190, v191
v_mfma_f32_16x16x32_bf16 v[192:195], a[40:43], v[216:219], v[192:195]
v_mfma_f32_16x16x32_bf16 v[192:195], a[44:47], v[220:223], v[192:195]
buffer_load_dwordx4 v243, s[16:19], s100 offen offset:2112 nt lds
v_mfma_f32_16x16x32_bf16 v[188:191], a[60:63], v[220:223], 0
s_add_u32 s100, s99, s51
s_nop 1
v_mfma_f32_16x16x32_bf16 v[188:191], a[56:59], v[216:219], v[188:191]
s_nop 1
v_cvt_pk_bf16_f32 v100, v192, v193
v_mfma_f32_16x16x32_bf16 v[188:191], a[52:55], v[200:203], v[188:191]
v_cvt_pk_bf16_f32 v101, v194, v195
v_mfma_f32_16x16x32_bf16 v[188:191], a[48:51], v[196:199], v[188:191]
s_nop 2
v_mfma_f32_16x16x32_bf16 v[136:139], a[192:195], v[196:199], 0
s_nop 2
v_mfma_f32_16x16x32_bf16 v[136:139], a[196:199], v[200:203], v[136:139]
v_cvt_pk_bf16_f32 v102, v188, v189
v_cvt_pk_bf16_f32 v103, v190, v191
v_mfma_f32_16x16x32_bf16 v[136:139], a[200:203], v[216:219], v[136:139]
v_mfma_f32_16x16x32_bf16 v[136:139], a[204:207], v[220:223], v[136:139]
v_smfmac_f32_16x16x64_bf16 v[170:173], v[212:215], v[8:15], v251
s_nop 2
v_smfmac_f32_16x16x64_bf16 v[174:177], v[212:215], v[24:31], v251
s_nop 2
v_smfmac_f32_16x16x64_bf16 v[178:181], v[212:215], v[40:47], v251
v_add_f32 v170, v170, v171
v_mfma_f32_16x16x32_bf16 v[140:143], a[220:223], v[220:223], 0
v_exp_f32 v170, v170
v_mfma_f32_16x16x32_bf16 v[140:143], a[216:219], v[216:219], v[140:143]
v_add_f32 v172, v172, v173
v_add_f32 v174, v174, v175
v_mfma_f32_16x16x32_bf16 v[140:143], a[212:215], v[200:203], v[140:143]
v_exp_f32 v172, v172
v_mfma_f32_16x16x32_bf16 v[140:143], a[208:211], v[196:199], v[140:143]
v_exp_f32 v174, v174
v_mfma_f32_16x16x32_bf16 v[144:147], a[224:227], v[196:199], 0
v_add_f32 v176, v176, v177
v_add_f32 v178, v178, v179
v_mfma_f32_16x16x32_bf16 v[144:147], a[228:231], v[200:203], v[144:147]
v_exp_f32 v176, v176
v_mfma_f32_16x16x32_bf16 v[144:147], a[232:235], v[216:219], v[144:147]
v_add_f32 v180, v168, v170
v_cvt_pk_bf16_f32 v169, v168, v170
v_mfma_f32_16x16x32_bf16 v[144:147], a[236:239], v[220:223], v[144:147]
ds_write_b16 v248, v169 offset:0
v_mfma_f32_16x16x32_bf16 v[148:151], a[252:255], v[220:223], 0
ds_write_b16_d16_hi v248, v169 offset:4
v_mfma_f32_16x16x32_bf16 v[148:151], a[248:251], v[216:219], v[148:151]
v_mov_b64 v[188:189], s[96:97]
v_mov_b64 v[190:191], s[96:97]
v_mfma_f32_16x16x32_bf16 v[148:151], a[244:247], v[200:203], v[148:151]
v_exp_f32 v178, v178
v_mfma_f32_16x16x32_bf16 v[148:151], a[240:243], v[196:199], v[148:151]
v_add_f32 v180, v180, v172
v_add_f32 v180, v180, v174
v_smfmac_f32_16x16x64_bf16 v[188:191], v[238:241], v[96:103], v251
v_add_f32 v180, v180, v176
v_mfma_f32_16x16x32_bf16 v[192:195], v[196:199], a[128:131], 0
v_add_f32 v180, v180, v178
v_cvt_pk_bf16_f32 v173, v172, v174
v_mfma_f32_16x16x32_bf16 v[192:195], v[200:203], a[132:135], v[192:195]
ds_write_b16 v248, v173 offset:272
v_mfma_f32_16x16x32_bf16 v[192:195], v[216:219], a[136:139], v[192:195]
ds_write_b16_d16_hi v248, v173 offset:276
v_mfma_f32_16x16x32_bf16 v[192:195], v[220:223], a[140:143], v[192:195]
buffer_load_dwordx4 v243, s[16:19], s101 offen offset:3168 nt lds
v_mfma_f32_16x16x32_bf16 v[204:207], v[220:223], a[156:159], 0
s_add_u32 m0, s49, 16896
v_add_f32 v188, v188, v189
v_add_f32 v190, v190, v191
v_mfma_f32_16x16x32_bf16 v[204:207], v[216:219], a[152:155], v[204:207]
s_add_u32 s101, s100, s51
v_exp_f32 v188, v188
v_mfma_f32_16x16x32_bf16 v[204:207], v[200:203], a[148:151], v[204:207]
s_and_b32 s51, s57, 13106176
v_exp_f32 v190, v190
v_mfma_f32_16x16x32_bf16 v[204:207], v[196:199], a[144:147], v[204:207]
s_sub_u32 s49, s49, s56
v_perm_b32 v116, v190, v188, v252
v_perm_b32 v117, v190, v188, v253
v_mfma_f32_16x16x32_bf16 v[208:211], v[196:199], a[160:163], 0
s_lshl3_add_u32 s48, s51, 8192
v_add_f32_dpp v180, v180, v180 row_ror:8 row_mask:0xf bank_mask:0xf
v_cvt_pk_bf16_f32 v177, v176, v178
v_mfma_f32_16x16x32_bf16 v[208:211], v[200:203], a[164:167], v[208:211]
s_sub_u32 s51, s51, 32
ds_write_b16 v248, v177 offset:544
v_mfma_f32_16x16x32_bf16 v[208:211], v[216:219], a[168:171], v[208:211]
ds_write_b16_d16_hi v248, v177 offset:548
v_mfma_f32_16x16x32_bf16 v[208:211], v[220:223], a[172:175], v[208:211]
v_add_f32_dpp v180, v180, v180 row_ror:4 row_mask:0xf bank_mask:0xf
v_cvt_pk_bf16_f32 v82, v192, v193
v_mfma_f32_16x16x32_bf16 v[212:215], v[220:223], a[188:191], 0
ds_write_b32 v250, v180 offset:256
v_mfma_f32_16x16x32_bf16 v[212:215], v[216:219], a[184:187], v[212:215]
v_cvt_pk_bf16_f32 v83, v194, v195
v_cvt_pk_bf16_f32 v86, v204, v205
v_mfma_f32_16x16x32_bf16 v[212:215], v[200:203], a[180:183], v[212:215]
v_cvt_pk_bf16_f32 v87, v206, v207
v_cvt_pk_bf16_f32 v90, v208, v209
v_mfma_f32_16x16x32_bf16 v[212:215], v[196:199], a[176:179], v[212:215]
v_cvt_pk_bf16_f32 v91, v210, v211
s_nop 0
v_mfma_f32_32x32x16_bf16 v[168:183], v[236:239], v[116:119], 0
buffer_store_dwordx4 v[152:155], v244, s[20:23], s53 offen offset:0 nt
buffer_store_dwordx4 v[160:163], v244, s[20:23], s53 offen offset:2048 nt
s_add_u32 s53, s46, 0
s_nop 1
v_cvt_pk_bf16_f32 v94, v212, v213
v_mfma_f32_16x16x32_bf16 v[188:191], v[36:39], v[100:103], 0
v_cvt_pk_bf16_f32 v95, v214, v215
v_mfma_f32_16x16x32_bf16 v[188:191], v[32:35], v[96:99], v[188:191]
s_nop 2
v_mfma_f32_16x16x32_bf16 v[192:195], v[40:43], v[96:99], 0
s_nop 2
v_mfma_f32_16x16x32_bf16 v[192:195], v[44:47], v[100:103], v[192:195]
ds_read_b128 v[196:199], v242 offset:768
ds_read_b128 v[200:203], v242 offset:512
v_mfma_f32_16x16x32_bf16 v[204:207], v[4:7], v[100:103], 0
ds_read_b128 v[208:211], v242 offset:256
ds_read_b128 v[212:215], v242 offset:0
v_mfma_f32_16x16x32_bf16 v[204:207], v[0:3], v[96:99], v[204:207]
v_exp_f32 v188, v188
v_mfma_f32_16x16x32_bf16 v[216:219], v[16:19], v[96:99], 0
v_exp_f32 v189, v189
v_mfma_f32_16x16x32_bf16 v[216:219], v[20:23], v[100:103], v[216:219]
v_exp_f32 v190, v190
v_mfma_f32_16x16x32_bf16 v[220:223], v[28:31], v[100:103], 0
v_exp_f32 v191, v191
v_mfma_f32_16x16x32_bf16 v[220:223], v[24:27], v[96:99], v[220:223]
v_cvt_pk_bf16_f32 v112, v188, v189
v_cvt_pk_bf16_f32 v113, v190, v191
v_mfma_f32_16x16x32_bf16 v[224:227], v[8:11], v[96:99], 0
s_waitcnt lgkmcnt(3)
v_exp_f32 v204, v204
v_mfma_f32_16x16x32_bf16 v[224:227], v[12:15], v[100:103], v[224:227]
s_waitcnt lgkmcnt(2)
v_exp_f32 v205, v205
v_mfma_f32_16x16x32_bf16 v[228:231], v[196:199], a[188:191], 0
s_waitcnt lgkmcnt(1)
v_exp_f32 v206, v206
v_mfma_f32_16x16x32_bf16 v[228:231], v[200:203], a[184:187], v[228:231]
s_waitcnt lgkmcnt(0)
v_exp_f32 v207, v207
v_mfma_f32_16x16x32_bf16 v[228:231], v[208:211], a[180:183], v[228:231]
v_cvt_pk_bf16_f32 v104, v204, v205
v_cvt_pk_bf16_f32 v105, v206, v207
v_mfma_f32_16x16x32_bf16 v[228:231], v[212:215], a[176:179], v[228:231]
v_exp_f32 v216, v216
v_mfma_f32_16x16x32_bf16 v[188:191], v[212:215], a[160:163], 0
v_exp_f32 v217, v217
v_mfma_f32_16x16x32_bf16 v[188:191], v[208:211], a[164:167], v[188:191]
v_exp_f32 v218, v218
v_mfma_f32_16x16x32_bf16 v[188:191], v[200:203], a[168:171], v[188:191]
v_exp_f32 v219, v219
v_mfma_f32_16x16x32_bf16 v[188:191], v[196:199], a[172:175], v[188:191]
v_cvt_pk_bf16_f32 v108, v216, v217
v_cvt_pk_bf16_f32 v109, v218, v219
v_mfma_f32_16x16x32_bf16 v[204:207], v[196:199], a[156:159], 0
v_cvt_pk_bf16_f32 v60, v228, v229
v_cvt_pk_bf16_f32 v61, v230, v231
v_mfma_f32_16x16x32_bf16 v[204:207], v[200:203], a[152:155], v[204:207]
v_exp_f32 v220, v220
v_mfma_f32_16x16x32_bf16 v[204:207], v[208:211], a[148:151], v[204:207]
v_cvt_pk_bf16_f32 v56, v188, v189
v_cvt_pk_bf16_f32 v57, v190, v191
v_mfma_f32_16x16x32_bf16 v[204:207], v[212:215], a[144:147], v[204:207]
v_exp_f32 v221, v221
v_mfma_f32_16x16x32_bf16 v[188:191], v[212:215], a[128:131], 0
v_exp_f32 v222, v222
v_mfma_f32_16x16x32_bf16 v[188:191], v[208:211], a[132:135], v[188:191]
v_exp_f32 v223, v223
v_mfma_f32_16x16x32_bf16 v[188:191], v[200:203], a[136:139], v[188:191]
v_cvt_pk_bf16_f32 v110, v220, v221
v_cvt_pk_bf16_f32 v111, v222, v223
v_mfma_f32_16x16x32_bf16 v[188:191], v[196:199], a[140:143], v[188:191]
v_cvt_pk_bf16_f32 v52, v204, v205
v_cvt_pk_bf16_f32 v53, v206, v207
v_mfma_f32_16x16x32_bf16 v[204:207], a[0:3], v[212:215], 0
v_exp_f32 v224, v224
v_mfma_f32_16x16x32_bf16 v[204:207], a[4:7], v[208:211], v[204:207]
v_exp_f32 v225, v225
v_mfma_f32_16x16x32_bf16 v[204:207], a[8:11], v[200:203], v[204:207]
s_nop 0
v_cvt_pk_bf16_f32 v48, v188, v189
v_cvt_pk_bf16_f32 v49, v190, v191
v_mfma_f32_16x16x32_bf16 v[204:207], a[12:15], v[196:199], v[204:207]
buffer_load_dwordx4 v243, s[16:19], s98 offen offset:0 nt lds
v_mfma_f32_16x16x32_bf16 v[216:219], a[28:31], v[196:199], 0
ds_read_b128 v[220:223], v242 offset:4224
ds_read_b128 v[188:191], v242 offset:4480
v_mfma_f32_16x16x32_bf16 v[216:219], a[24:27], v[200:203], v[216:219]
v_exp_f32 v226, v226
v_mfma_f32_16x16x32_bf16 v[216:219], a[20:23], v[208:211], v[216:219]
s_nop 0
v_cvt_pk_bf16_f32 v96, v204, v205
v_cvt_pk_bf16_f32 v97, v206, v207
v_mfma_f32_16x16x32_bf16 v[216:219], a[16:19], v[212:215], v[216:219]
ds_read_b128 v[204:207], v242 offset:4992
v_cvt_pk_bf16_f32 v106, v224, v225
v_mfma_f32_16x16x32_bf16 v[232:235], a[32:35], v[212:215], 0
v_exp_f32 v227, v227
v_mfma_f32_16x16x32_bf16 v[232:235], a[36:39], v[208:211], v[232:235]
v_cvt_pk_bf16_f32 v107, v226, v227
s_nop 0
v_mfma_f32_16x16x32_bf16 v[232:235], a[40:43], v[200:203], v[232:235]
s_waitcnt lgkmcnt(2)
ds_read_b128 v[224:227], v242 offset:4736
v_cvt_pk_bf16_f32 v98, v216, v217
v_mfma_f32_16x16x32_bf16 v[232:235], a[44:47], v[196:199], v[232:235]
v_cvt_pk_bf16_f32 v99, v218, v219
s_nop 0
v_mfma_f32_16x16x32_bf16 v[228:231], a[60:63], v[196:199], 0
ds_read_b128 v[216:219], v242 offset:16896
s_nop 0
v_mfma_f32_16x16x32_bf16 v[228:231], a[56:59], v[200:203], v[228:231]
v_exp_f32 v192, v192
v_mfma_f32_16x16x32_bf16 v[228:231], a[52:55], v[208:211], v[228:231]
v_cvt_pk_bf16_f32 v100, v232, v233
v_cvt_pk_bf16_f32 v101, v234, v235
v_mfma_f32_16x16x32_bf16 v[228:231], a[48:51], v[212:215], v[228:231]
ds_read_b128 v[232:235], v242 offset:17152
s_nop 0
v_mfma_f32_16x16x32_bf16 v[152:155], a[192:195], v[212:215], 0
v_exp_f32 v193, v193
v_mfma_f32_16x16x32_bf16 v[152:155], a[196:199], v[208:211], v[152:155]
s_waitcnt lgkmcnt(4)
v_exp_f32 v194, v194
v_mfma_f32_16x16x32_bf16 v[152:155], a[200:203], v[200:203], v[152:155]
v_cvt_pk_bf16_f32 v102, v228, v229
v_cvt_pk_bf16_f32 v103, v230, v231
v_mfma_f32_16x16x32_bf16 v[152:155], a[204:207], v[196:199], v[152:155]
ds_read_b128 v[228:231], v242 offset:17664
v_cvt_pk_bf16_f32 v114, v192, v193
v_mfma_f32_16x16x32_bf16 v[156:159], a[220:223], v[196:199], 0
s_waitcnt lgkmcnt(4)
v_exp_f32 v195, v195
v_mfma_f32_16x16x32_bf16 v[156:159], a[216:219], v[200:203], v[156:159]
v_cvt_pk_bf16_f32 v115, v194, v195
v_mfma_f32_16x16x32_bf16 v[156:159], a[212:215], v[208:211], v[156:159]
ds_read_b128 v[192:195], v242 offset:17408
v_mfma_f32_16x16x32_bf16 v[156:159], a[208:211], v[212:215], v[156:159]
buffer_load_dwordx4 v243, s[16:19], s99 offen offset:1056 nt lds
v_mfma_f32_16x16x32_bf16 v[160:163], a[224:227], v[212:215], 0
s_waitcnt lgkmcnt(4)
v_mfma_f32_16x16x32_bf16 v[160:163], a[228:231], v[208:211], v[160:163]
s_waitcnt lgkmcnt(3)
v_mfma_f32_16x16x32_bf16 v[160:163], a[232:235], v[200:203], v[160:163]
v_mfma_f32_16x16x32_bf16 v[160:163], a[236:239], v[196:199], v[160:163]
v_mfma_f32_16x16x32_bf16 v[164:167], a[252:255], v[196:199], 0
s_waitcnt lgkmcnt(0)
v_mov_b64 v[196:197], s[96:97]
v_mov_b64 v[198:199], s[96:97]
v_mfma_f32_16x16x32_bf16 v[164:167], a[248:251], v[200:203], v[164:167]
v_mfma_f32_16x16x32_bf16 v[164:167], a[244:247], v[208:211], v[164:167]
v_mfma_f32_16x16x32_bf16 v[164:167], a[240:243], v[212:215], v[164:167]
v_smfmac_f32_16x16x64_bf16 v[196:199], v[238:241], v[96:103], v251
s_nop 2
v_mfma_f32_16x16x32_bf16 v[200:203], v[0:3], v[96:99], 0
s_nop 2
v_mfma_f32_16x16x32_bf16 v[200:203], v[4:7], v[100:103], v[200:203]
v_add_f32 v196, v196, v197
v_add_f32 v198, v198, v199
v_mfma_f32_16x16x32_bf16 v[208:211], v[12:15], v[100:103], 0
v_exp_f32 v196, v196
v_mfma_f32_16x16x32_bf16 v[208:211], v[8:11], v[96:99], v[208:211]
v_exp_f32 v198, v198
v_mfma_f32_16x16x32_bf16 v[212:215], v[220:223], a[128:131], 0
v_perm_b32 v132, v198, v196, v252
v_perm_b32 v133, v198, v196, v253
v_mfma_f32_16x16x32_bf16 v[212:215], v[188:191], a[132:135], v[212:215]
v_exp_f32 v200, v200
v_mfma_f32_16x16x32_bf16 v[212:215], v[224:227], a[136:139], v[212:215]
v_exp_f32 v201, v201
v_mfma_f32_16x16x32_bf16 v[212:215], v[204:207], a[140:143], v[212:215]
v_exp_f32 v202, v202
v_mfma_f32_16x16x32_bf16 v[196:199], v[204:207], a[156:159], 0
v_exp_f32 v203, v203
v_mfma_f32_16x16x32_bf16 v[196:199], v[224:227], a[152:155], v[196:199]
v_cvt_pk_bf16_f32 v120, v200, v201
v_cvt_pk_bf16_f32 v121, v202, v203
v_mfma_f32_16x16x32_bf16 v[196:199], v[188:191], a[148:151], v[196:199]
s_nop 0
v_cvt_pk_bf16_f32 v50, v212, v213
v_cvt_pk_bf16_f32 v51, v214, v215
v_mfma_f32_16x16x32_bf16 v[196:199], v[220:223], a[144:147], v[196:199]
v_exp_f32 v208, v208
v_mfma_f32_16x16x32_bf16 v[200:203], v[220:223], a[160:163], 0
v_exp_f32 v209, v209
v_mfma_f32_16x16x32_bf16 v[200:203], v[188:191], a[164:167], v[200:203]
v_exp_f32 v210, v210
v_mfma_f32_16x16x32_bf16 v[200:203], v[224:227], a[168:171], v[200:203]
v_exp_f32 v211, v211
v_mfma_f32_16x16x32_bf16 v[200:203], v[204:207], a[172:175], v[200:203]
buffer_load_dwordx4 v243, s[16:19], s100 offen offset:2112 nt lds
v_mfma_f32_16x16x32_bf16 v[212:215], v[204:207], a[188:191], 0
v_cvt_pk_bf16_f32 v54, v196, v197
v_cvt_pk_bf16_f32 v55, v198, v199
v_mfma_f32_16x16x32_bf16 v[212:215], v[224:227], a[184:187], v[212:215]
v_mov_b64 v[196:197], 0
v_cvt_pk_bf16_f32 v122, v208, v209
v_mfma_f32_16x16x32_bf16 v[212:215], v[188:191], a[180:183], v[212:215]
v_cvt_pk_bf16_f32 v58, v200, v201
v_cvt_pk_bf16_f32 v59, v202, v203
v_mfma_f32_16x16x32_bf16 v[212:215], v[220:223], a[176:179], v[212:215]
v_cvt_pk_bf16_f32 v123, v210, v211
s_nop 0
v_mfma_f32_16x16x32_bf16 v[188:191], v[24:27], v[96:99], 0
s_nop 2
v_mfma_f32_16x16x32_bf16 v[188:191], v[28:31], v[100:103], v[188:191]
s_nop 0
v_cvt_pk_bf16_f32 v62, v212, v213
v_cvt_pk_bf16_f32 v63, v214, v215
v_smfmac_f32_16x16x64_bf16 v[196:199], v[184:187], v[104:111], v251
s_nop 2
v_smfmac_f32_16x16x64_bf16 v[196:199], v[184:187], v[112:119], v251 abid:1
s_nop 2
v_mfma_f32_16x16x32_bf16 v[200:203], v[20:23], v[100:103], 0
v_exp_f32 v188, v188
v_mfma_f32_16x16x32_bf16 v[200:203], v[16:19], v[96:99], v[200:203]
v_exp_f32 v189, v189
v_mfma_f32_16x16x32_bf16 v[204:207], v[32:35], v[96:99], 0
v_exp_f32 v190, v190
v_mfma_f32_16x16x32_bf16 v[204:207], v[36:39], v[100:103], v[204:207]
v_exp_f32 v191, v191
v_mfma_f32_16x16x32_bf16 v[208:211], v[228:231], a[188:191], 0
v_cvt_pk_bf16_f32 v126, v188, v189
v_cvt_pk_bf16_f32 v127, v190, v191
v_mfma_f32_16x16x32_bf16 v[208:211], v[192:195], a[184:187], v[208:211]
v_add_f32 v196, v196, v197
s_nop 0
v_mfma_f32_16x16x32_bf16 v[208:211], v[232:235], a[180:183], v[208:211]
v_rcp_f32 v254, v196
v_mfma_f32_16x16x32_bf16 v[208:211], v[216:219], a[176:179], v[208:211]
v_max3_f32 v255, v255, v196, v254
s_nop 0
v_mfma_f32_16x16x32_bf16 v[212:215], v[216:219], a[160:163], 0
v_exp_f32 v200, v200
v_mfma_f32_16x16x32_bf16 v[212:215], v[232:235], a[164:167], v[212:215]
v_exp_f32 v201, v201
v_mfma_f32_16x16x32_bf16 v[212:215], v[192:195], a[168:171], v[212:215]
s_nop 0
v_cvt_pk_bf16_f32 v92, v208, v209
v_cvt_pk_bf16_f32 v93, v210, v211
v_mfma_f32_16x16x32_bf16 v[212:215], v[228:231], a[172:175], v[212:215]
buffer_load_dwordx4 v243, s[16:19], s101 offen offset:3168 nt lds
v_mfma_f32_16x16x32_bf16 v[188:191], v[228:231], a[156:159], 0
s_mov_b32 m0, s58
v_exp_f32 v202, v202
v_mfma_f32_16x16x32_bf16 v[188:191], v[192:195], a[152:155], v[188:191]
v_exp_f32 v203, v203
v_mfma_f32_16x16x32_bf16 v[188:191], v[232:235], a[148:151], v[188:191]
s_nop 0
v_cvt_pk_bf16_f32 v88, v212, v213
v_cvt_pk_bf16_f32 v89, v214, v215
v_mfma_f32_16x16x32_bf16 v[188:191], v[216:219], a[144:147], v[188:191]
v_exp_f32 v204, v204
v_mfma_f32_16x16x32_bf16 v[196:199], v[216:219], a[128:131], 0
v_exp_f32 v205, v205
v_mfma_f32_16x16x32_bf16 v[196:199], v[232:235], a[132:135], v[196:199]
v_exp_f32 v206, v206
v_mfma_f32_16x16x32_bf16 v[196:199], v[192:195], a[136:139], v[196:199]
v_exp_f32 v207, v207
v_mfma_f32_16x16x32_bf16 v[196:199], v[228:231], a[140:143], v[196:199]
v_cvt_pk_bf16_f32 v84, v188, v189
v_cvt_pk_bf16_f32 v85, v190, v191
v_mfma_f32_16x16x32_bf16 v[188:191], v[40:43], v[96:99], 0
ds_read_b128 v[208:211], v249 offset:272
v_cvt_pk_bf16_f32 v128, v204, v205
v_mfma_f32_16x16x32_bf16 v[188:191], v[44:47], v[100:103], v[188:191]
ds_read_b128 v[212:215], v249 offset:544
v_cvt_pk_bf16_f32 v129, v206, v207
v_mfma_f32_16x16x32_bf16 v[168:171], v[48:51], v[104:107], v[168:171]
v_cvt_pk_bf16_f32 v80, v196, v197
v_cvt_pk_bf16_f32 v81, v198, v199
v_mfma_f32_16x16x32_bf16 v[168:171], v[64:67], v[108:111], v[168:171]
v_cvt_pk_bf16_f32 v124, v200, v201
v_cvt_pk_bf16_f32 v125, v202, v203
L_entryf:
v_mfma_f32_16x16x32_bf16 v[168:171], v[80:83], v[112:115], v[168:171]
ds_read_b128 v[200:203], v249 offset:0
s_nop 0
v_mfma_f32_16x16x32_bf16 v[172:175], v[84:87], v[112:115], v[172:175]
L_h2:
s_cbranch_execz L_ret
v_exp_f32 v188, v188
v_mfma_f32_16x16x32_bf16 v[172:175], v[52:55], v[104:107], v[172:175]
v_exp_f32 v189, v189
v_mfma_f32_16x16x32_bf16 v[172:175], v[68:71], v[108:111], v[172:175]
v_exp_f32 v190, v190
v_mfma_f32_16x16x32_bf16 v[176:179], v[72:75], v[108:111], v[176:179]
v_exp_f32 v191, v191
v_mfma_f32_16x16x32_bf16 v[176:179], v[88:91], v[112:115], v[176:179]
v_cvt_pk_bf16_f32 v130, v188, v189
v_cvt_pk_bf16_f32 v131, v190, v191
v_mfma_f32_16x16x32_bf16 v[176:179], v[56:59], v[104:107], v[176:179]
v_fmac_f32 v136, v168, v254
v_fmac_f32 v137, v169, v254
v_mfma_f32_16x16x32_bf16 v[180:183], v[60:63], v[104:107], v[180:183]
v_fmac_f32 v138, v170, v254
v_fmac_f32 v139, v171, v254
v_mfma_f32_16x16x32_bf16 v[180:183], v[76:79], v[108:111], v[180:183]
v_cvt_pk_bf16_f32 v136, v136, v137
v_fmac_f32 v140, v172, v254
v_mfma_f32_16x16x32_bf16 v[180:183], v[92:95], v[112:115], v[180:183]
s_waitcnt lgkmcnt(2)
v_fmac_f32 v144, v176, v254
v_fmac_f32 v145, v177, v254
v_mfma_f32_16x16x32_bf16 v[188:191], a[0:3], v[216:219], 0
s_waitcnt lgkmcnt(1)
v_fmac_f32 v146, v178, v254
v_fmac_f32 v147, v179, v254
v_mfma_f32_16x16x32_bf16 v[188:191], a[4:7], v[232:235], v[188:191]
v_cvt_pk_bf16_f32 v144, v144, v145
v_fmac_f32 v141, v173, v254
v_mfma_f32_16x16x32_bf16 v[188:191], a[8:11], v[192:195], v[188:191]
v_fmac_f32 v142, v174, v254
v_fmac_f32 v143, v175, v254
v_mfma_f32_16x16x32_bf16 v[188:191], a[12:15], v[228:231], v[188:191]
s_waitcnt lgkmcnt(0)
v_cvt_pk_bf16_f32 v137, v138, v139
v_fmac_f32 v148, v180, v254
v_mfma_f32_16x16x32_bf16 v[196:199], a[28:31], v[228:231], 0
v_fmac_f32 v149, v181, v254
v_fmac_f32 v150, v182, v254
v_mfma_f32_16x16x32_bf16 v[196:199], a[24:27], v[192:195], v[196:199]
s_nop 0
v_cvt_pk_bf16_f32 v96, v188, v189
v_cvt_pk_bf16_f32 v97, v190, v191
v_mfma_f32_16x16x32_bf16 v[196:199], a[20:23], v[232:235], v[196:199]
v_fmac_f32 v151, v183, v254
v_cvt_pk_bf16_f32 v145, v146, v147
v_mfma_f32_16x16x32_bf16 v[196:199], a[16:19], v[216:219], v[196:199]
v_cvt_pk_bf16_f32 v138, v140, v141
v_cvt_pk_bf16_f32 v139, v142, v143
v_mfma_f32_16x16x32_bf16 v[188:191], a[32:35], v[216:219], 0
v_cvt_pk_bf16_f32 v146, v148, v149
v_cvt_pk_bf16_f32 v147, v150, v151
v_mfma_f32_16x16x32_bf16 v[188:191], a[36:39], v[232:235], v[188:191]
v_pk_max_i16 v136, v136, 0
v_pk_max_i16 v137, v137, 0
v_mfma_f32_16x16x32_bf16 v[188:191], a[40:43], v[192:195], v[188:191]
v_cvt_pk_bf16_f32 v98, v196, v197
v_cvt_pk_bf16_f32 v99, v198, v199
v_mfma_f32_16x16x32_bf16 v[188:191], a[44:47], v[228:231], v[188:191]
v_mov_b64 v[196:197], 0
v_mov_b64 v[198:199], 0
v_mfma_f32_16x16x32_bf16 v[204:207], a[60:63], v[228:231], 0
v_pk_max_i16 v138, v138, 0
v_pk_max_i16 v139, v139, 0
v_mfma_f32_16x16x32_bf16 v[204:207], a[56:59], v[192:195], v[204:207]
v_pk_max_i16 v144, v144, 0
v_pk_max_i16 v145, v145, 0
v_mfma_f32_16x16x32_bf16 v[204:207], a[52:55], v[232:235], v[204:207]
v_mov_b64 v[220:221], 0
v_mov_b64 v[222:223], 0
v_mfma_f32_16x16x32_bf16 v[204:207], a[48:51], v[216:219], v[204:207]
v_cvt_pk_bf16_f32 v100, v188, v189
v_cvt_pk_bf16_f32 v101, v190, v191
v_smfmac_f32_16x16x64_bf16 v[196:199], v[200:203], v[48:55], v251
v_pk_max_i16 v146, v146, 0
v_smfmac_f32_16x16x64_bf16 v[196:199], v[208:211], v[64:71], v251
v_pk_max_i16 v147, v147, 0
v_smfmac_f32_16x16x64_bf16 v[196:199], v[212:215], v[80:87], v251
s_nop 0
v_cvt_pk_bf16_f32 v102, v204, v205
v_smfmac_f32_16x16x64_bf16 v[220:223], v[212:215], v[88:95], v251
v_cvt_pk_bf16_f32 v103, v206, v207
v_smfmac_f32_16x16x64_bf16 v[220:223], v[208:211], v[72:79], v251
v_mov_b64 v[140:141], v[136:137]
v_smfmac_f32_16x16x64_bf16 v[220:223], v[200:203], v[56:63], v251
v_mov_b64 v[142:143], v[138:139]
v_mfma_f32_16x16x32_bf16 v[188:191], v[12:15], v[100:103], 0
v_mov_b32_dpp v136, v144 row_ror:8 row_mask:0xf bank_mask:0xc
v_mov_b32_dpp v137, v145 row_ror:8 row_mask:0xf bank_mask:0xc
v_mfma_f32_16x16x32_bf16 v[188:191], v[8:11], v[96:99], v[188:191]
v_mov_b64 v[200:201], s[96:97]
v_mov_b64 v[202:203], s[96:97]
v_mfma_f32_16x16x32_bf16 v[204:207], v[24:27], v[96:99], 0
v_mov_b32_dpp v138, v146 row_ror:8 row_mask:0xf bank_mask:0xc
v_mov_b32_dpp v139, v147 row_ror:8 row_mask:0xf bank_mask:0xc
v_mfma_f32_16x16x32_bf16 v[204:207], v[28:31], v[100:103], v[204:207]
v_mov_b32_dpp v144, v140 row_ror:8 row_mask:0xf bank_mask:0x3
v_mov_b32_dpp v145, v141 row_ror:8 row_mask:0xf bank_mask:0x3
v_mfma_f32_16x16x32_bf16 v[208:211], v[4:7], v[100:103], 0
v_mov_b32_dpp v146, v142 row_ror:8 row_mask:0xf bank_mask:0x3
v_mov_b32_dpp v147, v143 row_ror:8 row_mask:0xf bank_mask:0x3
v_mfma_f32_16x16x32_bf16 v[208:211], v[0:3], v[96:99], v[208:211]
v_exp_f32 v188, v188
v_smfmac_f32_16x16x64_bf16 v[200:203], v[238:241], v[96:103], v251
v_add_f32 v196, v196, v197
v_mfma_f32_16x16x32_bf16 v[212:215], v[16:19], v[96:99], 0
ds_write_b32 v250, v196 offset:0
v_mfma_f32_16x16x32_bf16 v[212:215], v[20:23], v[100:103], v[212:215]
v_exp_f32 v189, v189
v_mfma_f32_32x32x16_bf16 v[168:183], v[236:239], v[132:135], 0
buffer_store_dwordx4 v[136:139], v244, s[20:23], s52 offen offset:0 nt
buffer_store_dwordx4 v[144:147], v244, s[20:23], s52 offen offset:2048 nt
v_exp_f32 v190, v190
v_exp_f32 v191, v191
v_mfma_f32_16x16x32_bf16 v[136:139], a[192:195], v[216:219], 0
s_add_u32 s52, s46, 16384
v_cvt_pk_bf16_f32 v106, v188, v189
v_cvt_pk_bf16_f32 v107, v190, v191
v_mfma_f32_16x16x32_bf16 v[136:139], a[196:199], v[232:235], v[136:139]
v_add_f32 v200, v200, v201
v_add_f32 v202, v202, v203
v_mfma_f32_16x16x32_bf16 v[136:139], a[200:203], v[192:195], v[136:139]
v_exp_f32 v200, v200
v_mfma_f32_16x16x32_bf16 v[136:139], a[204:207], v[228:231], v[136:139]
v_exp_f32 v202, v202
v_mfma_f32_16x16x32_bf16 v[140:143], a[220:223], v[228:231], 0
v_perm_b32 v116, v202, v200, v252
v_perm_b32 v117, v202, v200, v253
v_mfma_f32_16x16x32_bf16 v[140:143], a[216:219], v[192:195], v[140:143]
v_exp_f32 v204, v204
v_mfma_f32_16x16x32_bf16 v[140:143], a[212:215], v[232:235], v[140:143]
v_exp_f32 v205, v205
v_mfma_f32_16x16x32_bf16 v[140:143], a[208:211], v[216:219], v[140:143]
v_exp_f32 v206, v206
v_mfma_f32_16x16x32_bf16 v[144:147], a[224:227], v[216:219], 0
v_exp_f32 v207, v207
v_mfma_f32_16x16x32_bf16 v[144:147], a[228:231], v[232:235], v[144:147]
v_cvt_pk_bf16_f32 v110, v204, v205
v_cvt_pk_bf16_f32 v111, v206, v207
v_mfma_f32_16x16x32_bf16 v[144:147], a[232:235], v[192:195], v[144:147]
v_exp_f32 v208, v208
v_mfma_f32_16x16x32_bf16 v[144:147], a[236:239], v[228:231], v[144:147]
v_exp_f32 v209, v209
v_mfma_f32_16x16x32_bf16 v[188:191], v[40:43], v[96:99], 0
v_exp_f32 v210, v210
v_mfma_f32_16x16x32_bf16 v[188:191], v[44:47], v[100:103], v[188:191]
v_mov_b64 v[200:201], 0
v_cvt_pk_bf16_f32 v104, v208, v209
v_mfma_f32_16x16x32_bf16 v[148:151], a[252:255], v[228:231], 0
ds_read_b128 v[224:227], v242 offset:4224
ds_read_b128 v[228:231], v242 offset:4480
v_mfma_f32_16x16x32_bf16 v[148:151], a[248:251], v[192:195], v[148:151]
ds_read_b128 v[192:195], v242 offset:4736
v_add_f32 v198, v198, v199
v_mfma_f32_16x16x32_bf16 v[148:151], a[244:247], v[232:235], v[148:151]
ds_write_b32 v250, v198 offset:64
v_mfma_f32_16x16x32_bf16 v[148:151], a[240:243], v[216:219], v[148:151]
s_nop 0
ds_read_b128 v[196:199], v242 offset:4992
v_add_f32 v220, v220, v221
v_smfmac_f32_16x16x64_bf16 v[200:203], v[184:187], v[120:127], v251
ds_write_b32 v250, v220 offset:128
v_smfmac_f32_16x16x64_bf16 v[200:203], v[184:187], v[128:135], v251 abid:1
v_add_f32 v222, v222, v223
v_mfma_f32_16x16x32_bf16 v[168:171], v[80:83], v[128:131], v[168:171]
ds_write_b32 v250, v222 offset:192
v_mfma_f32_16x16x32_bf16 v[168:171], v[64:67], v[124:127], v[168:171]
s_waitcnt lgkmcnt(4)
v_exp_f32 v211, v211
v_mfma_f32_16x16x32_bf16 v[168:171], v[48:51], v[120:123], v[168:171]
v_cvt_pk_bf16_f32 v105, v210, v211
v_add_f32 v200, v200, v201
v_mfma_f32_16x16x32_bf16 v[172:175], v[52:55], v[120:123], v[172:175]
v_rcp_f32 v254, v200
v_mfma_f32_16x16x32_bf16 v[172:175], v[68:71], v[124:127], v[172:175]
v_max3_f32 v255, v255, v200, v254
v_add_u32 v250, 1728, v250
v_mfma_f32_16x16x32_bf16 v[172:175], v[84:87], v[128:131], v[172:175]
v_fmac_f32 v152, v168, v254
v_fmac_f32 v153, v169, v254
v_mfma_f32_16x16x32_bf16 v[176:179], v[88:91], v[128:131], v[176:179]
v_fmac_f32 v154, v170, v254
v_fmac_f32 v155, v171, v254
v_mfma_f32_16x16x32_bf16 v[176:179], v[72:75], v[124:127], v[176:179]
v_cvt_pk_bf16_f32 v152, v152, v153
v_cvt_pk_bf16_f32 v153, v154, v155
v_mfma_f32_16x16x32_bf16 v[176:179], v[56:59], v[120:123], v[176:179]
v_fmac_f32 v156, v172, v254
v_fmac_f32 v157, v173, v254
v_mfma_f32_16x16x32_bf16 v[180:183], v[60:63], v[120:123], v[180:183]
v_fmac_f32 v158, v174, v254
v_fmac_f32 v159, v175, v254
v_mfma_f32_16x16x32_bf16 v[180:183], v[76:79], v[124:127], v[180:183]
s_waitcnt lgkmcnt(2)
v_cvt_pk_bf16_f32 v154, v156, v157
v_fmac_f32 v160, v176, v254
v_mfma_f32_16x16x32_bf16 v[180:183], v[92:95], v[128:131], v[180:183]
v_fmac_f32 v161, v177, v254
v_fmac_f32 v162, v178, v254
v_mfma_f32_16x16x32_bf16 v[204:207], v[32:35], v[96:99], 0
v_fmac_f32 v163, v179, v254
v_cvt_pk_bf16_f32 v160, v160, v161
v_mfma_f32_16x16x32_bf16 v[204:207], v[36:39], v[100:103], v[204:207]
v_cvt_pk_bf16_f32 v161, v162, v163
v_cvt_pk_bf16_f32 v155, v158, v159
v_mfma_f32_16x16x32_bf16 v[208:211], a[0:3], v[224:227], 0
v_fmac_f32 v164, v180, v254
v_fmac_f32 v165, v181, v254
v_mfma_f32_16x16x32_bf16 v[208:211], a[4:7], v[228:231], v[208:211]
v_fmac_f32 v166, v182, v254
v_fmac_f32 v167, v183, v254
v_mfma_f32_16x16x32_bf16 v[208:211], a[8:11], v[192:195], v[208:211]
v_cvt_pk_bf16_f32 v162, v164, v165
v_cvt_pk_bf16_f32 v163, v166, v167
v_mfma_f32_16x16x32_bf16 v[208:211], a[12:15], v[196:199], v[208:211]
v_pk_max_i16 v152, v152, 0
v_pk_max_i16 v153, v153, 0
v_mfma_f32_16x16x32_bf16 v[216:219], a[28:31], v[196:199], 0
v_pk_max_i16 v154, v154, 0
v_pk_max_i16 v155, v155, 0
v_mfma_f32_16x16x32_bf16 v[216:219], a[24:27], v[192:195], v[216:219]
v_pk_max_i16 v160, v160, 0
v_pk_max_i16 v161, v161, 0
v_mfma_f32_16x16x32_bf16 v[216:219], a[20:23], v[228:231], v[216:219]
v_pk_max_i16 v162, v162, 0
v_pk_max_i16 v163, v163, 0
v_mfma_f32_16x16x32_bf16 v[216:219], a[16:19], v[224:227], v[216:219]
v_mov_b64 v[156:157], v[152:153]
v_mov_b64 v[158:159], v[154:155]
v_mfma_f32_16x16x32_bf16 v[200:203], a[32:35], v[224:227], 0
v_mov_b32_dpp v152, v160 row_ror:8 row_mask:0xf bank_mask:0xc
v_mov_b32_dpp v153, v161 row_ror:8 row_mask:0xf bank_mask:0xc
v_mfma_f32_16x16x32_bf16 v[200:203], a[36:39], v[228:231], v[200:203]
v_mov_b32_dpp v154, v162 row_ror:8 row_mask:0xf bank_mask:0xc
v_mov_b32_dpp v155, v163 row_ror:8 row_mask:0xf bank_mask:0xc
v_mfma_f32_16x16x32_bf16 v[200:203], a[40:43], v[192:195], v[200:203]
v_mov_b32_dpp v160, v156 row_ror:8 row_mask:0xf bank_mask:0x3
v_mov_b32_dpp v161, v157 row_ror:8 row_mask:0xf bank_mask:0x3
v_mfma_f32_16x16x32_bf16 v[200:203], a[44:47], v[196:199], v[200:203]
v_mov_b32_dpp v162, v158 row_ror:8 row_mask:0xf bank_mask:0x3
v_mov_b32_dpp v163, v159 row_ror:8 row_mask:0xf bank_mask:0x3
v_mfma_f32_32x32x16_bf16 v[168:183], v[236:239], v[116:119], 0
buffer_store_dwordx4 v[152:155], v244, s[20:23], s53 offen offset:0 nt
buffer_store_dwordx4 v[160:163], v244, s[20:23], s53 offen offset:2048 nt
v_cvt_pk_bf16_f32 v96, v208, v209
v_cvt_pk_bf16_f32 v97, v210, v211
v_exp_f32 v188, v188
v_mfma_f32_16x16x32_bf16 v[208:211], a[60:63], v[196:199], 0
s_add_u32 s53, s46, 4096
v_exp_f32 v189, v189
v_mfma_f32_16x16x32_bf16 v[208:211], a[56:59], v[192:195], v[208:211]
s_add_u32 s46, s46, 13107200
v_exp_f32 v190, v190
v_mfma_f32_16x16x32_bf16 v[208:211], a[52:55], v[228:231], v[208:211]
v_exp_f32 v191, v191
v_mfma_f32_16x16x32_bf16 v[208:211], a[48:51], v[224:227], v[208:211]
v_cvt_pk_bf16_f32 v114, v188, v189
v_cvt_pk_bf16_f32 v115, v190, v191
v_mfma_f32_16x16x32_bf16 v[152:155], a[192:195], v[224:227], 0
v_cvt_pk_bf16_f32 v98, v216, v217
v_cvt_pk_bf16_f32 v99, v218, v219
v_mfma_f32_16x16x32_bf16 v[152:155], a[196:199], v[228:231], v[152:155]
v_cvt_pk_bf16_f32 v100, v200, v201
v_cvt_pk_bf16_f32 v101, v202, v203
v_mfma_f32_16x16x32_bf16 v[152:155], a[200:203], v[192:195], v[152:155]
v_cvt_pk_bf16_f32 v102, v208, v209
v_cvt_pk_bf16_f32 v103, v210, v211
v_mfma_f32_16x16x32_bf16 v[152:155], a[204:207], v[196:199], v[152:155]
v_exp_f32 v212, v212
v_mfma_f32_16x16x32_bf16 v[156:159], a[220:223], v[196:199], 0
v_exp_f32 v213, v213
v_mfma_f32_16x16x32_bf16 v[156:159], a[216:219], v[192:195], v[156:159]
v_exp_f32 v214, v214
v_mfma_f32_16x16x32_bf16 v[156:159], a[212:215], v[228:231], v[156:159]
v_exp_f32 v215, v215
v_mfma_f32_16x16x32_bf16 v[156:159], a[208:211], v[224:227], v[156:159]
v_cvt_pk_bf16_f32 v108, v212, v213
v_cvt_pk_bf16_f32 v109, v214, v215
v_mfma_f32_16x16x32_bf16 v[160:163], a[224:227], v[224:227], 0
v_exp_f32 v204, v204
v_mfma_f32_16x16x32_bf16 v[160:163], a[228:231], v[228:231], v[160:163]
v_exp_f32 v205, v205
v_mfma_f32_16x16x32_bf16 v[160:163], a[232:235], v[192:195], v[160:163]
v_exp_f32 v206, v206
v_mfma_f32_16x16x32_bf16 v[160:163], a[236:239], v[196:199], v[160:163]
v_mov_b64 v[188:189], s[96:97]
v_mov_b64 v[190:191], s[96:97]
v_mfma_f32_16x16x32_bf16 v[164:167], a[252:255], v[196:199], 0
ds_read_b128 v[196:199], v242 offset:8448
v_cvt_pk_bf16_f32 v112, v204, v205
v_mfma_f32_16x16x32_bf16 v[164:167], a[248:251], v[192:195], v[164:167]
ds_read_b128 v[200:203], v242 offset:8704
ds_read_b128 v[192:195], v242 offset:8960
v_mfma_f32_16x16x32_bf16 v[164:167], a[244:247], v[228:231], v[164:167]
v_exp_f32 v207, v207
v_mfma_f32_16x16x32_bf16 v[164:167], a[240:243], v[224:227], v[164:167]
v_cvt_pk_bf16_f32 v113, v206, v207
v_smfmac_f32_16x16x64_bf16 v[188:191], v[238:241], v[96:103], v251
ds_read_b128 v[204:207], v242 offset:9216
v_mov_b64 v[208:209], 0
v_mfma_f32_16x16x32_bf16 v[212:215], v[16:19], v[96:99], 0
s_nop 2
v_mfma_f32_16x16x32_bf16 v[212:215], v[20:23], v[100:103], v[212:215]
s_nop 0
v_add_f32 v188, v188, v189
v_add_f32 v190, v190, v191
v_mfma_f32_16x16x32_bf16 v[216:219], v[12:15], v[100:103], 0
s_waitcnt lgkmcnt(1)
v_exp_f32 v188, v188
v_mfma_f32_16x16x32_bf16 v[216:219], v[8:11], v[96:99], v[216:219]
v_exp_f32 v190, v190
v_smfmac_f32_16x16x64_bf16 v[208:211], v[184:187], v[104:111], v251
v_perm_b32 v132, v190, v188, v252
v_smfmac_f32_16x16x64_bf16 v[208:211], v[184:187], v[112:119], v251 abid:1
v_perm_b32 v133, v190, v188, v253
v_mfma_f32_16x16x32_bf16 v[168:171], v[80:83], v[112:115], v[168:171]
v_exp_f32 v212, v212
v_mfma_f32_16x16x32_bf16 v[168:171], v[64:67], v[108:111], v[168:171]
v_exp_f32 v216, v216
v_mfma_f32_16x16x32_bf16 v[168:171], v[48:51], v[104:107], v[168:171]
v_exp_f32 v217, v217
v_mfma_f32_16x16x32_bf16 v[172:175], v[52:55], v[104:107], v[172:175]
v_add_f32 v208, v208, v209
v_cvt_pk_bf16_f32 v122, v216, v217
v_mfma_f32_16x16x32_bf16 v[172:175], v[68:71], v[108:111], v[172:175]
v_rcp_f32 v254, v208
v_mfma_f32_16x16x32_bf16 v[172:175], v[84:87], v[112:115], v[172:175]
v_max3_f32 v255, v255, v208, v254
v_fmac_f32 v136, v168, v254
v_mfma_f32_16x16x32_bf16 v[176:179], v[88:91], v[112:115], v[176:179]
s_waitcnt lgkmcnt(0)
v_exp_f32 v218, v218
v_mfma_f32_16x16x32_bf16 v[176:179], v[72:75], v[108:111], v[176:179]
v_exp_f32 v219, v219
v_mfma_f32_16x16x32_bf16 v[176:179], v[56:59], v[104:107], v[176:179]
v_cvt_pk_bf16_f32 v123, v218, v219
v_fmac_f32 v137, v169, v254
v_mfma_f32_16x16x32_bf16 v[180:183], v[60:63], v[104:107], v[180:183]
v_fmac_f32 v138, v170, v254
v_fmac_f32 v139, v171, v254
v_mfma_f32_16x16x32_bf16 v[180:183], v[76:79], v[108:111], v[180:183]
v_cvt_pk_bf16_f32 v136, v136, v137
v_cvt_pk_bf16_f32 v137, v138, v139
v_mfma_f32_16x16x32_bf16 v[180:183], v[92:95], v[112:115], v[180:183]
v_fmac_f32 v144, v176, v254
v_fmac_f32 v145, v177, v254
v_mfma_f32_16x16x32_bf16 v[188:191], v[44:47], v[100:103], 0
v_fmac_f32 v146, v178, v254
v_fmac_f32 v147, v179, v254
v_mfma_f32_16x16x32_bf16 v[188:191], v[40:43], v[96:99], v[188:191]
v_cvt_pk_bf16_f32 v144, v144, v145
v_fmac_f32 v140, v172, v254
v_mfma_f32_16x16x32_bf16 v[220:223], v[32:35], v[96:99], 0
v_fmac_f32 v141, v173, v254
v_fmac_f32 v142, v174, v254
v_mfma_f32_16x16x32_bf16 v[220:223], v[36:39], v[100:103], v[220:223]
v_fmac_f32 v143, v175, v254
v_cvt_pk_bf16_f32 v145, v146, v147
v_mfma_f32_16x16x32_bf16 v[224:227], v[4:7], v[100:103], 0
v_fmac_f32 v148, v180, v254
v_fmac_f32 v149, v181, v254
v_mfma_f32_16x16x32_bf16 v[224:227], v[0:3], v[96:99], v[224:227]
v_fmac_f32 v150, v182, v254
v_fmac_f32 v151, v183, v254
v_mfma_f32_16x16x32_bf16 v[228:231], v[24:27], v[96:99], 0
v_cvt_pk_bf16_f32 v138, v140, v141
v_cvt_pk_bf16_f32 v139, v142, v143
v_mfma_f32_16x16x32_bf16 v[228:231], v[28:31], v[100:103], v[228:231]
v_cvt_pk_bf16_f32 v146, v148, v149
v_cvt_pk_bf16_f32 v147, v150, v151
v_mfma_f32_16x16x32_bf16 v[208:211], a[0:3], v[196:199], 0
v_pk_max_i16 v136, v136, 0
v_pk_max_i16 v137, v137, 0
v_mfma_f32_16x16x32_bf16 v[208:211], a[4:7], v[200:203], v[208:211]
v_pk_max_i16 v138, v138, 0
v_pk_max_i16 v139, v139, 0
v_mfma_f32_16x16x32_bf16 v[208:211], a[8:11], v[192:195], v[208:211]
v_pk_max_i16 v144, v144, 0
v_pk_max_i16 v145, v145, 0
v_mfma_f32_16x16x32_bf16 v[208:211], a[12:15], v[204:207], v[208:211]
v_pk_max_i16 v146, v146, 0
v_pk_max_i16 v147, v147, 0
v_mfma_f32_16x16x32_bf16 v[232:235], a[28:31], v[204:207], 0
v_mov_b64 v[140:141], v[136:137]
v_mov_b64 v[142:143], v[138:139]
v_mfma_f32_16x16x32_bf16 v[232:235], a[24:27], v[192:195], v[232:235]
v_mov_b32_dpp v136, v144 row_ror:8 row_mask:0xf bank_mask:0xc
v_mov_b32_dpp v137, v145 row_ror:8 row_mask:0xf bank_mask:0xc
v_mfma_f32_16x16x32_bf16 v[232:235], a[20:23], v[200:203], v[232:235]
v_cvt_pk_bf16_f32 v96, v208, v209
v_cvt_pk_bf16_f32 v97, v210, v211
v_mfma_f32_16x16x32_bf16 v[232:235], a[16:19], v[196:199], v[232:235]
v_mov_b32_dpp v138, v146 row_ror:8 row_mask:0xf bank_mask:0xc
v_mov_b32_dpp v139, v147 row_ror:8 row_mask:0xf bank_mask:0xc
v_mfma_f32_16x16x32_bf16 v[208:211], a[32:35], v[196:199], 0
v_mov_b32_dpp v144, v140 row_ror:8 row_mask:0xf bank_mask:0x3
v_mov_b32_dpp v145, v141 row_ror:8 row_mask:0xf bank_mask:0x3
v_mfma_f32_16x16x32_bf16 v[208:211], a[36:39], v[200:203], v[208:211]
v_mov_b32_dpp v146, v142 row_ror:8 row_mask:0xf bank_mask:0x3
v_mov_b32_dpp v147, v143 row_ror:8 row_mask:0xf bank_mask:0x3
v_mfma_f32_16x16x32_bf16 v[208:211], a[40:43], v[192:195], v[208:211]
v_cvt_pk_bf16_f32 v98, v232, v233
v_cvt_pk_bf16_f32 v99, v234, v235
v_mfma_f32_16x16x32_bf16 v[208:211], a[44:47], v[204:207], v[208:211]
v_exp_f32 v224, v224
v_mfma_f32_16x16x32_bf16 v[216:219], a[60:63], v[204:207], 0
v_exp_f32 v225, v225
v_mfma_f32_16x16x32_bf16 v[216:219], a[56:59], v[192:195], v[216:219]
v_exp_f32 v226, v226
v_mfma_f32_16x16x32_bf16 v[216:219], a[52:55], v[200:203], v[216:219]
v_exp_f32 v227, v227
v_mfma_f32_16x16x32_bf16 v[216:219], a[48:51], v[196:199], v[216:219]
v_cvt_pk_bf16_f32 v100, v208, v209
v_cvt_pk_bf16_f32 v101, v210, v211
v_mfma_f32_32x32x16_bf16 v[168:183], v[236:239], v[132:135], 0
buffer_store_dwordx4 v[136:139], v244, s[20:23], s52 offen offset:0 nt
buffer_store_dwordx4 v[144:147], v244, s[20:23], s52 offen offset:2048 nt
v_cvt_pk_bf16_f32 v120, v224, v225
v_cvt_pk_bf16_f32 v121, v226, v227
v_exp_f32 v213, v213
v_mfma_f32_16x16x32_bf16 v[136:139], a[192:195], v[196:199], 0
v_cvt_pk_bf16_f32 v102, v216, v217
v_cvt_pk_bf16_f32 v103, v218, v219
v_mfma_f32_16x16x32_bf16 v[136:139], a[196:199], v[200:203], v[136:139]
v_exp_f32 v214, v214
v_mfma_f32_16x16x32_bf16 v[136:139], a[200:203], v[192:195], v[136:139]
v_exp_f32 v215, v215
v_mfma_f32_16x16x32_bf16 v[136:139], a[204:207], v[204:207], v[136:139]
v_exp_f32 v228, v228
v_mfma_f32_16x16x32_bf16 v[140:143], a[220:223], v[204:207], 0
v_exp_f32 v229, v229
v_mfma_f32_16x16x32_bf16 v[140:143], a[216:219], v[192:195], v[140:143]
v_exp_f32 v230, v230
v_mfma_f32_16x16x32_bf16 v[140:143], a[212:215], v[200:203], v[140:143]
v_exp_f32 v231, v231
v_mfma_f32_16x16x32_bf16 v[140:143], a[208:211], v[196:199], v[140:143]
v_cvt_pk_bf16_f32 v124, v212, v213
v_cvt_pk_bf16_f32 v125, v214, v215
v_mfma_f32_16x16x32_bf16 v[144:147], a[224:227], v[196:199], 0
v_cvt_pk_bf16_f32 v126, v228, v229
v_cvt_pk_bf16_f32 v127, v230, v231
v_mfma_f32_16x16x32_bf16 v[144:147], a[228:231], v[200:203], v[144:147]
v_exp_f32 v188, v188
v_mfma_f32_16x16x32_bf16 v[144:147], a[232:235], v[192:195], v[144:147]
v_exp_f32 v189, v189
v_mfma_f32_16x16x32_bf16 v[144:147], a[236:239], v[204:207], v[144:147]
v_mov_b64 v[208:209], s[96:97]
v_mov_b64 v[210:211], s[96:97]
v_mfma_f32_16x16x32_bf16 v[148:151], a[252:255], v[204:207], 0
v_exp_f32 v190, v190
v_mfma_f32_16x16x32_bf16 v[148:151], a[248:251], v[192:195], v[148:151]
v_exp_f32 v191, v191
v_mfma_f32_16x16x32_bf16 v[148:151], a[244:247], v[200:203], v[148:151]
v_exp_f32 v220, v220
v_mfma_f32_16x16x32_bf16 v[148:151], a[240:243], v[196:199], v[148:151]
v_exp_f32 v221, v221
v_smfmac_f32_16x16x64_bf16 v[208:211], v[238:241], v[96:103], v251
v_mov_b64 v[192:193], 0
v_mfma_f32_16x16x32_bf16 v[196:199], v[0:3], v[96:99], 0
v_exp_f32 v222, v222
v_mfma_f32_16x16x32_bf16 v[196:199], v[4:7], v[100:103], v[196:199]
v_exp_f32 v223, v223
v_mfma_f32_16x16x32_bf16 v[200:203], v[12:15], v[100:103], 0
v_cvt_pk_bf16_f32 v130, v188, v189
v_cvt_pk_bf16_f32 v131, v190, v191
v_mfma_f32_16x16x32_bf16 v[200:203], v[8:11], v[96:99], v[200:203]
ds_read_b128 v[204:207], v242 offset:12672
v_cvt_pk_bf16_f32 v128, v220, v221
v_smfmac_f32_16x16x64_bf16 v[192:195], v[184:187], v[120:127], v251
ds_read_b128 v[212:215], v242 offset:12928
v_cvt_pk_bf16_f32 v129, v222, v223
v_add_f32 v208, v208, v209
v_add_f32 v210, v210, v211
v_smfmac_f32_16x16x64_bf16 v[192:195], v[184:187], v[128:135], v251 abid:1
ds_read_b128 v[188:191], v242 offset:13184
ds_read_b128 v[216:219], v242 offset:13440
v_mfma_f32_16x16x32_bf16 v[168:171], v[80:83], v[128:131], v[168:171]
v_exp_f32 v208, v208
v_mfma_f32_16x16x32_bf16 v[168:171], v[48:51], v[120:123], v[168:171]
v_exp_f32 v210, v210
v_mfma_f32_16x16x32_bf16 v[168:171], v[64:67], v[124:127], v[168:171]
v_perm_b32 v116, v210, v208, v252
v_perm_b32 v117, v210, v208, v253
v_mfma_f32_16x16x32_bf16 v[172:175], v[68:71], v[124:127], v[172:175]
v_add_f32 v192, v192, v193
v_add_u32 v242, s56, v242
v_mfma_f32_16x16x32_bf16 v[172:175], v[84:87], v[128:131], v[172:175]
s_sub_u32 s56, 0, s56
v_rcp_f32 v254, v192
v_mfma_f32_16x16x32_bf16 v[172:175], v[52:55], v[120:123], v[172:175]
v_max3_f32 v255, v255, v192, v254
v_fmac_f32 v152, v168, v254
v_mfma_f32_16x16x32_bf16 v[176:179], v[56:59], v[120:123], v[176:179]
v_fmac_f32 v153, v169, v254
v_fmac_f32 v154, v170, v254
v_mfma_f32_16x16x32_bf16 v[176:179], v[72:75], v[124:127], v[176:179]
v_fmac_f32 v155, v171, v254
v_cvt_pk_bf16_f32 v152, v152, v153
v_mfma_f32_16x16x32_bf16 v[176:179], v[88:91], v[128:131], v[176:179]
v_mov_b32 v220, s45
v_fmac_f32 v156, v172, v254
v_mfma_f32_16x16x32_bf16 v[208:211], v[24:27], v[96:99], 0
s_waitcnt vmcnt(6)
ds_write_addtid_b32 v220 offset:65280
v_mfma_f32_16x16x32_bf16 v[208:211], v[28:31], v[100:103], v[208:211]
s_waitcnt lgkmcnt(4)
v_fmac_f32 v157, v173, v254
v_fmac_f32 v160, v176, v254
v_mfma_f32_16x16x32_bf16 v[224:227], v[20:23], v[100:103], 0
s_waitcnt lgkmcnt(3)
v_fmac_f32 v161, v177, v254
v_fmac_f32 v162, v178, v254
v_mfma_f32_16x16x32_bf16 v[224:227], v[16:19], v[96:99], v[224:227]
s_waitcnt lgkmcnt(1)
v_fmac_f32 v163, v179, v254
v_cvt_pk_bf16_f32 v160, v160, v161
v_mfma_f32_16x16x32_bf16 v[220:223], v[40:43], v[96:99], 0
v_fmac_f32 v158, v174, v254
v_fmac_f32 v159, v175, v254
v_mfma_f32_16x16x32_bf16 v[220:223], v[44:47], v[100:103], v[220:223]
v_cvt_pk_bf16_f32 v153, v154, v155
v_cvt_pk_bf16_f32 v161, v162, v163
v_mfma_f32_16x16x32_bf16 v[180:183], v[60:63], v[120:123], v[180:183]
v_cvt_pk_bf16_f32 v154, v156, v157
v_cvt_pk_bf16_f32 v155, v158, v159
v_mfma_f32_16x16x32_bf16 v[180:183], v[76:79], v[124:127], v[180:183]
v_pk_max_i16 v152, v152, 0
v_pk_max_i16 v153, v153, 0
v_mfma_f32_16x16x32_bf16 v[180:183], v[92:95], v[128:131], v[180:183]
v_pk_max_i16 v154, v154, 0
v_pk_max_i16 v155, v155, 0
v_mfma_f32_16x16x32_bf16 v[228:231], v[32:35], v[96:99], 0
v_pk_max_i16 v160, v160, 0
v_pk_max_i16 v161, v161, 0
v_mfma_f32_16x16x32_bf16 v[228:231], v[36:39], v[100:103], v[228:231]
v_mov_b64 v[156:157], v[152:153]
v_mov_b64 v[158:159], v[154:155]
v_mfma_f32_16x16x32_bf16 v[192:195], a[0:3], v[204:207], 0
v_fmac_f32 v164, v180, v254
v_fmac_f32 v165, v181, v254
v_mfma_f32_16x16x32_bf16 v[192:195], a[4:7], v[212:215], v[192:195]
v_fmac_f32 v166, v182, v254
v_fmac_f32 v167, v183, v254
v_mfma_f32_16x16x32_bf16 v[192:195], a[8:11], v[188:191], v[192:195]
v_cvt_pk_bf16_f32 v162, v164, v165
v_cvt_pk_bf16_f32 v163, v166, v167
v_mfma_f32_16x16x32_bf16 v[192:195], a[12:15], v[216:219], v[192:195]
v_pk_max_i16 v162, v162, 0
v_pk_max_i16 v163, v163, 0
v_mfma_f32_16x16x32_bf16 v[232:235], a[28:31], v[216:219], 0
v_mov_b32_dpp v152, v160 row_ror:8 row_mask:0xf bank_mask:0xc
v_mov_b32_dpp v153, v161 row_ror:8 row_mask:0xf bank_mask:0xc
v_mfma_f32_16x16x32_bf16 v[232:235], a[24:27], v[188:191], v[232:235]
v_mov_b32_dpp v154, v162 row_ror:8 row_mask:0xf bank_mask:0xc
v_mov_b32_dpp v155, v163 row_ror:8 row_mask:0xf bank_mask:0xc
v_mfma_f32_16x16x32_bf16 v[232:235], a[20:23], v[212:215], v[232:235]
v_cvt_pk_bf16_f32 v96, v192, v193
v_cvt_pk_bf16_f32 v97, v194, v195
v_mfma_f32_16x16x32_bf16 v[232:235], a[16:19], v[204:207], v[232:235]
v_mov_b32_dpp v160, v156 row_ror:8 row_mask:0xf bank_mask:0x3
v_mov_b32_dpp v161, v157 row_ror:8 row_mask:0xf bank_mask:0x3
v_mfma_f32_16x16x32_bf16 v[192:195], a[32:35], v[204:207], 0
v_mov_b32_dpp v162, v158 row_ror:8 row_mask:0xf bank_mask:0x3
v_mov_b32_dpp v163, v159 row_ror:8 row_mask:0xf bank_mask:0x3
v_mfma_f32_16x16x32_bf16 v[192:195], a[36:39], v[212:215], v[192:195]
v_exp_f32 v208, v208
v_mfma_f32_16x16x32_bf16 v[192:195], a[40:43], v[188:191], v[192:195]
v_cvt_pk_bf16_f32 v98, v232, v233
v_cvt_pk_bf16_f32 v99, v234, v235
v_mfma_f32_16x16x32_bf16 v[192:195], a[44:47], v[216:219], v[192:195]
v_exp_f32 v209, v209
v_mfma_f32_16x16x32_bf16 v[232:235], a[60:63], v[216:219], 0
v_exp_f32 v210, v210
v_mfma_f32_16x16x32_bf16 v[232:235], a[56:59], v[188:191], v[232:235]
v_exp_f32 v211, v211
v_mfma_f32_16x16x32_bf16 v[232:235], a[52:55], v[212:215], v[232:235]
v_cvt_pk_bf16_f32 v110, v208, v209
v_cvt_pk_bf16_f32 v111, v210, v211
v_mfma_f32_16x16x32_bf16 v[232:235], a[48:51], v[204:207], v[232:235]
v_cvt_pk_bf16_f32 v100, v192, v193
v_cvt_pk_bf16_f32 v101, v194, v195
v_mfma_f32_32x32x16_bf16 v[168:183], v[236:239], v[116:119], 0
s_cmp_lg_u32 s45, 0
buffer_store_dwordx4 v[152:155], v244, s[20:23], s53 offen offset:0 nt
buffer_store_dwordx4 v[160:163], v244, s[20:23], s53 offen offset:2048 nt
s_cbranch_scc1 L_loopf
v_mfma_f32_16x16x32_bf16 v[152:155], a[192:195], v[204:207], 0
s_mov_b32 m0, s59
v_cvt_pk_bf16_f32 v102, v232, v233
v_cvt_pk_bf16_f32 v103, v234, v235
v_mfma_f32_16x16x32_bf16 v[152:155], a[196:199], v[212:215], v[152:155]
s_mul_i32 s54, s41, 13824
ds_read_addtid_b32 v208 offset:65280
v_mov_b64 v[192:193], s[96:97]
v_mfma_f32_16x16x32_bf16 v[152:155], a[200:203], v[188:191], v[152:155]
s_lshl_b32 s55, s41, 9
v_mov_b64 v[194:195], s[96:97]
v_mbcnt_lo_u32_b32 v245, -1, 0
v_mfma_f32_16x16x32_bf16 v[152:155], a[204:207], v[216:219], v[152:155]
s_add_u32 s7, s54, 102400
v_exp_f32 v200, v200
v_mfma_f32_16x16x32_bf16 v[156:159], a[220:223], v[216:219], 0
L_h5:
s_cbranch_execz L_ret
s_add_u32 s9, s55, 160960
v_exp_f32 v201, v201
v_mfma_f32_16x16x32_bf16 v[156:159], a[216:219], v[188:191], v[156:159]
s_mov_b32 s6, 1728
v_exp_f32 v202, v202
v_mfma_f32_16x16x32_bf16 v[156:159], a[212:215], v[212:215], v[156:159]
s_mov_b32 s15, 272
v_exp_f32 v203, v203
v_mfma_f32_16x16x32_bf16 v[156:159], a[208:211], v[204:207], v[156:159]
s_waitcnt lgkmcnt(0)
v_cvt_pk_bf16_f32 v106, v200, v201
v_cvt_pk_bf16_f32 v107, v202, v203
v_mfma_f32_16x16x32_bf16 v[160:163], a[224:227], v[204:207], 0
s_add_u32 s8, s54, 103536
v_exp_f32 v224, v224
v_mfma_f32_16x16x32_bf16 v[160:163], a[228:231], v[212:215], v[160:163]
s_mov_b32 s57, 13106176
v_exp_f32 v225, v225
v_mfma_f32_16x16x32_bf16 v[160:163], a[232:235], v[188:191], v[160:163]
s_add_u32 s52, s47, 8192
v_exp_f32 v226, v226
v_mfma_f32_16x16x32_bf16 v[160:163], a[236:239], v[216:219], v[160:163]
s_add_u32 s98, s44, 24576
v_exp_f32 v227, v227
v_mfma_f32_16x16x32_bf16 v[164:167], a[252:255], v[216:219], 0
s_add_u32 s100, s44, 52453376
v_cvt_pk_bf16_f32 v108, v224, v225
v_cvt_pk_bf16_f32 v109, v226, v227
v_mfma_f32_16x16x32_bf16 v[164:167], a[248:251], v[188:191], v[164:167]
s_add_u32 s53, s47, 12288
v_exp_f32 v196, v196
v_mfma_f32_16x16x32_bf16 v[164:167], a[244:247], v[212:215], v[164:167]
s_add_u32 s99, s44, 26238976
v_exp_f32 v197, v197
v_mfma_f32_16x16x32_bf16 v[164:167], a[240:243], v[204:207], v[164:167]
s_add_u32 s101, s44, 78667776
v_exp_f32 v198, v198
v_smfmac_f32_16x16x64_bf16 v[192:195], v[238:241], v[96:103], v251
v_cvt_pk_bf16_f32 v104, v196, v197
v_mfma_f32_16x16x32_bf16 v[188:191], v[0:3], v[96:99], 0
v_exp_f32 v199, v199
v_mfma_f32_16x16x32_bf16 v[188:191], v[4:7], v[100:103], v[188:191]
v_cvt_pk_bf16_f32 v105, v198, v199
v_cmp_lt_u32 vcc, s45, v208
v_mfma_f32_16x16x32_bf16 v[200:203], v[12:15], v[100:103], 0
s_nop 0
v_add_f32 v192, v192, v193
v_add_f32 v194, v194, v195
v_mfma_f32_16x16x32_bf16 v[200:203], v[8:11], v[96:99], v[200:203]
v_exp_f32 v192, v192
v_mfma_f32_16x16x32_bf16 v[204:207], v[16:19], v[96:99], 0
s_cbranch_vccnz L_spine
L_backe:
v_exp_f32 v194, v194
v_mfma_f32_16x16x32_bf16 v[204:207], v[20:23], v[100:103], v[204:207]
s_mov_b32 vcc_lo, 0xf0000f
ds_read_b128 v[208:211], v242 offset:0
v_perm_b32 v132, v194, v192, v252
v_mfma_f32_16x16x32_bf16 v[212:215], v[28:31], v[100:103], 0
s_mov_b32 vcc_hi, 0xf0000f00
ds_read_b128 v[232:235], v242 offset:768
v_perm_b32 v133, v194, v192, v253
v_mfma_f32_16x16x32_bf16 v[212:215], v[24:27], v[96:99], v[212:215]
v_mov_b64 v[192:193], 0
v_mbcnt_hi_u32_b32 v245, -1, v245
v_mfma_f32_16x16x32_bf16 v[216:219], v[32:35], v[96:99], 0
v_exp_f32 v220, v220
v_mfma_f32_16x16x32_bf16 v[216:219], v[36:39], v[100:103], v[216:219]
v_exp_f32 v221, v221
v_mfma_f32_16x16x32_bf16 v[224:227], v[44:47], v[100:103], 0
v_exp_f32 v222, v222
v_mfma_f32_16x16x32_bf16 v[224:227], v[40:43], v[96:99], v[224:227]
v_exp_f32 v223, v223
v_smfmac_f32_16x16x64_bf16 v[192:195], v[184:187], v[104:111], v251
v_exp_f32 v228, v228
v_exp_f32 v229, v229
v_exp_f32 v230, v230
v_exp_f32 v231, v231
v_cvt_pk_bf16_f32 v114, v220, v221
v_cvt_pk_bf16_f32 v115, v222, v223
v_cvt_pk_bf16_f32 v112, v228, v229
v_cvt_pk_bf16_f32 v113, v230, v231
v_exp_f32 v188, v188
v_and_b32 v198, 15, v245
v_smfmac_f32_16x16x64_bf16 v[192:195], v[184:187], v[112:119], v251 abid:1
ds_read_b128 v[220:223], v242 offset:256
ds_read_b128 v[228:231], v242 offset:512
v_mfma_f32_16x16x32_bf16 v[168:171], v[80:83], v[112:115], v[168:171]
v_exp_f32 v189, v189
v_mfma_f32_16x16x32_bf16 v[168:171], v[64:67], v[108:111], v[168:171]
s_waitcnt lgkmcnt(3)
v_exp_f32 v190, v190
v_mfma_f32_16x16x32_bf16 v[168:171], v[48:51], v[104:107], v[168:171]
s_waitcnt lgkmcnt(2)
v_exp_f32 v191, v191
v_mfma_f32_16x16x32_bf16 v[172:175], v[52:55], v[104:107], v[172:175]
v_cvt_pk_bf16_f32 v120, v188, v189
v_cvt_pk_bf16_f32 v121, v190, v191
v_mfma_f32_16x16x32_bf16 v[172:175], v[68:71], v[108:111], v[172:175]
v_add_f32 v192, v192, v193
v_mov_b32 v243, s7
v_mfma_f32_16x16x32_bf16 v[172:175], v[84:87], v[112:115], v[172:175]
v_rcp_f32 v254, v192
v_mfma_f32_16x16x32_bf16 v[176:179], v[88:91], v[112:115], v[176:179]
v_max3_f32 v255, v255, v192, v254
v_bfe_u32 v246, v245, 2, 2
v_mfma_f32_16x16x32_bf16 v[176:179], v[72:75], v[108:111], v[176:179]
v_lshl_add_u32 v250, v198, 4, s9
v_and_b32 v196, 3, v245
v_mfma_f32_16x16x32_bf16 v[176:179], v[56:59], v[104:107], v[176:179]
ds_read_b64 v[96:97], v250 offset:0
v_mad_u32_u24 v243, v246, s6, v243
v_mfma_f32_16x16x32_bf16 v[180:183], v[60:63], v[104:107], v[180:183]
ds_read_b32 v102, v250 offset:8
v_lshrrev_b32 v197, 4, v245
v_mfma_f32_16x16x32_bf16 v[180:183], v[76:79], v[108:111], v[180:183]
ds_read_b64 v[100:101], v250 offset:256
v_mad_u32_u24 v243, v196, s15, v243
v_mfma_f32_16x16x32_bf16 v[180:183], v[92:95], v[112:115], v[180:183]
s_waitcnt lgkmcnt(4)
ds_read_b32 v103, v250 offset:264
v_lshl_add_u32 v247, v197, 4, v243
v_mfma_f32_16x16x32_bf16 v[0:3], a[192:195], v[208:211], 0
s_waitcnt lgkmcnt(4)
v_lshl_add_u32 v249, v198, 3, s8
v_mad_u32_u24 v249, v197, s6, v249
v_mfma_f32_16x16x32_bf16 v[0:3], a[196:199], v[220:223], v[0:3]
ds_read_b64 v[32:33], v249 offset:0
v_bfe_u32 v199, v245, 2, 1
v_mfma_f32_16x16x32_bf16 v[0:3], a[200:203], v[228:231], v[0:3]
s_waitcnt lgkmcnt(4)
ds_read_b64 v[34:35], v249 offset:6912
v_mad_u32_u24 v248, v199, s57, v244
v_mfma_f32_16x16x32_bf16 v[0:3], a[204:207], v[232:235], v[0:3]
s_waitcnt lgkmcnt(4)
ds_read_b128 v[188:191], v242 offset:4736
ds_read_b128 v[192:195], v242 offset:4480
v_mfma_f32_16x16x32_bf16 v[4:7], a[220:223], v[232:235], 0
s_waitcnt lgkmcnt(5)
ds_read_b128 v[196:199], v242 offset:4224
v_cndmask_b32 v96, 0, v96, vcc
v_mfma_f32_16x16x32_bf16 v[4:7], a[216:219], v[228:231], v[4:7]
s_waitcnt lgkmcnt(5)
ds_read_b64 v[36:37], v249 offset:128
v_cndmask_b32 v97, 0, v97, vcc
v_mfma_f32_16x16x32_bf16 v[4:7], a[212:215], v[220:223], v[4:7]
ds_read_b64 v[38:39], v249 offset:7040
ds_read_b64 v[40:41], v249 offset:256
v_mfma_f32_16x16x32_bf16 v[4:7], a[208:211], v[208:211], v[4:7]
ds_read_b64 v[42:43], v249 offset:7168
v_mov_b64 v[98:99], 0
v_mfma_f32_16x16x32_bf16 v[8:11], a[224:227], v[208:211], 0
ds_read_b64 v[44:45], v249 offset:384
ds_read_b64 v[46:47], v249 offset:7296
v_mfma_f32_16x16x32_bf16 v[8:11], a[228:231], v[220:223], v[8:11]
ds_read_b128 v[104:107], v247 offset:0
ds_read_b128 v[108:111], v247 offset:64
v_mfma_f32_16x16x32_bf16 v[8:11], a[232:235], v[228:231], v[8:11]
ds_read_b128 v[112:115], v247 offset:128
ds_read_b128 v[116:119], v247 offset:192
v_mfma_f32_16x16x32_bf16 v[8:11], a[236:239], v[232:235], v[8:11]
v_fmac_f32 v136, v168, v254
v_fmac_f32 v137, v169, v254
v_mfma_f32_16x16x32_bf16 v[12:15], a[252:255], v[232:235], 0
ds_read_b128 v[232:235], v242 offset:4992
v_fmac_f32 v144, v176, v254
v_mfma_f32_16x16x32_bf16 v[12:15], a[244:247], v[220:223], v[12:15]
ds_read_b128 v[220:223], v243 offset:256
v_fmac_f32 v145, v177, v254
v_mfma_f32_16x16x32_bf16 v[12:15], a[240:243], v[208:211], v[12:15]
s_waitcnt lgkmcnt(14)
v_fmac_f32 v138, v170, v254
v_fmac_f32 v139, v171, v254
v_mfma_f32_16x16x32_bf16 v[12:15], a[248:251], v[228:231], v[12:15]
v_cvt_pk_bf16_f32 v136, v136, v137
v_fmac_f32 v146, v178, v254
v_mfma_f32_16x16x32_bf16 v[28:31], a[248:251], v[188:191], 0
s_waitcnt lgkmcnt(13)
v_fmac_f32 v147, v179, v254
v_cvt_pk_bf16_f32 v144, v144, v145
v_fmac_f32 v140, v172, v254
v_fmac_f32 v141, v173, v254
v_fmac_f32 v142, v174, v254
s_waitcnt lgkmcnt(1)
v_mfma_f32_16x16x32_bf16 v[28:31], a[252:255], v[232:235], v[28:31]
v_fmac_f32 v143, v175, v254
v_cvt_pk_bf16_f32 v137, v138, v139
v_mfma_f32_16x16x32_bf16 v[28:31], a[244:247], v[192:195], v[28:31]
s_waitcnt lgkmcnt(0)
v_fmac_f32 v148, v180, v254
v_fmac_f32 v149, v181, v254
v_mfma_f32_16x16x32_bf16 v[28:31], a[240:243], v[196:199], v[28:31]
v_fmac_f32 v150, v182, v254
v_fmac_f32 v151, v183, v254
v_mfma_f32_16x16x32_bf16 v[104:107], v[32:35], v[96:99], v[104:107]
v_cvt_pk_bf16_f32 v145, v146, v147
v_cvt_pk_bf16_f32 v138, v140, v141
v_mfma_f32_16x16x32_bf16 v[108:111], v[36:39], v[96:99], v[108:111]
v_cvt_pk_bf16_f32 v139, v142, v143
v_cvt_pk_bf16_f32 v146, v148, v149
v_mfma_f32_16x16x32_bf16 v[112:115], v[40:43], v[96:99], v[112:115]
v_cvt_pk_bf16_f32 v147, v150, v151
v_pk_max_i16 v136, v136, 0
v_mfma_f32_16x16x32_bf16 v[116:119], v[44:47], v[96:99], v[116:119]
v_pk_max_i16 v137, v137, 0
v_pk_max_i16 v138, v138, 0
v_mfma_f32_16x16x32_bf16 v[24:27], a[224:227], v[196:199], 0
v_pk_max_i16 v139, v139, 0
v_pk_max_i16 v144, v144, 0
v_mfma_f32_16x16x32_bf16 v[24:27], a[228:231], v[192:195], v[24:27]
v_pk_max_i16 v145, v145, 0
v_pk_max_i16 v146, v146, 0
v_mfma_f32_16x16x32_bf16 v[24:27], a[232:235], v[188:191], v[24:27]
v_pk_max_i16 v147, v147, 0
v_mov_b64 v[140:141], v[136:137]
v_mfma_f32_16x16x32_bf16 v[24:27], a[236:239], v[232:235], v[24:27]
v_mov_b64 v[142:143], v[138:139]
v_mov_b32_dpp v136, v144 row_ror:8 row_mask:0xf bank_mask:0xc
v_mov_b32_dpp v137, v145 row_ror:8 row_mask:0xf bank_mask:0xc
v_mov_b32_dpp v138, v146 row_ror:8 row_mask:0xf bank_mask:0xc
v_mov_b32_dpp v139, v147 row_ror:8 row_mask:0xf bank_mask:0xc
v_mov_b32_dpp v144, v140 row_ror:8 row_mask:0xf bank_mask:0x3
v_mov_b32_dpp v145, v141 row_ror:8 row_mask:0xf bank_mask:0x3
v_mov_b32_dpp v146, v142 row_ror:8 row_mask:0xf bank_mask:0x3
v_mov_b32_dpp v147, v143 row_ror:8 row_mask:0xf bank_mask:0x3
v_mfma_f32_32x32x16_bf16 v[168:183], v[236:239], v[132:135], 0
buffer_store_dwordx4 v[136:139], v244, s[20:23], s52 offen offset:0 nt
buffer_store_dwordx4 v[144:147], v244, s[20:23], s52 offen offset:2048 nt
v_exp_f32 v200, v200
v_exp_f32 v201, v201
v_mfma_f32_16x16x32_bf16 v[20:23], a[220:223], v[232:235], 0
v_exp_f32 v202, v202
v_mfma_f32_16x16x32_bf16 v[20:23], a[216:219], v[188:191], v[20:23]
v_exp_f32 v203, v203
v_mfma_f32_16x16x32_bf16 v[20:23], a[212:215], v[192:195], v[20:23]
v_exp_f32 v204, v204
v_mfma_f32_16x16x32_bf16 v[20:23], a[208:211], v[196:199], v[20:23]
v_exp_f32 v205, v205
v_mfma_f32_16x16x32_bf16 v[16:19], a[192:195], v[196:199], 0
v_exp_f32 v206, v206
v_mfma_f32_16x16x32_bf16 v[16:19], a[196:199], v[192:195], v[16:19]
ds_read_b128 v[192:195], v247 offset:6912
v_cvt_pk_bf16_f32 v122, v200, v201
v_mfma_f32_16x16x32_bf16 v[16:19], a[200:203], v[188:191], v[16:19]
ds_read_b128 v[208:211], v247 offset:6976
v_cvt_pk_bf16_f32 v123, v202, v203
v_mfma_f32_16x16x32_bf16 v[16:19], a[204:207], v[232:235], v[16:19]
ds_read_b128 v[188:191], v247 offset:7040
v_exp_f32 v207, v207
v_cvt_pk_bf16_f32 v124, v204, v205
v_cvt_pk_bf16_f32 v125, v206, v207
v_exp_f32 v212, v212
v_exp_f32 v213, v213
v_exp_f32 v214, v214
v_exp_f32 v215, v215
v_cvt_pk_bf16_f32 v126, v212, v213
v_cvt_pk_bf16_f32 v127, v214, v215
v_mov_b64 v[196:197], 0
v_exp_f32 v216, v216
v_cndmask_b32 v100, 0, v100, vcc
v_smfmac_f32_16x16x64_bf16 v[196:199], v[184:187], v[120:127], v251
ds_read_b128 v[200:203], v247 offset:7104
v_exp_f32 v217, v217
v_exp_f32 v218, v218
v_exp_f32 v219, v219
v_exp_f32 v224, v224
v_exp_f32 v225, v225
v_exp_f32 v226, v226
v_exp_f32 v227, v227
v_cvt_pk_bf16_f32 v128, v216, v217
v_cvt_pk_bf16_f32 v129, v218, v219
v_cvt_pk_bf16_f32 v130, v224, v225
v_cvt_pk_bf16_f32 v131, v226, v227
v_cndmask_b32 v101, 0, v101, vcc
v_add_f32 v220, v220, v221
v_smfmac_f32_16x16x64_bf16 v[196:199], v[184:187], v[128:135], v251 abid:1
s_waitcnt lgkmcnt(3)
ds_read_b128 v[204:207], v243 offset:7168
v_add_f32 v222, v222, v223
v_mfma_f32_16x16x32_bf16 v[168:171], v[80:83], v[128:131], v[168:171]
s_waitcnt lgkmcnt(3)
v_add_f32 v220, v220, v102
v_add_f32 v220, v220, v222
v_mfma_f32_16x16x32_bf16 v[168:171], v[64:67], v[124:127], v[168:171]
s_waitcnt lgkmcnt(2)
v_rcp_f32 v252, v220
v_mfma_f32_16x16x32_bf16 v[168:171], v[48:51], v[120:123], v[168:171]
v_fmac_f32 v0, v104, v252
v_fmac_f32 v1, v105, v252
v_mfma_f32_16x16x32_bf16 v[172:175], v[52:55], v[120:123], v[172:175]
v_fmac_f32 v8, v112, v252
v_fmac_f32 v9, v113, v252
v_mfma_f32_16x16x32_bf16 v[172:175], v[68:71], v[124:127], v[172:175]
v_fmac_f32 v2, v106, v252
v_fmac_f32 v3, v107, v252
v_mfma_f32_16x16x32_bf16 v[172:175], v[84:87], v[128:131], v[172:175]
s_waitcnt lgkmcnt(0)
v_cvt_pk_bf16_f32 v0, v0, v1
v_fmac_f32 v10, v114, v252
v_mfma_f32_16x16x32_bf16 v[192:195], v[32:35], v[98:101], v[192:195]
v_fmac_f32 v11, v115, v252
v_cvt_pk_bf16_f32 v8, v8, v9
v_mfma_f32_16x16x32_bf16 v[208:211], v[36:39], v[98:101], v[208:211]
v_fmac_f32 v4, v108, v252
v_fmac_f32 v5, v109, v252
v_mfma_f32_16x16x32_bf16 v[188:191], v[40:43], v[98:101], v[188:191]
v_fmac_f32 v6, v110, v252
v_fmac_f32 v7, v111, v252
v_mfma_f32_16x16x32_bf16 v[200:203], v[44:47], v[98:101], v[200:203]
v_cvt_pk_bf16_f32 v1, v2, v3
v_fmac_f32 v12, v116, v252
v_mfma_f32_16x16x32_bf16 v[176:179], v[72:75], v[124:127], v[176:179]
v_fmac_f32 v13, v117, v252
v_fmac_f32 v14, v118, v252
v_mfma_f32_16x16x32_bf16 v[176:179], v[88:91], v[128:131], v[176:179]
v_fmac_f32 v15, v119, v252
v_cvt_pk_bf16_f32 v9, v10, v11
v_mfma_f32_16x16x32_bf16 v[176:179], v[56:59], v[120:123], v[176:179]
v_cvt_pk_bf16_f32 v2, v4, v5
v_cvt_pk_bf16_f32 v3, v6, v7
v_mfma_f32_16x16x32_bf16 v[180:183], v[60:63], v[120:123], v[180:183]
v_cvt_pk_bf16_f32 v10, v12, v13
v_cvt_pk_bf16_f32 v11, v14, v15
v_mfma_f32_16x16x32_bf16 v[180:183], v[76:79], v[124:127], v[180:183]
v_pk_max_i16 v0, v0, 0
v_pk_max_i16 v1, v1, 0
v_mfma_f32_16x16x32_bf16 v[180:183], v[92:95], v[128:131], v[180:183]
v_pk_max_i16 v2, v2, 0
v_pk_max_i16 v3, v3, 0
v_pk_max_i16 v8, v8, 0
v_pk_max_i16 v9, v9, 0
v_pk_max_i16 v10, v10, 0
v_pk_max_i16 v11, v11, 0
v_mov_b64 v[4:5], v[0:1]
v_mov_b64 v[6:7], v[2:3]
v_mov_b32_dpp v0, v8 row_ror:8 row_mask:0xf bank_mask:0xc
v_mov_b32_dpp v1, v9 row_ror:8 row_mask:0xf bank_mask:0xc
v_mov_b32_dpp v2, v10 row_ror:8 row_mask:0xf bank_mask:0xc
v_mov_b32_dpp v3, v11 row_ror:8 row_mask:0xf bank_mask:0xc
v_mov_b32_dpp v8, v4 row_ror:8 row_mask:0xf bank_mask:0x3
v_mov_b32_dpp v9, v5 row_ror:8 row_mask:0xf bank_mask:0x3
v_mov_b32_dpp v10, v6 row_ror:8 row_mask:0xf bank_mask:0x3
v_mov_b32_dpp v11, v7 row_ror:8 row_mask:0xf bank_mask:0x3
buffer_store_dwordx4 v[0:3], v248, s[20:23], s98 offen offset:0 nt
buffer_store_dwordx4 v[8:11], v248, s[20:23], s99 offen offset:0 nt
v_add_f32 v204, v204, v205
v_add_f32 v206, v206, v207
v_add_f32 v204, v204, v103
v_add_f32 v204, v204, v206
v_rcp_f32 v240, v204
v_add_f32 v196, v196, v197
v_pk_fma_f32 v[16:17], v[192:193], v[240:241], v[16:17] op_sel_hi:[1,0,1]
v_pk_fma_f32 v[24:25], v[188:189], v[240:241], v[24:25] op_sel_hi:[1,0,1]
v_pk_fma_f32 v[18:19], v[194:195], v[240:241], v[18:19] op_sel_hi:[1,0,1]
v_cvt_pk_bf16_f32 v16, v16, v17
v_pk_fma_f32 v[26:27], v[190:191], v[240:241], v[26:27] op_sel_hi:[1,0,1]
v_cvt_pk_bf16_f32 v24, v24, v25
v_pk_fma_f32 v[20:21], v[208:209], v[240:241], v[20:21] op_sel_hi:[1,0,1]
v_pk_fma_f32 v[22:23], v[210:211], v[240:241], v[22:23] op_sel_hi:[1,0,1]
v_cvt_pk_bf16_f32 v17, v18, v19
v_pk_fma_f32 v[28:29], v[200:201], v[240:241], v[28:29] op_sel_hi:[1,0,1]
v_pk_fma_f32 v[30:31], v[202:203], v[240:241], v[30:31] op_sel_hi:[1,0,1]
v_cvt_pk_bf16_f32 v25, v26, v27
v_cvt_pk_bf16_f32 v18, v20, v21
v_cvt_pk_bf16_f32 v19, v22, v23
v_cvt_pk_bf16_f32 v26, v28, v29
v_cvt_pk_bf16_f32 v27, v30, v31
v_pk_max_i16 v16, v16, 0
v_pk_max_i16 v17, v17, 0
v_pk_max_i16 v18, v18, 0
v_pk_max_i16 v19, v19, 0
v_pk_max_i16 v24, v24, 0
v_pk_max_i16 v25, v25, 0
v_pk_max_i16 v26, v26, 0
v_pk_max_i16 v27, v27, 0
v_mov_b64 v[20:21], v[16:17]
v_mov_b64 v[22:23], v[18:19]
v_mov_b32_dpp v16, v24 row_ror:8 row_mask:0xf bank_mask:0xc
v_mov_b32_dpp v17, v25 row_ror:8 row_mask:0xf bank_mask:0xc
v_mov_b32_dpp v18, v26 row_ror:8 row_mask:0xf bank_mask:0xc
v_mov_b32_dpp v19, v27 row_ror:8 row_mask:0xf bank_mask:0xc
v_mov_b32_dpp v24, v20 row_ror:8 row_mask:0xf bank_mask:0x3
v_mov_b32_dpp v25, v21 row_ror:8 row_mask:0xf bank_mask:0x3
v_mov_b32_dpp v26, v22 row_ror:8 row_mask:0xf bank_mask:0x3
v_mov_b32_dpp v27, v23 row_ror:8 row_mask:0xf bank_mask:0x3
buffer_store_dwordx4 v[16:19], v248, s[20:23], s100 offen offset:0 nt
buffer_store_dwordx4 v[24:27], v248, s[20:23], s101 offen offset:0 nt
v_rcp_f32 v254, v196
v_max3_f32 v255, v255, v220, v252
v_pk_fma_f32 v[152:153], v[168:169], v[254:255], v[152:153] op_sel_hi:[1,0,1]
v_pk_fma_f32 v[160:161], v[176:177], v[254:255], v[160:161] op_sel_hi:[1,0,1]
v_pk_fma_f32 v[154:155], v[170:171], v[254:255], v[154:155] op_sel_hi:[1,0,1]
v_cvt_pk_bf16_f32 v152, v152, v153
v_pk_fma_f32 v[162:163], v[178:179], v[254:255], v[162:163] op_sel_hi:[1,0,1]
v_cvt_pk_bf16_f32 v160, v160, v161
v_pk_fma_f32 v[156:157], v[172:173], v[254:255], v[156:157] op_sel_hi:[1,0,1]
v_pk_fma_f32 v[158:159], v[174:175], v[254:255], v[158:159] op_sel_hi:[1,0,1]
v_cvt_pk_bf16_f32 v153, v154, v155
v_pk_fma_f32 v[164:165], v[180:181], v[254:255], v[164:165] op_sel_hi:[1,0,1]
v_pk_fma_f32 v[166:167], v[182:183], v[254:255], v[166:167] op_sel_hi:[1,0,1]
v_cvt_pk_bf16_f32 v161, v162, v163
v_cvt_pk_bf16_f32 v154, v156, v157
v_cvt_pk_bf16_f32 v155, v158, v159
v_cvt_pk_bf16_f32 v162, v164, v165
v_cvt_pk_bf16_f32 v163, v166, v167
v_pk_max_i16 v152, v152, 0
v_pk_max_i16 v153, v153, 0
v_pk_max_i16 v154, v154, 0
v_pk_max_i16 v155, v155, 0
v_pk_max_i16 v160, v160, 0
v_pk_max_i16 v161, v161, 0
v_pk_max_i16 v162, v162, 0
v_pk_max_i16 v163, v163, 0
v_mov_b64 v[156:157], v[152:153]
v_mov_b64 v[158:159], v[154:155]
v_mov_b32_dpp v152, v160 row_ror:8 row_mask:0xf bank_mask:0xc
v_mov_b32_dpp v153, v161 row_ror:8 row_mask:0xf bank_mask:0xc
v_mov_b32_dpp v154, v162 row_ror:8 row_mask:0xf bank_mask:0xc
v_mov_b32_dpp v155, v163 row_ror:8 row_mask:0xf bank_mask:0xc
v_mov_b32_dpp v160, v156 row_ror:8 row_mask:0xf bank_mask:0x3
v_mov_b32_dpp v161, v157 row_ror:8 row_mask:0xf bank_mask:0x3
v_mov_b32_dpp v162, v158 row_ror:8 row_mask:0xf bank_mask:0x3
v_mov_b32_dpp v163, v159 row_ror:8 row_mask:0xf bank_mask:0x3
buffer_store_dwordx4 v[152:155], v244, s[20:23], s53 offen offset:0 nt
buffer_store_dwordx4 v[160:163], v244, s[20:23], s53 offen offset:2048 nt
v_max3_f32 v255, v255, v196, v254
v_max3_f32 v255, v255, v204, v240
v_mov_b32 v1, 0x53800000
v_cmp_nle_f32 vcc, v255, v1
s_lshl_b32 s52, s41, 2
s_add_u32 s52, s52, 163008
s_or_b32 s3, vcc_lo, vcc_hi
v_mov_b32 v2, s52
v_mov_b32 v3, s3
ds_write_b32 v2, v3
v_mov_b32 v2, 163008
s_waitcnt lgkmcnt(0)
s_barrier
ds_read_b128 v[4:7], v2
s_waitcnt lgkmcnt(0)
v_or_b32 v4, v4, v5
v_or3_b32 v4, v4, v6, v7
s_nop 0
v_readfirstlane_b32 s3, v4
s_nop 3
s_cmp_eq_u32 s3, 0
s_cbranch_scc0 L_fast_end
s_endpgm
L_fast_end:
s_waitcnt vmcnt(0)
s_barrier
s_mov_b32 s45, 8
s_mov_b32 s3, 64
s_mov_b32 s46, s44
s_mov_b32 s47, 0x7ff00000
s_mov_b32 s56, 50688
v_mbcnt_lo_u32_b32 v48, -1, 0
v_mbcnt_hi_u32_b32 v48, -1, v48
v_lshlrev_b32 v53, 4, v48
s_lshl_b32 s54, s41, 13
s_add_u32 s57, s54, 4096
v_and_b32 v49, 16, v48
v_lshlrev_b32 v52, 2, v49
v_lshlrev_b32 v49, 1, v49
v_xor_b32 v50, v53, v49
s_mul_i32 s49, s42, 25344
s_mul_i32 s53, s43, 1056
s_add_u32 s49, s49, s53
s_add_u32 m0, s49, 0
s_lshl_b32 s55, s43, 10
s_add_u32 s55, s55, s44
s_add_u32 s48, s55, 0
v_mov_b32 v237, 0
v_bfe_u32 v49, v48, 0, 2
v_lshl_add_u32 v237, v49, 4, v237
v_bfe_u32 v49, v48, 4, 2
v_lshl_add_u32 v237, v49, 6, v237
v_bfe_u32 v49, v48, 2, 2
v_lshl_add_u32 v237, v49, 8, v237
v_xor_b32 v51, 64, v50
s_lshl_b32 s53, s43, 14
v_mov_b32 v248, s53
v_add_u32 v248, 50688, v248
v_bfe_u32 v49, v48, 4, 2
v_lshl_add_u32 v248, v49, 10, v248
v_bfe_u32 v49, v48, 2, 2
v_lshl_add_u32 v248, v49, 7, v248
v_bfe_u32 v49, v48, 3, 1
v_lshl_add_u32 v248, v49, 5, v248
v_bfe_u32 v49, v48, 4, 1
v_lshl_add_u32 v248, v49, 6, v248
v_bfe_u32 v49, v48, 0, 2
v_lshl_add_u32 v248, v49, 3, v248
v_mov_b32 v252, s53
v_add_u32 v252, 116224, v252
v_bfe_u32 v49, v48, 4, 2
v_lshl_add_u32 v252, v49, 10, v252
v_bfe_u32 v49, v48, 2, 2
v_lshl_add_u32 v252, v49, 7, v252
v_bfe_u32 v49, v48, 3, 1
v_lshl_add_u32 v252, v49, 6, v252
v_bfe_u32 v49, v48, 0, 2
v_lshl_add_u32 v252, v49, 4, v252
s_mul_i32 s53, s42, 25344
v_bfe_u32 v49, v48, 2, 2
v_mov_b32 v236, s53
v_mul_u32_u24 v49, 1056, v49
v_add_u32 v236, v49, v236
v_bfe_u32 v49, v48, 0, 2
s_add_u32 s53, s54, 83456
v_lshl_add_u32 v236, v49, 6, v236
v_add_u32 v104, s53, v50
v_add_u32 v105, s53, v51
v_bfe_u32 v49, v48, 4, 2
s_lshl_b32 s53, s41, 12
v_lshl_add_u32 v236, v49, 4, v236
v_mov_b32 v54, s53
v_add_u32 v54, 50688, v54
v_bfe_u32 v49, v48, 3, 1
v_lshl_add_u32 v54, v49, 14, v54
v_bfe_u32 v49, v48, 4, 2
v_lshl_add_u32 v54, v49, 7, v54
v_bfe_u32 v49, v48, 2, 1
v_lshl_add_u32 v54, v49, 6, v54
v_bfe_u32 v49, v48, 5, 1
v_lshl_add_u32 v54, v49, 5, v54
v_bfe_u32 v49, v48, 0, 2
v_lshl_add_u32 v54, v49, 3, v54
s_lshl_b32 s53, s43, 7
v_mov_b32 v239, s53
v_bfe_u32 v49, v48, 0, 4
v_lshl_add_u32 v239, v49, 8, v239
s_mul_i32 s52, s41, 12288
s_add_u32 s52, s52, 101376
v_bfe_u32 v49, v48, 4, 2
v_lshl_add_u32 v239, v49, 4, v239
v_mov_b32 v241, s52
v_add_u32 v241, 8192, v241
v_bfe_u32 v49, v48, 4, 2
v_lshl_add_u32 v241, v49, 1, v241
v_bfe_u32 v49, v48, 0, 4
v_lshl_add_u32 v241, v49, 3, v241
buffer_load_dwordx4 v[152:155], v53, s[24:27], s54 offen offset:0
v_mov_b32 v240, s52
v_bfe_u32 v49, v48, 2, 2
v_lshl_add_u32 v240, v49, 7, v240
buffer_load_dwordx4 v[156:159], v53, s[24:27], s54 offen offset:1024
v_lshlrev_b32 v49, 2, v48
v_xor_b32 v49, v49, v48
v_and_b32 v49, 48, v49
buffer_load_dwordx4 v[160:163], v53, s[24:27], s54 offen offset:2048
s_lshl_b32 s53, s41, 10
v_add_u32 v240, v49, v240
v_mov_b32 v254, s53
v_add_u32 v254, 150528, v254
buffer_load_dwordx4 v[164:167], v53, s[24:27], s54 offen offset:3072
v_bfe_u32 v49, v48, 0, 6
v_mov_b32 v40, 0
v_mov_b32 v41, 0
buffer_load_dwordx4 v[168:171], v53, s[24:27], s57 offen offset:0
v_mov_b32 v42, 0
v_mov_b32 v43, 0
v_lshl_add_u32 v254, v49, 4, v254
buffer_load_dwordx4 v[172:175], v53, s[24:27], s57 offen offset:1024
ds_write_b128 v254, v[40:43] offset:0
buffer_load_dwordx4 v[176:179], v53, s[24:27], s57 offen offset:2048
ds_write_b128 v254, v[40:43] offset:256
buffer_load_dwordx4 v[180:183], v53, s[24:27], s57 offen offset:3072
buffer_load_dwordx4 v237, s[16:19], s48 offen nt lds
s_add_u32 m0, s49, 2112
s_add_u32 s48, s55, 2048
v_mov_b32 v245, s52
v_add_u32 v245, 4096, v245
buffer_load_dwordx4 v237, s[16:19], s48 offen nt lds
s_add_u32 m0, s49, 4224
s_add_u32 s48, s55, 4096
v_bfe_u32 v49, v48, 0, 2
buffer_load_dwordx4 v237, s[16:19], s48 offen nt lds
s_add_u32 m0, s49, 6336
s_add_u32 s48, s55, 6144
s_mov_b32 vcc_lo, 0x11111111
s_mov_b32 vcc_hi, 0x11111111
buffer_load_dwordx4 v237, s[16:19], s48 offen nt lds
s_add_u32 m0, s54, 50688
v_lshl_add_u32 v245, v49, 7, v245
v_mov_b32 v254, 150528
v_lshlrev_b32 v49, 4, v48
buffer_load_dwordx4 v50, s[28:31], s54 offen offset:0 lds
v_cndmask_b32 v240, v254, v240, vcc
v_xor_b32 v49, v49, v48
v_and_b32 v49, 48, v49
buffer_load_dwordx4 v51, s[28:31], s54 offen offset:1024 lds
s_mov_b32 vcc_lo, 0xf000f
s_mov_b32 vcc_hi, 0xf000f
v_add_u32 v245, v49, v245
buffer_load_dwordx4 v50, s[28:31], s54 offen offset:2048 lds
v_cndmask_b32 v242, v254, v245, vcc
s_mov_b32 vcc_lo, 0xf000f0
s_mov_b32 vcc_hi, 0xf000f0
buffer_load_dwordx4 v51, s[28:31], s54 offen offset:3072 lds
s_add_u32 m0, s57, 50688
v_cndmask_b32 v243, v254, v245, vcc
s_mov_b32 vcc_lo, 0xf000f00
s_mov_b32 vcc_hi, 0xf000f00
buffer_load_dwordx4 v50, s[28:31], s57 offen offset:0 lds
v_cndmask_b32 v244, v254, v245, vcc
s_mov_b32 vcc_lo, 0xf000f000
s_mov_b32 vcc_hi, 0xf000f000
v_mov_b32 v246, s52
buffer_load_dwordx4 v51, s[28:31], s57 offen offset:1024 lds
v_add_u32 v246, 4096, v246
v_bfe_u32 v49, v48, 0, 2
v_cndmask_b32 v245, v254, v245, vcc
buffer_load_dwordx4 v50, s[28:31], s57 offen offset:2048 lds
v_lshl_add_u32 v246, v49, 7, v246
v_mov_b32 v254, 154880
v_bfe_u32 v49, v48, 2, 2
buffer_load_dwordx4 v51, s[28:31], s57 offen offset:3072 lds
s_add_u32 m0, s49, 16896
s_mov_b32 vcc_lo, 0xf000f
s_mov_b32 vcc_hi, 0xf000f
v_lshl_add_u32 v254, v49, 3, v254
v_cndmask_b32 v246, v254, v246, vcc
v_xor_b32 v249, 32, v248
v_xor_b32 v250, 64, v248
v_xor_b32 v251, 96, v248
s_mul_i32 s4, s43, 13107200
s_add_u32 s4, s4, s44
s_add_u32 s4, s4, 24576
s_add_u32 s5, s55, 104857600
s_sub_u32 s5, s5, s4
s_add_u32 s48, s4, 0
v_xor_b32 v52, v53, v52
v_xor_b32 v55, 96, v54
v_xor_b32 v253, 64, v252
v_lshlrev_b32 v49, 4, v48
v_xor_b32 v49, v49, v48
v_and_b32 v49, 48, v49
v_add_u32 v246, v49, v246
v_add_u32 v246, v49, v246
v_mov_b32 v50, s52
v_bfe_u32 v49, v48, 0, 4
v_lshl_add_u32 v50, v49, 7, v50
v_lshlrev_b32 v49, 4, v48
v_xor_b32 v49, v49, v48
v_and_b32 v49, 48, v49
v_add_u32 v50, v49, v50
v_mov_b32 v51, s52
v_add_u32 v51, 8192, v51
v_bfe_u32 v49, v48, 4, 2
v_lshl_add_u32 v51, v49, 9, v51
v_bfe_u32 v49, v48, 0, 4
v_lshl_add_u32 v51, v49, 3, v51
s_add_u32 s50, s55, 13107200
s_mov_b32 s51, 2048
v_xor_b32 v247, 32, v48
s_mov_b32 s52, 0x7ff00000
v_lshlrev_b32 v247, 2, v247
s_waitcnt vmcnt(19)
v_and_b32 v254, 0xffff0000, v152
buffer_load_dwordx4 v237, s[16:19], s48 offen nt lds
s_add_u32 m0, s49, 19008
s_add_u32 s48, s4, 26214400
v_and_b32 v255, 0xffff0000, v153
v_lshlrev_b32 v152, 16, v152
v_lshlrev_b32 v153, 16, v153
v_mul_f32 v254, s40, v254
v_mul_f32 v152, s40, v152
v_mul_f32 v255, s40, v255
v_mul_f32 v153, s40, v153
v_cvt_pk_bf16_f32 v152, v152, v254
v_cvt_pk_bf16_f32 v153, v153, v255
v_and_b32 v254, 0xffff0000, v154
v_and_b32 v255, 0xffff0000, v155
v_lshlrev_b32 v154, 16, v154
v_lshlrev_b32 v155, 16, v155
v_mul_f32 v254, s40, v254
v_mul_f32 v154, s40, v154
v_mul_f32 v255, s40, v255
v_mul_f32 v155, s40, v155
v_cvt_pk_bf16_f32 v154, v154, v254
v_cvt_pk_bf16_f32 v155, v155, v255
s_waitcnt vmcnt(19)
v_and_b32 v254, 0xffff0000, v156
v_and_b32 v255, 0xffff0000, v157
v_lshlrev_b32 v156, 16, v156
v_lshlrev_b32 v157, 16, v157
v_mul_f32 v254, s40, v254
v_mul_f32 v156, s40, v156
v_mul_f32 v255, s40, v255
v_mul_f32 v157, s40, v157
v_cvt_pk_bf16_f32 v156, v156, v254
buffer_load_dwordx4 v237, s[16:19], s48 offen nt lds
s_add_u32 m0, s49, 21120
s_add_u32 s48, s4, 52428800
v_cvt_pk_bf16_f32 v157, v157, v255
v_and_b32 v254, 0xffff0000, v158
v_and_b32 v255, 0xffff0000, v159
v_lshlrev_b32 v158, 16, v158
v_lshlrev_b32 v159, 16, v159
v_mul_f32 v254, s40, v254
v_mul_f32 v158, s40, v158
v_mul_f32 v255, s40, v255
v_mul_f32 v159, s40, v159
v_cvt_pk_bf16_f32 v158, v158, v254
v_cvt_pk_bf16_f32 v159, v159, v255
s_waitcnt vmcnt(19)
v_and_b32 v254, 0xffff0000, v160
v_and_b32 v255, 0xffff0000, v161
v_lshlrev_b32 v160, 16, v160
v_lshlrev_b32 v161, 16, v161
v_mul_f32 v254, s40, v254
v_mul_f32 v160, s40, v160
v_mul_f32 v255, s40, v255
v_mul_f32 v161, s40, v161
v_cvt_pk_bf16_f32 v160, v160, v254
v_cvt_pk_bf16_f32 v161, v161, v255
v_and_b32 v254, 0xffff0000, v162
v_and_b32 v255, 0xffff0000, v163
v_lshlrev_b32 v162, 16, v162
v_lshlrev_b32 v163, 16, v163
v_mul_f32 v254, s40, v254
v_mul_f32 v162, s40, v162
v_mul_f32 v255, s40, v255
v_mul_f32 v163, s40, v163
v_cvt_pk_bf16_f32 v162, v162, v254
buffer_load_dwordx4 v237, s[16:19], s48 offen nt lds
s_add_u32 m0, s49, 23232
s_add_u32 s48, s4, 78643200
ds_write_b128 v104, v[152:155] offset:0
ds_write_b128 v105, v[156:159] offset:1024
v_cvt_pk_bf16_f32 v163, v163, v255
s_waitcnt vmcnt(19)
v_and_b32 v254, 0xffff0000, v164
v_and_b32 v255, 0xffff0000, v165
v_lshlrev_b32 v164, 16, v164
v_lshlrev_b32 v165, 16, v165
v_mul_f32 v254, s40, v254
v_mul_f32 v164, s40, v164
v_mul_f32 v255, s40, v255
v_mul_f32 v165, s40, v165
v_cvt_pk_bf16_f32 v164, v164, v254
v_cvt_pk_bf16_f32 v165, v165, v255
v_and_b32 v254, 0xffff0000, v166
v_and_b32 v255, 0xffff0000, v167
v_lshlrev_b32 v166, 16, v166
v_lshlrev_b32 v167, 16, v167
v_mul_f32 v254, s40, v254
buffer_load_dwordx4 v237, s[16:19], s48 offen nt lds
s_add_u32 m0, s54, 116224
s_add_u32 s48, s55, 8192
ds_write_b128 v104, v[160:163] offset:2048
v_mul_f32 v166, s40, v166
v_mul_f32 v255, s40, v255
v_mul_f32 v167, s40, v167
v_cvt_pk_bf16_f32 v166, v166, v254
v_cvt_pk_bf16_f32 v167, v167, v255
s_waitcnt vmcnt(19)
v_and_b32 v254, 0xffff0000, v168
v_and_b32 v255, 0xffff0000, v169
v_lshlrev_b32 v168, 16, v168
v_lshlrev_b32 v169, 16, v169
v_mul_f32 v254, s40, v254
v_mul_f32 v168, s40, v168
v_mul_f32 v255, s40, v255
v_mul_f32 v169, s40, v169
v_cvt_pk_bf16_f32 v168, v168, v254
v_cvt_pk_bf16_f32 v169, v169, v255
v_and_b32 v254, 0xffff0000, v170
v_and_b32 v255, 0xffff0000, v171
v_lshlrev_b32 v170, 16, v170
v_lshlrev_b32 v171, 16, v171
v_mul_f32 v254, s40, v254
v_mul_f32 v170, s40, v170
v_mul_f32 v255, s40, v255
v_mul_f32 v171, s40, v171
buffer_load_dwordx4 v52, s[32:35], s54 offen offset:0 lds
ds_write_b128 v105, v[164:167] offset:3072
v_cvt_pk_bf16_f32 v170, v170, v254
v_cvt_pk_bf16_f32 v171, v171, v255
s_waitcnt vmcnt(19)
v_and_b32 v254, 0xffff0000, v172
v_and_b32 v255, 0xffff0000, v173
v_lshlrev_b32 v172, 16, v172
v_lshlrev_b32 v173, 16, v173
v_mul_f32 v254, s40, v254
v_mul_f32 v172, s40, v172
v_mul_f32 v255, s40, v255
v_mul_f32 v173, s40, v173
v_cvt_pk_bf16_f32 v172, v172, v254
v_cvt_pk_bf16_f32 v173, v173, v255
v_and_b32 v254, 0xffff0000, v174
v_and_b32 v255, 0xffff0000, v175
v_lshlrev_b32 v174, 16, v174
v_lshlrev_b32 v175, 16, v175
v_mul_f32 v254, s40, v254
v_mul_f32 v174, s40, v174
v_mul_f32 v255, s40, v255
v_mul_f32 v175, s40, v175
v_cvt_pk_bf16_f32 v174, v174, v254
v_cvt_pk_bf16_f32 v175, v175, v255
s_waitcnt vmcnt(18)
v_and_b32 v254, 0xffff0000, v176
v_and_b32 v255, 0xffff0000, v177
v_lshlrev_b32 v176, 16, v176
buffer_load_dwordx4 v52, s[32:35], s54 offen offset:1024 lds
ds_write_b128 v104, v[168:171] offset:4096
v_lshlrev_b32 v177, 16, v177
v_mul_f32 v254, s40, v254
v_mul_f32 v176, s40, v176
v_mul_f32 v255, s40, v255
v_mul_f32 v177, s40, v177
v_cvt_pk_bf16_f32 v176, v176, v254
v_cvt_pk_bf16_f32 v177, v177, v255
v_and_b32 v254, 0xffff0000, v178
v_and_b32 v255, 0xffff0000, v179
v_lshlrev_b32 v178, 16, v178
v_lshlrev_b32 v179, 16, v179
v_mul_f32 v254, s40, v254
v_mul_f32 v178, s40, v178
v_mul_f32 v255, s40, v255
v_mul_f32 v179, s40, v179
v_cvt_pk_bf16_f32 v178, v178, v254
v_cvt_pk_bf16_f32 v179, v179, v255
s_waitcnt vmcnt(18)
v_and_b32 v254, 0xffff0000, v180
v_and_b32 v255, 0xffff0000, v181
v_lshlrev_b32 v180, 16, v180
v_lshlrev_b32 v181, 16, v181
v_mul_f32 v254, s40, v254
v_mul_f32 v180, s40, v180
v_mul_f32 v255, s40, v255
v_mul_f32 v181, s40, v181
buffer_load_dwordx4 v52, s[32:35], s54 offen offset:2048 lds
ds_write_b128 v105, v[172:175] offset:5120
ds_write_b128 v104, v[176:179] offset:6144
v_cvt_pk_bf16_f32 v180, v180, v254
v_cvt_pk_bf16_f32 v181, v181, v255
v_and_b32 v254, 0xffff0000, v182
v_and_b32 v255, 0xffff0000, v183
v_lshlrev_b32 v182, 16, v182
v_lshlrev_b32 v183, 16, v183
v_mul_f32 v254, s40, v254
v_mul_f32 v182, s40, v182
v_mul_f32 v255, s40, v255
v_mul_f32 v183, s40, v183
v_cvt_pk_bf16_f32 v182, v182, v254
v_cvt_pk_bf16_f32 v183, v183, v255
ds_write_b128 v105, v[180:183] offset:7168
buffer_load_dwordx4 v52, s[32:35], s54 offen offset:3072 lds
s_add_u32 m0, s57, 116224
v_xor_b32 v254, 32, v54
v_xor_b32 v255, 64, v54
s_mov_b32 s53, 0x7ff00000
buffer_load_dwordx4 v52, s[32:35], s57 offen offset:0 lds
buffer_load_dwordx4 v52, s[32:35], s57 offen offset:1024 lds
s_waitcnt vmcnt(10) lgkmcnt(0)
s_barrier
ds_read_b64_tr_b16 a[64:65], v248 offset:0
ds_read_b64_tr_b16 a[66:67], v248 offset:512
ds_read_b128 v[188:191], v236 offset:0
ds_read_b64_tr_b16 a[68:69], v248 offset:4096
ds_read_b64_tr_b16 a[70:71], v248 offset:4608
buffer_load_dwordx4 v52, s[32:35], s57 offen offset:2048 lds
ds_read_b128 v[196:199], v236 offset:256
ds_read_b64_tr_b16 a[72:73], v248 offset:8192
ds_read_b64_tr_b16 a[74:75], v248 offset:8704
ds_read_b128 v[200:203], v236 offset:512
ds_read_b64_tr_b16 a[76:77], v248 offset:12288
ds_read_b64_tr_b16 a[78:79], v248 offset:12800
ds_read_b128 v[204:207], v236 offset:768
ds_read_b64_tr_b16 a[92:93], v249 offset:12288
ds_read_b64_tr_b16 a[94:95], v249 offset:12800
ds_read_b64_tr_b16 a[88:89], v249 offset:8192
ds_read_b64_tr_b16 a[90:91], v249 offset:8704
ds_read_b64_tr_b16 a[84:85], v249 offset:4096
ds_read_b64_tr_b16 a[86:87], v249 offset:4608
ds_read_b64_tr_b16 a[80:81], v249 offset:0
ds_read_b64_tr_b16 a[82:83], v249 offset:512
s_waitcnt lgkmcnt(15)
v_mfma_f32_16x16x32_bf16 v[192:195], a[64:67], v[188:191], 0
ds_read_b64_tr_b16 a[96:97], v250 offset:0
ds_read_b64_tr_b16 a[98:99], v250 offset:512
s_waitcnt lgkmcnt(15)
v_mfma_f32_16x16x32_bf16 v[192:195], a[68:71], v[196:199], v[192:195]
s_waitcnt lgkmcnt(14)
ds_read_b64_tr_b16 a[100:101], v250 offset:4096
s_waitcnt lgkmcnt(14)
v_mfma_f32_16x16x32_bf16 v[192:195], a[72:75], v[200:203], v[192:195]
s_waitcnt lgkmcnt(11)
ds_read_b64_tr_b16 a[102:103], v250 offset:4608
ds_read_b64_tr_b16 a[104:105], v250 offset:8192
v_mfma_f32_16x16x32_bf16 v[192:195], a[76:79], v[204:207], v[192:195]
s_waitcnt lgkmcnt(9)
ds_read_b64_tr_b16 a[106:107], v250 offset:8704
ds_read_b64_tr_b16 a[108:109], v250 offset:12288
v_mfma_f32_16x16x32_bf16 v[208:211], a[92:95], v[204:207], 0
s_waitcnt lgkmcnt(7)
buffer_load_dwordx4 v52, s[32:35], s57 offen offset:3072 lds
s_add_u32 m0, s49, 8448
v_mfma_f32_16x16x32_bf16 v[208:211], a[88:91], v[200:203], v[208:211]
ds_read_b64_tr_b16 a[110:111], v250 offset:12800
v_cvt_pk_bf16_f32 v0, v192, v193
v_mfma_f32_16x16x32_bf16 v[208:211], a[84:87], v[196:199], v[208:211]
s_waitcnt lgkmcnt(6)
ds_read_b64_tr_b16 a[124:125], v251 offset:12288
v_cvt_pk_bf16_f32 v1, v194, v195
v_mfma_f32_16x16x32_bf16 v[208:211], a[80:83], v[188:191], v[208:211]
s_waitcnt lgkmcnt(6)
ds_read_b64_tr_b16 a[126:127], v251 offset:12800
ds_read_b64_tr_b16 a[120:121], v251 offset:8192
v_mfma_f32_16x16x32_bf16 v[192:195], a[96:99], v[188:191], 0
s_waitcnt lgkmcnt(6)
ds_read_b64_tr_b16 a[122:123], v251 offset:8704
ds_read_b64_tr_b16 a[116:117], v251 offset:4096
v_mfma_f32_16x16x32_bf16 v[192:195], a[100:103], v[196:199], v[192:195]
s_waitcnt lgkmcnt(6)
ds_read_b64_tr_b16 a[118:119], v251 offset:4608
v_cvt_pk_bf16_f32 v2, v208, v209
v_mfma_f32_16x16x32_bf16 v[192:195], a[104:107], v[200:203], v[192:195]
ds_read_b64_tr_b16 a[112:113], v251 offset:0
s_waitcnt lgkmcnt(7)
v_mfma_f32_16x16x32_bf16 v[192:195], a[108:111], v[204:207], v[192:195]
ds_read_b64_tr_b16 a[114:115], v251 offset:512
v_cvt_pk_bf16_f32 v3, v210, v211
ds_read_b128 v[184:187], v236 offset:4992
s_waitcnt lgkmcnt(7)
v_mfma_f32_16x16x32_bf16 v[208:211], a[124:127], v[204:207], 0
s_waitcnt lgkmcnt(6)
buffer_load_dwordx4 v[120:123], v53, s[36:39], s54 offen offset:0
s_waitcnt lgkmcnt(5)
v_mfma_f32_16x16x32_bf16 v[208:211], a[120:123], v[200:203], v[208:211]
s_waitcnt lgkmcnt(4)
ds_read_b128 v[216:219], v236 offset:4736
s_waitcnt lgkmcnt(4)
v_mfma_f32_16x16x32_bf16 v[208:211], a[116:119], v[196:199], v[208:211]
ds_read_b128 v[204:207], v236 offset:4480
v_cvt_pk_bf16_f32 v5, v194, v195
v_cvt_pk_bf16_f32 v4, v192, v193
s_waitcnt lgkmcnt(3)
v_mfma_f32_16x16x32_bf16 v[208:211], a[112:115], v[188:191], v[208:211]
ds_read_b128 v[192:195], v236 offset:4224
s_waitcnt lgkmcnt(3)
v_mfma_f32_16x16x32_bf16 v[200:203], a[124:127], v[184:187], 0
ds_read_b64_tr_b16 a[0:1], v248 offset:32768
ds_read_b64_tr_b16 a[2:3], v248 offset:33280
v_mfma_f32_16x16x32_bf16 v[220:223], a[92:95], v[184:187], 0
ds_read_b64_tr_b16 a[4:5], v248 offset:36864
s_waitcnt lgkmcnt(5)
v_mfma_f32_16x16x32_bf16 v[200:203], a[120:123], v[216:219], v[200:203]
ds_read_b64_tr_b16 a[6:7], v248 offset:37376
s_waitcnt lgkmcnt(5)
v_mfma_f32_16x16x32_bf16 v[200:203], a[116:119], v[204:207], v[200:203]
ds_read_b64_tr_b16 a[8:9], v248 offset:40960
v_cvt_pk_bf16_f32 v6, v208, v209
v_mfma_f32_16x16x32_bf16 v[220:223], a[88:91], v[216:219], v[220:223]
buffer_load_dwordx4 v[124:127], v53, s[36:39], s54 offen offset:1024
s_waitcnt lgkmcnt(5)
v_mfma_f32_16x16x32_bf16 v[200:203], a[112:115], v[192:195], v[200:203]
ds_read_b64_tr_b16 a[10:11], v248 offset:41472
v_cvt_pk_bf16_f32 v7, v210, v211
v_mfma_f32_16x16x32_bf16 v[208:211], a[96:99], v[192:195], 0
s_waitcnt lgkmcnt(4)
ds_read_b64_tr_b16 a[12:13], v248 offset:45056
ds_read_b64_tr_b16 a[14:15], v248 offset:45568
v_mfma_f32_16x16x32_bf16 v[208:211], a[100:103], v[204:207], v[208:211]
s_waitcnt lgkmcnt(5)
ds_read_b64_tr_b16 a[16:17], v249 offset:32768
ds_read_b64_tr_b16 a[18:19], v249 offset:33280
v_mfma_f32_16x16x32_bf16 v[208:211], a[104:107], v[216:219], v[208:211]
s_waitcnt lgkmcnt(6)
ds_read_b64_tr_b16 a[20:21], v249 offset:36864
ds_read_b64_tr_b16 a[22:23], v249 offset:37376
v_mfma_f32_16x16x32_bf16 v[208:211], a[108:111], v[184:187], v[208:211]
s_waitcnt lgkmcnt(7)
ds_read_b64_tr_b16 a[24:25], v249 offset:40960
ds_read_b64_tr_b16 a[26:27], v249 offset:41472
v_mfma_f32_16x16x32_bf16 v[220:223], a[84:87], v[204:207], v[220:223]
ds_read_b64_tr_b16 a[28:29], v249 offset:45056
ds_read_b64_tr_b16 a[30:31], v249 offset:45568
v_mfma_f32_16x16x32_bf16 v[220:223], a[80:83], v[192:195], v[220:223]
s_waitcnt lgkmcnt(10)
ds_read_b64_tr_b16 a[32:33], v250 offset:32768
ds_read_b64_tr_b16 a[34:35], v250 offset:33280
v_mfma_f32_16x16x32_bf16 v[188:191], a[64:67], v[192:195], 0
s_waitcnt lgkmcnt(10)
ds_read_b64_tr_b16 a[36:37], v250 offset:36864
ds_read_b64_tr_b16 a[38:39], v250 offset:37376
v_mfma_f32_16x16x32_bf16 v[188:191], a[72:75], v[216:219], v[188:191]
s_waitcnt lgkmcnt(10)
buffer_load_dwordx4 v[128:131], v53, s[36:39], s54 offen offset:2048
ds_read_b64_tr_b16 a[40:41], v250 offset:40960
v_mfma_f32_16x16x32_bf16 v[188:191], a[76:79], v[184:187], v[188:191]
s_waitcnt lgkmcnt(9)
ds_read_b64_tr_b16 a[42:43], v250 offset:41472
ds_read_b64_tr_b16 a[44:45], v250 offset:45056
v_mfma_f32_16x16x32_bf16 v[188:191], a[68:71], v[204:207], v[188:191]
s_waitcnt lgkmcnt(9)
ds_read_b64_tr_b16 a[46:47], v250 offset:45568
ds_read_b64_tr_b16 a[48:49], v251 offset:32768
ds_read_b64_tr_b16 a[50:51], v251 offset:33280
ds_read_b64_tr_b16 a[52:53], v251 offset:36864
ds_read_b64_tr_b16 a[54:55], v251 offset:37376
ds_read_b64_tr_b16 a[56:57], v251 offset:40960
ds_read_b64_tr_b16 a[58:59], v251 offset:41472
s_waitcnt vmcnt(11)
s_barrier
ds_read_b128 v[56:59], v236 offset:16896
ds_read_b128 v[60:63], v236 offset:17152
ds_read_b128 v[64:67], v236 offset:17408
ds_read_b128 v[68:71], v236 offset:17664
ds_read_b128 v[72:75], v236 offset:21120
ds_read_b128 v[76:79], v236 offset:21376
ds_read_b128 v[80:83], v236 offset:21632
ds_read_b128 v[84:87], v236 offset:21888
ds_read_b64_tr_b16 a[60:61], v251 offset:45056
ds_read_b64_tr_b16 a[62:63], v251 offset:45568
v_cvt_pk_bf16_f32 v14, v200, v201
buffer_load_dwordx4 v[132:135], v53, s[36:39], s54 offen offset:3072
v_cvt_pk_bf16_f32 v15, v202, v203
v_cvt_pk_bf16_f32 v9, v190, v191
v_cvt_pk_bf16_f32 v8, v188, v189
v_cvt_pk_bf16_f32 v13, v210, v211
v_cvt_pk_bf16_f32 v12, v208, v209
v_cvt_pk_bf16_f32 v10, v220, v221
v_cvt_pk_bf16_f32 v11, v222, v223
s_waitcnt lgkmcnt(9)
v_mfma_f32_16x16x32_bf16 v[156:159], a[64:67], v[56:59], 0
s_waitcnt lgkmcnt(7)
v_mfma_f32_16x16x32_bf16 v[156:159], a[68:71], v[60:63], v[156:159]
s_waitcnt lgkmcnt(3)
v_mfma_f32_16x16x32_bf16 v[156:159], a[72:75], v[64:67], v[156:159]
s_waitcnt lgkmcnt(0)
v_mfma_f32_16x16x32_bf16 v[156:159], a[76:79], v[68:71], v[156:159]
s_nop 2
v_mfma_f32_16x16x32_bf16 v[160:163], a[92:95], v[68:71], 0
s_nop 2
v_mfma_f32_16x16x32_bf16 v[160:163], a[88:91], v[64:67], v[160:163]
s_waitcnt vmcnt(4)
s_barrier
v_mfma_f32_16x16x32_bf16 v[160:163], a[84:87], v[60:63], v[160:163]
buffer_load_dwordx4 v[136:139], v53, s[36:39], s57 offen offset:0
ds_read_b64_tr_b16 a[128:129], v252 offset:0
v_mfma_f32_16x16x32_bf16 v[160:163], a[80:83], v[56:59], v[160:163]
ds_read_b64_tr_b16 a[130:131], v252 offset:512
ds_read_b64_tr_b16 a[132:133], v252 offset:4096
v_mfma_f32_16x16x32_bf16 v[164:167], a[96:99], v[56:59], 0
ds_read_b64_tr_b16 a[134:135], v252 offset:4608
ds_read_b64_tr_b16 a[136:137], v252 offset:8192
v_mfma_f32_16x16x32_bf16 v[164:167], a[100:103], v[60:63], v[164:167]
ds_read_b64_tr_b16 a[138:139], v252 offset:8704
ds_read_b64_tr_b16 a[140:141], v252 offset:12288
v_mfma_f32_16x16x32_bf16 v[164:167], a[104:107], v[64:67], v[164:167]
ds_read_b64_tr_b16 a[142:143], v252 offset:12800
ds_read_b64_tr_b16 a[144:145], v252 offset:8
v_mfma_f32_16x16x32_bf16 v[164:167], a[108:111], v[68:71], v[164:167]
ds_read_b64_tr_b16 a[146:147], v252 offset:520
ds_read_b64_tr_b16 a[148:149], v252 offset:4104
v_mfma_f32_16x16x32_bf16 v[168:171], a[124:127], v[68:71], 0
s_waitcnt lgkmcnt(10)
ds_read_b64_tr_b16 a[150:151], v252 offset:4616
v_cvt_pk_bf16_f32 v88, v156, v157
v_mfma_f32_16x16x32_bf16 v[168:171], a[120:123], v[64:67], v[168:171]
s_waitcnt lgkmcnt(9)
ds_read_b64_tr_b16 a[152:153], v252 offset:8200
v_cvt_pk_bf16_f32 v89, v158, v159
v_mfma_f32_16x16x32_bf16 v[168:171], a[116:119], v[60:63], v[168:171]
s_waitcnt lgkmcnt(8)
ds_read_b64_tr_b16 a[154:155], v252 offset:8712
ds_read_b64_tr_b16 a[156:157], v252 offset:12296
v_mfma_f32_16x16x32_bf16 v[168:171], a[112:115], v[56:59], v[168:171]
s_waitcnt lgkmcnt(8)
buffer_load_dwordx4 v[140:143], v53, s[36:39], s57 offen offset:1024
ds_read_b64_tr_b16 a[158:159], v252 offset:12808
v_mfma_f32_16x16x32_bf16 v[172:175], a[64:67], v[72:75], 0
s_waitcnt lgkmcnt(7)
ds_read_b64_tr_b16 a[160:161], v253 offset:0
v_cvt_pk_bf16_f32 v90, v160, v161
v_mfma_f32_16x16x32_bf16 v[172:175], a[68:71], v[76:79], v[172:175]
s_waitcnt lgkmcnt(6)
ds_read_b64_tr_b16 a[162:163], v253 offset:512
v_cvt_pk_bf16_f32 v91, v162, v163
v_mfma_f32_16x16x32_bf16 v[172:175], a[72:75], v[80:83], v[172:175]
s_waitcnt lgkmcnt(6)
ds_read_b64_tr_b16 a[164:165], v253 offset:4096
ds_read_b64_tr_b16 a[166:167], v253 offset:4608
v_mfma_f32_16x16x32_bf16 v[172:175], a[76:79], v[84:87], v[172:175]
s_waitcnt lgkmcnt(7)
ds_read_b64_tr_b16 a[168:169], v253 offset:8192
ds_read_b64_tr_b16 a[170:171], v253 offset:8704
v_mfma_f32_16x16x32_bf16 v[176:179], a[92:95], v[84:87], 0
s_waitcnt lgkmcnt(7)
ds_read_b64_tr_b16 a[172:173], v253 offset:12288
v_cvt_pk_bf16_f32 v92, v164, v165
v_mfma_f32_16x16x32_bf16 v[176:179], a[88:91], v[80:83], v[176:179]
s_waitcnt lgkmcnt(7)
ds_read_b64_tr_b16 a[174:175], v253 offset:12800
v_cvt_pk_bf16_f32 v93, v166, v167
v_mfma_f32_16x16x32_bf16 v[176:179], a[84:87], v[76:79], v[176:179]
s_waitcnt lgkmcnt(7)
ds_read_b64_tr_b16 a[176:177], v253 offset:8
ds_read_b64_tr_b16 a[178:179], v253 offset:520
v_mfma_f32_16x16x32_bf16 v[176:179], a[80:83], v[72:75], v[176:179]
s_waitcnt lgkmcnt(8)
ds_read_b64_tr_b16 a[180:181], v253 offset:4104
ds_read_b64_tr_b16 a[182:183], v253 offset:4616
v_mfma_f32_16x16x32_bf16 v[180:183], a[96:99], v[72:75], 0
s_waitcnt lgkmcnt(8)
buffer_load_dwordx4 v[144:147], v53, s[36:39], s57 offen offset:2048
v_cvt_pk_bf16_f32 v94, v168, v169
v_mfma_f32_16x16x32_bf16 v[180:183], a[100:103], v[76:79], v[180:183]
s_waitcnt lgkmcnt(6)
ds_read_b64_tr_b16 a[184:185], v253 offset:8200
v_cvt_pk_bf16_f32 v95, v170, v171
v_mfma_f32_16x16x32_bf16 v[180:183], a[104:107], v[80:83], v[180:183]
s_waitcnt lgkmcnt(6)
ds_read_b64_tr_b16 a[186:187], v253 offset:8712
ds_read_b64_tr_b16 a[188:189], v253 offset:12296
v_mfma_f32_16x16x32_bf16 v[180:183], a[108:111], v[84:87], v[180:183]
s_waitcnt lgkmcnt(7)
ds_read_b64_tr_b16 a[190:191], v253 offset:12808
v_cvt_pk_bf16_f32 v96, v172, v173
v_mfma_f32_16x16x32_bf16 v[152:155], a[124:127], v[84:87], 0
s_waitcnt lgkmcnt(6)
v_cvt_pk_bf16_f32 v97, v174, v175
v_cvt_pk_bf16_f32 v98, v176, v177
v_mfma_f32_16x16x32_bf16 v[152:155], a[120:123], v[80:83], v[152:155]
s_waitcnt lgkmcnt(4)
v_cvt_pk_bf16_f32 v99, v178, v179
v_cvt_pk_bf16_f32 v100, v180, v181
v_mfma_f32_16x16x32_bf16 v[152:155], a[116:119], v[76:79], v[152:155]
v_cvt_pk_bf16_f32 v101, v182, v183
v_mov_b32 v253, 0
v_mfma_f32_16x16x32_bf16 v[152:155], a[112:115], v[72:75], v[152:155]
s_waitcnt lgkmcnt(3)
v_mov_b32 v252, 1.0
s_nop 0
v_mfma_f32_16x16x32_bf16 v[156:159], a[0:3], v[56:59], 0
s_waitcnt lgkmcnt(1)
s_nop 1
v_mfma_f32_16x16x32_bf16 v[156:159], a[4:7], v[60:63], v[156:159]
s_waitcnt lgkmcnt(0)
buffer_load_dwordx4 v[148:151], v53, s[36:39], s57 offen offset:3072
v_cvt_pk_bf16_f32 v102, v152, v153
v_mfma_f32_16x16x32_bf16 v[156:159], a[8:11], v[64:67], v[156:159]
v_cvt_pk_bf16_f32 v103, v154, v155
v_mfma_f32_16x16x32_bf16 v[156:159], a[12:15], v[68:71], v[156:159]
s_nop 2
v_mfma_f32_16x16x32_bf16 v[160:163], a[28:31], v[68:71], 0
s_nop 2
v_mfma_f32_16x16x32_bf16 v[160:163], a[24:27], v[64:67], v[160:163]
v_cvt_pk_bf16_f32 v104, v156, v157
v_cvt_pk_bf16_f32 v105, v158, v159
v_mfma_f32_16x16x32_bf16 v[160:163], a[20:23], v[60:63], v[160:163]
v_mfma_f32_16x16x32_bf16 v[160:163], a[16:19], v[56:59], v[160:163]
s_nop 2
v_mfma_f32_16x16x32_bf16 v[164:167], a[32:35], v[56:59], 0
s_nop 2
v_mfma_f32_16x16x32_bf16 v[164:167], a[36:39], v[60:63], v[164:167]
v_cvt_pk_bf16_f32 v106, v160, v161
v_cvt_pk_bf16_f32 v107, v162, v163
v_mfma_f32_16x16x32_bf16 v[164:167], a[40:43], v[64:67], v[164:167]
buffer_load_dwordx4 v237, s[16:19], s48 offen nt lds
s_add_u32 m0, s49, 10560
v_mfma_f32_16x16x32_bf16 v[164:167], a[44:47], v[68:71], v[164:167]
s_add_u32 s48, s55, 10240
s_nop 1
v_mfma_f32_16x16x32_bf16 v[168:171], a[60:63], v[68:71], 0
s_nop 2
v_mfma_f32_16x16x32_bf16 v[168:171], a[56:59], v[64:67], v[168:171]
v_cvt_pk_bf16_f32 v108, v164, v165
v_cvt_pk_bf16_f32 v109, v166, v167
v_mfma_f32_16x16x32_bf16 v[168:171], a[52:55], v[60:63], v[168:171]
v_mfma_f32_16x16x32_bf16 v[168:171], a[48:51], v[56:59], v[168:171]
s_nop 2
v_mfma_f32_16x16x32_bf16 v[172:175], a[0:3], v[72:75], 0
s_waitcnt vmcnt(8)
ds_write_b64 v54, v[120:121] offset:0
v_mfma_f32_16x16x32_bf16 v[172:175], a[4:7], v[76:79], v[172:175]
ds_write_b64 v254, v[122:123] offset:0
v_mfma_f32_16x16x32_bf16 v[172:175], a[8:11], v[80:83], v[172:175]
buffer_load_dwordx4 v237, s[16:19], s48 offen nt lds
v_mfma_f32_16x16x32_bf16 v[172:175], a[12:15], v[84:87], v[172:175]
s_add_u32 m0, s49, 12672
s_add_u32 s48, s55, 12288
v_cvt_pk_bf16_f32 v110, v168, v169
v_mfma_f32_16x16x32_bf16 v[176:179], a[28:31], v[84:87], 0
s_waitcnt vmcnt(8)
ds_write_b64 v54, v[124:125] offset:512
v_mfma_f32_16x16x32_bf16 v[176:179], a[24:27], v[80:83], v[176:179]
ds_write_b64 v254, v[126:127] offset:512
v_mfma_f32_16x16x32_bf16 v[176:179], a[20:23], v[76:79], v[176:179]
s_waitcnt vmcnt(7)
ds_write_b64 v255, v[128:129] offset:1024
v_mfma_f32_16x16x32_bf16 v[176:179], a[16:19], v[72:75], v[176:179]
ds_write_b64 v55, v[130:131] offset:1024
v_mfma_f32_16x16x32_bf16 v[180:183], a[32:35], v[72:75], 0
s_waitcnt vmcnt(6)
ds_write_b64 v255, v[132:133] offset:1536
v_mfma_f32_16x16x32_bf16 v[180:183], a[36:39], v[76:79], v[180:183]
ds_write_b64 v55, v[134:135] offset:1536
v_mfma_f32_16x16x32_bf16 v[180:183], a[40:43], v[80:83], v[180:183]
buffer_load_dwordx4 v237, s[16:19], s48 offen nt lds
s_add_u32 m0, s49, 14784
v_mfma_f32_16x16x32_bf16 v[180:183], a[44:47], v[84:87], v[180:183]
s_add_u32 s48, s55, 14336
v_cvt_pk_bf16_f32 v111, v170, v171
v_cvt_pk_bf16_f32 v112, v172, v173
v_mfma_f32_16x16x32_bf16 v[152:155], a[60:63], v[84:87], 0
s_waitcnt vmcnt(6)
ds_write_b64 v54, v[136:137] offset:2048
v_mfma_f32_16x16x32_bf16 v[152:155], a[56:59], v[80:83], v[152:155]
ds_write_b64 v254, v[138:139] offset:2048
v_mfma_f32_16x16x32_bf16 v[152:155], a[52:55], v[76:79], v[152:155]
s_waitcnt vmcnt(5)
ds_write_b64 v54, v[140:141] offset:2560
v_mfma_f32_16x16x32_bf16 v[152:155], a[48:51], v[72:75], v[152:155]
ds_write_b64 v254, v[142:143] offset:2560
v_mfma_f32_16x16x32_bf16 v[156:159], v[56:59], a[128:131], 0
s_waitcnt vmcnt(4)
ds_write_b64 v255, v[144:145] offset:3072
v_mfma_f32_16x16x32_bf16 v[156:159], v[60:63], a[132:135], v[156:159]
ds_write_b64 v55, v[146:147] offset:3072
v_mfma_f32_16x16x32_bf16 v[156:159], v[64:67], a[136:139], v[156:159]
buffer_load_dwordx4 v237, s[16:19], s48 offen nt lds
s_add_u32 m0, s49, 16896
v_mfma_f32_16x16x32_bf16 v[156:159], v[68:71], a[140:143], v[156:159]
s_add_u32 s48, s55, 16384
buffer_load_dwordx4 v237, s[16:19], s48 offen nt lds
s_add_u32 m0, s49, 19008
v_mfma_f32_16x16x32_bf16 v[160:163], v[68:71], a[156:159], 0
s_add_u32 s48, s55, 18432
buffer_load_dwordx4 v237, s[16:19], s48 offen nt lds
s_add_u32 m0, s49, 21120
v_mfma_f32_16x16x32_bf16 v[160:163], v[64:67], a[152:155], v[160:163]
s_add_u32 s48, s55, 20480
buffer_load_dwordx4 v237, s[16:19], s48 offen nt lds
s_add_u32 m0, s49, 23232
v_mfma_f32_16x16x32_bf16 v[160:163], v[60:63], a[148:151], v[160:163]
s_add_u32 s48, s55, 22528
buffer_load_dwordx4 v237, s[16:19], s48 offen nt lds
v_cvt_pk_bf16_f32 v113, v174, v175
v_mfma_f32_16x16x32_bf16 v[160:163], v[56:59], a[144:147], v[160:163]
s_add_u32 s49, s49, 50688
v_cvt_pk_bf16_f32 v114, v176, v177
v_cvt_pk_bf16_f32 v115, v178, v179
v_mfma_f32_16x16x32_bf16 v[164:167], v[56:59], a[160:163], 0
s_waitcnt vmcnt(8)
ds_write_b64 v255, v[148:149] offset:3584
v_mfma_f32_16x16x32_bf16 v[164:167], v[60:63], a[164:167], v[164:167]
ds_write_b64 v55, v[150:151] offset:3584
v_mfma_f32_16x16x32_bf16 v[164:167], v[64:67], a[168:171], v[164:167]
v_cvt_pk_bf16_f32 v116, v180, v181
v_cvt_pk_bf16_f32 v117, v182, v183
v_mfma_f32_16x16x32_bf16 v[164:167], v[68:71], a[172:175], v[164:167]
v_cvt_pk_bf16_f32 v118, v152, v153
v_cvt_pk_bf16_f32 v119, v154, v155
v_mfma_f32_16x16x32_bf16 v[168:171], v[68:71], a[188:191], 0
v_cvt_pk_bf16_f32 v156, v156, v157
v_cvt_pk_bf16_f32 v157, v158, v159
v_mfma_f32_16x16x32_bf16 v[168:171], v[64:67], a[184:187], v[168:171]
v_cvt_pk_bf16_f32 v160, v160, v161
v_cvt_pk_bf16_f32 v161, v162, v163
v_mfma_f32_16x16x32_bf16 v[168:171], v[60:63], a[180:183], v[168:171]
s_waitcnt lgkmcnt(0)
s_barrier
v_mfma_f32_16x16x32_bf16 v[168:171], v[56:59], a[176:179], v[168:171]
ds_read_b64_tr_b16 a[192:193], v248 offset:0
ds_read_b64_tr_b16 a[194:195], v248 offset:512
v_mfma_f32_16x16x32_bf16 v[172:175], v[72:75], a[128:131], 0
ds_read_b64_tr_b16 a[196:197], v248 offset:4096
ds_read_b64_tr_b16 a[198:199], v248 offset:4608
v_mfma_f32_16x16x32_bf16 v[172:175], v[76:79], a[132:135], v[172:175]
ds_read_b64_tr_b16 a[200:201], v248 offset:8192
ds_read_b64_tr_b16 a[202:203], v248 offset:8704
v_mfma_f32_16x16x32_bf16 v[172:175], v[80:83], a[136:139], v[172:175]
ds_read_b64_tr_b16 a[204:205], v248 offset:12288
ds_read_b64_tr_b16 a[206:207], v248 offset:12800
v_mfma_f32_16x16x32_bf16 v[172:175], v[84:87], a[140:143], v[172:175]
ds_read_b64_tr_b16 a[208:209], v249 offset:0
ds_read_b64_tr_b16 a[210:211], v249 offset:512
v_mfma_f32_16x16x32_bf16 v[176:179], v[84:87], a[156:159], 0
ds_read_b64_tr_b16 a[212:213], v249 offset:4096
ds_read_b64_tr_b16 a[214:215], v249 offset:4608
v_mfma_f32_16x16x32_bf16 v[176:179], v[80:83], a[152:155], v[176:179]
s_waitcnt lgkmcnt(10)
ds_read_b64_tr_b16 a[216:217], v249 offset:8192
ds_read_b64_tr_b16 a[218:219], v249 offset:8704
v_mfma_f32_16x16x32_bf16 v[176:179], v[76:79], a[148:151], v[176:179]
s_waitcnt lgkmcnt(10)
ds_read_b64_tr_b16 a[220:221], v249 offset:12288
ds_read_b64_tr_b16 a[222:223], v249 offset:12800
v_mfma_f32_16x16x32_bf16 v[176:179], v[72:75], a[144:147], v[176:179]
s_waitcnt lgkmcnt(10)
ds_read_b64_tr_b16 a[224:225], v250 offset:0
ds_read_b64_tr_b16 a[226:227], v250 offset:512
v_mfma_f32_16x16x32_bf16 v[180:183], v[72:75], a[160:163], 0
s_waitcnt lgkmcnt(10)
ds_read_b64_tr_b16 a[228:229], v250 offset:4096
ds_read_b64_tr_b16 a[230:231], v250 offset:4608
v_mfma_f32_16x16x32_bf16 v[180:183], v[76:79], a[164:167], v[180:183]
s_waitcnt lgkmcnt(10)
ds_read_b64_tr_b16 a[232:233], v250 offset:8192
ds_read_b64_tr_b16 a[234:235], v250 offset:8704
v_mfma_f32_16x16x32_bf16 v[180:183], v[80:83], a[168:171], v[180:183]
s_waitcnt lgkmcnt(10)
ds_read_b64_tr_b16 a[236:237], v250 offset:12288
ds_read_b64_tr_b16 a[238:239], v250 offset:12800
v_mfma_f32_16x16x32_bf16 v[180:183], v[84:87], a[172:175], v[180:183]
s_waitcnt lgkmcnt(10)
ds_read_b64_tr_b16 a[240:241], v251 offset:0
ds_read_b64_tr_b16 a[242:243], v251 offset:512
v_mfma_f32_16x16x32_bf16 v[152:155], v[84:87], a[188:191], 0
s_waitcnt lgkmcnt(10)
ds_read_b64_tr_b16 a[244:245], v251 offset:4096
ds_read_b64_tr_b16 a[246:247], v251 offset:4608
v_mfma_f32_16x16x32_bf16 v[152:155], v[80:83], a[184:187], v[152:155]
s_waitcnt lgkmcnt(10)
ds_read_b64_tr_b16 a[248:249], v251 offset:8192
ds_read_b64_tr_b16 a[250:251], v251 offset:8704
v_mfma_f32_16x16x32_bf16 v[152:155], v[76:79], a[180:183], v[152:155]
s_waitcnt lgkmcnt(10)
ds_read_b64_tr_b16 a[252:253], v251 offset:12288
ds_read_b64_tr_b16 a[254:255], v251 offset:12800
v_mfma_f32_16x16x32_bf16 v[152:155], v[72:75], a[176:179], v[152:155]
s_waitcnt lgkmcnt(10)
ds_write_b128 v50, v[88:91] offset:0
ds_write_b128 v50, v[104:107] offset:4096
ds_write_b64 v51, v[156:157] offset:0
ds_write_b128 v50, v[92:95] offset:64
ds_write_b128 v50, v[108:111] offset:4160
ds_write_b64 v51, v[160:161] offset:128
v_cvt_pk_bf16_f32 v164, v164, v165
v_cvt_pk_bf16_f32 v165, v166, v167
v_cvt_pk_bf16_f32 v168, v168, v169
v_cvt_pk_bf16_f32 v169, v170, v171
v_cvt_pk_bf16_f32 v172, v172, v173
v_cvt_pk_bf16_f32 v173, v174, v175
v_cvt_pk_bf16_f32 v176, v176, v177
v_cvt_pk_bf16_f32 v177, v178, v179
v_cvt_pk_bf16_f32 v180, v180, v181
v_cvt_pk_bf16_f32 v181, v182, v183
v_cvt_pk_bf16_f32 v152, v152, v153
v_cvt_pk_bf16_f32 v153, v154, v155
v_mov_b32 v105, 0
v_mov_b32 v107, 0
v_mov_b32 v109, 0
v_mov_b32 v111, 0
v_mov_b32 v133, 0
v_mov_b32 v134, 0
v_mov_b32 v135, 0
v_mov_b32 v149, 0
v_mov_b32 v150, 0
v_mov_b32 v151, 0
v_mov_b32 v248, 1.0
v_mov_b32 v249, 1.0
v_mov_b32 v251, 1.0
ds_write_b64 v51, v[164:165] offset:256
ds_write_b64 v51, v[168:169] offset:384
ds_write_b128 v50, v[96:99] offset:2048
ds_write_b128 v50, v[112:115] offset:6144
ds_write_b64 v51, v[172:173] offset:2048
ds_write_b64 v51, v[176:177] offset:2176
s_waitcnt vmcnt(4)
s_barrier
ds_read_b128 v[200:203], v236 offset:8704
ds_read_b128 v[212:215], v236 offset:8448
ds_read_b128 v[224:227], v236 offset:8960
ds_read_b128 v[228:231], v236 offset:9216
ds_read_b128 v[192:195], v236 offset:13440
ds_read_b128 v[204:207], v236 offset:12928
ds_read_b128 v[208:211], v236 offset:12672
ds_write_b128 v50, v[100:103] offset:2112
ds_write_b128 v50, v[116:119] offset:6208
s_waitcnt lgkmcnt(8)
v_mfma_f32_16x16x32_bf16 v[184:187], a[68:71], v[200:203], 0
s_waitcnt lgkmcnt(6)
ds_write_b64 v51, v[180:181] offset:2304
v_mfma_f32_16x16x32_bf16 v[184:187], a[64:67], v[212:215], v[184:187]
s_waitcnt lgkmcnt(2)
ds_write_b64 v51, v[152:153] offset:2432
v_mfma_f32_16x16x32_bf16 v[184:187], a[72:75], v[224:227], v[184:187]
v_mfma_f32_16x16x32_bf16 v[184:187], a[76:79], v[228:231], v[184:187]
s_nop 2
v_mfma_f32_16x16x32_bf16 v[188:191], a[92:95], v[228:231], 0
s_nop 2
v_mfma_f32_16x16x32_bf16 v[188:191], a[88:91], v[224:227], v[188:191]
v_cvt_pk_bf16_f32 v16, v184, v185
v_cvt_pk_bf16_f32 v17, v186, v187
v_mfma_f32_16x16x32_bf16 v[188:191], a[84:87], v[200:203], v[188:191]
ds_read_b128 v[184:187], v236 offset:13184
v_mfma_f32_16x16x32_bf16 v[188:191], a[80:83], v[212:215], v[188:191]
s_nop 2
v_mfma_f32_16x16x32_bf16 v[196:199], a[96:99], v[212:215], 0
s_nop 2
v_mfma_f32_16x16x32_bf16 v[196:199], a[100:103], v[200:203], v[196:199]
v_cvt_pk_bf16_f32 v18, v188, v189
v_cvt_pk_bf16_f32 v19, v190, v191
v_mfma_f32_16x16x32_bf16 v[196:199], a[104:107], v[224:227], v[196:199]
v_mfma_f32_16x16x32_bf16 v[196:199], a[108:111], v[228:231], v[196:199]
s_nop 2
v_mfma_f32_16x16x32_bf16 v[188:191], a[124:127], v[228:231], 0
s_waitcnt lgkmcnt(0)
s_nop 1
v_mfma_f32_16x16x32_bf16 v[188:191], a[116:119], v[200:203], v[188:191]
v_cvt_pk_bf16_f32 v21, v198, v199
v_cvt_pk_bf16_f32 v20, v196, v197
v_mfma_f32_16x16x32_bf16 v[188:191], a[112:115], v[212:215], v[188:191]
v_mfma_f32_16x16x32_bf16 v[188:191], a[120:123], v[224:227], v[188:191]
s_nop 2
v_mfma_f32_16x16x32_bf16 v[196:199], a[120:123], v[184:187], 0
s_nop 2
v_mfma_f32_16x16x32_bf16 v[196:199], a[124:127], v[192:195], v[196:199]
v_cvt_pk_bf16_f32 v23, v190, v191
v_cvt_pk_bf16_f32 v22, v188, v189
v_mfma_f32_16x16x32_bf16 v[196:199], a[116:119], v[204:207], v[196:199]
v_mfma_f32_16x16x32_bf16 v[196:199], a[112:115], v[208:211], v[196:199]
s_nop 2
v_mfma_f32_16x16x32_bf16 v[188:191], a[96:99], v[208:211], 0
s_nop 2
v_mfma_f32_16x16x32_bf16 v[188:191], a[100:103], v[204:207], v[188:191]
v_cvt_pk_bf16_f32 v30, v196, v197
v_cvt_pk_bf16_f32 v31, v198, v199
v_mfma_f32_16x16x32_bf16 v[188:191], a[104:107], v[184:187], v[188:191]
v_mfma_f32_16x16x32_bf16 v[188:191], a[108:111], v[192:195], v[188:191]
s_nop 2
v_mfma_f32_16x16x32_bf16 v[212:215], a[92:95], v[192:195], 0
s_nop 2
v_mfma_f32_16x16x32_bf16 v[212:215], a[88:91], v[184:187], v[212:215]
v_cvt_pk_bf16_f32 v29, v190, v191
v_cvt_pk_bf16_f32 v28, v188, v189
v_mfma_f32_16x16x32_bf16 v[212:215], a[84:87], v[204:207], v[212:215]
v_mfma_f32_16x16x32_bf16 v[212:215], a[80:83], v[208:211], v[212:215]
s_nop 2
v_mfma_f32_16x16x32_bf16 v[188:191], a[64:67], v[208:211], 0
s_nop 2
v_mfma_f32_16x16x32_bf16 v[188:191], a[72:75], v[184:187], v[188:191]
v_cvt_pk_bf16_f32 v27, v214, v215
v_cvt_pk_bf16_f32 v26, v212, v213
v_mfma_f32_16x16x32_bf16 v[188:191], a[76:79], v[192:195], v[188:191]
s_waitcnt vmcnt(0)
s_barrier
v_mfma_f32_16x16x32_bf16 v[188:191], a[68:71], v[204:207], v[188:191]
s_mov_b32 s48, s50
ds_read_b128 v[196:199], v236 offset:17152
ds_read_b128 v[200:203], v236 offset:16896
ds_read_b128 v[216:219], v236 offset:17408
ds_read_b128 v[220:223], v236 offset:17664
ds_read_u16 v108, v241 offset:256
ds_read_b128 v[204:207], v236 offset:21376
ds_read_b128 v[208:211], v236 offset:21120
ds_read_b128 v[52:55], v240 offset:64
v_cvt_pk_bf16_f32 v24, v188, v189
v_cvt_pk_bf16_f32 v25, v190, v191
s_add_u32 m0, s49, 0
s_add_u32 s50, s50, 13107200
buffer_load_dwordx4 v237, s[16:19], s48 offen nt lds
ds_read_b128 v[192:195], v236 offset:21888
ds_read_b128 v[48:51], v240 offset:0
ds_read_u16 v110, v241 offset:384
v_add_u32 v240, 0x200, v240
s_add_u32 s48, s48, s51
s_add_u32 m0, s49, 2112
ds_read_u16 v106, v241 offset:128
buffer_load_dwordx4 v237, s[16:19], s48 offen nt lds
s_waitcnt lgkmcnt(11)
v_mfma_f32_16x16x32_bf16 v[184:187], a[68:71], v[196:199], 0
s_waitcnt lgkmcnt(9)
ds_read_u16 v104, v241 offset:0
s_add_u32 m0, s49, 4224
v_mfma_f32_16x16x32_bf16 v[184:187], a[64:67], v[200:203], v[184:187]
s_waitcnt lgkmcnt(6)
s_add_u32 s48, s48, s51
buffer_load_dwordx4 v237, s[16:19], s48 offen nt lds
v_mfma_f32_16x16x32_bf16 v[184:187], a[72:75], v[216:219], v[184:187]
s_add_u32 m0, s49, 6336
s_add_u32 s48, s48, s51
buffer_load_dwordx4 v237, s[16:19], s48 offen nt lds
v_mfma_f32_16x16x32_bf16 v[184:187], a[76:79], v[220:223], v[184:187]
s_add_u32 m0, s49, 8448
s_add_u32 s48, s48, s51
buffer_load_dwordx4 v237, s[16:19], s48 offen nt lds
v_mfma_f32_16x16x32_bf16 v[188:191], a[92:95], v[220:223], 0
s_add_u32 m0, s49, 10560
s_mov_b32 s47, s46
s_add_u32 s48, s48, s51
v_mfma_f32_16x16x32_bf16 v[188:191], a[88:91], v[216:219], v[188:191]
s_bfe_i32 s57, s3, 0x10000
buffer_load_dwordx4 v237, s[16:19], s48 offen nt lds
v_cvt_pk_bf16_f32 v32, v184, v185
v_mfma_f32_16x16x32_bf16 v[188:191], a[84:87], v[196:199], v[188:191]
s_and_b32 s54, s57, s5
v_cvt_pk_bf16_f32 v33, v186, v187
s_sub_u32 s45, s45, 1
v_mfma_f32_16x16x32_bf16 v[188:191], a[80:83], v[200:203], v[188:191]
s_sub_u32 s50, s50, s54
s_add_u32 s52, s46, 20480
s_lshr_b32 s3, s3, 1
v_mfma_f32_16x16x32_bf16 v[184:187], a[96:99], v[200:203], 0
s_waitcnt lgkmcnt(0)
s_nop 1
v_mfma_f32_16x16x32_bf16 v[184:187], a[100:103], v[196:199], v[184:187]
v_cvt_pk_bf16_f32 v35, v190, v191
v_cvt_pk_bf16_f32 v34, v188, v189
v_mfma_f32_16x16x32_bf16 v[184:187], a[104:107], v[216:219], v[184:187]
v_mfma_f32_16x16x32_bf16 v[184:187], a[108:111], v[220:223], v[184:187]
s_nop 2
v_mfma_f32_16x16x32_bf16 v[188:191], a[124:127], v[220:223], 0
s_nop 2
v_mfma_f32_16x16x32_bf16 v[188:191], a[120:123], v[216:219], v[188:191]
v_cvt_pk_bf16_f32 v37, v186, v187
v_cvt_pk_bf16_f32 v36, v184, v185
v_mfma_f32_16x16x32_bf16 v[188:191], a[116:119], v[196:199], v[188:191]
ds_read_b128 v[196:199], v236 offset:21632
v_mfma_f32_16x16x32_bf16 v[188:191], a[112:115], v[200:203], v[188:191]
s_nop 7
v_cvt_pk_bf16_f32 v39, v190, v191
v_cvt_pk_bf16_f32 v38, v188, v189
s_nop 7
s_waitcnt lgkmcnt(0)
s_branch L_entrys
.p2align 6
L_loops:
s_waitcnt vmcnt(8)
s_barrier
v_mfma_f32_16x16x32_bf16 v[176:179], a[224:227], v[220:223], 0
s_add_u32 s52, s47, 8192
v_exp_f32 v187, v187
v_mfma_f32_16x16x32_bf16 v[176:179], a[228:231], v[224:227], v[176:179]
s_add_u32 s53, s47, 12288
v_add_f32 v248, v184, v185
v_add_f32 v248, v248, v186
v_mfma_f32_16x16x32_bf16 v[176:179], a[232:235], v[212:215], v[176:179]
s_mov_b32 s47, s46
v_add_f32 v248, v248, v187
v_cvt_pk_bf16_f32 v120, v184, v185
v_mfma_f32_16x16x32_bf16 v[176:179], a[236:239], v[216:219], v[176:179]
s_bfe_i32 s57, s3, 0x10000
v_cvt_pk_bf16_f32 v121, v186, v187
v_sub_f32 v193, v193, v254
v_mfma_f32_16x16x32_bf16 v[180:183], a[252:255], v[216:219], 0
s_and_b32 s54, s57, s5
v_exp_f32 v188, v188
v_mfma_f32_16x16x32_bf16 v[180:183], a[248:251], v[212:215], v[180:183]
s_sub_u32 s45, s45, 1
v_exp_f32 v190, v190
v_mfma_f32_16x16x32_bf16 v[180:183], a[244:247], v[224:227], v[180:183]
s_lshr_b32 s3, s3, 1
v_sub_f32 v194, v194, v254
v_add_f32 v248, v248, v188
v_mfma_f32_16x16x32_bf16 v[180:183], a[240:243], v[220:223], v[180:183]
v_exp_f32 v189, v189
v_mfma_f32_16x16x32_bf16 v[212:215], v[0:3], v[112:115], 0
v_add_f32 v248, v248, v189
v_sub_f32 v191, v191, v254
v_mfma_f32_16x16x32_bf16 v[212:215], v[4:7], v[116:119], v[212:215]
v_exp_f32 v191, v191
v_mfma_f32_16x16x32_bf16 v[216:219], v[12:15], v[116:119], 0
v_sub_f32 v195, v195, v254
v_sub_f32 v192, v192, v254
v_mfma_f32_16x16x32_bf16 v[216:219], v[8:11], v[112:115], v[216:219]
v_exp_f32 v192, v192
v_mfma_f32_16x16x32_bf16 v[220:223], v[16:19], v[112:115], 0
v_exp_f32 v194, v194
v_mfma_f32_16x16x32_bf16 v[220:223], v[20:23], v[116:119], v[220:223]
v_exp_f32 v193, v193
v_mfma_f32_16x16x32_bf16 v[224:227], v[28:31], v[116:119], 0
v_add_f32 v248, v248, v190
v_add_f32 v248, v248, v191
v_mfma_f32_16x16x32_bf16 v[224:227], v[24:27], v[112:115], v[224:227]
v_exp_f32 v195, v195
v_mfma_f32_16x16x32_bf16 v[228:231], v[32:35], v[112:115], 0
v_add_f32 v248, v248, v192
v_add_f32 v248, v248, v193
v_mfma_f32_16x16x32_bf16 v[228:231], v[36:39], v[116:119], v[228:231]
v_add_f32 v248, v248, v194
v_add_f32 v248, v248, v195
v_mfma_f32_16x16x32_bf16 v[232:235], v[44:47], v[116:119], 0
v_cvt_pk_bf16_f32 v123, v190, v191
v_cvt_pk_bf16_f32 v122, v188, v189
v_mfma_f32_16x16x32_bf16 v[232:235], v[40:43], v[112:115], v[232:235]
s_mov_b32 s48, s50
ds_read_b128 v[188:191], v236 offset:0
v_cvt_pk_bf16_f32 v125, v194, v195
v_mfma_f32_16x16x32_bf16 v[184:187], v[48:51], v[112:115], 0
s_add_u32 m0, s49, 0
ds_read_b128 v[48:51], v240 offset:0
v_cvt_pk_bf16_f32 v124, v192, v193
v_mfma_f32_16x16x32_bf16 v[184:187], v[52:55], v[116:119], v[184:187]
s_add_u32 s50, s50, 13107200
buffer_load_dwordx4 v237, s[16:19], s48 offen nt lds
v_sub_f32 v196, v196, v254
v_sub_f32 v197, v197, v254
v_sub_f32 v199, v199, v254
v_sub_f32 v198, v198, v254
v_exp_f32 v196, v196
v_exp_f32 v197, v197
v_add_f32 v248, v248, v196
v_add_f32 v248, v248, v197
v_exp_f32 v198, v198
s_waitcnt lgkmcnt(1)
v_mfma_f32_16x16x32_bf16 v[192:195], a[64:67], v[188:191], 0
s_sub_u32 s50, s50, s54
ds_read_b128 v[52:55], v240 offset:64
v_exp_f32 v199, v199
v_add_f32 v248, v248, v198
v_add_f32 v248, v248, v199
v_cvt_pk_bf16_f32 v126, v196, v197
v_cvt_pk_bf16_f32 v127, v198, v199
ds_read_b128 v[196:199], v236 offset:256
v_sub_f32 v200, v200, v254
v_sub_f32 v203, v203, v254
v_sub_f32 v201, v201, v254
v_exp_f32 v201, v201
v_sub_f32 v202, v202, v254
v_exp_f32 v202, v202
v_exp_f32 v200, v200
v_exp_f32 v203, v203
v_add_f32 v248, v248, v200
v_add_f32 v248, v248, v201
v_add_f32 v248, v248, v202
v_add_f32 v248, v248, v203
v_cvt_pk_bf16_f32 v128, v200, v201
v_cvt_pk_bf16_f32 v129, v202, v203
v_sub_f32 v204, v204, v254
v_sub_f32 v205, v205, v254
s_waitcnt lgkmcnt(0)
v_mfma_f32_16x16x32_bf16 v[192:195], a[68:71], v[196:199], v[192:195]
ds_read_b128 v[200:203], v236 offset:512
v_exp_f32 v204, v204
v_sub_f32 v206, v206, v254
v_add_f32 v248, v248, v204
v_exp_f32 v206, v206
v_sub_f32 v207, v207, v254
v_exp_f32 v205, v205
v_exp_f32 v207, v207
v_add_f32 v248, v248, v205
v_cvt_pk_bf16_f32 v130, v204, v205
v_add_f32 v248, v248, v206
v_add_f32 v248, v248, v207
v_cvt_pk_bf16_f32 v131, v206, v207
v_sub_f32 v208, v208, v254
v_exp_f32 v208, v208
v_max3_f32 v254, v212, v213, v214
s_waitcnt lgkmcnt(0)
v_mfma_f32_16x16x32_bf16 v[192:195], a[72:75], v[200:203], v[192:195]
ds_read_b128 v[204:207], v236 offset:768
v_add_f32 v248, v248, v208
v_cvt_pk_bf16_f32 v132, v208, 0
v_max3_f32 v254, v254, v215, v216
v_max3_f32 v254, v254, v217, v218
v_max3_f32 v254, v254, v219, v220
v_max3_f32 v254, v254, v221, v222
v_max3_f32 v254, v254, v223, v224
v_max3_f32 v254, v254, v225, v226
v_max3_f32 v254, v254, v227, v228
v_max3_f32 v254, v254, v229, v230
v_max3_f32 v254, v254, v231, v232
v_max3_f32 v254, v254, v233, v234
v_max3_f32 v254, v254, v235, v184
v_add_u32 v240, 0x200, v240
ds_swizzle_b32 v250, v248 offset:0x401F
ds_swizzle_b32 v255, v254 offset:0x401F
s_waitcnt lgkmcnt(2)
v_mfma_f32_16x16x32_bf16 v[192:195], a[76:79], v[204:207], v[192:195]
s_nop 2
v_mfma_f32_16x16x32_bf16 v[208:211], a[92:95], v[204:207], 0
s_nop 2
v_mfma_f32_16x16x32_bf16 v[208:211], a[88:91], v[200:203], v[208:211]
v_cvt_pk_bf16_f32 v0, v192, v193
v_cvt_pk_bf16_f32 v1, v194, v195
v_mfma_f32_16x16x32_bf16 v[208:211], a[84:87], v[196:199], v[208:211]
v_mfma_f32_16x16x32_bf16 v[208:211], a[80:83], v[188:191], v[208:211]
s_waitcnt lgkmcnt(0)
v_add_f32 v248, v248, v250
v_max_f32 v254, v254, v255
v_mfma_f32_16x16x32_bf16 v[192:195], a[96:99], v[188:191], 0
ds_bpermute_b32 v250, v247, v248
v_mfma_f32_16x16x32_bf16 v[192:195], a[100:103], v[196:199], v[192:195]
ds_bpermute_b32 v255, v247, v254
v_mfma_f32_16x16x32_bf16 v[192:195], a[104:107], v[200:203], v[192:195]
v_cvt_pk_bf16_f32 v2, v208, v209
v_cvt_pk_bf16_f32 v3, v210, v211
v_mfma_f32_16x16x32_bf16 v[192:195], a[108:111], v[204:207], v[192:195]
s_nop 2
v_mfma_f32_16x16x32_bf16 v[208:211], a[124:127], v[204:207], 0
s_nop 2
v_mfma_f32_16x16x32_bf16 v[208:211], a[120:123], v[200:203], v[208:211]
v_cvt_pk_bf16_f32 v5, v194, v195
v_cvt_pk_bf16_f32 v4, v192, v193
v_mfma_f32_16x16x32_bf16 v[208:211], a[116:119], v[196:199], v[208:211]
s_waitcnt lgkmcnt(1)
v_add_f32 v248, v248, v250
v_mfma_f32_16x16x32_bf16 v[208:211], a[112:115], v[188:191], v[208:211]
s_waitcnt lgkmcnt(0)
v_rcp_f32 v251, v248
v_mfma_f32_16x16x32_bf16 v[188:191], v[56:59], v[120:123], 0
v_max_f32 v254, v254, v255
v_sub_f32 v214, v214, v254
v_mfma_f32_16x16x32_bf16 v[188:191], v[104:107], v[132:135], v[188:191]
s_add_u32 s48, s48, s51
v_sub_f32 v215, v215, v254
v_cvt_pk_bf16_f32 v6, v208, v209
v_mfma_f32_16x16x32_bf16 v[188:191], v[72:75], v[124:127], v[188:191]
s_add_u32 m0, s49, 2112
v_cvt_pk_bf16_f32 v7, v210, v211
v_sub_f32 v212, v212, v254
v_mfma_f32_16x16x32_bf16 v[188:191], v[88:91], v[128:131], v[188:191]
buffer_load_dwordx4 v237, s[16:19], s48 offen nt lds
v_sub_f32 v213, v213, v254
v_mfma_f32_16x16x32_bf16 v[196:199], v[92:95], v[128:131], 0
v_exp_f32 v212, v212
v_mfma_f32_16x16x32_bf16 v[196:199], v[76:79], v[124:127], v[196:199]
v_exp_f32 v214, v214
v_mfma_f32_16x16x32_bf16 v[196:199], v[106:109], v[132:135], v[196:199]
v_exp_f32 v213, v213
v_mfma_f32_16x16x32_bf16 v[196:199], v[60:63], v[120:123], v[196:199]
ds_read_b128 v[204:207], v236 offset:4480
v_sub_f32 v216, v216, v254
v_mfma_f32_16x16x32_bf16 v[200:203], v[64:67], v[120:123], 0
ds_read_b128 v[192:195], v236 offset:4224
v_sub_f32 v217, v217, v254
v_mfma_f32_16x16x32_bf16 v[200:203], v[108:111], v[132:135], v[200:203]
v_exp_f32 v215, v215
v_mfma_f32_16x16x32_bf16 v[200:203], v[80:83], v[124:127], v[200:203]
v_exp_f32 v217, v217
v_mfma_f32_16x16x32_bf16 v[200:203], v[96:99], v[128:131], v[200:203]
v_sub_f32 v218, v218, v254
v_add_f32 v249, v212, v213
v_mfma_f32_16x16x32_bf16 v[208:211], v[100:103], v[128:131], 0
v_add_f32 v249, v249, v214
v_add_f32 v249, v249, v215
v_mfma_f32_16x16x32_bf16 v[208:211], v[84:87], v[124:127], v[208:211]
s_waitcnt lgkmcnt(1)
v_exp_f32 v216, v216
v_mfma_f32_16x16x32_bf16 v[208:211], v[110:113], v[132:135], v[208:211]
s_waitcnt lgkmcnt(0)
v_sub_f32 v219, v219, v254
v_sub_f32 v220, v220, v254
v_mfma_f32_16x16x32_bf16 v[208:211], v[68:71], v[120:123], v[208:211]
v_exp_f32 v218, v218
v_sub_f32 v223, v223, v254
v_add_f32 v249, v249, v216
v_add_f32 v249, v249, v217
v_exp_f32 v219, v219
v_add_f32 v249, v249, v218
v_add_f32 v249, v249, v219
v_exp_f32 v220, v220
v_sub_f32 v224, v224, v254
v_exp_f32 v223, v223
v_sub_f32 v221, v221, v254
v_exp_f32 v224, v224
v_exp_f32 v221, v221
v_sub_f32 v222, v222, v254
v_sub_f32 v225, v225, v254
v_add_f32 v249, v249, v220
v_add_f32 v249, v249, v221
v_exp_f32 v222, v222
v_exp_f32 v225, v225
v_add_f32 v249, v249, v222
v_add_f32 v249, v249, v223
v_add_f32 v249, v249, v224
v_sub_f32 v226, v226, v254
v_add_f32 v249, v249, v225
v_exp_f32 v226, v226
v_sub_f32 v227, v227, v254
v_exp_f32 v227, v227
v_sub_f32 v228, v228, v254
v_exp_f32 v228, v228
v_add_f32 v249, v249, v226
v_sub_f32 v232, v232, v254
v_sub_f32 v229, v229, v254
v_sub_f32 v230, v230, v254
v_exp_f32 v230, v230
v_exp_f32 v229, v229
v_add_f32 v249, v249, v227
v_add_f32 v249, v249, v228
v_add_f32 v249, v249, v229
v_exp_f32 v232, v232
v_sub_f32 v233, v233, v254
v_exp_f32 v233, v233
v_sub_f32 v231, v231, v254
v_exp_f32 v231, v231
v_sub_f32 v234, v234, v254
v_sub_f32 v235, v235, v254
v_add_f32 v249, v249, v230
v_add_f32 v249, v249, v231
v_add_f32 v249, v249, v232
v_exp_f32 v234, v234
v_exp_f32 v235, v235
v_sub_f32 v184, v184, v254
v_exp_f32 v184, v184
v_add_f32 v249, v249, v233
v_cvt_pk_bf16_f32 v148, v184, 0
v_add_f32 v249, v249, v234
v_add_f32 v249, v249, v235
v_add_f32 v249, v249, v184
v_fmac_f32 v161, v201, v251
v_fmac_f32 v163, v203, v251
v_fmac_f32 v160, v200, v251
v_fmac_f32 v162, v202, v251
ds_read_b128 v[184:187], v236 offset:4992
v_cvt_pk_bf16_f32 v138, v216, v217
v_cvt_pk_bf16_f32 v139, v218, v219
v_fmac_f32 v167, v211, v251
v_fmac_f32 v165, v209, v251
v_fmac_f32 v166, v210, v251
v_fmac_f32 v164, v208, v251
v_cvt_pk_bf16_f32 v140, v220, v221
v_cvt_pk_bf16_f32 v141, v222, v223
v_fmac_f32 v155, v191, v251
v_fmac_f32 v154, v190, v251
v_fmac_f32 v152, v188, v251
v_fmac_f32 v153, v189, v251
v_cvt_pk_bf16_f32 v137, v214, v215
v_cvt_pk_bf16_f32 v136, v212, v213
v_cvt_pk_bf16_f32 v143, v226, v227
v_cvt_pk_bf16_f32 v142, v224, v225
v_cvt_pk_bf16_f32 v145, v230, v231
v_cvt_pk_bf16_f32 v144, v228, v229
v_fmac_f32 v156, v196, v251
v_fmac_f32 v157, v197, v251
s_waitcnt lgkmcnt(0)
v_mfma_f32_16x16x32_bf16 v[200:203], a[124:127], v[184:187], 0
ds_read_b128 v[216:219], v236 offset:4736
v_fmac_f32 v158, v198, v251
v_fmac_f32 v159, v199, v251
v_cvt_pk_bf16_f32 v147, v234, v235
v_cvt_pk_bf16_f32 v146, v232, v233
v_cvt_pk_bf16_f32 v160, v160, v161
v_cvt_pk_bf16_f32 v161, v162, v163
v_cvt_pk_bf16_f32 v163, v166, v167
v_cvt_pk_bf16_f32 v162, v164, v165
v_cvt_pk_bf16_f32 v152, v152, v153
v_cvt_pk_bf16_f32 v153, v154, v155
v_pk_max_i16 v160, v160, 0
v_pk_max_i16 v162, v162, 0
v_pk_max_i16 v153, v153, 0
v_pk_max_i16 v161, v161, 0
v_pk_max_i16 v163, v163, 0
v_cvt_pk_bf16_f32 v155, v158, v159
v_pk_max_i16 v155, v155, 0
v_pk_max_i16 v152, v152, 0
v_cvt_pk_bf16_f32 v154, v156, v157
v_pk_max_i16 v154, v154, 0
s_waitcnt lgkmcnt(0)
v_mfma_f32_16x16x32_bf16 v[200:203], a[120:123], v[216:219], v[200:203]
ds_swizzle_b32 v250, v249 offset:0x401F
buffer_store_dwordx4 v[152:155], v239, s[20:23], s52 offen offset:0 nt
buffer_store_dwordx4 v[160:163], v239, s[20:23], s52 offen offset:64 nt
s_add_u32 s52, s46, 20480
v_mfma_f32_16x16x32_bf16 v[200:203], a[116:119], v[204:207], v[200:203]
v_mfma_f32_16x16x32_bf16 v[200:203], a[112:115], v[192:195], v[200:203]
s_nop 2
v_mfma_f32_16x16x32_bf16 v[208:211], a[96:99], v[192:195], 0
s_waitcnt lgkmcnt(0)
v_add_f32 v249, v249, v250
v_mfma_f32_16x16x32_bf16 v[208:211], a[100:103], v[204:207], v[208:211]
s_add_u32 m0, s49, 4224
ds_bpermute_b32 v250, v247, v249
v_mfma_f32_16x16x32_bf16 v[208:211], a[104:107], v[216:219], v[208:211]
s_add_u32 s48, s48, s51
buffer_load_dwordx4 v237, s[16:19], s48 offen nt lds
v_cvt_pk_bf16_f32 v14, v200, v201
v_mfma_f32_16x16x32_bf16 v[208:211], a[108:111], v[184:187], v[208:211]
ds_read_b128 v[212:215], v236 offset:8448
v_cvt_pk_bf16_f32 v15, v202, v203
v_mfma_f32_16x16x32_bf16 v[220:223], a[92:95], v[184:187], 0
ds_read_b128 v[200:203], v236 offset:8704
ds_read_b128 v[224:227], v236 offset:8960
v_mfma_f32_16x16x32_bf16 v[220:223], a[88:91], v[216:219], v[220:223]
ds_read_b128 v[228:231], v236 offset:9216
v_mfma_f32_16x16x32_bf16 v[220:223], a[84:87], v[204:207], v[220:223]
v_cvt_pk_bf16_f32 v13, v210, v211
v_cvt_pk_bf16_f32 v12, v208, v209
v_mfma_f32_16x16x32_bf16 v[220:223], a[80:83], v[192:195], v[220:223]
s_waitcnt lgkmcnt(4)
v_add_f32 v249, v249, v250
s_nop 0
v_mfma_f32_16x16x32_bf16 v[188:191], a[64:67], v[192:195], 0
v_rcp_f32 v252, v249
v_mfma_f32_16x16x32_bf16 v[188:191], a[72:75], v[216:219], v[188:191]
s_waitcnt lgkmcnt(3)
s_nop 0
v_cvt_pk_bf16_f32 v10, v220, v221
v_mfma_f32_16x16x32_bf16 v[188:191], a[76:79], v[184:187], v[188:191]
s_waitcnt lgkmcnt(1)
v_cvt_pk_bf16_f32 v11, v222, v223
v_mfma_f32_16x16x32_bf16 v[188:191], a[68:71], v[204:207], v[188:191]
s_waitcnt lgkmcnt(0)
s_nop 1
v_mfma_f32_16x16x32_bf16 v[184:187], a[68:71], v[200:203], 0
s_nop 2
v_mfma_f32_16x16x32_bf16 v[184:187], a[64:67], v[212:215], v[184:187]
v_cvt_pk_bf16_f32 v9, v190, v191
v_cvt_pk_bf16_f32 v8, v188, v189
v_mfma_f32_16x16x32_bf16 v[184:187], a[72:75], v[224:227], v[184:187]
v_mfma_f32_16x16x32_bf16 v[184:187], a[76:79], v[228:231], v[184:187]
s_nop 2
v_mfma_f32_16x16x32_bf16 v[188:191], a[92:95], v[228:231], 0
s_nop 2
v_mfma_f32_16x16x32_bf16 v[188:191], a[88:91], v[224:227], v[188:191]
v_cvt_pk_bf16_f32 v16, v184, v185
v_cvt_pk_bf16_f32 v17, v186, v187
v_mfma_f32_16x16x32_bf16 v[188:191], a[84:87], v[200:203], v[188:191]
v_mfma_f32_16x16x32_bf16 v[188:191], a[80:83], v[212:215], v[188:191]
ds_read_b128 v[184:187], v236 offset:13184
ds_read_b128 v[192:195], v236 offset:13440
v_mfma_f32_16x16x32_bf16 v[196:199], a[96:99], v[212:215], 0
ds_read_b128 v[204:207], v236 offset:12928
ds_read_b128 v[208:211], v236 offset:12672
v_mfma_f32_16x16x32_bf16 v[196:199], a[100:103], v[200:203], v[196:199]
s_add_u32 m0, s49, 6336
s_add_u32 s48, s48, s51
v_cvt_pk_bf16_f32 v18, v188, v189
v_mfma_f32_16x16x32_bf16 v[196:199], a[104:107], v[224:227], v[196:199]
buffer_load_dwordx4 v237, s[16:19], s48 offen nt lds
v_cvt_pk_bf16_f32 v19, v190, v191
v_mfma_f32_16x16x32_bf16 v[196:199], a[108:111], v[228:231], v[196:199]
s_nop 2
v_mfma_f32_16x16x32_bf16 v[188:191], a[124:127], v[228:231], 0
s_nop 2
v_mfma_f32_16x16x32_bf16 v[188:191], a[116:119], v[200:203], v[188:191]
s_waitcnt lgkmcnt(2)
v_cvt_pk_bf16_f32 v21, v198, v199
v_cvt_pk_bf16_f32 v20, v196, v197
v_mfma_f32_16x16x32_bf16 v[188:191], a[112:115], v[212:215], v[188:191]
s_waitcnt lgkmcnt(0)
v_mfma_f32_16x16x32_bf16 v[188:191], a[120:123], v[224:227], v[188:191]
s_nop 2
v_mfma_f32_16x16x32_bf16 v[196:199], a[120:123], v[184:187], 0
s_nop 2
v_mfma_f32_16x16x32_bf16 v[196:199], a[124:127], v[192:195], v[196:199]
v_cvt_pk_bf16_f32 v23, v190, v191
v_cvt_pk_bf16_f32 v22, v188, v189
v_mfma_f32_16x16x32_bf16 v[196:199], a[116:119], v[204:207], v[196:199]
v_mfma_f32_16x16x32_bf16 v[196:199], a[112:115], v[208:211], v[196:199]
s_nop 2
v_mfma_f32_16x16x32_bf16 v[188:191], a[96:99], v[208:211], 0
s_nop 2
v_mfma_f32_16x16x32_bf16 v[188:191], a[100:103], v[204:207], v[188:191]
v_cvt_pk_bf16_f32 v30, v196, v197
v_cvt_pk_bf16_f32 v31, v198, v199
v_mfma_f32_16x16x32_bf16 v[188:191], a[104:107], v[184:187], v[188:191]
v_mfma_f32_16x16x32_bf16 v[188:191], a[108:111], v[192:195], v[188:191]
ds_read_b128 v[196:199], v236 offset:17152
ds_read_b128 v[200:203], v236 offset:16896
v_mfma_f32_16x16x32_bf16 v[212:215], a[92:95], v[192:195], 0
ds_read_b128 v[216:219], v236 offset:17408
ds_read_b128 v[220:223], v236 offset:17664
v_mfma_f32_16x16x32_bf16 v[212:215], a[88:91], v[184:187], v[212:215]
s_nop 1
v_cvt_pk_bf16_f32 v29, v190, v191
v_mfma_f32_16x16x32_bf16 v[212:215], a[84:87], v[204:207], v[212:215]
v_cvt_pk_bf16_f32 v28, v188, v189
v_mfma_f32_16x16x32_bf16 v[212:215], a[80:83], v[208:211], v[212:215]
s_nop 2
v_mfma_f32_16x16x32_bf16 v[188:191], a[64:67], v[208:211], 0
s_nop 2
v_mfma_f32_16x16x32_bf16 v[188:191], a[72:75], v[184:187], v[188:191]
s_add_u32 m0, s49, 8448
v_cvt_pk_bf16_f32 v27, v214, v215
v_cvt_pk_bf16_f32 v26, v212, v213
v_mfma_f32_16x16x32_bf16 v[188:191], a[76:79], v[192:195], v[188:191]
s_add_u32 s48, s48, s51
buffer_load_dwordx4 v237, s[16:19], s48 offen nt lds
v_mfma_f32_16x16x32_bf16 v[188:191], a[68:71], v[204:207], v[188:191]
s_waitcnt lgkmcnt(0)
s_nop 1
v_mfma_f32_16x16x32_bf16 v[184:187], a[68:71], v[196:199], 0
s_nop 2
v_mfma_f32_16x16x32_bf16 v[184:187], a[64:67], v[200:203], v[184:187]
v_cvt_pk_bf16_f32 v24, v188, v189
v_cvt_pk_bf16_f32 v25, v190, v191
v_mfma_f32_16x16x32_bf16 v[184:187], a[72:75], v[216:219], v[184:187]
v_mfma_f32_16x16x32_bf16 v[184:187], a[76:79], v[220:223], v[184:187]
s_nop 2
v_mfma_f32_16x16x32_bf16 v[188:191], a[92:95], v[220:223], 0
s_nop 2
v_mfma_f32_16x16x32_bf16 v[188:191], a[88:91], v[216:219], v[188:191]
v_cvt_pk_bf16_f32 v32, v184, v185
v_cvt_pk_bf16_f32 v33, v186, v187
v_mfma_f32_16x16x32_bf16 v[188:191], a[84:87], v[196:199], v[188:191]
v_mfma_f32_16x16x32_bf16 v[188:191], a[80:83], v[200:203], v[188:191]
s_nop 2
v_mfma_f32_16x16x32_bf16 v[184:187], a[96:99], v[200:203], 0
s_nop 2
v_mfma_f32_16x16x32_bf16 v[184:187], a[100:103], v[196:199], v[184:187]
v_cvt_pk_bf16_f32 v35, v190, v191
v_cvt_pk_bf16_f32 v34, v188, v189
v_mfma_f32_16x16x32_bf16 v[184:187], a[104:107], v[216:219], v[184:187]
v_mfma_f32_16x16x32_bf16 v[184:187], a[108:111], v[220:223], v[184:187]
s_nop 2
v_mfma_f32_16x16x32_bf16 v[188:191], a[124:127], v[220:223], 0
s_nop 2
v_mfma_f32_16x16x32_bf16 v[188:191], a[120:123], v[216:219], v[188:191]
v_cvt_pk_bf16_f32 v37, v186, v187
v_cvt_pk_bf16_f32 v36, v184, v185
v_mfma_f32_16x16x32_bf16 v[188:191], a[116:119], v[196:199], v[188:191]
v_mfma_f32_16x16x32_bf16 v[188:191], a[112:115], v[200:203], v[188:191]
s_nop 2
v_mfma_f32_16x16x32_bf16 v[184:187], v[56:59], v[136:139], 0
s_nop 2
v_mfma_f32_16x16x32_bf16 v[184:187], v[104:107], v[148:151], v[184:187]
s_add_u32 m0, s49, 10560
ds_read_u16 v104, v241 offset:0
v_cvt_pk_bf16_f32 v39, v190, v191
v_mfma_f32_16x16x32_bf16 v[184:187], v[72:75], v[140:143], v[184:187]
s_add_u32 s48, s48, s51
buffer_load_dwordx4 v237, s[16:19], s48 offen nt lds
v_cvt_pk_bf16_f32 v38, v188, v189
v_mfma_f32_16x16x32_bf16 v[184:187], v[88:91], v[144:147], v[184:187]
s_nop 2
v_mfma_f32_16x16x32_bf16 v[188:191], v[92:95], v[144:147], 0
s_nop 2
v_mfma_f32_16x16x32_bf16 v[188:191], v[76:79], v[140:143], v[188:191]
v_fmac_f32 v170, v186, v252
v_fmac_f32 v168, v184, v252
v_mfma_f32_16x16x32_bf16 v[188:191], v[106:109], v[148:151], v[188:191]
ds_read_u16 v106, v241 offset:128
v_fmac_f32 v171, v187, v252
v_mfma_f32_16x16x32_bf16 v[188:191], v[60:63], v[136:139], v[188:191]
s_waitcnt lgkmcnt(1)
ds_read_b128 v[192:195], v236 offset:21888
v_fmac_f32 v169, v185, v252
v_mfma_f32_16x16x32_bf16 v[200:203], v[64:67], v[136:139], 0
ds_read_b128 v[196:199], v236 offset:21632
ds_read_b128 v[204:207], v236 offset:21376
v_mfma_f32_16x16x32_bf16 v[200:203], v[108:111], v[148:151], v[200:203]
ds_read_b128 v[208:211], v236 offset:21120
v_fmac_f32 v174, v190, v252
v_mfma_f32_16x16x32_bf16 v[200:203], v[80:83], v[140:143], v[200:203]
ds_read_u16 v108, v241 offset:256
v_fmac_f32 v175, v191, v252
v_mfma_f32_16x16x32_bf16 v[200:203], v[96:99], v[144:147], v[200:203]
v_fmac_f32 v172, v188, v252
v_fmac_f32 v173, v189, v252
v_mfma_f32_16x16x32_bf16 v[184:187], v[100:103], v[144:147], 0
s_waitcnt lgkmcnt(5)
v_cvt_pk_bf16_f32 v168, v168, v169
v_cvt_pk_bf16_f32 v169, v170, v171
v_mfma_f32_16x16x32_bf16 v[184:187], v[84:87], v[140:143], v[184:187]
s_waitcnt lgkmcnt(4)
v_fmac_f32 v178, v202, v252
v_fmac_f32 v176, v200, v252
v_mfma_f32_16x16x32_bf16 v[184:187], v[110:113], v[148:151], v[184:187]
s_waitcnt lgkmcnt(2)
ds_read_u16 v110, v241 offset:384
v_fmac_f32 v177, v201, v252
v_mfma_f32_16x16x32_bf16 v[184:187], v[68:71], v[136:139], v[184:187]
L_entrys:
s_waitcnt lgkmcnt(2)
v_fmac_f32 v179, v203, v252
v_cvt_pk_bf16_f32 v176, v176, v177
v_mfma_f32_16x16x32_bf16 v[188:191], a[124:127], v[192:195], 0
s_waitcnt lgkmcnt(1)
v_cvt_pk_bf16_f32 v177, v178, v179
v_cvt_pk_bf16_f32 v171, v174, v175
v_mfma_f32_16x16x32_bf16 v[188:191], a[120:123], v[196:199], v[188:191]
v_fmac_f32 v180, v184, v252
v_fmac_f32 v181, v185, v252
v_mfma_f32_16x16x32_bf16 v[188:191], a[116:119], v[204:207], v[188:191]
v_fmac_f32 v183, v187, v252
v_fmac_f32 v182, v186, v252
v_mfma_f32_16x16x32_bf16 v[188:191], a[112:115], v[208:211], v[188:191]
v_cvt_pk_bf16_f32 v178, v180, v181
v_cvt_pk_bf16_f32 v170, v172, v173
v_mfma_f32_16x16x32_bf16 v[184:187], a[96:99], v[208:211], 0
s_waitcnt lgkmcnt(0)
v_cvt_pk_bf16_f32 v179, v182, v183
v_pk_max_i16 v168, v168, 0
v_mfma_f32_16x16x32_bf16 v[184:187], a[100:103], v[204:207], v[184:187]
s_add_u32 s48, s48, s51
v_cvt_pk_bf16_f32 v46, v188, v189
v_cvt_pk_bf16_f32 v47, v190, v191
v_mfma_f32_16x16x32_bf16 v[184:187], a[104:107], v[196:199], v[184:187]
s_add_u32 m0, s49, 12672
v_pk_max_i16 v176, v176, 0
v_pk_max_i16 v170, v170, 0
v_mfma_f32_16x16x32_bf16 v[184:187], a[108:111], v[192:195], v[184:187]
buffer_load_dwordx4 v237, s[16:19], s48 offen nt lds
v_pk_max_i16 v179, v179, 0
v_mfma_f32_16x16x32_bf16 v[188:191], a[92:95], v[192:195], 0
v_pk_max_i16 v178, v178, 0
v_pk_max_i16 v169, v169, 0
v_mfma_f32_16x16x32_bf16 v[188:191], a[88:91], v[196:199], v[188:191]
v_pk_max_i16 v177, v177, 0
v_pk_max_i16 v171, v171, 0
v_mfma_f32_16x16x32_bf16 v[188:191], a[84:87], v[204:207], v[188:191]
buffer_store_dwordx4 v[168:171], v239, s[20:23], s53 offen offset:0 nt
buffer_store_dwordx4 v[176:179], v239, s[20:23], s53 offen offset:64 nt
v_cvt_pk_bf16_f32 v44, v184, v185
v_cvt_pk_bf16_f32 v45, v186, v187
v_add_u32 v241, 0x200, v241
s_add_u32 s53, s46, 0
v_mfma_f32_16x16x32_bf16 v[188:191], a[80:83], v[208:211], v[188:191]
s_nop 2
v_mfma_f32_16x16x32_bf16 v[184:187], a[64:67], v[208:211], 0
s_nop 2
v_mfma_f32_16x16x32_bf16 v[184:187], a[72:75], v[196:199], v[184:187]
v_cvt_pk_bf16_f32 v42, v188, v189
v_cvt_pk_bf16_f32 v43, v190, v191
v_mfma_f32_16x16x32_bf16 v[184:187], a[76:79], v[192:195], v[184:187]
v_mfma_f32_16x16x32_bf16 v[184:187], a[68:71], v[204:207], v[184:187]
s_nop 2
v_mfma_f32_16x16x32_bf16 v[188:191], a[4:7], v[204:207], 0
s_nop 2
v_mfma_f32_16x16x32_bf16 v[188:191], a[0:3], v[208:211], v[188:191]
v_cvt_pk_bf16_f32 v41, v186, v187
v_cvt_pk_bf16_f32 v40, v184, v185
v_mfma_f32_16x16x32_bf16 v[188:191], a[8:11], v[196:199], v[188:191]
v_mfma_f32_16x16x32_bf16 v[188:191], a[12:15], v[192:195], v[188:191]
s_nop 2
v_mfma_f32_16x16x32_bf16 v[184:187], a[28:31], v[192:195], 0
s_nop 2
v_mfma_f32_16x16x32_bf16 v[184:187], a[24:27], v[196:199], v[184:187]
v_cvt_pk_bf16_f32 v112, v188, v189
v_cvt_pk_bf16_f32 v113, v190, v191
v_mfma_f32_16x16x32_bf16 v[184:187], a[20:23], v[204:207], v[184:187]
v_mfma_f32_16x16x32_bf16 v[184:187], a[16:19], v[208:211], v[184:187]
s_nop 2
v_mfma_f32_16x16x32_bf16 v[188:191], a[32:35], v[208:211], 0
s_nop 2
v_mfma_f32_16x16x32_bf16 v[188:191], a[36:39], v[204:207], v[188:191]
s_add_u32 m0, s49, 14784
v_cvt_pk_bf16_f32 v114, v184, v185
v_cvt_pk_bf16_f32 v115, v186, v187
v_mfma_f32_16x16x32_bf16 v[188:191], a[40:43], v[196:199], v[188:191]
s_add_u32 s48, s48, s51
buffer_load_dwordx4 v237, s[16:19], s48 offen nt lds
v_mfma_f32_16x16x32_bf16 v[188:191], a[44:47], v[192:195], v[188:191]
s_nop 2
v_mfma_f32_16x16x32_bf16 v[184:187], a[60:63], v[192:195], 0
s_nop 2
v_mfma_f32_16x16x32_bf16 v[184:187], a[56:59], v[196:199], v[184:187]
v_cvt_pk_bf16_f32 v116, v188, v189
v_cvt_pk_bf16_f32 v117, v190, v191
v_mfma_f32_16x16x32_bf16 v[184:187], a[52:55], v[204:207], v[184:187]
v_mfma_f32_16x16x32_bf16 v[184:187], a[48:51], v[208:211], v[184:187]
s_nop 2
v_mfma_f32_16x16x32_bf16 v[152:155], a[192:195], v[208:211], 0
s_nop 2
v_mfma_f32_16x16x32_bf16 v[152:155], a[196:199], v[204:207], v[152:155]
v_cvt_pk_bf16_f32 v118, v184, v185
v_cvt_pk_bf16_f32 v119, v186, v187
v_mfma_f32_16x16x32_bf16 v[152:155], a[200:203], v[196:199], v[152:155]
v_mfma_f32_16x16x32_bf16 v[152:155], a[204:207], v[192:195], v[152:155]
v_mfma_f32_16x16x32_bf16 v[156:159], a[220:223], v[192:195], 0
v_mfma_f32_16x16x32_bf16 v[156:159], a[216:219], v[196:199], v[156:159]
v_mfma_f32_16x16x32_bf16 v[156:159], a[212:215], v[204:207], v[156:159]
v_mfma_f32_16x16x32_bf16 v[156:159], a[208:211], v[208:211], v[156:159]
v_mfma_f32_16x16x32_bf16 v[160:163], a[224:227], v[208:211], 0
v_mfma_f32_16x16x32_bf16 v[160:163], a[228:231], v[204:207], v[160:163]
v_mfma_f32_16x16x32_bf16 v[160:163], a[232:235], v[196:199], v[160:163]
v_mfma_f32_16x16x32_bf16 v[160:163], a[236:239], v[192:195], v[160:163]
v_mfma_f32_16x16x32_bf16 v[164:167], a[252:255], v[192:195], 0
v_mfma_f32_16x16x32_bf16 v[164:167], a[248:251], v[196:199], v[164:167]
s_add_u32 s48, s48, s51
s_add_u32 m0, s49, 16896
v_mfma_f32_16x16x32_bf16 v[164:167], a[244:247], v[204:207], v[164:167]
buffer_load_dwordx4 v237, s[16:19], s48 offen nt lds
v_mfma_f32_16x16x32_bf16 v[164:167], a[240:243], v[208:211], v[164:167]
v_mfma_f32_16x16x32_bf16 v[184:187], v[0:3], v[112:115], 0
v_mfma_f32_16x16x32_bf16 v[184:187], v[4:7], v[116:119], v[184:187]
s_nop 2
v_mfma_f32_16x16x32_bf16 v[188:191], v[12:15], v[116:119], 0
s_nop 2
v_mfma_f32_16x16x32_bf16 v[188:191], v[8:11], v[112:115], v[188:191]
v_max3_f32 v254, v184, v185, v186
s_nop 0
v_mfma_f32_16x16x32_bf16 v[200:203], v[16:19], v[112:115], 0
s_nop 2
v_mfma_f32_16x16x32_bf16 v[200:203], v[20:23], v[116:119], v[200:203]
s_nop 0
v_max3_f32 v254, v254, v187, v188
v_max3_f32 v254, v254, v189, v190
v_mfma_f32_16x16x32_bf16 v[212:215], v[28:31], v[116:119], 0
s_nop 2
v_mfma_f32_16x16x32_bf16 v[212:215], v[24:27], v[112:115], v[212:215]
v_max3_f32 v254, v254, v191, v200
v_max3_f32 v254, v254, v201, v202
v_mfma_f32_16x16x32_bf16 v[216:219], v[32:35], v[112:115], 0
s_nop 2
v_mfma_f32_16x16x32_bf16 v[216:219], v[36:39], v[116:119], v[216:219]
s_nop 0
v_max3_f32 v254, v254, v203, v212
v_max3_f32 v254, v254, v213, v214
v_mfma_f32_16x16x32_bf16 v[220:223], v[44:47], v[116:119], 0
s_nop 2
v_mfma_f32_16x16x32_bf16 v[220:223], v[40:43], v[112:115], v[220:223]
v_max3_f32 v254, v254, v215, v216
v_max3_f32 v254, v254, v217, v218
v_mfma_f32_16x16x32_bf16 v[224:227], v[48:51], v[112:115], 0
s_nop 2
v_mfma_f32_16x16x32_bf16 v[224:227], v[52:55], v[116:119], v[224:227]
s_nop 0
v_max3_f32 v254, v254, v219, v220
v_max3_f32 v254, v254, v221, v222
v_mfma_f32_16x16x32_bf16 v[228:231], v[208:211], a[128:131], 0
s_nop 2
v_mfma_f32_16x16x32_bf16 v[228:231], v[204:207], a[132:135], v[228:231]
v_max3_f32 v254, v254, v223, v224
v_mfma_f32_16x16x32_bf16 v[228:231], v[196:199], a[136:139], v[228:231]
ds_swizzle_b32 v255, v254 offset:0x401F
v_mfma_f32_16x16x32_bf16 v[228:231], v[192:195], a[140:143], v[228:231]
s_add_u32 m0, s49, 19008
s_add_u32 s48, s48, s51
buffer_load_dwordx4 v237, s[16:19], s48 offen nt lds
v_mfma_f32_16x16x32_bf16 v[232:235], v[192:195], a[156:159], 0
s_nop 2
v_mfma_f32_16x16x32_bf16 v[232:235], v[196:199], a[152:155], v[232:235]
v_cvt_pk_bf16_f32 v91, v230, v231
v_cvt_pk_bf16_f32 v90, v228, v229
v_mfma_f32_16x16x32_bf16 v[232:235], v[204:207], a[148:151], v[232:235]
v_mfma_f32_16x16x32_bf16 v[232:235], v[208:211], a[144:147], v[232:235]
s_nop 2
v_mfma_f32_16x16x32_bf16 v[228:231], v[208:211], a[160:163], 0
s_waitcnt lgkmcnt(0)
v_max_f32 v254, v254, v255
s_nop 0
v_mfma_f32_16x16x32_bf16 v[228:231], v[204:207], a[164:167], v[228:231]
ds_bpermute_b32 v255, v247, v254
v_mfma_f32_16x16x32_bf16 v[228:231], v[196:199], a[168:171], v[228:231]
v_cvt_pk_bf16_f32 v95, v234, v235
v_cvt_pk_bf16_f32 v94, v232, v233
v_mfma_f32_16x16x32_bf16 v[228:231], v[192:195], a[172:175], v[228:231]
s_nop 2
v_mfma_f32_16x16x32_bf16 v[232:235], v[192:195], a[188:191], 0
ds_read_b128 v[192:195], v236 offset:4224
s_nop 0
v_mfma_f32_16x16x32_bf16 v[232:235], v[204:207], a[180:183], v[232:235]
ds_read_b128 v[204:207], v236 offset:4480
v_cvt_pk_bf16_f32 v99, v230, v231
v_mfma_f32_16x16x32_bf16 v[232:235], v[208:211], a[176:179], v[232:235]
ds_read_b128 v[208:211], v236 offset:4736
v_cvt_pk_bf16_f32 v98, v228, v229
v_mfma_f32_16x16x32_bf16 v[232:235], v[196:199], a[184:187], v[232:235]
s_waitcnt lgkmcnt(3)
ds_read_b128 v[196:199], v236 offset:4992
v_max_f32 v254, v254, v255
v_sub_f32 v184, v184, v254
v_sub_f32 v185, v185, v254
v_exp_f32 v184, v184
v_exp_f32 v185, v185
v_sub_f32 v187, v187, v254
v_cvt_pk_bf16_f32 v103, v234, v235
v_cvt_pk_bf16_f32 v102, v232, v233
v_add_f32 v248, v184, v185
v_sub_f32 v186, v186, v254
v_exp_f32 v186, v186
v_cvt_pk_bf16_f32 v120, v184, v185
v_add_f32 v248, v248, v186
s_waitcnt lgkmcnt(1)
v_mfma_f32_16x16x32_bf16 v[228:231], v[208:211], a[184:187], 0
v_sub_f32 v188, v188, v254
s_waitcnt lgkmcnt(0)
v_mfma_f32_16x16x32_bf16 v[228:231], v[196:199], a[188:191], v[228:231]
v_exp_f32 v187, v187
v_mfma_f32_16x16x32_bf16 v[228:231], v[204:207], a[180:183], v[228:231]
v_cvt_pk_bf16_f32 v121, v186, v187
v_add_f32 v248, v248, v187
v_mfma_f32_16x16x32_bf16 v[228:231], v[192:195], a[176:179], v[228:231]
v_sub_f32 v189, v189, v254
v_sub_f32 v190, v190, v254
v_mfma_f32_16x16x32_bf16 v[232:235], v[192:195], a[160:163], 0
v_exp_f32 v189, v189
v_mfma_f32_16x16x32_bf16 v[232:235], v[204:207], a[164:167], v[232:235]
v_exp_f32 v190, v190
v_mfma_f32_16x16x32_bf16 v[232:235], v[208:211], a[168:171], v[232:235]
s_nop 0
v_cvt_pk_bf16_f32 v71, v230, v231
v_cvt_pk_bf16_f32 v70, v228, v229
v_mfma_f32_16x16x32_bf16 v[232:235], v[196:199], a[172:175], v[232:235]
s_add_u32 s48, s48, s51
v_exp_f32 v188, v188
v_mfma_f32_16x16x32_bf16 v[228:231], v[196:199], a[156:159], 0
s_add_u32 m0, s49, 21120
v_add_f32 v248, v248, v188
v_sub_f32 v191, v191, v254
v_mfma_f32_16x16x32_bf16 v[228:231], v[208:211], a[152:155], v[228:231]
buffer_load_dwordx4 v237, s[16:19], s48 offen nt lds
v_cvt_pk_bf16_f32 v66, v232, v233
v_mfma_f32_16x16x32_bf16 v[228:231], v[204:207], a[148:151], v[228:231]
v_cvt_pk_bf16_f32 v67, v234, v235
v_add_f32 v248, v248, v189
v_mfma_f32_16x16x32_bf16 v[228:231], v[192:195], a[144:147], v[228:231]
v_exp_f32 v191, v191
v_mfma_f32_16x16x32_bf16 v[232:235], v[192:195], a[128:131], 0
ds_read_b128 v[192:195], v236 offset:0
v_cvt_pk_bf16_f32 v122, v188, v189
v_mfma_f32_16x16x32_bf16 v[232:235], v[208:211], a[136:139], v[232:235]
ds_read_b128 v[208:211], v236 offset:256
v_add_f32 v248, v248, v190
v_mfma_f32_16x16x32_bf16 v[232:235], v[196:199], a[140:143], v[232:235]
ds_read_b128 v[196:199], v236 offset:512
v_cvt_pk_bf16_f32 v62, v228, v229
v_mfma_f32_16x16x32_bf16 v[232:235], v[204:207], a[132:135], v[232:235]
ds_read_b128 v[204:207], v236 offset:768
v_cvt_pk_bf16_f32 v63, v230, v231
v_add_f32 v248, v248, v191
v_cvt_pk_bf16_f32 v123, v190, v191
v_sub_f32 v200, v200, v254
v_exp_f32 v200, v200
v_sub_f32 v201, v201, v254
v_exp_f32 v201, v201
v_cvt_pk_bf16_f32 v59, v234, v235
v_cvt_pk_bf16_f32 v58, v232, v233
v_sub_f32 v203, v203, v254
s_waitcnt lgkmcnt(2)
v_mfma_f32_16x16x32_bf16 v[228:231], v[208:211], a[132:135], 0
ds_read_b128 v[188:191], v242 offset:64
v_sub_f32 v202, v202, v254
v_mfma_f32_16x16x32_bf16 v[228:231], v[192:195], a[128:131], v[228:231]
s_waitcnt lgkmcnt(2)
v_exp_f32 v203, v203
v_mfma_f32_16x16x32_bf16 v[228:231], v[196:199], a[136:139], v[228:231]
s_waitcnt lgkmcnt(1)
v_exp_f32 v202, v202
v_mfma_f32_16x16x32_bf16 v[228:231], v[204:207], a[140:143], v[228:231]
v_add_f32 v248, v248, v200
v_add_f32 v248, v248, v201
v_mfma_f32_16x16x32_bf16 v[184:187], v[204:207], a[156:159], 0
v_add_f32 v248, v248, v202
v_add_f32 v248, v248, v203
v_mfma_f32_16x16x32_bf16 v[184:187], v[196:199], a[152:155], v[184:187]
v_cvt_pk_bf16_f32 v124, v200, v201
v_cvt_pk_bf16_f32 v125, v202, v203
v_mfma_f32_16x16x32_bf16 v[184:187], v[208:211], a[148:151], v[184:187]
s_waitcnt lgkmcnt(0)
v_cvt_pk_bf16_f32 v56, v228, v229
v_cvt_pk_bf16_f32 v57, v230, v231
v_mfma_f32_16x16x32_bf16 v[184:187], v[192:195], a[144:147], v[184:187]
v_sub_f32 v212, v212, v254
v_sub_f32 v213, v213, v254
v_mfma_f32_16x16x32_bf16 v[228:231], v[192:195], a[160:163], 0
v_exp_f32 v212, v212
v_mfma_f32_16x16x32_bf16 v[228:231], v[208:211], a[164:167], v[228:231]
v_sub_f32 v214, v214, v254
v_add_f32 v248, v248, v212
v_mfma_f32_16x16x32_bf16 v[228:231], v[196:199], a[168:171], v[228:231]
v_cvt_pk_bf16_f32 v60, v184, v185
v_cvt_pk_bf16_f32 v61, v186, v187
v_mfma_f32_16x16x32_bf16 v[228:231], v[204:207], a[172:175], v[228:231]
s_add_u32 m0, s49, 23232
ds_read_b128 v[184:187], v242 offset:0
v_sub_f32 v215, v215, v254
v_mfma_f32_16x16x32_bf16 v[232:235], v[204:207], a[188:191], 0
s_add_u32 s48, s48, s51
buffer_load_dwordx4 v237, s[16:19], s48 offen nt lds
v_sub_f32 v216, v216, v254
v_mfma_f32_16x16x32_bf16 v[232:235], v[196:199], a[184:187], v[232:235]
s_sub_u32 s49, s49, s56
v_exp_f32 v213, v213
v_mfma_f32_16x16x32_bf16 v[232:235], v[208:211], a[180:183], v[232:235]
s_and_b32 s51, s57, 26212352
v_exp_f32 v214, v214
v_mfma_f32_16x16x32_bf16 v[232:235], v[192:195], a[176:179], v[232:235]
s_add_u32 s51, s51, 2048
v_cvt_pk_bf16_f32 v126, v212, v213
v_add_f32 v248, v248, v213
v_mfma_f32_16x16x32_bf16 v[200:203], v[4:7], v[188:191], 0
v_add_f32 v248, v248, v214
s_waitcnt lgkmcnt(0)
v_mfma_f32_16x16x32_bf16 v[200:203], v[0:3], v[184:187], v[200:203]
s_nop 0
v_cvt_pk_bf16_f32 v69, v234, v235
v_cvt_pk_bf16_f32 v68, v232, v233
v_mfma_f32_16x16x32_bf16 v[232:235], v[32:35], v[184:187], 0
ds_read_b128 v[184:187], v245 offset:64
v_sub_f32 v218, v218, v254
v_mfma_f32_16x16x32_bf16 v[232:235], v[36:39], v[188:191], v[232:235]
ds_read_b128 v[188:191], v243 offset:0
v_exp_f32 v215, v215
s_nop 0
v_add_f32 v248, v248, v215
v_cvt_pk_bf16_f32 v127, v214, v215
ds_read_b128 v[212:215], v243 offset:64
v_exp_f32 v216, v216
v_sub_f32 v217, v217, v254
v_add_f32 v248, v248, v216
v_exp_f32 v218, v218
v_sub_f32 v219, v219, v254
v_exp_f32 v217, v217
v_exp_f32 v219, v219
v_cvt_pk_bf16_f32 v128, v216, v217
v_cvt_pk_bf16_f32 v129, v218, v219
v_add_f32 v248, v248, v217
v_add_f32 v248, v248, v218
v_add_f32 v248, v248, v219
v_cvt_pk_bf16_f32 v64, v228, v229
v_cvt_pk_bf16_f32 v65, v230, v231
v_sub_f32 v220, v220, v254
v_sub_f32 v221, v221, v254
s_waitcnt lgkmcnt(0)
v_mfma_f32_16x16x32_bf16 v[200:203], v[12:15], v[212:215], v[200:203]
ds_read_b128 v[216:219], v244 offset:0
ds_read_b128 v[228:231], v245 offset:0
v_mfma_f32_16x16x32_bf16 v[200:203], v[8:11], v[188:191], v[200:203]
v_exp_f32 v220, v220
v_mfma_f32_16x16x32_bf16 v[232:235], v[40:43], v[188:191], v[232:235]
ds_read_b128 v[188:191], v244 offset:64
v_add_f32 v248, v248, v220
v_mfma_f32_16x16x32_bf16 v[232:235], v[44:47], v[212:215], v[232:235]
v_exp_f32 v221, v221
v_sub_f32 v223, v223, v254
v_add_f32 v248, v248, v221
v_exp_f32 v223, v223
v_sub_f32 v222, v222, v254
v_exp_f32 v222, v222
v_cvt_pk_bf16_f32 v130, v220, v221
v_mov_b32 v221, 0xff800000
v_add_f32 v248, v248, v222
v_cvt_pk_bf16_f32 v131, v222, v223
v_add_f32 v248, v248, v223
v_sub_f32 v224, v224, v254
v_exp_f32 v224, v224
s_waitcnt lgkmcnt(0)
v_mfma_f32_16x16x32_bf16 v[200:203], v[20:23], v[188:191], v[200:203]
v_cvt_pk_bf16_f32 v132, v224, 0
v_add_f32 v248, v248, v224
v_mfma_f32_16x16x32_bf16 v[200:203], v[16:19], v[216:219], v[200:203]
ds_swizzle_b32 v250, v248 offset:0x401F
v_add_u32 v245, 0x200, v245
v_mfma_f32_16x16x32_bf16 v[232:235], v[48:51], v[216:219], v[232:235]
v_add_u32 v244, 0x200, v244
v_add_u32 v243, 0x200, v243
v_mfma_f32_16x16x32_bf16 v[232:235], v[52:55], v[188:191], v[232:235]
v_add_u32 v242, 0x200, v242
s_nop 0
v_mfma_f32_16x16x32_bf16 v[200:203], v[24:27], v[228:231], v[200:203]
s_nop 2
v_mfma_f32_16x16x32_bf16 v[200:203], v[28:31], v[184:187], v[200:203]
s_nop 0
v_mov_b32_dpp v233, v221 quad_perm:[0,1,2,3] row_mask:0xf bank_mask:0xc
v_mov_b32_dpp v232, v221 quad_perm:[0,1,2,3] row_mask:0xf bank_mask:0x8
v_mfma_f32_16x16x32_bf16 v[184:187], a[0:3], v[192:195], 0
v_mov_b32_dpp v234, v221 quad_perm:[0,1,2,3] row_mask:0xf bank_mask:0xc
v_mov_b32_dpp v235, v221 quad_perm:[0,1,2,3] row_mask:0xf bank_mask:0xc
v_mfma_f32_16x16x32_bf16 v[184:187], a[4:7], v[208:211], v[184:187]
s_waitcnt lgkmcnt(0)
v_max3_f32 v223, v200, v201, v202
v_max3_f32 v223, v223, v203, v232
v_mfma_f32_16x16x32_bf16 v[184:187], a[8:11], v[196:199], v[184:187]
v_max3_f32 v223, v223, v233, v234
v_max_f32 v223, v223, v235
v_mfma_f32_16x16x32_bf16 v[184:187], a[12:15], v[204:207], v[184:187]
s_nop 0
v_max_f32_dpp v223, v223, v223 row_ror:8 row_mask:0xf bank_mask:0xf
v_add_f32 v248, v248, v250
v_mfma_f32_16x16x32_bf16 v[188:191], a[28:31], v[204:207], 0
ds_bpermute_b32 v250, v247, v248
v_mfma_f32_16x16x32_bf16 v[188:191], a[24:27], v[196:199], v[188:191]
v_max_f32_dpp v223, v223, v223 row_ror:4 row_mask:0xf bank_mask:0xf
v_mfma_f32_16x16x32_bf16 v[188:191], a[20:23], v[208:211], v[188:191]
ds_swizzle_b32 v221, v223 offset:0x401F
v_cvt_pk_bf16_f32 v113, v186, v187
v_mfma_f32_16x16x32_bf16 v[188:191], a[16:19], v[192:195], v[188:191]
v_cvt_pk_bf16_f32 v112, v184, v185
s_nop 0
v_mfma_f32_16x16x32_bf16 v[184:187], a[32:35], v[192:195], 0
s_nop 2
v_mfma_f32_16x16x32_bf16 v[184:187], a[36:39], v[208:211], v[184:187]
s_nop 0
v_cvt_pk_bf16_f32 v115, v190, v191
v_cvt_pk_bf16_f32 v114, v188, v189
v_mfma_f32_16x16x32_bf16 v[184:187], a[40:43], v[196:199], v[184:187]
s_waitcnt lgkmcnt(1)
v_add_f32 v248, v248, v250
v_mfma_f32_16x16x32_bf16 v[184:187], a[44:47], v[204:207], v[184:187]
v_rcp_f32 v251, v248
v_mfma_f32_16x16x32_bf16 v[188:191], a[60:63], v[204:207], 0
s_waitcnt lgkmcnt(0)
v_max_f32 v223, v223, v221
s_nop 0
v_mfma_f32_16x16x32_bf16 v[188:191], a[56:59], v[196:199], v[188:191]
ds_bpermute_b32 v221, v247, v223
v_mfma_f32_16x16x32_bf16 v[188:191], a[52:55], v[208:211], v[188:191]
v_cvt_pk_bf16_f32 v117, v186, v187
v_cvt_pk_bf16_f32 v116, v184, v185
v_mfma_f32_16x16x32_bf16 v[188:191], a[48:51], v[192:195], v[188:191]
s_nop 2
v_mfma_f32_16x16x32_bf16 v[168:171], a[192:195], v[192:195], 0
s_nop 2
v_mfma_f32_16x16x32_bf16 v[168:171], a[196:199], v[208:211], v[168:171]
v_cvt_pk_bf16_f32 v119, v190, v191
v_cvt_pk_bf16_f32 v118, v188, v189
v_mfma_f32_16x16x32_bf16 v[168:171], a[200:203], v[196:199], v[168:171]
v_mfma_f32_16x16x32_bf16 v[168:171], a[204:207], v[204:207], v[168:171]
s_waitcnt lgkmcnt(0)
v_max_f32 v223, v223, v221
v_sub_f32 v200, v200, v223
v_mfma_f32_16x16x32_bf16 v[172:175], a[220:223], v[204:207], 0
v_exp_f32 v200, v200
v_mfma_f32_16x16x32_bf16 v[172:175], a[216:219], v[196:199], v[172:175]
v_sub_f32 v201, v201, v223
v_sub_f32 v202, v202, v223
v_mfma_f32_16x16x32_bf16 v[172:175], a[212:215], v[208:211], v[172:175]
v_exp_f32 v202, v202
v_mfma_f32_16x16x32_bf16 v[172:175], a[208:211], v[192:195], v[172:175]
v_exp_f32 v201, v201
v_mfma_f32_16x16x32_bf16 v[176:179], a[224:227], v[192:195], 0
v_add_f32 v220, v200, v201
v_add_f32 v220, v220, v202
v_mfma_f32_16x16x32_bf16 v[176:179], a[228:231], v[208:211], v[176:179]
v_sub_f32 v203, v203, v223
v_sub_f32 v233, v233, v223
v_mfma_f32_16x16x32_bf16 v[176:179], a[232:235], v[196:199], v[176:179]
v_exp_f32 v233, v233
v_mfma_f32_16x16x32_bf16 v[176:179], a[236:239], v[204:207], v[176:179]
v_exp_f32 v203, v203
v_mfma_f32_16x16x32_bf16 v[180:183], a[252:255], v[204:207], 0
v_sub_f32 v232, v232, v223
v_sub_f32 v234, v234, v223
v_mfma_f32_16x16x32_bf16 v[180:183], a[248:251], v[196:199], v[180:183]
v_exp_f32 v232, v232
v_mfma_f32_16x16x32_bf16 v[180:183], a[244:247], v[208:211], v[180:183]
v_exp_f32 v234, v234
v_mfma_f32_16x16x32_bf16 v[180:183], a[240:243], v[192:195], v[180:183]
v_add_f32 v220, v220, v203
v_add_f32 v220, v220, v232
v_mfma_f32_16x16x32_bf16 v[184:187], v[0:3], v[112:115], 0
v_add_f32 v220, v220, v233
v_add_f32 v220, v220, v234
v_mfma_f32_16x16x32_bf16 v[184:187], v[4:7], v[116:119], v[184:187]
v_sub_f32 v235, v235, v223
v_cvt_pk_bf16_f32 v200, v200, v201
v_mfma_f32_16x16x32_bf16 v[188:191], v[12:15], v[116:119], 0
v_exp_f32 v235, v235
v_mfma_f32_16x16x32_bf16 v[188:191], v[8:11], v[112:115], v[188:191]
v_add_f32 v220, v220, v235
v_cvt_pk_bf16_f32 v201, v202, v203
v_mfma_f32_16x16x32_bf16 v[192:195], v[16:19], v[112:115], 0
v_cvt_pk_bf16_f32 v202, v232, v233
v_cvt_pk_bf16_f32 v203, v234, v235
v_mfma_f32_16x16x32_bf16 v[192:195], v[20:23], v[116:119], v[192:195]
ds_read_b128 v[196:199], v236 offset:8448
v_add_f32_dpp v220, v220, v220 row_ror:8 row_mask:0xf bank_mask:0xf
v_mfma_f32_16x16x32_bf16 v[208:211], v[28:31], v[116:119], 0
ds_read_b128 v[204:207], v236 offset:8704
v_add_f32_dpp v220, v220, v220 row_ror:4 row_mask:0xf bank_mask:0xf
v_mfma_f32_16x16x32_bf16 v[208:211], v[24:27], v[112:115], v[208:211]
ds_write_b32 v246, v220 offset:4096
ds_read_b128 v[212:215], v236 offset:8960
v_mfma_f32_16x16x32_bf16 v[216:219], v[32:35], v[112:115], 0
ds_read_b128 v[224:227], v236 offset:9216
v_max3_f32 v254, v184, v185, v186
v_mfma_f32_16x16x32_bf16 v[216:219], v[36:39], v[116:119], v[216:219]
v_max3_f32 v254, v254, v187, v188
v_max3_f32 v254, v254, v189, v190
v_mfma_f32_16x16x32_bf16 v[228:231], v[44:47], v[116:119], 0
v_max3_f32 v254, v254, v191, v192
v_max3_f32 v254, v254, v193, v194
v_mfma_f32_16x16x32_bf16 v[228:231], v[40:43], v[112:115], v[228:231]
s_waitcnt lgkmcnt(4)
v_max3_f32 v254, v254, v195, v208
v_max3_f32 v254, v254, v209, v210
v_mfma_f32_16x16x32_bf16 v[232:235], v[48:51], v[112:115], 0
s_waitcnt lgkmcnt(3)
v_max3_f32 v254, v254, v211, v216
v_max3_f32 v254, v254, v217, v218
v_mfma_f32_16x16x32_bf16 v[232:235], v[52:55], v[116:119], v[232:235]
s_waitcnt lgkmcnt(1)
v_max3_f32 v254, v254, v219, v228
v_max3_f32 v254, v254, v229, v230
v_mfma_f32_16x16x32_bf16 v[220:223], v[196:199], a[128:131], 0
s_waitcnt lgkmcnt(0)
s_nop 1
v_mfma_f32_16x16x32_bf16 v[220:223], v[204:207], a[132:135], v[220:223]
v_max3_f32 v254, v254, v231, v232
v_mfma_f32_16x16x32_bf16 v[220:223], v[212:215], a[136:139], v[220:223]
ds_swizzle_b32 v255, v254 offset:0x401F
v_mfma_f32_16x16x32_bf16 v[220:223], v[224:227], a[140:143], v[220:223]
s_nop 7
v_cvt_pk_bf16_f32 v73, v222, v223
v_cvt_pk_bf16_f32 v72, v220, v221
v_mfma_f32_16x16x32_bf16 v[220:223], v[224:227], a[156:159], 0
v_mfma_f32_16x16x32_bf16 v[220:223], v[212:215], a[152:155], v[220:223]
v_mfma_f32_16x16x32_bf16 v[220:223], v[204:207], a[148:151], v[220:223]
s_waitcnt lgkmcnt(0)
v_max_f32 v254, v254, v255
v_mfma_f32_16x16x32_bf16 v[220:223], v[196:199], a[144:147], v[220:223]
ds_bpermute_b32 v255, v247, v254
s_nop 6
v_cvt_pk_bf16_f32 v76, v220, v221
v_cvt_pk_bf16_f32 v77, v222, v223
v_mfma_f32_16x16x32_bf16 v[220:223], v[196:199], a[160:163], 0
v_mfma_f32_16x16x32_bf16 v[220:223], v[204:207], a[164:167], v[220:223]
v_mfma_f32_16x16x32_bf16 v[220:223], v[212:215], a[168:171], v[220:223]
s_waitcnt lgkmcnt(0)
v_max_f32 v254, v254, v255
v_mfma_f32_16x16x32_bf16 v[220:223], v[224:227], a[172:175], v[220:223]
v_sub_f32 v184, v184, v254
v_exp_f32 v184, v184
v_sub_f32 v185, v185, v254
v_sub_f32 v187, v187, v254
v_exp_f32 v185, v185
s_nop 2
v_cvt_pk_bf16_f32 v81, v222, v223
v_cvt_pk_bf16_f32 v80, v220, v221
v_mfma_f32_16x16x32_bf16 v[220:223], v[224:227], a[188:191], 0
ds_read_b128 v[224:227], v236 offset:12672
v_add_f32 v249, v184, v185
v_mfma_f32_16x16x32_bf16 v[220:223], v[204:207], a[180:183], v[220:223]
ds_read_b128 v[204:207], v236 offset:12928
v_sub_f32 v186, v186, v254
v_mfma_f32_16x16x32_bf16 v[220:223], v[196:199], a[176:179], v[220:223]
ds_read_b128 v[196:199], v236 offset:13184
v_cvt_pk_bf16_f32 v136, v184, v185
v_mfma_f32_16x16x32_bf16 v[220:223], v[212:215], a[184:187], v[220:223]
ds_read_b128 v[212:215], v236 offset:13440
v_exp_f32 v186, v186
v_exp_f32 v187, v187
v_add_f32 v249, v249, v186
v_add_f32 v249, v249, v187
v_cvt_pk_bf16_f32 v137, v186, v187
v_sub_f32 v189, v189, v254
v_sub_f32 v188, v188, v254
v_cvt_pk_bf16_f32 v84, v220, v221
v_cvt_pk_bf16_f32 v85, v222, v223
v_exp_f32 v188, v188
v_exp_f32 v189, v189
v_sub_f32 v191, v191, v254
s_waitcnt lgkmcnt(1)
v_mfma_f32_16x16x32_bf16 v[184:187], v[196:199], a[184:187], 0
v_sub_f32 v190, v190, v254
s_waitcnt lgkmcnt(0)
v_mfma_f32_16x16x32_bf16 v[184:187], v[212:215], a[188:191], v[184:187]
v_exp_f32 v190, v190
v_mfma_f32_16x16x32_bf16 v[184:187], v[204:207], a[180:183], v[184:187]
v_exp_f32 v191, v191
v_mfma_f32_16x16x32_bf16 v[184:187], v[224:227], a[176:179], v[184:187]
v_add_f32 v249, v249, v188
v_add_f32 v249, v249, v189
v_mfma_f32_16x16x32_bf16 v[220:223], v[224:227], a[160:163], 0
v_add_f32 v249, v249, v190
v_cvt_pk_bf16_f32 v139, v190, v191
v_mfma_f32_16x16x32_bf16 v[220:223], v[204:207], a[164:167], v[220:223]
v_cvt_pk_bf16_f32 v138, v188, v189
v_add_f32 v249, v249, v191
v_mfma_f32_16x16x32_bf16 v[220:223], v[196:199], a[168:171], v[220:223]
v_cvt_pk_bf16_f32 v86, v184, v185
v_cvt_pk_bf16_f32 v87, v186, v187
v_mfma_f32_16x16x32_bf16 v[220:223], v[212:215], a[172:175], v[220:223]
v_sub_f32 v192, v192, v254
v_sub_f32 v194, v194, v254
v_mfma_f32_16x16x32_bf16 v[184:187], v[212:215], a[156:159], 0
v_exp_f32 v192, v192
v_mfma_f32_16x16x32_bf16 v[184:187], v[196:199], a[152:155], v[184:187]
v_add_f32 v249, v249, v192
v_sub_f32 v193, v193, v254
v_mfma_f32_16x16x32_bf16 v[184:187], v[204:207], a[148:151], v[184:187]
v_cvt_pk_bf16_f32 v83, v222, v223
v_cvt_pk_bf16_f32 v82, v220, v221
v_mfma_f32_16x16x32_bf16 v[184:187], v[224:227], a[144:147], v[184:187]
v_exp_f32 v193, v193
v_mfma_f32_16x16x32_bf16 v[220:223], v[224:227], a[128:131], 0
ds_read_b128 v[224:227], v236 offset:16896
v_sub_f32 v209, v209, v254
v_mfma_f32_16x16x32_bf16 v[220:223], v[196:199], a[136:139], v[220:223]
ds_read_b128 v[196:199], v236 offset:17152
v_sub_f32 v208, v208, v254
v_mfma_f32_16x16x32_bf16 v[220:223], v[212:215], a[140:143], v[220:223]
ds_read_b128 v[212:215], v236 offset:17408
v_cvt_pk_bf16_f32 v79, v186, v187
v_mfma_f32_16x16x32_bf16 v[220:223], v[204:207], a[132:135], v[220:223]
ds_read_b128 v[204:207], v236 offset:17664
v_cvt_pk_bf16_f32 v78, v184, v185
v_exp_f32 v208, v208
v_exp_f32 v209, v209
v_exp_f32 v194, v194
v_add_f32 v249, v249, v193
v_add_f32 v249, v249, v194
v_sub_f32 v195, v195, v254
v_cvt_pk_bf16_f32 v74, v220, v221
v_cvt_pk_bf16_f32 v75, v222, v223
s_waitcnt lgkmcnt(2)
v_mfma_f32_16x16x32_bf16 v[184:187], v[196:199], a[132:135], 0
v_exp_f32 v195, v195
v_mfma_f32_16x16x32_bf16 v[184:187], v[224:227], a[128:131], v[184:187]
s_waitcnt lgkmcnt(1)
v_sub_f32 v216, v216, v254
v_sub_f32 v211, v211, v254
v_mfma_f32_16x16x32_bf16 v[184:187], v[212:215], a[136:139], v[184:187]
s_waitcnt lgkmcnt(0)
v_sub_f32 v210, v210, v254
v_add_f32 v249, v249, v195
v_mfma_f32_16x16x32_bf16 v[184:187], v[204:207], a[140:143], v[184:187]
v_exp_f32 v211, v211
v_mfma_f32_16x16x32_bf16 v[220:223], v[204:207], a[156:159], 0
v_exp_f32 v210, v210
v_mfma_f32_16x16x32_bf16 v[220:223], v[212:215], a[152:155], v[220:223]
v_add_f32 v249, v249, v208
v_sub_f32 v219, v219, v254
v_mfma_f32_16x16x32_bf16 v[220:223], v[196:199], a[148:151], v[220:223]
s_nop 0
v_cvt_pk_bf16_f32 v89, v186, v187
v_cvt_pk_bf16_f32 v88, v184, v185
v_mfma_f32_16x16x32_bf16 v[220:223], v[224:227], a[144:147], v[220:223]
v_exp_f32 v216, v216
v_mfma_f32_16x16x32_bf16 v[184:187], v[224:227], a[160:163], 0
v_sub_f32 v217, v217, v254
v_add_f32 v249, v249, v209
v_mfma_f32_16x16x32_bf16 v[184:187], v[196:199], a[164:167], v[184:187]
v_sub_f32 v228, v228, v254
v_add_f32 v249, v249, v210
v_mfma_f32_16x16x32_bf16 v[184:187], v[212:215], a[168:171], v[184:187]
v_exp_f32 v217, v217
v_mfma_f32_16x16x32_bf16 v[184:187], v[204:207], a[172:175], v[184:187]
v_sub_f32 v229, v229, v254
v_sub_f32 v218, v218, v254
v_mfma_f32_16x16x32_bf16 v[188:191], v[204:207], a[188:191], 0
v_exp_f32 v218, v218
v_mfma_f32_16x16x32_bf16 v[188:191], v[212:215], a[184:187], v[188:191]
v_add_f32 v249, v249, v211
v_add_f32 v249, v249, v216
v_mfma_f32_16x16x32_bf16 v[188:191], v[196:199], a[180:183], v[188:191]
v_cvt_pk_bf16_f32 v96, v184, v185
v_cvt_pk_bf16_f32 v97, v186, v187
v_mfma_f32_16x16x32_bf16 v[188:191], v[224:227], a[176:179], v[188:191]
v_exp_f32 v219, v219
v_mfma_f32_16x16x32_bf16 v[184:187], a[0:3], v[224:227], 0
v_add_f32 v249, v249, v217
v_add_f32 v249, v249, v218
v_mfma_f32_16x16x32_bf16 v[184:187], a[4:7], v[196:199], v[184:187]
v_add_f32 v249, v249, v219
v_cvt_pk_bf16_f32 v144, v216, v217
v_mfma_f32_16x16x32_bf16 v[184:187], a[8:11], v[212:215], v[184:187]
v_cvt_pk_bf16_f32 v100, v188, v189
v_cvt_pk_bf16_f32 v101, v190, v191
v_mfma_f32_16x16x32_bf16 v[184:187], a[12:15], v[204:207], v[184:187]
v_cvt_pk_bf16_f32 v145, v218, v219
v_cvt_pk_bf16_f32 v92, v220, v221
v_mfma_f32_16x16x32_bf16 v[188:191], a[28:31], v[204:207], 0
v_cvt_pk_bf16_f32 v93, v222, v223
v_sub_f32 v232, v232, v254
v_mfma_f32_16x16x32_bf16 v[188:191], a[24:27], v[212:215], v[188:191]
v_exp_f32 v228, v228
v_mfma_f32_16x16x32_bf16 v[188:191], a[20:23], v[196:199], v[188:191]
v_cvt_pk_bf16_f32 v112, v184, v185
v_cvt_pk_bf16_f32 v113, v186, v187
v_mfma_f32_16x16x32_bf16 v[188:191], a[16:19], v[224:227], v[188:191]
v_exp_f32 v229, v229
v_mfma_f32_16x16x32_bf16 v[184:187], a[32:35], v[224:227], 0
v_add_f32 v249, v249, v228
v_sub_f32 v231, v231, v254
v_mfma_f32_16x16x32_bf16 v[184:187], a[36:39], v[196:199], v[184:187]
v_exp_f32 v232, v232
v_mfma_f32_16x16x32_bf16 v[184:187], a[40:43], v[212:215], v[184:187]
s_nop 0
v_cvt_pk_bf16_f32 v115, v190, v191
v_cvt_pk_bf16_f32 v114, v188, v189
v_mfma_f32_16x16x32_bf16 v[184:187], a[44:47], v[204:207], v[184:187]
v_sub_f32 v230, v230, v254
v_add_f32 v249, v249, v229
v_mfma_f32_16x16x32_bf16 v[188:191], a[60:63], v[204:207], 0
v_cvt_pk_bf16_f32 v140, v192, v193
v_mov_b32 v192, v202
v_mfma_f32_16x16x32_bf16 v[188:191], a[56:59], v[212:215], v[188:191]
v_cvt_pk_bf16_f32 v142, v208, v209
v_mov_b32_dpp v209, v201 row_ror:8 row_mask:0xf bank_mask:0xf
v_mfma_f32_16x16x32_bf16 v[188:191], a[52:55], v[196:199], v[188:191]
v_cvt_pk_bf16_f32 v116, v184, v185
v_cvt_pk_bf16_f32 v117, v186, v187
v_mfma_f32_16x16x32_bf16 v[188:191], a[48:51], v[224:227], v[188:191]
v_mov_b32_dpp v208, v200 row_ror:8 row_mask:0xf bank_mask:0xf
v_cvt_pk_bf16_f32 v143, v210, v211
v_mfma_f32_16x16x32_bf16 v[216:219], v[56:59], v[120:123], 0
v_mov_b32_dpp v211, v201 row_ror:4 row_mask:0xf bank_mask:0xf
v_mov_b32_dpp v210, v200 row_ror:4 row_mask:0xf bank_mask:0xf
v_mfma_f32_16x16x32_bf16 v[216:219], v[104:107], v[132:135], v[216:219]
v_cvt_pk_bf16_f32 v141, v194, v195
v_mov_b32_dpp v194, v202 row_ror:12 row_mask:0xf bank_mask:0xf
v_mfma_f32_16x16x32_bf16 v[216:219], v[72:75], v[124:127], v[216:219]
v_cvt_pk_bf16_f32 v118, v188, v189
v_cvt_pk_bf16_f32 v119, v190, v191
v_mfma_f32_16x16x32_bf16 v[216:219], v[88:91], v[128:131], v[216:219]
v_mov_b32_dpp v195, v203 row_ror:12 row_mask:0xf bank_mask:0xf
v_mov_b32 v193, v203
v_mfma_f32_16x16x32_bf16 v[220:223], v[92:95], v[128:131], 0
v_mov_b32_dpp v203, v201 row_ror:12 row_mask:0xf bank_mask:0xf
v_mov_b32_dpp v202, v200 row_ror:12 row_mask:0xf bank_mask:0xf
v_mfma_f32_16x16x32_bf16 v[220:223], v[76:79], v[124:127], v[220:223]
v_exp_f32 v230, v230
v_mfma_f32_16x16x32_bf16 v[220:223], v[106:109], v[132:135], v[220:223]
v_fmac_f32 v154, v218, v251
v_fmac_f32 v152, v216, v251
v_mfma_f32_16x16x32_bf16 v[220:223], v[60:63], v[120:123], v[220:223]
v_fmac_f32 v155, v219, v251
v_fmac_f32 v153, v217, v251
v_mfma_f32_16x16x32_bf16 v[188:191], v[64:67], v[120:123], 0
v_exp_f32 v231, v231
v_mfma_f32_16x16x32_bf16 v[188:191], v[108:111], v[132:135], v[188:191]
v_add_f32 v249, v249, v230
v_add_f32 v249, v249, v231
v_mfma_f32_16x16x32_bf16 v[188:191], v[80:83], v[124:127], v[188:191]
v_cvt_pk_bf16_f32 v146, v228, v229
v_cvt_pk_bf16_f32 v147, v230, v231
v_mfma_f32_16x16x32_bf16 v[188:191], v[96:99], v[128:131], v[188:191]
v_add_f32 v249, v249, v232
v_fmac_f32 v156, v220, v251
v_mfma_f32_16x16x32_bf16 v[184:187], v[100:103], v[128:131], 0
ds_swizzle_b32 v250, v249 offset:0x401F
v_fmac_f32 v158, v222, v251
v_mfma_f32_16x16x32_bf16 v[184:187], v[84:87], v[124:127], v[184:187]
v_fmac_f32 v157, v221, v251
v_fmac_f32 v159, v223, v251
v_mfma_f32_16x16x32_bf16 v[184:187], v[68:71], v[120:123], v[184:187]
v_fmac_f32 v161, v189, v251
v_fmac_f32 v160, v188, v251
v_mfma_f32_16x16x32_bf16 v[184:187], v[110:113], v[132:135], v[184:187]
v_mov_b32_dpp v132, v192 row_ror:8 row_mask:0xf bank_mask:0xf
v_fmac_f32 v163, v191, v251
v_fmac_f32 v162, v190, v251
v_mfma_f32_16x16x32_bf16 v[216:219], v[110:113], v[132:135], 0
v_cvt_pk_bf16_f32 v152, v152, v153
v_cvt_pk_bf16_f32 v153, v154, v155
v_mfma_f32_16x16x32_bf16 v[216:219], v[84:87], v[208:211], v[216:219]
s_nop 0
v_fmac_f32 v167, v187, v251
v_fmac_f32 v164, v184, v251
v_mfma_f32_16x16x32_bf16 v[216:219], v[100:103], v[192:195], v[216:219]
s_waitcnt lgkmcnt(0)
v_fmac_f32 v165, v185, v251
v_fmac_f32 v166, v186, v251
v_mfma_f32_16x16x32_bf16 v[216:219], v[68:71], v[200:203], v[216:219]
v_add_f32 v249, v249, v250
v_pk_max_i16 v153, v153, 0
v_mfma_f32_16x16x32_bf16 v[188:191], v[64:67], v[200:203], 0
ds_bpermute_b32 v250, v247, v249
v_mfma_f32_16x16x32_bf16 v[188:191], v[80:83], v[208:211], v[188:191]
v_cvt_pk_bf16_f32 v160, v160, v161
v_cvt_pk_bf16_f32 v161, v162, v163
v_mfma_f32_16x16x32_bf16 v[188:191], v[96:99], v[192:195], v[188:191]
v_cvt_pk_bf16_f32 v216, v216, v217
v_cvt_pk_bf16_f32 v217, v218, v219
v_mfma_f32_16x16x32_bf16 v[188:191], v[108:111], v[132:135], v[188:191]
ds_write_b64 v246, v[216:217] offset:24
v_mfma_f32_16x16x32_bf16 v[228:231], v[106:109], v[132:135], 0
v_cvt_pk_bf16_f32 v162, v164, v165
v_pk_max_i16 v160, v160, 0
v_mfma_f32_16x16x32_bf16 v[228:231], v[76:79], v[208:211], v[228:231]
v_pk_max_i16 v161, v161, 0
v_cvt_pk_bf16_f32 v163, v166, v167
v_mfma_f32_16x16x32_bf16 v[228:231], v[92:95], v[192:195], v[228:231]
s_waitcnt lgkmcnt(1)
v_cvt_pk_bf16_f32 v188, v188, v189
v_cvt_pk_bf16_f32 v189, v190, v191
v_mfma_f32_16x16x32_bf16 v[228:231], v[60:63], v[200:203], v[228:231]
ds_write_b64 v246, v[188:189] offset:16
v_mfma_f32_16x16x32_bf16 v[184:187], v[56:59], v[200:203], 0
v_pk_max_i16 v163, v163, 0
v_cvt_pk_bf16_f32 v155, v158, v159
v_mfma_f32_16x16x32_bf16 v[184:187], v[72:75], v[208:211], v[184:187]
v_pk_max_i16 v162, v162, 0
v_cvt_pk_bf16_f32 v154, v156, v157
v_mfma_f32_16x16x32_bf16 v[184:187], v[88:91], v[192:195], v[184:187]
v_cvt_pk_bf16_f32 v228, v228, v229
v_cvt_pk_bf16_f32 v229, v230, v231
v_mfma_f32_16x16x32_bf16 v[184:187], v[104:107], v[132:135], v[184:187]
ds_write_b64 v246, v[228:229] offset:8
v_mfma_f32_16x16x32_bf16 v[188:191], v[0:3], v[112:115], 0
v_pk_max_i16 v154, v154, 0
v_pk_max_i16 v152, v152, 0
v_mfma_f32_16x16x32_bf16 v[188:191], v[4:7], v[116:119], v[188:191]
v_pk_max_i16 v155, v155, 0
v_add_f32 v249, v249, v250
v_mfma_f32_16x16x32_bf16 v[192:195], v[12:15], v[116:119], 0
buffer_store_dwordx4 v[152:155], v239, s[20:23], s52 offen offset:0 nt
buffer_store_dwordx4 v[160:163], v239, s[20:23], s52 offen offset:64 nt
v_cvt_pk_bf16_f32 v184, v184, v185
v_cvt_pk_bf16_f32 v185, v186, v187
v_rcp_f32 v252, v249
v_max3_f32 v254, v188, v189, v190
v_cvt_pk_bf16_f32 v148, v232, 0
s_add_u32 s52, s46, 16384
v_mfma_f32_16x16x32_bf16 v[192:195], v[8:11], v[112:115], v[192:195]
ds_write_b64 v246, v[184:185] offset:0
v_mfma_f32_16x16x32_bf16 v[200:203], v[16:19], v[112:115], 0
s_nop 0
v_add_u32 v246, 0x200, v246
s_nop 0
v_mfma_f32_16x16x32_bf16 v[200:203], v[20:23], v[116:119], v[200:203]
s_nop 1
v_max3_f32 v254, v254, v191, v192
v_mfma_f32_16x16x32_bf16 v[184:187], v[28:31], v[116:119], 0
v_max3_f32 v254, v254, v193, v194
s_nop 0
v_mfma_f32_16x16x32_bf16 v[184:187], v[24:27], v[112:115], v[184:187]
s_nop 0
v_max3_f32 v254, v254, v195, v200
v_max3_f32 v254, v254, v201, v202
v_mfma_f32_16x16x32_bf16 v[208:211], v[32:35], v[112:115], 0
s_nop 2
v_mfma_f32_16x16x32_bf16 v[208:211], v[36:39], v[116:119], v[208:211]
v_max3_f32 v254, v254, v203, v184
v_max3_f32 v254, v254, v185, v186
v_mfma_f32_16x16x32_bf16 v[216:219], v[44:47], v[116:119], 0
s_nop 2
v_mfma_f32_16x16x32_bf16 v[216:219], v[40:43], v[112:115], v[216:219]
s_nop 0
v_max3_f32 v254, v254, v187, v208
v_max3_f32 v254, v254, v209, v210
v_mfma_f32_16x16x32_bf16 v[220:223], v[48:51], v[112:115], 0
s_nop 2
v_mfma_f32_16x16x32_bf16 v[220:223], v[52:55], v[116:119], v[220:223]
v_max3_f32 v254, v254, v211, v216
v_max3_f32 v254, v254, v217, v218
v_mfma_f32_16x16x32_bf16 v[152:155], a[192:195], v[224:227], 0
s_nop 2
v_mfma_f32_16x16x32_bf16 v[152:155], a[196:199], v[196:199], v[152:155]
s_nop 0
v_max3_f32 v254, v254, v219, v220
v_mfma_f32_16x16x32_bf16 v[152:155], a[200:203], v[212:215], v[152:155]
ds_swizzle_b32 v255, v254 offset:0x401F
v_mfma_f32_16x16x32_bf16 v[152:155], a[204:207], v[204:207], v[152:155]
v_mfma_f32_16x16x32_bf16 v[156:159], a[220:223], v[204:207], 0
v_mfma_f32_16x16x32_bf16 v[156:159], a[216:219], v[212:215], v[156:159]
v_mfma_f32_16x16x32_bf16 v[156:159], a[212:215], v[196:199], v[156:159]
v_mfma_f32_16x16x32_bf16 v[156:159], a[208:211], v[224:227], v[156:159]
v_mfma_f32_16x16x32_bf16 v[160:163], a[224:227], v[224:227], 0
s_waitcnt lgkmcnt(0)
v_max_f32 v254, v254, v255
v_mfma_f32_16x16x32_bf16 v[160:163], a[228:231], v[196:199], v[160:163]
ds_bpermute_b32 v255, v247, v254
v_mfma_f32_16x16x32_bf16 v[160:163], a[232:235], v[212:215], v[160:163]
v_mfma_f32_16x16x32_bf16 v[160:163], a[236:239], v[204:207], v[160:163]
v_mfma_f32_16x16x32_bf16 v[164:167], a[252:255], v[204:207], 0
v_mfma_f32_16x16x32_bf16 v[164:167], a[248:251], v[212:215], v[164:167]
v_mfma_f32_16x16x32_bf16 v[164:167], a[244:247], v[196:199], v[164:167]
v_mfma_f32_16x16x32_bf16 v[164:167], a[240:243], v[224:227], v[164:167]
s_waitcnt lgkmcnt(0)
v_max_f32 v254, v254, v255
v_sub_f32 v188, v188, v254
v_mfma_f32_16x16x32_bf16 v[196:199], v[56:59], v[136:139], 0
v_sub_f32 v190, v190, v254
v_sub_f32 v189, v189, v254
v_mfma_f32_16x16x32_bf16 v[196:199], v[104:107], v[148:151], v[196:199]
v_exp_f32 v189, v189
v_mfma_f32_16x16x32_bf16 v[196:199], v[72:75], v[140:143], v[196:199]
v_exp_f32 v188, v188
v_mfma_f32_16x16x32_bf16 v[196:199], v[88:91], v[144:147], v[196:199]
v_add_f32 v248, v188, v189
v_sub_f32 v191, v191, v254
v_mfma_f32_16x16x32_bf16 v[204:207], v[92:95], v[144:147], 0
v_exp_f32 v191, v191
v_mfma_f32_16x16x32_bf16 v[204:207], v[76:79], v[140:143], v[204:207]
v_exp_f32 v190, v190
v_mfma_f32_16x16x32_bf16 v[204:207], v[106:109], v[148:151], v[204:207]
v_cvt_pk_bf16_f32 v120, v188, v189
v_add_f32 v248, v248, v190
v_mfma_f32_16x16x32_bf16 v[204:207], v[60:63], v[136:139], v[204:207]
ds_read_b128 v[212:215], v236 offset:4224
v_add_f32 v248, v248, v191
v_mfma_f32_16x16x32_bf16 v[228:231], v[64:67], v[136:139], 0
ds_read_b128 v[224:227], v236 offset:4480
v_cvt_pk_bf16_f32 v121, v190, v191
v_mfma_f32_16x16x32_bf16 v[228:231], v[108:111], v[148:151], v[228:231]
v_fmac_f32 v170, v198, v252
v_fmac_f32 v171, v199, v252
v_mfma_f32_16x16x32_bf16 v[228:231], v[80:83], v[140:143], v[228:231]
v_fmac_f32 v168, v196, v252
v_fmac_f32 v169, v197, v252
v_mfma_f32_16x16x32_bf16 v[228:231], v[96:99], v[144:147], v[228:231]
ds_read_b128 v[196:199], v236 offset:4736
v_fmac_f32 v175, v207, v252
v_mfma_f32_16x16x32_bf16 v[232:235], v[100:103], v[144:147], 0
v_fmac_f32 v172, v204, v252
v_fmac_f32 v174, v206, v252
v_mfma_f32_16x16x32_bf16 v[232:235], v[84:87], v[140:143], v[232:235]
s_waitcnt lgkmcnt(2)
v_fmac_f32 v173, v205, v252
v_fmac_f32 v177, v229, v252
v_mfma_f32_16x16x32_bf16 v[232:235], v[110:113], v[148:151], v[232:235]
s_waitcnt lgkmcnt(1)
ds_read_b128 v[204:207], v236 offset:4992
v_fmac_f32 v176, v228, v252
v_mfma_f32_16x16x32_bf16 v[232:235], v[68:71], v[136:139], v[232:235]
v_fmac_f32 v178, v230, v252
v_fmac_f32 v179, v231, v252
v_mfma_f32_16x16x32_bf16 v[188:191], a[0:3], v[212:215], 0
v_cvt_pk_bf16_f32 v176, v176, v177
v_cvt_pk_bf16_f32 v168, v168, v169
v_mfma_f32_16x16x32_bf16 v[188:191], a[4:7], v[224:227], v[188:191]
s_waitcnt lgkmcnt(1)
v_cvt_pk_bf16_f32 v169, v170, v171
v_fmac_f32 v181, v233, v252
v_mfma_f32_16x16x32_bf16 v[188:191], a[8:11], v[196:199], v[188:191]
v_fmac_f32 v182, v234, v252
v_fmac_f32 v180, v232, v252
v_fmac_f32 v183, v235, v252
v_cvt_pk_bf16_f32 v170, v172, v173
v_pk_max_i16 v170, v170, 0
s_waitcnt lgkmcnt(0)
v_mfma_f32_16x16x32_bf16 v[188:191], a[12:15], v[204:207], v[188:191]
v_cvt_pk_bf16_f32 v171, v174, v175
v_pk_max_i16 v176, v176, 0
v_mfma_f32_16x16x32_bf16 v[232:235], a[28:31], v[204:207], 0
v_pk_max_i16 v171, v171, 0
v_cvt_pk_bf16_f32 v177, v178, v179
v_mfma_f32_16x16x32_bf16 v[232:235], a[24:27], v[196:199], v[232:235]
v_cvt_pk_bf16_f32 v178, v180, v181
v_pk_max_i16 v177, v177, 0
v_mfma_f32_16x16x32_bf16 v[232:235], a[20:23], v[224:227], v[232:235]
v_cvt_pk_bf16_f32 v112, v188, v189
v_cvt_pk_bf16_f32 v113, v190, v191
v_mfma_f32_16x16x32_bf16 v[232:235], a[16:19], v[212:215], v[232:235]
v_pk_max_i16 v168, v168, 0
v_cvt_pk_bf16_f32 v179, v182, v183
v_mfma_f32_16x16x32_bf16 v[188:191], a[32:35], v[212:215], 0
v_pk_max_i16 v179, v179, 0
v_pk_max_i16 v169, v169, 0
v_mfma_f32_16x16x32_bf16 v[188:191], a[36:39], v[224:227], v[188:191]
v_pk_max_i16 v178, v178, 0
v_sub_f32 v192, v192, v254
v_mfma_f32_16x16x32_bf16 v[188:191], a[40:43], v[196:199], v[188:191]
buffer_store_dwordx4 v[168:171], v239, s[20:23], s53 offen offset:0 nt
buffer_store_dwordx4 v[176:179], v239, s[20:23], s53 offen offset:64 nt
v_sub_f32 v193, v193, v254
v_exp_f32 v192, v192
v_exp_f32 v193, v193
v_sub_f32 v195, v195, v254
v_exp_f32 v195, v195
v_mfma_f32_16x16x32_bf16 v[188:191], a[44:47], v[204:207], v[188:191]
s_add_u32 s53, s46, 4096
v_add_f32 v248, v248, v192
v_sub_f32 v194, v194, v254
v_mfma_f32_16x16x32_bf16 v[228:231], a[60:63], v[204:207], 0
s_add_u32 s46, s46, 13107200
v_cvt_pk_bf16_f32 v114, v232, v233
v_cvt_pk_bf16_f32 v115, v234, v235
v_mfma_f32_16x16x32_bf16 v[228:231], a[56:59], v[196:199], v[228:231]
v_cvt_pk_bf16_f32 v117, v190, v191
v_cvt_pk_bf16_f32 v116, v188, v189
v_mfma_f32_16x16x32_bf16 v[228:231], a[52:55], v[224:227], v[228:231]
v_exp_f32 v194, v194
v_mfma_f32_16x16x32_bf16 v[228:231], a[48:51], v[212:215], v[228:231]
v_add_f32 v248, v248, v193
v_add_f32 v248, v248, v194
v_mfma_f32_16x16x32_bf16 v[168:171], a[192:195], v[212:215], 0
v_add_f32 v248, v248, v195
v_cvt_pk_bf16_f32 v122, v192, v193
v_mfma_f32_16x16x32_bf16 v[168:171], a[196:199], v[224:227], v[168:171]
v_cvt_pk_bf16_f32 v123, v194, v195
v_sub_f32 v201, v201, v254
v_mfma_f32_16x16x32_bf16 v[168:171], a[200:203], v[196:199], v[168:171]
v_cvt_pk_bf16_f32 v119, v230, v231
v_cvt_pk_bf16_f32 v118, v228, v229
v_mfma_f32_16x16x32_bf16 v[168:171], a[204:207], v[204:207], v[168:171]
v_sub_f32 v202, v202, v254
v_sub_f32 v200, v200, v254
v_mfma_f32_16x16x32_bf16 v[172:175], a[220:223], v[204:207], 0
v_exp_f32 v200, v200
v_mfma_f32_16x16x32_bf16 v[172:175], a[216:219], v[196:199], v[172:175]
v_exp_f32 v202, v202
v_mfma_f32_16x16x32_bf16 v[172:175], a[212:215], v[224:227], v[172:175]
v_exp_f32 v201, v201
v_mfma_f32_16x16x32_bf16 v[172:175], a[208:211], v[212:215], v[172:175]
v_sub_f32 v203, v203, v254
v_add_f32 v248, v248, v200
v_mfma_f32_16x16x32_bf16 v[176:179], a[224:227], v[212:215], 0
v_exp_f32 v203, v203
v_mfma_f32_16x16x32_bf16 v[176:179], a[228:231], v[224:227], v[176:179]
v_cvt_pk_bf16_f32 v125, v202, v203
v_add_f32 v248, v248, v201
v_mfma_f32_16x16x32_bf16 v[176:179], a[232:235], v[196:199], v[176:179]
v_add_f32 v248, v248, v202
v_cvt_pk_bf16_f32 v124, v200, v201
v_mfma_f32_16x16x32_bf16 v[176:179], a[236:239], v[204:207], v[176:179]
v_add_f32 v248, v248, v203
v_sub_f32 v184, v184, v254
v_mfma_f32_16x16x32_bf16 v[180:183], a[252:255], v[204:207], 0
v_sub_f32 v185, v185, v254
v_sub_f32 v187, v187, v254
v_mfma_f32_16x16x32_bf16 v[180:183], a[248:251], v[196:199], v[180:183]
v_sub_f32 v186, v186, v254
v_sub_f32 v220, v220, v254
v_mfma_f32_16x16x32_bf16 v[180:183], a[244:247], v[224:227], v[180:183]
v_exp_f32 v184, v184
v_mfma_f32_16x16x32_bf16 v[180:183], a[240:243], v[212:215], v[180:183]
v_add_f32 v248, v248, v184
v_sub_f32 v216, v216, v254
v_mfma_f32_16x16x32_bf16 v[188:191], v[0:3], v[112:115], 0
v_exp_f32 v187, v187
v_mfma_f32_16x16x32_bf16 v[188:191], v[4:7], v[116:119], v[188:191]
v_exp_f32 v186, v186
v_mfma_f32_16x16x32_bf16 v[192:195], v[12:15], v[116:119], 0
v_exp_f32 v185, v185
v_mfma_f32_16x16x32_bf16 v[192:195], v[8:11], v[112:115], v[192:195]
v_add_f32 v248, v248, v185
v_add_f32 v248, v248, v186
v_mfma_f32_16x16x32_bf16 v[196:199], v[16:19], v[112:115], 0
v_add_f32 v248, v248, v187
v_cvt_pk_bf16_f32 v127, v186, v187
v_mfma_f32_16x16x32_bf16 v[196:199], v[20:23], v[116:119], v[196:199]
v_cvt_pk_bf16_f32 v126, v184, v185
v_sub_f32 v218, v218, v254
v_mfma_f32_16x16x32_bf16 v[200:203], v[28:31], v[116:119], 0
v_exp_f32 v220, v220
v_mfma_f32_16x16x32_bf16 v[200:203], v[24:27], v[112:115], v[200:203]
v_cvt_pk_bf16_f32 v132, v220, 0
v_sub_f32 v217, v217, v254
v_mfma_f32_16x16x32_bf16 v[204:207], v[32:35], v[112:115], 0
v_sub_f32 v211, v211, v254
v_sub_f32 v210, v210, v254
v_mfma_f32_16x16x32_bf16 v[204:207], v[36:39], v[116:119], v[204:207]
v_sub_f32 v219, v219, v254
v_sub_f32 v208, v208, v254
v_mfma_f32_16x16x32_bf16 v[212:215], v[44:47], v[116:119], 0
v_sub_f32 v209, v209, v254
v_max3_f32 v254, v188, v189, v190
v_mfma_f32_16x16x32_bf16 v[212:215], v[40:43], v[112:115], v[212:215]
v_exp_f32 v209, v209
v_mfma_f32_16x16x32_bf16 v[224:227], v[48:51], v[112:115], 0
v_exp_f32 v208, v208
v_mfma_f32_16x16x32_bf16 v[224:227], v[52:55], v[116:119], v[224:227]
v_exp_f32 v217, v217
v_mfma_f32_16x16x32_bf16 v[184:187], v[56:59], v[120:123], 0
v_exp_f32 v210, v210
v_mfma_f32_16x16x32_bf16 v[184:187], v[104:107], v[132:135], v[184:187]
v_exp_f32 v218, v218
v_mfma_f32_16x16x32_bf16 v[184:187], v[72:75], v[124:127], v[184:187]
v_exp_f32 v211, v211
v_exp_f32 v216, v216
v_exp_f32 v219, v219
v_cvt_pk_bf16_f32 v129, v210, v211
v_cvt_pk_bf16_f32 v131, v218, v219
v_cvt_pk_bf16_f32 v130, v216, v217
v_cvt_pk_bf16_f32 v128, v208, v209
v_add_f32 v248, v248, v208
v_add_f32 v248, v248, v209
v_mfma_f32_16x16x32_bf16 v[184:187], v[88:91], v[128:131], v[184:187]
v_add_f32 v248, v248, v210
v_add_f32 v248, v248, v211
v_mfma_f32_16x16x32_bf16 v[208:211], v[92:95], v[128:131], 0
v_max3_f32 v254, v254, v191, v192
v_max3_f32 v254, v254, v193, v194
v_mfma_f32_16x16x32_bf16 v[208:211], v[76:79], v[124:127], v[208:211]
v_max3_f32 v254, v254, v195, v196
v_max3_f32 v254, v254, v197, v198
v_mfma_f32_16x16x32_bf16 v[208:211], v[106:109], v[132:135], v[208:211]
v_max3_f32 v254, v254, v199, v200
v_max3_f32 v254, v254, v201, v202
v_mfma_f32_16x16x32_bf16 v[208:211], v[60:63], v[120:123], v[208:211]
v_max3_f32 v254, v254, v203, v204
v_max3_f32 v254, v254, v205, v206
v_mfma_f32_16x16x32_bf16 v[228:231], v[64:67], v[120:123], 0
v_max3_f32 v254, v254, v207, v212
v_max3_f32 v254, v254, v213, v214
v_mfma_f32_16x16x32_bf16 v[228:231], v[108:111], v[132:135], v[228:231]
v_max3_f32 v254, v254, v215, v224
v_add_f32 v248, v248, v216
v_mfma_f32_16x16x32_bf16 v[228:231], v[80:83], v[124:127], v[228:231]
ds_swizzle_b32 v255, v254 offset:0x401F
v_add_f32 v248, v248, v217
v_mfma_f32_16x16x32_bf16 v[228:231], v[96:99], v[128:131], v[228:231]
v_add_f32 v248, v248, v218
v_add_f32 v248, v248, v219
v_mfma_f32_16x16x32_bf16 v[232:235], v[100:103], v[128:131], 0
ds_read_b128 v[216:219], v236 offset:8448
v_add_f32 v248, v248, v220
v_mfma_f32_16x16x32_bf16 v[232:235], v[84:87], v[124:127], v[232:235]
ds_read_b128 v[220:223], v236 offset:8704
ds_swizzle_b32 v250, v248 offset:0x401F
v_mfma_f32_16x16x32_bf16 v[232:235], v[110:113], v[132:135], v[232:235]
v_mfma_f32_16x16x32_bf16 v[232:235], v[68:71], v[120:123], v[232:235]
s_waitcnt lgkmcnt(3)
v_max_f32 v254, v254, v255
ds_bpermute_b32 v255, v247, v254
s_waitcnt lgkmcnt(1)
v_add_f32 v248, v248, v250
ds_bpermute_b32 v250, v247, v248
s_waitcnt lgkmcnt(1)
v_max_f32 v254, v254, v255
v_sub_f32 v188, v188, v254
v_exp_f32 v188, v188
v_sub_f32 v189, v189, v254
v_sub_f32 v190, v190, v254
v_sub_f32 v191, v191, v254
v_exp_f32 v189, v189
v_exp_f32 v191, v191
v_exp_f32 v190, v190
v_add_f32 v249, v188, v189
v_add_f32 v249, v249, v190
v_add_f32 v249, v249, v191
v_cvt_pk_bf16_f32 v137, v190, v191
v_cvt_pk_bf16_f32 v136, v188, v189
v_mfma_f32_16x16x32_bf16 v[188:191], a[0:3], v[216:219], 0
s_waitcnt lgkmcnt(0)
v_sub_f32 v192, v192, v254
v_sub_f32 v195, v195, v254
v_mfma_f32_16x16x32_bf16 v[188:191], a[4:7], v[220:223], v[188:191]
v_exp_f32 v192, v192
v_sub_f32 v193, v193, v254
v_sub_f32 v194, v194, v254
v_exp_f32 v195, v195
v_exp_f32 v193, v193
v_exp_f32 v194, v194
v_add_f32 v249, v249, v192
v_add_f32 v249, v249, v193
v_add_f32 v249, v249, v194
v_add_f32 v249, v249, v195
v_cvt_pk_bf16_f32 v139, v194, v195
v_cvt_pk_bf16_f32 v138, v192, v193
ds_read_b128 v[192:195], v236 offset:8960
v_sub_f32 v198, v198, v254
v_sub_f32 v197, v197, v254
v_sub_f32 v196, v196, v254
v_exp_f32 v196, v196
v_exp_f32 v198, v198
v_sub_f32 v202, v202, v254
v_sub_f32 v200, v200, v254
v_exp_f32 v197, v197
v_sub_f32 v201, v201, v254
v_sub_f32 v199, v199, v254
v_exp_f32 v199, v199
v_exp_f32 v200, v200
v_add_f32 v249, v249, v196
v_add_f32 v249, v249, v197
v_add_f32 v249, v249, v198
s_waitcnt lgkmcnt(0)
v_mfma_f32_16x16x32_bf16 v[188:191], a[8:11], v[192:195], v[188:191]
v_sub_f32 v203, v203, v254
v_add_f32 v249, v249, v199
v_add_f32 v249, v249, v200
v_exp_f32 v201, v201
v_exp_f32 v202, v202
v_exp_f32 v203, v203
v_sub_f32 v204, v204, v254
v_exp_f32 v204, v204
v_add_f32 v249, v249, v201
v_add_f32 v249, v249, v202
v_add_f32 v249, v249, v203
v_sub_f32 v205, v205, v254
v_sub_f32 v206, v206, v254
v_exp_f32 v205, v205
v_exp_f32 v206, v206
v_add_f32 v249, v249, v204
v_add_f32 v249, v249, v205
v_sub_f32 v207, v207, v254
v_exp_f32 v207, v207
v_add_f32 v249, v249, v206
v_add_f32 v249, v249, v207
v_cvt_pk_bf16_f32 v145, v206, v207
v_cvt_pk_bf16_f32 v144, v204, v205
ds_read_b128 v[204:207], v236 offset:9216
v_add_f32 v248, v248, v250
v_rcp_f32 v251, v248
v_sub_f32 v212, v212, v254
v_fmac_f32 v152, v184, v251
v_fmac_f32 v153, v185, v251
v_fmac_f32 v155, v187, v251
v_fmac_f32 v154, v186, v251
v_fmac_f32 v157, v209, v251
v_fmac_f32 v159, v211, v251
v_fmac_f32 v158, v210, v251
v_fmac_f32 v156, v208, v251
v_exp_f32 v212, v212
v_sub_f32 v213, v213, v254
v_exp_f32 v213, v213
v_sub_f32 v214, v214, v254
v_exp_f32 v214, v214
s_waitcnt lgkmcnt(0)
v_mfma_f32_16x16x32_bf16 v[188:191], a[12:15], v[204:207], v[188:191]
v_sub_f32 v215, v215, v254
v_add_f32 v249, v249, v212
v_mfma_f32_16x16x32_bf16 v[184:187], a[28:31], v[204:207], 0
v_exp_f32 v215, v215
v_mfma_f32_16x16x32_bf16 v[184:187], a[24:27], v[192:195], v[184:187]
v_add_f32 v249, v249, v213
v_add_f32 v249, v249, v214
v_mfma_f32_16x16x32_bf16 v[184:187], a[20:23], v[220:223], v[184:187]
v_add_f32 v249, v249, v215
v_cvt_pk_bf16_f32 v147, v214, v215
v_mfma_f32_16x16x32_bf16 v[184:187], a[16:19], v[216:219], v[184:187]
v_cvt_pk_bf16_f32 v146, v212, v213
v_fmac_f32 v163, v231, v251
v_mfma_f32_16x16x32_bf16 v[208:211], a[32:35], v[216:219], 0
v_fmac_f32 v161, v229, v251
v_cvt_pk_bf16_f32 v152, v152, v153
v_mfma_f32_16x16x32_bf16 v[208:211], a[36:39], v[220:223], v[208:211]
v_fmac_f32 v167, v235, v251
v_fmac_f32 v160, v228, v251
v_mfma_f32_16x16x32_bf16 v[208:211], a[40:43], v[192:195], v[208:211]
v_fmac_f32 v164, v232, v251
v_cvt_pk_bf16_f32 v160, v160, v161
v_mfma_f32_16x16x32_bf16 v[208:211], a[44:47], v[204:207], v[208:211]
v_cvt_pk_bf16_f32 v153, v154, v155
v_cvt_pk_bf16_f32 v154, v156, v157
v_mfma_f32_16x16x32_bf16 v[212:215], a[60:63], v[204:207], 0
v_fmac_f32 v166, v234, v251
v_fmac_f32 v162, v230, v251
v_mfma_f32_16x16x32_bf16 v[212:215], a[56:59], v[192:195], v[212:215]
v_fmac_f32 v165, v233, v251
v_cvt_pk_bf16_f32 v155, v158, v159
v_mfma_f32_16x16x32_bf16 v[212:215], a[52:55], v[220:223], v[212:215]
v_cvt_pk_bf16_f32 v161, v162, v163
v_cvt_pk_bf16_f32 v162, v164, v165
v_mfma_f32_16x16x32_bf16 v[212:215], a[48:51], v[216:219], v[212:215]
v_cvt_pk_bf16_f32 v163, v166, v167
v_pk_max_i16 v162, v162, 0
v_pk_max_i16 v161, v161, 0
v_pk_max_i16 v163, v163, 0
v_pk_max_i16 v153, v153, 0
v_pk_max_i16 v155, v155, 0
v_pk_max_i16 v152, v152, 0
v_pk_max_i16 v160, v160, 0
v_pk_max_i16 v154, v154, 0
buffer_store_dwordx4 v[152:155], v239, s[20:23], s52 offen offset:0 nt
buffer_store_dwordx4 v[160:163], v239, s[20:23], s52 offen offset:64 nt
v_cvt_pk_bf16_f32 v112, v188, v189
v_cvt_pk_bf16_f32 v113, v190, v191
v_cvt_pk_bf16_f32 v114, v184, v185
v_cvt_pk_bf16_f32 v115, v186, v187
v_cvt_pk_bf16_f32 v118, v212, v213
v_cvt_pk_bf16_f32 v119, v214, v215
v_cvt_pk_bf16_f32 v116, v208, v209
v_cvt_pk_bf16_f32 v117, v210, v211
v_mfma_f32_16x16x32_bf16 v[152:155], a[192:195], v[216:219], 0
v_sub_f32 v224, v224, v254
v_cvt_pk_bf16_f32 v142, v200, v201
v_mfma_f32_16x16x32_bf16 v[152:155], a[196:199], v[220:223], v[152:155]
v_exp_f32 v224, v224
v_mfma_f32_16x16x32_bf16 v[152:155], a[200:203], v[192:195], v[152:155]
v_cvt_pk_bf16_f32 v141, v198, v199
v_cvt_pk_bf16_f32 v140, v196, v197
v_mfma_f32_16x16x32_bf16 v[152:155], a[204:207], v[204:207], v[152:155]
v_add_f32 v249, v249, v224
v_cvt_pk_bf16_f32 v143, v202, v203
v_mfma_f32_16x16x32_bf16 v[156:159], a[220:223], v[204:207], 0
ds_swizzle_b32 v250, v249 offset:0x401F
v_cvt_pk_bf16_f32 v148, v224, 0
v_mfma_f32_16x16x32_bf16 v[156:159], a[216:219], v[192:195], v[156:159]
v_mfma_f32_16x16x32_bf16 v[156:159], a[212:215], v[220:223], v[156:159]
v_mfma_f32_16x16x32_bf16 v[156:159], a[208:211], v[216:219], v[156:159]
v_mfma_f32_16x16x32_bf16 v[160:163], a[224:227], v[216:219], 0
v_mfma_f32_16x16x32_bf16 v[160:163], a[228:231], v[220:223], v[160:163]
v_mfma_f32_16x16x32_bf16 v[160:163], a[232:235], v[192:195], v[160:163]
s_waitcnt lgkmcnt(0)
v_add_f32 v249, v249, v250
v_mfma_f32_16x16x32_bf16 v[160:163], a[236:239], v[204:207], v[160:163]
ds_bpermute_b32 v250, v247, v249
v_mfma_f32_16x16x32_bf16 v[164:167], a[252:255], v[204:207], 0
v_mfma_f32_16x16x32_bf16 v[164:167], a[248:251], v[192:195], v[164:167]
v_mfma_f32_16x16x32_bf16 v[164:167], a[244:247], v[220:223], v[164:167]
v_mfma_f32_16x16x32_bf16 v[164:167], a[240:243], v[216:219], v[164:167]
v_mfma_f32_16x16x32_bf16 v[184:187], v[0:3], v[112:115], 0
v_mfma_f32_16x16x32_bf16 v[184:187], v[4:7], v[116:119], v[184:187]
s_waitcnt lgkmcnt(0)
v_add_f32 v249, v249, v250
s_nop 0
v_mfma_f32_16x16x32_bf16 v[188:191], v[12:15], v[116:119], 0
v_rcp_f32 v252, v249
v_mfma_f32_16x16x32_bf16 v[188:191], v[8:11], v[112:115], v[188:191]
s_nop 1
v_max3_f32 v254, v184, v185, v186
v_mfma_f32_16x16x32_bf16 v[192:195], v[16:19], v[112:115], 0
s_nop 2
v_mfma_f32_16x16x32_bf16 v[192:195], v[20:23], v[116:119], v[192:195]
v_max3_f32 v254, v254, v187, v188
v_max3_f32 v254, v254, v189, v190
v_mfma_f32_16x16x32_bf16 v[196:199], v[28:31], v[116:119], 0
s_nop 2
v_mfma_f32_16x16x32_bf16 v[196:199], v[24:27], v[112:115], v[196:199]
s_nop 0
v_max3_f32 v254, v254, v191, v192
v_max3_f32 v254, v254, v193, v194
v_mfma_f32_16x16x32_bf16 v[200:203], v[32:35], v[112:115], 0
s_nop 2
v_mfma_f32_16x16x32_bf16 v[200:203], v[36:39], v[116:119], v[200:203]
v_max3_f32 v254, v254, v195, v196
v_max3_f32 v254, v254, v197, v198
v_mfma_f32_16x16x32_bf16 v[204:207], v[44:47], v[116:119], 0
s_nop 2
v_mfma_f32_16x16x32_bf16 v[204:207], v[40:43], v[112:115], v[204:207]
s_nop 0
v_max3_f32 v254, v254, v199, v200
v_max3_f32 v254, v254, v201, v202
v_mfma_f32_16x16x32_bf16 v[208:211], v[48:51], v[112:115], 0
s_nop 2
v_mfma_f32_16x16x32_bf16 v[208:211], v[52:55], v[116:119], v[208:211]
v_max3_f32 v254, v254, v203, v204
v_max3_f32 v254, v254, v205, v206
v_mfma_f32_16x16x32_bf16 v[212:215], v[56:59], v[136:139], 0
s_nop 2
v_mfma_f32_16x16x32_bf16 v[212:215], v[104:107], v[148:151], v[212:215]
s_nop 0
v_max3_f32 v254, v254, v207, v208
v_mfma_f32_16x16x32_bf16 v[212:215], v[72:75], v[140:143], v[212:215]
ds_swizzle_b32 v255, v254 offset:0x401F
v_mfma_f32_16x16x32_bf16 v[212:215], v[88:91], v[144:147], v[212:215]
s_nop 2
v_mfma_f32_16x16x32_bf16 v[216:219], v[92:95], v[144:147], 0
s_nop 2
v_mfma_f32_16x16x32_bf16 v[216:219], v[76:79], v[140:143], v[216:219]
v_fmac_f32 v169, v213, v252
v_fmac_f32 v168, v212, v252
v_mfma_f32_16x16x32_bf16 v[216:219], v[106:109], v[148:151], v[216:219]
v_fmac_f32 v171, v215, v252
v_fmac_f32 v170, v214, v252
v_mfma_f32_16x16x32_bf16 v[216:219], v[60:63], v[136:139], v[216:219]
ds_read_b128 v[220:223], v236 offset:12672
ds_read_b128 v[224:227], v236 offset:12928
v_mfma_f32_16x16x32_bf16 v[228:231], v[64:67], v[136:139], 0
s_waitcnt lgkmcnt(2)
ds_read_b128 v[212:215], v236 offset:13184
v_cvt_pk_bf16_f32 v168, v168, v169
v_mfma_f32_16x16x32_bf16 v[228:231], v[108:111], v[148:151], v[228:231]
s_nop 0
v_fmac_f32 v172, v216, v252
v_fmac_f32 v174, v218, v252
v_mfma_f32_16x16x32_bf16 v[228:231], v[80:83], v[140:143], v[228:231]
v_fmac_f32 v173, v217, v252
v_fmac_f32 v175, v219, v252
v_mfma_f32_16x16x32_bf16 v[228:231], v[96:99], v[144:147], v[228:231]
ds_read_b128 v[216:219], v236 offset:13440
v_cvt_pk_bf16_f32 v169, v170, v171
v_mfma_f32_16x16x32_bf16 v[232:235], v[100:103], v[144:147], 0
v_cvt_pk_bf16_f32 v170, v172, v173
v_cvt_pk_bf16_f32 v171, v174, v175
v_mfma_f32_16x16x32_bf16 v[232:235], v[84:87], v[140:143], v[232:235]
s_waitcnt lgkmcnt(2)
v_pk_max_i16 v170, v170, 0
v_fmac_f32 v178, v230, v252
v_mfma_f32_16x16x32_bf16 v[232:235], v[110:113], v[148:151], v[232:235]
s_waitcnt lgkmcnt(1)
v_fmac_f32 v179, v231, v252
v_fmac_f32 v176, v228, v252
v_mfma_f32_16x16x32_bf16 v[232:235], v[68:71], v[136:139], v[232:235]
v_fmac_f32 v177, v229, v252
v_cvt_pk_bf16_f32 v176, v176, v177
v_mfma_f32_16x16x32_bf16 v[228:231], a[0:3], v[220:223], 0
v_cvt_pk_bf16_f32 v177, v178, v179
v_pk_max_i16 v169, v169, 0
v_mfma_f32_16x16x32_bf16 v[228:231], a[4:7], v[224:227], v[228:231]
s_waitcnt lgkmcnt(0)
v_pk_max_i16 v171, v171, 0
v_fmac_f32 v182, v234, v252
v_mfma_f32_16x16x32_bf16 v[228:231], a[8:11], v[212:215], v[228:231]
v_fmac_f32 v181, v233, v252
v_fmac_f32 v183, v235, v252
v_mfma_f32_16x16x32_bf16 v[228:231], a[12:15], v[216:219], v[228:231]
v_fmac_f32 v180, v232, v252
v_cvt_pk_bf16_f32 v179, v182, v183
v_mfma_f32_16x16x32_bf16 v[232:235], a[28:31], v[216:219], 0
v_cvt_pk_bf16_f32 v178, v180, v181
v_pk_max_i16 v178, v178, 0
v_mfma_f32_16x16x32_bf16 v[232:235], a[24:27], v[212:215], v[232:235]
v_pk_max_i16 v179, v179, 0
v_pk_max_i16 v176, v176, 0
v_mfma_f32_16x16x32_bf16 v[232:235], a[20:23], v[224:227], v[232:235]
v_cvt_pk_bf16_f32 v113, v230, v231
v_cvt_pk_bf16_f32 v112, v228, v229
v_mfma_f32_16x16x32_bf16 v[232:235], a[16:19], v[220:223], v[232:235]
v_pk_max_i16 v168, v168, 0
v_pk_max_i16 v177, v177, 0
v_mfma_f32_16x16x32_bf16 v[228:231], a[32:35], v[220:223], 0
buffer_store_dwordx4 v[168:171], v239, s[20:23], s53 offen offset:0 nt
buffer_store_dwordx4 v[176:179], v239, s[20:23], s53 offen offset:64 nt
v_add_u32 v236, s56, v236
v_max_f32 v254, v254, v255
s_sub_u32 s56, 0, s56
v_cvt_pk_bf16_f32 v115, v234, v235
v_cvt_pk_bf16_f32 v114, v232, v233
v_mfma_f32_16x16x32_bf16 v[228:231], a[36:39], v[224:227], v[228:231]
ds_bpermute_b32 v255, v247, v254
v_mfma_f32_16x16x32_bf16 v[228:231], a[40:43], v[212:215], v[228:231]
v_mfma_f32_16x16x32_bf16 v[228:231], a[44:47], v[216:219], v[228:231]
s_nop 2
v_mfma_f32_16x16x32_bf16 v[232:235], a[60:63], v[216:219], 0
s_nop 2
v_mfma_f32_16x16x32_bf16 v[232:235], a[56:59], v[212:215], v[232:235]
v_cvt_pk_bf16_f32 v116, v228, v229
v_cvt_pk_bf16_f32 v117, v230, v231
v_mfma_f32_16x16x32_bf16 v[232:235], a[52:55], v[224:227], v[232:235]
v_mfma_f32_16x16x32_bf16 v[232:235], a[48:51], v[220:223], v[232:235]
s_waitcnt lgkmcnt(0)
v_max_f32 v254, v254, v255
v_sub_f32 v184, v184, v254
v_mfma_f32_16x16x32_bf16 v[168:171], a[192:195], v[220:223], 0
v_exp_f32 v184, v184
v_mfma_f32_16x16x32_bf16 v[168:171], a[196:199], v[224:227], v[168:171]
v_sub_f32 v185, v185, v254
v_sub_f32 v186, v186, v254
v_mfma_f32_16x16x32_bf16 v[168:171], a[200:203], v[212:215], v[168:171]
v_cvt_pk_bf16_f32 v119, v234, v235
v_cvt_pk_bf16_f32 v118, v232, v233
v_mfma_f32_16x16x32_bf16 v[168:171], a[204:207], v[216:219], v[168:171]
v_exp_f32 v186, v186
v_mfma_f32_16x16x32_bf16 v[172:175], a[220:223], v[216:219], 0
v_exp_f32 v185, v185
v_mfma_f32_16x16x32_bf16 v[172:175], a[216:219], v[212:215], v[172:175]
v_sub_f32 v189, v189, v254
v_sub_f32 v187, v187, v254
v_mfma_f32_16x16x32_bf16 v[172:175], a[212:215], v[224:227], v[172:175]
v_sub_f32 v188, v188, v254
v_sub_f32 v190, v190, v254
v_mfma_f32_16x16x32_bf16 v[172:175], a[208:211], v[220:223], v[172:175]
s_cmp_lg_u32 s45, 0
s_cbranch_scc1 L_loops
v_mfma_f32_16x16x32_bf16 v[176:179], a[224:227], v[220:223], 0
s_waitcnt vmcnt(8)
s_barrier
v_mfma_f32_16x16x32_bf16 v[176:179], a[228:231], v[224:227], v[176:179]
s_add_u32 s52, s47, 8192
ds_read_b128 v[232:235], v236 offset:0
v_add_f32 v248, v184, v185
v_mfma_f32_16x16x32_bf16 v[176:179], a[232:235], v[212:215], v[176:179]
s_add_u32 s53, s47, 12288
v_exp_f32 v188, v188
v_mfma_f32_16x16x32_bf16 v[176:179], a[236:239], v[216:219], v[176:179]
v_add_f32 v248, v248, v186
v_sub_f32 v191, v191, v254
v_mfma_f32_16x16x32_bf16 v[180:183], a[252:255], v[216:219], 0
v_exp_f32 v187, v187
v_mfma_f32_16x16x32_bf16 v[180:183], a[248:251], v[212:215], v[180:183]
v_exp_f32 v190, v190
v_mfma_f32_16x16x32_bf16 v[180:183], a[244:247], v[224:227], v[180:183]
v_add_f32 v248, v248, v187
v_add_f32 v248, v248, v188
v_mfma_f32_16x16x32_bf16 v[180:183], a[240:243], v[220:223], v[180:183]
s_waitcnt lgkmcnt(0)
v_exp_f32 v189, v189
v_mfma_f32_16x16x32_bf16 v[228:231], v[0:3], v[112:115], 0
v_add_f32 v248, v248, v189
v_add_f32 v248, v248, v190
v_mfma_f32_16x16x32_bf16 v[228:231], v[4:7], v[116:119], v[228:231]
v_exp_f32 v191, v191
v_cvt_pk_bf16_f32 v122, v188, v189
v_add_f32 v248, v248, v191
v_cvt_pk_bf16_f32 v123, v190, v191
v_mfma_f32_16x16x32_bf16 v[188:191], v[12:15], v[116:119], 0
v_sub_f32 v193, v193, v254
v_sub_f32 v194, v194, v254
v_mfma_f32_16x16x32_bf16 v[188:191], v[8:11], v[112:115], v[188:191]
v_sub_f32 v195, v195, v254
v_exp_f32 v194, v194
v_sub_f32 v192, v192, v254
v_exp_f32 v192, v192
v_sub_f32 v196, v196, v254
v_exp_f32 v193, v193
v_sub_f32 v197, v197, v254
v_sub_f32 v199, v199, v254
v_sub_f32 v198, v198, v254
v_exp_f32 v195, v195
v_add_f32 v248, v248, v192
v_add_f32 v248, v248, v193
v_exp_f32 v196, v196
v_exp_f32 v197, v197
v_add_f32 v248, v248, v194
v_add_f32 v248, v248, v195
v_add_f32 v248, v248, v196
v_add_f32 v248, v248, v197
v_exp_f32 v198, v198
v_sub_f32 v200, v200, v254
v_sub_f32 v203, v203, v254
v_exp_f32 v199, v199
v_sub_f32 v201, v201, v254
v_exp_f32 v201, v201
v_sub_f32 v202, v202, v254
v_exp_f32 v202, v202
v_add_f32 v248, v248, v198
v_exp_f32 v200, v200
v_add_f32 v248, v248, v199
v_add_f32 v248, v248, v200
v_add_f32 v248, v248, v201
v_exp_f32 v203, v203
v_add_f32 v248, v248, v202
v_add_f32 v248, v248, v203
v_cvt_pk_bf16_f32 v128, v200, v201
v_cvt_pk_bf16_f32 v129, v202, v203
v_mfma_f32_16x16x32_bf16 v[200:203], v[16:19], v[112:115], 0
v_sub_f32 v204, v204, v254
v_sub_f32 v205, v205, v254
v_mfma_f32_16x16x32_bf16 v[200:203], v[20:23], v[116:119], v[200:203]
v_exp_f32 v204, v204
v_sub_f32 v206, v206, v254
v_add_f32 v248, v248, v204
v_exp_f32 v206, v206
v_sub_f32 v207, v207, v254
v_exp_f32 v205, v205
v_exp_f32 v207, v207
v_add_f32 v248, v248, v205
v_add_f32 v248, v248, v206
v_add_f32 v248, v248, v207
v_cvt_pk_bf16_f32 v130, v204, v205
v_cvt_pk_bf16_f32 v131, v206, v207
v_mfma_f32_16x16x32_bf16 v[204:207], v[28:31], v[116:119], 0
v_sub_f32 v208, v208, v254
v_cvt_pk_bf16_f32 v120, v184, v185
v_mfma_f32_16x16x32_bf16 v[204:207], v[24:27], v[112:115], v[204:207]
v_exp_f32 v208, v208
s_nop 0
v_add_f32 v248, v248, v208
v_cvt_pk_bf16_f32 v132, v208, 0
v_mfma_f32_16x16x32_bf16 v[208:211], v[32:35], v[112:115], 0
ds_swizzle_b32 v250, v248 offset:0x401F
v_cvt_pk_bf16_f32 v121, v186, v187
v_mfma_f32_16x16x32_bf16 v[208:211], v[36:39], v[116:119], v[208:211]
ds_read_b128 v[184:187], v236 offset:256
v_cvt_pk_bf16_f32 v126, v196, v197
v_mfma_f32_16x16x32_bf16 v[212:215], v[44:47], v[116:119], 0
v_cvt_pk_bf16_f32 v125, v194, v195
v_cvt_pk_bf16_f32 v127, v198, v199
v_mfma_f32_16x16x32_bf16 v[212:215], v[40:43], v[112:115], v[212:215]
ds_read_b128 v[196:199], v236 offset:768
v_cvt_pk_bf16_f32 v124, v192, v193
v_mfma_f32_16x16x32_bf16 v[216:219], v[48:51], v[112:115], 0
ds_read_b128 v[192:195], v236 offset:512
v_max3_f32 v254, v228, v229, v230
v_mfma_f32_16x16x32_bf16 v[216:219], v[52:55], v[116:119], v[216:219]
v_max3_f32 v254, v254, v231, v188
v_max3_f32 v254, v254, v189, v190
v_mfma_f32_16x16x32_bf16 v[220:223], v[56:59], v[120:123], 0
s_waitcnt lgkmcnt(3)
v_add_f32 v248, v248, v250
v_max3_f32 v254, v254, v191, v200
v_mfma_f32_16x16x32_bf16 v[220:223], v[104:107], v[132:135], v[220:223]
s_waitcnt lgkmcnt(2)
ds_bpermute_b32 v250, v247, v248
v_mfma_f32_16x16x32_bf16 v[220:223], v[72:75], v[124:127], v[220:223]
v_max3_f32 v254, v254, v201, v202
v_max3_f32 v254, v254, v203, v204
v_mfma_f32_16x16x32_bf16 v[220:223], v[88:91], v[128:131], v[220:223]
s_waitcnt lgkmcnt(2)
v_max3_f32 v254, v254, v205, v206
v_max3_f32 v254, v254, v207, v208
v_mfma_f32_16x16x32_bf16 v[224:227], v[92:95], v[128:131], 0
s_waitcnt lgkmcnt(1)
v_max3_f32 v254, v254, v209, v210
v_max3_f32 v254, v254, v211, v212
v_mfma_f32_16x16x32_bf16 v[224:227], v[76:79], v[124:127], v[224:227]
v_max3_f32 v254, v254, v213, v214
v_max3_f32 v254, v254, v215, v216
v_mfma_f32_16x16x32_bf16 v[224:227], v[106:109], v[132:135], v[224:227]
ds_swizzle_b32 v255, v254 offset:0x401F
v_mbcnt_lo_u32_b32 v242, -1, 0
v_mfma_f32_16x16x32_bf16 v[224:227], v[60:63], v[120:123], v[224:227]
s_waitcnt lgkmcnt(1)
v_add_f32 v248, v248, v250
v_rcp_f32 v251, v248
s_nop 0
v_fmac_f32 v152, v220, v251
v_fmac_f32 v153, v221, v251
v_fmac_f32 v154, v222, v251
v_fmac_f32 v155, v223, v251
v_mfma_f32_16x16x32_bf16 v[220:223], v[64:67], v[120:123], 0
v_fmac_f32 v156, v224, v251
v_fmac_f32 v157, v225, v251
v_mfma_f32_16x16x32_bf16 v[220:223], v[108:111], v[132:135], v[220:223]
v_fmac_f32 v158, v226, v251
v_fmac_f32 v159, v227, v251
v_mfma_f32_16x16x32_bf16 v[220:223], v[80:83], v[124:127], v[220:223]
s_waitcnt lgkmcnt(0)
v_cvt_pk_bf16_f32 v152, v152, v153
v_cvt_pk_bf16_f32 v153, v154, v155
v_mfma_f32_16x16x32_bf16 v[220:223], v[96:99], v[128:131], v[220:223]
v_cvt_pk_bf16_f32 v154, v156, v157
v_cvt_pk_bf16_f32 v155, v158, v159
v_mfma_f32_16x16x32_bf16 v[224:227], v[100:103], v[128:131], 0
v_pk_max_i16 v152, v152, 0
v_pk_max_i16 v153, v153, 0
v_mfma_f32_16x16x32_bf16 v[224:227], v[84:87], v[124:127], v[224:227]
v_max_f32 v254, v254, v255
v_pk_max_i16 v154, v154, 0
v_mfma_f32_16x16x32_bf16 v[224:227], v[110:113], v[132:135], v[224:227]
ds_bpermute_b32 v255, v247, v254
v_mfma_f32_16x16x32_bf16 v[224:227], v[68:71], v[120:123], v[224:227]
v_fmac_f32 v160, v220, v251
v_fmac_f32 v161, v221, v251
v_mfma_f32_16x16x32_bf16 v[0:3], a[192:195], v[232:235], 0
v_fmac_f32 v162, v222, v251
v_fmac_f32 v163, v223, v251
v_mfma_f32_16x16x32_bf16 v[0:3], a[196:199], v[184:187], v[0:3]
v_cvt_pk_bf16_f32 v160, v160, v161
v_cvt_pk_bf16_f32 v161, v162, v163
v_mfma_f32_16x16x32_bf16 v[0:3], a[200:203], v[192:195], v[0:3]
v_fmac_f32 v164, v224, v251
v_fmac_f32 v165, v225, v251
v_mfma_f32_16x16x32_bf16 v[0:3], a[204:207], v[196:199], v[0:3]
v_fmac_f32 v166, v226, v251
v_fmac_f32 v167, v227, v251
v_mfma_f32_16x16x32_bf16 v[4:7], a[220:223], v[196:199], 0
s_waitcnt lgkmcnt(0)
v_max_f32 v254, v254, v255
v_sub_f32 v228, v228, v254
v_mfma_f32_16x16x32_bf16 v[4:7], a[216:219], v[192:195], v[4:7]
v_sub_f32 v229, v229, v254
v_sub_f32 v230, v230, v254
v_mfma_f32_16x16x32_bf16 v[4:7], a[212:215], v[184:187], v[4:7]
v_exp_f32 v228, v228
v_mfma_f32_16x16x32_bf16 v[4:7], a[208:211], v[232:235], v[4:7]
ds_read_b128 v[220:223], v236 offset:4224
v_sub_f32 v231, v231, v254
v_mfma_f32_16x16x32_bf16 v[8:11], a[224:227], v[232:235], 0
v_exp_f32 v229, v229
v_mfma_f32_16x16x32_bf16 v[8:11], a[228:231], v[184:187], v[8:11]
v_exp_f32 v230, v230
v_mfma_f32_16x16x32_bf16 v[8:11], a[232:235], v[192:195], v[8:11]
v_exp_f32 v231, v231
v_mfma_f32_16x16x32_bf16 v[8:11], a[236:239], v[196:199], v[8:11]
v_add_f32 v249, v228, v229
v_add_f32 v249, v249, v230
v_mfma_f32_16x16x32_bf16 v[12:15], a[252:255], v[196:199], 0
ds_read_b128 v[196:199], v236 offset:4736
v_add_f32 v249, v249, v231
v_mfma_f32_16x16x32_bf16 v[12:15], a[248:251], v[192:195], v[12:15]
s_waitcnt lgkmcnt(1)
ds_read_b128 v[192:195], v236 offset:4992
v_cvt_pk_bf16_f32 v136, v228, v229
v_mfma_f32_16x16x32_bf16 v[12:15], a[244:247], v[184:187], v[12:15]
v_cvt_pk_bf16_f32 v137, v230, v231
v_sub_f32 v188, v188, v254
v_mfma_f32_16x16x32_bf16 v[12:15], a[240:243], v[232:235], v[12:15]
ds_read_b128 v[228:231], v236 offset:4480
v_sub_f32 v189, v189, v254
v_mfma_f32_16x16x32_bf16 v[16:19], a[192:195], v[220:223], 0
v_exp_f32 v188, v188
v_exp_f32 v189, v189
v_sub_f32 v190, v190, v254
v_cvt_pk_bf16_f32 v138, v188, v189
v_sub_f32 v191, v191, v254
v_exp_f32 v190, v190
v_exp_f32 v191, v191
v_sub_f32 v216, v216, v254
v_cvt_pk_bf16_f32 v139, v190, v191
v_exp_f32 v216, v216
v_sub_f32 v200, v200, v254
v_cvt_pk_bf16_f32 v148, v216, 0
s_waitcnt lgkmcnt(0)
v_mfma_f32_16x16x32_bf16 v[16:19], a[196:199], v[228:231], v[16:19]
v_sub_f32 v201, v201, v254
v_sub_f32 v202, v202, v254
v_mfma_f32_16x16x32_bf16 v[16:19], a[200:203], v[196:199], v[16:19]
v_exp_f32 v200, v200
v_mfma_f32_16x16x32_bf16 v[16:19], a[204:207], v[192:195], v[16:19]
v_exp_f32 v201, v201
v_mfma_f32_16x16x32_bf16 v[20:23], a[220:223], v[192:195], 0
v_exp_f32 v202, v202
v_mfma_f32_16x16x32_bf16 v[20:23], a[216:219], v[196:199], v[20:23]
v_sub_f32 v203, v203, v254
v_sub_f32 v204, v204, v254
v_mfma_f32_16x16x32_bf16 v[20:23], a[212:215], v[228:231], v[20:23]
v_exp_f32 v203, v203
v_mfma_f32_16x16x32_bf16 v[20:23], a[208:211], v[220:223], v[20:23]
v_exp_f32 v204, v204
v_mfma_f32_16x16x32_bf16 v[24:27], a[224:227], v[220:223], 0
v_sub_f32 v205, v205, v254
v_sub_f32 v206, v206, v254
v_mfma_f32_16x16x32_bf16 v[24:27], a[228:231], v[228:231], v[24:27]
v_exp_f32 v205, v205
v_mfma_f32_16x16x32_bf16 v[24:27], a[232:235], v[196:199], v[24:27]
v_exp_f32 v206, v206
v_mfma_f32_16x16x32_bf16 v[24:27], a[236:239], v[192:195], v[24:27]
v_sub_f32 v207, v207, v254
v_cvt_pk_bf16_f32 v140, v200, v201
v_mfma_f32_16x16x32_bf16 v[28:31], a[252:255], v[192:195], 0
v_exp_f32 v207, v207
v_mfma_f32_16x16x32_bf16 v[28:31], a[248:251], v[196:199], v[28:31]
v_cvt_pk_bf16_f32 v141, v202, v203
v_cvt_pk_bf16_f32 v142, v204, v205
v_mfma_f32_16x16x32_bf16 v[28:31], a[244:247], v[228:231], v[28:31]
v_cvt_pk_bf16_f32 v143, v206, v207
v_sub_f32 v208, v208, v254
v_mfma_f32_16x16x32_bf16 v[28:31], a[240:243], v[220:223], v[28:31]
v_sub_f32 v209, v209, v254
v_sub_f32 v210, v210, v254
v_mfma_f32_16x16x32_bf16 v[228:231], v[56:59], v[136:139], 0
v_exp_f32 v208, v208
v_mfma_f32_16x16x32_bf16 v[228:231], v[104:107], v[148:151], v[228:231]
v_exp_f32 v209, v209
v_mfma_f32_16x16x32_bf16 v[228:231], v[72:75], v[140:143], v[228:231]
v_exp_f32 v210, v210
v_sub_f32 v211, v211, v254
v_exp_f32 v211, v211
v_sub_f32 v212, v212, v254
v_exp_f32 v212, v212
v_sub_f32 v213, v213, v254
v_exp_f32 v213, v213
v_sub_f32 v214, v214, v254
v_exp_f32 v214, v214
v_sub_f32 v215, v215, v254
v_exp_f32 v215, v215
v_cvt_pk_bf16_f32 v144, v208, v209
v_cvt_pk_bf16_f32 v145, v210, v211
v_cvt_pk_bf16_f32 v146, v212, v213
v_cvt_pk_bf16_f32 v147, v214, v215
v_cvt_pk_bf16_f32 v162, v164, v165
v_cvt_pk_bf16_f32 v163, v166, v167
v_mfma_f32_16x16x32_bf16 v[228:231], v[88:91], v[144:147], v[228:231]
v_pk_max_i16 v155, v155, 0
v_pk_max_i16 v160, v160, 0
v_mfma_f32_16x16x32_bf16 v[192:195], v[92:95], v[144:147], 0
v_pk_max_i16 v161, v161, 0
v_pk_max_i16 v162, v162, 0
v_mfma_f32_16x16x32_bf16 v[192:195], v[76:79], v[140:143], v[192:195]
v_pk_max_i16 v163, v163, 0
v_mbcnt_hi_u32_b32 v242, -1, v242
v_mfma_f32_16x16x32_bf16 v[192:195], v[106:109], v[148:151], v[192:195]
buffer_store_dwordx4 v[152:155], v239, s[20:23], s52 offen offset:0 nt
buffer_store_dwordx4 v[160:163], v239, s[20:23], s52 offen offset:64 nt
s_mul_i32 s54, s41, 12288
s_add_u32 s54, s54, 105472
v_mov_b32 v244, s54
v_bfe_u32 v243, v242, 0, 4
v_lshl_add_u32 v244, v243, 7, v244
v_lshlrev_b32 v243, 4, v242
v_xor_b32 v243, v243, v242
v_and_b32 v243, 48, v243
v_mfma_f32_16x16x32_bf16 v[192:195], v[60:63], v[136:139], v[192:195]
v_add_u32 v244, v243, v244
v_add_u32 v244, v243, v244
v_mfma_f32_16x16x32_bf16 v[220:223], v[64:67], v[136:139], 0
ds_read_b128 v[184:187], v244 offset:0
ds_read_b128 v[232:235], v244 offset:16
v_mfma_f32_16x16x32_bf16 v[220:223], v[108:111], v[148:151], v[220:223]
ds_read_b128 v[196:199], v244 offset:2048
v_add_f32 v249, v249, v188
v_mfma_f32_16x16x32_bf16 v[220:223], v[80:83], v[140:143], v[220:223]
ds_read_b32 v188, v244 offset:4096
v_add_f32 v249, v249, v189
v_mfma_f32_16x16x32_bf16 v[220:223], v[96:99], v[144:147], v[220:223]
v_add_f32 v249, v249, v190
v_add_f32 v249, v249, v191
v_mfma_f32_16x16x32_bf16 v[224:227], v[100:103], v[144:147], 0
v_mov_b32 v245, 24576
v_bfe_u32 v243, v242, 0, 2
v_mfma_f32_16x16x32_bf16 v[224:227], v[84:87], v[140:143], v[224:227]
v_lshl_add_u32 v245, v243, 8, v245
v_bfe_u32 v243, v242, 2, 2
v_mfma_f32_16x16x32_bf16 v[224:227], v[110:113], v[148:151], v[224:227]
s_waitcnt lgkmcnt(2)
v_lshlrev_b32 v190, 16, v184
v_lshlrev_b32 v191, 16, v185
v_mfma_f32_16x16x32_bf16 v[224:227], v[68:71], v[136:139], v[224:227]
s_waitcnt lgkmcnt(1)
s_waitcnt lgkmcnt(0)
ds_swizzle_b32 v189, v188 offset:0x401F
v_and_b32 v184, 0xffff0000, v184
v_and_b32 v185, 0xffff0000, v185
v_mul_u32_u24 v243, 13107200, v243
v_add_u32 v245, v243, v245
s_lshl_b32 s48, s43, 7
s_add_u32 s48, s48, s44
s_add_u32 s48, s48, 0
v_bfe_u32 v243, v242, 4, 2
v_lshl_add_u32 v245, v243, 4, v245
v_add_f32 v249, v249, v200
v_add_f32 v249, v249, v201
v_add_f32 v249, v249, v202
v_add_f32 v249, v249, v203
ds_read_b128 v[200:203], v244 offset:2064
v_add_f32 v249, v249, v204
ds_read_b32 v204, v244 offset:6144
v_add_f32 v249, v249, v205
v_add_f32 v249, v249, v206
v_add_f32 v249, v249, v207
v_add_f32 v249, v249, v208
v_add_f32 v249, v249, v209
v_add_f32 v249, v249, v210
v_add_f32 v249, v249, v211
v_add_f32 v249, v249, v212
v_add_f32 v249, v249, v213
v_add_f32 v249, v249, v214
v_add_f32 v249, v249, v215
v_add_f32 v249, v249, v216
ds_swizzle_b32 v250, v249 offset:0x401F
v_lshlrev_b32 v206, 16, v196
v_lshlrev_b32 v207, 16, v197
v_and_b32 v196, 0xffff0000, v196
v_and_b32 v197, 0xffff0000, v197
s_waitcnt lgkmcnt(1)
ds_swizzle_b32 v205, v204 offset:0x401F
v_add_f32 v188, v188, v189
ds_bpermute_b32 v189, v247, v188
s_lshl_b32 s51, s43, 7
s_add_u32 s51, s51, s44
s_add_u32 s51, s51, 52428800
s_waitcnt lgkmcnt(2)
v_add_f32 v249, v249, v250
ds_bpermute_b32 v250, v247, v249
s_waitcnt lgkmcnt(2)
v_add_f32 v204, v204, v205
ds_bpermute_b32 v205, v247, v204
s_waitcnt lgkmcnt(2)
v_add_f32 v188, v188, v189
v_rcp_f32 v189, v188
s_nop 0
v_fmac_f32 v0, v190, v189
v_fmac_f32 v2, v191, v189
v_lshlrev_b32 v190, 16, v186
v_lshlrev_b32 v191, 16, v187
v_fmac_f32 v4, v190, v189
v_fmac_f32 v6, v191, v189
v_lshlrev_b32 v190, 16, v232
v_lshlrev_b32 v191, 16, v233
v_and_b32 v232, 0xffff0000, v232
v_fmac_f32 v8, v190, v189
v_fmac_f32 v10, v191, v189
v_fmac_f32 v1, v184, v189
v_fmac_f32 v9, v232, v189
v_and_b32 v233, 0xffff0000, v233
v_lshlrev_b32 v190, 16, v234
v_lshlrev_b32 v191, 16, v235
v_fmac_f32 v3, v185, v189
v_and_b32 v186, 0xffff0000, v186
v_and_b32 v187, 0xffff0000, v187
v_fmac_f32 v11, v233, v189
v_and_b32 v234, 0xffff0000, v234
v_and_b32 v235, 0xffff0000, v235
v_cvt_pk_bf16_f32 v0, v0, v1
v_cvt_pk_bf16_f32 v8, v8, v9
v_fmac_f32 v5, v186, v189
v_fmac_f32 v7, v187, v189
v_fmac_f32 v12, v190, v189
v_fmac_f32 v13, v234, v189
v_fmac_f32 v14, v191, v189
v_fmac_f32 v15, v235, v189
v_cvt_pk_bf16_f32 v1, v2, v3
v_cvt_pk_bf16_f32 v9, v10, v11
v_cvt_pk_bf16_f32 v2, v4, v5
v_cvt_pk_bf16_f32 v3, v6, v7
v_cvt_pk_bf16_f32 v10, v12, v13
v_cvt_pk_bf16_f32 v11, v14, v15
v_pk_max_i16 v0, v0, 0
v_pk_max_i16 v1, v1, 0
v_pk_max_i16 v2, v2, 0
v_pk_max_i16 v3, v3, 0
v_pk_max_i16 v8, v8, 0
v_pk_max_i16 v9, v9, 0
v_pk_max_i16 v10, v10, 0
v_pk_max_i16 v11, v11, 0
buffer_store_dwordx4 v[0:3], v245, s[20:23], s48 offen offset:0 nt
buffer_store_dwordx4 v[8:11], v245, s[20:23], s48 offen offset:64 nt
s_waitcnt lgkmcnt(1)
v_add_f32 v249, v249, v250
v_rcp_f32 v252, v249
s_nop 0
v_fmac_f32 v168, v228, v252
v_fmac_f32 v169, v229, v252
v_fmac_f32 v176, v220, v252
v_fmac_f32 v177, v221, v252
v_fmac_f32 v170, v230, v252
v_fmac_f32 v171, v231, v252
v_cvt_pk_bf16_f32 v168, v168, v169
v_fmac_f32 v178, v222, v252
v_fmac_f32 v179, v223, v252
v_cvt_pk_bf16_f32 v176, v176, v177
v_fmac_f32 v172, v192, v252
v_fmac_f32 v173, v193, v252
v_fmac_f32 v174, v194, v252
v_fmac_f32 v175, v195, v252
v_cvt_pk_bf16_f32 v169, v170, v171
v_fmac_f32 v180, v224, v252
v_fmac_f32 v181, v225, v252
v_fmac_f32 v182, v226, v252
v_fmac_f32 v183, v227, v252
v_cvt_pk_bf16_f32 v177, v178, v179
v_cvt_pk_bf16_f32 v170, v172, v173
v_cvt_pk_bf16_f32 v171, v174, v175
v_cvt_pk_bf16_f32 v178, v180, v181
v_cvt_pk_bf16_f32 v179, v182, v183
v_pk_max_i16 v168, v168, 0
v_pk_max_i16 v169, v169, 0
v_pk_max_i16 v170, v170, 0
v_pk_max_i16 v171, v171, 0
v_pk_max_i16 v176, v176, 0
v_pk_max_i16 v177, v177, 0
v_pk_max_i16 v178, v178, 0
v_pk_max_i16 v179, v179, 0
buffer_store_dwordx4 v[168:171], v239, s[20:23], s53 offen offset:0 nt
buffer_store_dwordx4 v[176:179], v239, s[20:23], s53 offen offset:64 nt
s_waitcnt lgkmcnt(0)
v_add_f32 v204, v204, v205
v_rcp_f32 v205, v204
s_nop 0
v_fmac_f32 v16, v206, v205
v_fmac_f32 v18, v207, v205
v_lshlrev_b32 v206, 16, v198
v_lshlrev_b32 v207, 16, v199
v_fmac_f32 v20, v206, v205
v_fmac_f32 v22, v207, v205
v_lshlrev_b32 v206, 16, v200
v_lshlrev_b32 v207, 16, v201
v_and_b32 v200, 0xffff0000, v200
v_fmac_f32 v24, v206, v205
v_fmac_f32 v26, v207, v205
v_fmac_f32 v17, v196, v205
v_fmac_f32 v25, v200, v205
v_and_b32 v201, 0xffff0000, v201
v_lshlrev_b32 v206, 16, v202
v_lshlrev_b32 v207, 16, v203
v_fmac_f32 v19, v197, v205
v_and_b32 v198, 0xffff0000, v198
v_and_b32 v199, 0xffff0000, v199
v_fmac_f32 v27, v201, v205
v_and_b32 v202, 0xffff0000, v202
v_and_b32 v203, 0xffff0000, v203
v_cvt_pk_bf16_f32 v16, v16, v17
v_cvt_pk_bf16_f32 v24, v24, v25
v_fmac_f32 v21, v198, v205
v_fmac_f32 v23, v199, v205
v_fmac_f32 v28, v206, v205
v_fmac_f32 v29, v202, v205
v_fmac_f32 v30, v207, v205
v_fmac_f32 v31, v203, v205
v_cvt_pk_bf16_f32 v17, v18, v19
v_cvt_pk_bf16_f32 v25, v26, v27
v_cvt_pk_bf16_f32 v18, v20, v21
v_cvt_pk_bf16_f32 v19, v22, v23
v_cvt_pk_bf16_f32 v26, v28, v29
v_cvt_pk_bf16_f32 v27, v30, v31
v_pk_max_i16 v16, v16, 0
v_pk_max_i16 v17, v17, 0
v_pk_max_i16 v18, v18, 0
v_pk_max_i16 v19, v19, 0
v_pk_max_i16 v24, v24, 0
v_pk_max_i16 v25, v25, 0
v_pk_max_i16 v26, v26, 0
v_pk_max_i16 v27, v27, 0
buffer_store_dwordx4 v[16:19], v245, s[20:23], s51 offen offset:0 nt
buffer_store_dwordx4 v[24:27], v245, s[20:23], s51 offen offset:64 nt
L_end:
s_endpgm
.section .rodata,"a"
.p2align 6
.amdhsa_kernel standalone__attention_interact_autoint__recsys_kernel
  .amdhsa_next_free_vgpr 512
  .amdhsa_next_free_sgpr 102
  .amdhsa_accum_offset 256
  .amdhsa_group_segment_fixed_size 0
  .amdhsa_kernarg_size 64
  .amdhsa_user_sgpr_count 2
  .amdhsa_user_sgpr_kernarg_segment_ptr 1
  .amdhsa_system_sgpr_workgroup_id_x 1
.end_amdhsa_kernel
```

```asm
; @launch grid=(256,1,1) block=(256,1,1) lds=163840
.amdgcn_target "amdgcn-amd-amdhsa--gfx950"
.text
.globl standalone__attention_interact_autoint__recsys_kernel
.p2align 8
.type standalone__attention_interact_autoint__recsys_kernel,@function
standalone__attention_interact_autoint__recsys_kernel:
s_cmp_ge_u32 s2, 256
s_cbranch_scc1 L_end
s_load_dwordx2 s[24:25], s[0:1], 8
s_load_dwordx2 s[16:17], s[0:1], 0
s_load_dwordx2 s[28:29], s[0:1], 16
s_load_dwordx2 s[32:33], s[0:1], 24
s_load_dwordx2 s[36:37], s[0:1], 32
s_load_dwordx2 s[20:21], s[0:1], 40
s_getpc_b64 s[58:59]
L_pc:
s_lshl_b32 s3, s2, 8
s_and_b32 s3, s3, 0x7800
v_lshrrev_b32 v2, 4, v0
v_lshl_add_u32 v2, v2, 7, s3
v_min_u32 v2, L_fast_end-L_pc-4, v2
global_load_dword v96, v2, s[58:59]
v_lshrrev_b32 v1, 6, v0
s_mov_b32 s19, 0x20000
v_readfirstlane_b32 s41, v1
s_mov_b32 s18, 104857600
s_mov_b32 s26, 32768
s_mov_b32 s27, s19
s_lshr_b32 s42, s41, 1
s_and_b32 s43, s41, 1
s_lshl1_add_u32 s44, s2, s42
s_mul_i32 s44, s44, 25600
s_mov_b64 s[30:31], s[26:27]
s_mov_b64 s[34:35], s[26:27]
s_mov_b64 s[38:39], s[26:27]
s_lshl_b32 s54, s41, 13
s_mul_i32 s49, s42, 25344
s_mul_i32 s53, s43, 1056
s_add_u32 s49, s49, s53
s_lshl_b32 s55, s43, 10
s_add_u32 s55, s55, s44
s_lshl_b32 s6, s2, 7
s_and_b32 s6, s6, 0x7c00
s_add_u32 s57, s54, 4096
s_add_u32 m0, s49, 21120
s_add_u32 s48, s55, 20480
v_and_b32 v168, 63, v0
v_lshlrev_b32 v175, 4, v168
v_and_b32 v243, 48, v175
v_and_b32 v169, 48, v168
v_lshl_add_u32 v243, v169, 2, v243
v_and_b32 v169, 12, v168
v_lshl_add_u32 v243, v169, 6, v243
v_lshrrev_b32 v169, 5, v0
v_lshlrev_b32 v169, 7, v169
s_waitcnt lgkmcnt(0)
buffer_load_dword v97, v169, s[24:27], s6 offen
buffer_load_dword v98, v169, s[28:31], s6 offen
buffer_load_dword v99, v169, s[32:35], s6 offen
buffer_load_dword v100, v169, s[36:39], s6 offen
buffer_load_dwordx4 v[104:107], v175, s[24:27], s54 offen offset:0
buffer_load_dwordx4 v[108:111], v175, s[24:27], s54 offen offset:1024
buffer_load_dwordx4 v[112:115], v175, s[24:27], s54 offen offset:2048
buffer_load_dwordx4 v[116:119], v175, s[24:27], s54 offen offset:3072
buffer_load_dwordx4 v[120:123], v175, s[24:27], s57 offen offset:0
buffer_load_dwordx4 v[124:127], v175, s[24:27], s57 offen offset:1024
buffer_load_dwordx4 v[128:131], v175, s[24:27], s57 offen offset:2048
buffer_load_dwordx4 v[132:135], v175, s[24:27], s57 offen offset:3072
s_mov_b32 s40, 0x3e38aa3b
s_mov_b32 s22, s18
s_mov_b32 s23, s19
s_mov_b32 s45, 8
s_mov_b32 s3, 64
s_mov_b32 s46, s44
s_mov_b32 s47, 0x7ff00000
s_mov_b32 s56, 50688
s_mov_b32 s96, 0x3b8265d9
s_mov_b32 s97, 0
s_mov_b32 s14, 0x55555555
s_mov_b32 s15, 0x55555555
s_mul_i32 s98, s42, 25344
s_lshl_b32 s53, s43, 13
s_add_u32 s98, s98, s53
s_add_u32 s53, s98, 4224
v_and_b32 v169, 16, v168
v_mov_b32 v180, v169
v_lshlrev_b32 v169, 1, v169
v_xor_b32 v170, v175, v169
v_add_u32 v172, s53, v170
v_xor_b32 v171, 64, v170
v_add_u32 v173, s53, v171
s_mul_i32 s53, s43, 25344
s_add_u32 s7, s53, 4224
v_lshrrev_b32 v82, 4, v168
v_lshl_add_u32 v176, v82, 10, s7
v_bfe_u32 v83, v168, 2, 2
v_lshl_add_u32 v176, v83, 7, v176
v_bfe_u32 v84, v168, 3, 1
v_lshl_add_u32 v176, v84, 5, v176
v_bfe_u32 v85, v168, 4, 1
v_lshl_add_u32 v176, v85, 6, v176
v_and_b32 v86, 3, v168
v_lshl_add_u32 v176, v86, 3, v176
v_xor_b32 v177, 32, v176
v_xor_b32 v178, 64, v176
s_mul_i32 s53, s42, 25344
v_lshl_add_u32 v242, v86, 6, s53
v_lshl_add_u32 v242, v82, 4, v242
s_mov_b32 s6, 1056
v_mad_u32_u24 v242, v83, s6, v242
v_xor_b32 v179, 96, v176
s_mul_i32 s4, s43, 13107200
s_add_u32 s4, s4, s44
s_add_u32 s4, s4, 24576
s_mul_i32 s5, s43, -52424704
s_add_u32 s5, s5, 104833024
s_add_u32 s99, s4, 0
s_add_u32 s100, s4, 26212288
v_lshrrev_b32 v80, 3, v168
v_lshlrev_b32 v174, 8, v80
v_and_b32 v81, 7, v168
v_lshl_add_u32 v174, v81, 4, v174
v_xor_b32 v174, v174, v180
v_xor_b32 v180, v175, v180
s_mul_i32 s53, s41, 816
s_add_u32 s53, s53, 157696
v_and_b32 v88, 1, v168
v_lshl_add_u32 v249, v83, 6, s53
v_lshl_add_u32 v249, v88, 5, v249
s_add_u32 s8, s53, 256
s_mov_b32 vcc_lo, 0x33333333
s_mov_b32 vcc_hi, 0xcccccccc
v_lshl_add_u32 v249, v85, 4, v249
v_mov_b32 v166, s8
v_cndmask_b32 v249, v166, v249, vcc
s_add_u32 s9, s53, 256
v_lshl_add_u32 v166, v83, 2, s9
s_mov_b32 s8, 272
v_lshl_add_u32 v248, v82, 6, s53
v_mov_b32 v236, 0
v_mad_u32_u24 v166, v86, s8, v166
s_lshl_b32 s53, s41, 8
s_add_u32 s10, s53, 101376
ds_write_b32 v166, v236 offset:0
s_add_u32 s58, s53, 36096
s_xor_b32 s59, s53, 256
s_add_u32 s59, s59, 36096
v_lshl_add_u32 v166, v168, 2, s10
v_bfe_u32 v87, v168, 1, 1
v_lshl_add_u32 v248, v87, 5, v248
v_lshl_add_u32 v248, v83, 3, v248
v_lshl_add_u32 v248, v88, 1, v248
ds_write_b32 v166, v166 offset:0
s_mov_b64 exec, 0
s_cmp_eq_u32 s41, 0
s_cbranch_scc1 L_h0
s_cmp_eq_u32 s41, 1
s_cbranch_scc1 L_h1
s_cmp_eq_u32 s41, 2
s_cbranch_scc1 L_h2
s_branch L_h3
L_ret:
s_mov_b64 exec, -1
buffer_load_dwordx4 v243, s[16:19], s48 offen nt lds
s_add_u32 m0, s49, 23232
s_add_u32 s48, s55, 22528
buffer_load_dwordx4 v243, s[16:19], s48 offen nt lds
s_add_u32 m0, s49, 0
s_add_u32 s48, s55, 0
buffer_load_dwordx4 v243, s[16:19], s48 offen nt lds
s_add_u32 m0, s49, 2112
s_add_u32 s48, s55, 2048
buffer_load_dwordx4 v243, s[16:19], s48 offen nt lds
s_add_u32 m0, s98, 102400
s_waitcnt vmcnt(11)
v_and_b32 v160, 0xffff0000, v104
v_and_b32 v161, 0xffff0000, v105
v_and_b32 v162, 0xffff0000, v106
v_and_b32 v163, 0xffff0000, v107
v_lshlrev_b32 v104, 16, v104
v_lshlrev_b32 v105, 16, v105
v_lshlrev_b32 v106, 16, v106
v_lshlrev_b32 v107, 16, v107
v_mul_f32 v160, s40, v160
v_mul_f32 v104, s40, v104
v_mul_f32 v161, s40, v161
v_mul_f32 v105, s40, v105
v_mul_f32 v162, s40, v162
v_mul_f32 v106, s40, v106
v_mul_f32 v163, s40, v163
v_mul_f32 v107, s40, v107
v_cvt_pk_bf16_f32 v104, v104, v160
v_cvt_pk_bf16_f32 v105, v105, v161
v_cvt_pk_bf16_f32 v106, v106, v162
v_cvt_pk_bf16_f32 v107, v107, v163
ds_write_b128 v172, v[104:107] offset:0
buffer_load_dwordx4 v170, s[28:31], s54 offen offset:0 lds
buffer_load_dwordx4 v171, s[28:31], s54 offen offset:1024 lds
s_waitcnt vmcnt(12)
v_and_b32 v160, 0xffff0000, v108
v_and_b32 v161, 0xffff0000, v109
v_and_b32 v162, 0xffff0000, v110
v_and_b32 v163, 0xffff0000, v111
v_lshlrev_b32 v108, 16, v108
v_lshlrev_b32 v109, 16, v109
v_lshlrev_b32 v110, 16, v110
v_lshlrev_b32 v111, 16, v111
v_mul_f32 v160, s40, v160
v_mul_f32 v108, s40, v108
v_mul_f32 v161, s40, v161
v_mul_f32 v109, s40, v109
v_mul_f32 v162, s40, v162
v_mul_f32 v110, s40, v110
v_mul_f32 v163, s40, v163
v_mul_f32 v111, s40, v111
v_cvt_pk_bf16_f32 v108, v108, v160
v_cvt_pk_bf16_f32 v109, v109, v161
v_cvt_pk_bf16_f32 v110, v110, v162
v_cvt_pk_bf16_f32 v111, v111, v163
ds_write_b128 v173, v[108:111] offset:1024
buffer_load_dwordx4 v170, s[28:31], s54 offen offset:2048 lds
buffer_load_dwordx4 v171, s[28:31], s54 offen offset:3072 lds
s_add_u32 m0, s98, 106496
s_waitcnt vmcnt(13)
v_and_b32 v160, 0xffff0000, v112
v_and_b32 v161, 0xffff0000, v113
v_and_b32 v162, 0xffff0000, v114
v_and_b32 v163, 0xffff0000, v115
v_lshlrev_b32 v112, 16, v112
v_lshlrev_b32 v113, 16, v113
v_lshlrev_b32 v114, 16, v114
v_lshlrev_b32 v115, 16, v115
v_mul_f32 v160, s40, v160
v_mul_f32 v112, s40, v112
v_mul_f32 v161, s40, v161
v_mul_f32 v113, s40, v113
v_mul_f32 v162, s40, v162
v_mul_f32 v114, s40, v114
v_mul_f32 v163, s40, v163
v_mul_f32 v115, s40, v115
v_cvt_pk_bf16_f32 v112, v112, v160
v_cvt_pk_bf16_f32 v113, v113, v161
v_cvt_pk_bf16_f32 v114, v114, v162
v_cvt_pk_bf16_f32 v115, v115, v163
ds_write_b128 v172, v[112:115] offset:2048
buffer_load_dwordx4 v170, s[28:31], s57 offen offset:0 lds
buffer_load_dwordx4 v171, s[28:31], s57 offen offset:1024 lds
s_waitcnt vmcnt(14)
v_and_b32 v160, 0xffff0000, v116
v_and_b32 v161, 0xffff0000, v117
v_and_b32 v162, 0xffff0000, v118
v_and_b32 v163, 0xffff0000, v119
v_lshlrev_b32 v116, 16, v116
v_lshlrev_b32 v117, 16, v117
v_lshlrev_b32 v118, 16, v118
v_lshlrev_b32 v119, 16, v119
v_mul_f32 v160, s40, v160
v_mul_f32 v116, s40, v116
v_mul_f32 v161, s40, v161
v_mul_f32 v117, s40, v117
v_mul_f32 v162, s40, v162
v_mul_f32 v118, s40, v118
v_mul_f32 v163, s40, v163
v_mul_f32 v119, s40, v119
v_cvt_pk_bf16_f32 v116, v116, v160
v_cvt_pk_bf16_f32 v117, v117, v161
v_cvt_pk_bf16_f32 v118, v118, v162
v_cvt_pk_bf16_f32 v119, v119, v163
ds_write_b128 v173, v[116:119] offset:3072
buffer_load_dwordx4 v170, s[28:31], s57 offen offset:2048 lds
buffer_load_dwordx4 v171, s[28:31], s57 offen offset:3072 lds
s_add_u32 m0, s49, 50688
s_waitcnt vmcnt(15)
v_and_b32 v160, 0xffff0000, v120
v_and_b32 v161, 0xffff0000, v121
v_and_b32 v162, 0xffff0000, v122
v_and_b32 v163, 0xffff0000, v123
v_lshlrev_b32 v120, 16, v120
v_lshlrev_b32 v121, 16, v121
v_lshlrev_b32 v122, 16, v122
v_lshlrev_b32 v123, 16, v123
v_mul_f32 v160, s40, v160
v_mul_f32 v120, s40, v120
v_mul_f32 v161, s40, v161
v_mul_f32 v121, s40, v121
v_mul_f32 v162, s40, v162
v_mul_f32 v122, s40, v122
v_mul_f32 v163, s40, v163
v_mul_f32 v123, s40, v123
v_cvt_pk_bf16_f32 v120, v120, v160
v_cvt_pk_bf16_f32 v121, v121, v161
v_cvt_pk_bf16_f32 v122, v122, v162
v_cvt_pk_bf16_f32 v123, v123, v163
ds_write_b128 v172, v[120:123] offset:4096
s_waitcnt vmcnt(14)
v_and_b32 v160, 0xffff0000, v124
v_and_b32 v161, 0xffff0000, v125
v_and_b32 v162, 0xffff0000, v126
v_and_b32 v163, 0xffff0000, v127
v_lshlrev_b32 v124, 16, v124
v_lshlrev_b32 v125, 16, v125
v_lshlrev_b32 v126, 16, v126
v_lshlrev_b32 v127, 16, v127
v_mul_f32 v160, s40, v160
v_mul_f32 v124, s40, v124
v_mul_f32 v161, s40, v161
v_mul_f32 v125, s40, v125
v_mul_f32 v162, s40, v162
v_mul_f32 v126, s40, v126
v_mul_f32 v163, s40, v163
v_mul_f32 v127, s40, v127
v_cvt_pk_bf16_f32 v124, v124, v160
v_cvt_pk_bf16_f32 v125, v125, v161
v_cvt_pk_bf16_f32 v126, v126, v162
v_cvt_pk_bf16_f32 v127, v127, v163
ds_write_b128 v173, v[124:127] offset:5120
s_waitcnt vmcnt(13)
v_and_b32 v160, 0xffff0000, v128
v_and_b32 v161, 0xffff0000, v129
v_and_b32 v162, 0xffff0000, v130
v_and_b32 v163, 0xffff0000, v131
v_lshlrev_b32 v128, 16, v128
v_lshlrev_b32 v129, 16, v129
v_lshlrev_b32 v130, 16, v130
v_lshlrev_b32 v131, 16, v131
v_mul_f32 v160, s40, v160
v_mul_f32 v128, s40, v128
v_mul_f32 v161, s40, v161
v_mul_f32 v129, s40, v129
v_mul_f32 v162, s40, v162
v_mul_f32 v130, s40, v130
v_mul_f32 v163, s40, v163
v_mul_f32 v131, s40, v131
v_cvt_pk_bf16_f32 v128, v128, v160
v_cvt_pk_bf16_f32 v129, v129, v161
v_cvt_pk_bf16_f32 v130, v130, v162
v_cvt_pk_bf16_f32 v131, v131, v163
ds_write_b128 v172, v[128:131] offset:6144
s_waitcnt vmcnt(12)
v_and_b32 v160, 0xffff0000, v132
v_and_b32 v161, 0xffff0000, v133
v_and_b32 v162, 0xffff0000, v134
v_and_b32 v163, 0xffff0000, v135
v_lshlrev_b32 v132, 16, v132
v_lshlrev_b32 v133, 16, v133
v_lshlrev_b32 v134, 16, v134
v_lshlrev_b32 v135, 16, v135
v_mul_f32 v160, s40, v160
v_mul_f32 v132, s40, v132
v_mul_f32 v161, s40, v161
v_mul_f32 v133, s40, v133
v_mul_f32 v162, s40, v162
v_mul_f32 v134, s40, v134
v_mul_f32 v163, s40, v163
v_mul_f32 v135, s40, v135
v_cvt_pk_bf16_f32 v132, v132, v160
v_cvt_pk_bf16_f32 v133, v133, v161
v_cvt_pk_bf16_f32 v134, v134, v162
v_cvt_pk_bf16_f32 v135, v135, v163
ds_write_b128 v173, v[132:135] offset:7168
s_waitcnt vmcnt(10) lgkmcnt(0)
s_barrier
ds_read_b64_tr_b16 a[28:29], v177 offset:12288
ds_read_b128 v[188:191], v242 offset:21120
ds_read_b64_tr_b16 a[30:31], v177 offset:12800
ds_read_b128 v[212:215], v242 offset:21376
ds_read_b64_tr_b16 a[0:1], v176 offset:0
ds_read_b128 v[224:227], v242 offset:21632
ds_read_b64_tr_b16 a[2:3], v176 offset:512
ds_read_b128 v[232:235], v242 offset:21888
ds_read_b64_tr_b16 a[24:25], v177 offset:8192
ds_read_b64_tr_b16 a[26:27], v177 offset:8704
ds_read_b64_tr_b16 a[4:5], v176 offset:4096
ds_read_b64_tr_b16 a[6:7], v176 offset:4608
ds_read_b64_tr_b16 a[20:21], v177 offset:4096
ds_read_b64_tr_b16 a[22:23], v177 offset:4608
ds_read_b64_tr_b16 a[8:9], v176 offset:8192
ds_read_b64_tr_b16 a[10:11], v176 offset:8704
ds_read_b64_tr_b16 a[16:17], v177 offset:0
ds_read_b64_tr_b16 a[18:19], v177 offset:512
ds_read_b64_tr_b16 a[12:13], v176 offset:12288
ds_read_b64_tr_b16 a[14:15], v176 offset:12800
ds_read_b64_tr_b16 a[32:33], v178 offset:0
ds_read_b64_tr_b16 a[34:35], v178 offset:512
ds_read_b64_tr_b16 a[36:37], v178 offset:4096
ds_read_b64_tr_b16 a[38:39], v178 offset:4608
ds_read_b64_tr_b16 a[40:41], v178 offset:8192
ds_read_b64_tr_b16 a[42:43], v178 offset:8704
ds_read_b64_tr_b16 a[44:45], v178 offset:12288
ds_read_b64_tr_b16 a[46:47], v178 offset:12800
s_waitcnt lgkmcnt(15)
v_mfma_f32_16x16x32_bf16 v[192:195], a[0:3], v[188:191], 0
s_waitcnt lgkmcnt(12)
ds_read_b64_tr_b16 a[48:49], v179 offset:0
v_add_u32 v176, 98176, v176
v_mfma_f32_16x16x32_bf16 v[192:195], a[4:7], v[212:215], v[192:195]
s_waitcnt lgkmcnt(9)
ds_read_b64_tr_b16 a[50:51], v179 offset:512
v_add_u32 v177, 98176, v177
v_mfma_f32_16x16x32_bf16 v[192:195], a[8:11], v[224:227], v[192:195]
s_mul_i32 s53, s43, 25344
ds_read_b64_tr_b16 a[52:53], v179 offset:4096
v_add_u32 v178, 98176, v178
v_mfma_f32_16x16x32_bf16 v[192:195], a[12:15], v[232:235], v[192:195]
s_add_u32 s11, s53, 59648
ds_read_b64_tr_b16 a[54:55], v179 offset:4608
v_lshl_add_u32 v182, v82, 10, s11
v_mfma_f32_16x16x32_bf16 v[196:199], a[28:31], v[232:235], 0
s_lshl_b32 s53, s43, 7
ds_read_b64_tr_b16 a[56:57], v179 offset:8192
v_lshl_add_u32 v182, v83, 7, v182
v_mfma_f32_16x16x32_bf16 v[196:199], a[24:27], v[224:227], v[196:199]
s_mov_b32 s51, -32
ds_read_b64_tr_b16 a[58:59], v179 offset:8704
v_cvt_pk_bf16_f32 v152, v192, v193
v_mfma_f32_16x16x32_bf16 v[196:199], a[20:23], v[212:215], v[196:199]
s_waitcnt lgkmcnt(12)
ds_read_b64_tr_b16 a[60:61], v179 offset:12288
v_cvt_pk_bf16_f32 v153, v194, v195
v_mfma_f32_16x16x32_bf16 v[196:199], a[16:19], v[188:191], v[196:199]
s_waitcnt lgkmcnt(11)
ds_read_b64_tr_b16 a[62:63], v179 offset:12800
v_add_u32 v179, 98176, v179
v_mfma_f32_16x16x32_bf16 v[200:203], a[32:35], v[188:191], 0
s_waitcnt lgkmcnt(10)
buffer_load_dwordx4 v243, s[16:19], s99 offen offset:0 nt lds
v_mfma_f32_16x16x32_bf16 v[200:203], a[36:39], v[212:215], v[200:203]
s_waitcnt lgkmcnt(8)
buffer_load_dwordx4 v243, s[16:19], s100 offen offset:2112 nt lds
v_mfma_f32_16x16x32_bf16 v[200:203], a[40:43], v[224:227], v[200:203]
s_add_u32 m0, s49, 54912
s_add_u32 s99, s4, 52428800
s_add_u32 s100, s4, 78641088
v_mfma_f32_16x16x32_bf16 v[200:203], a[44:47], v[232:235], v[200:203]
s_waitcnt lgkmcnt(4)
buffer_load_dwordx4 v243, s[16:19], s99 offen offset:0 nt lds
s_add_u32 s99, s55, 4096
v_cvt_pk_bf16_f32 v154, v196, v197
v_cvt_pk_bf16_f32 v155, v198, v199
s_waitcnt lgkmcnt(0)
v_mfma_f32_16x16x32_bf16 v[204:207], a[60:63], v[232:235], 0
buffer_load_dwordx4 v243, s[16:19], s100 offen offset:2112 nt lds
v_mfma_f32_16x16x32_bf16 v[204:207], a[52:55], v[212:215], v[204:207]
s_waitcnt vmcnt(12)
s_barrier
v_mfma_f32_16x16x32_bf16 v[204:207], a[48:51], v[188:191], v[204:207]
s_add_u32 m0, s98, 59648
ds_read_b128 v[208:211], v242 offset:512
ds_read_b128 v[216:219], v242 offset:768
v_mfma_f32_16x16x32_bf16 v[204:207], a[56:59], v[224:227], v[204:207]
s_add_u32 s100, s55, 4032
ds_read_b128 v[220:223], v242 offset:256
ds_read_b128 v[228:231], v242 offset:0
v_cvt_pk_bf16_f32 v156, v200, v201
v_cvt_pk_bf16_f32 v157, v202, v203
v_lshl_add_u32 v182, v84, 4, v182
v_lshl_add_u32 v182, v86, 5, v182
v_xor_b32 v183, 16, v182
v_bfe_u32 v89, v168, 1, 3
v_cvt_pk_bf16_f32 v158, v204, v205
v_cvt_pk_bf16_f32 v159, v206, v207
v_lshl_add_u32 v244, v89, 9, s53
s_mul_i32 s52, s41, 13824
s_add_u32 s52, s52, 102400
v_lshlrev_b32 v95, 4, v83
s_mov_b32 vcc_lo, 0x33333333
s_mov_b32 vcc_hi, 0x33333333
v_and_b32 v16, 15, v168
s_waitcnt lgkmcnt(3)
v_mfma_f32_16x16x32_bf16 v[192:195], a[56:59], v[208:211], 0
s_waitcnt lgkmcnt(2)
v_mov_b32 v169, 163024
v_lshrrev_b32 v92, 5, v168
v_mfma_f32_16x16x32_bf16 v[192:195], a[60:63], v[216:219], v[192:195]
s_waitcnt lgkmcnt(0)
v_lshl_add_u32 v164, v86, 7, s52
v_lshl_add_u32 v164, v92, 4, v164
v_mfma_f32_16x16x32_bf16 v[192:195], a[52:55], v[220:223], v[192:195]
s_waitcnt vmcnt(4)
s_barrier
v_mfma_f32_16x16x32_bf16 v[192:195], a[48:51], v[228:231], v[192:195]
s_lshl_b32 s53, s41, 9
ds_read_b64_tr_b16 a[64:65], v176 offset:0
v_lshl_add_u32 v164, v85, 3, v164
v_mfma_f32_16x16x32_bf16 v[196:199], a[32:35], v[228:231], 0
s_add_u32 s11, s53, 160960
ds_read_b64_tr_b16 a[66:67], v176 offset:512
v_lshl_add_u32 v167, v16, 4, s11
v_mfma_f32_16x16x32_bf16 v[196:199], a[36:39], v[220:223], v[196:199]
s_add_u32 s13, s52, 512
ds_read_b64_tr_b16 a[68:69], v176 offset:4096
v_cvt_pk_bf16_f32 v102, v192, v193
v_mfma_f32_16x16x32_bf16 v[196:199], a[40:43], v[208:211], v[196:199]
s_add_u32 s7, s52, 1072
ds_read_b64_tr_b16 a[70:71], v176 offset:4608
v_cvt_pk_bf16_f32 v103, v194, v195
v_mfma_f32_16x16x32_bf16 v[196:199], a[44:47], v[216:219], v[196:199]
s_add_u32 s10, s52, 1136
ds_read_b64_tr_b16 a[72:73], v176 offset:8192
v_lshl_add_u32 v247, v83, 7, s13
v_mfma_f32_16x16x32_bf16 v[192:195], a[28:31], v[216:219], 0
s_add_u32 s12, s52, 1136
ds_read_b64_tr_b16 a[74:75], v176 offset:8704
v_lshl_add_u32 v247, v88, 6, v247
v_mfma_f32_16x16x32_bf16 v[192:195], a[24:27], v[208:211], v[192:195]
s_add_u32 s9, s52, 1072
ds_read_b64_tr_b16 a[76:77], v176 offset:12288
v_cvt_pk_bf16_f32 v100, v196, v197
v_mfma_f32_16x16x32_bf16 v[192:195], a[20:23], v[220:223], v[192:195]
ds_read_b64_tr_b16 a[78:79], v176 offset:12800
v_cvt_pk_bf16_f32 v101, v198, v199
v_mfma_f32_16x16x32_bf16 v[192:195], a[16:19], v[228:231], v[192:195]
ds_read_b64_tr_b16 a[80:81], v177 offset:0
v_lshl_add_u32 v247, v82, 4, v247
v_mfma_f32_16x16x32_bf16 v[196:199], a[0:3], v[228:231], 0
ds_read_b64_tr_b16 a[82:83], v177 offset:512
v_mov_b32 v166, s7
v_mfma_f32_16x16x32_bf16 v[196:199], a[4:7], v[220:223], v[196:199]
s_mov_b32 s7, 1728
ds_read_b64_tr_b16 a[84:85], v177 offset:4096
v_cvt_pk_bf16_f32 v98, v192, v193
v_mfma_f32_16x16x32_bf16 v[196:199], a[8:11], v[208:211], v[196:199]
s_waitcnt lgkmcnt(9)
ds_read_b64_tr_b16 a[86:87], v177 offset:4608
v_cvt_pk_bf16_f32 v99, v194, v195
v_mfma_f32_16x16x32_bf16 v[196:199], a[12:15], v[216:219], v[196:199]
L_h0:
s_cbranch_execz L_h4
s_waitcnt lgkmcnt(8)
ds_read_b64_tr_b16 a[88:89], v177 offset:8192
v_xor_b32 v247, v95, v247
v_mfma_f32_16x16x32_bf16 v[192:195], a[64:67], v[188:191], 0
s_waitcnt lgkmcnt(7)
ds_read_b64_tr_b16 a[90:91], v177 offset:8704
v_cndmask_b32 v247, v166, v247, vcc
v_mfma_f32_16x16x32_bf16 v[192:195], a[68:71], v[212:215], v[192:195]
s_waitcnt lgkmcnt(6)
ds_read_b64_tr_b16 a[92:93], v177 offset:12288
v_cvt_pk_bf16_f32 v96, v196, v197
v_mfma_f32_16x16x32_bf16 v[192:195], a[72:75], v[224:227], v[192:195]
ds_read_b64_tr_b16 a[94:95], v177 offset:12800
v_cvt_pk_bf16_f32 v97, v198, v199
v_mfma_f32_16x16x32_bf16 v[192:195], a[76:79], v[232:235], v[192:195]
ds_read_b64_tr_b16 a[96:97], v178 offset:0
v_lshlrev_b32 v17, 4, v86
v_mfma_f32_16x16x32_bf16 v[196:199], a[76:79], v[216:219], 0
ds_read_b64_tr_b16 a[98:99], v178 offset:512
v_mad_u32_u24 v164, v83, s7, v164
v_mfma_f32_16x16x32_bf16 v[196:199], a[64:67], v[228:231], v[196:199]
ds_read_b64_tr_b16 a[100:101], v178 offset:4096
v_lshl_add_u32 v250, v16, 2, s52
v_mfma_f32_16x16x32_bf16 v[196:199], a[68:71], v[220:223], v[196:199]
s_waitcnt lgkmcnt(5)
ds_read_b64_tr_b16 a[102:103], v178 offset:4608
v_cvt_pk_bf16_f32 v40, v192, v193
v_mfma_f32_16x16x32_bf16 v[196:199], a[72:75], v[208:211], v[196:199]
ds_read_b64_tr_b16 a[104:105], v178 offset:8192
v_cvt_pk_bf16_f32 v41, v194, v195
v_mfma_f32_16x16x32_bf16 v[200:203], a[88:91], v[208:211], 0
ds_read_b64_tr_b16 a[106:107], v178 offset:8704
v_lshl_add_u32 v181, v16, 3, s10
v_mfma_f32_16x16x32_bf16 v[200:203], a[84:87], v[220:223], v[200:203]
s_waitcnt lgkmcnt(6)
ds_read_b64_tr_b16 a[108:109], v178 offset:12288
v_cvt_pk_bf16_f32 v0, v196, v197
v_mfma_f32_16x16x32_bf16 v[200:203], a[80:83], v[228:231], v[200:203]
ds_read_b64_tr_b16 a[110:111], v178 offset:12800
v_cvt_pk_bf16_f32 v1, v198, v199
v_mfma_f32_16x16x32_bf16 v[200:203], a[92:95], v[216:219], v[200:203]
ds_read_b64_tr_b16 a[112:113], v179 offset:0
v_xor_b32 v164, v17, v164
v_mfma_f32_16x16x32_bf16 v[192:195], a[92:95], v[232:235], 0
ds_read_b64_tr_b16 a[114:115], v179 offset:512
v_bfe_u32 v90, v168, 3, 2
v_mfma_f32_16x16x32_bf16 v[192:195], a[88:91], v[224:227], v[192:195]
ds_read_b64_tr_b16 a[116:117], v179 offset:4096
v_bfe_u32 v91, v168, 2, 1
v_mfma_f32_16x16x32_bf16 v[192:195], a[84:87], v[212:215], v[192:195]
s_waitcnt lgkmcnt(9)
ds_read_b64_tr_b16 a[118:119], v179 offset:4608
v_cvt_pk_bf16_f32 v2, v200, v201
v_mfma_f32_16x16x32_bf16 v[192:195], a[80:83], v[188:191], v[192:195]
s_waitcnt lgkmcnt(8)
ds_read_b64_tr_b16 a[120:121], v179 offset:8192
v_cvt_pk_bf16_f32 v3, v202, v203
v_mfma_f32_16x16x32_bf16 v[196:199], a[96:99], v[188:191], 0
s_waitcnt lgkmcnt(7)
ds_read_b64_tr_b16 a[122:123], v179 offset:8704
v_lshl_add_u32 v246, v90, 7, s12
v_mfma_f32_16x16x32_bf16 v[196:199], a[100:103], v[212:215], v[196:199]
s_waitcnt lgkmcnt(6)
ds_read_b64_tr_b16 a[124:125], v179 offset:12288
v_cvt_pk_bf16_f32 v42, v192, v193
v_mfma_f32_16x16x32_bf16 v[196:199], a[104:107], v[224:227], v[196:199]
ds_read_b64_tr_b16 a[126:127], v179 offset:12800
v_cvt_pk_bf16_f32 v43, v194, v195
v_mfma_f32_16x16x32_bf16 v[196:199], a[108:111], v[232:235], v[196:199]
buffer_load_dwordx4 v180, s[32:35], s54 offen offset:0 lds
v_mfma_f32_16x16x32_bf16 v[192:195], a[108:111], v[216:219], 0
buffer_load_dwordx4 v180, s[32:35], s54 offen offset:1024 lds
v_mfma_f32_16x16x32_bf16 v[192:195], a[96:99], v[228:231], v[192:195]
s_mov_b32 vcc_lo, 0xf0000f
s_mov_b32 vcc_hi, 0xf0000f00
v_cndmask_b32 v167, v169, v167, vcc
v_mfma_f32_16x16x32_bf16 v[192:195], a[100:103], v[220:223], v[192:195]
s_waitcnt lgkmcnt(2)
buffer_load_dwordx4 v180, s[32:35], s54 offen offset:2048 lds
v_mfma_f32_16x16x32_bf16 v[192:195], a[104:107], v[208:211], v[192:195]
buffer_load_dwordx4 v180, s[32:35], s54 offen offset:3072 lds
v_mfma_f32_16x16x32_bf16 v[200:203], a[120:123], v[208:211], 0
s_add_u32 m0, s98, 63744
v_cvt_pk_bf16_f32 v44, v196, v197
v_cvt_pk_bf16_f32 v45, v198, v199
v_mfma_f32_16x16x32_bf16 v[200:203], a[116:119], v[220:223], v[200:203]
s_waitcnt lgkmcnt(0)
buffer_load_dwordx4 v180, s[32:35], s57 offen offset:0 lds
v_mfma_f32_16x16x32_bf16 v[200:203], a[112:115], v[228:231], v[200:203]
buffer_load_dwordx4 v180, s[32:35], s57 offen offset:1024 lds
v_mfma_f32_16x16x32_bf16 v[200:203], a[124:127], v[216:219], v[200:203]
v_cvt_pk_bf16_f32 v4, v192, v193
v_cvt_pk_bf16_f32 v5, v194, v195
v_mfma_f32_16x16x32_bf16 v[192:195], a[124:127], v[232:235], 0
buffer_load_dwordx4 v180, s[32:35], s57 offen offset:2048 lds
v_mfma_f32_16x16x32_bf16 v[192:195], a[120:123], v[224:227], v[192:195]
buffer_load_dwordx4 v180, s[32:35], s57 offen offset:3072 lds
v_mfma_f32_16x16x32_bf16 v[192:195], a[116:119], v[212:215], v[192:195]
s_add_u32 m0, s49, 4224
s_lshl_b32 s57, s43, 14
s_lshl_b32 s53, s42, 7
s_add_u32 s57, s57, s53
v_mfma_f32_16x16x32_bf16 v[192:195], a[112:115], v[188:191], v[192:195]
v_cvt_pk_bf16_f32 v6, v200, v201
v_cvt_pk_bf16_f32 v7, v202, v203
v_lshl_add_u32 v245, v84, 8, s52
v_lshl_add_u32 v246, v91, 6, v246
v_mfma_f32_16x16x32_bf16 v[196:199], v[4:7], v[156:159], 0
v_lshl_add_u32 v245, v87, 7, v245
v_lshlrev_b32 v94, 4, v87
v_mfma_f32_16x16x32_bf16 v[196:199], v[0:3], v[152:155], v[196:199]
v_cvt_pk_bf16_f32 v46, v192, v193
v_cvt_pk_bf16_f32 v47, v194, v195
v_mfma_f32_16x16x32_bf16 v[192:195], v[40:43], v[152:155], 0
v_lshl_add_u32 v246, v86, 3, v246
v_xor_b32 v165, 32, v164
v_mfma_f32_16x16x32_bf16 v[192:195], v[44:47], v[156:159], v[192:195]
v_lshl_add_u32 v245, v88, 6, v245
v_lshl_add_u32 v245, v82, 4, v245
v_mfma_f32_16x16x32_bf16 v[200:203], v[44:47], v[100:103], 0
v_exp_f32 v196, v196
v_mfma_f32_16x16x32_bf16 v[200:203], v[40:43], v[96:99], v[200:203]
v_exp_f32 v197, v197
v_mfma_f32_16x16x32_bf16 v[204:207], v[0:3], v[96:99], 0
s_nop 0
v_exp_f32 v192, v192
v_mfma_f32_16x16x32_bf16 v[204:207], v[4:7], v[100:103], v[204:207]
v_exp_f32 v193, v193
v_exp_f32 v194, v194
v_exp_f32 v195, v195
v_cvt_pk_bf16_f32 v114, v192, v193
v_cvt_pk_bf16_f32 v115, v194, v195
v_exp_f32 v198, v198
v_exp_f32 v199, v199
v_cvt_pk_bf16_f32 v104, v196, v197
v_cvt_pk_bf16_f32 v105, v198, v199
v_exp_f32 v200, v200
v_exp_f32 v201, v201
v_exp_f32 v202, v202
v_exp_f32 v203, v203
v_cvt_pk_bf16_f32 v130, v200, v201
v_cvt_pk_bf16_f32 v131, v202, v203
v_exp_f32 v204, v204
v_exp_f32 v205, v205
v_exp_f32 v206, v206
v_exp_f32 v207, v207
v_cvt_pk_bf16_f32 v120, v204, v205
v_cvt_pk_bf16_f32 v121, v206, v207
v_lshlrev_b32 v93, 5, v84
v_xor_b32 v245, v93, v245
v_xor_b32 v245, v94, v245
s_mov_b32 vcc_lo, 0x33333333
s_mov_b32 vcc_hi, 0x33333333
v_mov_b32 v184, 0
v_mov_b32 v169, 0x3f803f80
v_cndmask_b32 v184, v184, v169, vcc
s_waitcnt vmcnt(8)
s_barrier
ds_read_b128 v[48:51], v242 offset:50688
ds_read_b128 v[52:55], v242 offset:50944
ds_read_b128 v[56:59], v242 offset:51200
ds_read_b128 v[60:63], v242 offset:51456
ds_read_b128 v[64:67], v242 offset:54912
ds_read_b128 v[68:71], v242 offset:55168
ds_read_b128 v[72:75], v242 offset:55424
ds_read_b128 v[76:79], v242 offset:55680
s_mov_b32 vcc_lo, 0xaaaaaaaa
s_mov_b32 vcc_hi, 0xaaaaaaaa
v_mov_b32 v251, 0x44444444
v_mov_b32 v169, 0xeeeeeeee
v_cndmask_b32 v251, v251, v169, vcc
s_mov_b32 vcc_lo, 0x0
s_mov_b32 vcc_hi, 0xaaaaaaaa
v_mov_b32 v169, 0xe4eeeeee
v_cndmask_b32 v251, v251, v169, vcc
s_mov_b32 vcc_lo, 0xffff
s_mov_b32 vcc_hi, 0xffff
v_mov_b32 v252, 0x0c0c0c0c
v_mov_b32 v169, 0x07060302
s_waitcnt lgkmcnt(7)
v_mfma_f32_16x16x32_bf16 v[192:195], a[64:67], v[48:51], 0
s_waitcnt lgkmcnt(5)
buffer_load_dwordx4 v243, s[16:19], s99 offen offset:0 nt lds
v_mfma_f32_16x16x32_bf16 v[192:195], a[68:71], v[52:55], v[192:195]
s_waitcnt lgkmcnt(4)
buffer_load_dwordx4 v243, s[16:19], s100 offen offset:2112 nt lds
v_mfma_f32_16x16x32_bf16 v[192:195], a[72:75], v[56:59], v[192:195]
s_add_u32 m0, s49, 8448
s_add_u32 s99, s55, 8192
s_add_u32 s100, s55, 8128
v_mfma_f32_16x16x32_bf16 v[192:195], a[76:79], v[60:63], v[192:195]
v_cndmask_b32 v252, v252, v169, vcc
v_mov_b32 v253, 0x0c0c0c0c
v_mfma_f32_16x16x32_bf16 v[196:199], a[92:95], v[60:63], 0
s_mov_b32 vcc_lo, 0xffff0000
s_mov_b32 vcc_hi, 0xffff0000
v_mov_b32 v169, 0x07060302
v_mfma_f32_16x16x32_bf16 v[196:199], a[88:91], v[56:59], v[196:199]
s_nop 0
v_cvt_pk_bf16_f32 v136, v192, v193
v_cvt_pk_bf16_f32 v138, v194, v195
v_mfma_f32_16x16x32_bf16 v[196:199], a[84:87], v[52:55], v[196:199]
v_cndmask_b32 v253, v253, v169, vcc
v_lshl_add_u32 v244, v88, 4, v244
v_mfma_f32_16x16x32_bf16 v[196:199], a[80:83], v[48:51], v[196:199]
buffer_load_dwordx4 v243, s[16:19], s99 offen offset:0 nt lds
v_mfma_f32_16x16x32_bf16 v[200:203], a[96:99], v[48:51], 0
s_add_u32 s99, s55, 12288
buffer_load_dwordx4 v243, s[16:19], s100 offen offset:2112 nt lds
v_mfma_f32_16x16x32_bf16 v[200:203], a[100:103], v[52:55], v[200:203]
s_add_u32 m0, s49, 12672
s_add_u32 s100, s55, 12224
v_mad_u32_u24 v181, v82, s7, v181
v_mfma_f32_16x16x32_bf16 v[200:203], a[104:107], v[56:59], v[200:203]
s_waitcnt lgkmcnt(0)
v_cvt_pk_bf16_f32 v137, v196, v197
v_cvt_pk_bf16_f32 v139, v198, v199
v_mfma_f32_16x16x32_bf16 v[200:203], a[108:111], v[60:63], v[200:203]
ds_write_b64 v164, v[136:137] offset:0
v_mfma_f32_16x16x32_bf16 v[192:195], a[124:127], v[60:63], 0
ds_write_b64 v164, v[138:139] offset:64
v_mfma_f32_16x16x32_bf16 v[192:195], a[116:119], v[52:55], v[192:195]
v_mad_u32_u24 v250, v82, s8, v250
v_lshl_add_u32 v244, v82, 5, v244
v_mfma_f32_16x16x32_bf16 v[192:195], a[112:115], v[48:51], v[192:195]
buffer_load_dwordx4 v243, s[16:19], s99 offen offset:0 nt lds
v_mfma_f32_16x16x32_bf16 v[192:195], a[120:123], v[56:59], v[192:195]
s_add_u32 s99, s55, 16384
buffer_load_dwordx4 v243, s[16:19], s100 offen offset:2112 nt lds
v_mfma_f32_16x16x32_bf16 v[196:199], a[56:59], v[56:59], 0
s_add_u32 m0, s49, 16896
s_add_u32 s100, s55, 16320
v_cvt_pk_bf16_f32 v140, v200, v201
v_mfma_f32_16x16x32_bf16 v[196:199], a[60:63], v[60:63], v[196:199]
s_nop 0
v_cvt_pk_bf16_f32 v141, v192, v193
v_cvt_pk_bf16_f32 v143, v194, v195
v_mfma_f32_16x16x32_bf16 v[196:199], a[52:55], v[52:55], v[196:199]
ds_write_b64 v165, v[140:141] offset:0
v_mfma_f32_16x16x32_bf16 v[196:199], a[48:51], v[48:51], v[196:199]
v_cvt_pk_bf16_f32 v142, v202, v203
v_lshl_add_u32 v166, v90, 2, s9
v_mfma_f32_16x16x32_bf16 v[192:195], a[32:35], v[48:51], 0
ds_write_b64 v165, v[142:143] offset:64
v_mfma_f32_16x16x32_bf16 v[192:195], a[36:39], v[52:55], v[192:195]
buffer_load_dwordx4 v243, s[16:19], s99 offen offset:0 nt lds
v_mfma_f32_16x16x32_bf16 v[192:195], a[40:43], v[56:59], v[192:195]
s_add_u32 s99, s57, 0
buffer_load_dwordx4 v243, s[16:19], s100 offen offset:2112 nt lds
v_mfma_f32_16x16x32_bf16 v[192:195], a[44:47], v[60:63], v[192:195]
s_add_u32 m0, s98, 59648
s_add_u32 s100, s57, 1024
v_cvt_pk_bf16_f32 v149, v196, v197
v_mfma_f32_16x16x32_bf16 v[200:203], a[28:31], v[60:63], 0
ds_read_b128 v[238:241], v245 offset:0
v_cvt_pk_bf16_f32 v151, v198, v199
v_mfma_f32_16x16x32_bf16 v[200:203], a[24:27], v[56:59], v[200:203]
s_nop 0
v_cvt_pk_bf16_f32 v148, v192, v193
v_cvt_pk_bf16_f32 v150, v194, v195
v_mfma_f32_16x16x32_bf16 v[200:203], a[20:23], v[52:55], v[200:203]
s_lshl_b32 s50, s43, 12
s_add_u32 s50, s50, s44
s_add_u32 s50, s50, 13107200
v_mfma_f32_16x16x32_bf16 v[200:203], a[16:19], v[48:51], v[200:203]
s_mul_i32 s48, s43, 3168
s_add_u32 s49, s49, s48
s_add_u32 s49, s49, 50688
s_mov_b32 s48, 8192
v_mfma_f32_16x16x32_bf16 v[192:195], a[0:3], v[48:51], 0
v_mad_u32_u24 v166, v81, s7, v166
v_lshl_add_u32 v246, v92, 2, v246
v_mfma_f32_16x16x32_bf16 v[192:195], a[8:11], v[56:59], v[192:195]
ds_write_b32 v166, v236 offset:0
v_mfma_f32_16x16x32_bf16 v[192:195], a[12:15], v[60:63], v[192:195]
v_cvt_pk_bf16_f32 v145, v200, v201
v_cvt_pk_bf16_f32 v147, v202, v203
v_mfma_f32_16x16x32_bf16 v[192:195], a[4:7], v[52:55], v[192:195]
v_mov_b32 v185, v184
v_mov_b32 v186, v184
v_mfma_f32_16x16x32_bf16 v[196:199], a[4:7], v[68:71], 0
v_mov_b32 v187, v184
v_mov_b32 v118, 0
v_mfma_f32_16x16x32_bf16 v[196:199], a[0:3], v[64:67], v[196:199]
v_mov_b32 v119, 0
v_mov_b32 v255, 0
v_mfma_f32_16x16x32_bf16 v[196:199], a[8:11], v[72:75], v[196:199]
v_cvt_pk_bf16_f32 v144, v192, v193
v_cvt_pk_bf16_f32 v146, v194, v195
v_mfma_f32_16x16x32_bf16 v[196:199], a[12:15], v[76:79], v[196:199]
ds_write_b64 v164, v[144:145] offset:512
v_mfma_f32_16x16x32_bf16 v[192:195], v[136:139], v[144:147], 0
ds_write_b64 v164, v[146:147] offset:576
v_mfma_f32_16x16x32_bf16 v[192:195], v[140:143], v[148:151], v[192:195]
s_waitcnt vmcnt(8)
s_barrier
v_mfma_f32_16x16x32_bf16 v[200:203], a[28:31], v[76:79], 0
s_waitcnt lgkmcnt(3)
ds_read_b64_tr_b16 a[176:177], v183 offset:8
v_cvt_pk_bf16_f32 v32, v196, v197
v_mfma_f32_16x16x32_bf16 v[200:203], a[24:27], v[72:75], v[200:203]
ds_read_b64_tr_b16 a[178:179], v183 offset:520
v_cvt_pk_bf16_f32 v34, v198, v199
v_mfma_f32_16x16x32_bf16 v[200:203], a[20:23], v[68:71], v[200:203]
ds_read_b64_tr_b16 a[180:181], v183 offset:4104
v_mov_b32 v134, 0
v_mfma_f32_16x16x32_bf16 v[200:203], a[16:19], v[64:67], v[200:203]
ds_read_b64_tr_b16 a[182:183], v183 offset:4616
v_mov_b32 v135, 0
v_mfma_f32_16x16x32_bf16 v[196:199], a[32:35], v[64:67], 0
ds_read_b64_tr_b16 a[184:185], v183 offset:8200
s_nop 0
v_mfma_f32_16x16x32_bf16 v[196:199], a[36:39], v[68:71], v[196:199]
ds_read_b64_tr_b16 a[186:187], v183 offset:8712
v_mfma_f32_16x16x32_bf16 v[196:199], a[40:43], v[72:75], v[196:199]
ds_read_b64_tr_b16 a[188:189], v183 offset:12296
v_cvt_pk_bf16_f32 v33, v200, v201
v_mfma_f32_16x16x32_bf16 v[196:199], a[44:47], v[76:79], v[196:199]
ds_read_b64_tr_b16 a[190:191], v183 offset:12808
v_cvt_pk_bf16_f32 v35, v202, v203
v_mfma_f32_16x16x32_bf16 v[200:203], a[60:63], v[76:79], 0
ds_read_b64_tr_b16 a[160:161], v183 offset:0
s_nop 0
v_mfma_f32_16x16x32_bf16 v[200:203], a[52:55], v[68:71], v[200:203]
ds_read_b64_tr_b16 a[162:163], v183 offset:512
v_mfma_f32_16x16x32_bf16 v[200:203], a[48:51], v[64:67], v[200:203]
ds_read_b64_tr_b16 a[164:165], v183 offset:4096
v_cvt_pk_bf16_f32 v36, v196, v197
v_mfma_f32_16x16x32_bf16 v[200:203], a[56:59], v[72:75], v[200:203]
ds_read_b64_tr_b16 a[166:167], v183 offset:4608
v_cvt_pk_bf16_f32 v38, v198, v199
v_mfma_f32_16x16x32_bf16 v[196:199], a[120:123], v[72:75], 0
ds_read_b64_tr_b16 a[168:169], v183 offset:8192
s_nop 0
v_mfma_f32_16x16x32_bf16 v[196:199], a[124:127], v[76:79], v[196:199]
s_waitcnt lgkmcnt(12)
ds_read_b64_tr_b16 a[170:171], v183 offset:8704
v_cvt_pk_bf16_f32 v37, v200, v201
v_mfma_f32_16x16x32_bf16 v[196:199], a[116:119], v[68:71], v[196:199]
s_waitcnt lgkmcnt(12)
ds_read_b64_tr_b16 a[172:173], v183 offset:12288
v_cvt_pk_bf16_f32 v39, v202, v203
v_mfma_f32_16x16x32_bf16 v[196:199], a[112:115], v[64:67], v[196:199]
s_waitcnt lgkmcnt(12)
ds_read_b64_tr_b16 a[174:175], v183 offset:12800
s_nop 0
v_mfma_f32_16x16x32_bf16 v[200:203], a[96:99], v[64:67], 0
s_waitcnt lgkmcnt(12)
ds_read_b64_tr_b16 a[144:145], v182 offset:8
s_nop 0
v_mfma_f32_16x16x32_bf16 v[200:203], a[100:103], v[68:71], v[200:203]
s_waitcnt lgkmcnt(12)
ds_read_b64_tr_b16 a[146:147], v182 offset:520
v_cvt_pk_bf16_f32 v29, v196, v197
v_mfma_f32_16x16x32_bf16 v[200:203], a[104:107], v[72:75], v[200:203]
s_waitcnt lgkmcnt(12)
ds_read_b64_tr_b16 a[148:149], v182 offset:4104
v_cvt_pk_bf16_f32 v31, v198, v199
v_mfma_f32_16x16x32_bf16 v[200:203], a[108:111], v[76:79], v[200:203]
s_waitcnt lgkmcnt(12)
ds_read_b64_tr_b16 a[150:151], v182 offset:4616
s_nop 0
v_mfma_f32_16x16x32_bf16 v[196:199], a[92:95], v[76:79], 0
s_waitcnt lgkmcnt(12)
ds_read_b64_tr_b16 a[152:153], v182 offset:8200
s_nop 0
v_mfma_f32_16x16x32_bf16 v[196:199], a[88:91], v[72:75], v[196:199]
s_waitcnt lgkmcnt(12)
ds_read_b64_tr_b16 a[154:155], v182 offset:8712
v_cvt_pk_bf16_f32 v28, v200, v201
v_mfma_f32_16x16x32_bf16 v[196:199], a[84:87], v[68:71], v[196:199]
s_waitcnt lgkmcnt(12)
ds_read_b64_tr_b16 a[156:157], v182 offset:12296
v_cvt_pk_bf16_f32 v30, v202, v203
v_mfma_f32_16x16x32_bf16 v[196:199], a[80:83], v[64:67], v[196:199]
s_waitcnt lgkmcnt(12)
ds_read_b64_tr_b16 a[158:159], v182 offset:12808
s_nop 0
v_mfma_f32_16x16x32_bf16 v[200:203], a[64:67], v[64:67], 0
s_waitcnt lgkmcnt(12)
ds_read_b64_tr_b16 a[128:129], v182 offset:0
s_nop 0
v_mfma_f32_16x16x32_bf16 v[200:203], a[68:71], v[68:71], v[200:203]
s_waitcnt lgkmcnt(12)
ds_read_b64_tr_b16 a[130:131], v182 offset:512
v_cvt_pk_bf16_f32 v25, v196, v197
v_mfma_f32_16x16x32_bf16 v[200:203], a[72:75], v[72:75], v[200:203]
s_waitcnt lgkmcnt(12)
ds_read_b64_tr_b16 a[132:133], v182 offset:4096
v_cvt_pk_bf16_f32 v27, v198, v199
v_mfma_f32_16x16x32_bf16 v[200:203], a[76:79], v[76:79], v[200:203]
s_waitcnt lgkmcnt(12)
ds_read_b64_tr_b16 a[134:135], v182 offset:4608
s_nop 0
v_mfma_f32_16x16x32_bf16 v[196:199], v[76:79], a[188:191], 0
s_waitcnt lgkmcnt(12)
ds_read_b64_tr_b16 a[136:137], v182 offset:8192
s_nop 0
v_mfma_f32_16x16x32_bf16 v[196:199], v[72:75], a[184:187], v[196:199]
s_waitcnt lgkmcnt(12)
ds_read_b64_tr_b16 a[138:139], v182 offset:8704
v_cvt_pk_bf16_f32 v24, v200, v201
v_mfma_f32_16x16x32_bf16 v[196:199], v[68:71], a[180:183], v[196:199]
s_waitcnt lgkmcnt(12)
ds_read_b64_tr_b16 a[140:141], v182 offset:12288
v_cvt_pk_bf16_f32 v26, v202, v203
v_mfma_f32_16x16x32_bf16 v[196:199], v[64:67], a[176:179], v[196:199]
s_waitcnt lgkmcnt(12)
ds_read_b64_tr_b16 a[142:143], v182 offset:12800
s_nop 0
v_mfma_f32_16x16x32_bf16 v[200:203], v[64:67], a[160:163], 0
s_waitcnt lgkmcnt(12)
ds_write_b64 v165, v[148:149] offset:512
v_mfma_f32_16x16x32_bf16 v[200:203], v[68:71], a[164:167], v[200:203]
s_waitcnt lgkmcnt(12)
ds_write_b64 v165, v[150:151] offset:576
v_mfma_f32_16x16x32_bf16 v[200:203], v[72:75], a[168:171], v[200:203]
s_waitcnt lgkmcnt(12)
ds_write_b64 v164, v[32:33] offset:7424
v_mfma_f32_16x16x32_bf16 v[200:203], v[76:79], a[172:175], v[200:203]
s_waitcnt lgkmcnt(11)
ds_write_b64 v164, v[34:35] offset:7488
v_mfma_f32_16x16x32_bf16 v[204:207], v[24:27], v[32:35], 0
s_waitcnt lgkmcnt(11)
ds_write_b64 v165, v[36:37] offset:7424
v_mfma_f32_16x16x32_bf16 v[204:207], v[28:31], v[36:39], v[204:207]
s_waitcnt lgkmcnt(11)
ds_write_b64 v165, v[38:39] offset:7488
v_mfma_f32_16x16x32_bf16 v[208:211], v[76:79], a[156:159], 0
s_waitcnt lgkmcnt(11)
ds_write_b64 v164, v[24:25] offset:6912
v_mfma_f32_16x16x32_bf16 v[208:211], v[72:75], a[152:155], v[208:211]
s_waitcnt lgkmcnt(10)
ds_write_b64 v164, v[26:27] offset:6976
v_mfma_f32_16x16x32_bf16 v[208:211], v[68:71], a[148:151], v[208:211]
s_waitcnt lgkmcnt(10)
ds_write_b64 v165, v[28:29] offset:6912
v_mfma_f32_16x16x32_bf16 v[208:211], v[64:67], a[144:147], v[208:211]
s_waitcnt lgkmcnt(10)
ds_write_b64 v165, v[30:31] offset:6976
v_mfma_f32_16x16x32_bf16 v[216:219], v[64:67], a[128:131], 0
s_waitcnt lgkmcnt(10)
v_cvt_pk_bf16_f32 v14, v196, v197
v_cvt_pk_bf16_f32 v15, v198, v199
v_mfma_f32_16x16x32_bf16 v[216:219], v[72:75], a[136:139], v[216:219]
ds_write_b64 v181, v[14:15] offset:7296
v_mfma_f32_16x16x32_bf16 v[216:219], v[76:79], a[140:143], v[216:219]
v_cvt_pk_bf16_f32 v12, v200, v201
v_cvt_pk_bf16_f32 v13, v202, v203
v_mfma_f32_16x16x32_bf16 v[216:219], v[68:71], a[132:135], v[216:219]
ds_write_b64 v181, v[12:13] offset:7168
v_mfma_f32_16x16x32_bf16 v[196:199], v[52:55], a[132:135], 0
v_cvt_pk_bf16_f32 v10, v208, v209
v_cvt_pk_bf16_f32 v11, v210, v211
v_mfma_f32_16x16x32_bf16 v[196:199], v[48:51], a[128:131], v[196:199]
ds_write_b64 v181, v[10:11] offset:7040
v_mfma_f32_16x16x32_bf16 v[196:199], v[56:59], a[136:139], v[196:199]
s_nop 0
v_cvt_pk_bf16_f32 v8, v216, v217
v_cvt_pk_bf16_f32 v9, v218, v219
v_mfma_f32_16x16x32_bf16 v[196:199], v[60:63], a[140:143], v[196:199]
ds_write_b64 v181, v[8:9] offset:6912
v_mfma_f32_16x16x32_bf16 v[200:203], v[60:63], a[156:159], 0
v_exp_f32 v192, v192
v_mfma_f32_16x16x32_bf16 v[200:203], v[56:59], a[152:155], v[200:203]
v_exp_f32 v193, v193
v_mfma_f32_16x16x32_bf16 v[200:203], v[52:55], a[148:151], v[200:203]
v_add_f32 v160, v192, v193
v_cvt_pk_bf16_f32 v192, v192, v193
v_mfma_f32_16x16x32_bf16 v[200:203], v[48:51], a[144:147], v[200:203]
ds_write_b32 v167, v192 offset:0
v_mfma_f32_16x16x32_bf16 v[208:211], v[48:51], a[160:163], 0
v_exp_f32 v194, v194
v_mfma_f32_16x16x32_bf16 v[208:211], v[52:55], a[164:167], v[208:211]
v_exp_f32 v195, v195
v_mfma_f32_16x16x32_bf16 v[208:211], v[56:59], a[168:171], v[208:211]
ds_read_b128 v[228:231], v242 offset:256
v_cvt_pk_bf16_f32 v193, v194, v195
v_mfma_f32_16x16x32_bf16 v[208:211], v[60:63], a[172:175], v[208:211]
ds_write_b32 v167, v193 offset:4
v_mfma_f32_16x16x32_bf16 v[220:223], v[60:63], a[188:191], 0
v_mov_b64 v[216:217], s[96:97]
v_mov_b64 v[218:219], s[96:97]
v_mfma_f32_16x16x32_bf16 v[220:223], v[56:59], a[184:187], v[220:223]
v_cvt_pk_bf16_f32 v18, v200, v201
v_cvt_pk_bf16_f32 v19, v202, v203
v_mfma_f32_16x16x32_bf16 v[220:223], v[52:55], a[180:183], v[220:223]
v_mov_b64 v[200:201], s[96:97]
v_mov_b64 v[202:203], s[96:97]
v_mfma_f32_16x16x32_bf16 v[220:223], v[48:51], a[176:179], v[220:223]
v_add_f32 v161, v194, v195
v_add_f32 v194, v160, v161
v_smfmac_f32_16x16x64_bf16 v[216:219], v[238:241], v[152:159], v251
ds_write_b32 v167, v194 offset:8
v_smfmac_f32_16x16x64_bf16 v[200:203], v[238:241], v[96:103], v251
s_nop 0
ds_read_b128 v[192:195], v242 offset:768
v_exp_f32 v204, v204
s_nop 2
v_add_f32 v216, v216, v217
v_add_f32 v218, v218, v219
v_exp_f32 v216, v216
v_exp_f32 v218, v218
s_nop 0
v_perm_b32 v116, v218, v216, v252
v_perm_b32 v117, v218, v216, v253
v_mfma_f32_16x16x32_bf16 v[216:219], v[232:235], a[188:191], 0
v_cvt_pk_bf16_f32 v22, v220, v221
v_cvt_pk_bf16_f32 v23, v222, v223
v_mfma_f32_16x16x32_bf16 v[216:219], v[224:227], a[184:187], v[216:219]
v_exp_f32 v205, v205
v_mfma_f32_16x16x32_bf16 v[216:219], v[212:215], a[180:183], v[216:219]
s_waitcnt lgkmcnt(3)
v_add_f32 v160, v204, v205
v_cvt_pk_bf16_f32 v204, v204, v205
v_mfma_f32_16x16x32_bf16 v[216:219], v[188:191], a[176:179], v[216:219]
ds_write_b32 v167, v204 offset:256
v_mfma_f32_16x16x32_bf16 v[220:223], v[188:191], a[160:163], 0
v_exp_f32 v206, v206
v_mfma_f32_16x16x32_bf16 v[220:223], v[212:215], a[164:167], v[220:223]
v_exp_f32 v207, v207
v_mfma_f32_16x16x32_bf16 v[220:223], v[224:227], a[168:171], v[220:223]
v_cvt_pk_bf16_f32 v205, v206, v207
v_add_f32 v161, v206, v207
v_mfma_f32_16x16x32_bf16 v[220:223], v[232:235], a[172:175], v[220:223]
ds_write_b32 v167, v205 offset:260
v_add_f32 v206, v160, v161
ds_write_b32 v167, v206 offset:264
v_add_f32 v200, v200, v201
v_add_f32 v202, v202, v203
v_mfma_f32_16x16x32_bf16 v[204:207], v[232:235], a[156:159], 0
s_waitcnt lgkmcnt(3)
v_exp_f32 v200, v200
v_mfma_f32_16x16x32_bf16 v[204:207], v[224:227], a[152:155], v[204:207]
v_exp_f32 v202, v202
v_mfma_f32_16x16x32_bf16 v[204:207], v[212:215], a[148:151], v[204:207]
v_perm_b32 v132, v202, v200, v252
v_perm_b32 v133, v202, v200, v253
v_mfma_f32_16x16x32_bf16 v[204:207], v[188:191], a[144:147], v[204:207]
v_cvt_pk_bf16_f32 v16, v196, v197
v_cvt_pk_bf16_f32 v17, v198, v199
v_mfma_f32_16x16x32_bf16 v[200:203], v[188:191], a[128:131], 0
ds_read_b128 v[196:199], v242 offset:0
v_cvt_pk_bf16_f32 v20, v208, v209
v_mfma_f32_16x16x32_bf16 v[200:203], v[224:227], a[136:139], v[200:203]
ds_write_b64 v181, v[16:17] offset:0
v_mfma_f32_16x16x32_bf16 v[200:203], v[232:235], a[140:143], v[200:203]
ds_write_b64 v181, v[18:19] offset:128
v_mfma_f32_16x16x32_bf16 v[200:203], v[212:215], a[132:135], v[200:203]
v_cvt_pk_bf16_f32 v86, v204, v205
v_cvt_pk_bf16_f32 v87, v206, v207
v_mfma_f32_16x16x32_bf16 v[204:207], v[228:231], a[132:135], 0
v_cvt_pk_bf16_f32 v21, v210, v211
v_cvt_pk_bf16_f32 v94, v216, v217
v_cvt_pk_bf16_f32 v95, v218, v219
s_waitcnt lgkmcnt(2)
v_mfma_f32_16x16x32_bf16 v[204:207], v[196:199], a[128:131], v[204:207]
ds_read_b128 v[208:211], v242 offset:512
v_cvt_pk_bf16_f32 v82, v200, v201
v_cvt_pk_bf16_f32 v83, v202, v203
v_cvt_pk_bf16_f32 v90, v220, v221
v_cvt_pk_bf16_f32 v91, v222, v223
ds_write_b64 v181, v[20:21] offset:256
ds_write_b64 v181, v[22:23] offset:384
ds_read2_b32 v[236:237], v246 offset0:0 offset1:8
s_waitcnt lgkmcnt(3)
v_mfma_f32_16x16x32_bf16 v[204:207], v[208:211], a[136:139], v[204:207]
s_waitcnt vmcnt(4)
s_barrier
v_mfma_f32_16x16x32_bf16 v[204:207], v[192:195], a[140:143], v[204:207]
ds_read_b128 v[188:191], v242 offset:4224
ds_read_b128 v[212:215], v242 offset:4480
v_mfma_f32_16x16x32_bf16 v[200:203], v[192:195], a[156:159], 0
ds_read_b128 v[224:227], v242 offset:4736
ds_read_b128 v[232:235], v242 offset:4992
v_mfma_f32_16x16x32_bf16 v[200:203], v[208:211], a[152:155], v[200:203]
s_nop 1
v_cvt_pk_bf16_f32 v48, v204, v205
v_mfma_f32_16x16x32_bf16 v[200:203], v[228:231], a[148:151], v[200:203]
v_cvt_pk_bf16_f32 v49, v206, v207
v_mfma_f32_16x16x32_bf16 v[200:203], v[196:199], a[144:147], v[200:203]
s_nop 2
v_mfma_f32_16x16x32_bf16 v[204:207], v[196:199], a[160:163], 0
buffer_load_dwordx4 v174, s[36:39], s99 offen offset:0 lds
v_mfma_f32_16x16x32_bf16 v[204:207], v[228:231], a[164:167], v[204:207]
s_add_u32 s99, s57, 2048
buffer_load_dwordx4 v174, s[36:39], s100 offen offset:1024 lds
v_mfma_f32_16x16x32_bf16 v[204:207], v[208:211], a[168:171], v[204:207]
s_add_u32 s100, s57, 3072
v_cvt_pk_bf16_f32 v52, v200, v201
v_cvt_pk_bf16_f32 v53, v202, v203
v_mfma_f32_16x16x32_bf16 v[204:207], v[192:195], a[172:175], v[204:207]
L_h1:
s_cbranch_execz L_h5
s_waitcnt lgkmcnt(4)
s_nop 1
v_mfma_f32_16x16x32_bf16 v[200:203], v[192:195], a[188:191], 0
s_nop 2
v_mfma_f32_16x16x32_bf16 v[200:203], v[208:211], a[184:187], v[200:203]
v_cvt_pk_bf16_f32 v56, v204, v205
v_cvt_pk_bf16_f32 v57, v206, v207
v_mfma_f32_16x16x32_bf16 v[200:203], v[228:231], a[180:183], v[200:203]
s_waitcnt lgkmcnt(3)
v_mfma_f32_16x16x32_bf16 v[200:203], v[196:199], a[176:179], v[200:203]
s_waitcnt lgkmcnt(2)
s_nop 1
v_mfma_f32_16x16x32_bf16 v[192:195], a[64:67], v[188:191], 0
s_waitcnt lgkmcnt(1)
s_nop 1
v_mfma_f32_16x16x32_bf16 v[192:195], a[68:71], v[212:215], v[192:195]
s_waitcnt lgkmcnt(0)
v_cvt_pk_bf16_f32 v60, v200, v201
v_cvt_pk_bf16_f32 v61, v202, v203
v_mfma_f32_16x16x32_bf16 v[192:195], a[72:75], v[224:227], v[192:195]
buffer_load_dwordx4 v174, s[36:39], s99 offen offset:2048 lds
v_mfma_f32_16x16x32_bf16 v[192:195], a[76:79], v[232:235], v[192:195]
s_add_u32 s99, s57, 8192
buffer_load_dwordx4 v174, s[36:39], s100 offen offset:3072 lds
v_mfma_f32_16x16x32_bf16 v[196:199], a[92:95], v[232:235], 0
s_add_u32 m0, s98, 63744
s_add_u32 s100, s57, 9216
s_mov_b32 s98, s50
v_mfma_f32_16x16x32_bf16 v[196:199], a[88:91], v[224:227], v[196:199]
s_nop 0
v_cvt_pk_bf16_f32 v8, v192, v193
v_cvt_pk_bf16_f32 v9, v194, v195
v_mfma_f32_16x16x32_bf16 v[196:199], a[84:87], v[212:215], v[196:199]
v_mfma_f32_16x16x32_bf16 v[196:199], a[80:83], v[188:191], v[196:199]
s_nop 2
v_mfma_f32_16x16x32_bf16 v[192:195], a[96:99], v[188:191], 0
s_nop 2
v_mfma_f32_16x16x32_bf16 v[192:195], a[100:103], v[212:215], v[192:195]
v_cvt_pk_bf16_f32 v10, v196, v197
v_cvt_pk_bf16_f32 v11, v198, v199
v_mfma_f32_16x16x32_bf16 v[192:195], a[104:107], v[224:227], v[192:195]
v_mfma_f32_16x16x32_bf16 v[192:195], a[108:111], v[232:235], v[192:195]
s_nop 2
v_mfma_f32_16x16x32_bf16 v[196:199], a[124:127], v[232:235], 0
buffer_load_dwordx4 v174, s[36:39], s99 offen offset:0 lds
v_mfma_f32_16x16x32_bf16 v[196:199], a[120:123], v[224:227], v[196:199]
s_add_u32 s99, s57, 10240
buffer_load_dwordx4 v174, s[36:39], s100 offen offset:1024 lds
v_mfma_f32_16x16x32_bf16 v[196:199], a[116:119], v[212:215], v[196:199]
s_add_u32 s100, s57, 11264
v_cvt_pk_bf16_f32 v12, v192, v193
v_cvt_pk_bf16_f32 v13, v194, v195
v_mfma_f32_16x16x32_bf16 v[196:199], a[112:115], v[188:191], v[196:199]
s_nop 2
v_mfma_f32_16x16x32_bf16 v[192:195], v[188:191], a[128:131], 0
s_nop 2
v_mfma_f32_16x16x32_bf16 v[192:195], v[212:215], a[132:135], v[192:195]
v_cvt_pk_bf16_f32 v14, v196, v197
v_cvt_pk_bf16_f32 v15, v198, v199
v_mfma_f32_16x16x32_bf16 v[192:195], v[224:227], a[136:139], v[192:195]
v_mfma_f32_16x16x32_bf16 v[192:195], v[232:235], a[140:143], v[192:195]
s_nop 2
v_mfma_f32_16x16x32_bf16 v[196:199], v[12:15], v[156:159], 0
s_nop 2
v_mfma_f32_16x16x32_bf16 v[196:199], v[8:11], v[152:155], v[196:199]
v_cvt_pk_bf16_f32 v50, v192, v193
v_cvt_pk_bf16_f32 v51, v194, v195
v_mfma_f32_16x16x32_bf16 v[192:195], v[8:11], v[96:99], 0
buffer_load_dwordx4 v174, s[36:39], s99 offen offset:2048 lds
v_mfma_f32_16x16x32_bf16 v[192:195], v[12:15], v[100:103], v[192:195]
s_add_u32 s99, s98, s51
buffer_load_dwordx4 v174, s[36:39], s100 offen offset:3072 lds
v_mfma_f32_16x16x32_bf16 v[200:203], v[232:235], a[156:159], 0
s_add_u32 s100, s99, s51
ds_read_b128 v[204:207], v242 offset:8448
ds_read_b128 v[208:211], v242 offset:8704
v_mfma_f32_16x16x32_bf16 v[200:203], v[224:227], a[152:155], v[200:203]
s_add_u32 m0, s49, 0
ds_read_b128 v[216:219], v242 offset:8960
ds_read_b128 v[220:223], v242 offset:9216
v_mfma_f32_16x16x32_bf16 v[200:203], v[212:215], a[148:151], v[200:203]
s_add_u32 s101, s100, s51
v_exp_f32 v196, v196
v_mfma_f32_16x16x32_bf16 v[200:203], v[188:191], a[144:147], v[200:203]
v_exp_f32 v197, v197
v_mfma_f32_16x16x32_bf16 v[228:231], v[188:191], a[160:163], 0
v_exp_f32 v198, v198
v_mfma_f32_16x16x32_bf16 v[228:231], v[212:215], a[164:167], v[228:231]
v_exp_f32 v199, v199
v_mfma_f32_16x16x32_bf16 v[228:231], v[224:227], a[168:171], v[228:231]
v_cvt_pk_bf16_f32 v106, v196, v197
v_cvt_pk_bf16_f32 v107, v198, v199
v_mfma_f32_16x16x32_bf16 v[228:231], v[232:235], a[172:175], v[228:231]
v_cvt_pk_bf16_f32 v54, v200, v201
v_cvt_pk_bf16_f32 v55, v202, v203
v_mfma_f32_16x16x32_bf16 v[196:199], v[232:235], a[188:191], 0
v_exp_f32 v192, v192
v_mfma_f32_16x16x32_bf16 v[196:199], v[224:227], a[184:187], v[196:199]
v_exp_f32 v193, v193
v_mfma_f32_16x16x32_bf16 v[196:199], v[212:215], a[180:183], v[196:199]
s_waitcnt lgkmcnt(3)
v_exp_f32 v194, v194
v_mfma_f32_16x16x32_bf16 v[196:199], v[188:191], a[176:179], v[196:199]
s_waitcnt lgkmcnt(2)
v_exp_f32 v195, v195
v_mfma_f32_16x16x32_bf16 v[200:203], a[64:67], v[204:207], 0
s_waitcnt lgkmcnt(1)
v_cvt_pk_bf16_f32 v122, v192, v193
v_cvt_pk_bf16_f32 v123, v194, v195
v_mfma_f32_16x16x32_bf16 v[200:203], a[68:71], v[208:211], v[200:203]
s_waitcnt lgkmcnt(0)
v_cvt_pk_bf16_f32 v62, v196, v197
v_cvt_pk_bf16_f32 v63, v198, v199
v_mfma_f32_16x16x32_bf16 v[200:203], a[72:75], v[216:219], v[200:203]
v_cvt_pk_bf16_f32 v58, v228, v229
v_cvt_pk_bf16_f32 v59, v230, v231
v_mfma_f32_16x16x32_bf16 v[200:203], a[76:79], v[220:223], v[200:203]
s_nop 2
v_mfma_f32_16x16x32_bf16 v[192:195], a[92:95], v[220:223], 0
s_nop 2
v_mfma_f32_16x16x32_bf16 v[192:195], a[88:91], v[216:219], v[192:195]
v_cvt_pk_bf16_f32 v16, v200, v201
v_cvt_pk_bf16_f32 v17, v202, v203
v_mfma_f32_16x16x32_bf16 v[192:195], a[84:87], v[208:211], v[192:195]
v_mfma_f32_16x16x32_bf16 v[192:195], a[80:83], v[204:207], v[192:195]
s_nop 2
v_mfma_f32_16x16x32_bf16 v[196:199], a[96:99], v[204:207], 0
s_nop 2
v_mfma_f32_16x16x32_bf16 v[196:199], a[100:103], v[208:211], v[196:199]
v_cvt_pk_bf16_f32 v18, v192, v193
v_cvt_pk_bf16_f32 v19, v194, v195
v_mfma_f32_16x16x32_bf16 v[196:199], a[104:107], v[216:219], v[196:199]
v_mfma_f32_16x16x32_bf16 v[196:199], a[108:111], v[220:223], v[196:199]
s_nop 2
v_mfma_f32_16x16x32_bf16 v[192:195], a[124:127], v[220:223], 0
s_nop 2
v_mfma_f32_16x16x32_bf16 v[192:195], a[120:123], v[216:219], v[192:195]
v_cvt_pk_bf16_f32 v20, v196, v197
v_cvt_pk_bf16_f32 v21, v198, v199
v_mfma_f32_16x16x32_bf16 v[192:195], a[116:119], v[208:211], v[192:195]
v_mfma_f32_16x16x32_bf16 v[192:195], a[112:115], v[204:207], v[192:195]
s_nop 2
v_mfma_f32_16x16x32_bf16 v[196:199], v[204:207], a[128:131], 0
s_nop 2
v_mfma_f32_16x16x32_bf16 v[196:199], v[208:211], a[132:135], v[196:199]
v_cvt_pk_bf16_f32 v22, v192, v193
v_cvt_pk_bf16_f32 v23, v194, v195
v_mfma_f32_16x16x32_bf16 v[196:199], v[216:219], a[136:139], v[196:199]
v_mfma_f32_16x16x32_bf16 v[196:199], v[220:223], a[140:143], v[196:199]
s_nop 2
v_mfma_f32_16x16x32_bf16 v[192:195], v[20:23], v[156:159], 0
s_nop 2
v_mfma_f32_16x16x32_bf16 v[192:195], v[16:19], v[152:155], v[192:195]
v_cvt_pk_bf16_f32 v64, v196, v197
v_cvt_pk_bf16_f32 v65, v198, v199
v_mfma_f32_16x16x32_bf16 v[196:199], v[16:19], v[96:99], 0
s_nop 2
v_mfma_f32_16x16x32_bf16 v[196:199], v[20:23], v[100:103], v[196:199]
s_nop 0
v_exp_f32 v192, v192
v_mfma_f32_16x16x32_bf16 v[200:203], v[220:223], a[156:159], 0
v_exp_f32 v193, v193
v_mfma_f32_16x16x32_bf16 v[200:203], v[216:219], a[152:155], v[200:203]
v_exp_f32 v194, v194
v_mfma_f32_16x16x32_bf16 v[200:203], v[208:211], a[148:151], v[200:203]
v_exp_f32 v195, v195
v_mfma_f32_16x16x32_bf16 v[200:203], v[204:207], a[144:147], v[200:203]
s_waitcnt vmcnt(0)
s_barrier
v_mfma_f32_16x16x32_bf16 v[228:231], v[204:207], a[160:163], 0
ds_read_b128 v[188:191], v242 offset:16896
v_cvt_pk_bf16_f32 v108, v192, v193
v_mfma_f32_16x16x32_bf16 v[228:231], v[208:211], a[164:167], v[228:231]
ds_read_b128 v[212:215], v242 offset:17152
v_cvt_pk_bf16_f32 v109, v194, v195
v_mfma_f32_16x16x32_bf16 v[228:231], v[216:219], a[168:171], v[228:231]
ds_read_b128 v[224:227], v242 offset:17408
v_cvt_pk_bf16_f32 v68, v200, v201
v_mfma_f32_16x16x32_bf16 v[228:231], v[220:223], a[172:175], v[228:231]
ds_read_b128 v[232:235], v242 offset:17664
v_cvt_pk_bf16_f32 v69, v202, v203
v_mfma_f32_16x16x32_bf16 v[192:195], v[220:223], a[188:191], 0
ds_read_b64_tr_b16 a[192:193], v182 offset:0
s_nop 0
v_mfma_f32_16x16x32_bf16 v[192:195], v[216:219], a[184:187], v[192:195]
ds_read_b64_tr_b16 a[194:195], v182 offset:512
v_mfma_f32_16x16x32_bf16 v[192:195], v[208:211], a[180:183], v[192:195]
s_waitcnt lgkmcnt(5)
ds_read_b64_tr_b16 a[196:197], v182 offset:4096
v_cvt_pk_bf16_f32 v72, v228, v229
v_mfma_f32_16x16x32_bf16 v[192:195], v[204:207], a[176:179], v[192:195]
buffer_load_dwordx4 v243, s[16:19], s98 offen offset:0 nt lds
v_mfma_f32_16x16x32_bf16 v[200:203], a[64:67], v[188:191], 0
s_waitcnt lgkmcnt(4)
ds_read_b64_tr_b16 a[198:199], v182 offset:4608
v_cvt_pk_bf16_f32 v73, v230, v231
v_mfma_f32_16x16x32_bf16 v[200:203], a[68:71], v[212:215], v[200:203]
s_waitcnt lgkmcnt(4)
ds_read_b64_tr_b16 a[200:201], v182 offset:8192
v_cvt_pk_bf16_f32 v76, v192, v193
v_mfma_f32_16x16x32_bf16 v[200:203], a[72:75], v[224:227], v[200:203]
ds_read_b64_tr_b16 a[202:203], v182 offset:8704
v_cvt_pk_bf16_f32 v77, v194, v195
v_mfma_f32_16x16x32_bf16 v[200:203], a[76:79], v[232:235], v[200:203]
ds_read_b64_tr_b16 a[204:205], v182 offset:12288
s_nop 0
v_mfma_f32_16x16x32_bf16 v[192:195], a[92:95], v[232:235], 0
ds_read_b64_tr_b16 a[206:207], v182 offset:12800
s_nop 0
v_mfma_f32_16x16x32_bf16 v[192:195], a[88:91], v[224:227], v[192:195]
ds_read_b64_tr_b16 a[208:209], v182 offset:8
v_mfma_f32_16x16x32_bf16 v[192:195], a[84:87], v[212:215], v[192:195]
ds_read_b64_tr_b16 a[210:211], v182 offset:520
v_cvt_pk_bf16_f32 v32, v200, v201
v_mfma_f32_16x16x32_bf16 v[192:195], a[80:83], v[188:191], v[192:195]
buffer_load_dwordx4 v243, s[16:19], s99 offen offset:1056 nt lds
v_mfma_f32_16x16x32_bf16 v[204:207], a[96:99], v[188:191], 0
ds_read_b64_tr_b16 a[212:213], v182 offset:4104
v_cvt_pk_bf16_f32 v33, v202, v203
v_mfma_f32_16x16x32_bf16 v[204:207], a[100:103], v[212:215], v[204:207]
s_waitcnt lgkmcnt(10)
ds_read_b64_tr_b16 a[214:215], v182 offset:4616
v_mfma_f32_16x16x32_bf16 v[204:207], a[104:107], v[224:227], v[204:207]
s_waitcnt lgkmcnt(10)
ds_read_b64_tr_b16 a[216:217], v182 offset:8200
v_cvt_pk_bf16_f32 v34, v192, v193
v_mfma_f32_16x16x32_bf16 v[204:207], a[108:111], v[232:235], v[204:207]
s_waitcnt lgkmcnt(10)
ds_read_b64_tr_b16 a[218:219], v182 offset:8712
v_cvt_pk_bf16_f32 v35, v194, v195
v_mfma_f32_16x16x32_bf16 v[192:195], a[124:127], v[232:235], 0
ds_read_b64_tr_b16 a[220:221], v182 offset:12296
s_nop 0
v_mfma_f32_16x16x32_bf16 v[192:195], a[120:123], v[224:227], v[192:195]
s_waitcnt lgkmcnt(11)
ds_read_b64_tr_b16 a[222:223], v182 offset:12808
v_cvt_pk_bf16_f32 v36, v204, v205
v_mfma_f32_16x16x32_bf16 v[192:195], a[116:119], v[212:215], v[192:195]
s_waitcnt lgkmcnt(11)
ds_read_b64_tr_b16 a[224:225], v183 offset:0
v_cvt_pk_bf16_f32 v37, v206, v207
v_mfma_f32_16x16x32_bf16 v[192:195], a[112:115], v[188:191], v[192:195]
buffer_load_dwordx4 v243, s[16:19], s100 offen offset:2112 nt lds
v_mfma_f32_16x16x32_bf16 v[200:203], v[188:191], a[128:131], 0
s_waitcnt lgkmcnt(10)
ds_read_b64_tr_b16 a[226:227], v183 offset:512
s_nop 0
v_mfma_f32_16x16x32_bf16 v[200:203], v[212:215], a[132:135], v[200:203]
s_waitcnt lgkmcnt(10)
ds_read_b64_tr_b16 a[228:229], v183 offset:4096
v_cvt_pk_bf16_f32 v38, v192, v193
v_mfma_f32_16x16x32_bf16 v[200:203], v[224:227], a[136:139], v[200:203]
s_waitcnt lgkmcnt(10)
ds_read_b64_tr_b16 a[230:231], v183 offset:4608
v_cvt_pk_bf16_f32 v39, v194, v195
v_mfma_f32_16x16x32_bf16 v[200:203], v[232:235], a[140:143], v[200:203]
s_waitcnt lgkmcnt(10)
ds_read_b64_tr_b16 a[232:233], v183 offset:8192
s_nop 0
v_mfma_f32_16x16x32_bf16 v[192:195], v[36:39], v[156:159], 0
ds_read_b64_tr_b16 a[234:235], v183 offset:8704
s_nop 0
v_mfma_f32_16x16x32_bf16 v[192:195], v[32:35], v[152:155], v[192:195]
s_waitcnt lgkmcnt(11)
ds_read_b64_tr_b16 a[236:237], v183 offset:12288
v_cvt_pk_bf16_f32 v80, v200, v201
v_mfma_f32_16x16x32_bf16 v[204:207], v[32:35], v[96:99], 0
s_waitcnt lgkmcnt(11)
ds_read_b64_tr_b16 a[238:239], v183 offset:12800
v_cvt_pk_bf16_f32 v81, v202, v203
v_mfma_f32_16x16x32_bf16 v[204:207], v[36:39], v[100:103], v[204:207]
s_waitcnt lgkmcnt(11)
ds_read_b64_tr_b16 a[240:241], v183 offset:8
s_nop 0
v_mfma_f32_16x16x32_bf16 v[200:203], v[232:235], a[156:159], 0
s_waitcnt lgkmcnt(11)
ds_read_b64_tr_b16 a[242:243], v183 offset:520
ds_read_b128 v[208:211], v242 offset:12672
v_mfma_f32_16x16x32_bf16 v[200:203], v[224:227], a[152:155], v[200:203]
s_waitcnt lgkmcnt(12)
ds_read_b128 v[216:219], v242 offset:12928
ds_read_b128 v[220:223], v242 offset:13184
v_mfma_f32_16x16x32_bf16 v[200:203], v[212:215], a[148:151], v[200:203]
s_waitcnt lgkmcnt(13)
v_exp_f32 v192, v192
v_mfma_f32_16x16x32_bf16 v[200:203], v[188:191], a[144:147], v[200:203]
buffer_load_dwordx4 v243, s[16:19], s101 offen offset:3168 nt lds
v_mfma_f32_16x16x32_bf16 v[228:231], v[188:191], a[160:163], 0
s_waitcnt lgkmcnt(12)
v_exp_f32 v193, v193
v_mfma_f32_16x16x32_bf16 v[228:231], v[212:215], a[164:167], v[228:231]
s_waitcnt lgkmcnt(11)
v_exp_f32 v194, v194
v_mfma_f32_16x16x32_bf16 v[228:231], v[224:227], a[168:171], v[228:231]
s_waitcnt lgkmcnt(10)
ds_read_b64_tr_b16 a[244:245], v183 offset:4104
v_cvt_pk_bf16_f32 v112, v192, v193
v_mfma_f32_16x16x32_bf16 v[228:231], v[232:235], a[172:175], v[228:231]
s_waitcnt lgkmcnt(10)
ds_read_b64_tr_b16 a[246:247], v183 offset:4616
v_exp_f32 v195, v195
s_nop 0
v_cvt_pk_bf16_f32 v113, v194, v195
v_mfma_f32_16x16x32_bf16 v[192:195], v[232:235], a[188:191], 0
s_waitcnt lgkmcnt(9)
ds_read_b64_tr_b16 a[248:249], v183 offset:8200
v_cvt_pk_bf16_f32 v88, v228, v229
v_mfma_f32_16x16x32_bf16 v[192:195], v[224:227], a[184:187], v[192:195]
s_waitcnt lgkmcnt(9)
ds_read_b64_tr_b16 a[250:251], v183 offset:8712
v_cvt_pk_bf16_f32 v89, v230, v231
v_mfma_f32_16x16x32_bf16 v[192:195], v[212:215], a[180:183], v[192:195]
s_waitcnt lgkmcnt(6)
ds_read_b64_tr_b16 a[252:253], v183 offset:12296
v_cvt_pk_bf16_f32 v84, v200, v201
v_mfma_f32_16x16x32_bf16 v[192:195], v[188:191], a[176:179], v[192:195]
s_waitcnt lgkmcnt(6)
ds_read_b64_tr_b16 a[254:255], v183 offset:12808
v_cvt_pk_bf16_f32 v85, v202, v203
v_mfma_f32_16x16x32_bf16 v[228:231], a[64:67], v[208:211], 0
s_waitcnt lgkmcnt(6)
ds_read_b128 v[200:203], v242 offset:13440
s_nop 0
v_mfma_f32_16x16x32_bf16 v[228:231], a[68:71], v[216:219], v[228:231]
v_cvt_pk_bf16_f32 v92, v192, v193
v_cvt_pk_bf16_f32 v93, v194, v195
v_mfma_f32_16x16x32_bf16 v[228:231], a[72:75], v[220:223], v[228:231]
v_exp_f32 v204, v204
v_exp_f32 v205, v205
v_exp_f32 v206, v206
v_exp_f32 v207, v207
v_cvt_pk_bf16_f32 v128, v204, v205
v_cvt_pk_bf16_f32 v129, v206, v207
v_exp_f32 v196, v196
s_waitcnt lgkmcnt(0)
v_mfma_f32_16x16x32_bf16 v[228:231], a[76:79], v[200:203], v[228:231]
s_barrier
v_mfma_f32_16x16x32_bf16 v[192:195], a[92:95], v[200:203], 0
s_add_u32 s98, s98, s48
v_exp_f32 v197, v197
v_mfma_f32_16x16x32_bf16 v[192:195], a[88:91], v[220:223], v[192:195]
s_add_u32 s99, s98, s51
v_exp_f32 v198, v198
v_mfma_f32_16x16x32_bf16 v[192:195], a[84:87], v[216:219], v[192:195]
s_add_u32 s100, s99, s51
s_add_u32 m0, s49, 8448
s_add_u32 s101, s100, s51
v_mfma_f32_16x16x32_bf16 v[192:195], a[80:83], v[208:211], v[192:195]
buffer_load_dwordx4 v243, s[16:19], s98 offen offset:0 nt lds
v_cvt_pk_bf16_f32 v24, v228, v229
v_cvt_pk_bf16_f32 v25, v230, v231
v_mfma_f32_16x16x32_bf16 v[228:231], a[96:99], v[208:211], 0
s_add_u32 s98, s98, s48
v_exp_f32 v199, v199
v_mfma_f32_16x16x32_bf16 v[228:231], a[100:103], v[216:219], v[228:231]
s_bfe_i32 s57, s3, 0x10000
v_cvt_pk_bf16_f32 v26, v192, v193
v_cvt_pk_bf16_f32 v27, v194, v195
v_mfma_f32_16x16x32_bf16 v[228:231], a[104:107], v[220:223], v[228:231]
s_and_b32 s54, s57, s5
v_cvt_pk_bf16_f32 v124, v196, v197
v_cvt_pk_bf16_f32 v125, v198, v199
v_mfma_f32_16x16x32_bf16 v[228:231], a[108:111], v[200:203], v[228:231]
s_add_u32 s50, s50, 13107200
ds_read_b128 v[196:199], v247 offset:0
v_add_u32 v245, 1728, v245
v_mfma_f32_16x16x32_bf16 v[192:195], a[124:127], v[200:203], 0
s_mov_b32 s47, s46
v_add_u32 v246, 1728, v246
v_add_u32 v247, 1728, v247
v_mfma_f32_16x16x32_bf16 v[192:195], a[120:123], v[220:223], v[192:195]
s_lshr_b32 s3, s3, 1
v_cvt_pk_bf16_f32 v28, v228, v229
v_cvt_pk_bf16_f32 v29, v230, v231
v_mfma_f32_16x16x32_bf16 v[192:195], a[116:119], v[216:219], v[192:195]
s_sub_u32 s45, s45, 1
s_sub_u32 s50, s50, s54
s_add_u32 s52, s46, 20480
v_mfma_f32_16x16x32_bf16 v[192:195], a[112:115], v[208:211], v[192:195]
buffer_load_dwordx4 v243, s[16:19], s99 offen offset:1056 nt lds
v_mfma_f32_16x16x32_bf16 v[204:207], v[208:211], a[128:131], 0
s_add_u32 s99, s98, s51
s_add_u32 s53, s46, 0
s_nop 0
v_mfma_f32_16x16x32_bf16 v[204:207], v[216:219], a[132:135], v[204:207]
s_nop 1
v_cvt_pk_bf16_f32 v30, v192, v193
v_mfma_f32_16x16x32_bf16 v[204:207], v[220:223], a[136:139], v[204:207]
v_cvt_pk_bf16_f32 v31, v194, v195
v_mfma_f32_16x16x32_bf16 v[204:207], v[200:203], a[140:143], v[204:207]
v_mov_b64 v[168:169], 0
v_mov_b64 v[170:171], 0
v_mfma_f32_16x16x32_bf16 v[192:195], v[28:31], v[156:159], 0
v_mov_b64 v[172:173], 0
v_mov_b64 v[174:175], 0
v_mfma_f32_16x16x32_bf16 v[192:195], v[24:27], v[152:155], v[192:195]
v_mov_b64 v[176:177], 0
s_nop 0
v_cvt_pk_bf16_f32 v66, v204, v205
v_cvt_pk_bf16_f32 v67, v206, v207
v_mfma_f32_16x16x32_bf16 v[204:207], v[24:27], v[96:99], 0
s_waitcnt lgkmcnt(0)
v_mov_b64 v[178:179], 0
v_mfma_f32_16x16x32_bf16 v[204:207], v[28:31], v[100:103], v[204:207]
ds_read_b128 v[152:155], v242 offset:21120
ds_read_b128 v[156:159], v242 offset:21376
v_smfmac_f32_16x16x64_bf16 v[168:171], v[196:199], v[0:7], v251
ds_read_b128 v[160:163], v242 offset:21632
ds_read_b128 v[164:167], v242 offset:21888
v_smfmac_f32_16x16x64_bf16 v[172:175], v[196:199], v[16:23], v251
s_nop 2
v_smfmac_f32_16x16x64_bf16 v[176:179], v[196:199], v[32:39], v251
s_nop 0
v_add_f32 v168, v168, v169
v_mfma_f32_16x16x32_bf16 v[228:231], v[200:203], a[156:159], 0
v_exp_f32 v192, v192
v_mfma_f32_16x16x32_bf16 v[228:231], v[220:223], a[152:155], v[228:231]
v_exp_f32 v193, v193
v_mfma_f32_16x16x32_bf16 v[228:231], v[216:219], a[148:151], v[228:231]
v_exp_f32 v194, v194
v_mfma_f32_16x16x32_bf16 v[228:231], v[208:211], a[144:147], v[228:231]
v_exp_f32 v195, v195
v_smfmac_f32_16x16x64_bf16 v[170:173], v[196:199], v[8:15], v251
v_cvt_pk_bf16_f32 v110, v192, v193
v_smfmac_f32_16x16x64_bf16 v[174:177], v[196:199], v[24:31], v251
v_cvt_pk_bf16_f32 v111, v194, v195
v_smfmac_f32_16x16x64_bf16 v[178:181], v[196:199], v[40:47], v251
s_nop 1
v_cvt_pk_bf16_f32 v70, v228, v229
v_mfma_f32_16x16x32_bf16 v[192:195], v[208:211], a[160:163], 0
v_cvt_pk_bf16_f32 v71, v230, v231
v_add_f32 v170, v170, v171
v_mfma_f32_16x16x32_bf16 v[192:195], v[216:219], a[164:167], v[192:195]
v_exp_f32 v204, v204
v_mfma_f32_16x16x32_bf16 v[192:195], v[220:223], a[168:171], v[192:195]
s_waitcnt lgkmcnt(2)
v_exp_f32 v205, v205
v_mfma_f32_16x16x32_bf16 v[192:195], v[200:203], a[172:175], v[192:195]
buffer_load_dwordx4 v243, s[16:19], s100 offen offset:2112 nt lds
v_mfma_f32_16x16x32_bf16 v[196:199], v[200:203], a[188:191], 0
s_waitcnt lgkmcnt(0)
ds_read_b128 v[200:203], v242 offset:0
v_mov_b64 v[228:229], 0
v_mfma_f32_16x16x32_bf16 v[196:199], v[220:223], a[184:187], v[196:199]
s_add_u32 s100, s99, s51
ds_read_b128 v[220:223], v242 offset:256
v_cvt_pk_bf16_f32 v74, v192, v193
v_mfma_f32_16x16x32_bf16 v[196:199], v[216:219], a[180:183], v[196:199]
ds_read_b128 v[216:219], v242 offset:512
v_cvt_pk_bf16_f32 v75, v194, v195
v_mfma_f32_16x16x32_bf16 v[196:199], v[208:211], a[176:179], v[196:199]
ds_read_b128 v[192:195], v242 offset:768
v_cvt_pk_bf16_f32 v126, v204, v205
v_smfmac_f32_16x16x64_bf16 v[228:231], v[184:187], v[104:111], v251
v_add_f32 v172, v172, v173
v_smfmac_f32_16x16x64_bf16 v[228:231], v[184:187], v[112:119], v251 abid:1
v_add_f32 v174, v174, v175
v_mfma_f32_16x16x32_bf16 v[136:139], a[192:195], v[152:155], 0
v_exp_f32 v168, v168
v_mfma_f32_16x16x32_bf16 v[136:139], a[196:199], v[156:159], v[136:139]
v_exp_f32 v170, v170
v_mfma_f32_16x16x32_bf16 v[136:139], a[200:203], v[160:163], v[136:139]
v_exp_f32 v172, v172
v_mfma_f32_16x16x32_bf16 v[136:139], a[204:207], v[164:167], v[136:139]
buffer_load_dwordx4 v243, s[16:19], s101 offen offset:3168 nt lds
v_mfma_f32_16x16x32_bf16 v[140:143], a[220:223], v[164:167], 0
s_add_u32 m0, s49, 16896
v_exp_f32 v174, v174
v_mfma_f32_16x16x32_bf16 v[140:143], a[216:219], v[160:163], v[140:143]
s_add_u32 s101, s100, s51
v_add_f32 v176, v176, v177
v_add_f32 v178, v178, v179
v_mfma_f32_16x16x32_bf16 v[140:143], a[212:215], v[156:159], v[140:143]
s_and_b32 s51, s57, 13106176
v_exp_f32 v176, v176
v_mfma_f32_16x16x32_bf16 v[140:143], a[208:211], v[152:155], v[140:143]
s_waitcnt lgkmcnt(3)
v_add_f32 v180, v168, v170
v_cvt_pk_bf16_f32 v169, v168, v170
v_mfma_f32_16x16x32_bf16 v[144:147], a[224:227], v[152:155], 0
s_waitcnt lgkmcnt(2)
ds_write_b16 v248, v169 offset:0
v_mfma_f32_16x16x32_bf16 v[144:147], a[228:231], v[156:159], v[144:147]
s_waitcnt lgkmcnt(2)
ds_write_b16_d16_hi v248, v169 offset:4
v_mfma_f32_16x16x32_bf16 v[144:147], a[232:235], v[160:163], v[144:147]
s_waitcnt lgkmcnt(2)
v_exp_f32 v178, v178
v_mfma_f32_16x16x32_bf16 v[144:147], a[236:239], v[164:167], v[144:147]
buffer_load_dwordx4 v243, s[16:19], s98 offen offset:0 nt lds
v_mfma_f32_16x16x32_bf16 v[148:151], a[252:255], v[164:167], 0
s_lshl3_add_u32 s48, s51, 8192
v_add_f32 v180, v180, v172
v_add_f32 v180, v180, v174
v_mfma_f32_16x16x32_bf16 v[148:151], a[244:247], v[156:159], v[148:151]
s_sub_u32 s49, s49, s56
v_add_f32 v180, v180, v176
v_add_f32 v180, v180, v178
v_mfma_f32_16x16x32_bf16 v[148:151], a[240:243], v[152:155], v[148:151]
s_sub_u32 s51, s51, 32
v_cvt_pk_bf16_f32 v173, v172, v174
v_add_f32_dpp v180, v180, v180 row_ror:8 row_mask:0xf bank_mask:0xf
v_mfma_f32_16x16x32_bf16 v[148:151], a[248:251], v[160:163], v[148:151]
ds_write_b16 v248, v173 offset:272
v_mfma_f32_16x16x32_bf16 v[164:167], a[248:251], v[216:219], 0
ds_write_b16_d16_hi v248, v173 offset:276
v_mfma_f32_16x16x32_bf16 v[164:167], a[252:255], v[192:195], v[164:167]
v_cvt_pk_bf16_f32 v177, v176, v178
v_add_f32_dpp v180, v180, v180 row_ror:4 row_mask:0xf bank_mask:0xf
v_mfma_f32_16x16x32_bf16 v[164:167], a[244:247], v[220:223], v[164:167]
ds_write_b16 v248, v177 offset:544
v_mfma_f32_16x16x32_bf16 v[164:167], a[240:243], v[200:203], v[164:167]
buffer_load_dwordx4 v243, s[16:19], s99 offen offset:1056 nt lds
v_mfma_f32_16x16x32_bf16 v[160:163], a[224:227], v[200:203], 0
ds_write_b32 v250, v180 offset:256
v_mfma_f32_16x16x32_bf16 v[160:163], a[228:231], v[220:223], v[160:163]
ds_write_b16_d16_hi v248, v177 offset:548
v_mfma_f32_16x16x32_bf16 v[160:163], a[232:235], v[216:219], v[160:163]
ds_read_b128 v[208:211], v249 offset:0
v_add_f32 v228, v228, v229
v_mfma_f32_16x16x32_bf16 v[160:163], a[236:239], v[192:195], v[160:163]
v_exp_f32 v206, v206
v_mfma_f32_32x32x16_bf16 v[168:183], v[236:239], v[116:119], 0
v_exp_f32 v207, v207
v_rcp_f32 v254, v228
v_cvt_pk_bf16_f32 v127, v206, v207
v_cvt_pk_bf16_f32 v78, v196, v197
v_mfma_f32_16x16x32_bf16 v[156:159], a[220:223], v[192:195], 0
v_cvt_pk_bf16_f32 v79, v198, v199
v_max3_f32 v255, v255, v228, v254
v_mfma_f32_16x16x32_bf16 v[156:159], a[216:219], v[216:219], v[156:159]
v_mfma_f32_16x16x32_bf16 v[156:159], a[212:215], v[220:223], v[156:159]
v_mfma_f32_16x16x32_bf16 v[156:159], a[208:211], v[200:203], v[156:159]
buffer_load_dwordx4 v243, s[16:19], s100 offen offset:2112 nt lds
v_mfma_f32_16x16x32_bf16 v[152:155], a[192:195], v[200:203], 0
v_mfma_f32_16x16x32_bf16 v[152:155], a[196:199], v[220:223], v[152:155]
ds_read_b128 v[220:223], v249 offset:544
v_mfma_f32_16x16x32_bf16 v[152:155], a[200:203], v[216:219], v[152:155]
ds_read_b128 v[216:219], v249 offset:272
v_mfma_f32_16x16x32_bf16 v[152:155], a[204:207], v[192:195], v[152:155]
buffer_load_dwordx4 v243, s[16:19], s101 offen offset:3168 nt lds
v_mfma_f32_16x16x32_bf16 v[168:171], v[48:51], v[104:107], v[168:171]
s_mov_b32 m0, s58
v_mfma_f32_16x16x32_bf16 v[168:171], v[64:67], v[108:111], v[168:171]
s_waitcnt lgkmcnt(2)
v_mfma_f32_16x16x32_bf16 v[168:171], v[80:83], v[112:115], v[168:171]
v_mfma_f32_16x16x32_bf16 v[172:175], v[84:87], v[112:115], v[172:175]
v_mfma_f32_16x16x32_bf16 v[172:175], v[52:55], v[104:107], v[172:175]
v_mfma_f32_16x16x32_bf16 v[172:175], v[68:71], v[108:111], v[172:175]
v_mfma_f32_16x16x32_bf16 v[176:179], v[72:75], v[108:111], v[176:179]
v_mfma_f32_16x16x32_bf16 v[176:179], v[88:91], v[112:115], v[176:179]
v_mfma_f32_16x16x32_bf16 v[176:179], v[56:59], v[104:107], v[176:179]
s_branch L_entryf
L_spin:
ds_read_addtid_b32 v192 offset:65280
s_waitcnt lgkmcnt(0)
v_cmp_lt_u32 vcc, s45, v192
s_nop 1
s_cbranch_vccnz L_spin
s_branch L_back
L_spine:
ds_read_addtid_b32 v188 offset:65280
s_waitcnt lgkmcnt(0)
v_cmp_lt_u32 vcc, s45, v188
s_nop 1
s_cbranch_vccnz L_spine
s_branch L_backe
.p2align 12
.fill 511, 4, 0xbf800000
L_h3:
s_cbranch_execz L_ret
L_loopf:
v_mfma_f32_16x16x32_bf16 v[152:155], a[192:195], v[188:191], 0
s_mov_b32 m0, s59
v_cvt_pk_bf16_f32 v102, v232, v233
v_cvt_pk_bf16_f32 v103, v234, v235
v_mfma_f32_16x16x32_bf16 v[152:155], a[196:199], v[208:211], v[152:155]
s_add_u32 s52, s47, 8192
ds_read_addtid_b32 v192 offset:65280
v_cvt_pk_bf16_f32 v106, v204, v205
v_mfma_f32_16x16x32_bf16 v[152:155], a[200:203], v[212:215], v[152:155]
s_add_u32 s53, s47, 12288
v_exp_f32 v221, v221
v_mfma_f32_16x16x32_bf16 v[152:155], a[204:207], v[216:219], v[152:155]
s_bfe_i32 s57, s3, 0x10000
v_exp_f32 v222, v222
v_mfma_f32_16x16x32_bf16 v[156:159], a[220:223], v[216:219], 0
s_mov_b32 s47, s46
v_exp_f32 v223, v223
v_mfma_f32_16x16x32_bf16 v[156:159], a[216:219], v[212:215], v[156:159]
s_and_b32 s54, s57, s5
v_cvt_pk_bf16_f32 v110, v220, v221
v_cvt_pk_bf16_f32 v111, v222, v223
v_mfma_f32_16x16x32_bf16 v[156:159], a[212:215], v[208:211], v[156:159]
s_lshr_b32 s3, s3, 1
v_exp_f32 v196, v196
v_mfma_f32_16x16x32_bf16 v[156:159], a[208:211], v[188:191], v[156:159]
s_waitcnt lgkmcnt(0)
v_cmp_lt_u32 vcc, s45, v192
v_cvt_pk_bf16_f32 v107, v206, v207
v_mfma_f32_16x16x32_bf16 v[160:163], a[224:227], v[188:191], 0
v_exp_f32 v197, v197
v_mfma_f32_16x16x32_bf16 v[160:163], a[228:231], v[208:211], v[160:163]
v_exp_f32 v198, v198
v_mfma_f32_16x16x32_bf16 v[160:163], a[232:235], v[212:215], v[160:163]
s_cbranch_vccnz L_spin
L_back:
v_exp_f32 v199, v199
v_mfma_f32_16x16x32_bf16 v[160:163], a[236:239], v[216:219], v[160:163]
s_mov_b32 s98, s50
ds_read_b128 v[192:195], v242 offset:0
v_cvt_pk_bf16_f32 v104, v196, v197
v_mfma_f32_16x16x32_bf16 v[164:167], a[252:255], v[216:219], 0
s_add_u32 s99, s98, s51
ds_read_b128 v[216:219], v242 offset:512
v_cvt_pk_bf16_f32 v105, v198, v199
v_mfma_f32_16x16x32_bf16 v[164:167], a[248:251], v[212:215], v[164:167]
s_add_u32 s100, s99, s51
ds_read_b128 v[196:199], v242 offset:256
v_mov_b64 v[212:213], s[96:97]
v_mfma_f32_16x16x32_bf16 v[164:167], a[244:247], v[208:211], v[164:167]
s_add_u32 m0, s49, 0
ds_read_b128 v[204:207], v242 offset:768
v_mov_b64 v[214:215], s[96:97]
v_mfma_f32_16x16x32_bf16 v[164:167], a[240:243], v[188:191], v[164:167]
s_add_u32 s101, s100, s51
v_exp_f32 v224, v224
v_mfma_f32_16x16x32_bf16 v[188:191], v[12:15], v[100:103], 0
s_sub_u32 s45, s45, 1
v_exp_f32 v225, v225
v_mfma_f32_16x16x32_bf16 v[188:191], v[8:11], v[96:99], v[188:191]
s_waitcnt lgkmcnt(3)
v_exp_f32 v226, v226
v_smfmac_f32_16x16x64_bf16 v[212:215], v[238:241], v[96:103], v251
s_add_u32 s50, s50, 13107200
s_sub_u32 s50, s50, s54
v_cvt_pk_bf16_f32 v108, v224, v225
v_mfma_f32_16x16x32_bf16 v[208:211], v[0:3], v[96:99], 0
v_exp_f32 v227, v227
v_mfma_f32_16x16x32_bf16 v[208:211], v[4:7], v[100:103], v[208:211]
s_waitcnt lgkmcnt(1)
v_cvt_pk_bf16_f32 v109, v226, v227
v_add_f32 v212, v212, v213
v_mfma_f32_16x16x32_bf16 v[220:223], a[64:67], v[192:195], 0
v_exp_f32 v200, v200
v_mfma_f32_16x16x32_bf16 v[220:223], a[68:71], v[196:199], v[220:223]
s_waitcnt lgkmcnt(0)
v_exp_f32 v201, v201
v_mfma_f32_16x16x32_bf16 v[220:223], a[72:75], v[216:219], v[220:223]
v_exp_f32 v202, v202
v_mfma_f32_16x16x32_bf16 v[220:223], a[76:79], v[204:207], v[220:223]
v_exp_f32 v203, v203
v_mfma_f32_16x16x32_bf16 v[224:227], a[92:95], v[204:207], 0
v_cvt_pk_bf16_f32 v112, v200, v201
v_cvt_pk_bf16_f32 v113, v202, v203
v_mfma_f32_16x16x32_bf16 v[224:227], a[88:91], v[216:219], v[224:227]
v_exp_f32 v228, v228
v_mfma_f32_16x16x32_bf16 v[224:227], a[84:87], v[196:199], v[224:227]
s_nop 0
v_cvt_pk_bf16_f32 v0, v220, v221
v_cvt_pk_bf16_f32 v1, v222, v223
v_mfma_f32_16x16x32_bf16 v[224:227], a[80:83], v[192:195], v[224:227]
buffer_load_dwordx4 v243, s[16:19], s98 offen offset:0 nt lds
v_mfma_f32_16x16x32_bf16 v[200:203], a[96:99], v[192:195], 0
s_add_u32 s98, s98, s48
v_exp_f32 v229, v229
v_mfma_f32_16x16x32_bf16 v[200:203], a[100:103], v[196:199], v[200:203]
v_exp_f32 v230, v230
v_mfma_f32_16x16x32_bf16 v[200:203], a[104:107], v[216:219], v[200:203]
v_exp_f32 v231, v231
v_mfma_f32_16x16x32_bf16 v[200:203], a[108:111], v[204:207], v[200:203]
v_mov_b64 v[220:221], 0
v_cvt_pk_bf16_f32 v114, v228, v229
v_mfma_f32_16x16x32_bf16 v[232:235], a[124:127], v[204:207], 0
v_cvt_pk_bf16_f32 v115, v230, v231
v_cvt_pk_bf16_f32 v2, v224, v225
v_mfma_f32_16x16x32_bf16 v[232:235], a[120:123], v[216:219], v[232:235]
v_exp_f32 v188, v188
v_mfma_f32_16x16x32_bf16 v[232:235], a[116:119], v[196:199], v[232:235]
v_cvt_pk_bf16_f32 v4, v200, v201
v_cvt_pk_bf16_f32 v5, v202, v203
v_mfma_f32_16x16x32_bf16 v[232:235], a[112:115], v[192:195], v[232:235]
v_exp_f32 v189, v189
v_smfmac_f32_16x16x64_bf16 v[220:223], v[184:187], v[104:111], v251
ds_read_b128 v[192:195], v242 offset:4992
v_cvt_pk_bf16_f32 v122, v188, v189
v_smfmac_f32_16x16x64_bf16 v[220:223], v[184:187], v[112:119], v251 abid:1
ds_read_b128 v[196:199], v242 offset:4736
ds_read_b128 v[204:207], v242 offset:4480
v_mfma_f32_16x16x32_bf16 v[168:171], v[80:83], v[112:115], v[168:171]
ds_read_b128 v[216:219], v242 offset:4224
v_cvt_pk_bf16_f32 v3, v226, v227
v_mfma_f32_16x16x32_bf16 v[168:171], v[64:67], v[108:111], v[168:171]
v_exp_f32 v190, v190
v_mfma_f32_16x16x32_bf16 v[168:171], v[48:51], v[104:107], v[168:171]
v_exp_f32 v191, v191
v_mfma_f32_16x16x32_bf16 v[172:175], v[52:55], v[104:107], v[172:175]
v_cvt_pk_bf16_f32 v123, v190, v191
v_add_f32 v220, v220, v221
v_mfma_f32_16x16x32_bf16 v[172:175], v[68:71], v[108:111], v[172:175]
s_waitcnt lgkmcnt(3)
v_rcp_f32 v254, v220
v_mfma_f32_16x16x32_bf16 v[172:175], v[84:87], v[112:115], v[172:175]
v_max3_f32 v255, v255, v220, v254
v_cvt_pk_bf16_f32 v6, v232, v233
v_mfma_f32_16x16x32_bf16 v[200:203], v[40:43], v[96:99], 0
v_exp_f32 v208, v208
v_mfma_f32_16x16x32_bf16 v[200:203], v[44:47], v[100:103], v[200:203]
v_exp_f32 v209, v209
v_mfma_f32_16x16x32_bf16 v[176:179], v[56:59], v[104:107], v[176:179]
v_exp_f32 v210, v210
v_mfma_f32_16x16x32_bf16 v[176:179], v[72:75], v[108:111], v[176:179]
v_exp_f32 v211, v211
v_mfma_f32_16x16x32_bf16 v[176:179], v[88:91], v[112:115], v[176:179]
v_cvt_pk_bf16_f32 v120, v208, v209
v_cvt_pk_bf16_f32 v121, v210, v211
v_mfma_f32_16x16x32_bf16 v[180:183], v[92:95], v[112:115], v[180:183]
v_cvt_pk_bf16_f32 v7, v234, v235
v_add_f32 v214, v214, v215
v_mfma_f32_16x16x32_bf16 v[180:183], v[76:79], v[108:111], v[180:183]
s_waitcnt lgkmcnt(1)
v_exp_f32 v212, v212
v_mfma_f32_16x16x32_bf16 v[180:183], v[60:63], v[104:107], v[180:183]
s_waitcnt lgkmcnt(0)
v_exp_f32 v214, v214
v_mfma_f32_16x16x32_bf16 v[188:191], v[16:19], v[96:99], 0
s_mov_b64 vcc, s[14:15]
v_perm_b32 v132, v214, v212, v252
v_perm_b32 v133, v214, v212, v253
v_mfma_f32_16x16x32_bf16 v[188:191], v[20:23], v[100:103], v[188:191]
v_exp_f32 v200, v200
v_mfma_f32_16x16x32_bf16 v[220:223], a[124:127], v[192:195], 0
v_exp_f32 v201, v201
v_mfma_f32_16x16x32_bf16 v[220:223], a[120:123], v[196:199], v[220:223]
v_exp_f32 v202, v202
v_mfma_f32_16x16x32_bf16 v[220:223], a[116:119], v[204:207], v[220:223]
v_exp_f32 v203, v203
v_mfma_f32_16x16x32_bf16 v[220:223], a[112:115], v[216:219], v[220:223]
buffer_load_dwordx4 v243, s[16:19], s99 offen offset:1056 nt lds
v_mfma_f32_16x16x32_bf16 v[224:227], a[96:99], v[216:219], 0
s_add_u32 s99, s98, s51
v_exp_f32 v188, v188
v_mfma_f32_16x16x32_bf16 v[224:227], a[100:103], v[204:207], v[224:227]
v_exp_f32 v189, v189
v_mfma_f32_16x16x32_bf16 v[224:227], a[104:107], v[196:199], v[224:227]
v_exp_f32 v190, v190
v_mfma_f32_16x16x32_bf16 v[224:227], a[108:111], v[192:195], v[224:227]
v_exp_f32 v191, v191
v_mfma_f32_16x16x32_bf16 v[228:231], a[92:95], v[192:195], 0
v_cvt_pk_bf16_f32 v124, v188, v189
v_cvt_pk_bf16_f32 v125, v190, v191
v_mfma_f32_16x16x32_bf16 v[228:231], a[88:91], v[196:199], v[228:231]
v_cvt_pk_bf16_f32 v14, v220, v221
v_cvt_pk_bf16_f32 v15, v222, v223
v_mfma_f32_16x16x32_bf16 v[228:231], a[84:87], v[204:207], v[228:231]
ds_read_b128 v[220:223], v242 offset:16896
v_cvt_pk_bf16_f32 v12, v224, v225
v_mfma_f32_16x16x32_bf16 v[228:231], a[80:83], v[216:219], v[228:231]
v_cvt_pk_bf16_f32 v13, v226, v227
v_cvt_pk_bf16_f32 v130, v200, v201
v_mfma_f32_16x16x32_bf16 v[208:211], a[64:67], v[216:219], 0
ds_read_b128 v[224:227], v242 offset:17152
ds_read_b128 v[216:219], v242 offset:17408
v_mfma_f32_16x16x32_bf16 v[208:211], a[68:71], v[204:207], v[208:211]
v_cvt_pk_bf16_f32 v131, v202, v203
v_fmac_f32 v136, v168, v254
v_mfma_f32_16x16x32_bf16 v[208:211], a[72:75], v[196:199], v[208:211]
v_cvt_pk_bf16_f32 v10, v228, v229
v_cvt_pk_bf16_f32 v11, v230, v231
v_mfma_f32_16x16x32_bf16 v[208:211], a[76:79], v[192:195], v[208:211]
ds_read_b128 v[228:231], v242 offset:17664
v_fmac_f32 v137, v169, v254
v_mfma_f32_16x16x32_bf16 v[188:191], v[28:31], v[100:103], 0
v_fmac_f32 v138, v170, v254
v_fmac_f32 v139, v171, v254
v_mfma_f32_16x16x32_bf16 v[188:191], v[24:27], v[96:99], v[188:191]
v_fmac_f32 v140, v172, v254
v_fmac_f32 v141, v173, v254
v_mfma_f32_16x16x32_bf16 v[192:195], v[32:35], v[96:99], 0
s_waitcnt lgkmcnt(3)
v_fmac_f32 v142, v174, v254
v_fmac_f32 v143, v175, v254
v_mfma_f32_16x16x32_bf16 v[192:195], v[36:39], v[100:103], v[192:195]
s_waitcnt lgkmcnt(2)
v_exp_f32 v188, v188
v_mfma_f32_16x16x32_bf16 v[196:199], a[64:67], v[220:223], 0
s_waitcnt lgkmcnt(1)
v_exp_f32 v189, v189
v_mfma_f32_16x16x32_bf16 v[196:199], a[68:71], v[224:227], v[196:199]
s_waitcnt lgkmcnt(0)
v_exp_f32 v190, v190
v_mfma_f32_16x16x32_bf16 v[196:199], a[72:75], v[216:219], v[196:199]
v_exp_f32 v191, v191
v_mfma_f32_16x16x32_bf16 v[196:199], a[76:79], v[228:231], v[196:199]
buffer_load_dwordx4 v243, s[16:19], s100 offen offset:2112 nt lds
v_mfma_f32_16x16x32_bf16 v[204:207], a[92:95], v[228:231], 0
s_add_u32 s100, s99, s51
ds_read_b128 v[212:215], v242 offset:8960
ds_read_b128 v[200:203], v242 offset:9216
v_mfma_f32_16x16x32_bf16 v[204:207], a[88:91], v[216:219], v[204:207]
ds_read_b128 v[232:235], v242 offset:8704
v_cvt_pk_bf16_f32 v126, v188, v189
v_mfma_f32_16x16x32_bf16 v[204:207], a[84:87], v[224:227], v[204:207]
v_cvt_pk_bf16_f32 v32, v196, v197
v_cvt_pk_bf16_f32 v33, v198, v199
v_mfma_f32_16x16x32_bf16 v[204:207], a[80:83], v[220:223], v[204:207]
v_cvt_pk_bf16_f32 v127, v190, v191
v_fmac_f32 v144, v176, v254
v_mfma_f32_16x16x32_bf16 v[196:199], a[96:99], v[220:223], 0
ds_read_b128 v[188:191], v242 offset:8448
v_fmac_f32 v145, v177, v254
v_mfma_f32_16x16x32_bf16 v[196:199], a[100:103], v[224:227], v[196:199]
v_exp_f32 v192, v192
v_mfma_f32_16x16x32_bf16 v[196:199], a[104:107], v[216:219], v[196:199]
v_cvt_pk_bf16_f32 v34, v204, v205
v_cvt_pk_bf16_f32 v35, v206, v207
v_mfma_f32_16x16x32_bf16 v[196:199], a[108:111], v[228:231], v[196:199]
s_waitcnt lgkmcnt(1)
v_exp_f32 v193, v193
v_mfma_f32_16x16x32_bf16 v[204:207], a[124:127], v[228:231], 0
v_exp_f32 v194, v194
v_mfma_f32_16x16x32_bf16 v[204:207], a[116:119], v[224:227], v[204:207]
v_exp_f32 v195, v195
v_mfma_f32_16x16x32_bf16 v[204:207], a[112:115], v[220:223], v[204:207]
v_cvt_pk_bf16_f32 v128, v192, v193
v_cvt_pk_bf16_f32 v129, v194, v195
v_mfma_f32_16x16x32_bf16 v[204:207], a[120:123], v[216:219], v[204:207]
v_cvt_pk_bf16_f32 v36, v196, v197
v_cvt_pk_bf16_f32 v37, v198, v199
v_mfma_f32_16x16x32_bf16 v[216:219], a[120:123], v[212:215], 0
v_fmac_f32 v146, v178, v254
v_fmac_f32 v147, v179, v254
v_mfma_f32_16x16x32_bf16 v[216:219], a[124:127], v[200:203], v[216:219]
s_waitcnt lgkmcnt(0)
v_fmac_f32 v148, v180, v254
v_fmac_f32 v149, v181, v254
v_mfma_f32_16x16x32_bf16 v[216:219], a[116:119], v[232:235], v[216:219]
v_fmac_f32 v150, v182, v254
v_fmac_f32 v151, v183, v254
v_mfma_f32_16x16x32_bf16 v[216:219], a[112:115], v[188:191], v[216:219]
v_cvt_pk_bf16_f32 v136, v136, v137
v_cvt_pk_bf16_f32 v144, v144, v145
v_mfma_f32_16x16x32_bf16 v[192:195], a[96:99], v[188:191], 0
v_cvt_pk_bf16_f32 v137, v138, v139
v_cvt_pk_bf16_f32 v145, v146, v147
v_mfma_f32_16x16x32_bf16 v[192:195], a[100:103], v[232:235], v[192:195]
v_cvt_pk_bf16_f32 v138, v140, v141
v_cvt_pk_bf16_f32 v139, v142, v143
v_mfma_f32_16x16x32_bf16 v[192:195], a[104:107], v[212:215], v[192:195]
v_cvt_pk_bf16_f32 v146, v148, v149
v_cvt_pk_bf16_f32 v147, v150, v151
v_mfma_f32_16x16x32_bf16 v[192:195], a[108:111], v[200:203], v[192:195]
v_pk_max_i16 v136, v136, 0
v_pk_max_i16 v137, v137, 0
v_mfma_f32_16x16x32_bf16 v[196:199], a[92:95], v[200:203], 0
v_pk_max_i16 v138, v138, 0
v_pk_max_i16 v139, v139, 0
v_mfma_f32_16x16x32_bf16 v[196:199], a[88:91], v[212:215], v[196:199]
v_pk_max_i16 v144, v144, 0
v_pk_max_i16 v145, v145, 0
v_mfma_f32_16x16x32_bf16 v[196:199], a[84:87], v[232:235], v[196:199]
v_cvt_pk_bf16_f32 v20, v192, v193
v_cvt_pk_bf16_f32 v21, v194, v195
v_mfma_f32_16x16x32_bf16 v[196:199], a[80:83], v[188:191], v[196:199]
v_pk_max_i16 v146, v146, 0
v_pk_max_i16 v147, v147, 0
v_mfma_f32_16x16x32_bf16 v[192:195], a[64:67], v[188:191], 0
v_cndmask_b32_dpp v140, v144, v136, vcc quad_perm:[1,0,3,2] row_mask:0xf bank_mask:0xf
v_cndmask_b32_dpp v141, v145, v137, vcc quad_perm:[1,0,3,2] row_mask:0xf bank_mask:0xf
v_mfma_f32_16x16x32_bf16 v[192:195], a[68:71], v[232:235], v[192:195]
v_cndmask_b32_dpp v142, v146, v138, vcc quad_perm:[1,0,3,2] row_mask:0xf bank_mask:0xf
v_cndmask_b32_dpp v143, v147, v139, vcc quad_perm:[1,0,3,2] row_mask:0xf bank_mask:0xf
v_mfma_f32_16x16x32_bf16 v[192:195], a[72:75], v[212:215], v[192:195]
s_not_b64 vcc, vcc
ds_read_b128 v[220:223], v242 offset:13440
v_cndmask_b32_dpp v144, v136, v144, vcc quad_perm:[1,0,3,2] row_mask:0xf bank_mask:0xf
v_mfma_f32_16x16x32_bf16 v[192:195], a[76:79], v[200:203], v[192:195]
v_cndmask_b32_dpp v145, v137, v145, vcc quad_perm:[1,0,3,2] row_mask:0xf bank_mask:0xf
v_cndmask_b32_dpp v146, v138, v146, vcc quad_perm:[1,0,3,2] row_mask:0xf bank_mask:0xf
L_h4:
s_cbranch_execz L_ret
v_cndmask_b32_dpp v147, v139, v147, vcc quad_perm:[1,0,3,2] row_mask:0xf bank_mask:0xf
v_mfma_f32_32x32x16_bf16 v[168:183], v[236:239], v[132:135], 0
buffer_store_dwordx4 v[140:143], v244, s[20:23], s52 offen offset:0 nt
buffer_store_dwordx4 v[144:147], v244, s[20:23], s52 offen offset:256 nt
v_cvt_pk_bf16_f32 v38, v204, v205
v_mov_b64 v[204:205], 0
v_cvt_pk_bf16_f32 v39, v206, v207
v_cvt_pk_bf16_f32 v16, v192, v193
v_smfmac_f32_16x16x64_bf16 v[204:207], v[184:187], v[120:127], v251
s_add_u32 s52, s46, 20480
v_cvt_pk_bf16_f32 v17, v194, v195
v_smfmac_f32_16x16x64_bf16 v[204:207], v[184:187], v[128:135], v251 abid:1
v_cvt_pk_bf16_f32 v22, v216, v217
v_mfma_f32_16x16x32_bf16 v[168:171], v[80:83], v[128:131], v[168:171]
v_cvt_pk_bf16_f32 v23, v218, v219
v_cvt_pk_bf16_f32 v8, v208, v209
v_mfma_f32_16x16x32_bf16 v[168:171], v[64:67], v[124:127], v[168:171]
ds_read_b128 v[216:219], v242 offset:13184
v_cvt_pk_bf16_f32 v9, v210, v211
v_mfma_f32_16x16x32_bf16 v[168:171], v[48:51], v[120:123], v[168:171]
ds_read_b128 v[208:211], v242 offset:12928
v_add_f32 v204, v204, v205
v_mfma_f32_16x16x32_bf16 v[172:175], v[52:55], v[120:123], v[172:175]
ds_read_b128 v[238:241], v245 offset:0
v_cvt_pk_bf16_f32 v18, v196, v197
v_mfma_f32_16x16x32_bf16 v[172:175], v[68:71], v[124:127], v[172:175]
ds_read2_b32 v[236:237], v246 offset0:0 offset1:8
v_cvt_pk_bf16_f32 v19, v198, v199
v_mfma_f32_16x16x32_bf16 v[172:175], v[84:87], v[128:131], v[172:175]
ds_read_b128 v[196:199], v242 offset:12672
v_add_u32 v245, 1728, v245
v_mfma_f32_16x16x32_bf16 v[176:179], v[88:91], v[128:131], v[176:179]
s_waitcnt lgkmcnt(5)
v_rcp_f32 v254, v204
v_mfma_f32_16x16x32_bf16 v[176:179], v[72:75], v[124:127], v[176:179]
v_max3_f32 v255, v255, v204, v254
v_fmac_f32 v152, v168, v254
v_mfma_f32_16x16x32_bf16 v[176:179], v[56:59], v[120:123], v[176:179]
v_fmac_f32 v153, v169, v254
v_fmac_f32 v154, v170, v254
v_mfma_f32_16x16x32_bf16 v[180:183], v[60:63], v[120:123], v[180:183]
v_fmac_f32 v155, v171, v254
v_fmac_f32 v156, v172, v254
v_mfma_f32_16x16x32_bf16 v[180:183], v[76:79], v[124:127], v[180:183]
v_fmac_f32 v157, v173, v254
v_fmac_f32 v158, v174, v254
v_mfma_f32_16x16x32_bf16 v[180:183], v[92:95], v[128:131], v[180:183]
s_mov_b64 vcc, s[14:15]
v_fmac_f32 v159, v175, v254
v_fmac_f32 v160, v176, v254
v_mfma_f32_16x16x32_bf16 v[192:195], v[188:191], a[128:131], 0
v_fmac_f32 v161, v177, v254
v_fmac_f32 v162, v178, v254
v_mfma_f32_16x16x32_bf16 v[192:195], v[232:235], a[132:135], v[192:195]
v_fmac_f32 v163, v179, v254
v_fmac_f32 v164, v180, v254
v_mfma_f32_16x16x32_bf16 v[192:195], v[212:215], a[136:139], v[192:195]
s_waitcnt lgkmcnt(4)
v_fmac_f32 v165, v181, v254
v_cvt_pk_bf16_f32 v152, v152, v153
v_mfma_f32_16x16x32_bf16 v[192:195], v[200:203], a[140:143], v[192:195]
s_waitcnt lgkmcnt(3)
v_cvt_pk_bf16_f32 v160, v160, v161
v_cvt_pk_bf16_f32 v153, v154, v155
v_mfma_f32_16x16x32_bf16 v[204:207], v[200:203], a[156:159], 0
s_waitcnt lgkmcnt(2)
v_fmac_f32 v166, v182, v254
v_fmac_f32 v167, v183, v254
v_mfma_f32_16x16x32_bf16 v[204:207], v[212:215], a[152:155], v[204:207]
s_waitcnt lgkmcnt(1)
v_cvt_pk_bf16_f32 v64, v192, v193
v_cvt_pk_bf16_f32 v65, v194, v195
v_mfma_f32_16x16x32_bf16 v[204:207], v[232:235], a[148:151], v[204:207]
s_waitcnt lgkmcnt(0)
v_cvt_pk_bf16_f32 v161, v162, v163
v_cvt_pk_bf16_f32 v154, v156, v157
v_mfma_f32_16x16x32_bf16 v[204:207], v[188:191], a[144:147], v[204:207]
v_cvt_pk_bf16_f32 v155, v158, v159
v_cvt_pk_bf16_f32 v162, v164, v165
v_mfma_f32_16x16x32_bf16 v[224:227], v[188:191], a[160:163], 0
v_cvt_pk_bf16_f32 v163, v166, v167
v_pk_max_i16 v152, v152, 0
v_mfma_f32_16x16x32_bf16 v[224:227], v[232:235], a[164:167], v[224:227]
v_pk_max_i16 v153, v153, 0
v_pk_max_i16 v154, v154, 0
v_mfma_f32_16x16x32_bf16 v[224:227], v[212:215], a[168:171], v[224:227]
v_cvt_pk_bf16_f32 v68, v204, v205
v_cvt_pk_bf16_f32 v69, v206, v207
v_mfma_f32_16x16x32_bf16 v[224:227], v[200:203], a[172:175], v[224:227]
buffer_load_dwordx4 v243, s[16:19], s101 offen offset:3168 nt lds
v_mfma_f32_16x16x32_bf16 v[192:195], v[200:203], a[188:191], 0
s_add_u32 m0, s49, 8448
v_pk_max_i16 v155, v155, 0
v_pk_max_i16 v160, v160, 0
v_mfma_f32_16x16x32_bf16 v[192:195], v[232:235], a[180:183], v[192:195]
s_add_u32 s101, s100, s51
v_pk_max_i16 v161, v161, 0
v_cvt_pk_bf16_f32 v72, v224, v225
v_mfma_f32_16x16x32_bf16 v[192:195], v[188:191], a[176:179], v[192:195]
v_cvt_pk_bf16_f32 v73, v226, v227
v_pk_max_i16 v162, v162, 0
v_mfma_f32_16x16x32_bf16 v[192:195], v[212:215], a[184:187], v[192:195]
v_pk_max_i16 v163, v163, 0
v_cndmask_b32_dpp v156, v160, v152, vcc quad_perm:[1,0,3,2] row_mask:0xf bank_mask:0xf
v_mfma_f32_16x16x32_bf16 v[188:191], v[216:219], a[184:187], 0
v_cndmask_b32_dpp v157, v161, v153, vcc quad_perm:[1,0,3,2] row_mask:0xf bank_mask:0xf
v_cndmask_b32_dpp v158, v162, v154, vcc quad_perm:[1,0,3,2] row_mask:0xf bank_mask:0xf
v_mfma_f32_16x16x32_bf16 v[188:191], v[220:223], a[188:191], v[188:191]
v_cndmask_b32_dpp v159, v163, v155, vcc quad_perm:[1,0,3,2] row_mask:0xf bank_mask:0xf
v_add_u32 v246, 1728, v246
v_mfma_f32_16x16x32_bf16 v[188:191], v[208:211], a[180:183], v[188:191]
s_not_b64 vcc, vcc
v_cvt_pk_bf16_f32 v76, v192, v193
v_cvt_pk_bf16_f32 v77, v194, v195
v_mfma_f32_16x16x32_bf16 v[188:191], v[196:199], a[176:179], v[188:191]
v_cndmask_b32_dpp v160, v152, v160, vcc quad_perm:[1,0,3,2] row_mask:0xf bank_mask:0xf
v_cndmask_b32_dpp v161, v153, v161, vcc quad_perm:[1,0,3,2] row_mask:0xf bank_mask:0xf
v_mfma_f32_16x16x32_bf16 v[192:195], v[196:199], a[160:163], 0
v_cndmask_b32_dpp v162, v154, v162, vcc quad_perm:[1,0,3,2] row_mask:0xf bank_mask:0xf
v_cndmask_b32_dpp v163, v155, v163, vcc quad_perm:[1,0,3,2] row_mask:0xf bank_mask:0xf
v_mfma_f32_16x16x32_bf16 v[192:195], v[208:211], a[164:167], v[192:195]
s_nop 1
v_cvt_pk_bf16_f32 v78, v188, v189
v_mfma_f32_16x16x32_bf16 v[192:195], v[216:219], a[168:171], v[192:195]
v_cvt_pk_bf16_f32 v79, v190, v191
v_mfma_f32_16x16x32_bf16 v[192:195], v[220:223], a[172:175], v[192:195]
s_nop 2
v_mfma_f32_16x16x32_bf16 v[188:191], v[220:223], a[156:159], 0
s_nop 2
v_mfma_f32_16x16x32_bf16 v[188:191], v[216:219], a[152:155], v[188:191]
v_cvt_pk_bf16_f32 v74, v192, v193
v_cvt_pk_bf16_f32 v75, v194, v195
v_mfma_f32_16x16x32_bf16 v[188:191], v[208:211], a[148:151], v[188:191]
v_mfma_f32_16x16x32_bf16 v[188:191], v[196:199], a[144:147], v[188:191]
s_nop 2
v_mfma_f32_16x16x32_bf16 v[192:195], v[196:199], a[128:131], 0
s_nop 2
v_mfma_f32_16x16x32_bf16 v[192:195], v[208:211], a[132:135], v[192:195]
v_cvt_pk_bf16_f32 v70, v188, v189
v_cvt_pk_bf16_f32 v71, v190, v191
v_mfma_f32_16x16x32_bf16 v[192:195], v[216:219], a[136:139], v[192:195]
v_mfma_f32_16x16x32_bf16 v[192:195], v[220:223], a[140:143], v[192:195]
s_nop 2
v_mfma_f32_16x16x32_bf16 v[188:191], a[64:67], v[196:199], 0
s_nop 2
v_mfma_f32_16x16x32_bf16 v[188:191], a[68:71], v[208:211], v[188:191]
v_cvt_pk_bf16_f32 v66, v192, v193
v_cvt_pk_bf16_f32 v67, v194, v195
v_mfma_f32_16x16x32_bf16 v[188:191], a[72:75], v[216:219], v[188:191]
v_mfma_f32_16x16x32_bf16 v[188:191], a[76:79], v[220:223], v[188:191]
buffer_load_dwordx4 v243, s[16:19], s98 offen offset:0 nt lds
v_mfma_f32_16x16x32_bf16 v[192:195], a[92:95], v[220:223], 0
s_add_u32 s98, s98, s48
ds_read_b128 v[200:203], v242 offset:21632
ds_read_b128 v[204:207], v242 offset:21888
v_mfma_f32_16x16x32_bf16 v[192:195], a[88:91], v[216:219], v[192:195]
ds_read_b128 v[212:215], v242 offset:21376
ds_read_b128 v[224:227], v242 offset:21120
v_mfma_f32_16x16x32_bf16 v[192:195], a[84:87], v[208:211], v[192:195]
v_cvt_pk_bf16_f32 v24, v188, v189
v_cvt_pk_bf16_f32 v25, v190, v191
v_mfma_f32_16x16x32_bf16 v[192:195], a[80:83], v[196:199], v[192:195]
s_nop 2
v_mfma_f32_16x16x32_bf16 v[188:191], a[96:99], v[196:199], 0
s_nop 2
v_mfma_f32_16x16x32_bf16 v[188:191], a[100:103], v[208:211], v[188:191]
v_cvt_pk_bf16_f32 v26, v192, v193
v_cvt_pk_bf16_f32 v27, v194, v195
v_mfma_f32_16x16x32_bf16 v[188:191], a[104:107], v[216:219], v[188:191]
v_mfma_f32_16x16x32_bf16 v[188:191], a[108:111], v[220:223], v[188:191]
s_nop 2
v_mfma_f32_16x16x32_bf16 v[192:195], a[124:127], v[220:223], 0
s_nop 2
v_mfma_f32_16x16x32_bf16 v[192:195], a[116:119], v[208:211], v[192:195]
v_cvt_pk_bf16_f32 v28, v188, v189
v_cvt_pk_bf16_f32 v29, v190, v191
v_mfma_f32_16x16x32_bf16 v[192:195], a[112:115], v[196:199], v[192:195]
s_waitcnt lgkmcnt(3)
v_mfma_f32_16x16x32_bf16 v[192:195], a[120:123], v[216:219], v[192:195]
s_waitcnt lgkmcnt(2)
s_nop 1
v_mfma_f32_16x16x32_bf16 v[188:191], a[120:123], v[200:203], 0
s_waitcnt lgkmcnt(1)
s_nop 1
v_mfma_f32_16x16x32_bf16 v[188:191], a[124:127], v[204:207], v[188:191]
s_waitcnt lgkmcnt(0)
v_cvt_pk_bf16_f32 v30, v192, v193
v_cvt_pk_bf16_f32 v31, v194, v195
v_mfma_f32_16x16x32_bf16 v[188:191], a[116:119], v[212:215], v[188:191]
v_mfma_f32_16x16x32_bf16 v[188:191], a[112:115], v[224:227], v[188:191]
s_nop 2
v_mfma_f32_16x16x32_bf16 v[192:195], a[96:99], v[224:227], 0
s_nop 2
v_mfma_f32_16x16x32_bf16 v[192:195], a[100:103], v[212:215], v[192:195]
v_cvt_pk_bf16_f32 v46, v188, v189
v_cvt_pk_bf16_f32 v47, v190, v191
v_mfma_f32_16x16x32_bf16 v[192:195], a[104:107], v[200:203], v[192:195]
v_mfma_f32_16x16x32_bf16 v[192:195], a[108:111], v[204:207], v[192:195]
buffer_load_dwordx4 v243, s[16:19], s99 offen offset:1056 nt lds
v_mfma_f32_16x16x32_bf16 v[188:191], a[92:95], v[204:207], 0
s_add_u32 s99, s98, s51
s_nop 1
v_mfma_f32_16x16x32_bf16 v[188:191], a[88:91], v[200:203], v[188:191]
s_nop 1
v_cvt_pk_bf16_f32 v44, v192, v193
v_mfma_f32_16x16x32_bf16 v[188:191], a[84:87], v[212:215], v[188:191]
v_cvt_pk_bf16_f32 v45, v194, v195
v_mfma_f32_16x16x32_bf16 v[188:191], a[80:83], v[224:227], v[188:191]
s_nop 2
v_mfma_f32_16x16x32_bf16 v[192:195], a[64:67], v[224:227], 0
s_nop 2
v_mfma_f32_16x16x32_bf16 v[192:195], a[72:75], v[200:203], v[192:195]
v_cvt_pk_bf16_f32 v42, v188, v189
v_cvt_pk_bf16_f32 v43, v190, v191
v_mfma_f32_16x16x32_bf16 v[192:195], a[76:79], v[204:207], v[192:195]
v_mfma_f32_16x16x32_bf16 v[192:195], a[68:71], v[212:215], v[192:195]
s_nop 2
v_mfma_f32_16x16x32_bf16 v[188:191], a[4:7], v[212:215], 0
s_nop 2
v_mfma_f32_16x16x32_bf16 v[188:191], a[0:3], v[224:227], v[188:191]
v_cvt_pk_bf16_f32 v40, v192, v193
v_cvt_pk_bf16_f32 v41, v194, v195
v_mfma_f32_16x16x32_bf16 v[188:191], a[8:11], v[200:203], v[188:191]
v_mfma_f32_16x16x32_bf16 v[188:191], a[12:15], v[204:207], v[188:191]
s_nop 2
v_mfma_f32_16x16x32_bf16 v[192:195], a[28:31], v[204:207], 0
s_nop 2
v_mfma_f32_16x16x32_bf16 v[192:195], a[24:27], v[200:203], v[192:195]
v_cvt_pk_bf16_f32 v96, v188, v189
v_cvt_pk_bf16_f32 v97, v190, v191
v_mfma_f32_16x16x32_bf16 v[192:195], a[20:23], v[212:215], v[192:195]
v_mfma_f32_16x16x32_bf16 v[192:195], a[16:19], v[224:227], v[192:195]
ds_read_b128 v[188:191], v247 offset:0
v_add_u32 v247, 1728, v247
v_mfma_f32_16x16x32_bf16 v[196:199], a[32:35], v[224:227], 0
s_nop 2
v_mfma_f32_16x16x32_bf16 v[196:199], a[36:39], v[212:215], v[196:199]
s_nop 0
v_cvt_pk_bf16_f32 v98, v192, v193
v_cvt_pk_bf16_f32 v99, v194, v195
v_mfma_f32_16x16x32_bf16 v[196:199], a[40:43], v[200:203], v[196:199]
v_mfma_f32_16x16x32_bf16 v[196:199], a[44:47], v[204:207], v[196:199]
v_mov_b64 v[168:169], 0
v_mov_b64 v[170:171], 0
v_mfma_f32_16x16x32_bf16 v[192:195], a[60:63], v[204:207], 0
v_mov_b64 v[172:173], 0
v_mov_b64 v[174:175], 0
v_mfma_f32_16x16x32_bf16 v[192:195], a[56:59], v[200:203], v[192:195]
v_mov_b64 v[176:177], 0
v_mov_b64 v[178:179], 0
v_mfma_f32_16x16x32_bf16 v[192:195], a[52:55], v[212:215], v[192:195]
s_waitcnt lgkmcnt(0)
v_cvt_pk_bf16_f32 v100, v196, v197
v_cvt_pk_bf16_f32 v101, v198, v199
v_mfma_f32_16x16x32_bf16 v[192:195], a[48:51], v[224:227], v[192:195]
s_nop 2
v_smfmac_f32_16x16x64_bf16 v[168:171], v[188:191], v[0:7], v251
s_nop 2
v_smfmac_f32_16x16x64_bf16 v[172:175], v[188:191], v[16:23], v251
v_cvt_pk_bf16_f32 v102, v192, v193
v_smfmac_f32_16x16x64_bf16 v[176:179], v[188:191], v[32:39], v251
v_cvt_pk_bf16_f32 v103, v194, v195
v_mfma_f32_16x16x32_bf16 v[136:139], a[192:195], v[224:227], 0
v_add_f32 v168, v168, v169
v_mfma_f32_16x16x32_bf16 v[136:139], a[196:199], v[212:215], v[136:139]
v_exp_f32 v168, v168
v_mfma_f32_16x16x32_bf16 v[136:139], a[200:203], v[200:203], v[136:139]
v_mfma_f32_16x16x32_bf16 v[136:139], a[204:207], v[204:207], v[136:139]
buffer_load_dwordx4 v243, s[16:19], s100 offen offset:2112 nt lds
v_mfma_f32_16x16x32_bf16 v[140:143], a[220:223], v[204:207], 0
s_add_u32 s100, s99, s51
v_mfma_f32_16x16x32_bf16 v[140:143], a[216:219], v[200:203], v[140:143]
v_mfma_f32_16x16x32_bf16 v[140:143], a[212:215], v[212:215], v[140:143]
v_mfma_f32_16x16x32_bf16 v[140:143], a[208:211], v[224:227], v[140:143]
v_mfma_f32_16x16x32_bf16 v[144:147], a[224:227], v[224:227], 0
v_mfma_f32_16x16x32_bf16 v[144:147], a[228:231], v[212:215], v[144:147]
v_mfma_f32_16x16x32_bf16 v[144:147], a[232:235], v[200:203], v[144:147]
v_mfma_f32_16x16x32_bf16 v[144:147], a[236:239], v[204:207], v[144:147]
v_mfma_f32_16x16x32_bf16 v[148:151], a[252:255], v[204:207], 0
v_mfma_f32_16x16x32_bf16 v[148:151], a[248:251], v[200:203], v[148:151]
v_mfma_f32_16x16x32_bf16 v[148:151], a[244:247], v[212:215], v[148:151]
v_mfma_f32_16x16x32_bf16 v[148:151], a[240:243], v[224:227], v[148:151]
v_smfmac_f32_16x16x64_bf16 v[170:173], v[188:191], v[8:15], v251
v_mov_b64 v[192:193], s[96:97]
v_smfmac_f32_16x16x64_bf16 v[174:177], v[188:191], v[24:31], v251
v_mov_b64 v[194:195], s[96:97]
v_smfmac_f32_16x16x64_bf16 v[178:181], v[188:191], v[40:47], v251
s_nop 2
v_mfma_f32_16x16x32_bf16 v[188:191], v[4:7], v[100:103], 0
v_add_f32 v170, v170, v171
v_add_f32 v172, v172, v173
v_mfma_f32_16x16x32_bf16 v[188:191], v[0:3], v[96:99], v[188:191]
v_exp_f32 v170, v170
v_smfmac_f32_16x16x64_bf16 v[192:195], v[238:241], v[96:103], v251
v_add_f32 v174, v174, v175
v_mfma_f32_16x16x32_bf16 v[196:199], v[224:227], a[128:131], 0
v_exp_f32 v172, v172
v_mfma_f32_16x16x32_bf16 v[196:199], v[212:215], a[132:135], v[196:199]
v_exp_f32 v174, v174
v_mfma_f32_16x16x32_bf16 v[196:199], v[200:203], a[136:139], v[196:199]
v_add_f32 v176, v176, v177
v_add_f32 v178, v178, v179
v_mfma_f32_16x16x32_bf16 v[196:199], v[204:207], a[140:143], v[196:199]
buffer_load_dwordx4 v243, s[16:19], s101 offen offset:3168 nt lds
v_mfma_f32_16x16x32_bf16 v[208:211], v[204:207], a[156:159], 0
s_add_u32 m0, s49, 16896
ds_read_b128 v[216:219], v242 offset:512
ds_read_b128 v[220:223], v242 offset:256
v_mfma_f32_16x16x32_bf16 v[208:211], v[200:203], a[152:155], v[208:211]
s_add_u32 s101, s100, s51
ds_read_b128 v[228:231], v242 offset:0
v_cvt_pk_bf16_f32 v82, v196, v197
v_mfma_f32_16x16x32_bf16 v[208:211], v[212:215], a[148:151], v[208:211]
s_and_b32 s51, s57, 13106176
v_cvt_pk_bf16_f32 v83, v198, v199
v_add_f32 v192, v192, v193
v_mfma_f32_16x16x32_bf16 v[208:211], v[224:227], a[144:147], v[208:211]
s_sub_u32 s49, s49, s56
ds_read_b128 v[196:199], v242 offset:768
v_add_f32 v194, v194, v195
v_mfma_f32_16x16x32_bf16 v[232:235], v[224:227], a[160:163], 0
s_lshl3_add_u32 s48, s51, 8192
v_exp_f32 v192, v192
v_mfma_f32_16x16x32_bf16 v[232:235], v[212:215], a[164:167], v[232:235]
s_sub_u32 s51, s51, 32
v_cvt_pk_bf16_f32 v86, v208, v209
v_cvt_pk_bf16_f32 v87, v210, v211
v_mfma_f32_16x16x32_bf16 v[232:235], v[200:203], a[168:171], v[232:235]
v_exp_f32 v194, v194
v_mfma_f32_16x16x32_bf16 v[232:235], v[204:207], a[172:175], v[232:235]
v_perm_b32 v116, v194, v192, v252
v_perm_b32 v117, v194, v192, v253
v_mfma_f32_16x16x32_bf16 v[208:211], v[204:207], a[188:191], 0
v_add_f32 v180, v168, v170
v_cvt_pk_bf16_f32 v169, v168, v170
v_mfma_f32_16x16x32_bf16 v[208:211], v[212:215], a[180:183], v[208:211]
ds_write_b16 v248, v169 offset:0
v_mfma_f32_16x16x32_bf16 v[208:211], v[224:227], a[176:179], v[208:211]
s_waitcnt lgkmcnt(4)
ds_write_b16_d16_hi v248, v169 offset:4
v_mfma_f32_16x16x32_bf16 v[208:211], v[200:203], a[184:187], v[208:211]
s_waitcnt lgkmcnt(2)
v_exp_f32 v176, v176
v_mfma_f32_16x16x32_bf16 v[200:203], v[216:219], a[184:187], 0
v_exp_f32 v178, v178
v_mfma_f32_16x16x32_bf16 v[200:203], v[196:199], a[188:191], v[200:203]
v_add_f32 v180, v180, v172
v_add_f32 v180, v180, v174
v_mfma_f32_16x16x32_bf16 v[200:203], v[220:223], a[180:183], v[200:203]
v_cvt_pk_bf16_f32 v94, v208, v209
v_cvt_pk_bf16_f32 v95, v210, v211
v_mfma_f32_16x16x32_bf16 v[200:203], v[228:231], a[176:179], v[200:203]
v_add_f32 v180, v180, v176
v_add_f32 v180, v180, v178
v_mfma_f32_16x16x32_bf16 v[204:207], v[228:231], a[160:163], 0
v_cvt_pk_bf16_f32 v173, v172, v174
v_add_f32_dpp v180, v180, v180 row_ror:8 row_mask:0xf bank_mask:0xf
v_mfma_f32_16x16x32_bf16 v[204:207], v[220:223], a[164:167], v[204:207]
ds_write_b16 v248, v173 offset:272
v_mfma_f32_16x16x32_bf16 v[204:207], v[216:219], a[168:171], v[204:207]
ds_write_b16_d16_hi v248, v173 offset:276
v_mfma_f32_16x16x32_bf16 v[204:207], v[196:199], a[172:175], v[204:207]
v_cvt_pk_bf16_f32 v60, v200, v201
v_cvt_pk_bf16_f32 v61, v202, v203
v_mfma_f32_16x16x32_bf16 v[212:215], v[24:27], v[96:99], 0
v_cvt_pk_bf16_f32 v177, v176, v178
v_add_f32_dpp v180, v180, v180 row_ror:4 row_mask:0xf bank_mask:0xf
v_mfma_f32_16x16x32_bf16 v[212:215], v[28:31], v[100:103], v[212:215]
ds_write_b16 v248, v177 offset:544
v_mfma_f32_16x16x32_bf16 v[192:195], v[36:39], v[100:103], 0
ds_write_b32 v250, v180 offset:256
v_mfma_f32_16x16x32_bf16 v[192:195], v[32:35], v[96:99], v[192:195]
ds_write_b16_d16_hi v248, v177 offset:548
v_mfma_f32_16x16x32_bf16 v[200:203], v[40:43], v[96:99], 0
v_cvt_pk_bf16_f32 v56, v204, v205
v_cvt_pk_bf16_f32 v57, v206, v207
v_mfma_f32_16x16x32_bf16 v[200:203], v[44:47], v[100:103], v[200:203]
v_cvt_pk_bf16_f32 v90, v232, v233
v_cvt_pk_bf16_f32 v91, v234, v235
v_mfma_f32_16x16x32_bf16 v[204:207], v[12:15], v[100:103], 0
v_exp_f32 v192, v192
v_mfma_f32_16x16x32_bf16 v[204:207], v[8:11], v[96:99], v[204:207]
v_exp_f32 v193, v193
v_mfma_f32_16x16x32_bf16 v[208:211], v[16:19], v[96:99], 0
v_exp_f32 v194, v194
v_mfma_f32_16x16x32_bf16 v[208:211], v[20:23], v[100:103], v[208:211]
v_exp_f32 v195, v195
v_mfma_f32_32x32x16_bf16 v[168:183], v[236:239], v[116:119], 0
buffer_store_dwordx4 v[156:159], v244, s[20:23], s53 offen offset:0 nt
buffer_store_dwordx4 v[160:163], v244, s[20:23], s53 offen offset:256 nt
v_exp_f32 v204, v204
v_exp_f32 v205, v205
v_mfma_f32_16x16x32_bf16 v[224:227], v[196:199], a[156:159], 0
s_add_u32 s53, s46, 0
v_exp_f32 v206, v206
v_mfma_f32_16x16x32_bf16 v[224:227], v[216:219], a[152:155], v[224:227]
v_exp_f32 v207, v207
v_mfma_f32_16x16x32_bf16 v[224:227], v[220:223], a[148:151], v[224:227]
v_cvt_pk_bf16_f32 v106, v204, v205
v_cvt_pk_bf16_f32 v107, v206, v207
v_mfma_f32_16x16x32_bf16 v[224:227], v[228:231], a[144:147], v[224:227]
v_exp_f32 v208, v208
v_mfma_f32_16x16x32_bf16 v[232:235], v[228:231], a[128:131], 0
v_exp_f32 v209, v209
v_mfma_f32_16x16x32_bf16 v[232:235], v[220:223], a[132:135], v[232:235]
v_exp_f32 v210, v210
v_mfma_f32_16x16x32_bf16 v[232:235], v[216:219], a[136:139], v[232:235]
v_exp_f32 v211, v211
v_mfma_f32_16x16x32_bf16 v[232:235], v[196:199], a[140:143], v[232:235]
v_cvt_pk_bf16_f32 v108, v208, v209
v_cvt_pk_bf16_f32 v109, v210, v211
v_mfma_f32_16x16x32_bf16 v[204:207], a[0:3], v[228:231], 0
v_cvt_pk_bf16_f32 v112, v192, v193
v_cvt_pk_bf16_f32 v113, v194, v195
v_mfma_f32_16x16x32_bf16 v[204:207], a[4:7], v[220:223], v[204:207]
v_exp_f32 v200, v200
v_mfma_f32_16x16x32_bf16 v[204:207], a[8:11], v[216:219], v[204:207]
v_exp_f32 v201, v201
v_mfma_f32_16x16x32_bf16 v[204:207], a[12:15], v[196:199], v[204:207]
buffer_load_dwordx4 v243, s[16:19], s98 offen offset:0 nt lds
v_mfma_f32_16x16x32_bf16 v[208:211], a[28:31], v[196:199], 0
v_exp_f32 v202, v202
v_mfma_f32_16x16x32_bf16 v[208:211], a[24:27], v[216:219], v[208:211]
v_exp_f32 v203, v203
v_mfma_f32_16x16x32_bf16 v[208:211], a[20:23], v[220:223], v[208:211]
v_cvt_pk_bf16_f32 v114, v200, v201
v_cvt_pk_bf16_f32 v115, v202, v203
v_mfma_f32_16x16x32_bf16 v[208:211], a[16:19], v[228:231], v[208:211]
v_cvt_pk_bf16_f32 v96, v204, v205
v_cvt_pk_bf16_f32 v97, v206, v207
v_mfma_f32_16x16x32_bf16 v[204:207], a[32:35], v[228:231], 0
v_exp_f32 v188, v188
v_mfma_f32_16x16x32_bf16 v[204:207], a[36:39], v[220:223], v[204:207]
v_exp_f32 v189, v189
v_mfma_f32_16x16x32_bf16 v[204:207], a[40:43], v[216:219], v[204:207]
s_nop 0
v_cvt_pk_bf16_f32 v98, v208, v209
v_cvt_pk_bf16_f32 v99, v210, v211
v_mfma_f32_16x16x32_bf16 v[204:207], a[44:47], v[196:199], v[204:207]
v_exp_f32 v190, v190
v_mfma_f32_16x16x32_bf16 v[192:195], a[60:63], v[196:199], 0
v_exp_f32 v191, v191
v_mfma_f32_16x16x32_bf16 v[192:195], a[56:59], v[216:219], v[192:195]
v_cvt_pk_bf16_f32 v104, v188, v189
v_cvt_pk_bf16_f32 v105, v190, v191
v_mfma_f32_16x16x32_bf16 v[192:195], a[52:55], v[220:223], v[192:195]
ds_read_b128 v[188:191], v242 offset:16896
v_cvt_pk_bf16_f32 v100, v204, v205
v_mfma_f32_16x16x32_bf16 v[192:195], a[48:51], v[228:231], v[192:195]
v_cvt_pk_bf16_f32 v101, v206, v207
v_cvt_pk_bf16_f32 v52, v224, v225
v_mfma_f32_16x16x32_bf16 v[152:155], a[192:195], v[228:231], 0
v_exp_f32 v212, v212
v_mfma_f32_16x16x32_bf16 v[152:155], a[196:199], v[220:223], v[152:155]
v_exp_f32 v213, v213
v_mfma_f32_16x16x32_bf16 v[152:155], a[200:203], v[216:219], v[152:155]
s_nop 0
v_cvt_pk_bf16_f32 v102, v192, v193
v_cvt_pk_bf16_f32 v103, v194, v195
v_mfma_f32_16x16x32_bf16 v[152:155], a[204:207], v[196:199], v[152:155]
v_exp_f32 v214, v214
v_mfma_f32_16x16x32_bf16 v[156:159], a[220:223], v[196:199], 0
v_exp_f32 v215, v215
v_mfma_f32_16x16x32_bf16 v[156:159], a[216:219], v[216:219], v[156:159]
v_cvt_pk_bf16_f32 v110, v212, v213
v_cvt_pk_bf16_f32 v111, v214, v215
v_mfma_f32_16x16x32_bf16 v[156:159], a[212:215], v[220:223], v[156:159]
ds_read_b128 v[192:195], v242 offset:4224
ds_read_b128 v[200:203], v242 offset:4480
v_mfma_f32_16x16x32_bf16 v[156:159], a[208:211], v[228:231], v[156:159]
buffer_load_dwordx4 v243, s[16:19], s99 offen offset:1056 nt lds
v_mfma_f32_16x16x32_bf16 v[160:163], a[224:227], v[228:231], 0
ds_read_b128 v[204:207], v242 offset:4736
ds_read_b128 v[212:215], v242 offset:17152
v_mfma_f32_16x16x32_bf16 v[160:163], a[228:231], v[220:223], v[160:163]
v_cvt_pk_bf16_f32 v53, v226, v227
v_cvt_pk_bf16_f32 v48, v232, v233
v_mfma_f32_16x16x32_bf16 v[160:163], a[232:235], v[216:219], v[160:163]
ds_read_b128 v[224:227], v242 offset:17408
v_cvt_pk_bf16_f32 v49, v234, v235
v_mfma_f32_16x16x32_bf16 v[160:163], a[236:239], v[196:199], v[160:163]
s_waitcnt lgkmcnt(5)
ds_read_b128 v[232:235], v242 offset:17664
v_mfma_f32_16x16x32_bf16 v[208:211], v[8:11], v[96:99], 0
s_waitcnt lgkmcnt(5)
v_mfma_f32_16x16x32_bf16 v[208:211], v[12:15], v[100:103], v[208:211]
s_nop 2
v_mfma_f32_16x16x32_bf16 v[164:167], a[252:255], v[196:199], 0
ds_read_b128 v[196:199], v242 offset:4992
s_nop 0
v_mfma_f32_16x16x32_bf16 v[164:167], a[248:251], v[216:219], v[164:167]
v_mov_b64 v[216:217], s[96:97]
v_mov_b64 v[218:219], s[96:97]
v_mfma_f32_16x16x32_bf16 v[164:167], a[244:247], v[220:223], v[164:167]
v_exp_f32 v208, v208
v_mfma_f32_16x16x32_bf16 v[164:167], a[240:243], v[228:231], v[164:167]
s_waitcnt lgkmcnt(1)
v_exp_f32 v209, v209
v_mfma_f32_16x16x32_bf16 v[220:223], v[4:7], v[100:103], 0
v_exp_f32 v210, v210
v_mfma_f32_16x16x32_bf16 v[220:223], v[0:3], v[96:99], v[220:223]
v_exp_f32 v211, v211
v_smfmac_f32_16x16x64_bf16 v[216:219], v[238:241], v[96:103], v251
v_cvt_pk_bf16_f32 v122, v208, v209
v_mfma_f32_16x16x32_bf16 v[228:231], v[192:195], a[128:131], 0
v_cvt_pk_bf16_f32 v123, v210, v211
s_nop 0
v_mfma_f32_16x16x32_bf16 v[228:231], v[200:203], a[132:135], v[228:231]
s_waitcnt lgkmcnt(0)
v_exp_f32 v220, v220
v_mfma_f32_16x16x32_bf16 v[228:231], v[204:207], a[136:139], v[228:231]
v_exp_f32 v221, v221
v_mfma_f32_16x16x32_bf16 v[228:231], v[196:199], a[140:143], v[228:231]
v_exp_f32 v222, v222
v_mfma_f32_16x16x32_bf16 v[208:211], v[196:199], a[156:159], 0
v_exp_f32 v223, v223
v_mfma_f32_16x16x32_bf16 v[208:211], v[204:207], a[152:155], v[208:211]
v_cvt_pk_bf16_f32 v120, v220, v221
v_cvt_pk_bf16_f32 v121, v222, v223
v_mfma_f32_16x16x32_bf16 v[208:211], v[200:203], a[148:151], v[208:211]
v_add_f32 v216, v216, v217
v_add_f32 v218, v218, v219
v_mfma_f32_16x16x32_bf16 v[208:211], v[192:195], a[144:147], v[208:211]
v_exp_f32 v216, v216
v_mfma_f32_16x16x32_bf16 v[220:223], v[192:195], a[160:163], 0
v_exp_f32 v218, v218
v_mfma_f32_16x16x32_bf16 v[220:223], v[200:203], a[164:167], v[220:223]
v_perm_b32 v132, v218, v216, v252
v_perm_b32 v133, v218, v216, v253
v_mfma_f32_16x16x32_bf16 v[220:223], v[204:207], a[168:171], v[220:223]
s_nop 0
v_cvt_pk_bf16_f32 v54, v208, v209
v_cvt_pk_bf16_f32 v55, v210, v211
v_mfma_f32_16x16x32_bf16 v[220:223], v[196:199], a[172:175], v[220:223]
buffer_load_dwordx4 v243, s[16:19], s100 offen offset:2112 nt lds
v_mfma_f32_16x16x32_bf16 v[208:211], v[196:199], a[188:191], 0
v_cvt_pk_bf16_f32 v50, v228, v229
v_cvt_pk_bf16_f32 v51, v230, v231
v_mfma_f32_16x16x32_bf16 v[208:211], v[204:207], a[184:187], v[208:211]
s_nop 1
v_mfma_f32_16x16x32_bf16 v[208:211], v[200:203], a[180:183], v[208:211]
v_cvt_pk_bf16_f32 v58, v220, v221
v_cvt_pk_bf16_f32 v59, v222, v223
v_mfma_f32_16x16x32_bf16 v[208:211], v[192:195], a[176:179], v[208:211]
s_nop 2
v_mfma_f32_16x16x32_bf16 v[192:195], v[16:19], v[96:99], 0
s_nop 2
v_mfma_f32_16x16x32_bf16 v[192:195], v[20:23], v[100:103], v[192:195]
v_mov_b64 v[196:197], 0
v_cvt_pk_bf16_f32 v62, v208, v209
v_mfma_f32_16x16x32_bf16 v[200:203], v[36:39], v[100:103], 0
v_cvt_pk_bf16_f32 v63, v210, v211
s_nop 0
v_mfma_f32_16x16x32_bf16 v[200:203], v[32:35], v[96:99], v[200:203]
s_nop 2
v_mfma_f32_16x16x32_bf16 v[204:207], v[24:27], v[96:99], 0
v_exp_f32 v192, v192
v_mfma_f32_16x16x32_bf16 v[204:207], v[28:31], v[100:103], v[204:207]
v_exp_f32 v193, v193
v_smfmac_f32_16x16x64_bf16 v[196:199], v[184:187], v[104:111], v251
v_cvt_pk_bf16_f32 v124, v192, v193
v_smfmac_f32_16x16x64_bf16 v[196:199], v[184:187], v[112:119], v251 abid:1
s_nop 2
v_mfma_f32_16x16x32_bf16 v[208:211], v[232:235], a[188:191], 0
v_exp_f32 v194, v194
v_mfma_f32_16x16x32_bf16 v[208:211], v[224:227], a[184:187], v[208:211]
v_exp_f32 v195, v195
v_mfma_f32_16x16x32_bf16 v[208:211], v[212:215], a[180:183], v[208:211]
v_cvt_pk_bf16_f32 v125, v194, v195
v_add_f32 v196, v196, v197
v_mfma_f32_16x16x32_bf16 v[208:211], v[188:191], a[176:179], v[208:211]
v_exp_f32 v204, v204
v_mfma_f32_16x16x32_bf16 v[192:195], v[188:191], a[160:163], 0
v_exp_f32 v205, v205
v_mfma_f32_16x16x32_bf16 v[192:195], v[212:215], a[164:167], v[192:195]
v_exp_f32 v206, v206
v_mfma_f32_16x16x32_bf16 v[192:195], v[224:227], a[168:171], v[192:195]
v_exp_f32 v207, v207
v_mfma_f32_16x16x32_bf16 v[192:195], v[232:235], a[172:175], v[192:195]
buffer_load_dwordx4 v243, s[16:19], s101 offen offset:3168 nt lds
v_mfma_f32_16x16x32_bf16 v[216:219], v[232:235], a[156:159], 0
s_mov_b32 m0, s58
v_cvt_pk_bf16_f32 v126, v204, v205
v_cvt_pk_bf16_f32 v127, v206, v207
v_mfma_f32_16x16x32_bf16 v[216:219], v[224:227], a[152:155], v[216:219]
v_cvt_pk_bf16_f32 v92, v208, v209
v_cvt_pk_bf16_f32 v93, v210, v211
v_mfma_f32_16x16x32_bf16 v[216:219], v[212:215], a[148:151], v[216:219]
v_cvt_pk_bf16_f32 v88, v192, v193
v_cvt_pk_bf16_f32 v89, v194, v195
v_mfma_f32_16x16x32_bf16 v[216:219], v[188:191], a[144:147], v[216:219]
v_rcp_f32 v254, v196
v_mfma_f32_16x16x32_bf16 v[192:195], v[188:191], a[128:131], 0
v_max3_f32 v255, v255, v196, v254
s_nop 0
v_mfma_f32_16x16x32_bf16 v[192:195], v[212:215], a[132:135], v[192:195]
L_h2:
s_cbranch_execz L_ret
v_exp_f32 v200, v200
v_mfma_f32_16x16x32_bf16 v[192:195], v[224:227], a[136:139], v[192:195]
s_nop 0
v_cvt_pk_bf16_f32 v84, v216, v217
v_cvt_pk_bf16_f32 v85, v218, v219
v_mfma_f32_16x16x32_bf16 v[192:195], v[232:235], a[140:143], v[192:195]
v_exp_f32 v201, v201
v_mfma_f32_16x16x32_bf16 v[204:207], v[40:43], v[96:99], 0
ds_read_b128 v[208:211], v249 offset:0
ds_read_b128 v[216:219], v249 offset:272
v_mfma_f32_16x16x32_bf16 v[204:207], v[44:47], v[100:103], v[204:207]
ds_read_b128 v[220:223], v249 offset:544
v_cvt_pk_bf16_f32 v128, v200, v201
v_mfma_f32_16x16x32_bf16 v[168:171], v[48:51], v[104:107], v[168:171]
v_cvt_pk_bf16_f32 v80, v192, v193
v_cvt_pk_bf16_f32 v81, v194, v195
v_mfma_f32_16x16x32_bf16 v[168:171], v[64:67], v[108:111], v[168:171]
v_exp_f32 v202, v202
v_mfma_f32_16x16x32_bf16 v[168:171], v[80:83], v[112:115], v[168:171]
v_exp_f32 v203, v203
v_mfma_f32_16x16x32_bf16 v[172:175], v[84:87], v[112:115], v[172:175]
v_cvt_pk_bf16_f32 v129, v202, v203
s_nop 0
v_mfma_f32_16x16x32_bf16 v[172:175], v[52:55], v[104:107], v[172:175]
v_exp_f32 v204, v204
v_mfma_f32_16x16x32_bf16 v[172:175], v[68:71], v[108:111], v[172:175]
v_exp_f32 v205, v205
v_mfma_f32_16x16x32_bf16 v[176:179], v[72:75], v[108:111], v[176:179]
v_exp_f32 v206, v206
v_mfma_f32_16x16x32_bf16 v[176:179], v[88:91], v[112:115], v[176:179]
v_exp_f32 v207, v207
v_mfma_f32_16x16x32_bf16 v[176:179], v[56:59], v[104:107], v[176:179]
v_cvt_pk_bf16_f32 v130, v204, v205
v_cvt_pk_bf16_f32 v131, v206, v207
L_entryf:
v_mfma_f32_16x16x32_bf16 v[180:183], v[60:63], v[104:107], v[180:183]
v_fmac_f32 v136, v168, v254
v_fmac_f32 v137, v169, v254
v_mfma_f32_16x16x32_bf16 v[180:183], v[76:79], v[108:111], v[180:183]
v_fmac_f32 v138, v170, v254
v_fmac_f32 v139, v171, v254
v_mfma_f32_16x16x32_bf16 v[180:183], v[92:95], v[112:115], v[180:183]
s_waitcnt lgkmcnt(1)
v_fmac_f32 v144, v176, v254
v_fmac_f32 v145, v177, v254
v_mfma_f32_16x16x32_bf16 v[192:195], a[0:3], v[188:191], 0
s_waitcnt lgkmcnt(0)
v_fmac_f32 v146, v178, v254
v_fmac_f32 v147, v179, v254
v_mfma_f32_16x16x32_bf16 v[192:195], a[4:7], v[212:215], v[192:195]
s_mov_b64 vcc, s[14:15]
v_cvt_pk_bf16_f32 v144, v144, v145
v_fmac_f32 v148, v180, v254
v_mfma_f32_16x16x32_bf16 v[192:195], a[8:11], v[224:227], v[192:195]
v_fmac_f32 v149, v181, v254
v_fmac_f32 v150, v182, v254
v_mfma_f32_16x16x32_bf16 v[192:195], a[12:15], v[232:235], v[192:195]
v_fmac_f32 v151, v183, v254
v_cvt_pk_bf16_f32 v145, v146, v147
v_mfma_f32_16x16x32_bf16 v[196:199], a[28:31], v[232:235], 0
v_cvt_pk_bf16_f32 v146, v148, v149
v_cvt_pk_bf16_f32 v147, v150, v151
v_mfma_f32_16x16x32_bf16 v[196:199], a[24:27], v[224:227], v[196:199]
v_cvt_pk_bf16_f32 v136, v136, v137
v_fmac_f32 v140, v172, v254
v_mfma_f32_16x16x32_bf16 v[196:199], a[20:23], v[212:215], v[196:199]
v_cvt_pk_bf16_f32 v96, v192, v193
v_cvt_pk_bf16_f32 v97, v194, v195
v_mfma_f32_16x16x32_bf16 v[196:199], a[16:19], v[188:191], v[196:199]
v_fmac_f32 v141, v173, v254
v_fmac_f32 v142, v174, v254
v_mfma_f32_16x16x32_bf16 v[192:195], a[32:35], v[188:191], 0
v_fmac_f32 v143, v175, v254
v_cvt_pk_bf16_f32 v137, v138, v139
v_mfma_f32_16x16x32_bf16 v[192:195], a[36:39], v[212:215], v[192:195]
v_cvt_pk_bf16_f32 v138, v140, v141
v_cvt_pk_bf16_f32 v139, v142, v143
v_mfma_f32_16x16x32_bf16 v[192:195], a[40:43], v[224:227], v[192:195]
v_cvt_pk_bf16_f32 v98, v196, v197
v_cvt_pk_bf16_f32 v99, v198, v199
v_mfma_f32_16x16x32_bf16 v[192:195], a[44:47], v[232:235], v[192:195]
v_mov_b64 v[196:197], 0
v_mov_b64 v[198:199], 0
v_mfma_f32_16x16x32_bf16 v[200:203], a[60:63], v[232:235], 0
v_pk_max_i16 v136, v136, 0
v_pk_max_i16 v137, v137, 0
v_mfma_f32_16x16x32_bf16 v[200:203], a[56:59], v[224:227], v[200:203]
v_pk_max_i16 v138, v138, 0
v_pk_max_i16 v139, v139, 0
v_mfma_f32_16x16x32_bf16 v[200:203], a[52:55], v[212:215], v[200:203]
v_mov_b64 v[204:205], 0
v_mov_b64 v[206:207], 0
v_mfma_f32_16x16x32_bf16 v[200:203], a[48:51], v[188:191], v[200:203]
v_cvt_pk_bf16_f32 v100, v192, v193
v_cvt_pk_bf16_f32 v101, v194, v195
v_smfmac_f32_16x16x64_bf16 v[196:199], v[208:211], v[48:55], v251
v_pk_max_i16 v144, v144, 0
v_smfmac_f32_16x16x64_bf16 v[196:199], v[216:219], v[64:71], v251
v_pk_max_i16 v145, v145, 0
v_smfmac_f32_16x16x64_bf16 v[196:199], v[220:223], v[80:87], v251
s_nop 0
v_cvt_pk_bf16_f32 v102, v200, v201
v_smfmac_f32_16x16x64_bf16 v[204:207], v[220:223], v[88:95], v251
v_cvt_pk_bf16_f32 v103, v202, v203
v_smfmac_f32_16x16x64_bf16 v[204:207], v[216:219], v[72:79], v251
v_mov_b64 v[192:193], s[96:97]
v_smfmac_f32_16x16x64_bf16 v[204:207], v[208:211], v[56:63], v251
v_mov_b64 v[194:195], s[96:97]
v_mfma_f32_16x16x32_bf16 v[200:203], v[4:7], v[100:103], 0
v_pk_max_i16 v146, v146, 0
v_pk_max_i16 v147, v147, 0
v_mfma_f32_16x16x32_bf16 v[200:203], v[0:3], v[96:99], v[200:203]
v_cndmask_b32_dpp v140, v144, v136, vcc quad_perm:[1,0,3,2] row_mask:0xf bank_mask:0xf
v_cndmask_b32_dpp v141, v145, v137, vcc quad_perm:[1,0,3,2] row_mask:0xf bank_mask:0xf
v_smfmac_f32_16x16x64_bf16 v[192:195], v[238:241], v[96:103], v251
v_cndmask_b32_dpp v142, v146, v138, vcc quad_perm:[1,0,3,2] row_mask:0xf bank_mask:0xf
v_mfma_f32_16x16x32_bf16 v[208:211], v[16:19], v[96:99], 0
v_cndmask_b32_dpp v143, v147, v139, vcc quad_perm:[1,0,3,2] row_mask:0xf bank_mask:0xf
v_add_f32 v196, v196, v197
v_mfma_f32_16x16x32_bf16 v[208:211], v[20:23], v[100:103], v[208:211]
s_not_b64 vcc, vcc
ds_write_b32 v250, v196 offset:0
v_mfma_f32_16x16x32_bf16 v[216:219], v[12:15], v[100:103], 0
v_cndmask_b32_dpp v144, v136, v144, vcc quad_perm:[1,0,3,2] row_mask:0xf bank_mask:0xf
v_cndmask_b32_dpp v145, v137, v145, vcc quad_perm:[1,0,3,2] row_mask:0xf bank_mask:0xf
v_mfma_f32_16x16x32_bf16 v[216:219], v[8:11], v[96:99], v[216:219]
v_cndmask_b32_dpp v146, v138, v146, vcc quad_perm:[1,0,3,2] row_mask:0xf bank_mask:0xf
v_cndmask_b32_dpp v147, v139, v147, vcc quad_perm:[1,0,3,2] row_mask:0xf bank_mask:0xf
v_mfma_f32_16x16x32_bf16 v[220:223], v[24:27], v[96:99], 0
v_add_f32 v198, v198, v199
v_add_f32 v192, v192, v193
v_mfma_f32_16x16x32_bf16 v[220:223], v[28:31], v[100:103], v[220:223]
ds_write_b32 v250, v198 offset:64
v_mfma_f32_32x32x16_bf16 v[168:183], v[236:239], v[132:135], 0
buffer_store_dwordx4 v[140:143], v244, s[20:23], s52 offen offset:0 nt
buffer_store_dwordx4 v[144:147], v244, s[20:23], s52 offen offset:256 nt
v_exp_f32 v200, v200
v_exp_f32 v201, v201
v_mfma_f32_16x16x32_bf16 v[136:139], a[192:195], v[188:191], 0
s_add_u32 s52, s46, 16384
v_exp_f32 v202, v202
v_mfma_f32_16x16x32_bf16 v[136:139], a[196:199], v[212:215], v[136:139]
v_exp_f32 v203, v203
v_mfma_f32_16x16x32_bf16 v[136:139], a[200:203], v[224:227], v[136:139]
v_exp_f32 v216, v216
v_mfma_f32_16x16x32_bf16 v[136:139], a[204:207], v[232:235], v[136:139]
v_exp_f32 v217, v217
v_mfma_f32_16x16x32_bf16 v[140:143], a[220:223], v[232:235], 0
v_exp_f32 v218, v218
v_mfma_f32_16x16x32_bf16 v[140:143], a[216:219], v[224:227], v[140:143]
v_exp_f32 v219, v219
v_mfma_f32_16x16x32_bf16 v[140:143], a[212:215], v[212:215], v[140:143]
v_cvt_pk_bf16_f32 v104, v200, v201
v_cvt_pk_bf16_f32 v105, v202, v203
v_mfma_f32_16x16x32_bf16 v[140:143], a[208:211], v[188:191], v[140:143]
v_cvt_pk_bf16_f32 v106, v216, v217
v_cvt_pk_bf16_f32 v107, v218, v219
v_mfma_f32_16x16x32_bf16 v[144:147], a[224:227], v[188:191], 0
v_add_f32 v194, v194, v195
v_add_f32 v204, v204, v205
v_mfma_f32_16x16x32_bf16 v[144:147], a[228:231], v[212:215], v[144:147]
ds_write_b32 v250, v204 offset:128
v_mfma_f32_16x16x32_bf16 v[144:147], a[232:235], v[224:227], v[144:147]
v_exp_f32 v192, v192
v_mfma_f32_16x16x32_bf16 v[144:147], a[236:239], v[232:235], v[144:147]
v_exp_f32 v194, v194
v_mfma_f32_16x16x32_bf16 v[148:151], a[252:255], v[232:235], 0
v_perm_b32 v116, v194, v192, v252
v_perm_b32 v117, v194, v192, v253
v_mfma_f32_16x16x32_bf16 v[148:151], a[248:251], v[224:227], v[148:151]
v_mov_b64 v[196:197], 0
v_add_f32 v206, v206, v207
v_mfma_f32_16x16x32_bf16 v[148:151], a[244:247], v[212:215], v[148:151]
ds_write_b32 v250, v206 offset:192
v_mfma_f32_16x16x32_bf16 v[148:151], a[240:243], v[188:191], v[148:151]
v_exp_f32 v220, v220
v_mfma_f32_16x16x32_bf16 v[188:191], v[40:43], v[96:99], 0
v_exp_f32 v221, v221
v_mfma_f32_16x16x32_bf16 v[188:191], v[44:47], v[100:103], v[188:191]
v_exp_f32 v222, v222
v_smfmac_f32_16x16x64_bf16 v[196:199], v[184:187], v[120:127], v251
ds_read_b128 v[200:203], v242 offset:4224
v_cvt_pk_bf16_f32 v110, v220, v221
v_smfmac_f32_16x16x64_bf16 v[196:199], v[184:187], v[128:135], v251 abid:1
ds_read_b128 v[212:215], v242 offset:4736
ds_read_b128 v[216:219], v242 offset:4992
v_mfma_f32_16x16x32_bf16 v[168:171], v[80:83], v[128:131], v[168:171]
v_exp_f32 v223, v223
v_mfma_f32_16x16x32_bf16 v[168:171], v[64:67], v[124:127], v[168:171]
v_cvt_pk_bf16_f32 v111, v222, v223
v_add_u32 v250, 1728, v250
v_mfma_f32_16x16x32_bf16 v[168:171], v[48:51], v[120:123], v[168:171]
v_exp_f32 v208, v208
v_mfma_f32_16x16x32_bf16 v[172:175], v[52:55], v[120:123], v[172:175]
v_exp_f32 v209, v209
v_mfma_f32_16x16x32_bf16 v[172:175], v[68:71], v[124:127], v[172:175]
v_exp_f32 v210, v210
v_mfma_f32_16x16x32_bf16 v[172:175], v[84:87], v[128:131], v[172:175]
v_exp_f32 v211, v211
v_mfma_f32_16x16x32_bf16 v[176:179], v[88:91], v[128:131], v[176:179]
v_cvt_pk_bf16_f32 v108, v208, v209
v_cvt_pk_bf16_f32 v109, v210, v211
v_mfma_f32_16x16x32_bf16 v[176:179], v[72:75], v[124:127], v[176:179]
ds_read_b128 v[208:211], v242 offset:4480
v_add_f32 v196, v196, v197
v_mfma_f32_16x16x32_bf16 v[176:179], v[56:59], v[120:123], v[176:179]
v_rcp_f32 v254, v196
v_mfma_f32_16x16x32_bf16 v[180:183], v[60:63], v[120:123], v[180:183]
v_max3_f32 v255, v255, v196, v254
v_fmac_f32 v152, v168, v254
v_mfma_f32_16x16x32_bf16 v[180:183], v[76:79], v[124:127], v[180:183]
v_fmac_f32 v153, v169, v254
v_fmac_f32 v154, v170, v254
v_mfma_f32_16x16x32_bf16 v[180:183], v[92:95], v[128:131], v[180:183]
s_waitcnt lgkmcnt(3)
v_fmac_f32 v160, v176, v254
v_fmac_f32 v161, v177, v254
v_mfma_f32_16x16x32_bf16 v[192:195], v[32:35], v[96:99], 0
s_waitcnt lgkmcnt(1)
v_fmac_f32 v155, v171, v254
v_cvt_pk_bf16_f32 v152, v152, v153
v_mfma_f32_16x16x32_bf16 v[192:195], v[36:39], v[100:103], v[192:195]
s_waitcnt lgkmcnt(0)
v_fmac_f32 v162, v178, v254
v_fmac_f32 v163, v179, v254
v_mfma_f32_16x16x32_bf16 v[220:223], a[0:3], v[200:203], 0
s_mov_b64 vcc, s[14:15]
v_cvt_pk_bf16_f32 v160, v160, v161
v_fmac_f32 v156, v172, v254
v_mfma_f32_16x16x32_bf16 v[220:223], a[4:7], v[208:211], v[220:223]
v_fmac_f32 v157, v173, v254
v_fmac_f32 v158, v174, v254
v_mfma_f32_16x16x32_bf16 v[220:223], a[8:11], v[212:215], v[220:223]
v_fmac_f32 v159, v175, v254
v_cvt_pk_bf16_f32 v153, v154, v155
v_mfma_f32_16x16x32_bf16 v[220:223], a[12:15], v[216:219], v[220:223]
v_fmac_f32 v164, v180, v254
v_fmac_f32 v165, v181, v254
v_mfma_f32_16x16x32_bf16 v[224:227], a[28:31], v[216:219], 0
v_fmac_f32 v166, v182, v254
v_fmac_f32 v167, v183, v254
v_mfma_f32_16x16x32_bf16 v[224:227], a[24:27], v[212:215], v[224:227]
v_cvt_pk_bf16_f32 v161, v162, v163
v_cvt_pk_bf16_f32 v154, v156, v157
v_mfma_f32_16x16x32_bf16 v[224:227], a[20:23], v[208:211], v[224:227]
v_cvt_pk_bf16_f32 v155, v158, v159
v_cvt_pk_bf16_f32 v162, v164, v165
v_mfma_f32_16x16x32_bf16 v[224:227], a[16:19], v[200:203], v[224:227]
v_cvt_pk_bf16_f32 v163, v166, v167
v_pk_max_i16 v152, v152, 0
v_mfma_f32_16x16x32_bf16 v[228:231], a[32:35], v[200:203], 0
v_pk_max_i16 v153, v153, 0
v_pk_max_i16 v154, v154, 0
v_mfma_f32_16x16x32_bf16 v[228:231], a[36:39], v[208:211], v[228:231]
v_pk_max_i16 v155, v155, 0
v_pk_max_i16 v160, v160, 0
v_mfma_f32_16x16x32_bf16 v[228:231], a[40:43], v[212:215], v[228:231]
v_pk_max_i16 v161, v161, 0
v_pk_max_i16 v162, v162, 0
v_mfma_f32_16x16x32_bf16 v[228:231], a[44:47], v[216:219], v[228:231]
v_pk_max_i16 v163, v163, 0
v_cndmask_b32_dpp v156, v160, v152, vcc quad_perm:[1,0,3,2] row_mask:0xf bank_mask:0xf
v_mfma_f32_16x16x32_bf16 v[196:199], a[60:63], v[216:219], 0
v_cndmask_b32_dpp v157, v161, v153, vcc quad_perm:[1,0,3,2] row_mask:0xf bank_mask:0xf
v_cndmask_b32_dpp v158, v162, v154, vcc quad_perm:[1,0,3,2] row_mask:0xf bank_mask:0xf
v_mfma_f32_16x16x32_bf16 v[196:199], a[56:59], v[212:215], v[196:199]
v_cndmask_b32_dpp v159, v163, v155, vcc quad_perm:[1,0,3,2] row_mask:0xf bank_mask:0xf
v_cvt_pk_bf16_f32 v96, v220, v221
v_mfma_f32_16x16x32_bf16 v[196:199], a[52:55], v[208:211], v[196:199]
s_not_b64 vcc, vcc
v_cndmask_b32_dpp v160, v152, v160, vcc quad_perm:[1,0,3,2] row_mask:0xf bank_mask:0xf
v_cndmask_b32_dpp v161, v153, v161, vcc quad_perm:[1,0,3,2] row_mask:0xf bank_mask:0xf
v_mfma_f32_16x16x32_bf16 v[196:199], a[48:51], v[200:203], v[196:199]
v_cndmask_b32_dpp v162, v154, v162, vcc quad_perm:[1,0,3,2] row_mask:0xf bank_mask:0xf
v_cndmask_b32_dpp v163, v155, v163, vcc quad_perm:[1,0,3,2] row_mask:0xf bank_mask:0xf
v_mfma_f32_32x32x16_bf16 v[168:183], v[236:239], v[116:119], 0
buffer_store_dwordx4 v[156:159], v244, s[20:23], s53 offen offset:0 nt
buffer_store_dwordx4 v[160:163], v244, s[20:23], s53 offen offset:256 nt
v_cvt_pk_bf16_f32 v100, v228, v229
v_cvt_pk_bf16_f32 v101, v230, v231
v_exp_f32 v188, v188
v_mfma_f32_16x16x32_bf16 v[152:155], a[192:195], v[200:203], 0
s_add_u32 s53, s46, 4096
v_cvt_pk_bf16_f32 v102, v196, v197
v_cvt_pk_bf16_f32 v103, v198, v199
v_mfma_f32_16x16x32_bf16 v[152:155], a[196:199], v[208:211], v[152:155]
s_add_u32 s46, s46, 13107200
v_exp_f32 v189, v189
v_mfma_f32_16x16x32_bf16 v[152:155], a[200:203], v[212:215], v[152:155]
v_exp_f32 v190, v190
v_mfma_f32_16x16x32_bf16 v[152:155], a[204:207], v[216:219], v[152:155]
v_exp_f32 v191, v191
v_mfma_f32_16x16x32_bf16 v[156:159], a[220:223], v[216:219], 0
v_cvt_pk_bf16_f32 v114, v188, v189
v_cvt_pk_bf16_f32 v115, v190, v191
v_mfma_f32_16x16x32_bf16 v[156:159], a[216:219], v[212:215], v[156:159]
v_cvt_pk_bf16_f32 v97, v222, v223
v_cvt_pk_bf16_f32 v98, v224, v225
v_mfma_f32_16x16x32_bf16 v[156:159], a[212:215], v[208:211], v[156:159]
v_cvt_pk_bf16_f32 v99, v226, v227
v_mfma_f32_16x16x32_bf16 v[156:159], a[208:211], v[200:203], v[156:159]
v_exp_f32 v192, v192
v_mfma_f32_16x16x32_bf16 v[160:163], a[224:227], v[200:203], 0
v_exp_f32 v193, v193
v_mfma_f32_16x16x32_bf16 v[160:163], a[228:231], v[208:211], v[160:163]
v_exp_f32 v194, v194
v_mfma_f32_16x16x32_bf16 v[160:163], a[232:235], v[212:215], v[160:163]
v_exp_f32 v195, v195
v_mfma_f32_16x16x32_bf16 v[160:163], a[236:239], v[216:219], v[160:163]
v_cvt_pk_bf16_f32 v112, v192, v193
v_cvt_pk_bf16_f32 v113, v194, v195
v_mfma_f32_16x16x32_bf16 v[188:191], v[36:39], v[100:103], 0
ds_read_b128 v[192:195], v242 offset:8448
ds_read_b128 v[204:207], v242 offset:8704
v_mfma_f32_16x16x32_bf16 v[188:191], v[32:35], v[96:99], v[188:191]
ds_read_b128 v[220:223], v242 offset:8960
ds_read_b128 v[196:199], v242 offset:9216
v_mfma_f32_16x16x32_bf16 v[224:227], v[8:11], v[96:99], 0
s_nop 2
v_mfma_f32_16x16x32_bf16 v[224:227], v[12:15], v[100:103], v[224:227]
v_mov_b64 v[228:229], 0
s_nop 0
v_mfma_f32_16x16x32_bf16 v[164:167], a[252:255], v[216:219], 0
v_exp_f32 v188, v188
v_mfma_f32_16x16x32_bf16 v[164:167], a[248:251], v[212:215], v[164:167]
v_exp_f32 v189, v189
v_mfma_f32_16x16x32_bf16 v[164:167], a[244:247], v[208:211], v[164:167]
s_waitcnt lgkmcnt(3)
v_exp_f32 v224, v224
v_mfma_f32_16x16x32_bf16 v[164:167], a[240:243], v[200:203], v[164:167]
v_mov_b64 v[200:201], s[96:97]
v_mov_b64 v[202:203], s[96:97]
v_smfmac_f32_16x16x64_bf16 v[228:231], v[184:187], v[104:111], v251
v_cvt_pk_bf16_f32 v128, v188, v189
v_smfmac_f32_16x16x64_bf16 v[228:231], v[184:187], v[112:119], v251 abid:1
s_nop 2
v_mfma_f32_16x16x32_bf16 v[208:211], v[4:7], v[100:103], 0
v_exp_f32 v225, v225
v_mfma_f32_16x16x32_bf16 v[208:211], v[0:3], v[96:99], v[208:211]
v_exp_f32 v226, v226
v_smfmac_f32_16x16x64_bf16 v[200:203], v[238:241], v[96:103], v251
v_add_f32 v228, v228, v229
v_mfma_f32_16x16x32_bf16 v[168:171], v[48:51], v[104:107], v[168:171]
s_waitcnt lgkmcnt(2)
v_rcp_f32 v254, v228
v_mfma_f32_16x16x32_bf16 v[168:171], v[64:67], v[108:111], v[168:171]
s_waitcnt lgkmcnt(0)
v_max3_f32 v255, v255, v228, v254
v_cvt_pk_bf16_f32 v122, v224, v225
v_mfma_f32_16x16x32_bf16 v[168:171], v[80:83], v[112:115], v[168:171]
v_add_f32 v200, v200, v201
v_add_f32 v202, v202, v203
v_mfma_f32_16x16x32_bf16 v[212:215], v[24:27], v[96:99], 0
v_exp_f32 v200, v200
v_mfma_f32_16x16x32_bf16 v[212:215], v[28:31], v[100:103], v[212:215]
v_exp_f32 v202, v202
v_mfma_f32_16x16x32_bf16 v[216:219], v[44:47], v[100:103], 0
v_perm_b32 v132, v202, v200, v252
v_perm_b32 v133, v202, v200, v253
v_mfma_f32_16x16x32_bf16 v[216:219], v[40:43], v[96:99], v[216:219]
v_exp_f32 v227, v227
v_mfma_f32_16x16x32_bf16 v[228:231], v[16:19], v[96:99], 0
v_cvt_pk_bf16_f32 v123, v226, v227
v_fmac_f32 v136, v168, v254
v_mfma_f32_16x16x32_bf16 v[228:231], v[20:23], v[100:103], v[228:231]
v_exp_f32 v208, v208
v_mfma_f32_16x16x32_bf16 v[172:175], v[52:55], v[104:107], v[172:175]
v_exp_f32 v209, v209
v_mfma_f32_16x16x32_bf16 v[172:175], v[68:71], v[108:111], v[172:175]
v_exp_f32 v210, v210
v_mfma_f32_16x16x32_bf16 v[172:175], v[84:87], v[112:115], v[172:175]
v_exp_f32 v211, v211
v_mfma_f32_16x16x32_bf16 v[176:179], v[88:91], v[112:115], v[176:179]
v_cvt_pk_bf16_f32 v120, v208, v209
v_cvt_pk_bf16_f32 v121, v210, v211
v_mfma_f32_16x16x32_bf16 v[176:179], v[72:75], v[108:111], v[176:179]
v_fmac_f32 v137, v169, v254
v_fmac_f32 v138, v170, v254
v_mfma_f32_16x16x32_bf16 v[176:179], v[56:59], v[104:107], v[176:179]
v_fmac_f32 v139, v171, v254
v_cvt_pk_bf16_f32 v136, v136, v137
v_mfma_f32_16x16x32_bf16 v[180:183], v[60:63], v[104:107], v[180:183]
v_cvt_pk_bf16_f32 v137, v138, v139
v_fmac_f32 v140, v172, v254
v_mfma_f32_16x16x32_bf16 v[180:183], v[76:79], v[108:111], v[180:183]
v_fmac_f32 v141, v173, v254
v_fmac_f32 v142, v174, v254
v_mfma_f32_16x16x32_bf16 v[180:183], v[92:95], v[112:115], v[180:183]
s_mov_b64 vcc, s[14:15]
v_fmac_f32 v144, v176, v254
v_fmac_f32 v145, v177, v254
v_mfma_f32_16x16x32_bf16 v[200:203], a[0:3], v[192:195], 0
v_fmac_f32 v146, v178, v254
v_fmac_f32 v147, v179, v254
v_mfma_f32_16x16x32_bf16 v[200:203], a[4:7], v[204:207], v[200:203]
v_cvt_pk_bf16_f32 v144, v144, v145
v_fmac_f32 v143, v175, v254
v_mfma_f32_16x16x32_bf16 v[200:203], a[8:11], v[220:223], v[200:203]
v_fmac_f32 v148, v180, v254
v_fmac_f32 v149, v181, v254
v_mfma_f32_16x16x32_bf16 v[200:203], a[12:15], v[196:199], v[200:203]
v_fmac_f32 v150, v182, v254
v_fmac_f32 v151, v183, v254
v_mfma_f32_16x16x32_bf16 v[224:227], a[28:31], v[196:199], 0
v_cvt_pk_bf16_f32 v145, v146, v147
v_cvt_pk_bf16_f32 v138, v140, v141
v_mfma_f32_16x16x32_bf16 v[224:227], a[24:27], v[220:223], v[224:227]
v_cvt_pk_bf16_f32 v139, v142, v143
v_cvt_pk_bf16_f32 v146, v148, v149
v_mfma_f32_16x16x32_bf16 v[224:227], a[20:23], v[204:207], v[224:227]
v_cvt_pk_bf16_f32 v96, v200, v201
v_cvt_pk_bf16_f32 v97, v202, v203
v_mfma_f32_16x16x32_bf16 v[224:227], a[16:19], v[192:195], v[224:227]
v_cvt_pk_bf16_f32 v147, v150, v151
v_pk_max_i16 v136, v136, 0
v_mfma_f32_16x16x32_bf16 v[200:203], a[32:35], v[192:195], 0
v_pk_max_i16 v137, v137, 0
v_pk_max_i16 v138, v138, 0
v_mfma_f32_16x16x32_bf16 v[200:203], a[36:39], v[204:207], v[200:203]
v_pk_max_i16 v139, v139, 0
v_pk_max_i16 v144, v144, 0
v_mfma_f32_16x16x32_bf16 v[200:203], a[40:43], v[220:223], v[200:203]
v_pk_max_i16 v145, v145, 0
v_pk_max_i16 v146, v146, 0
v_mfma_f32_16x16x32_bf16 v[200:203], a[44:47], v[196:199], v[200:203]
v_pk_max_i16 v147, v147, 0
v_cndmask_b32_dpp v140, v144, v136, vcc quad_perm:[1,0,3,2] row_mask:0xf bank_mask:0xf
v_mfma_f32_16x16x32_bf16 v[208:211], a[60:63], v[196:199], 0
v_cndmask_b32_dpp v141, v145, v137, vcc quad_perm:[1,0,3,2] row_mask:0xf bank_mask:0xf
v_cndmask_b32_dpp v142, v146, v138, vcc quad_perm:[1,0,3,2] row_mask:0xf bank_mask:0xf
v_mfma_f32_16x16x32_bf16 v[208:211], a[56:59], v[220:223], v[208:211]
v_cndmask_b32_dpp v143, v147, v139, vcc quad_perm:[1,0,3,2] row_mask:0xf bank_mask:0xf
v_cvt_pk_bf16_f32 v98, v224, v225
v_mfma_f32_16x16x32_bf16 v[208:211], a[52:55], v[204:207], v[208:211]
s_not_b64 vcc, vcc
v_cndmask_b32_dpp v144, v136, v144, vcc quad_perm:[1,0,3,2] row_mask:0xf bank_mask:0xf
v_cndmask_b32_dpp v145, v137, v145, vcc quad_perm:[1,0,3,2] row_mask:0xf bank_mask:0xf
v_mfma_f32_16x16x32_bf16 v[208:211], a[48:51], v[192:195], v[208:211]
v_cndmask_b32_dpp v146, v138, v146, vcc quad_perm:[1,0,3,2] row_mask:0xf bank_mask:0xf
v_cndmask_b32_dpp v147, v139, v147, vcc quad_perm:[1,0,3,2] row_mask:0xf bank_mask:0xf
v_mfma_f32_32x32x16_bf16 v[168:183], v[236:239], v[132:135], 0
buffer_store_dwordx4 v[140:143], v244, s[20:23], s52 offen offset:0 nt
buffer_store_dwordx4 v[144:147], v244, s[20:23], s52 offen offset:256 nt
v_cvt_pk_bf16_f32 v100, v200, v201
v_cvt_pk_bf16_f32 v101, v202, v203
v_cvt_pk_bf16_f32 v99, v226, v227
v_cvt_pk_bf16_f32 v102, v208, v209
v_mfma_f32_16x16x32_bf16 v[136:139], a[192:195], v[192:195], 0
v_cvt_pk_bf16_f32 v103, v210, v211
v_mfma_f32_16x16x32_bf16 v[136:139], a[196:199], v[204:207], v[136:139]
v_exp_f32 v212, v212
v_mfma_f32_16x16x32_bf16 v[136:139], a[200:203], v[220:223], v[136:139]
v_exp_f32 v213, v213
v_mfma_f32_16x16x32_bf16 v[136:139], a[204:207], v[196:199], v[136:139]
v_exp_f32 v214, v214
v_mfma_f32_16x16x32_bf16 v[140:143], a[220:223], v[196:199], 0
v_exp_f32 v215, v215
v_mfma_f32_16x16x32_bf16 v[140:143], a[216:219], v[220:223], v[140:143]
v_exp_f32 v228, v228
v_mfma_f32_16x16x32_bf16 v[140:143], a[212:215], v[204:207], v[140:143]
v_exp_f32 v229, v229
v_mfma_f32_16x16x32_bf16 v[140:143], a[208:211], v[192:195], v[140:143]
v_exp_f32 v230, v230
v_mfma_f32_16x16x32_bf16 v[144:147], a[224:227], v[192:195], 0
v_exp_f32 v231, v231
v_mfma_f32_16x16x32_bf16 v[144:147], a[228:231], v[204:207], v[144:147]
v_cvt_pk_bf16_f32 v126, v212, v213
v_cvt_pk_bf16_f32 v127, v214, v215
v_mfma_f32_16x16x32_bf16 v[144:147], a[232:235], v[220:223], v[144:147]
v_cvt_pk_bf16_f32 v124, v228, v229
v_cvt_pk_bf16_f32 v125, v230, v231
v_mfma_f32_16x16x32_bf16 v[144:147], a[236:239], v[196:199], v[144:147]
v_mov_b64 v[200:201], s[96:97]
v_mov_b64 v[202:203], s[96:97]
v_mfma_f32_16x16x32_bf16 v[148:151], a[252:255], v[196:199], 0
v_exp_f32 v190, v190
v_mfma_f32_16x16x32_bf16 v[148:151], a[248:251], v[220:223], v[148:151]
v_exp_f32 v191, v191
v_mfma_f32_16x16x32_bf16 v[148:151], a[244:247], v[204:207], v[148:151]
v_exp_f32 v216, v216
v_mfma_f32_16x16x32_bf16 v[148:151], a[240:243], v[192:195], v[148:151]
v_exp_f32 v217, v217
v_smfmac_f32_16x16x64_bf16 v[200:203], v[238:241], v[96:103], v251
v_mov_b64 v[192:193], 0
v_mfma_f32_16x16x32_bf16 v[196:199], v[0:3], v[96:99], 0
v_exp_f32 v218, v218
v_mfma_f32_16x16x32_bf16 v[196:199], v[4:7], v[100:103], v[196:199]
v_exp_f32 v219, v219
v_mfma_f32_16x16x32_bf16 v[204:207], v[12:15], v[100:103], 0
v_cvt_pk_bf16_f32 v129, v190, v191
v_cvt_pk_bf16_f32 v130, v216, v217
v_mfma_f32_16x16x32_bf16 v[204:207], v[8:11], v[96:99], v[204:207]
v_cvt_pk_bf16_f32 v131, v218, v219
v_add_f32 v200, v200, v201
v_smfmac_f32_16x16x64_bf16 v[192:195], v[184:187], v[120:127], v251
ds_read_b128 v[188:191], v242 offset:12672
v_add_f32 v202, v202, v203
v_smfmac_f32_16x16x64_bf16 v[192:195], v[184:187], v[128:135], v251 abid:1
ds_read_b128 v[208:211], v242 offset:12928
ds_read_b128 v[212:215], v242 offset:13184
v_mfma_f32_16x16x32_bf16 v[168:171], v[80:83], v[128:131], v[168:171]
ds_read_b128 v[216:219], v242 offset:13440
v_add_u32 v242, s56, v242
v_mfma_f32_16x16x32_bf16 v[168:171], v[64:67], v[124:127], v[168:171]
s_sub_u32 s56, 0, s56
v_exp_f32 v200, v200
v_mfma_f32_16x16x32_bf16 v[168:171], v[48:51], v[120:123], v[168:171]
v_exp_f32 v202, v202
v_mfma_f32_16x16x32_bf16 v[172:175], v[52:55], v[120:123], v[172:175]
v_perm_b32 v116, v202, v200, v252
v_perm_b32 v117, v202, v200, v253
v_mfma_f32_16x16x32_bf16 v[172:175], v[68:71], v[124:127], v[172:175]
v_add_f32 v192, v192, v193
v_mfma_f32_16x16x32_bf16 v[172:175], v[84:87], v[128:131], v[172:175]
v_rcp_f32 v254, v192
v_mfma_f32_16x16x32_bf16 v[176:179], v[88:91], v[128:131], v[176:179]
v_max3_f32 v255, v255, v192, v254
v_fmac_f32 v152, v168, v254
v_mfma_f32_16x16x32_bf16 v[176:179], v[72:75], v[124:127], v[176:179]
v_fmac_f32 v153, v169, v254
v_fmac_f32 v154, v170, v254
v_mfma_f32_16x16x32_bf16 v[176:179], v[56:59], v[120:123], v[176:179]
v_fmac_f32 v155, v171, v254
v_cvt_pk_bf16_f32 v152, v152, v153
v_mfma_f32_16x16x32_bf16 v[180:183], v[60:63], v[120:123], v[180:183]
v_fmac_f32 v156, v172, v254
v_fmac_f32 v157, v173, v254
v_mfma_f32_16x16x32_bf16 v[180:183], v[76:79], v[124:127], v[180:183]
v_fmac_f32 v158, v174, v254
v_fmac_f32 v159, v175, v254
v_mfma_f32_16x16x32_bf16 v[180:183], v[92:95], v[128:131], v[180:183]
s_waitcnt lgkmcnt(3)
v_fmac_f32 v160, v176, v254
v_fmac_f32 v161, v177, v254
v_mfma_f32_16x16x32_bf16 v[200:203], v[36:39], v[100:103], 0
s_waitcnt lgkmcnt(1)
v_fmac_f32 v162, v178, v254
v_fmac_f32 v163, v179, v254
v_mfma_f32_16x16x32_bf16 v[200:203], v[32:35], v[96:99], v[200:203]
s_waitcnt lgkmcnt(0)
v_cvt_pk_bf16_f32 v160, v160, v161
v_cvt_pk_bf16_f32 v153, v154, v155
v_mfma_f32_16x16x32_bf16 v[220:223], v[24:27], v[96:99], 0
s_mov_b64 vcc, s[14:15]
v_fmac_f32 v164, v180, v254
v_fmac_f32 v165, v181, v254
v_mfma_f32_16x16x32_bf16 v[220:223], v[28:31], v[100:103], v[220:223]
v_fmac_f32 v166, v182, v254
v_fmac_f32 v167, v183, v254
v_mfma_f32_16x16x32_bf16 v[224:227], v[20:23], v[100:103], 0
v_cvt_pk_bf16_f32 v161, v162, v163
v_cvt_pk_bf16_f32 v154, v156, v157
v_mfma_f32_16x16x32_bf16 v[224:227], v[16:19], v[96:99], v[224:227]
v_mov_b32 v232, s45
v_cvt_pk_bf16_f32 v155, v158, v159
v_mfma_f32_16x16x32_bf16 v[228:231], v[40:43], v[96:99], 0
s_waitcnt vmcnt(6)
ds_write_addtid_b32 v232 offset:65280
v_mfma_f32_16x16x32_bf16 v[228:231], v[44:47], v[100:103], v[228:231]
v_cvt_pk_bf16_f32 v162, v164, v165
v_cvt_pk_bf16_f32 v163, v166, v167
v_mfma_f32_16x16x32_bf16 v[192:195], a[0:3], v[188:191], 0
v_pk_max_i16 v152, v152, 0
v_pk_max_i16 v153, v153, 0
v_mfma_f32_16x16x32_bf16 v[192:195], a[4:7], v[208:211], v[192:195]
v_pk_max_i16 v154, v154, 0
v_pk_max_i16 v155, v155, 0
v_mfma_f32_16x16x32_bf16 v[192:195], a[8:11], v[212:215], v[192:195]
v_pk_max_i16 v160, v160, 0
v_pk_max_i16 v161, v161, 0
v_mfma_f32_16x16x32_bf16 v[192:195], a[12:15], v[216:219], v[192:195]
v_pk_max_i16 v162, v162, 0
v_pk_max_i16 v163, v163, 0
v_mfma_f32_16x16x32_bf16 v[232:235], a[28:31], v[216:219], 0
v_cndmask_b32_dpp v156, v160, v152, vcc quad_perm:[1,0,3,2] row_mask:0xf bank_mask:0xf
v_cndmask_b32_dpp v157, v161, v153, vcc quad_perm:[1,0,3,2] row_mask:0xf bank_mask:0xf
v_mfma_f32_16x16x32_bf16 v[232:235], a[24:27], v[212:215], v[232:235]
v_cndmask_b32_dpp v158, v162, v154, vcc quad_perm:[1,0,3,2] row_mask:0xf bank_mask:0xf
v_cndmask_b32_dpp v159, v163, v155, vcc quad_perm:[1,0,3,2] row_mask:0xf bank_mask:0xf
v_mfma_f32_16x16x32_bf16 v[232:235], a[20:23], v[208:211], v[232:235]
s_not_b64 vcc, vcc
v_cvt_pk_bf16_f32 v96, v192, v193
v_cvt_pk_bf16_f32 v97, v194, v195
v_mfma_f32_16x16x32_bf16 v[232:235], a[16:19], v[188:191], v[232:235]
v_cndmask_b32_dpp v160, v152, v160, vcc quad_perm:[1,0,3,2] row_mask:0xf bank_mask:0xf
v_cndmask_b32_dpp v161, v153, v161, vcc quad_perm:[1,0,3,2] row_mask:0xf bank_mask:0xf
v_mfma_f32_16x16x32_bf16 v[192:195], a[32:35], v[188:191], 0
v_cndmask_b32_dpp v162, v154, v162, vcc quad_perm:[1,0,3,2] row_mask:0xf bank_mask:0xf
v_cndmask_b32_dpp v163, v155, v163, vcc quad_perm:[1,0,3,2] row_mask:0xf bank_mask:0xf
v_mfma_f32_16x16x32_bf16 v[192:195], a[36:39], v[208:211], v[192:195]
v_exp_f32 v204, v204
v_mfma_f32_16x16x32_bf16 v[192:195], a[40:43], v[212:215], v[192:195]
v_cvt_pk_bf16_f32 v98, v232, v233
v_cvt_pk_bf16_f32 v99, v234, v235
v_mfma_f32_16x16x32_bf16 v[192:195], a[44:47], v[216:219], v[192:195]
v_exp_f32 v205, v205
v_mfma_f32_16x16x32_bf16 v[232:235], a[60:63], v[216:219], 0
v_exp_f32 v206, v206
v_mfma_f32_16x16x32_bf16 v[232:235], a[56:59], v[212:215], v[232:235]
v_exp_f32 v207, v207
v_mfma_f32_16x16x32_bf16 v[232:235], a[52:55], v[208:211], v[232:235]
v_exp_f32 v220, v220
v_mfma_f32_16x16x32_bf16 v[232:235], a[48:51], v[188:191], v[232:235]
v_cvt_pk_bf16_f32 v100, v192, v193
v_cvt_pk_bf16_f32 v101, v194, v195
v_mfma_f32_32x32x16_bf16 v[168:183], v[236:239], v[116:119], 0
s_cmp_lg_u32 s45, 0
buffer_store_dwordx4 v[156:159], v244, s[20:23], s53 offen offset:0 nt
buffer_store_dwordx4 v[160:163], v244, s[20:23], s53 offen offset:256 nt
s_cbranch_scc1 L_loopf
v_mfma_f32_16x16x32_bf16 v[152:155], a[192:195], v[188:191], 0
L_h5:
s_cbranch_execz L_ret
s_mov_b32 m0, s59
v_cvt_pk_bf16_f32 v102, v232, v233
v_cvt_pk_bf16_f32 v103, v234, v235
v_mfma_f32_16x16x32_bf16 v[152:155], a[196:199], v[208:211], v[152:155]
s_mul_i32 s54, s41, 13824
v_mov_b64 v[192:193], s[96:97]
v_mov_b64 v[194:195], s[96:97]
v_mfma_f32_16x16x32_bf16 v[152:155], a[200:203], v[212:215], v[152:155]
s_add_u32 s7, s54, 102400
v_exp_f32 v196, v196
v_mfma_f32_16x16x32_bf16 v[152:155], a[204:207], v[216:219], v[152:155]
s_mov_b32 s6, 1728
v_exp_f32 v197, v197
v_mfma_f32_16x16x32_bf16 v[156:159], a[220:223], v[216:219], 0
s_lshl_b32 s55, s41, 9
v_exp_f32 v198, v198
v_mfma_f32_16x16x32_bf16 v[156:159], a[216:219], v[212:215], v[156:159]
s_mov_b32 s13, 272
v_exp_f32 v199, v199
v_mfma_f32_16x16x32_bf16 v[156:159], a[212:215], v[208:211], v[156:159]
s_add_u32 s8, s54, 103536
v_cvt_pk_bf16_f32 v104, v196, v197
v_cvt_pk_bf16_f32 v105, v198, v199
v_mfma_f32_16x16x32_bf16 v[156:159], a[208:211], v[188:191], v[156:159]
s_add_u32 s9, s55, 160960
v_cvt_pk_bf16_f32 v106, v204, v205
v_cvt_pk_bf16_f32 v107, v206, v207
v_mfma_f32_16x16x32_bf16 v[160:163], a[224:227], v[188:191], 0
s_add_u32 s52, s47, 8192
v_exp_f32 v200, v200
v_mfma_f32_16x16x32_bf16 v[160:163], a[228:231], v[208:211], v[160:163]
s_mov_b32 s57, 13106176
v_exp_f32 v201, v201
v_mfma_f32_16x16x32_bf16 v[160:163], a[232:235], v[212:215], v[160:163]
s_add_u32 s98, s44, 24576
v_exp_f32 v202, v202
v_mfma_f32_16x16x32_bf16 v[160:163], a[236:239], v[216:219], v[160:163]
s_add_u32 s99, s44, 52453376
v_exp_f32 v203, v203
v_mfma_f32_16x16x32_bf16 v[164:167], a[252:255], v[216:219], 0
s_add_u32 s53, s47, 12288
v_cvt_pk_bf16_f32 v112, v200, v201
v_cvt_pk_bf16_f32 v113, v202, v203
v_mfma_f32_16x16x32_bf16 v[164:167], a[248:251], v[212:215], v[164:167]
v_mbcnt_lo_u32_b32 v245, -1, 0
v_mbcnt_hi_u32_b32 v245, -1, v245
v_mfma_f32_16x16x32_bf16 v[164:167], a[244:247], v[208:211], v[164:167]
v_mov_b32 v243, s7
v_bfe_u32 v246, v245, 2, 2
v_mfma_f32_16x16x32_bf16 v[164:167], a[240:243], v[188:191], v[164:167]
ds_read_addtid_b32 v188 offset:65280
v_and_b32 v200, 3, v245
v_smfmac_f32_16x16x64_bf16 v[192:195], v[238:241], v[96:103], v251
v_and_b32 v202, 15, v245
v_mfma_f32_16x16x32_bf16 v[196:199], v[0:3], v[96:99], 0
v_mad_u32_u24 v243, v246, s6, v243
v_lshrrev_b32 v201, 4, v245
v_mfma_f32_16x16x32_bf16 v[196:199], v[4:7], v[100:103], v[196:199]
v_mad_u32_u24 v243, v200, s13, v243
v_lshl_add_u32 v249, v202, 3, s8
v_mfma_f32_16x16x32_bf16 v[204:207], v[12:15], v[100:103], 0
v_lshl_add_u32 v250, v202, 4, s9
v_lshl_add_u32 v247, v201, 4, v243
v_mfma_f32_16x16x32_bf16 v[204:207], v[8:11], v[96:99], v[204:207]
v_mad_u32_u24 v249, v201, s6, v249
v_add_f32 v192, v192, v193
v_mfma_f32_16x16x32_bf16 v[208:211], v[16:19], v[96:99], 0
s_waitcnt lgkmcnt(0)
v_exp_f32 v224, v224
v_mfma_f32_16x16x32_bf16 v[208:211], v[20:23], v[100:103], v[208:211]
v_exp_f32 v225, v225
v_mfma_f32_16x16x32_bf16 v[212:215], v[28:31], v[100:103], 0
v_exp_f32 v226, v226
v_mfma_f32_16x16x32_bf16 v[212:215], v[24:27], v[96:99], v[212:215]
v_exp_f32 v227, v227
v_mfma_f32_16x16x32_bf16 v[200:203], v[32:35], v[96:99], 0
ds_read_b64 v[32:33], v249 offset:0
v_cvt_pk_bf16_f32 v108, v224, v225
v_mfma_f32_16x16x32_bf16 v[200:203], v[36:39], v[100:103], v[200:203]
ds_read_b64 v[34:35], v249 offset:6912
v_cvt_pk_bf16_f32 v109, v226, v227
v_mfma_f32_16x16x32_bf16 v[224:227], v[44:47], v[100:103], 0
ds_read_b64 v[36:37], v249 offset:128
v_cmp_lt_u32 vcc, s45, v188
v_mfma_f32_16x16x32_bf16 v[224:227], v[40:43], v[96:99], v[224:227]
ds_read_b64 v[96:97], v250 offset:0
v_exp_f32 v221, v221
v_exp_f32 v222, v222
v_exp_f32 v223, v223
s_cbranch_vccnz L_spine
L_backe:
v_cvt_pk_bf16_f32 v110, v220, v221
v_cvt_pk_bf16_f32 v111, v222, v223
v_mov_b64 v[188:189], 0
v_exp_f32 v228, v228
v_add_f32 v194, v194, v195
v_smfmac_f32_16x16x64_bf16 v[188:191], v[184:187], v[104:111], v251
ds_read_b128 v[216:219], v242 offset:0
v_exp_f32 v229, v229
v_exp_f32 v230, v230
v_exp_f32 v231, v231
v_cvt_pk_bf16_f32 v114, v228, v229
v_cvt_pk_bf16_f32 v115, v230, v231
v_exp_f32 v192, v192
v_mad_u32_u24 v248, v246, s57, v244
v_smfmac_f32_16x16x64_bf16 v[188:191], v[184:187], v[112:119], v251 abid:1
s_waitcnt lgkmcnt(1)
ds_read_b128 v[220:223], v242 offset:256
ds_read_b128 v[228:231], v242 offset:512
v_mfma_f32_16x16x32_bf16 v[168:171], v[80:83], v[112:115], v[168:171]
ds_read_b128 v[232:235], v242 offset:768
ds_read_b64 v[40:41], v249 offset:256
v_mfma_f32_16x16x32_bf16 v[168:171], v[64:67], v[108:111], v[168:171]
ds_read_b64 v[42:43], v249 offset:7168
v_add_f32 v188, v188, v189
v_mfma_f32_16x16x32_bf16 v[168:171], v[48:51], v[104:107], v[168:171]
ds_read_b64 v[38:39], v249 offset:7040
ds_read_b64 v[44:45], v249 offset:384
v_mfma_f32_16x16x32_bf16 v[172:175], v[52:55], v[104:107], v[172:175]
ds_read_b64 v[46:47], v249 offset:7296
ds_read_b32 v102, v250 offset:8
v_mfma_f32_16x16x32_bf16 v[172:175], v[68:71], v[108:111], v[172:175]
ds_read_b64 v[100:101], v250 offset:256
ds_read_b32 v103, v250 offset:264
v_mfma_f32_16x16x32_bf16 v[172:175], v[84:87], v[112:115], v[172:175]
v_exp_f32 v196, v196
v_mfma_f32_16x16x32_bf16 v[176:179], v[88:91], v[112:115], v[176:179]
v_exp_f32 v197, v197
v_mfma_f32_16x16x32_bf16 v[176:179], v[72:75], v[108:111], v[176:179]
v_exp_f32 v198, v198
v_mfma_f32_16x16x32_bf16 v[176:179], v[56:59], v[104:107], v[176:179]
v_exp_f32 v199, v199
v_mfma_f32_16x16x32_bf16 v[180:183], v[60:63], v[104:107], v[180:183]
s_waitcnt lgkmcnt(2)
v_cvt_pk_bf16_f32 v120, v196, v197
v_cvt_pk_bf16_f32 v121, v198, v199
v_mfma_f32_16x16x32_bf16 v[180:183], v[76:79], v[108:111], v[180:183]
s_waitcnt lgkmcnt(0)
v_exp_f32 v194, v194
v_mfma_f32_16x16x32_bf16 v[180:183], v[92:95], v[112:115], v[180:183]
s_mov_b64 vcc, s[14:15]
v_perm_b32 v132, v194, v192, v252
v_perm_b32 v133, v194, v192, v253
v_mfma_f32_16x16x32_bf16 v[0:3], a[192:195], v[216:219], 0
v_rcp_f32 v254, v188
v_mfma_f32_16x16x32_bf16 v[0:3], a[196:199], v[220:223], v[0:3]
v_max3_f32 v255, v255, v188, v254
v_fmac_f32 v136, v168, v254
v_mfma_f32_16x16x32_bf16 v[0:3], a[200:203], v[228:231], v[0:3]
v_fmac_f32 v137, v169, v254
v_fmac_f32 v144, v176, v254
v_mfma_f32_16x16x32_bf16 v[0:3], a[204:207], v[232:235], v[0:3]
v_fmac_f32 v145, v177, v254
v_fmac_f32 v138, v170, v254
v_mfma_f32_16x16x32_bf16 v[4:7], a[220:223], v[232:235], 0
ds_read_b128 v[196:199], v242 offset:4736
ds_read_b128 v[192:195], v242 offset:4480
v_mfma_f32_16x16x32_bf16 v[4:7], a[216:219], v[228:231], v[4:7]
ds_read_b128 v[188:191], v242 offset:4224
v_fmac_f32 v139, v171, v254
v_mfma_f32_16x16x32_bf16 v[4:7], a[212:215], v[220:223], v[4:7]
v_cvt_pk_bf16_f32 v136, v136, v137
v_fmac_f32 v146, v178, v254
v_mfma_f32_16x16x32_bf16 v[4:7], a[208:211], v[216:219], v[4:7]
v_fmac_f32 v147, v179, v254
v_cvt_pk_bf16_f32 v144, v144, v145
v_mfma_f32_16x16x32_bf16 v[8:11], a[224:227], v[216:219], 0
v_fmac_f32 v140, v172, v254
v_fmac_f32 v141, v173, v254
v_mfma_f32_16x16x32_bf16 v[8:11], a[228:231], v[220:223], v[8:11]
ds_read_b128 v[104:107], v247 offset:0
v_fmac_f32 v142, v174, v254
v_mfma_f32_16x16x32_bf16 v[8:11], a[232:235], v[228:231], v[8:11]
ds_read_b128 v[108:111], v247 offset:64
v_fmac_f32 v143, v175, v254
v_mfma_f32_16x16x32_bf16 v[8:11], a[236:239], v[232:235], v[8:11]
ds_read_b128 v[112:115], v247 offset:128
v_cvt_pk_bf16_f32 v137, v138, v139
v_mfma_f32_16x16x32_bf16 v[12:15], a[252:255], v[232:235], 0
ds_read_b128 v[232:235], v242 offset:4992
v_fmac_f32 v148, v180, v254
v_mfma_f32_16x16x32_bf16 v[12:15], a[244:247], v[220:223], v[12:15]
ds_read_b128 v[116:119], v247 offset:192
v_fmac_f32 v149, v181, v254
v_mfma_f32_16x16x32_bf16 v[12:15], a[240:243], v[216:219], v[12:15]
s_waitcnt lgkmcnt(7)
ds_read_b128 v[220:223], v243 offset:256
v_fmac_f32 v150, v182, v254
v_mfma_f32_16x16x32_bf16 v[12:15], a[248:251], v[228:231], v[12:15]
v_fmac_f32 v151, v183, v254
v_cvt_pk_bf16_f32 v145, v146, v147
v_mfma_f32_16x16x32_bf16 v[28:31], a[248:251], v[196:199], 0
s_waitcnt lgkmcnt(7)
v_cvt_pk_bf16_f32 v138, v140, v141
v_cvt_pk_bf16_f32 v139, v142, v143
v_cvt_pk_bf16_f32 v146, v148, v149
v_cvt_pk_bf16_f32 v147, v150, v151
v_pk_max_i16 v136, v136, 0
s_waitcnt lgkmcnt(2)
v_mfma_f32_16x16x32_bf16 v[28:31], a[252:255], v[232:235], v[28:31]
v_pk_max_i16 v137, v137, 0
v_pk_max_i16 v138, v138, 0
v_mfma_f32_16x16x32_bf16 v[28:31], a[244:247], v[192:195], v[28:31]
v_pk_max_i16 v139, v139, 0
v_pk_max_i16 v144, v144, 0
v_mfma_f32_16x16x32_bf16 v[28:31], a[240:243], v[188:191], v[28:31]
s_waitcnt lgkmcnt(0)
v_pk_max_i16 v145, v145, 0
v_pk_max_i16 v146, v146, 0
v_pk_max_i16 v147, v147, 0
v_cndmask_b32_dpp v140, v144, v136, vcc quad_perm:[1,0,3,2] row_mask:0xf bank_mask:0xf
v_cndmask_b32_dpp v141, v145, v137, vcc quad_perm:[1,0,3,2] row_mask:0xf bank_mask:0xf
v_cndmask_b32_dpp v142, v146, v138, vcc quad_perm:[1,0,3,2] row_mask:0xf bank_mask:0xf
v_cndmask_b32_dpp v143, v147, v139, vcc quad_perm:[1,0,3,2] row_mask:0xf bank_mask:0xf
s_not_b64 vcc, vcc
v_cndmask_b32_dpp v144, v136, v144, vcc quad_perm:[1,0,3,2] row_mask:0xf bank_mask:0xf
v_cndmask_b32_dpp v145, v137, v145, vcc quad_perm:[1,0,3,2] row_mask:0xf bank_mask:0xf
v_cndmask_b32_dpp v146, v138, v146, vcc quad_perm:[1,0,3,2] row_mask:0xf bank_mask:0xf
v_cndmask_b32_dpp v147, v139, v147, vcc quad_perm:[1,0,3,2] row_mask:0xf bank_mask:0xf
s_mov_b32 vcc_lo, 0xf0000f
s_mov_b32 vcc_hi, 0xf0000f00
v_mov_b64 v[98:99], 0
v_cndmask_b32 v96, 0, v96, vcc
v_cndmask_b32 v97, 0, v97, vcc
v_exp_f32 v204, v204
v_add_f32 v220, v220, v221
v_mfma_f32_16x16x32_bf16 v[104:107], v[32:35], v[96:99], v[104:107]
v_exp_f32 v205, v205
v_mfma_f32_16x16x32_bf16 v[108:111], v[36:39], v[96:99], v[108:111]
v_exp_f32 v206, v206
v_mfma_f32_16x16x32_bf16 v[112:115], v[40:43], v[96:99], v[112:115]
v_exp_f32 v207, v207
v_mfma_f32_16x16x32_bf16 v[116:119], v[44:47], v[96:99], v[116:119]
v_cvt_pk_bf16_f32 v122, v204, v205
v_cvt_pk_bf16_f32 v123, v206, v207
v_mfma_f32_16x16x32_bf16 v[24:27], a[224:227], v[188:191], 0
v_exp_f32 v208, v208
v_mfma_f32_16x16x32_bf16 v[24:27], a[228:231], v[192:195], v[24:27]
v_exp_f32 v209, v209
v_mfma_f32_16x16x32_bf16 v[24:27], a[232:235], v[196:199], v[24:27]
v_exp_f32 v210, v210
v_mfma_f32_16x16x32_bf16 v[24:27], a[236:239], v[232:235], v[24:27]
v_exp_f32 v211, v211
v_mfma_f32_32x32x16_bf16 v[168:183], v[236:239], v[132:135], 0
buffer_store_dwordx4 v[140:143], v244, s[20:23], s52 offen offset:0 nt
buffer_store_dwordx4 v[144:147], v244, s[20:23], s52 offen offset:256 nt
v_exp_f32 v212, v212
v_exp_f32 v213, v213
v_mfma_f32_16x16x32_bf16 v[20:23], a[220:223], v[232:235], 0
v_exp_f32 v214, v214
v_mfma_f32_16x16x32_bf16 v[20:23], a[216:219], v[196:199], v[20:23]
v_exp_f32 v215, v215
v_mfma_f32_16x16x32_bf16 v[20:23], a[212:215], v[192:195], v[20:23]
v_cvt_pk_bf16_f32 v124, v208, v209
v_cvt_pk_bf16_f32 v125, v210, v211
v_mfma_f32_16x16x32_bf16 v[20:23], a[208:211], v[188:191], v[20:23]
v_cvt_pk_bf16_f32 v126, v212, v213
v_cvt_pk_bf16_f32 v127, v214, v215
v_mfma_f32_16x16x32_bf16 v[16:19], a[192:195], v[188:191], 0
v_mov_b64 v[188:189], 0
v_cndmask_b32 v100, 0, v100, vcc
v_mfma_f32_16x16x32_bf16 v[16:19], a[196:199], v[192:195], v[16:19]
ds_read_b128 v[192:195], v247 offset:6912
v_cndmask_b32 v101, 0, v101, vcc
v_mfma_f32_16x16x32_bf16 v[16:19], a[200:203], v[196:199], v[16:19]
ds_read_b128 v[196:199], v247 offset:6976
ds_read_b128 v[204:207], v247 offset:7040
v_mfma_f32_16x16x32_bf16 v[16:19], a[204:207], v[232:235], v[16:19]
ds_read_b128 v[208:211], v247 offset:7104
v_add_f32 v222, v222, v223
v_smfmac_f32_16x16x64_bf16 v[188:191], v[184:187], v[120:127], v251
ds_read_b128 v[212:215], v243 offset:7168
v_exp_f32 v200, v200
v_exp_f32 v201, v201
v_exp_f32 v202, v202
v_exp_f32 v203, v203
v_exp_f32 v224, v224
v_exp_f32 v225, v225
v_exp_f32 v226, v226
v_exp_f32 v227, v227
v_cvt_pk_bf16_f32 v128, v200, v201
v_cvt_pk_bf16_f32 v129, v202, v203
v_cvt_pk_bf16_f32 v130, v224, v225
v_cvt_pk_bf16_f32 v131, v226, v227
v_add_f32 v220, v220, v102
v_add_f32 v220, v220, v222
v_smfmac_f32_16x16x64_bf16 v[188:191], v[184:187], v[128:135], v251 abid:1
s_waitcnt lgkmcnt(0)
v_add_f32 v212, v212, v213
v_mfma_f32_16x16x32_bf16 v[168:171], v[80:83], v[128:131], v[168:171]
v_rcp_f32 v252, v220
v_mfma_f32_16x16x32_bf16 v[168:171], v[64:67], v[124:127], v[168:171]
v_fmac_f32 v0, v104, v252
v_fmac_f32 v1, v105, v252
v_mfma_f32_16x16x32_bf16 v[168:171], v[48:51], v[120:123], v[168:171]
v_fmac_f32 v8, v112, v252
v_fmac_f32 v9, v113, v252
v_mfma_f32_16x16x32_bf16 v[172:175], v[52:55], v[120:123], v[172:175]
v_fmac_f32 v2, v106, v252
v_fmac_f32 v3, v107, v252
v_mfma_f32_16x16x32_bf16 v[172:175], v[68:71], v[124:127], v[172:175]
v_cvt_pk_bf16_f32 v0, v0, v1
v_fmac_f32 v10, v114, v252
v_mfma_f32_16x16x32_bf16 v[172:175], v[84:87], v[128:131], v[172:175]
v_fmac_f32 v11, v115, v252
v_cvt_pk_bf16_f32 v8, v8, v9
v_mfma_f32_16x16x32_bf16 v[192:195], v[32:35], v[98:101], v[192:195]
v_fmac_f32 v4, v108, v252
v_fmac_f32 v5, v109, v252
v_mfma_f32_16x16x32_bf16 v[196:199], v[36:39], v[98:101], v[196:199]
v_fmac_f32 v6, v110, v252
v_fmac_f32 v7, v111, v252
v_mfma_f32_16x16x32_bf16 v[204:207], v[40:43], v[98:101], v[204:207]
v_cvt_pk_bf16_f32 v1, v2, v3
v_fmac_f32 v12, v116, v252
v_mfma_f32_16x16x32_bf16 v[208:211], v[44:47], v[98:101], v[208:211]
v_fmac_f32 v13, v117, v252
v_fmac_f32 v14, v118, v252
v_mfma_f32_16x16x32_bf16 v[176:179], v[72:75], v[124:127], v[176:179]
v_fmac_f32 v15, v119, v252
v_cvt_pk_bf16_f32 v9, v10, v11
v_mfma_f32_16x16x32_bf16 v[176:179], v[88:91], v[128:131], v[176:179]
v_cvt_pk_bf16_f32 v2, v4, v5
v_cvt_pk_bf16_f32 v3, v6, v7
v_mfma_f32_16x16x32_bf16 v[176:179], v[56:59], v[120:123], v[176:179]
v_cvt_pk_bf16_f32 v10, v12, v13
v_cvt_pk_bf16_f32 v11, v14, v15
v_mfma_f32_16x16x32_bf16 v[180:183], v[60:63], v[120:123], v[180:183]
v_pk_max_i16 v0, v0, 0
v_pk_max_i16 v1, v1, 0
v_mfma_f32_16x16x32_bf16 v[180:183], v[76:79], v[124:127], v[180:183]
v_pk_max_i16 v2, v2, 0
v_pk_max_i16 v3, v3, 0
v_mfma_f32_16x16x32_bf16 v[180:183], v[92:95], v[128:131], v[180:183]
s_mov_b64 vcc, s[14:15]
v_pk_max_i16 v8, v8, 0
v_pk_max_i16 v9, v9, 0
v_pk_max_i16 v10, v10, 0
v_pk_max_i16 v11, v11, 0
v_cndmask_b32_dpp v4, v8, v0, vcc quad_perm:[1,0,3,2] row_mask:0xf bank_mask:0xf
v_cndmask_b32_dpp v5, v9, v1, vcc quad_perm:[1,0,3,2] row_mask:0xf bank_mask:0xf
v_cndmask_b32_dpp v6, v10, v2, vcc quad_perm:[1,0,3,2] row_mask:0xf bank_mask:0xf
v_cndmask_b32_dpp v7, v11, v3, vcc quad_perm:[1,0,3,2] row_mask:0xf bank_mask:0xf
s_not_b64 vcc, vcc
v_cndmask_b32_dpp v8, v0, v8, vcc quad_perm:[1,0,3,2] row_mask:0xf bank_mask:0xf
v_cndmask_b32_dpp v9, v1, v9, vcc quad_perm:[1,0,3,2] row_mask:0xf bank_mask:0xf
v_cndmask_b32_dpp v10, v2, v10, vcc quad_perm:[1,0,3,2] row_mask:0xf bank_mask:0xf
v_cndmask_b32_dpp v11, v3, v11, vcc quad_perm:[1,0,3,2] row_mask:0xf bank_mask:0xf
buffer_store_dwordx4 v[4:7], v248, s[20:23], s98 offen offset:0 nt
buffer_store_dwordx4 v[8:11], v248, s[20:23], s98 offen offset:256 nt
v_add_f32 v214, v214, v215
v_add_f32 v212, v212, v103
v_add_f32 v212, v212, v214
v_rcp_f32 v240, v212
s_mov_b64 vcc, s[14:15]
v_pk_fma_f32 v[16:17], v[192:193], v[240:241], v[16:17] op_sel_hi:[1,0,1]
v_pk_fma_f32 v[24:25], v[204:205], v[240:241], v[24:25] op_sel_hi:[1,0,1]
v_pk_fma_f32 v[18:19], v[194:195], v[240:241], v[18:19] op_sel_hi:[1,0,1]
v_cvt_pk_bf16_f32 v16, v16, v17
v_pk_fma_f32 v[26:27], v[206:207], v[240:241], v[26:27] op_sel_hi:[1,0,1]
v_cvt_pk_bf16_f32 v24, v24, v25
v_pk_fma_f32 v[20:21], v[196:197], v[240:241], v[20:21] op_sel_hi:[1,0,1]
v_pk_fma_f32 v[22:23], v[198:199], v[240:241], v[22:23] op_sel_hi:[1,0,1]
v_cvt_pk_bf16_f32 v17, v18, v19
v_pk_fma_f32 v[28:29], v[208:209], v[240:241], v[28:29] op_sel_hi:[1,0,1]
v_pk_fma_f32 v[30:31], v[210:211], v[240:241], v[30:31] op_sel_hi:[1,0,1]
v_cvt_pk_bf16_f32 v25, v26, v27
v_cvt_pk_bf16_f32 v18, v20, v21
v_cvt_pk_bf16_f32 v19, v22, v23
v_cvt_pk_bf16_f32 v26, v28, v29
v_cvt_pk_bf16_f32 v27, v30, v31
v_pk_max_i16 v16, v16, 0
v_pk_max_i16 v17, v17, 0
v_pk_max_i16 v18, v18, 0
v_pk_max_i16 v19, v19, 0
v_pk_max_i16 v24, v24, 0
v_pk_max_i16 v25, v25, 0
v_pk_max_i16 v26, v26, 0
v_pk_max_i16 v27, v27, 0
v_cndmask_b32_dpp v20, v24, v16, vcc quad_perm:[1,0,3,2] row_mask:0xf bank_mask:0xf
v_cndmask_b32_dpp v21, v25, v17, vcc quad_perm:[1,0,3,2] row_mask:0xf bank_mask:0xf
v_cndmask_b32_dpp v22, v26, v18, vcc quad_perm:[1,0,3,2] row_mask:0xf bank_mask:0xf
v_cndmask_b32_dpp v23, v27, v19, vcc quad_perm:[1,0,3,2] row_mask:0xf bank_mask:0xf
s_not_b64 vcc, vcc
v_cndmask_b32_dpp v24, v16, v24, vcc quad_perm:[1,0,3,2] row_mask:0xf bank_mask:0xf
v_cndmask_b32_dpp v25, v17, v25, vcc quad_perm:[1,0,3,2] row_mask:0xf bank_mask:0xf
v_cndmask_b32_dpp v26, v18, v26, vcc quad_perm:[1,0,3,2] row_mask:0xf bank_mask:0xf
v_cndmask_b32_dpp v27, v19, v27, vcc quad_perm:[1,0,3,2] row_mask:0xf bank_mask:0xf
buffer_store_dwordx4 v[20:23], v248, s[20:23], s99 offen offset:0 nt
buffer_store_dwordx4 v[24:27], v248, s[20:23], s99 offen offset:256 nt
v_add_f32 v188, v188, v189
v_rcp_f32 v254, v188
s_mov_b64 vcc, s[14:15]
v_pk_fma_f32 v[152:153], v[168:169], v[254:255], v[152:153] op_sel_hi:[1,0,1]
v_pk_fma_f32 v[160:161], v[176:177], v[254:255], v[160:161] op_sel_hi:[1,0,1]
v_pk_fma_f32 v[154:155], v[170:171], v[254:255], v[154:155] op_sel_hi:[1,0,1]
v_cvt_pk_bf16_f32 v152, v152, v153
v_pk_fma_f32 v[162:163], v[178:179], v[254:255], v[162:163] op_sel_hi:[1,0,1]
v_cvt_pk_bf16_f32 v160, v160, v161
v_pk_fma_f32 v[156:157], v[172:173], v[254:255], v[156:157] op_sel_hi:[1,0,1]
v_pk_fma_f32 v[158:159], v[174:175], v[254:255], v[158:159] op_sel_hi:[1,0,1]
v_cvt_pk_bf16_f32 v153, v154, v155
v_pk_fma_f32 v[164:165], v[180:181], v[254:255], v[164:165] op_sel_hi:[1,0,1]
v_pk_fma_f32 v[166:167], v[182:183], v[254:255], v[166:167] op_sel_hi:[1,0,1]
v_cvt_pk_bf16_f32 v161, v162, v163
v_cvt_pk_bf16_f32 v154, v156, v157
v_cvt_pk_bf16_f32 v155, v158, v159
v_cvt_pk_bf16_f32 v162, v164, v165
v_cvt_pk_bf16_f32 v163, v166, v167
v_pk_max_i16 v152, v152, 0
v_pk_max_i16 v153, v153, 0
v_pk_max_i16 v154, v154, 0
v_pk_max_i16 v155, v155, 0
v_pk_max_i16 v160, v160, 0
v_pk_max_i16 v161, v161, 0
v_pk_max_i16 v162, v162, 0
v_pk_max_i16 v163, v163, 0
v_cndmask_b32_dpp v156, v160, v152, vcc quad_perm:[1,0,3,2] row_mask:0xf bank_mask:0xf
v_cndmask_b32_dpp v157, v161, v153, vcc quad_perm:[1,0,3,2] row_mask:0xf bank_mask:0xf
v_cndmask_b32_dpp v158, v162, v154, vcc quad_perm:[1,0,3,2] row_mask:0xf bank_mask:0xf
v_cndmask_b32_dpp v159, v163, v155, vcc quad_perm:[1,0,3,2] row_mask:0xf bank_mask:0xf
s_not_b64 vcc, vcc
v_cndmask_b32_dpp v160, v152, v160, vcc quad_perm:[1,0,3,2] row_mask:0xf bank_mask:0xf
v_cndmask_b32_dpp v161, v153, v161, vcc quad_perm:[1,0,3,2] row_mask:0xf bank_mask:0xf
v_cndmask_b32_dpp v162, v154, v162, vcc quad_perm:[1,0,3,2] row_mask:0xf bank_mask:0xf
v_cndmask_b32_dpp v163, v155, v163, vcc quad_perm:[1,0,3,2] row_mask:0xf bank_mask:0xf
buffer_store_dwordx4 v[156:159], v244, s[20:23], s53 offen offset:0 nt
buffer_store_dwordx4 v[160:163], v244, s[20:23], s53 offen offset:256 nt
v_max3_f32 v255, v255, v220, v252
v_max3_f32 v255, v255, v188, v254
v_max3_f32 v255, v255, v212, v240
v_mov_b32 v1, 0x53800000
v_cmp_nle_f32 vcc, v255, v1
s_lshl_b32 s52, s41, 2
s_add_u32 s52, s52, 163008
s_or_b32 s3, vcc_lo, vcc_hi
v_mov_b32 v2, s52
v_mov_b32 v3, s3
ds_write_b32 v2, v3
v_mov_b32 v2, 163008
s_waitcnt lgkmcnt(0)
s_barrier
ds_read_b128 v[4:7], v2
s_waitcnt lgkmcnt(0)
v_or_b32 v4, v4, v5
v_or3_b32 v4, v4, v6, v7
s_nop 0
v_readfirstlane_b32 s3, v4
s_nop 3
s_cmp_eq_u32 s3, 0
s_cbranch_scc0 L_fast_end
s_endpgm
L_fast_end:
s_waitcnt vmcnt(0)
s_barrier
s_mov_b32 s45, 8
s_mov_b32 s3, 64
s_mov_b32 s46, s44
s_mov_b32 s47, 0x7ff00000
s_mov_b32 s56, 50688
v_mbcnt_lo_u32_b32 v48, -1, 0
v_mbcnt_hi_u32_b32 v48, -1, v48
v_lshlrev_b32 v53, 4, v48
s_lshl_b32 s54, s41, 13
s_add_u32 s57, s54, 4096
v_and_b32 v49, 16, v48
v_lshlrev_b32 v52, 2, v49
v_lshlrev_b32 v49, 1, v49
v_xor_b32 v50, v53, v49
s_mul_i32 s49, s42, 25344
s_mul_i32 s53, s43, 1056
s_add_u32 s49, s49, s53
s_add_u32 m0, s49, 0
s_lshl_b32 s55, s43, 10
s_add_u32 s55, s55, s44
s_add_u32 s48, s55, 0
v_mov_b32 v237, 0
v_bfe_u32 v49, v48, 0, 2
v_lshl_add_u32 v237, v49, 4, v237
v_bfe_u32 v49, v48, 4, 2
v_lshl_add_u32 v237, v49, 6, v237
v_bfe_u32 v49, v48, 2, 2
v_lshl_add_u32 v237, v49, 8, v237
v_xor_b32 v51, 64, v50
s_lshl_b32 s53, s43, 14
v_mov_b32 v248, s53
v_add_u32 v248, 50688, v248
v_bfe_u32 v49, v48, 4, 2
v_lshl_add_u32 v248, v49, 10, v248
v_bfe_u32 v49, v48, 2, 2
v_lshl_add_u32 v248, v49, 7, v248
v_bfe_u32 v49, v48, 3, 1
v_lshl_add_u32 v248, v49, 5, v248
v_bfe_u32 v49, v48, 4, 1
v_lshl_add_u32 v248, v49, 6, v248
v_bfe_u32 v49, v48, 0, 2
v_lshl_add_u32 v248, v49, 3, v248
v_mov_b32 v252, s53
v_add_u32 v252, 116224, v252
v_bfe_u32 v49, v48, 4, 2
v_lshl_add_u32 v252, v49, 10, v252
v_bfe_u32 v49, v48, 2, 2
v_lshl_add_u32 v252, v49, 7, v252
v_bfe_u32 v49, v48, 3, 1
v_lshl_add_u32 v252, v49, 6, v252
v_bfe_u32 v49, v48, 0, 2
v_lshl_add_u32 v252, v49, 4, v252
s_mul_i32 s53, s42, 25344
v_bfe_u32 v49, v48, 2, 2
v_mov_b32 v236, s53
v_mul_u32_u24 v49, 1056, v49
v_add_u32 v236, v49, v236
v_bfe_u32 v49, v48, 0, 2
s_add_u32 s53, s54, 83456
v_lshl_add_u32 v236, v49, 6, v236
v_add_u32 v104, s53, v50
v_add_u32 v105, s53, v51
v_bfe_u32 v49, v48, 4, 2
s_lshl_b32 s53, s41, 12
v_lshl_add_u32 v236, v49, 4, v236
v_mov_b32 v54, s53
v_add_u32 v54, 50688, v54
v_bfe_u32 v49, v48, 3, 1
v_lshl_add_u32 v54, v49, 14, v54
v_bfe_u32 v49, v48, 4, 2
v_lshl_add_u32 v54, v49, 7, v54
v_bfe_u32 v49, v48, 2, 1
v_lshl_add_u32 v54, v49, 6, v54
v_bfe_u32 v49, v48, 5, 1
v_lshl_add_u32 v54, v49, 5, v54
v_bfe_u32 v49, v48, 0, 2
v_lshl_add_u32 v54, v49, 3, v54
s_lshl_b32 s53, s43, 7
v_mov_b32 v239, s53
v_bfe_u32 v49, v48, 0, 4
v_lshl_add_u32 v239, v49, 8, v239
s_mul_i32 s52, s41, 12288
s_add_u32 s52, s52, 101376
v_bfe_u32 v49, v48, 4, 2
v_lshl_add_u32 v239, v49, 4, v239
v_mov_b32 v241, s52
v_add_u32 v241, 8192, v241
v_bfe_u32 v49, v48, 4, 2
v_lshl_add_u32 v241, v49, 1, v241
v_bfe_u32 v49, v48, 0, 4
v_lshl_add_u32 v241, v49, 3, v241
buffer_load_dwordx4 v[152:155], v53, s[24:27], s54 offen offset:0
v_mov_b32 v240, s52
v_bfe_u32 v49, v48, 2, 2
v_lshl_add_u32 v240, v49, 7, v240
buffer_load_dwordx4 v[156:159], v53, s[24:27], s54 offen offset:1024
v_lshlrev_b32 v49, 2, v48
v_xor_b32 v49, v49, v48
v_and_b32 v49, 48, v49
buffer_load_dwordx4 v[160:163], v53, s[24:27], s54 offen offset:2048
s_lshl_b32 s53, s41, 10
v_add_u32 v240, v49, v240
v_mov_b32 v254, s53
v_add_u32 v254, 150528, v254
buffer_load_dwordx4 v[164:167], v53, s[24:27], s54 offen offset:3072
v_bfe_u32 v49, v48, 0, 6
v_mov_b32 v40, 0
v_mov_b32 v41, 0
buffer_load_dwordx4 v[168:171], v53, s[24:27], s57 offen offset:0
v_mov_b32 v42, 0
v_mov_b32 v43, 0
v_lshl_add_u32 v254, v49, 4, v254
buffer_load_dwordx4 v[172:175], v53, s[24:27], s57 offen offset:1024
ds_write_b128 v254, v[40:43] offset:0
buffer_load_dwordx4 v[176:179], v53, s[24:27], s57 offen offset:2048
ds_write_b128 v254, v[40:43] offset:256
buffer_load_dwordx4 v[180:183], v53, s[24:27], s57 offen offset:3072
buffer_load_dwordx4 v237, s[16:19], s48 offen nt lds
s_add_u32 m0, s49, 2112
s_add_u32 s48, s55, 2048
v_mov_b32 v245, s52
v_add_u32 v245, 4096, v245
buffer_load_dwordx4 v237, s[16:19], s48 offen nt lds
s_add_u32 m0, s49, 4224
s_add_u32 s48, s55, 4096
v_bfe_u32 v49, v48, 0, 2
buffer_load_dwordx4 v237, s[16:19], s48 offen nt lds
s_add_u32 m0, s49, 6336
s_add_u32 s48, s55, 6144
s_mov_b32 vcc_lo, 0x11111111
s_mov_b32 vcc_hi, 0x11111111
buffer_load_dwordx4 v237, s[16:19], s48 offen nt lds
s_add_u32 m0, s54, 50688
v_lshl_add_u32 v245, v49, 7, v245
v_mov_b32 v254, 150528
v_lshlrev_b32 v49, 4, v48
buffer_load_dwordx4 v50, s[28:31], s54 offen offset:0 lds
v_cndmask_b32 v240, v254, v240, vcc
v_xor_b32 v49, v49, v48
v_and_b32 v49, 48, v49
buffer_load_dwordx4 v51, s[28:31], s54 offen offset:1024 lds
s_mov_b32 vcc_lo, 0xf000f
s_mov_b32 vcc_hi, 0xf000f
v_add_u32 v245, v49, v245
buffer_load_dwordx4 v50, s[28:31], s54 offen offset:2048 lds
v_cndmask_b32 v242, v254, v245, vcc
s_mov_b32 vcc_lo, 0xf000f0
s_mov_b32 vcc_hi, 0xf000f0
buffer_load_dwordx4 v51, s[28:31], s54 offen offset:3072 lds
s_add_u32 m0, s57, 50688
v_cndmask_b32 v243, v254, v245, vcc
s_mov_b32 vcc_lo, 0xf000f00
s_mov_b32 vcc_hi, 0xf000f00
buffer_load_dwordx4 v50, s[28:31], s57 offen offset:0 lds
v_cndmask_b32 v244, v254, v245, vcc
s_mov_b32 vcc_lo, 0xf000f000
s_mov_b32 vcc_hi, 0xf000f000
v_mov_b32 v246, s52
buffer_load_dwordx4 v51, s[28:31], s57 offen offset:1024 lds
v_add_u32 v246, 4096, v246
v_bfe_u32 v49, v48, 0, 2
v_cndmask_b32 v245, v254, v245, vcc
buffer_load_dwordx4 v50, s[28:31], s57 offen offset:2048 lds
v_lshl_add_u32 v246, v49, 7, v246
v_mov_b32 v254, 154880
v_bfe_u32 v49, v48, 2, 2
buffer_load_dwordx4 v51, s[28:31], s57 offen offset:3072 lds
s_add_u32 m0, s49, 16896
s_mov_b32 vcc_lo, 0xf000f
s_mov_b32 vcc_hi, 0xf000f
v_lshl_add_u32 v254, v49, 3, v254
v_cndmask_b32 v246, v254, v246, vcc
v_xor_b32 v249, 32, v248
v_xor_b32 v250, 64, v248
v_xor_b32 v251, 96, v248
s_mul_i32 s4, s43, 13107200
s_add_u32 s4, s4, s44
s_add_u32 s4, s4, 24576
s_add_u32 s5, s55, 104857600
s_sub_u32 s5, s5, s4
s_add_u32 s48, s4, 0
v_xor_b32 v52, v53, v52
v_xor_b32 v55, 96, v54
v_xor_b32 v253, 64, v252
v_lshlrev_b32 v49, 4, v48
v_xor_b32 v49, v49, v48
v_and_b32 v49, 48, v49
v_add_u32 v246, v49, v246
v_add_u32 v246, v49, v246
v_mov_b32 v50, s52
v_bfe_u32 v49, v48, 0, 4
v_lshl_add_u32 v50, v49, 7, v50
v_lshlrev_b32 v49, 4, v48
v_xor_b32 v49, v49, v48
v_and_b32 v49, 48, v49
v_add_u32 v50, v49, v50
v_mov_b32 v51, s52
v_add_u32 v51, 8192, v51
v_bfe_u32 v49, v48, 4, 2
v_lshl_add_u32 v51, v49, 9, v51
v_bfe_u32 v49, v48, 0, 4
v_lshl_add_u32 v51, v49, 3, v51
s_add_u32 s50, s55, 13107200
s_mov_b32 s51, 2048
v_xor_b32 v247, 32, v48
s_mov_b32 s52, 0x7ff00000
v_lshlrev_b32 v247, 2, v247
s_waitcnt vmcnt(19)
v_and_b32 v254, 0xffff0000, v152
buffer_load_dwordx4 v237, s[16:19], s48 offen nt lds
s_add_u32 m0, s49, 19008
s_add_u32 s48, s4, 26214400
v_and_b32 v255, 0xffff0000, v153
v_lshlrev_b32 v152, 16, v152
v_lshlrev_b32 v153, 16, v153
v_mul_f32 v254, s40, v254
v_mul_f32 v152, s40, v152
v_mul_f32 v255, s40, v255
v_mul_f32 v153, s40, v153
v_cvt_pk_bf16_f32 v152, v152, v254
v_cvt_pk_bf16_f32 v153, v153, v255
v_and_b32 v254, 0xffff0000, v154
v_and_b32 v255, 0xffff0000, v155
v_lshlrev_b32 v154, 16, v154
v_lshlrev_b32 v155, 16, v155
v_mul_f32 v254, s40, v254
v_mul_f32 v154, s40, v154
v_mul_f32 v255, s40, v255
v_mul_f32 v155, s40, v155
v_cvt_pk_bf16_f32 v154, v154, v254
v_cvt_pk_bf16_f32 v155, v155, v255
s_waitcnt vmcnt(19)
v_and_b32 v254, 0xffff0000, v156
v_and_b32 v255, 0xffff0000, v157
v_lshlrev_b32 v156, 16, v156
v_lshlrev_b32 v157, 16, v157
v_mul_f32 v254, s40, v254
v_mul_f32 v156, s40, v156
v_mul_f32 v255, s40, v255
v_mul_f32 v157, s40, v157
v_cvt_pk_bf16_f32 v156, v156, v254
buffer_load_dwordx4 v237, s[16:19], s48 offen nt lds
s_add_u32 m0, s49, 21120
s_add_u32 s48, s4, 52428800
v_cvt_pk_bf16_f32 v157, v157, v255
v_and_b32 v254, 0xffff0000, v158
v_and_b32 v255, 0xffff0000, v159
v_lshlrev_b32 v158, 16, v158
v_lshlrev_b32 v159, 16, v159
v_mul_f32 v254, s40, v254
v_mul_f32 v158, s40, v158
v_mul_f32 v255, s40, v255
v_mul_f32 v159, s40, v159
v_cvt_pk_bf16_f32 v158, v158, v254
v_cvt_pk_bf16_f32 v159, v159, v255
s_waitcnt vmcnt(19)
v_and_b32 v254, 0xffff0000, v160
v_and_b32 v255, 0xffff0000, v161
v_lshlrev_b32 v160, 16, v160
v_lshlrev_b32 v161, 16, v161
v_mul_f32 v254, s40, v254
v_mul_f32 v160, s40, v160
v_mul_f32 v255, s40, v255
v_mul_f32 v161, s40, v161
v_cvt_pk_bf16_f32 v160, v160, v254
v_cvt_pk_bf16_f32 v161, v161, v255
v_and_b32 v254, 0xffff0000, v162
v_and_b32 v255, 0xffff0000, v163
v_lshlrev_b32 v162, 16, v162
v_lshlrev_b32 v163, 16, v163
v_mul_f32 v254, s40, v254
v_mul_f32 v162, s40, v162
v_mul_f32 v255, s40, v255
v_mul_f32 v163, s40, v163
v_cvt_pk_bf16_f32 v162, v162, v254
buffer_load_dwordx4 v237, s[16:19], s48 offen nt lds
s_add_u32 m0, s49, 23232
s_add_u32 s48, s4, 78643200
ds_write_b128 v104, v[152:155] offset:0
ds_write_b128 v105, v[156:159] offset:1024
v_cvt_pk_bf16_f32 v163, v163, v255
s_waitcnt vmcnt(19)
v_and_b32 v254, 0xffff0000, v164
v_and_b32 v255, 0xffff0000, v165
v_lshlrev_b32 v164, 16, v164
v_lshlrev_b32 v165, 16, v165
v_mul_f32 v254, s40, v254
v_mul_f32 v164, s40, v164
v_mul_f32 v255, s40, v255
v_mul_f32 v165, s40, v165
v_cvt_pk_bf16_f32 v164, v164, v254
v_cvt_pk_bf16_f32 v165, v165, v255
v_and_b32 v254, 0xffff0000, v166
v_and_b32 v255, 0xffff0000, v167
v_lshlrev_b32 v166, 16, v166
v_lshlrev_b32 v167, 16, v167
v_mul_f32 v254, s40, v254
buffer_load_dwordx4 v237, s[16:19], s48 offen nt lds
s_add_u32 m0, s54, 116224
s_add_u32 s48, s55, 8192
ds_write_b128 v104, v[160:163] offset:2048
v_mul_f32 v166, s40, v166
v_mul_f32 v255, s40, v255
v_mul_f32 v167, s40, v167
v_cvt_pk_bf16_f32 v166, v166, v254
v_cvt_pk_bf16_f32 v167, v167, v255
s_waitcnt vmcnt(19)
v_and_b32 v254, 0xffff0000, v168
v_and_b32 v255, 0xffff0000, v169
v_lshlrev_b32 v168, 16, v168
v_lshlrev_b32 v169, 16, v169
v_mul_f32 v254, s40, v254
v_mul_f32 v168, s40, v168
v_mul_f32 v255, s40, v255
v_mul_f32 v169, s40, v169
v_cvt_pk_bf16_f32 v168, v168, v254
v_cvt_pk_bf16_f32 v169, v169, v255
v_and_b32 v254, 0xffff0000, v170
v_and_b32 v255, 0xffff0000, v171
v_lshlrev_b32 v170, 16, v170
v_lshlrev_b32 v171, 16, v171
v_mul_f32 v254, s40, v254
v_mul_f32 v170, s40, v170
v_mul_f32 v255, s40, v255
v_mul_f32 v171, s40, v171
buffer_load_dwordx4 v52, s[32:35], s54 offen offset:0 lds
ds_write_b128 v105, v[164:167] offset:3072
v_cvt_pk_bf16_f32 v170, v170, v254
v_cvt_pk_bf16_f32 v171, v171, v255
s_waitcnt vmcnt(19)
v_and_b32 v254, 0xffff0000, v172
v_and_b32 v255, 0xffff0000, v173
v_lshlrev_b32 v172, 16, v172
v_lshlrev_b32 v173, 16, v173
v_mul_f32 v254, s40, v254
v_mul_f32 v172, s40, v172
v_mul_f32 v255, s40, v255
v_mul_f32 v173, s40, v173
v_cvt_pk_bf16_f32 v172, v172, v254
v_cvt_pk_bf16_f32 v173, v173, v255
v_and_b32 v254, 0xffff0000, v174
v_and_b32 v255, 0xffff0000, v175
v_lshlrev_b32 v174, 16, v174
v_lshlrev_b32 v175, 16, v175
v_mul_f32 v254, s40, v254
v_mul_f32 v174, s40, v174
v_mul_f32 v255, s40, v255
v_mul_f32 v175, s40, v175
v_cvt_pk_bf16_f32 v174, v174, v254
v_cvt_pk_bf16_f32 v175, v175, v255
s_waitcnt vmcnt(18)
v_and_b32 v254, 0xffff0000, v176
v_and_b32 v255, 0xffff0000, v177
v_lshlrev_b32 v176, 16, v176
buffer_load_dwordx4 v52, s[32:35], s54 offen offset:1024 lds
ds_write_b128 v104, v[168:171] offset:4096
v_lshlrev_b32 v177, 16, v177
v_mul_f32 v254, s40, v254
v_mul_f32 v176, s40, v176
v_mul_f32 v255, s40, v255
v_mul_f32 v177, s40, v177
v_cvt_pk_bf16_f32 v176, v176, v254
v_cvt_pk_bf16_f32 v177, v177, v255
v_and_b32 v254, 0xffff0000, v178
v_and_b32 v255, 0xffff0000, v179
v_lshlrev_b32 v178, 16, v178
v_lshlrev_b32 v179, 16, v179
v_mul_f32 v254, s40, v254
v_mul_f32 v178, s40, v178
v_mul_f32 v255, s40, v255
v_mul_f32 v179, s40, v179
v_cvt_pk_bf16_f32 v178, v178, v254
v_cvt_pk_bf16_f32 v179, v179, v255
s_waitcnt vmcnt(18)
v_and_b32 v254, 0xffff0000, v180
v_and_b32 v255, 0xffff0000, v181
v_lshlrev_b32 v180, 16, v180
v_lshlrev_b32 v181, 16, v181
v_mul_f32 v254, s40, v254
v_mul_f32 v180, s40, v180
v_mul_f32 v255, s40, v255
v_mul_f32 v181, s40, v181
buffer_load_dwordx4 v52, s[32:35], s54 offen offset:2048 lds
ds_write_b128 v105, v[172:175] offset:5120
ds_write_b128 v104, v[176:179] offset:6144
v_cvt_pk_bf16_f32 v180, v180, v254
v_cvt_pk_bf16_f32 v181, v181, v255
v_and_b32 v254, 0xffff0000, v182
v_and_b32 v255, 0xffff0000, v183
v_lshlrev_b32 v182, 16, v182
v_lshlrev_b32 v183, 16, v183
v_mul_f32 v254, s40, v254
v_mul_f32 v182, s40, v182
v_mul_f32 v255, s40, v255
v_mul_f32 v183, s40, v183
v_cvt_pk_bf16_f32 v182, v182, v254
v_cvt_pk_bf16_f32 v183, v183, v255
ds_write_b128 v105, v[180:183] offset:7168
buffer_load_dwordx4 v52, s[32:35], s54 offen offset:3072 lds
s_add_u32 m0, s57, 116224
v_xor_b32 v254, 32, v54
v_xor_b32 v255, 64, v54
s_mov_b32 s53, 0x7ff00000
buffer_load_dwordx4 v52, s[32:35], s57 offen offset:0 lds
buffer_load_dwordx4 v52, s[32:35], s57 offen offset:1024 lds
s_waitcnt vmcnt(10) lgkmcnt(0)
s_barrier
ds_read_b64_tr_b16 a[64:65], v248 offset:0
ds_read_b64_tr_b16 a[66:67], v248 offset:512
ds_read_b128 v[188:191], v236 offset:0
ds_read_b64_tr_b16 a[68:69], v248 offset:4096
ds_read_b64_tr_b16 a[70:71], v248 offset:4608
buffer_load_dwordx4 v52, s[32:35], s57 offen offset:2048 lds
ds_read_b128 v[196:199], v236 offset:256
ds_read_b64_tr_b16 a[72:73], v248 offset:8192
ds_read_b64_tr_b16 a[74:75], v248 offset:8704
ds_read_b128 v[200:203], v236 offset:512
ds_read_b64_tr_b16 a[76:77], v248 offset:12288
ds_read_b64_tr_b16 a[78:79], v248 offset:12800
ds_read_b128 v[204:207], v236 offset:768
ds_read_b64_tr_b16 a[92:93], v249 offset:12288
ds_read_b64_tr_b16 a[94:95], v249 offset:12800
ds_read_b64_tr_b16 a[88:89], v249 offset:8192
ds_read_b64_tr_b16 a[90:91], v249 offset:8704
ds_read_b64_tr_b16 a[84:85], v249 offset:4096
ds_read_b64_tr_b16 a[86:87], v249 offset:4608
ds_read_b64_tr_b16 a[80:81], v249 offset:0
ds_read_b64_tr_b16 a[82:83], v249 offset:512
s_waitcnt lgkmcnt(15)
v_mfma_f32_16x16x32_bf16 v[192:195], a[64:67], v[188:191], 0
ds_read_b64_tr_b16 a[96:97], v250 offset:0
ds_read_b64_tr_b16 a[98:99], v250 offset:512
s_waitcnt lgkmcnt(15)
v_mfma_f32_16x16x32_bf16 v[192:195], a[68:71], v[196:199], v[192:195]
s_waitcnt lgkmcnt(14)
ds_read_b64_tr_b16 a[100:101], v250 offset:4096
s_waitcnt lgkmcnt(14)
v_mfma_f32_16x16x32_bf16 v[192:195], a[72:75], v[200:203], v[192:195]
s_waitcnt lgkmcnt(11)
ds_read_b64_tr_b16 a[102:103], v250 offset:4608
ds_read_b64_tr_b16 a[104:105], v250 offset:8192
v_mfma_f32_16x16x32_bf16 v[192:195], a[76:79], v[204:207], v[192:195]
s_waitcnt lgkmcnt(9)
ds_read_b64_tr_b16 a[106:107], v250 offset:8704
ds_read_b64_tr_b16 a[108:109], v250 offset:12288
v_mfma_f32_16x16x32_bf16 v[208:211], a[92:95], v[204:207], 0
s_waitcnt lgkmcnt(7)
buffer_load_dwordx4 v52, s[32:35], s57 offen offset:3072 lds
s_add_u32 m0, s49, 8448
v_mfma_f32_16x16x32_bf16 v[208:211], a[88:91], v[200:203], v[208:211]
ds_read_b64_tr_b16 a[110:111], v250 offset:12800
v_cvt_pk_bf16_f32 v0, v192, v193
v_mfma_f32_16x16x32_bf16 v[208:211], a[84:87], v[196:199], v[208:211]
s_waitcnt lgkmcnt(6)
ds_read_b64_tr_b16 a[124:125], v251 offset:12288
v_cvt_pk_bf16_f32 v1, v194, v195
v_mfma_f32_16x16x32_bf16 v[208:211], a[80:83], v[188:191], v[208:211]
s_waitcnt lgkmcnt(6)
ds_read_b64_tr_b16 a[126:127], v251 offset:12800
ds_read_b64_tr_b16 a[120:121], v251 offset:8192
v_mfma_f32_16x16x32_bf16 v[192:195], a[96:99], v[188:191], 0
s_waitcnt lgkmcnt(6)
ds_read_b64_tr_b16 a[122:123], v251 offset:8704
ds_read_b64_tr_b16 a[116:117], v251 offset:4096
v_mfma_f32_16x16x32_bf16 v[192:195], a[100:103], v[196:199], v[192:195]
s_waitcnt lgkmcnt(6)
ds_read_b64_tr_b16 a[118:119], v251 offset:4608
v_cvt_pk_bf16_f32 v2, v208, v209
v_mfma_f32_16x16x32_bf16 v[192:195], a[104:107], v[200:203], v[192:195]
ds_read_b64_tr_b16 a[112:113], v251 offset:0
s_waitcnt lgkmcnt(7)
v_mfma_f32_16x16x32_bf16 v[192:195], a[108:111], v[204:207], v[192:195]
ds_read_b64_tr_b16 a[114:115], v251 offset:512
v_cvt_pk_bf16_f32 v3, v210, v211
ds_read_b128 v[184:187], v236 offset:4992
s_waitcnt lgkmcnt(7)
v_mfma_f32_16x16x32_bf16 v[208:211], a[124:127], v[204:207], 0
s_waitcnt lgkmcnt(6)
buffer_load_dwordx4 v[120:123], v53, s[36:39], s54 offen offset:0
s_waitcnt lgkmcnt(5)
v_mfma_f32_16x16x32_bf16 v[208:211], a[120:123], v[200:203], v[208:211]
s_waitcnt lgkmcnt(4)
ds_read_b128 v[216:219], v236 offset:4736
s_waitcnt lgkmcnt(4)
v_mfma_f32_16x16x32_bf16 v[208:211], a[116:119], v[196:199], v[208:211]
ds_read_b128 v[204:207], v236 offset:4480
v_cvt_pk_bf16_f32 v5, v194, v195
v_cvt_pk_bf16_f32 v4, v192, v193
s_waitcnt lgkmcnt(3)
v_mfma_f32_16x16x32_bf16 v[208:211], a[112:115], v[188:191], v[208:211]
ds_read_b128 v[192:195], v236 offset:4224
s_waitcnt lgkmcnt(3)
v_mfma_f32_16x16x32_bf16 v[200:203], a[124:127], v[184:187], 0
ds_read_b64_tr_b16 a[0:1], v248 offset:32768
ds_read_b64_tr_b16 a[2:3], v248 offset:33280
v_mfma_f32_16x16x32_bf16 v[220:223], a[92:95], v[184:187], 0
ds_read_b64_tr_b16 a[4:5], v248 offset:36864
s_waitcnt lgkmcnt(5)
v_mfma_f32_16x16x32_bf16 v[200:203], a[120:123], v[216:219], v[200:203]
ds_read_b64_tr_b16 a[6:7], v248 offset:37376
s_waitcnt lgkmcnt(5)
v_mfma_f32_16x16x32_bf16 v[200:203], a[116:119], v[204:207], v[200:203]
ds_read_b64_tr_b16 a[8:9], v248 offset:40960
v_cvt_pk_bf16_f32 v6, v208, v209
v_mfma_f32_16x16x32_bf16 v[220:223], a[88:91], v[216:219], v[220:223]
buffer_load_dwordx4 v[124:127], v53, s[36:39], s54 offen offset:1024
s_waitcnt lgkmcnt(5)
v_mfma_f32_16x16x32_bf16 v[200:203], a[112:115], v[192:195], v[200:203]
ds_read_b64_tr_b16 a[10:11], v248 offset:41472
v_cvt_pk_bf16_f32 v7, v210, v211
v_mfma_f32_16x16x32_bf16 v[208:211], a[96:99], v[192:195], 0
s_waitcnt lgkmcnt(4)
ds_read_b64_tr_b16 a[12:13], v248 offset:45056
ds_read_b64_tr_b16 a[14:15], v248 offset:45568
v_mfma_f32_16x16x32_bf16 v[208:211], a[100:103], v[204:207], v[208:211]
s_waitcnt lgkmcnt(5)
ds_read_b64_tr_b16 a[16:17], v249 offset:32768
ds_read_b64_tr_b16 a[18:19], v249 offset:33280
v_mfma_f32_16x16x32_bf16 v[208:211], a[104:107], v[216:219], v[208:211]
s_waitcnt lgkmcnt(6)
ds_read_b64_tr_b16 a[20:21], v249 offset:36864
ds_read_b64_tr_b16 a[22:23], v249 offset:37376
v_mfma_f32_16x16x32_bf16 v[208:211], a[108:111], v[184:187], v[208:211]
s_waitcnt lgkmcnt(7)
ds_read_b64_tr_b16 a[24:25], v249 offset:40960
ds_read_b64_tr_b16 a[26:27], v249 offset:41472
v_mfma_f32_16x16x32_bf16 v[220:223], a[84:87], v[204:207], v[220:223]
ds_read_b64_tr_b16 a[28:29], v249 offset:45056
ds_read_b64_tr_b16 a[30:31], v249 offset:45568
v_mfma_f32_16x16x32_bf16 v[220:223], a[80:83], v[192:195], v[220:223]
s_waitcnt lgkmcnt(10)
ds_read_b64_tr_b16 a[32:33], v250 offset:32768
ds_read_b64_tr_b16 a[34:35], v250 offset:33280
v_mfma_f32_16x16x32_bf16 v[188:191], a[64:67], v[192:195], 0
s_waitcnt lgkmcnt(10)
ds_read_b64_tr_b16 a[36:37], v250 offset:36864
ds_read_b64_tr_b16 a[38:39], v250 offset:37376
v_mfma_f32_16x16x32_bf16 v[188:191], a[72:75], v[216:219], v[188:191]
s_waitcnt lgkmcnt(10)
buffer_load_dwordx4 v[128:131], v53, s[36:39], s54 offen offset:2048
ds_read_b64_tr_b16 a[40:41], v250 offset:40960
v_mfma_f32_16x16x32_bf16 v[188:191], a[76:79], v[184:187], v[188:191]
s_waitcnt lgkmcnt(9)
ds_read_b64_tr_b16 a[42:43], v250 offset:41472
ds_read_b64_tr_b16 a[44:45], v250 offset:45056
v_mfma_f32_16x16x32_bf16 v[188:191], a[68:71], v[204:207], v[188:191]
s_waitcnt lgkmcnt(9)
ds_read_b64_tr_b16 a[46:47], v250 offset:45568
ds_read_b64_tr_b16 a[48:49], v251 offset:32768
ds_read_b64_tr_b16 a[50:51], v251 offset:33280
ds_read_b64_tr_b16 a[52:53], v251 offset:36864
ds_read_b64_tr_b16 a[54:55], v251 offset:37376
ds_read_b64_tr_b16 a[56:57], v251 offset:40960
ds_read_b64_tr_b16 a[58:59], v251 offset:41472
s_waitcnt vmcnt(11)
s_barrier
ds_read_b128 v[56:59], v236 offset:16896
ds_read_b128 v[60:63], v236 offset:17152
ds_read_b128 v[64:67], v236 offset:17408
ds_read_b128 v[68:71], v236 offset:17664
ds_read_b128 v[72:75], v236 offset:21120
ds_read_b128 v[76:79], v236 offset:21376
ds_read_b128 v[80:83], v236 offset:21632
ds_read_b128 v[84:87], v236 offset:21888
ds_read_b64_tr_b16 a[60:61], v251 offset:45056
ds_read_b64_tr_b16 a[62:63], v251 offset:45568
v_cvt_pk_bf16_f32 v14, v200, v201
buffer_load_dwordx4 v[132:135], v53, s[36:39], s54 offen offset:3072
v_cvt_pk_bf16_f32 v15, v202, v203
v_cvt_pk_bf16_f32 v9, v190, v191
v_cvt_pk_bf16_f32 v8, v188, v189
v_cvt_pk_bf16_f32 v13, v210, v211
v_cvt_pk_bf16_f32 v12, v208, v209
v_cvt_pk_bf16_f32 v10, v220, v221
v_cvt_pk_bf16_f32 v11, v222, v223
s_waitcnt lgkmcnt(9)
v_mfma_f32_16x16x32_bf16 v[156:159], a[64:67], v[56:59], 0
s_waitcnt lgkmcnt(7)
v_mfma_f32_16x16x32_bf16 v[156:159], a[68:71], v[60:63], v[156:159]
s_waitcnt lgkmcnt(3)
v_mfma_f32_16x16x32_bf16 v[156:159], a[72:75], v[64:67], v[156:159]
s_waitcnt lgkmcnt(0)
v_mfma_f32_16x16x32_bf16 v[156:159], a[76:79], v[68:71], v[156:159]
s_nop 2
v_mfma_f32_16x16x32_bf16 v[160:163], a[92:95], v[68:71], 0
s_nop 2
v_mfma_f32_16x16x32_bf16 v[160:163], a[88:91], v[64:67], v[160:163]
s_waitcnt vmcnt(4)
s_barrier
v_mfma_f32_16x16x32_bf16 v[160:163], a[84:87], v[60:63], v[160:163]
buffer_load_dwordx4 v[136:139], v53, s[36:39], s57 offen offset:0
ds_read_b64_tr_b16 a[128:129], v252 offset:0
v_mfma_f32_16x16x32_bf16 v[160:163], a[80:83], v[56:59], v[160:163]
ds_read_b64_tr_b16 a[130:131], v252 offset:512
ds_read_b64_tr_b16 a[132:133], v252 offset:4096
v_mfma_f32_16x16x32_bf16 v[164:167], a[96:99], v[56:59], 0
ds_read_b64_tr_b16 a[134:135], v252 offset:4608
ds_read_b64_tr_b16 a[136:137], v252 offset:8192
v_mfma_f32_16x16x32_bf16 v[164:167], a[100:103], v[60:63], v[164:167]
ds_read_b64_tr_b16 a[138:139], v252 offset:8704
ds_read_b64_tr_b16 a[140:141], v252 offset:12288
v_mfma_f32_16x16x32_bf16 v[164:167], a[104:107], v[64:67], v[164:167]
ds_read_b64_tr_b16 a[142:143], v252 offset:12800
ds_read_b64_tr_b16 a[144:145], v252 offset:8
v_mfma_f32_16x16x32_bf16 v[164:167], a[108:111], v[68:71], v[164:167]
ds_read_b64_tr_b16 a[146:147], v252 offset:520
ds_read_b64_tr_b16 a[148:149], v252 offset:4104
v_mfma_f32_16x16x32_bf16 v[168:171], a[124:127], v[68:71], 0
s_waitcnt lgkmcnt(10)
ds_read_b64_tr_b16 a[150:151], v252 offset:4616
v_cvt_pk_bf16_f32 v88, v156, v157
v_mfma_f32_16x16x32_bf16 v[168:171], a[120:123], v[64:67], v[168:171]
s_waitcnt lgkmcnt(9)
ds_read_b64_tr_b16 a[152:153], v252 offset:8200
v_cvt_pk_bf16_f32 v89, v158, v159
v_mfma_f32_16x16x32_bf16 v[168:171], a[116:119], v[60:63], v[168:171]
s_waitcnt lgkmcnt(8)
ds_read_b64_tr_b16 a[154:155], v252 offset:8712
ds_read_b64_tr_b16 a[156:157], v252 offset:12296
v_mfma_f32_16x16x32_bf16 v[168:171], a[112:115], v[56:59], v[168:171]
s_waitcnt lgkmcnt(8)
buffer_load_dwordx4 v[140:143], v53, s[36:39], s57 offen offset:1024
ds_read_b64_tr_b16 a[158:159], v252 offset:12808
v_mfma_f32_16x16x32_bf16 v[172:175], a[64:67], v[72:75], 0
s_waitcnt lgkmcnt(7)
ds_read_b64_tr_b16 a[160:161], v253 offset:0
v_cvt_pk_bf16_f32 v90, v160, v161
v_mfma_f32_16x16x32_bf16 v[172:175], a[68:71], v[76:79], v[172:175]
s_waitcnt lgkmcnt(6)
ds_read_b64_tr_b16 a[162:163], v253 offset:512
v_cvt_pk_bf16_f32 v91, v162, v163
v_mfma_f32_16x16x32_bf16 v[172:175], a[72:75], v[80:83], v[172:175]
s_waitcnt lgkmcnt(6)
ds_read_b64_tr_b16 a[164:165], v253 offset:4096
ds_read_b64_tr_b16 a[166:167], v253 offset:4608
v_mfma_f32_16x16x32_bf16 v[172:175], a[76:79], v[84:87], v[172:175]
s_waitcnt lgkmcnt(7)
ds_read_b64_tr_b16 a[168:169], v253 offset:8192
ds_read_b64_tr_b16 a[170:171], v253 offset:8704
v_mfma_f32_16x16x32_bf16 v[176:179], a[92:95], v[84:87], 0
s_waitcnt lgkmcnt(7)
ds_read_b64_tr_b16 a[172:173], v253 offset:12288
v_cvt_pk_bf16_f32 v92, v164, v165
v_mfma_f32_16x16x32_bf16 v[176:179], a[88:91], v[80:83], v[176:179]
s_waitcnt lgkmcnt(7)
ds_read_b64_tr_b16 a[174:175], v253 offset:12800
v_cvt_pk_bf16_f32 v93, v166, v167
v_mfma_f32_16x16x32_bf16 v[176:179], a[84:87], v[76:79], v[176:179]
s_waitcnt lgkmcnt(7)
ds_read_b64_tr_b16 a[176:177], v253 offset:8
ds_read_b64_tr_b16 a[178:179], v253 offset:520
v_mfma_f32_16x16x32_bf16 v[176:179], a[80:83], v[72:75], v[176:179]
s_waitcnt lgkmcnt(8)
ds_read_b64_tr_b16 a[180:181], v253 offset:4104
ds_read_b64_tr_b16 a[182:183], v253 offset:4616
v_mfma_f32_16x16x32_bf16 v[180:183], a[96:99], v[72:75], 0
s_waitcnt lgkmcnt(8)
buffer_load_dwordx4 v[144:147], v53, s[36:39], s57 offen offset:2048
v_cvt_pk_bf16_f32 v94, v168, v169
v_mfma_f32_16x16x32_bf16 v[180:183], a[100:103], v[76:79], v[180:183]
s_waitcnt lgkmcnt(6)
ds_read_b64_tr_b16 a[184:185], v253 offset:8200
v_cvt_pk_bf16_f32 v95, v170, v171
v_mfma_f32_16x16x32_bf16 v[180:183], a[104:107], v[80:83], v[180:183]
s_waitcnt lgkmcnt(6)
ds_read_b64_tr_b16 a[186:187], v253 offset:8712
ds_read_b64_tr_b16 a[188:189], v253 offset:12296
v_mfma_f32_16x16x32_bf16 v[180:183], a[108:111], v[84:87], v[180:183]
s_waitcnt lgkmcnt(7)
ds_read_b64_tr_b16 a[190:191], v253 offset:12808
v_cvt_pk_bf16_f32 v96, v172, v173
v_mfma_f32_16x16x32_bf16 v[152:155], a[124:127], v[84:87], 0
s_waitcnt lgkmcnt(6)
v_cvt_pk_bf16_f32 v97, v174, v175
v_cvt_pk_bf16_f32 v98, v176, v177
v_mfma_f32_16x16x32_bf16 v[152:155], a[120:123], v[80:83], v[152:155]
s_waitcnt lgkmcnt(4)
v_cvt_pk_bf16_f32 v99, v178, v179
v_cvt_pk_bf16_f32 v100, v180, v181
v_mfma_f32_16x16x32_bf16 v[152:155], a[116:119], v[76:79], v[152:155]
v_cvt_pk_bf16_f32 v101, v182, v183
v_mov_b32 v253, 0
v_mfma_f32_16x16x32_bf16 v[152:155], a[112:115], v[72:75], v[152:155]
s_waitcnt lgkmcnt(3)
v_mov_b32 v252, 1.0
s_nop 0
v_mfma_f32_16x16x32_bf16 v[156:159], a[0:3], v[56:59], 0
s_waitcnt lgkmcnt(1)
s_nop 1
v_mfma_f32_16x16x32_bf16 v[156:159], a[4:7], v[60:63], v[156:159]
s_waitcnt lgkmcnt(0)
buffer_load_dwordx4 v[148:151], v53, s[36:39], s57 offen offset:3072
v_cvt_pk_bf16_f32 v102, v152, v153
v_mfma_f32_16x16x32_bf16 v[156:159], a[8:11], v[64:67], v[156:159]
v_cvt_pk_bf16_f32 v103, v154, v155
v_mfma_f32_16x16x32_bf16 v[156:159], a[12:15], v[68:71], v[156:159]
s_nop 2
v_mfma_f32_16x16x32_bf16 v[160:163], a[28:31], v[68:71], 0
s_nop 2
v_mfma_f32_16x16x32_bf16 v[160:163], a[24:27], v[64:67], v[160:163]
v_cvt_pk_bf16_f32 v104, v156, v157
v_cvt_pk_bf16_f32 v105, v158, v159
v_mfma_f32_16x16x32_bf16 v[160:163], a[20:23], v[60:63], v[160:163]
v_mfma_f32_16x16x32_bf16 v[160:163], a[16:19], v[56:59], v[160:163]
s_nop 2
v_mfma_f32_16x16x32_bf16 v[164:167], a[32:35], v[56:59], 0
s_nop 2
v_mfma_f32_16x16x32_bf16 v[164:167], a[36:39], v[60:63], v[164:167]
v_cvt_pk_bf16_f32 v106, v160, v161
v_cvt_pk_bf16_f32 v107, v162, v163
v_mfma_f32_16x16x32_bf16 v[164:167], a[40:43], v[64:67], v[164:167]
buffer_load_dwordx4 v237, s[16:19], s48 offen nt lds
s_add_u32 m0, s49, 10560
v_mfma_f32_16x16x32_bf16 v[164:167], a[44:47], v[68:71], v[164:167]
s_add_u32 s48, s55, 10240
s_nop 1
v_mfma_f32_16x16x32_bf16 v[168:171], a[60:63], v[68:71], 0
s_nop 2
v_mfma_f32_16x16x32_bf16 v[168:171], a[56:59], v[64:67], v[168:171]
v_cvt_pk_bf16_f32 v108, v164, v165
v_cvt_pk_bf16_f32 v109, v166, v167
v_mfma_f32_16x16x32_bf16 v[168:171], a[52:55], v[60:63], v[168:171]
v_mfma_f32_16x16x32_bf16 v[168:171], a[48:51], v[56:59], v[168:171]
s_nop 2
v_mfma_f32_16x16x32_bf16 v[172:175], a[0:3], v[72:75], 0
s_waitcnt vmcnt(8)
ds_write_b64 v54, v[120:121] offset:0
v_mfma_f32_16x16x32_bf16 v[172:175], a[4:7], v[76:79], v[172:175]
ds_write_b64 v254, v[122:123] offset:0
v_mfma_f32_16x16x32_bf16 v[172:175], a[8:11], v[80:83], v[172:175]
buffer_load_dwordx4 v237, s[16:19], s48 offen nt lds
v_mfma_f32_16x16x32_bf16 v[172:175], a[12:15], v[84:87], v[172:175]
s_add_u32 m0, s49, 12672
s_add_u32 s48, s55, 12288
v_cvt_pk_bf16_f32 v110, v168, v169
v_mfma_f32_16x16x32_bf16 v[176:179], a[28:31], v[84:87], 0
s_waitcnt vmcnt(8)
ds_write_b64 v54, v[124:125] offset:512
v_mfma_f32_16x16x32_bf16 v[176:179], a[24:27], v[80:83], v[176:179]
ds_write_b64 v254, v[126:127] offset:512
v_mfma_f32_16x16x32_bf16 v[176:179], a[20:23], v[76:79], v[176:179]
s_waitcnt vmcnt(7)
ds_write_b64 v255, v[128:129] offset:1024
v_mfma_f32_16x16x32_bf16 v[176:179], a[16:19], v[72:75], v[176:179]
ds_write_b64 v55, v[130:131] offset:1024
v_mfma_f32_16x16x32_bf16 v[180:183], a[32:35], v[72:75], 0
s_waitcnt vmcnt(6)
ds_write_b64 v255, v[132:133] offset:1536
v_mfma_f32_16x16x32_bf16 v[180:183], a[36:39], v[76:79], v[180:183]
ds_write_b64 v55, v[134:135] offset:1536
v_mfma_f32_16x16x32_bf16 v[180:183], a[40:43], v[80:83], v[180:183]
buffer_load_dwordx4 v237, s[16:19], s48 offen nt lds
s_add_u32 m0, s49, 14784
v_mfma_f32_16x16x32_bf16 v[180:183], a[44:47], v[84:87], v[180:183]
s_add_u32 s48, s55, 14336
v_cvt_pk_bf16_f32 v111, v170, v171
v_cvt_pk_bf16_f32 v112, v172, v173
v_mfma_f32_16x16x32_bf16 v[152:155], a[60:63], v[84:87], 0
s_waitcnt vmcnt(6)
ds_write_b64 v54, v[136:137] offset:2048
v_mfma_f32_16x16x32_bf16 v[152:155], a[56:59], v[80:83], v[152:155]
ds_write_b64 v254, v[138:139] offset:2048
v_mfma_f32_16x16x32_bf16 v[152:155], a[52:55], v[76:79], v[152:155]
s_waitcnt vmcnt(5)
ds_write_b64 v54, v[140:141] offset:2560
v_mfma_f32_16x16x32_bf16 v[152:155], a[48:51], v[72:75], v[152:155]
ds_write_b64 v254, v[142:143] offset:2560
v_mfma_f32_16x16x32_bf16 v[156:159], v[56:59], a[128:131], 0
s_waitcnt vmcnt(4)
ds_write_b64 v255, v[144:145] offset:3072
v_mfma_f32_16x16x32_bf16 v[156:159], v[60:63], a[132:135], v[156:159]
ds_write_b64 v55, v[146:147] offset:3072
v_mfma_f32_16x16x32_bf16 v[156:159], v[64:67], a[136:139], v[156:159]
buffer_load_dwordx4 v237, s[16:19], s48 offen nt lds
s_add_u32 m0, s49, 16896
v_mfma_f32_16x16x32_bf16 v[156:159], v[68:71], a[140:143], v[156:159]
s_add_u32 s48, s55, 16384
buffer_load_dwordx4 v237, s[16:19], s48 offen nt lds
s_add_u32 m0, s49, 19008
v_mfma_f32_16x16x32_bf16 v[160:163], v[68:71], a[156:159], 0
s_add_u32 s48, s55, 18432
buffer_load_dwordx4 v237, s[16:19], s48 offen nt lds
s_add_u32 m0, s49, 21120
v_mfma_f32_16x16x32_bf16 v[160:163], v[64:67], a[152:155], v[160:163]
s_add_u32 s48, s55, 20480
buffer_load_dwordx4 v237, s[16:19], s48 offen nt lds
s_add_u32 m0, s49, 23232
v_mfma_f32_16x16x32_bf16 v[160:163], v[60:63], a[148:151], v[160:163]
s_add_u32 s48, s55, 22528
buffer_load_dwordx4 v237, s[16:19], s48 offen nt lds
v_cvt_pk_bf16_f32 v113, v174, v175
v_mfma_f32_16x16x32_bf16 v[160:163], v[56:59], a[144:147], v[160:163]
s_add_u32 s49, s49, 50688
v_cvt_pk_bf16_f32 v114, v176, v177
v_cvt_pk_bf16_f32 v115, v178, v179
v_mfma_f32_16x16x32_bf16 v[164:167], v[56:59], a[160:163], 0
s_waitcnt vmcnt(8)
ds_write_b64 v255, v[148:149] offset:3584
v_mfma_f32_16x16x32_bf16 v[164:167], v[60:63], a[164:167], v[164:167]
ds_write_b64 v55, v[150:151] offset:3584
v_mfma_f32_16x16x32_bf16 v[164:167], v[64:67], a[168:171], v[164:167]
v_cvt_pk_bf16_f32 v116, v180, v181
v_cvt_pk_bf16_f32 v117, v182, v183
v_mfma_f32_16x16x32_bf16 v[164:167], v[68:71], a[172:175], v[164:167]
v_cvt_pk_bf16_f32 v118, v152, v153
v_cvt_pk_bf16_f32 v119, v154, v155
v_mfma_f32_16x16x32_bf16 v[168:171], v[68:71], a[188:191], 0
v_cvt_pk_bf16_f32 v156, v156, v157
v_cvt_pk_bf16_f32 v157, v158, v159
v_mfma_f32_16x16x32_bf16 v[168:171], v[64:67], a[184:187], v[168:171]
v_cvt_pk_bf16_f32 v160, v160, v161
v_cvt_pk_bf16_f32 v161, v162, v163
v_mfma_f32_16x16x32_bf16 v[168:171], v[60:63], a[180:183], v[168:171]
s_waitcnt lgkmcnt(0)
s_barrier
v_mfma_f32_16x16x32_bf16 v[168:171], v[56:59], a[176:179], v[168:171]
ds_read_b64_tr_b16 a[192:193], v248 offset:0
ds_read_b64_tr_b16 a[194:195], v248 offset:512
v_mfma_f32_16x16x32_bf16 v[172:175], v[72:75], a[128:131], 0
ds_read_b64_tr_b16 a[196:197], v248 offset:4096
ds_read_b64_tr_b16 a[198:199], v248 offset:4608
v_mfma_f32_16x16x32_bf16 v[172:175], v[76:79], a[132:135], v[172:175]
ds_read_b64_tr_b16 a[200:201], v248 offset:8192
ds_read_b64_tr_b16 a[202:203], v248 offset:8704
v_mfma_f32_16x16x32_bf16 v[172:175], v[80:83], a[136:139], v[172:175]
ds_read_b64_tr_b16 a[204:205], v248 offset:12288
ds_read_b64_tr_b16 a[206:207], v248 offset:12800
v_mfma_f32_16x16x32_bf16 v[172:175], v[84:87], a[140:143], v[172:175]
ds_read_b64_tr_b16 a[208:209], v249 offset:0
ds_read_b64_tr_b16 a[210:211], v249 offset:512
v_mfma_f32_16x16x32_bf16 v[176:179], v[84:87], a[156:159], 0
ds_read_b64_tr_b16 a[212:213], v249 offset:4096
ds_read_b64_tr_b16 a[214:215], v249 offset:4608
v_mfma_f32_16x16x32_bf16 v[176:179], v[80:83], a[152:155], v[176:179]
s_waitcnt lgkmcnt(10)
ds_read_b64_tr_b16 a[216:217], v249 offset:8192
ds_read_b64_tr_b16 a[218:219], v249 offset:8704
v_mfma_f32_16x16x32_bf16 v[176:179], v[76:79], a[148:151], v[176:179]
s_waitcnt lgkmcnt(10)
ds_read_b64_tr_b16 a[220:221], v249 offset:12288
ds_read_b64_tr_b16 a[222:223], v249 offset:12800
v_mfma_f32_16x16x32_bf16 v[176:179], v[72:75], a[144:147], v[176:179]
s_waitcnt lgkmcnt(10)
ds_read_b64_tr_b16 a[224:225], v250 offset:0
ds_read_b64_tr_b16 a[226:227], v250 offset:512
v_mfma_f32_16x16x32_bf16 v[180:183], v[72:75], a[160:163], 0
s_waitcnt lgkmcnt(10)
ds_read_b64_tr_b16 a[228:229], v250 offset:4096
ds_read_b64_tr_b16 a[230:231], v250 offset:4608
v_mfma_f32_16x16x32_bf16 v[180:183], v[76:79], a[164:167], v[180:183]
s_waitcnt lgkmcnt(10)
ds_read_b64_tr_b16 a[232:233], v250 offset:8192
ds_read_b64_tr_b16 a[234:235], v250 offset:8704
v_mfma_f32_16x16x32_bf16 v[180:183], v[80:83], a[168:171], v[180:183]
s_waitcnt lgkmcnt(10)
ds_read_b64_tr_b16 a[236:237], v250 offset:12288
ds_read_b64_tr_b16 a[238:239], v250 offset:12800
v_mfma_f32_16x16x32_bf16 v[180:183], v[84:87], a[172:175], v[180:183]
s_waitcnt lgkmcnt(10)
ds_read_b64_tr_b16 a[240:241], v251 offset:0
ds_read_b64_tr_b16 a[242:243], v251 offset:512
v_mfma_f32_16x16x32_bf16 v[152:155], v[84:87], a[188:191], 0
s_waitcnt lgkmcnt(10)
ds_read_b64_tr_b16 a[244:245], v251 offset:4096
ds_read_b64_tr_b16 a[246:247], v251 offset:4608
v_mfma_f32_16x16x32_bf16 v[152:155], v[80:83], a[184:187], v[152:155]
s_waitcnt lgkmcnt(10)
ds_read_b64_tr_b16 a[248:249], v251 offset:8192
ds_read_b64_tr_b16 a[250:251], v251 offset:8704
v_mfma_f32_16x16x32_bf16 v[152:155], v[76:79], a[180:183], v[152:155]
s_waitcnt lgkmcnt(10)
ds_read_b64_tr_b16 a[252:253], v251 offset:12288
ds_read_b64_tr_b16 a[254:255], v251 offset:12800
v_mfma_f32_16x16x32_bf16 v[152:155], v[72:75], a[176:179], v[152:155]
s_waitcnt lgkmcnt(10)
ds_write_b128 v50, v[88:91] offset:0
ds_write_b128 v50, v[104:107] offset:4096
ds_write_b64 v51, v[156:157] offset:0
ds_write_b128 v50, v[92:95] offset:64
ds_write_b128 v50, v[108:111] offset:4160
ds_write_b64 v51, v[160:161] offset:128
v_cvt_pk_bf16_f32 v164, v164, v165
v_cvt_pk_bf16_f32 v165, v166, v167
v_cvt_pk_bf16_f32 v168, v168, v169
v_cvt_pk_bf16_f32 v169, v170, v171
v_cvt_pk_bf16_f32 v172, v172, v173
v_cvt_pk_bf16_f32 v173, v174, v175
v_cvt_pk_bf16_f32 v176, v176, v177
v_cvt_pk_bf16_f32 v177, v178, v179
v_cvt_pk_bf16_f32 v180, v180, v181
v_cvt_pk_bf16_f32 v181, v182, v183
v_cvt_pk_bf16_f32 v152, v152, v153
v_cvt_pk_bf16_f32 v153, v154, v155
v_mov_b32 v105, 0
v_mov_b32 v107, 0
v_mov_b32 v109, 0
v_mov_b32 v111, 0
v_mov_b32 v133, 0
v_mov_b32 v134, 0
v_mov_b32 v135, 0
v_mov_b32 v149, 0
v_mov_b32 v150, 0
v_mov_b32 v151, 0
v_mov_b32 v248, 1.0
v_mov_b32 v249, 1.0
v_mov_b32 v251, 1.0
ds_write_b64 v51, v[164:165] offset:256
ds_write_b64 v51, v[168:169] offset:384
ds_write_b128 v50, v[96:99] offset:2048
ds_write_b128 v50, v[112:115] offset:6144
ds_write_b64 v51, v[172:173] offset:2048
ds_write_b64 v51, v[176:177] offset:2176
s_waitcnt vmcnt(4)
s_barrier
ds_read_b128 v[200:203], v236 offset:8704
ds_read_b128 v[212:215], v236 offset:8448
ds_read_b128 v[224:227], v236 offset:8960
ds_read_b128 v[228:231], v236 offset:9216
ds_read_b128 v[192:195], v236 offset:13440
ds_read_b128 v[204:207], v236 offset:12928
ds_read_b128 v[208:211], v236 offset:12672
ds_write_b128 v50, v[100:103] offset:2112
ds_write_b128 v50, v[116:119] offset:6208
s_waitcnt lgkmcnt(8)
v_mfma_f32_16x16x32_bf16 v[184:187], a[68:71], v[200:203], 0
s_waitcnt lgkmcnt(6)
ds_write_b64 v51, v[180:181] offset:2304
v_mfma_f32_16x16x32_bf16 v[184:187], a[64:67], v[212:215], v[184:187]
s_waitcnt lgkmcnt(2)
ds_write_b64 v51, v[152:153] offset:2432
v_mfma_f32_16x16x32_bf16 v[184:187], a[72:75], v[224:227], v[184:187]
v_mfma_f32_16x16x32_bf16 v[184:187], a[76:79], v[228:231], v[184:187]
s_nop 2
v_mfma_f32_16x16x32_bf16 v[188:191], a[92:95], v[228:231], 0
s_nop 2
v_mfma_f32_16x16x32_bf16 v[188:191], a[88:91], v[224:227], v[188:191]
v_cvt_pk_bf16_f32 v16, v184, v185
v_cvt_pk_bf16_f32 v17, v186, v187
v_mfma_f32_16x16x32_bf16 v[188:191], a[84:87], v[200:203], v[188:191]
ds_read_b128 v[184:187], v236 offset:13184
v_mfma_f32_16x16x32_bf16 v[188:191], a[80:83], v[212:215], v[188:191]
s_nop 2
v_mfma_f32_16x16x32_bf16 v[196:199], a[96:99], v[212:215], 0
s_nop 2
v_mfma_f32_16x16x32_bf16 v[196:199], a[100:103], v[200:203], v[196:199]
v_cvt_pk_bf16_f32 v18, v188, v189
v_cvt_pk_bf16_f32 v19, v190, v191
v_mfma_f32_16x16x32_bf16 v[196:199], a[104:107], v[224:227], v[196:199]
v_mfma_f32_16x16x32_bf16 v[196:199], a[108:111], v[228:231], v[196:199]
s_nop 2
v_mfma_f32_16x16x32_bf16 v[188:191], a[124:127], v[228:231], 0
s_waitcnt lgkmcnt(0)
s_nop 1
v_mfma_f32_16x16x32_bf16 v[188:191], a[116:119], v[200:203], v[188:191]
v_cvt_pk_bf16_f32 v21, v198, v199
v_cvt_pk_bf16_f32 v20, v196, v197
v_mfma_f32_16x16x32_bf16 v[188:191], a[112:115], v[212:215], v[188:191]
v_mfma_f32_16x16x32_bf16 v[188:191], a[120:123], v[224:227], v[188:191]
s_nop 2
v_mfma_f32_16x16x32_bf16 v[196:199], a[120:123], v[184:187], 0
s_nop 2
v_mfma_f32_16x16x32_bf16 v[196:199], a[124:127], v[192:195], v[196:199]
v_cvt_pk_bf16_f32 v23, v190, v191
v_cvt_pk_bf16_f32 v22, v188, v189
v_mfma_f32_16x16x32_bf16 v[196:199], a[116:119], v[204:207], v[196:199]
v_mfma_f32_16x16x32_bf16 v[196:199], a[112:115], v[208:211], v[196:199]
s_nop 2
v_mfma_f32_16x16x32_bf16 v[188:191], a[96:99], v[208:211], 0
s_nop 2
v_mfma_f32_16x16x32_bf16 v[188:191], a[100:103], v[204:207], v[188:191]
v_cvt_pk_bf16_f32 v30, v196, v197
v_cvt_pk_bf16_f32 v31, v198, v199
v_mfma_f32_16x16x32_bf16 v[188:191], a[104:107], v[184:187], v[188:191]
v_mfma_f32_16x16x32_bf16 v[188:191], a[108:111], v[192:195], v[188:191]
s_nop 2
v_mfma_f32_16x16x32_bf16 v[212:215], a[92:95], v[192:195], 0
s_nop 2
v_mfma_f32_16x16x32_bf16 v[212:215], a[88:91], v[184:187], v[212:215]
v_cvt_pk_bf16_f32 v29, v190, v191
v_cvt_pk_bf16_f32 v28, v188, v189
v_mfma_f32_16x16x32_bf16 v[212:215], a[84:87], v[204:207], v[212:215]
v_mfma_f32_16x16x32_bf16 v[212:215], a[80:83], v[208:211], v[212:215]
s_nop 2
v_mfma_f32_16x16x32_bf16 v[188:191], a[64:67], v[208:211], 0
s_nop 2
v_mfma_f32_16x16x32_bf16 v[188:191], a[72:75], v[184:187], v[188:191]
v_cvt_pk_bf16_f32 v27, v214, v215
v_cvt_pk_bf16_f32 v26, v212, v213
v_mfma_f32_16x16x32_bf16 v[188:191], a[76:79], v[192:195], v[188:191]
s_waitcnt vmcnt(0)
s_barrier
v_mfma_f32_16x16x32_bf16 v[188:191], a[68:71], v[204:207], v[188:191]
s_mov_b32 s48, s50
ds_read_b128 v[196:199], v236 offset:17152
ds_read_b128 v[200:203], v236 offset:16896
ds_read_b128 v[216:219], v236 offset:17408
ds_read_b128 v[220:223], v236 offset:17664
ds_read_u16 v108, v241 offset:256
ds_read_b128 v[204:207], v236 offset:21376
ds_read_b128 v[208:211], v236 offset:21120
ds_read_b128 v[52:55], v240 offset:64
v_cvt_pk_bf16_f32 v24, v188, v189
v_cvt_pk_bf16_f32 v25, v190, v191
s_add_u32 m0, s49, 0
s_add_u32 s50, s50, 13107200
buffer_load_dwordx4 v237, s[16:19], s48 offen nt lds
ds_read_b128 v[192:195], v236 offset:21888
ds_read_b128 v[48:51], v240 offset:0
ds_read_u16 v110, v241 offset:384
v_add_u32 v240, 0x200, v240
s_add_u32 s48, s48, s51
s_add_u32 m0, s49, 2112
ds_read_u16 v106, v241 offset:128
buffer_load_dwordx4 v237, s[16:19], s48 offen nt lds
s_waitcnt lgkmcnt(11)
v_mfma_f32_16x16x32_bf16 v[184:187], a[68:71], v[196:199], 0
s_waitcnt lgkmcnt(9)
ds_read_u16 v104, v241 offset:0
s_add_u32 m0, s49, 4224
v_mfma_f32_16x16x32_bf16 v[184:187], a[64:67], v[200:203], v[184:187]
s_waitcnt lgkmcnt(6)
s_add_u32 s48, s48, s51
buffer_load_dwordx4 v237, s[16:19], s48 offen nt lds
v_mfma_f32_16x16x32_bf16 v[184:187], a[72:75], v[216:219], v[184:187]
s_add_u32 m0, s49, 6336
s_add_u32 s48, s48, s51
buffer_load_dwordx4 v237, s[16:19], s48 offen nt lds
v_mfma_f32_16x16x32_bf16 v[184:187], a[76:79], v[220:223], v[184:187]
s_add_u32 m0, s49, 8448
s_add_u32 s48, s48, s51
buffer_load_dwordx4 v237, s[16:19], s48 offen nt lds
v_mfma_f32_16x16x32_bf16 v[188:191], a[92:95], v[220:223], 0
s_add_u32 m0, s49, 10560
s_mov_b32 s47, s46
s_add_u32 s48, s48, s51
v_mfma_f32_16x16x32_bf16 v[188:191], a[88:91], v[216:219], v[188:191]
s_bfe_i32 s57, s3, 0x10000
buffer_load_dwordx4 v237, s[16:19], s48 offen nt lds
v_cvt_pk_bf16_f32 v32, v184, v185
v_mfma_f32_16x16x32_bf16 v[188:191], a[84:87], v[196:199], v[188:191]
s_and_b32 s54, s57, s5
v_cvt_pk_bf16_f32 v33, v186, v187
s_sub_u32 s45, s45, 1
v_mfma_f32_16x16x32_bf16 v[188:191], a[80:83], v[200:203], v[188:191]
s_sub_u32 s50, s50, s54
s_add_u32 s52, s46, 20480
s_lshr_b32 s3, s3, 1
v_mfma_f32_16x16x32_bf16 v[184:187], a[96:99], v[200:203], 0
s_waitcnt lgkmcnt(0)
s_nop 1
v_mfma_f32_16x16x32_bf16 v[184:187], a[100:103], v[196:199], v[184:187]
v_cvt_pk_bf16_f32 v35, v190, v191
v_cvt_pk_bf16_f32 v34, v188, v189
v_mfma_f32_16x16x32_bf16 v[184:187], a[104:107], v[216:219], v[184:187]
v_mfma_f32_16x16x32_bf16 v[184:187], a[108:111], v[220:223], v[184:187]
s_nop 2
v_mfma_f32_16x16x32_bf16 v[188:191], a[124:127], v[220:223], 0
s_nop 2
v_mfma_f32_16x16x32_bf16 v[188:191], a[120:123], v[216:219], v[188:191]
v_cvt_pk_bf16_f32 v37, v186, v187
v_cvt_pk_bf16_f32 v36, v184, v185
v_mfma_f32_16x16x32_bf16 v[188:191], a[116:119], v[196:199], v[188:191]
ds_read_b128 v[196:199], v236 offset:21632
v_mfma_f32_16x16x32_bf16 v[188:191], a[112:115], v[200:203], v[188:191]
s_nop 7
v_cvt_pk_bf16_f32 v39, v190, v191
v_cvt_pk_bf16_f32 v38, v188, v189
s_nop 7
s_waitcnt lgkmcnt(0)
s_branch L_entrys
.p2align 6
L_loops:
s_waitcnt vmcnt(8)
s_barrier
v_mfma_f32_16x16x32_bf16 v[176:179], a[224:227], v[220:223], 0
s_add_u32 s52, s47, 8192
v_exp_f32 v187, v187
v_mfma_f32_16x16x32_bf16 v[176:179], a[228:231], v[224:227], v[176:179]
s_add_u32 s53, s47, 12288
v_add_f32 v248, v184, v185
v_add_f32 v248, v248, v186
v_mfma_f32_16x16x32_bf16 v[176:179], a[232:235], v[212:215], v[176:179]
s_mov_b32 s47, s46
v_add_f32 v248, v248, v187
v_cvt_pk_bf16_f32 v120, v184, v185
v_mfma_f32_16x16x32_bf16 v[176:179], a[236:239], v[216:219], v[176:179]
s_bfe_i32 s57, s3, 0x10000
v_cvt_pk_bf16_f32 v121, v186, v187
v_sub_f32 v193, v193, v254
v_mfma_f32_16x16x32_bf16 v[180:183], a[252:255], v[216:219], 0
s_and_b32 s54, s57, s5
v_exp_f32 v188, v188
v_mfma_f32_16x16x32_bf16 v[180:183], a[248:251], v[212:215], v[180:183]
s_sub_u32 s45, s45, 1
v_exp_f32 v190, v190
v_mfma_f32_16x16x32_bf16 v[180:183], a[244:247], v[224:227], v[180:183]
s_lshr_b32 s3, s3, 1
v_sub_f32 v194, v194, v254
v_add_f32 v248, v248, v188
v_mfma_f32_16x16x32_bf16 v[180:183], a[240:243], v[220:223], v[180:183]
v_exp_f32 v189, v189
v_mfma_f32_16x16x32_bf16 v[212:215], v[0:3], v[112:115], 0
v_add_f32 v248, v248, v189
v_sub_f32 v191, v191, v254
v_mfma_f32_16x16x32_bf16 v[212:215], v[4:7], v[116:119], v[212:215]
v_exp_f32 v191, v191
v_mfma_f32_16x16x32_bf16 v[216:219], v[12:15], v[116:119], 0
v_sub_f32 v195, v195, v254
v_sub_f32 v192, v192, v254
v_mfma_f32_16x16x32_bf16 v[216:219], v[8:11], v[112:115], v[216:219]
v_exp_f32 v192, v192
v_mfma_f32_16x16x32_bf16 v[220:223], v[16:19], v[112:115], 0
v_exp_f32 v194, v194
v_mfma_f32_16x16x32_bf16 v[220:223], v[20:23], v[116:119], v[220:223]
v_exp_f32 v193, v193
v_mfma_f32_16x16x32_bf16 v[224:227], v[28:31], v[116:119], 0
v_add_f32 v248, v248, v190
v_add_f32 v248, v248, v191
v_mfma_f32_16x16x32_bf16 v[224:227], v[24:27], v[112:115], v[224:227]
v_exp_f32 v195, v195
v_mfma_f32_16x16x32_bf16 v[228:231], v[32:35], v[112:115], 0
v_add_f32 v248, v248, v192
v_add_f32 v248, v248, v193
v_mfma_f32_16x16x32_bf16 v[228:231], v[36:39], v[116:119], v[228:231]
v_add_f32 v248, v248, v194
v_add_f32 v248, v248, v195
v_mfma_f32_16x16x32_bf16 v[232:235], v[44:47], v[116:119], 0
v_cvt_pk_bf16_f32 v123, v190, v191
v_cvt_pk_bf16_f32 v122, v188, v189
v_mfma_f32_16x16x32_bf16 v[232:235], v[40:43], v[112:115], v[232:235]
s_mov_b32 s48, s50
ds_read_b128 v[188:191], v236 offset:0
v_cvt_pk_bf16_f32 v125, v194, v195
v_mfma_f32_16x16x32_bf16 v[184:187], v[48:51], v[112:115], 0
s_add_u32 m0, s49, 0
ds_read_b128 v[48:51], v240 offset:0
v_cvt_pk_bf16_f32 v124, v192, v193
v_mfma_f32_16x16x32_bf16 v[184:187], v[52:55], v[116:119], v[184:187]
s_add_u32 s50, s50, 13107200
buffer_load_dwordx4 v237, s[16:19], s48 offen nt lds
v_sub_f32 v196, v196, v254
v_sub_f32 v197, v197, v254
v_sub_f32 v199, v199, v254
v_sub_f32 v198, v198, v254
v_exp_f32 v196, v196
v_exp_f32 v197, v197
v_add_f32 v248, v248, v196
v_add_f32 v248, v248, v197
v_exp_f32 v198, v198
s_waitcnt lgkmcnt(1)
v_mfma_f32_16x16x32_bf16 v[192:195], a[64:67], v[188:191], 0
s_sub_u32 s50, s50, s54
ds_read_b128 v[52:55], v240 offset:64
v_exp_f32 v199, v199
v_add_f32 v248, v248, v198
v_add_f32 v248, v248, v199
v_cvt_pk_bf16_f32 v126, v196, v197
v_cvt_pk_bf16_f32 v127, v198, v199
ds_read_b128 v[196:199], v236 offset:256
v_sub_f32 v200, v200, v254
v_sub_f32 v203, v203, v254
v_sub_f32 v201, v201, v254
v_exp_f32 v201, v201
v_sub_f32 v202, v202, v254
v_exp_f32 v202, v202
v_exp_f32 v200, v200
v_exp_f32 v203, v203
v_add_f32 v248, v248, v200
v_add_f32 v248, v248, v201
v_add_f32 v248, v248, v202
v_add_f32 v248, v248, v203
v_cvt_pk_bf16_f32 v128, v200, v201
v_cvt_pk_bf16_f32 v129, v202, v203
v_sub_f32 v204, v204, v254
v_sub_f32 v205, v205, v254
s_waitcnt lgkmcnt(0)
v_mfma_f32_16x16x32_bf16 v[192:195], a[68:71], v[196:199], v[192:195]
ds_read_b128 v[200:203], v236 offset:512
v_exp_f32 v204, v204
v_sub_f32 v206, v206, v254
v_add_f32 v248, v248, v204
v_exp_f32 v206, v206
v_sub_f32 v207, v207, v254
v_exp_f32 v205, v205
v_exp_f32 v207, v207
v_add_f32 v248, v248, v205
v_cvt_pk_bf16_f32 v130, v204, v205
v_add_f32 v248, v248, v206
v_add_f32 v248, v248, v207
v_cvt_pk_bf16_f32 v131, v206, v207
v_sub_f32 v208, v208, v254
v_exp_f32 v208, v208
v_max3_f32 v254, v212, v213, v214
s_waitcnt lgkmcnt(0)
v_mfma_f32_16x16x32_bf16 v[192:195], a[72:75], v[200:203], v[192:195]
ds_read_b128 v[204:207], v236 offset:768
v_add_f32 v248, v248, v208
v_cvt_pk_bf16_f32 v132, v208, 0
v_max3_f32 v254, v254, v215, v216
v_max3_f32 v254, v254, v217, v218
v_max3_f32 v254, v254, v219, v220
v_max3_f32 v254, v254, v221, v222
v_max3_f32 v254, v254, v223, v224
v_max3_f32 v254, v254, v225, v226
v_max3_f32 v254, v254, v227, v228
v_max3_f32 v254, v254, v229, v230
v_max3_f32 v254, v254, v231, v232
v_max3_f32 v254, v254, v233, v234
v_max3_f32 v254, v254, v235, v184
v_add_u32 v240, 0x200, v240
ds_swizzle_b32 v250, v248 offset:0x401F
ds_swizzle_b32 v255, v254 offset:0x401F
s_waitcnt lgkmcnt(2)
v_mfma_f32_16x16x32_bf16 v[192:195], a[76:79], v[204:207], v[192:195]
s_nop 2
v_mfma_f32_16x16x32_bf16 v[208:211], a[92:95], v[204:207], 0
s_nop 2
v_mfma_f32_16x16x32_bf16 v[208:211], a[88:91], v[200:203], v[208:211]
v_cvt_pk_bf16_f32 v0, v192, v193
v_cvt_pk_bf16_f32 v1, v194, v195
v_mfma_f32_16x16x32_bf16 v[208:211], a[84:87], v[196:199], v[208:211]
v_mfma_f32_16x16x32_bf16 v[208:211], a[80:83], v[188:191], v[208:211]
s_waitcnt lgkmcnt(0)
v_add_f32 v248, v248, v250
v_max_f32 v254, v254, v255
v_mfma_f32_16x16x32_bf16 v[192:195], a[96:99], v[188:191], 0
ds_bpermute_b32 v250, v247, v248
v_mfma_f32_16x16x32_bf16 v[192:195], a[100:103], v[196:199], v[192:195]
ds_bpermute_b32 v255, v247, v254
v_mfma_f32_16x16x32_bf16 v[192:195], a[104:107], v[200:203], v[192:195]
v_cvt_pk_bf16_f32 v2, v208, v209
v_cvt_pk_bf16_f32 v3, v210, v211
v_mfma_f32_16x16x32_bf16 v[192:195], a[108:111], v[204:207], v[192:195]
s_nop 2
v_mfma_f32_16x16x32_bf16 v[208:211], a[124:127], v[204:207], 0
s_nop 2
v_mfma_f32_16x16x32_bf16 v[208:211], a[120:123], v[200:203], v[208:211]
v_cvt_pk_bf16_f32 v5, v194, v195
v_cvt_pk_bf16_f32 v4, v192, v193
v_mfma_f32_16x16x32_bf16 v[208:211], a[116:119], v[196:199], v[208:211]
s_waitcnt lgkmcnt(1)
v_add_f32 v248, v248, v250
v_mfma_f32_16x16x32_bf16 v[208:211], a[112:115], v[188:191], v[208:211]
s_waitcnt lgkmcnt(0)
v_rcp_f32 v251, v248
v_mfma_f32_16x16x32_bf16 v[188:191], v[56:59], v[120:123], 0
v_max_f32 v254, v254, v255
v_sub_f32 v214, v214, v254
v_mfma_f32_16x16x32_bf16 v[188:191], v[104:107], v[132:135], v[188:191]
s_add_u32 s48, s48, s51
v_sub_f32 v215, v215, v254
v_cvt_pk_bf16_f32 v6, v208, v209
v_mfma_f32_16x16x32_bf16 v[188:191], v[72:75], v[124:127], v[188:191]
s_add_u32 m0, s49, 2112
v_cvt_pk_bf16_f32 v7, v210, v211
v_sub_f32 v212, v212, v254
v_mfma_f32_16x16x32_bf16 v[188:191], v[88:91], v[128:131], v[188:191]
buffer_load_dwordx4 v237, s[16:19], s48 offen nt lds
v_sub_f32 v213, v213, v254
v_mfma_f32_16x16x32_bf16 v[196:199], v[92:95], v[128:131], 0
v_exp_f32 v212, v212
v_mfma_f32_16x16x32_bf16 v[196:199], v[76:79], v[124:127], v[196:199]
v_exp_f32 v214, v214
v_mfma_f32_16x16x32_bf16 v[196:199], v[106:109], v[132:135], v[196:199]
v_exp_f32 v213, v213
v_mfma_f32_16x16x32_bf16 v[196:199], v[60:63], v[120:123], v[196:199]
ds_read_b128 v[204:207], v236 offset:4480
v_sub_f32 v216, v216, v254
v_mfma_f32_16x16x32_bf16 v[200:203], v[64:67], v[120:123], 0
ds_read_b128 v[192:195], v236 offset:4224
v_sub_f32 v217, v217, v254
v_mfma_f32_16x16x32_bf16 v[200:203], v[108:111], v[132:135], v[200:203]
v_exp_f32 v215, v215
v_mfma_f32_16x16x32_bf16 v[200:203], v[80:83], v[124:127], v[200:203]
v_exp_f32 v217, v217
v_mfma_f32_16x16x32_bf16 v[200:203], v[96:99], v[128:131], v[200:203]
v_sub_f32 v218, v218, v254
v_add_f32 v249, v212, v213
v_mfma_f32_16x16x32_bf16 v[208:211], v[100:103], v[128:131], 0
v_add_f32 v249, v249, v214
v_add_f32 v249, v249, v215
v_mfma_f32_16x16x32_bf16 v[208:211], v[84:87], v[124:127], v[208:211]
s_waitcnt lgkmcnt(1)
v_exp_f32 v216, v216
v_mfma_f32_16x16x32_bf16 v[208:211], v[110:113], v[132:135], v[208:211]
s_waitcnt lgkmcnt(0)
v_sub_f32 v219, v219, v254
v_sub_f32 v220, v220, v254
v_mfma_f32_16x16x32_bf16 v[208:211], v[68:71], v[120:123], v[208:211]
v_exp_f32 v218, v218
v_sub_f32 v223, v223, v254
v_add_f32 v249, v249, v216
v_add_f32 v249, v249, v217
v_exp_f32 v219, v219
v_add_f32 v249, v249, v218
v_add_f32 v249, v249, v219
v_exp_f32 v220, v220
v_sub_f32 v224, v224, v254
v_exp_f32 v223, v223
v_sub_f32 v221, v221, v254
v_exp_f32 v224, v224
v_exp_f32 v221, v221
v_sub_f32 v222, v222, v254
v_sub_f32 v225, v225, v254
v_add_f32 v249, v249, v220
v_add_f32 v249, v249, v221
v_exp_f32 v222, v222
v_exp_f32 v225, v225
v_add_f32 v249, v249, v222
v_add_f32 v249, v249, v223
v_add_f32 v249, v249, v224
v_sub_f32 v226, v226, v254
v_add_f32 v249, v249, v225
v_exp_f32 v226, v226
v_sub_f32 v227, v227, v254
v_exp_f32 v227, v227
v_sub_f32 v228, v228, v254
v_exp_f32 v228, v228
v_add_f32 v249, v249, v226
v_sub_f32 v232, v232, v254
v_sub_f32 v229, v229, v254
v_sub_f32 v230, v230, v254
v_exp_f32 v230, v230
v_exp_f32 v229, v229
v_add_f32 v249, v249, v227
v_add_f32 v249, v249, v228
v_add_f32 v249, v249, v229
v_exp_f32 v232, v232
v_sub_f32 v233, v233, v254
v_exp_f32 v233, v233
v_sub_f32 v231, v231, v254
v_exp_f32 v231, v231
v_sub_f32 v234, v234, v254
v_sub_f32 v235, v235, v254
v_add_f32 v249, v249, v230
v_add_f32 v249, v249, v231
v_add_f32 v249, v249, v232
v_exp_f32 v234, v234
v_exp_f32 v235, v235
v_sub_f32 v184, v184, v254
v_exp_f32 v184, v184
v_add_f32 v249, v249, v233
v_cvt_pk_bf16_f32 v148, v184, 0
v_add_f32 v249, v249, v234
v_add_f32 v249, v249, v235
v_add_f32 v249, v249, v184
v_fmac_f32 v161, v201, v251
v_fmac_f32 v163, v203, v251
v_fmac_f32 v160, v200, v251
v_fmac_f32 v162, v202, v251
ds_read_b128 v[184:187], v236 offset:4992
v_cvt_pk_bf16_f32 v138, v216, v217
v_cvt_pk_bf16_f32 v139, v218, v219
v_fmac_f32 v167, v211, v251
v_fmac_f32 v165, v209, v251
v_fmac_f32 v166, v210, v251
v_fmac_f32 v164, v208, v251
v_cvt_pk_bf16_f32 v140, v220, v221
v_cvt_pk_bf16_f32 v141, v222, v223
v_fmac_f32 v155, v191, v251
v_fmac_f32 v154, v190, v251
v_fmac_f32 v152, v188, v251
v_fmac_f32 v153, v189, v251
v_cvt_pk_bf16_f32 v137, v214, v215
v_cvt_pk_bf16_f32 v136, v212, v213
v_cvt_pk_bf16_f32 v143, v226, v227
v_cvt_pk_bf16_f32 v142, v224, v225
v_cvt_pk_bf16_f32 v145, v230, v231
v_cvt_pk_bf16_f32 v144, v228, v229
v_fmac_f32 v156, v196, v251
v_fmac_f32 v157, v197, v251
s_waitcnt lgkmcnt(0)
v_mfma_f32_16x16x32_bf16 v[200:203], a[124:127], v[184:187], 0
ds_read_b128 v[216:219], v236 offset:4736
v_fmac_f32 v158, v198, v251
v_fmac_f32 v159, v199, v251
v_cvt_pk_bf16_f32 v147, v234, v235
v_cvt_pk_bf16_f32 v146, v232, v233
v_cvt_pk_bf16_f32 v160, v160, v161
v_cvt_pk_bf16_f32 v161, v162, v163
v_cvt_pk_bf16_f32 v163, v166, v167
v_cvt_pk_bf16_f32 v162, v164, v165
v_cvt_pk_bf16_f32 v152, v152, v153
v_cvt_pk_bf16_f32 v153, v154, v155
v_pk_max_i16 v160, v160, 0
v_pk_max_i16 v162, v162, 0
v_pk_max_i16 v153, v153, 0
v_pk_max_i16 v161, v161, 0
v_pk_max_i16 v163, v163, 0
v_cvt_pk_bf16_f32 v155, v158, v159
v_pk_max_i16 v155, v155, 0
v_pk_max_i16 v152, v152, 0
v_cvt_pk_bf16_f32 v154, v156, v157
v_pk_max_i16 v154, v154, 0
s_waitcnt lgkmcnt(0)
v_mfma_f32_16x16x32_bf16 v[200:203], a[120:123], v[216:219], v[200:203]
ds_swizzle_b32 v250, v249 offset:0x401F
buffer_store_dwordx4 v[152:155], v239, s[20:23], s52 offen offset:0 nt
buffer_store_dwordx4 v[160:163], v239, s[20:23], s52 offen offset:64 nt
s_add_u32 s52, s46, 20480
v_mfma_f32_16x16x32_bf16 v[200:203], a[116:119], v[204:207], v[200:203]
v_mfma_f32_16x16x32_bf16 v[200:203], a[112:115], v[192:195], v[200:203]
s_nop 2
v_mfma_f32_16x16x32_bf16 v[208:211], a[96:99], v[192:195], 0
s_waitcnt lgkmcnt(0)
v_add_f32 v249, v249, v250
v_mfma_f32_16x16x32_bf16 v[208:211], a[100:103], v[204:207], v[208:211]
s_add_u32 m0, s49, 4224
ds_bpermute_b32 v250, v247, v249
v_mfma_f32_16x16x32_bf16 v[208:211], a[104:107], v[216:219], v[208:211]
s_add_u32 s48, s48, s51
buffer_load_dwordx4 v237, s[16:19], s48 offen nt lds
v_cvt_pk_bf16_f32 v14, v200, v201
v_mfma_f32_16x16x32_bf16 v[208:211], a[108:111], v[184:187], v[208:211]
ds_read_b128 v[212:215], v236 offset:8448
v_cvt_pk_bf16_f32 v15, v202, v203
v_mfma_f32_16x16x32_bf16 v[220:223], a[92:95], v[184:187], 0
ds_read_b128 v[200:203], v236 offset:8704
ds_read_b128 v[224:227], v236 offset:8960
v_mfma_f32_16x16x32_bf16 v[220:223], a[88:91], v[216:219], v[220:223]
ds_read_b128 v[228:231], v236 offset:9216
v_mfma_f32_16x16x32_bf16 v[220:223], a[84:87], v[204:207], v[220:223]
v_cvt_pk_bf16_f32 v13, v210, v211
v_cvt_pk_bf16_f32 v12, v208, v209
v_mfma_f32_16x16x32_bf16 v[220:223], a[80:83], v[192:195], v[220:223]
s_waitcnt lgkmcnt(4)
v_add_f32 v249, v249, v250
s_nop 0
v_mfma_f32_16x16x32_bf16 v[188:191], a[64:67], v[192:195], 0
v_rcp_f32 v252, v249
v_mfma_f32_16x16x32_bf16 v[188:191], a[72:75], v[216:219], v[188:191]
s_waitcnt lgkmcnt(3)
s_nop 0
v_cvt_pk_bf16_f32 v10, v220, v221
v_mfma_f32_16x16x32_bf16 v[188:191], a[76:79], v[184:187], v[188:191]
s_waitcnt lgkmcnt(1)
v_cvt_pk_bf16_f32 v11, v222, v223
v_mfma_f32_16x16x32_bf16 v[188:191], a[68:71], v[204:207], v[188:191]
s_waitcnt lgkmcnt(0)
s_nop 1
v_mfma_f32_16x16x32_bf16 v[184:187], a[68:71], v[200:203], 0
s_nop 2
v_mfma_f32_16x16x32_bf16 v[184:187], a[64:67], v[212:215], v[184:187]
v_cvt_pk_bf16_f32 v9, v190, v191
v_cvt_pk_bf16_f32 v8, v188, v189
v_mfma_f32_16x16x32_bf16 v[184:187], a[72:75], v[224:227], v[184:187]
v_mfma_f32_16x16x32_bf16 v[184:187], a[76:79], v[228:231], v[184:187]
s_nop 2
v_mfma_f32_16x16x32_bf16 v[188:191], a[92:95], v[228:231], 0
s_nop 2
v_mfma_f32_16x16x32_bf16 v[188:191], a[88:91], v[224:227], v[188:191]
v_cvt_pk_bf16_f32 v16, v184, v185
v_cvt_pk_bf16_f32 v17, v186, v187
v_mfma_f32_16x16x32_bf16 v[188:191], a[84:87], v[200:203], v[188:191]
v_mfma_f32_16x16x32_bf16 v[188:191], a[80:83], v[212:215], v[188:191]
ds_read_b128 v[184:187], v236 offset:13184
ds_read_b128 v[192:195], v236 offset:13440
v_mfma_f32_16x16x32_bf16 v[196:199], a[96:99], v[212:215], 0
ds_read_b128 v[204:207], v236 offset:12928
ds_read_b128 v[208:211], v236 offset:12672
v_mfma_f32_16x16x32_bf16 v[196:199], a[100:103], v[200:203], v[196:199]
s_add_u32 m0, s49, 6336
s_add_u32 s48, s48, s51
v_cvt_pk_bf16_f32 v18, v188, v189
v_mfma_f32_16x16x32_bf16 v[196:199], a[104:107], v[224:227], v[196:199]
buffer_load_dwordx4 v237, s[16:19], s48 offen nt lds
v_cvt_pk_bf16_f32 v19, v190, v191
v_mfma_f32_16x16x32_bf16 v[196:199], a[108:111], v[228:231], v[196:199]
s_nop 2
v_mfma_f32_16x16x32_bf16 v[188:191], a[124:127], v[228:231], 0
s_nop 2
v_mfma_f32_16x16x32_bf16 v[188:191], a[116:119], v[200:203], v[188:191]
s_waitcnt lgkmcnt(2)
v_cvt_pk_bf16_f32 v21, v198, v199
v_cvt_pk_bf16_f32 v20, v196, v197
v_mfma_f32_16x16x32_bf16 v[188:191], a[112:115], v[212:215], v[188:191]
s_waitcnt lgkmcnt(0)
v_mfma_f32_16x16x32_bf16 v[188:191], a[120:123], v[224:227], v[188:191]
s_nop 2
v_mfma_f32_16x16x32_bf16 v[196:199], a[120:123], v[184:187], 0
s_nop 2
v_mfma_f32_16x16x32_bf16 v[196:199], a[124:127], v[192:195], v[196:199]
v_cvt_pk_bf16_f32 v23, v190, v191
v_cvt_pk_bf16_f32 v22, v188, v189
v_mfma_f32_16x16x32_bf16 v[196:199], a[116:119], v[204:207], v[196:199]
v_mfma_f32_16x16x32_bf16 v[196:199], a[112:115], v[208:211], v[196:199]
s_nop 2
v_mfma_f32_16x16x32_bf16 v[188:191], a[96:99], v[208:211], 0
s_nop 2
v_mfma_f32_16x16x32_bf16 v[188:191], a[100:103], v[204:207], v[188:191]
v_cvt_pk_bf16_f32 v30, v196, v197
v_cvt_pk_bf16_f32 v31, v198, v199
v_mfma_f32_16x16x32_bf16 v[188:191], a[104:107], v[184:187], v[188:191]
v_mfma_f32_16x16x32_bf16 v[188:191], a[108:111], v[192:195], v[188:191]
ds_read_b128 v[196:199], v236 offset:17152
ds_read_b128 v[200:203], v236 offset:16896
v_mfma_f32_16x16x32_bf16 v[212:215], a[92:95], v[192:195], 0
ds_read_b128 v[216:219], v236 offset:17408
ds_read_b128 v[220:223], v236 offset:17664
v_mfma_f32_16x16x32_bf16 v[212:215], a[88:91], v[184:187], v[212:215]
s_nop 1
v_cvt_pk_bf16_f32 v29, v190, v191
v_mfma_f32_16x16x32_bf16 v[212:215], a[84:87], v[204:207], v[212:215]
v_cvt_pk_bf16_f32 v28, v188, v189
v_mfma_f32_16x16x32_bf16 v[212:215], a[80:83], v[208:211], v[212:215]
s_nop 2
v_mfma_f32_16x16x32_bf16 v[188:191], a[64:67], v[208:211], 0
s_nop 2
v_mfma_f32_16x16x32_bf16 v[188:191], a[72:75], v[184:187], v[188:191]
s_add_u32 m0, s49, 8448
v_cvt_pk_bf16_f32 v27, v214, v215
v_cvt_pk_bf16_f32 v26, v212, v213
v_mfma_f32_16x16x32_bf16 v[188:191], a[76:79], v[192:195], v[188:191]
s_add_u32 s48, s48, s51
buffer_load_dwordx4 v237, s[16:19], s48 offen nt lds
v_mfma_f32_16x16x32_bf16 v[188:191], a[68:71], v[204:207], v[188:191]
s_waitcnt lgkmcnt(0)
s_nop 1
v_mfma_f32_16x16x32_bf16 v[184:187], a[68:71], v[196:199], 0
s_nop 2
v_mfma_f32_16x16x32_bf16 v[184:187], a[64:67], v[200:203], v[184:187]
v_cvt_pk_bf16_f32 v24, v188, v189
v_cvt_pk_bf16_f32 v25, v190, v191
v_mfma_f32_16x16x32_bf16 v[184:187], a[72:75], v[216:219], v[184:187]
v_mfma_f32_16x16x32_bf16 v[184:187], a[76:79], v[220:223], v[184:187]
s_nop 2
v_mfma_f32_16x16x32_bf16 v[188:191], a[92:95], v[220:223], 0
s_nop 2
v_mfma_f32_16x16x32_bf16 v[188:191], a[88:91], v[216:219], v[188:191]
v_cvt_pk_bf16_f32 v32, v184, v185
v_cvt_pk_bf16_f32 v33, v186, v187
v_mfma_f32_16x16x32_bf16 v[188:191], a[84:87], v[196:199], v[188:191]
v_mfma_f32_16x16x32_bf16 v[188:191], a[80:83], v[200:203], v[188:191]
s_nop 2
v_mfma_f32_16x16x32_bf16 v[184:187], a[96:99], v[200:203], 0
s_nop 2
v_mfma_f32_16x16x32_bf16 v[184:187], a[100:103], v[196:199], v[184:187]
v_cvt_pk_bf16_f32 v35, v190, v191
v_cvt_pk_bf16_f32 v34, v188, v189
v_mfma_f32_16x16x32_bf16 v[184:187], a[104:107], v[216:219], v[184:187]
v_mfma_f32_16x16x32_bf16 v[184:187], a[108:111], v[220:223], v[184:187]
s_nop 2
v_mfma_f32_16x16x32_bf16 v[188:191], a[124:127], v[220:223], 0
s_nop 2
v_mfma_f32_16x16x32_bf16 v[188:191], a[120:123], v[216:219], v[188:191]
v_cvt_pk_bf16_f32 v37, v186, v187
v_cvt_pk_bf16_f32 v36, v184, v185
v_mfma_f32_16x16x32_bf16 v[188:191], a[116:119], v[196:199], v[188:191]
v_mfma_f32_16x16x32_bf16 v[188:191], a[112:115], v[200:203], v[188:191]
s_nop 2
v_mfma_f32_16x16x32_bf16 v[184:187], v[56:59], v[136:139], 0
s_nop 2
v_mfma_f32_16x16x32_bf16 v[184:187], v[104:107], v[148:151], v[184:187]
s_add_u32 m0, s49, 10560
ds_read_u16 v104, v241 offset:0
v_cvt_pk_bf16_f32 v39, v190, v191
v_mfma_f32_16x16x32_bf16 v[184:187], v[72:75], v[140:143], v[184:187]
s_add_u32 s48, s48, s51
buffer_load_dwordx4 v237, s[16:19], s48 offen nt lds
v_cvt_pk_bf16_f32 v38, v188, v189
v_mfma_f32_16x16x32_bf16 v[184:187], v[88:91], v[144:147], v[184:187]
s_nop 2
v_mfma_f32_16x16x32_bf16 v[188:191], v[92:95], v[144:147], 0
s_nop 2
v_mfma_f32_16x16x32_bf16 v[188:191], v[76:79], v[140:143], v[188:191]
v_fmac_f32 v170, v186, v252
v_fmac_f32 v168, v184, v252
v_mfma_f32_16x16x32_bf16 v[188:191], v[106:109], v[148:151], v[188:191]
ds_read_u16 v106, v241 offset:128
v_fmac_f32 v171, v187, v252
v_mfma_f32_16x16x32_bf16 v[188:191], v[60:63], v[136:139], v[188:191]
s_waitcnt lgkmcnt(1)
ds_read_b128 v[192:195], v236 offset:21888
v_fmac_f32 v169, v185, v252
v_mfma_f32_16x16x32_bf16 v[200:203], v[64:67], v[136:139], 0
ds_read_b128 v[196:199], v236 offset:21632
ds_read_b128 v[204:207], v236 offset:21376
v_mfma_f32_16x16x32_bf16 v[200:203], v[108:111], v[148:151], v[200:203]
ds_read_b128 v[208:211], v236 offset:21120
v_fmac_f32 v174, v190, v252
v_mfma_f32_16x16x32_bf16 v[200:203], v[80:83], v[140:143], v[200:203]
ds_read_u16 v108, v241 offset:256
v_fmac_f32 v175, v191, v252
v_mfma_f32_16x16x32_bf16 v[200:203], v[96:99], v[144:147], v[200:203]
v_fmac_f32 v172, v188, v252
v_fmac_f32 v173, v189, v252
v_mfma_f32_16x16x32_bf16 v[184:187], v[100:103], v[144:147], 0
s_waitcnt lgkmcnt(5)
v_cvt_pk_bf16_f32 v168, v168, v169
v_cvt_pk_bf16_f32 v169, v170, v171
v_mfma_f32_16x16x32_bf16 v[184:187], v[84:87], v[140:143], v[184:187]
s_waitcnt lgkmcnt(4)
v_fmac_f32 v178, v202, v252
v_fmac_f32 v176, v200, v252
v_mfma_f32_16x16x32_bf16 v[184:187], v[110:113], v[148:151], v[184:187]
s_waitcnt lgkmcnt(2)
ds_read_u16 v110, v241 offset:384
v_fmac_f32 v177, v201, v252
v_mfma_f32_16x16x32_bf16 v[184:187], v[68:71], v[136:139], v[184:187]
L_entrys:
s_waitcnt lgkmcnt(2)
v_fmac_f32 v179, v203, v252
v_cvt_pk_bf16_f32 v176, v176, v177
v_mfma_f32_16x16x32_bf16 v[188:191], a[124:127], v[192:195], 0
s_waitcnt lgkmcnt(1)
v_cvt_pk_bf16_f32 v177, v178, v179
v_cvt_pk_bf16_f32 v171, v174, v175
v_mfma_f32_16x16x32_bf16 v[188:191], a[120:123], v[196:199], v[188:191]
v_fmac_f32 v180, v184, v252
v_fmac_f32 v181, v185, v252
v_mfma_f32_16x16x32_bf16 v[188:191], a[116:119], v[204:207], v[188:191]
v_fmac_f32 v183, v187, v252
v_fmac_f32 v182, v186, v252
v_mfma_f32_16x16x32_bf16 v[188:191], a[112:115], v[208:211], v[188:191]
v_cvt_pk_bf16_f32 v178, v180, v181
v_cvt_pk_bf16_f32 v170, v172, v173
v_mfma_f32_16x16x32_bf16 v[184:187], a[96:99], v[208:211], 0
s_waitcnt lgkmcnt(0)
v_cvt_pk_bf16_f32 v179, v182, v183
v_pk_max_i16 v168, v168, 0
v_mfma_f32_16x16x32_bf16 v[184:187], a[100:103], v[204:207], v[184:187]
s_add_u32 s48, s48, s51
v_cvt_pk_bf16_f32 v46, v188, v189
v_cvt_pk_bf16_f32 v47, v190, v191
v_mfma_f32_16x16x32_bf16 v[184:187], a[104:107], v[196:199], v[184:187]
s_add_u32 m0, s49, 12672
v_pk_max_i16 v176, v176, 0
v_pk_max_i16 v170, v170, 0
v_mfma_f32_16x16x32_bf16 v[184:187], a[108:111], v[192:195], v[184:187]
buffer_load_dwordx4 v237, s[16:19], s48 offen nt lds
v_pk_max_i16 v179, v179, 0
v_mfma_f32_16x16x32_bf16 v[188:191], a[92:95], v[192:195], 0
v_pk_max_i16 v178, v178, 0
v_pk_max_i16 v169, v169, 0
v_mfma_f32_16x16x32_bf16 v[188:191], a[88:91], v[196:199], v[188:191]
v_pk_max_i16 v177, v177, 0
v_pk_max_i16 v171, v171, 0
v_mfma_f32_16x16x32_bf16 v[188:191], a[84:87], v[204:207], v[188:191]
buffer_store_dwordx4 v[168:171], v239, s[20:23], s53 offen offset:0 nt
buffer_store_dwordx4 v[176:179], v239, s[20:23], s53 offen offset:64 nt
v_cvt_pk_bf16_f32 v44, v184, v185
v_cvt_pk_bf16_f32 v45, v186, v187
v_add_u32 v241, 0x200, v241
s_add_u32 s53, s46, 0
v_mfma_f32_16x16x32_bf16 v[188:191], a[80:83], v[208:211], v[188:191]
s_nop 2
v_mfma_f32_16x16x32_bf16 v[184:187], a[64:67], v[208:211], 0
s_nop 2
v_mfma_f32_16x16x32_bf16 v[184:187], a[72:75], v[196:199], v[184:187]
v_cvt_pk_bf16_f32 v42, v188, v189
v_cvt_pk_bf16_f32 v43, v190, v191
v_mfma_f32_16x16x32_bf16 v[184:187], a[76:79], v[192:195], v[184:187]
v_mfma_f32_16x16x32_bf16 v[184:187], a[68:71], v[204:207], v[184:187]
s_nop 2
v_mfma_f32_16x16x32_bf16 v[188:191], a[4:7], v[204:207], 0
s_nop 2
v_mfma_f32_16x16x32_bf16 v[188:191], a[0:3], v[208:211], v[188:191]
v_cvt_pk_bf16_f32 v41, v186, v187
v_cvt_pk_bf16_f32 v40, v184, v185
v_mfma_f32_16x16x32_bf16 v[188:191], a[8:11], v[196:199], v[188:191]
v_mfma_f32_16x16x32_bf16 v[188:191], a[12:15], v[192:195], v[188:191]
s_nop 2
v_mfma_f32_16x16x32_bf16 v[184:187], a[28:31], v[192:195], 0
s_nop 2
v_mfma_f32_16x16x32_bf16 v[184:187], a[24:27], v[196:199], v[184:187]
v_cvt_pk_bf16_f32 v112, v188, v189
v_cvt_pk_bf16_f32 v113, v190, v191
v_mfma_f32_16x16x32_bf16 v[184:187], a[20:23], v[204:207], v[184:187]
v_mfma_f32_16x16x32_bf16 v[184:187], a[16:19], v[208:211], v[184:187]
s_nop 2
v_mfma_f32_16x16x32_bf16 v[188:191], a[32:35], v[208:211], 0
s_nop 2
v_mfma_f32_16x16x32_bf16 v[188:191], a[36:39], v[204:207], v[188:191]
s_add_u32 m0, s49, 14784
v_cvt_pk_bf16_f32 v114, v184, v185
v_cvt_pk_bf16_f32 v115, v186, v187
v_mfma_f32_16x16x32_bf16 v[188:191], a[40:43], v[196:199], v[188:191]
s_add_u32 s48, s48, s51
buffer_load_dwordx4 v237, s[16:19], s48 offen nt lds
v_mfma_f32_16x16x32_bf16 v[188:191], a[44:47], v[192:195], v[188:191]
s_nop 2
v_mfma_f32_16x16x32_bf16 v[184:187], a[60:63], v[192:195], 0
s_nop 2
v_mfma_f32_16x16x32_bf16 v[184:187], a[56:59], v[196:199], v[184:187]
v_cvt_pk_bf16_f32 v116, v188, v189
v_cvt_pk_bf16_f32 v117, v190, v191
v_mfma_f32_16x16x32_bf16 v[184:187], a[52:55], v[204:207], v[184:187]
v_mfma_f32_16x16x32_bf16 v[184:187], a[48:51], v[208:211], v[184:187]
s_nop 2
v_mfma_f32_16x16x32_bf16 v[152:155], a[192:195], v[208:211], 0
s_nop 2
v_mfma_f32_16x16x32_bf16 v[152:155], a[196:199], v[204:207], v[152:155]
v_cvt_pk_bf16_f32 v118, v184, v185
v_cvt_pk_bf16_f32 v119, v186, v187
v_mfma_f32_16x16x32_bf16 v[152:155], a[200:203], v[196:199], v[152:155]
v_mfma_f32_16x16x32_bf16 v[152:155], a[204:207], v[192:195], v[152:155]
v_mfma_f32_16x16x32_bf16 v[156:159], a[220:223], v[192:195], 0
v_mfma_f32_16x16x32_bf16 v[156:159], a[216:219], v[196:199], v[156:159]
v_mfma_f32_16x16x32_bf16 v[156:159], a[212:215], v[204:207], v[156:159]
v_mfma_f32_16x16x32_bf16 v[156:159], a[208:211], v[208:211], v[156:159]
v_mfma_f32_16x16x32_bf16 v[160:163], a[224:227], v[208:211], 0
v_mfma_f32_16x16x32_bf16 v[160:163], a[228:231], v[204:207], v[160:163]
v_mfma_f32_16x16x32_bf16 v[160:163], a[232:235], v[196:199], v[160:163]
v_mfma_f32_16x16x32_bf16 v[160:163], a[236:239], v[192:195], v[160:163]
v_mfma_f32_16x16x32_bf16 v[164:167], a[252:255], v[192:195], 0
v_mfma_f32_16x16x32_bf16 v[164:167], a[248:251], v[196:199], v[164:167]
s_add_u32 s48, s48, s51
s_add_u32 m0, s49, 16896
v_mfma_f32_16x16x32_bf16 v[164:167], a[244:247], v[204:207], v[164:167]
buffer_load_dwordx4 v237, s[16:19], s48 offen nt lds
v_mfma_f32_16x16x32_bf16 v[164:167], a[240:243], v[208:211], v[164:167]
v_mfma_f32_16x16x32_bf16 v[184:187], v[0:3], v[112:115], 0
v_mfma_f32_16x16x32_bf16 v[184:187], v[4:7], v[116:119], v[184:187]
s_nop 2
v_mfma_f32_16x16x32_bf16 v[188:191], v[12:15], v[116:119], 0
s_nop 2
v_mfma_f32_16x16x32_bf16 v[188:191], v[8:11], v[112:115], v[188:191]
v_max3_f32 v254, v184, v185, v186
s_nop 0
v_mfma_f32_16x16x32_bf16 v[200:203], v[16:19], v[112:115], 0
s_nop 2
v_mfma_f32_16x16x32_bf16 v[200:203], v[20:23], v[116:119], v[200:203]
s_nop 0
v_max3_f32 v254, v254, v187, v188
v_max3_f32 v254, v254, v189, v190
v_mfma_f32_16x16x32_bf16 v[212:215], v[28:31], v[116:119], 0
s_nop 2
v_mfma_f32_16x16x32_bf16 v[212:215], v[24:27], v[112:115], v[212:215]
v_max3_f32 v254, v254, v191, v200
v_max3_f32 v254, v254, v201, v202
v_mfma_f32_16x16x32_bf16 v[216:219], v[32:35], v[112:115], 0
s_nop 2
v_mfma_f32_16x16x32_bf16 v[216:219], v[36:39], v[116:119], v[216:219]
s_nop 0
v_max3_f32 v254, v254, v203, v212
v_max3_f32 v254, v254, v213, v214
v_mfma_f32_16x16x32_bf16 v[220:223], v[44:47], v[116:119], 0
s_nop 2
v_mfma_f32_16x16x32_bf16 v[220:223], v[40:43], v[112:115], v[220:223]
v_max3_f32 v254, v254, v215, v216
v_max3_f32 v254, v254, v217, v218
v_mfma_f32_16x16x32_bf16 v[224:227], v[48:51], v[112:115], 0
s_nop 2
v_mfma_f32_16x16x32_bf16 v[224:227], v[52:55], v[116:119], v[224:227]
s_nop 0
v_max3_f32 v254, v254, v219, v220
v_max3_f32 v254, v254, v221, v222
v_mfma_f32_16x16x32_bf16 v[228:231], v[208:211], a[128:131], 0
s_nop 2
v_mfma_f32_16x16x32_bf16 v[228:231], v[204:207], a[132:135], v[228:231]
v_max3_f32 v254, v254, v223, v224
v_mfma_f32_16x16x32_bf16 v[228:231], v[196:199], a[136:139], v[228:231]
ds_swizzle_b32 v255, v254 offset:0x401F
v_mfma_f32_16x16x32_bf16 v[228:231], v[192:195], a[140:143], v[228:231]
s_add_u32 m0, s49, 19008
s_add_u32 s48, s48, s51
buffer_load_dwordx4 v237, s[16:19], s48 offen nt lds
v_mfma_f32_16x16x32_bf16 v[232:235], v[192:195], a[156:159], 0
s_nop 2
v_mfma_f32_16x16x32_bf16 v[232:235], v[196:199], a[152:155], v[232:235]
v_cvt_pk_bf16_f32 v91, v230, v231
v_cvt_pk_bf16_f32 v90, v228, v229
v_mfma_f32_16x16x32_bf16 v[232:235], v[204:207], a[148:151], v[232:235]
v_mfma_f32_16x16x32_bf16 v[232:235], v[208:211], a[144:147], v[232:235]
s_nop 2
v_mfma_f32_16x16x32_bf16 v[228:231], v[208:211], a[160:163], 0
s_waitcnt lgkmcnt(0)
v_max_f32 v254, v254, v255
s_nop 0
v_mfma_f32_16x16x32_bf16 v[228:231], v[204:207], a[164:167], v[228:231]
ds_bpermute_b32 v255, v247, v254
v_mfma_f32_16x16x32_bf16 v[228:231], v[196:199], a[168:171], v[228:231]
v_cvt_pk_bf16_f32 v95, v234, v235
v_cvt_pk_bf16_f32 v94, v232, v233
v_mfma_f32_16x16x32_bf16 v[228:231], v[192:195], a[172:175], v[228:231]
s_nop 2
v_mfma_f32_16x16x32_bf16 v[232:235], v[192:195], a[188:191], 0
ds_read_b128 v[192:195], v236 offset:4224
s_nop 0
v_mfma_f32_16x16x32_bf16 v[232:235], v[204:207], a[180:183], v[232:235]
ds_read_b128 v[204:207], v236 offset:4480
v_cvt_pk_bf16_f32 v99, v230, v231
v_mfma_f32_16x16x32_bf16 v[232:235], v[208:211], a[176:179], v[232:235]
ds_read_b128 v[208:211], v236 offset:4736
v_cvt_pk_bf16_f32 v98, v228, v229
v_mfma_f32_16x16x32_bf16 v[232:235], v[196:199], a[184:187], v[232:235]
s_waitcnt lgkmcnt(3)
ds_read_b128 v[196:199], v236 offset:4992
v_max_f32 v254, v254, v255
v_sub_f32 v184, v184, v254
v_sub_f32 v185, v185, v254
v_exp_f32 v184, v184
v_exp_f32 v185, v185
v_sub_f32 v187, v187, v254
v_cvt_pk_bf16_f32 v103, v234, v235
v_cvt_pk_bf16_f32 v102, v232, v233
v_add_f32 v248, v184, v185
v_sub_f32 v186, v186, v254
v_exp_f32 v186, v186
v_cvt_pk_bf16_f32 v120, v184, v185
v_add_f32 v248, v248, v186
s_waitcnt lgkmcnt(1)
v_mfma_f32_16x16x32_bf16 v[228:231], v[208:211], a[184:187], 0
v_sub_f32 v188, v188, v254
s_waitcnt lgkmcnt(0)
v_mfma_f32_16x16x32_bf16 v[228:231], v[196:199], a[188:191], v[228:231]
v_exp_f32 v187, v187
v_mfma_f32_16x16x32_bf16 v[228:231], v[204:207], a[180:183], v[228:231]
v_cvt_pk_bf16_f32 v121, v186, v187
v_add_f32 v248, v248, v187
v_mfma_f32_16x16x32_bf16 v[228:231], v[192:195], a[176:179], v[228:231]
v_sub_f32 v189, v189, v254
v_sub_f32 v190, v190, v254
v_mfma_f32_16x16x32_bf16 v[232:235], v[192:195], a[160:163], 0
v_exp_f32 v189, v189
v_mfma_f32_16x16x32_bf16 v[232:235], v[204:207], a[164:167], v[232:235]
v_exp_f32 v190, v190
v_mfma_f32_16x16x32_bf16 v[232:235], v[208:211], a[168:171], v[232:235]
s_nop 0
v_cvt_pk_bf16_f32 v71, v230, v231
v_cvt_pk_bf16_f32 v70, v228, v229
v_mfma_f32_16x16x32_bf16 v[232:235], v[196:199], a[172:175], v[232:235]
s_add_u32 s48, s48, s51
v_exp_f32 v188, v188
v_mfma_f32_16x16x32_bf16 v[228:231], v[196:199], a[156:159], 0
s_add_u32 m0, s49, 21120
v_add_f32 v248, v248, v188
v_sub_f32 v191, v191, v254
v_mfma_f32_16x16x32_bf16 v[228:231], v[208:211], a[152:155], v[228:231]
buffer_load_dwordx4 v237, s[16:19], s48 offen nt lds
v_cvt_pk_bf16_f32 v66, v232, v233
v_mfma_f32_16x16x32_bf16 v[228:231], v[204:207], a[148:151], v[228:231]
v_cvt_pk_bf16_f32 v67, v234, v235
v_add_f32 v248, v248, v189
v_mfma_f32_16x16x32_bf16 v[228:231], v[192:195], a[144:147], v[228:231]
v_exp_f32 v191, v191
v_mfma_f32_16x16x32_bf16 v[232:235], v[192:195], a[128:131], 0
ds_read_b128 v[192:195], v236 offset:0
v_cvt_pk_bf16_f32 v122, v188, v189
v_mfma_f32_16x16x32_bf16 v[232:235], v[208:211], a[136:139], v[232:235]
ds_read_b128 v[208:211], v236 offset:256
v_add_f32 v248, v248, v190
v_mfma_f32_16x16x32_bf16 v[232:235], v[196:199], a[140:143], v[232:235]
ds_read_b128 v[196:199], v236 offset:512
v_cvt_pk_bf16_f32 v62, v228, v229
v_mfma_f32_16x16x32_bf16 v[232:235], v[204:207], a[132:135], v[232:235]
ds_read_b128 v[204:207], v236 offset:768
v_cvt_pk_bf16_f32 v63, v230, v231
v_add_f32 v248, v248, v191
v_cvt_pk_bf16_f32 v123, v190, v191
v_sub_f32 v200, v200, v254
v_exp_f32 v200, v200
v_sub_f32 v201, v201, v254
v_exp_f32 v201, v201
v_cvt_pk_bf16_f32 v59, v234, v235
v_cvt_pk_bf16_f32 v58, v232, v233
v_sub_f32 v203, v203, v254
s_waitcnt lgkmcnt(2)
v_mfma_f32_16x16x32_bf16 v[228:231], v[208:211], a[132:135], 0
ds_read_b128 v[188:191], v242 offset:64
v_sub_f32 v202, v202, v254
v_mfma_f32_16x16x32_bf16 v[228:231], v[192:195], a[128:131], v[228:231]
s_waitcnt lgkmcnt(2)
v_exp_f32 v203, v203
v_mfma_f32_16x16x32_bf16 v[228:231], v[196:199], a[136:139], v[228:231]
s_waitcnt lgkmcnt(1)
v_exp_f32 v202, v202
v_mfma_f32_16x16x32_bf16 v[228:231], v[204:207], a[140:143], v[228:231]
v_add_f32 v248, v248, v200
v_add_f32 v248, v248, v201
v_mfma_f32_16x16x32_bf16 v[184:187], v[204:207], a[156:159], 0
v_add_f32 v248, v248, v202
v_add_f32 v248, v248, v203
v_mfma_f32_16x16x32_bf16 v[184:187], v[196:199], a[152:155], v[184:187]
v_cvt_pk_bf16_f32 v124, v200, v201
v_cvt_pk_bf16_f32 v125, v202, v203
v_mfma_f32_16x16x32_bf16 v[184:187], v[208:211], a[148:151], v[184:187]
s_waitcnt lgkmcnt(0)
v_cvt_pk_bf16_f32 v56, v228, v229
v_cvt_pk_bf16_f32 v57, v230, v231
v_mfma_f32_16x16x32_bf16 v[184:187], v[192:195], a[144:147], v[184:187]
v_sub_f32 v212, v212, v254
v_sub_f32 v213, v213, v254
v_mfma_f32_16x16x32_bf16 v[228:231], v[192:195], a[160:163], 0
v_exp_f32 v212, v212
v_mfma_f32_16x16x32_bf16 v[228:231], v[208:211], a[164:167], v[228:231]
v_sub_f32 v214, v214, v254
v_add_f32 v248, v248, v212
v_mfma_f32_16x16x32_bf16 v[228:231], v[196:199], a[168:171], v[228:231]
v_cvt_pk_bf16_f32 v60, v184, v185
v_cvt_pk_bf16_f32 v61, v186, v187
v_mfma_f32_16x16x32_bf16 v[228:231], v[204:207], a[172:175], v[228:231]
s_add_u32 m0, s49, 23232
ds_read_b128 v[184:187], v242 offset:0
v_sub_f32 v215, v215, v254
v_mfma_f32_16x16x32_bf16 v[232:235], v[204:207], a[188:191], 0
s_add_u32 s48, s48, s51
buffer_load_dwordx4 v237, s[16:19], s48 offen nt lds
v_sub_f32 v216, v216, v254
v_mfma_f32_16x16x32_bf16 v[232:235], v[196:199], a[184:187], v[232:235]
s_sub_u32 s49, s49, s56
v_exp_f32 v213, v213
v_mfma_f32_16x16x32_bf16 v[232:235], v[208:211], a[180:183], v[232:235]
s_and_b32 s51, s57, 26212352
v_exp_f32 v214, v214
v_mfma_f32_16x16x32_bf16 v[232:235], v[192:195], a[176:179], v[232:235]
s_add_u32 s51, s51, 2048
v_cvt_pk_bf16_f32 v126, v212, v213
v_add_f32 v248, v248, v213
v_mfma_f32_16x16x32_bf16 v[200:203], v[4:7], v[188:191], 0
v_add_f32 v248, v248, v214
s_waitcnt lgkmcnt(0)
v_mfma_f32_16x16x32_bf16 v[200:203], v[0:3], v[184:187], v[200:203]
s_nop 0
v_cvt_pk_bf16_f32 v69, v234, v235
v_cvt_pk_bf16_f32 v68, v232, v233
v_mfma_f32_16x16x32_bf16 v[232:235], v[32:35], v[184:187], 0
ds_read_b128 v[184:187], v245 offset:64
v_sub_f32 v218, v218, v254
v_mfma_f32_16x16x32_bf16 v[232:235], v[36:39], v[188:191], v[232:235]
ds_read_b128 v[188:191], v243 offset:0
v_exp_f32 v215, v215
s_nop 0
v_add_f32 v248, v248, v215
v_cvt_pk_bf16_f32 v127, v214, v215
ds_read_b128 v[212:215], v243 offset:64
v_exp_f32 v216, v216
v_sub_f32 v217, v217, v254
v_add_f32 v248, v248, v216
v_exp_f32 v218, v218
v_sub_f32 v219, v219, v254
v_exp_f32 v217, v217
v_exp_f32 v219, v219
v_cvt_pk_bf16_f32 v128, v216, v217
v_cvt_pk_bf16_f32 v129, v218, v219
v_add_f32 v248, v248, v217
v_add_f32 v248, v248, v218
v_add_f32 v248, v248, v219
v_cvt_pk_bf16_f32 v64, v228, v229
v_cvt_pk_bf16_f32 v65, v230, v231
v_sub_f32 v220, v220, v254
v_sub_f32 v221, v221, v254
s_waitcnt lgkmcnt(0)
v_mfma_f32_16x16x32_bf16 v[200:203], v[12:15], v[212:215], v[200:203]
ds_read_b128 v[216:219], v244 offset:0
ds_read_b128 v[228:231], v245 offset:0
v_mfma_f32_16x16x32_bf16 v[200:203], v[8:11], v[188:191], v[200:203]
v_exp_f32 v220, v220
v_mfma_f32_16x16x32_bf16 v[232:235], v[40:43], v[188:191], v[232:235]
ds_read_b128 v[188:191], v244 offset:64
v_add_f32 v248, v248, v220
v_mfma_f32_16x16x32_bf16 v[232:235], v[44:47], v[212:215], v[232:235]
v_exp_f32 v221, v221
v_sub_f32 v223, v223, v254
v_add_f32 v248, v248, v221
v_exp_f32 v223, v223
v_sub_f32 v222, v222, v254
v_exp_f32 v222, v222
v_cvt_pk_bf16_f32 v130, v220, v221
v_mov_b32 v221, 0xff800000
v_add_f32 v248, v248, v222
v_cvt_pk_bf16_f32 v131, v222, v223
v_add_f32 v248, v248, v223
v_sub_f32 v224, v224, v254
v_exp_f32 v224, v224
s_waitcnt lgkmcnt(0)
v_mfma_f32_16x16x32_bf16 v[200:203], v[20:23], v[188:191], v[200:203]
v_cvt_pk_bf16_f32 v132, v224, 0
v_add_f32 v248, v248, v224
v_mfma_f32_16x16x32_bf16 v[200:203], v[16:19], v[216:219], v[200:203]
ds_swizzle_b32 v250, v248 offset:0x401F
v_add_u32 v245, 0x200, v245
v_mfma_f32_16x16x32_bf16 v[232:235], v[48:51], v[216:219], v[232:235]
v_add_u32 v244, 0x200, v244
v_add_u32 v243, 0x200, v243
v_mfma_f32_16x16x32_bf16 v[232:235], v[52:55], v[188:191], v[232:235]
v_add_u32 v242, 0x200, v242
s_nop 0
v_mfma_f32_16x16x32_bf16 v[200:203], v[24:27], v[228:231], v[200:203]
s_nop 2
v_mfma_f32_16x16x32_bf16 v[200:203], v[28:31], v[184:187], v[200:203]
s_nop 0
v_mov_b32_dpp v233, v221 quad_perm:[0,1,2,3] row_mask:0xf bank_mask:0xc
v_mov_b32_dpp v232, v221 quad_perm:[0,1,2,3] row_mask:0xf bank_mask:0x8
v_mfma_f32_16x16x32_bf16 v[184:187], a[0:3], v[192:195], 0
v_mov_b32_dpp v234, v221 quad_perm:[0,1,2,3] row_mask:0xf bank_mask:0xc
v_mov_b32_dpp v235, v221 quad_perm:[0,1,2,3] row_mask:0xf bank_mask:0xc
v_mfma_f32_16x16x32_bf16 v[184:187], a[4:7], v[208:211], v[184:187]
s_waitcnt lgkmcnt(0)
v_max3_f32 v223, v200, v201, v202
v_max3_f32 v223, v223, v203, v232
v_mfma_f32_16x16x32_bf16 v[184:187], a[8:11], v[196:199], v[184:187]
v_max3_f32 v223, v223, v233, v234
v_max_f32 v223, v223, v235
v_mfma_f32_16x16x32_bf16 v[184:187], a[12:15], v[204:207], v[184:187]
s_nop 0
v_max_f32_dpp v223, v223, v223 row_ror:8 row_mask:0xf bank_mask:0xf
v_add_f32 v248, v248, v250
v_mfma_f32_16x16x32_bf16 v[188:191], a[28:31], v[204:207], 0
ds_bpermute_b32 v250, v247, v248
v_mfma_f32_16x16x32_bf16 v[188:191], a[24:27], v[196:199], v[188:191]
v_max_f32_dpp v223, v223, v223 row_ror:4 row_mask:0xf bank_mask:0xf
v_mfma_f32_16x16x32_bf16 v[188:191], a[20:23], v[208:211], v[188:191]
ds_swizzle_b32 v221, v223 offset:0x401F
v_cvt_pk_bf16_f32 v113, v186, v187
v_mfma_f32_16x16x32_bf16 v[188:191], a[16:19], v[192:195], v[188:191]
v_cvt_pk_bf16_f32 v112, v184, v185
s_nop 0
v_mfma_f32_16x16x32_bf16 v[184:187], a[32:35], v[192:195], 0
s_nop 2
v_mfma_f32_16x16x32_bf16 v[184:187], a[36:39], v[208:211], v[184:187]
s_nop 0
v_cvt_pk_bf16_f32 v115, v190, v191
v_cvt_pk_bf16_f32 v114, v188, v189
v_mfma_f32_16x16x32_bf16 v[184:187], a[40:43], v[196:199], v[184:187]
s_waitcnt lgkmcnt(1)
v_add_f32 v248, v248, v250
v_mfma_f32_16x16x32_bf16 v[184:187], a[44:47], v[204:207], v[184:187]
v_rcp_f32 v251, v248
v_mfma_f32_16x16x32_bf16 v[188:191], a[60:63], v[204:207], 0
s_waitcnt lgkmcnt(0)
v_max_f32 v223, v223, v221
s_nop 0
v_mfma_f32_16x16x32_bf16 v[188:191], a[56:59], v[196:199], v[188:191]
ds_bpermute_b32 v221, v247, v223
v_mfma_f32_16x16x32_bf16 v[188:191], a[52:55], v[208:211], v[188:191]
v_cvt_pk_bf16_f32 v117, v186, v187
v_cvt_pk_bf16_f32 v116, v184, v185
v_mfma_f32_16x16x32_bf16 v[188:191], a[48:51], v[192:195], v[188:191]
s_nop 2
v_mfma_f32_16x16x32_bf16 v[168:171], a[192:195], v[192:195], 0
s_nop 2
v_mfma_f32_16x16x32_bf16 v[168:171], a[196:199], v[208:211], v[168:171]
v_cvt_pk_bf16_f32 v119, v190, v191
v_cvt_pk_bf16_f32 v118, v188, v189
v_mfma_f32_16x16x32_bf16 v[168:171], a[200:203], v[196:199], v[168:171]
v_mfma_f32_16x16x32_bf16 v[168:171], a[204:207], v[204:207], v[168:171]
s_waitcnt lgkmcnt(0)
v_max_f32 v223, v223, v221
v_sub_f32 v200, v200, v223
v_mfma_f32_16x16x32_bf16 v[172:175], a[220:223], v[204:207], 0
v_exp_f32 v200, v200
v_mfma_f32_16x16x32_bf16 v[172:175], a[216:219], v[196:199], v[172:175]
v_sub_f32 v201, v201, v223
v_sub_f32 v202, v202, v223
v_mfma_f32_16x16x32_bf16 v[172:175], a[212:215], v[208:211], v[172:175]
v_exp_f32 v202, v202
v_mfma_f32_16x16x32_bf16 v[172:175], a[208:211], v[192:195], v[172:175]
v_exp_f32 v201, v201
v_mfma_f32_16x16x32_bf16 v[176:179], a[224:227], v[192:195], 0
v_add_f32 v220, v200, v201
v_add_f32 v220, v220, v202
v_mfma_f32_16x16x32_bf16 v[176:179], a[228:231], v[208:211], v[176:179]
v_sub_f32 v203, v203, v223
v_sub_f32 v233, v233, v223
v_mfma_f32_16x16x32_bf16 v[176:179], a[232:235], v[196:199], v[176:179]
v_exp_f32 v233, v233
v_mfma_f32_16x16x32_bf16 v[176:179], a[236:239], v[204:207], v[176:179]
v_exp_f32 v203, v203
v_mfma_f32_16x16x32_bf16 v[180:183], a[252:255], v[204:207], 0
v_sub_f32 v232, v232, v223
v_sub_f32 v234, v234, v223
v_mfma_f32_16x16x32_bf16 v[180:183], a[248:251], v[196:199], v[180:183]
v_exp_f32 v232, v232
v_mfma_f32_16x16x32_bf16 v[180:183], a[244:247], v[208:211], v[180:183]
v_exp_f32 v234, v234
v_mfma_f32_16x16x32_bf16 v[180:183], a[240:243], v[192:195], v[180:183]
v_add_f32 v220, v220, v203
v_add_f32 v220, v220, v232
v_mfma_f32_16x16x32_bf16 v[184:187], v[0:3], v[112:115], 0
v_add_f32 v220, v220, v233
v_add_f32 v220, v220, v234
v_mfma_f32_16x16x32_bf16 v[184:187], v[4:7], v[116:119], v[184:187]
v_sub_f32 v235, v235, v223
v_cvt_pk_bf16_f32 v200, v200, v201
v_mfma_f32_16x16x32_bf16 v[188:191], v[12:15], v[116:119], 0
v_exp_f32 v235, v235
v_mfma_f32_16x16x32_bf16 v[188:191], v[8:11], v[112:115], v[188:191]
v_add_f32 v220, v220, v235
v_cvt_pk_bf16_f32 v201, v202, v203
v_mfma_f32_16x16x32_bf16 v[192:195], v[16:19], v[112:115], 0
v_cvt_pk_bf16_f32 v202, v232, v233
v_cvt_pk_bf16_f32 v203, v234, v235
v_mfma_f32_16x16x32_bf16 v[192:195], v[20:23], v[116:119], v[192:195]
ds_read_b128 v[196:199], v236 offset:8448
v_add_f32_dpp v220, v220, v220 row_ror:8 row_mask:0xf bank_mask:0xf
v_mfma_f32_16x16x32_bf16 v[208:211], v[28:31], v[116:119], 0
ds_read_b128 v[204:207], v236 offset:8704
v_add_f32_dpp v220, v220, v220 row_ror:4 row_mask:0xf bank_mask:0xf
v_mfma_f32_16x16x32_bf16 v[208:211], v[24:27], v[112:115], v[208:211]
ds_write_b32 v246, v220 offset:4096
ds_read_b128 v[212:215], v236 offset:8960
v_mfma_f32_16x16x32_bf16 v[216:219], v[32:35], v[112:115], 0
ds_read_b128 v[224:227], v236 offset:9216
v_max3_f32 v254, v184, v185, v186
v_mfma_f32_16x16x32_bf16 v[216:219], v[36:39], v[116:119], v[216:219]
v_max3_f32 v254, v254, v187, v188
v_max3_f32 v254, v254, v189, v190
v_mfma_f32_16x16x32_bf16 v[228:231], v[44:47], v[116:119], 0
v_max3_f32 v254, v254, v191, v192
v_max3_f32 v254, v254, v193, v194
v_mfma_f32_16x16x32_bf16 v[228:231], v[40:43], v[112:115], v[228:231]
s_waitcnt lgkmcnt(4)
v_max3_f32 v254, v254, v195, v208
v_max3_f32 v254, v254, v209, v210
v_mfma_f32_16x16x32_bf16 v[232:235], v[48:51], v[112:115], 0
s_waitcnt lgkmcnt(3)
v_max3_f32 v254, v254, v211, v216
v_max3_f32 v254, v254, v217, v218
v_mfma_f32_16x16x32_bf16 v[232:235], v[52:55], v[116:119], v[232:235]
s_waitcnt lgkmcnt(1)
v_max3_f32 v254, v254, v219, v228
v_max3_f32 v254, v254, v229, v230
v_mfma_f32_16x16x32_bf16 v[220:223], v[196:199], a[128:131], 0
s_waitcnt lgkmcnt(0)
s_nop 1
v_mfma_f32_16x16x32_bf16 v[220:223], v[204:207], a[132:135], v[220:223]
v_max3_f32 v254, v254, v231, v232
v_mfma_f32_16x16x32_bf16 v[220:223], v[212:215], a[136:139], v[220:223]
ds_swizzle_b32 v255, v254 offset:0x401F
v_mfma_f32_16x16x32_bf16 v[220:223], v[224:227], a[140:143], v[220:223]
s_nop 7
v_cvt_pk_bf16_f32 v73, v222, v223
v_cvt_pk_bf16_f32 v72, v220, v221
v_mfma_f32_16x16x32_bf16 v[220:223], v[224:227], a[156:159], 0
v_mfma_f32_16x16x32_bf16 v[220:223], v[212:215], a[152:155], v[220:223]
v_mfma_f32_16x16x32_bf16 v[220:223], v[204:207], a[148:151], v[220:223]
s_waitcnt lgkmcnt(0)
v_max_f32 v254, v254, v255
v_mfma_f32_16x16x32_bf16 v[220:223], v[196:199], a[144:147], v[220:223]
ds_bpermute_b32 v255, v247, v254
s_nop 6
v_cvt_pk_bf16_f32 v76, v220, v221
v_cvt_pk_bf16_f32 v77, v222, v223
v_mfma_f32_16x16x32_bf16 v[220:223], v[196:199], a[160:163], 0
v_mfma_f32_16x16x32_bf16 v[220:223], v[204:207], a[164:167], v[220:223]
v_mfma_f32_16x16x32_bf16 v[220:223], v[212:215], a[168:171], v[220:223]
s_waitcnt lgkmcnt(0)
v_max_f32 v254, v254, v255
v_mfma_f32_16x16x32_bf16 v[220:223], v[224:227], a[172:175], v[220:223]
v_sub_f32 v184, v184, v254
v_exp_f32 v184, v184
v_sub_f32 v185, v185, v254
v_sub_f32 v187, v187, v254
v_exp_f32 v185, v185
s_nop 2
v_cvt_pk_bf16_f32 v81, v222, v223
v_cvt_pk_bf16_f32 v80, v220, v221
v_mfma_f32_16x16x32_bf16 v[220:223], v[224:227], a[188:191], 0
ds_read_b128 v[224:227], v236 offset:12672
v_add_f32 v249, v184, v185
v_mfma_f32_16x16x32_bf16 v[220:223], v[204:207], a[180:183], v[220:223]
ds_read_b128 v[204:207], v236 offset:12928
v_sub_f32 v186, v186, v254
v_mfma_f32_16x16x32_bf16 v[220:223], v[196:199], a[176:179], v[220:223]
ds_read_b128 v[196:199], v236 offset:13184
v_cvt_pk_bf16_f32 v136, v184, v185
v_mfma_f32_16x16x32_bf16 v[220:223], v[212:215], a[184:187], v[220:223]
ds_read_b128 v[212:215], v236 offset:13440
v_exp_f32 v186, v186
v_exp_f32 v187, v187
v_add_f32 v249, v249, v186
v_add_f32 v249, v249, v187
v_cvt_pk_bf16_f32 v137, v186, v187
v_sub_f32 v189, v189, v254
v_sub_f32 v188, v188, v254
v_cvt_pk_bf16_f32 v84, v220, v221
v_cvt_pk_bf16_f32 v85, v222, v223
v_exp_f32 v188, v188
v_exp_f32 v189, v189
v_sub_f32 v191, v191, v254
s_waitcnt lgkmcnt(1)
v_mfma_f32_16x16x32_bf16 v[184:187], v[196:199], a[184:187], 0
v_sub_f32 v190, v190, v254
s_waitcnt lgkmcnt(0)
v_mfma_f32_16x16x32_bf16 v[184:187], v[212:215], a[188:191], v[184:187]
v_exp_f32 v190, v190
v_mfma_f32_16x16x32_bf16 v[184:187], v[204:207], a[180:183], v[184:187]
v_exp_f32 v191, v191
v_mfma_f32_16x16x32_bf16 v[184:187], v[224:227], a[176:179], v[184:187]
v_add_f32 v249, v249, v188
v_add_f32 v249, v249, v189
v_mfma_f32_16x16x32_bf16 v[220:223], v[224:227], a[160:163], 0
v_add_f32 v249, v249, v190
v_cvt_pk_bf16_f32 v139, v190, v191
v_mfma_f32_16x16x32_bf16 v[220:223], v[204:207], a[164:167], v[220:223]
v_cvt_pk_bf16_f32 v138, v188, v189
v_add_f32 v249, v249, v191
v_mfma_f32_16x16x32_bf16 v[220:223], v[196:199], a[168:171], v[220:223]
v_cvt_pk_bf16_f32 v86, v184, v185
v_cvt_pk_bf16_f32 v87, v186, v187
v_mfma_f32_16x16x32_bf16 v[220:223], v[212:215], a[172:175], v[220:223]
v_sub_f32 v192, v192, v254
v_sub_f32 v194, v194, v254
v_mfma_f32_16x16x32_bf16 v[184:187], v[212:215], a[156:159], 0
v_exp_f32 v192, v192
v_mfma_f32_16x16x32_bf16 v[184:187], v[196:199], a[152:155], v[184:187]
v_add_f32 v249, v249, v192
v_sub_f32 v193, v193, v254
v_mfma_f32_16x16x32_bf16 v[184:187], v[204:207], a[148:151], v[184:187]
v_cvt_pk_bf16_f32 v83, v222, v223
v_cvt_pk_bf16_f32 v82, v220, v221
v_mfma_f32_16x16x32_bf16 v[184:187], v[224:227], a[144:147], v[184:187]
v_exp_f32 v193, v193
v_mfma_f32_16x16x32_bf16 v[220:223], v[224:227], a[128:131], 0
ds_read_b128 v[224:227], v236 offset:16896
v_sub_f32 v209, v209, v254
v_mfma_f32_16x16x32_bf16 v[220:223], v[196:199], a[136:139], v[220:223]
ds_read_b128 v[196:199], v236 offset:17152
v_sub_f32 v208, v208, v254
v_mfma_f32_16x16x32_bf16 v[220:223], v[212:215], a[140:143], v[220:223]
ds_read_b128 v[212:215], v236 offset:17408
v_cvt_pk_bf16_f32 v79, v186, v187
v_mfma_f32_16x16x32_bf16 v[220:223], v[204:207], a[132:135], v[220:223]
ds_read_b128 v[204:207], v236 offset:17664
v_cvt_pk_bf16_f32 v78, v184, v185
v_exp_f32 v208, v208
v_exp_f32 v209, v209
v_exp_f32 v194, v194
v_add_f32 v249, v249, v193
v_add_f32 v249, v249, v194
v_sub_f32 v195, v195, v254
v_cvt_pk_bf16_f32 v74, v220, v221
v_cvt_pk_bf16_f32 v75, v222, v223
s_waitcnt lgkmcnt(2)
v_mfma_f32_16x16x32_bf16 v[184:187], v[196:199], a[132:135], 0
v_exp_f32 v195, v195
v_mfma_f32_16x16x32_bf16 v[184:187], v[224:227], a[128:131], v[184:187]
s_waitcnt lgkmcnt(1)
v_sub_f32 v216, v216, v254
v_sub_f32 v211, v211, v254
v_mfma_f32_16x16x32_bf16 v[184:187], v[212:215], a[136:139], v[184:187]
s_waitcnt lgkmcnt(0)
v_sub_f32 v210, v210, v254
v_add_f32 v249, v249, v195
v_mfma_f32_16x16x32_bf16 v[184:187], v[204:207], a[140:143], v[184:187]
v_exp_f32 v211, v211
v_mfma_f32_16x16x32_bf16 v[220:223], v[204:207], a[156:159], 0
v_exp_f32 v210, v210
v_mfma_f32_16x16x32_bf16 v[220:223], v[212:215], a[152:155], v[220:223]
v_add_f32 v249, v249, v208
v_sub_f32 v219, v219, v254
v_mfma_f32_16x16x32_bf16 v[220:223], v[196:199], a[148:151], v[220:223]
s_nop 0
v_cvt_pk_bf16_f32 v89, v186, v187
v_cvt_pk_bf16_f32 v88, v184, v185
v_mfma_f32_16x16x32_bf16 v[220:223], v[224:227], a[144:147], v[220:223]
v_exp_f32 v216, v216
v_mfma_f32_16x16x32_bf16 v[184:187], v[224:227], a[160:163], 0
v_sub_f32 v217, v217, v254
v_add_f32 v249, v249, v209
v_mfma_f32_16x16x32_bf16 v[184:187], v[196:199], a[164:167], v[184:187]
v_sub_f32 v228, v228, v254
v_add_f32 v249, v249, v210
v_mfma_f32_16x16x32_bf16 v[184:187], v[212:215], a[168:171], v[184:187]
v_exp_f32 v217, v217
v_mfma_f32_16x16x32_bf16 v[184:187], v[204:207], a[172:175], v[184:187]
v_sub_f32 v229, v229, v254
v_sub_f32 v218, v218, v254
v_mfma_f32_16x16x32_bf16 v[188:191], v[204:207], a[188:191], 0
v_exp_f32 v218, v218
v_mfma_f32_16x16x32_bf16 v[188:191], v[212:215], a[184:187], v[188:191]
v_add_f32 v249, v249, v211
v_add_f32 v249, v249, v216
v_mfma_f32_16x16x32_bf16 v[188:191], v[196:199], a[180:183], v[188:191]
v_cvt_pk_bf16_f32 v96, v184, v185
v_cvt_pk_bf16_f32 v97, v186, v187
v_mfma_f32_16x16x32_bf16 v[188:191], v[224:227], a[176:179], v[188:191]
v_exp_f32 v219, v219
v_mfma_f32_16x16x32_bf16 v[184:187], a[0:3], v[224:227], 0
v_add_f32 v249, v249, v217
v_add_f32 v249, v249, v218
v_mfma_f32_16x16x32_bf16 v[184:187], a[4:7], v[196:199], v[184:187]
v_add_f32 v249, v249, v219
v_cvt_pk_bf16_f32 v144, v216, v217
v_mfma_f32_16x16x32_bf16 v[184:187], a[8:11], v[212:215], v[184:187]
v_cvt_pk_bf16_f32 v100, v188, v189
v_cvt_pk_bf16_f32 v101, v190, v191
v_mfma_f32_16x16x32_bf16 v[184:187], a[12:15], v[204:207], v[184:187]
v_cvt_pk_bf16_f32 v145, v218, v219
v_cvt_pk_bf16_f32 v92, v220, v221
v_mfma_f32_16x16x32_bf16 v[188:191], a[28:31], v[204:207], 0
v_cvt_pk_bf16_f32 v93, v222, v223
v_sub_f32 v232, v232, v254
v_mfma_f32_16x16x32_bf16 v[188:191], a[24:27], v[212:215], v[188:191]
v_exp_f32 v228, v228
v_mfma_f32_16x16x32_bf16 v[188:191], a[20:23], v[196:199], v[188:191]
v_cvt_pk_bf16_f32 v112, v184, v185
v_cvt_pk_bf16_f32 v113, v186, v187
v_mfma_f32_16x16x32_bf16 v[188:191], a[16:19], v[224:227], v[188:191]
v_exp_f32 v229, v229
v_mfma_f32_16x16x32_bf16 v[184:187], a[32:35], v[224:227], 0
v_add_f32 v249, v249, v228
v_sub_f32 v231, v231, v254
v_mfma_f32_16x16x32_bf16 v[184:187], a[36:39], v[196:199], v[184:187]
v_exp_f32 v232, v232
v_mfma_f32_16x16x32_bf16 v[184:187], a[40:43], v[212:215], v[184:187]
s_nop 0
v_cvt_pk_bf16_f32 v115, v190, v191
v_cvt_pk_bf16_f32 v114, v188, v189
v_mfma_f32_16x16x32_bf16 v[184:187], a[44:47], v[204:207], v[184:187]
v_sub_f32 v230, v230, v254
v_add_f32 v249, v249, v229
v_mfma_f32_16x16x32_bf16 v[188:191], a[60:63], v[204:207], 0
v_cvt_pk_bf16_f32 v140, v192, v193
v_mov_b32 v192, v202
v_mfma_f32_16x16x32_bf16 v[188:191], a[56:59], v[212:215], v[188:191]
v_cvt_pk_bf16_f32 v142, v208, v209
v_mov_b32_dpp v209, v201 row_ror:8 row_mask:0xf bank_mask:0xf
v_mfma_f32_16x16x32_bf16 v[188:191], a[52:55], v[196:199], v[188:191]
v_cvt_pk_bf16_f32 v116, v184, v185
v_cvt_pk_bf16_f32 v117, v186, v187
v_mfma_f32_16x16x32_bf16 v[188:191], a[48:51], v[224:227], v[188:191]
v_mov_b32_dpp v208, v200 row_ror:8 row_mask:0xf bank_mask:0xf
v_cvt_pk_bf16_f32 v143, v210, v211
v_mfma_f32_16x16x32_bf16 v[216:219], v[56:59], v[120:123], 0
v_mov_b32_dpp v211, v201 row_ror:4 row_mask:0xf bank_mask:0xf
v_mov_b32_dpp v210, v200 row_ror:4 row_mask:0xf bank_mask:0xf
v_mfma_f32_16x16x32_bf16 v[216:219], v[104:107], v[132:135], v[216:219]
v_cvt_pk_bf16_f32 v141, v194, v195
v_mov_b32_dpp v194, v202 row_ror:12 row_mask:0xf bank_mask:0xf
v_mfma_f32_16x16x32_bf16 v[216:219], v[72:75], v[124:127], v[216:219]
v_cvt_pk_bf16_f32 v118, v188, v189
v_cvt_pk_bf16_f32 v119, v190, v191
v_mfma_f32_16x16x32_bf16 v[216:219], v[88:91], v[128:131], v[216:219]
v_mov_b32_dpp v195, v203 row_ror:12 row_mask:0xf bank_mask:0xf
v_mov_b32 v193, v203
v_mfma_f32_16x16x32_bf16 v[220:223], v[92:95], v[128:131], 0
v_mov_b32_dpp v203, v201 row_ror:12 row_mask:0xf bank_mask:0xf
v_mov_b32_dpp v202, v200 row_ror:12 row_mask:0xf bank_mask:0xf
v_mfma_f32_16x16x32_bf16 v[220:223], v[76:79], v[124:127], v[220:223]
v_exp_f32 v230, v230
v_mfma_f32_16x16x32_bf16 v[220:223], v[106:109], v[132:135], v[220:223]
v_fmac_f32 v154, v218, v251
v_fmac_f32 v152, v216, v251
v_mfma_f32_16x16x32_bf16 v[220:223], v[60:63], v[120:123], v[220:223]
v_fmac_f32 v155, v219, v251
v_fmac_f32 v153, v217, v251
v_mfma_f32_16x16x32_bf16 v[188:191], v[64:67], v[120:123], 0
v_exp_f32 v231, v231
v_mfma_f32_16x16x32_bf16 v[188:191], v[108:111], v[132:135], v[188:191]
v_add_f32 v249, v249, v230
v_add_f32 v249, v249, v231
v_mfma_f32_16x16x32_bf16 v[188:191], v[80:83], v[124:127], v[188:191]
v_cvt_pk_bf16_f32 v146, v228, v229
v_cvt_pk_bf16_f32 v147, v230, v231
v_mfma_f32_16x16x32_bf16 v[188:191], v[96:99], v[128:131], v[188:191]
v_add_f32 v249, v249, v232
v_fmac_f32 v156, v220, v251
v_mfma_f32_16x16x32_bf16 v[184:187], v[100:103], v[128:131], 0
ds_swizzle_b32 v250, v249 offset:0x401F
v_fmac_f32 v158, v222, v251
v_mfma_f32_16x16x32_bf16 v[184:187], v[84:87], v[124:127], v[184:187]
v_fmac_f32 v157, v221, v251
v_fmac_f32 v159, v223, v251
v_mfma_f32_16x16x32_bf16 v[184:187], v[68:71], v[120:123], v[184:187]
v_fmac_f32 v161, v189, v251
v_fmac_f32 v160, v188, v251
v_mfma_f32_16x16x32_bf16 v[184:187], v[110:113], v[132:135], v[184:187]
v_mov_b32_dpp v132, v192 row_ror:8 row_mask:0xf bank_mask:0xf
v_fmac_f32 v163, v191, v251
v_fmac_f32 v162, v190, v251
v_mfma_f32_16x16x32_bf16 v[216:219], v[110:113], v[132:135], 0
v_cvt_pk_bf16_f32 v152, v152, v153
v_cvt_pk_bf16_f32 v153, v154, v155
v_mfma_f32_16x16x32_bf16 v[216:219], v[84:87], v[208:211], v[216:219]
s_nop 0
v_fmac_f32 v167, v187, v251
v_fmac_f32 v164, v184, v251
v_mfma_f32_16x16x32_bf16 v[216:219], v[100:103], v[192:195], v[216:219]
s_waitcnt lgkmcnt(0)
v_fmac_f32 v165, v185, v251
v_fmac_f32 v166, v186, v251
v_mfma_f32_16x16x32_bf16 v[216:219], v[68:71], v[200:203], v[216:219]
v_add_f32 v249, v249, v250
v_pk_max_i16 v153, v153, 0
v_mfma_f32_16x16x32_bf16 v[188:191], v[64:67], v[200:203], 0
ds_bpermute_b32 v250, v247, v249
v_mfma_f32_16x16x32_bf16 v[188:191], v[80:83], v[208:211], v[188:191]
v_cvt_pk_bf16_f32 v160, v160, v161
v_cvt_pk_bf16_f32 v161, v162, v163
v_mfma_f32_16x16x32_bf16 v[188:191], v[96:99], v[192:195], v[188:191]
v_cvt_pk_bf16_f32 v216, v216, v217
v_cvt_pk_bf16_f32 v217, v218, v219
v_mfma_f32_16x16x32_bf16 v[188:191], v[108:111], v[132:135], v[188:191]
ds_write_b64 v246, v[216:217] offset:24
v_mfma_f32_16x16x32_bf16 v[228:231], v[106:109], v[132:135], 0
v_cvt_pk_bf16_f32 v162, v164, v165
v_pk_max_i16 v160, v160, 0
v_mfma_f32_16x16x32_bf16 v[228:231], v[76:79], v[208:211], v[228:231]
v_pk_max_i16 v161, v161, 0
v_cvt_pk_bf16_f32 v163, v166, v167
v_mfma_f32_16x16x32_bf16 v[228:231], v[92:95], v[192:195], v[228:231]
s_waitcnt lgkmcnt(1)
v_cvt_pk_bf16_f32 v188, v188, v189
v_cvt_pk_bf16_f32 v189, v190, v191
v_mfma_f32_16x16x32_bf16 v[228:231], v[60:63], v[200:203], v[228:231]
ds_write_b64 v246, v[188:189] offset:16
v_mfma_f32_16x16x32_bf16 v[184:187], v[56:59], v[200:203], 0
v_pk_max_i16 v163, v163, 0
v_cvt_pk_bf16_f32 v155, v158, v159
v_mfma_f32_16x16x32_bf16 v[184:187], v[72:75], v[208:211], v[184:187]
v_pk_max_i16 v162, v162, 0
v_cvt_pk_bf16_f32 v154, v156, v157
v_mfma_f32_16x16x32_bf16 v[184:187], v[88:91], v[192:195], v[184:187]
v_cvt_pk_bf16_f32 v228, v228, v229
v_cvt_pk_bf16_f32 v229, v230, v231
v_mfma_f32_16x16x32_bf16 v[184:187], v[104:107], v[132:135], v[184:187]
ds_write_b64 v246, v[228:229] offset:8
v_mfma_f32_16x16x32_bf16 v[188:191], v[0:3], v[112:115], 0
v_pk_max_i16 v154, v154, 0
v_pk_max_i16 v152, v152, 0
v_mfma_f32_16x16x32_bf16 v[188:191], v[4:7], v[116:119], v[188:191]
v_pk_max_i16 v155, v155, 0
v_add_f32 v249, v249, v250
v_mfma_f32_16x16x32_bf16 v[192:195], v[12:15], v[116:119], 0
buffer_store_dwordx4 v[152:155], v239, s[20:23], s52 offen offset:0 nt
buffer_store_dwordx4 v[160:163], v239, s[20:23], s52 offen offset:64 nt
v_cvt_pk_bf16_f32 v184, v184, v185
v_cvt_pk_bf16_f32 v185, v186, v187
v_rcp_f32 v252, v249
v_max3_f32 v254, v188, v189, v190
v_cvt_pk_bf16_f32 v148, v232, 0
s_add_u32 s52, s46, 16384
v_mfma_f32_16x16x32_bf16 v[192:195], v[8:11], v[112:115], v[192:195]
ds_write_b64 v246, v[184:185] offset:0
v_mfma_f32_16x16x32_bf16 v[200:203], v[16:19], v[112:115], 0
s_nop 0
v_add_u32 v246, 0x200, v246
s_nop 0
v_mfma_f32_16x16x32_bf16 v[200:203], v[20:23], v[116:119], v[200:203]
s_nop 1
v_max3_f32 v254, v254, v191, v192
v_mfma_f32_16x16x32_bf16 v[184:187], v[28:31], v[116:119], 0
v_max3_f32 v254, v254, v193, v194
s_nop 0
v_mfma_f32_16x16x32_bf16 v[184:187], v[24:27], v[112:115], v[184:187]
s_nop 0
v_max3_f32 v254, v254, v195, v200
v_max3_f32 v254, v254, v201, v202
v_mfma_f32_16x16x32_bf16 v[208:211], v[32:35], v[112:115], 0
s_nop 2
v_mfma_f32_16x16x32_bf16 v[208:211], v[36:39], v[116:119], v[208:211]
v_max3_f32 v254, v254, v203, v184
v_max3_f32 v254, v254, v185, v186
v_mfma_f32_16x16x32_bf16 v[216:219], v[44:47], v[116:119], 0
s_nop 2
v_mfma_f32_16x16x32_bf16 v[216:219], v[40:43], v[112:115], v[216:219]
s_nop 0
v_max3_f32 v254, v254, v187, v208
v_max3_f32 v254, v254, v209, v210
v_mfma_f32_16x16x32_bf16 v[220:223], v[48:51], v[112:115], 0
s_nop 2
v_mfma_f32_16x16x32_bf16 v[220:223], v[52:55], v[116:119], v[220:223]
v_max3_f32 v254, v254, v211, v216
v_max3_f32 v254, v254, v217, v218
v_mfma_f32_16x16x32_bf16 v[152:155], a[192:195], v[224:227], 0
s_nop 2
v_mfma_f32_16x16x32_bf16 v[152:155], a[196:199], v[196:199], v[152:155]
s_nop 0
v_max3_f32 v254, v254, v219, v220
v_mfma_f32_16x16x32_bf16 v[152:155], a[200:203], v[212:215], v[152:155]
ds_swizzle_b32 v255, v254 offset:0x401F
v_mfma_f32_16x16x32_bf16 v[152:155], a[204:207], v[204:207], v[152:155]
v_mfma_f32_16x16x32_bf16 v[156:159], a[220:223], v[204:207], 0
v_mfma_f32_16x16x32_bf16 v[156:159], a[216:219], v[212:215], v[156:159]
v_mfma_f32_16x16x32_bf16 v[156:159], a[212:215], v[196:199], v[156:159]
v_mfma_f32_16x16x32_bf16 v[156:159], a[208:211], v[224:227], v[156:159]
v_mfma_f32_16x16x32_bf16 v[160:163], a[224:227], v[224:227], 0
s_waitcnt lgkmcnt(0)
v_max_f32 v254, v254, v255
v_mfma_f32_16x16x32_bf16 v[160:163], a[228:231], v[196:199], v[160:163]
ds_bpermute_b32 v255, v247, v254
v_mfma_f32_16x16x32_bf16 v[160:163], a[232:235], v[212:215], v[160:163]
v_mfma_f32_16x16x32_bf16 v[160:163], a[236:239], v[204:207], v[160:163]
v_mfma_f32_16x16x32_bf16 v[164:167], a[252:255], v[204:207], 0
v_mfma_f32_16x16x32_bf16 v[164:167], a[248:251], v[212:215], v[164:167]
v_mfma_f32_16x16x32_bf16 v[164:167], a[244:247], v[196:199], v[164:167]
v_mfma_f32_16x16x32_bf16 v[164:167], a[240:243], v[224:227], v[164:167]
s_waitcnt lgkmcnt(0)
v_max_f32 v254, v254, v255
v_sub_f32 v188, v188, v254
v_mfma_f32_16x16x32_bf16 v[196:199], v[56:59], v[136:139], 0
v_sub_f32 v190, v190, v254
v_sub_f32 v189, v189, v254
v_mfma_f32_16x16x32_bf16 v[196:199], v[104:107], v[148:151], v[196:199]
v_exp_f32 v189, v189
v_mfma_f32_16x16x32_bf16 v[196:199], v[72:75], v[140:143], v[196:199]
v_exp_f32 v188, v188
v_mfma_f32_16x16x32_bf16 v[196:199], v[88:91], v[144:147], v[196:199]
v_add_f32 v248, v188, v189
v_sub_f32 v191, v191, v254
v_mfma_f32_16x16x32_bf16 v[204:207], v[92:95], v[144:147], 0
v_exp_f32 v191, v191
v_mfma_f32_16x16x32_bf16 v[204:207], v[76:79], v[140:143], v[204:207]
v_exp_f32 v190, v190
v_mfma_f32_16x16x32_bf16 v[204:207], v[106:109], v[148:151], v[204:207]
v_cvt_pk_bf16_f32 v120, v188, v189
v_add_f32 v248, v248, v190
v_mfma_f32_16x16x32_bf16 v[204:207], v[60:63], v[136:139], v[204:207]
ds_read_b128 v[212:215], v236 offset:4224
v_add_f32 v248, v248, v191
v_mfma_f32_16x16x32_bf16 v[228:231], v[64:67], v[136:139], 0
ds_read_b128 v[224:227], v236 offset:4480
v_cvt_pk_bf16_f32 v121, v190, v191
v_mfma_f32_16x16x32_bf16 v[228:231], v[108:111], v[148:151], v[228:231]
v_fmac_f32 v170, v198, v252
v_fmac_f32 v171, v199, v252
v_mfma_f32_16x16x32_bf16 v[228:231], v[80:83], v[140:143], v[228:231]
v_fmac_f32 v168, v196, v252
v_fmac_f32 v169, v197, v252
v_mfma_f32_16x16x32_bf16 v[228:231], v[96:99], v[144:147], v[228:231]
ds_read_b128 v[196:199], v236 offset:4736
v_fmac_f32 v175, v207, v252
v_mfma_f32_16x16x32_bf16 v[232:235], v[100:103], v[144:147], 0
v_fmac_f32 v172, v204, v252
v_fmac_f32 v174, v206, v252
v_mfma_f32_16x16x32_bf16 v[232:235], v[84:87], v[140:143], v[232:235]
s_waitcnt lgkmcnt(2)
v_fmac_f32 v173, v205, v252
v_fmac_f32 v177, v229, v252
v_mfma_f32_16x16x32_bf16 v[232:235], v[110:113], v[148:151], v[232:235]
s_waitcnt lgkmcnt(1)
ds_read_b128 v[204:207], v236 offset:4992
v_fmac_f32 v176, v228, v252
v_mfma_f32_16x16x32_bf16 v[232:235], v[68:71], v[136:139], v[232:235]
v_fmac_f32 v178, v230, v252
v_fmac_f32 v179, v231, v252
v_mfma_f32_16x16x32_bf16 v[188:191], a[0:3], v[212:215], 0
v_cvt_pk_bf16_f32 v176, v176, v177
v_cvt_pk_bf16_f32 v168, v168, v169
v_mfma_f32_16x16x32_bf16 v[188:191], a[4:7], v[224:227], v[188:191]
s_waitcnt lgkmcnt(1)
v_cvt_pk_bf16_f32 v169, v170, v171
v_fmac_f32 v181, v233, v252
v_mfma_f32_16x16x32_bf16 v[188:191], a[8:11], v[196:199], v[188:191]
v_fmac_f32 v182, v234, v252
v_fmac_f32 v180, v232, v252
v_fmac_f32 v183, v235, v252
v_cvt_pk_bf16_f32 v170, v172, v173
v_pk_max_i16 v170, v170, 0
s_waitcnt lgkmcnt(0)
v_mfma_f32_16x16x32_bf16 v[188:191], a[12:15], v[204:207], v[188:191]
v_cvt_pk_bf16_f32 v171, v174, v175
v_pk_max_i16 v176, v176, 0
v_mfma_f32_16x16x32_bf16 v[232:235], a[28:31], v[204:207], 0
v_pk_max_i16 v171, v171, 0
v_cvt_pk_bf16_f32 v177, v178, v179
v_mfma_f32_16x16x32_bf16 v[232:235], a[24:27], v[196:199], v[232:235]
v_cvt_pk_bf16_f32 v178, v180, v181
v_pk_max_i16 v177, v177, 0
v_mfma_f32_16x16x32_bf16 v[232:235], a[20:23], v[224:227], v[232:235]
v_cvt_pk_bf16_f32 v112, v188, v189
v_cvt_pk_bf16_f32 v113, v190, v191
v_mfma_f32_16x16x32_bf16 v[232:235], a[16:19], v[212:215], v[232:235]
v_pk_max_i16 v168, v168, 0
v_cvt_pk_bf16_f32 v179, v182, v183
v_mfma_f32_16x16x32_bf16 v[188:191], a[32:35], v[212:215], 0
v_pk_max_i16 v179, v179, 0
v_pk_max_i16 v169, v169, 0
v_mfma_f32_16x16x32_bf16 v[188:191], a[36:39], v[224:227], v[188:191]
v_pk_max_i16 v178, v178, 0
v_sub_f32 v192, v192, v254
v_mfma_f32_16x16x32_bf16 v[188:191], a[40:43], v[196:199], v[188:191]
buffer_store_dwordx4 v[168:171], v239, s[20:23], s53 offen offset:0 nt
buffer_store_dwordx4 v[176:179], v239, s[20:23], s53 offen offset:64 nt
v_sub_f32 v193, v193, v254
v_exp_f32 v192, v192
v_exp_f32 v193, v193
v_sub_f32 v195, v195, v254
v_exp_f32 v195, v195
v_mfma_f32_16x16x32_bf16 v[188:191], a[44:47], v[204:207], v[188:191]
s_add_u32 s53, s46, 4096
v_add_f32 v248, v248, v192
v_sub_f32 v194, v194, v254
v_mfma_f32_16x16x32_bf16 v[228:231], a[60:63], v[204:207], 0
s_add_u32 s46, s46, 13107200
v_cvt_pk_bf16_f32 v114, v232, v233
v_cvt_pk_bf16_f32 v115, v234, v235
v_mfma_f32_16x16x32_bf16 v[228:231], a[56:59], v[196:199], v[228:231]
v_cvt_pk_bf16_f32 v117, v190, v191
v_cvt_pk_bf16_f32 v116, v188, v189
v_mfma_f32_16x16x32_bf16 v[228:231], a[52:55], v[224:227], v[228:231]
v_exp_f32 v194, v194
v_mfma_f32_16x16x32_bf16 v[228:231], a[48:51], v[212:215], v[228:231]
v_add_f32 v248, v248, v193
v_add_f32 v248, v248, v194
v_mfma_f32_16x16x32_bf16 v[168:171], a[192:195], v[212:215], 0
v_add_f32 v248, v248, v195
v_cvt_pk_bf16_f32 v122, v192, v193
v_mfma_f32_16x16x32_bf16 v[168:171], a[196:199], v[224:227], v[168:171]
v_cvt_pk_bf16_f32 v123, v194, v195
v_sub_f32 v201, v201, v254
v_mfma_f32_16x16x32_bf16 v[168:171], a[200:203], v[196:199], v[168:171]
v_cvt_pk_bf16_f32 v119, v230, v231
v_cvt_pk_bf16_f32 v118, v228, v229
v_mfma_f32_16x16x32_bf16 v[168:171], a[204:207], v[204:207], v[168:171]
v_sub_f32 v202, v202, v254
v_sub_f32 v200, v200, v254
v_mfma_f32_16x16x32_bf16 v[172:175], a[220:223], v[204:207], 0
v_exp_f32 v200, v200
v_mfma_f32_16x16x32_bf16 v[172:175], a[216:219], v[196:199], v[172:175]
v_exp_f32 v202, v202
v_mfma_f32_16x16x32_bf16 v[172:175], a[212:215], v[224:227], v[172:175]
v_exp_f32 v201, v201
v_mfma_f32_16x16x32_bf16 v[172:175], a[208:211], v[212:215], v[172:175]
v_sub_f32 v203, v203, v254
v_add_f32 v248, v248, v200
v_mfma_f32_16x16x32_bf16 v[176:179], a[224:227], v[212:215], 0
v_exp_f32 v203, v203
v_mfma_f32_16x16x32_bf16 v[176:179], a[228:231], v[224:227], v[176:179]
v_cvt_pk_bf16_f32 v125, v202, v203
v_add_f32 v248, v248, v201
v_mfma_f32_16x16x32_bf16 v[176:179], a[232:235], v[196:199], v[176:179]
v_add_f32 v248, v248, v202
v_cvt_pk_bf16_f32 v124, v200, v201
v_mfma_f32_16x16x32_bf16 v[176:179], a[236:239], v[204:207], v[176:179]
v_add_f32 v248, v248, v203
v_sub_f32 v184, v184, v254
v_mfma_f32_16x16x32_bf16 v[180:183], a[252:255], v[204:207], 0
v_sub_f32 v185, v185, v254
v_sub_f32 v187, v187, v254
v_mfma_f32_16x16x32_bf16 v[180:183], a[248:251], v[196:199], v[180:183]
v_sub_f32 v186, v186, v254
v_sub_f32 v220, v220, v254
v_mfma_f32_16x16x32_bf16 v[180:183], a[244:247], v[224:227], v[180:183]
v_exp_f32 v184, v184
v_mfma_f32_16x16x32_bf16 v[180:183], a[240:243], v[212:215], v[180:183]
v_add_f32 v248, v248, v184
v_sub_f32 v216, v216, v254
v_mfma_f32_16x16x32_bf16 v[188:191], v[0:3], v[112:115], 0
v_exp_f32 v187, v187
v_mfma_f32_16x16x32_bf16 v[188:191], v[4:7], v[116:119], v[188:191]
v_exp_f32 v186, v186
v_mfma_f32_16x16x32_bf16 v[192:195], v[12:15], v[116:119], 0
v_exp_f32 v185, v185
v_mfma_f32_16x16x32_bf16 v[192:195], v[8:11], v[112:115], v[192:195]
v_add_f32 v248, v248, v185
v_add_f32 v248, v248, v186
v_mfma_f32_16x16x32_bf16 v[196:199], v[16:19], v[112:115], 0
v_add_f32 v248, v248, v187
v_cvt_pk_bf16_f32 v127, v186, v187
v_mfma_f32_16x16x32_bf16 v[196:199], v[20:23], v[116:119], v[196:199]
v_cvt_pk_bf16_f32 v126, v184, v185
v_sub_f32 v218, v218, v254
v_mfma_f32_16x16x32_bf16 v[200:203], v[28:31], v[116:119], 0
v_exp_f32 v220, v220
v_mfma_f32_16x16x32_bf16 v[200:203], v[24:27], v[112:115], v[200:203]
v_cvt_pk_bf16_f32 v132, v220, 0
v_sub_f32 v217, v217, v254
v_mfma_f32_16x16x32_bf16 v[204:207], v[32:35], v[112:115], 0
v_sub_f32 v211, v211, v254
v_sub_f32 v210, v210, v254
v_mfma_f32_16x16x32_bf16 v[204:207], v[36:39], v[116:119], v[204:207]
v_sub_f32 v219, v219, v254
v_sub_f32 v208, v208, v254
v_mfma_f32_16x16x32_bf16 v[212:215], v[44:47], v[116:119], 0
v_sub_f32 v209, v209, v254
v_max3_f32 v254, v188, v189, v190
v_mfma_f32_16x16x32_bf16 v[212:215], v[40:43], v[112:115], v[212:215]
v_exp_f32 v209, v209
v_mfma_f32_16x16x32_bf16 v[224:227], v[48:51], v[112:115], 0
v_exp_f32 v208, v208
v_mfma_f32_16x16x32_bf16 v[224:227], v[52:55], v[116:119], v[224:227]
v_exp_f32 v217, v217
v_mfma_f32_16x16x32_bf16 v[184:187], v[56:59], v[120:123], 0
v_exp_f32 v210, v210
v_mfma_f32_16x16x32_bf16 v[184:187], v[104:107], v[132:135], v[184:187]
v_exp_f32 v218, v218
v_mfma_f32_16x16x32_bf16 v[184:187], v[72:75], v[124:127], v[184:187]
v_exp_f32 v211, v211
v_exp_f32 v216, v216
v_exp_f32 v219, v219
v_cvt_pk_bf16_f32 v129, v210, v211
v_cvt_pk_bf16_f32 v131, v218, v219
v_cvt_pk_bf16_f32 v130, v216, v217
v_cvt_pk_bf16_f32 v128, v208, v209
v_add_f32 v248, v248, v208
v_add_f32 v248, v248, v209
v_mfma_f32_16x16x32_bf16 v[184:187], v[88:91], v[128:131], v[184:187]
v_add_f32 v248, v248, v210
v_add_f32 v248, v248, v211
v_mfma_f32_16x16x32_bf16 v[208:211], v[92:95], v[128:131], 0
v_max3_f32 v254, v254, v191, v192
v_max3_f32 v254, v254, v193, v194
v_mfma_f32_16x16x32_bf16 v[208:211], v[76:79], v[124:127], v[208:211]
v_max3_f32 v254, v254, v195, v196
v_max3_f32 v254, v254, v197, v198
v_mfma_f32_16x16x32_bf16 v[208:211], v[106:109], v[132:135], v[208:211]
v_max3_f32 v254, v254, v199, v200
v_max3_f32 v254, v254, v201, v202
v_mfma_f32_16x16x32_bf16 v[208:211], v[60:63], v[120:123], v[208:211]
v_max3_f32 v254, v254, v203, v204
v_max3_f32 v254, v254, v205, v206
v_mfma_f32_16x16x32_bf16 v[228:231], v[64:67], v[120:123], 0
v_max3_f32 v254, v254, v207, v212
v_max3_f32 v254, v254, v213, v214
v_mfma_f32_16x16x32_bf16 v[228:231], v[108:111], v[132:135], v[228:231]
v_max3_f32 v254, v254, v215, v224
v_add_f32 v248, v248, v216
v_mfma_f32_16x16x32_bf16 v[228:231], v[80:83], v[124:127], v[228:231]
ds_swizzle_b32 v255, v254 offset:0x401F
v_add_f32 v248, v248, v217
v_mfma_f32_16x16x32_bf16 v[228:231], v[96:99], v[128:131], v[228:231]
v_add_f32 v248, v248, v218
v_add_f32 v248, v248, v219
v_mfma_f32_16x16x32_bf16 v[232:235], v[100:103], v[128:131], 0
ds_read_b128 v[216:219], v236 offset:8448
v_add_f32 v248, v248, v220
v_mfma_f32_16x16x32_bf16 v[232:235], v[84:87], v[124:127], v[232:235]
ds_read_b128 v[220:223], v236 offset:8704
ds_swizzle_b32 v250, v248 offset:0x401F
v_mfma_f32_16x16x32_bf16 v[232:235], v[110:113], v[132:135], v[232:235]
v_mfma_f32_16x16x32_bf16 v[232:235], v[68:71], v[120:123], v[232:235]
s_waitcnt lgkmcnt(3)
v_max_f32 v254, v254, v255
ds_bpermute_b32 v255, v247, v254
s_waitcnt lgkmcnt(1)
v_add_f32 v248, v248, v250
ds_bpermute_b32 v250, v247, v248
s_waitcnt lgkmcnt(1)
v_max_f32 v254, v254, v255
v_sub_f32 v188, v188, v254
v_exp_f32 v188, v188
v_sub_f32 v189, v189, v254
v_sub_f32 v190, v190, v254
v_sub_f32 v191, v191, v254
v_exp_f32 v189, v189
v_exp_f32 v191, v191
v_exp_f32 v190, v190
v_add_f32 v249, v188, v189
v_add_f32 v249, v249, v190
v_add_f32 v249, v249, v191
v_cvt_pk_bf16_f32 v137, v190, v191
v_cvt_pk_bf16_f32 v136, v188, v189
v_mfma_f32_16x16x32_bf16 v[188:191], a[0:3], v[216:219], 0
s_waitcnt lgkmcnt(0)
v_sub_f32 v192, v192, v254
v_sub_f32 v195, v195, v254
v_mfma_f32_16x16x32_bf16 v[188:191], a[4:7], v[220:223], v[188:191]
v_exp_f32 v192, v192
v_sub_f32 v193, v193, v254
v_sub_f32 v194, v194, v254
v_exp_f32 v195, v195
v_exp_f32 v193, v193
v_exp_f32 v194, v194
v_add_f32 v249, v249, v192
v_add_f32 v249, v249, v193
v_add_f32 v249, v249, v194
v_add_f32 v249, v249, v195
v_cvt_pk_bf16_f32 v139, v194, v195
v_cvt_pk_bf16_f32 v138, v192, v193
ds_read_b128 v[192:195], v236 offset:8960
v_sub_f32 v198, v198, v254
v_sub_f32 v197, v197, v254
v_sub_f32 v196, v196, v254
v_exp_f32 v196, v196
v_exp_f32 v198, v198
v_sub_f32 v202, v202, v254
v_sub_f32 v200, v200, v254
v_exp_f32 v197, v197
v_sub_f32 v201, v201, v254
v_sub_f32 v199, v199, v254
v_exp_f32 v199, v199
v_exp_f32 v200, v200
v_add_f32 v249, v249, v196
v_add_f32 v249, v249, v197
v_add_f32 v249, v249, v198
s_waitcnt lgkmcnt(0)
v_mfma_f32_16x16x32_bf16 v[188:191], a[8:11], v[192:195], v[188:191]
v_sub_f32 v203, v203, v254
v_add_f32 v249, v249, v199
v_add_f32 v249, v249, v200
v_exp_f32 v201, v201
v_exp_f32 v202, v202
v_exp_f32 v203, v203
v_sub_f32 v204, v204, v254
v_exp_f32 v204, v204
v_add_f32 v249, v249, v201
v_add_f32 v249, v249, v202
v_add_f32 v249, v249, v203
v_sub_f32 v205, v205, v254
v_sub_f32 v206, v206, v254
v_exp_f32 v205, v205
v_exp_f32 v206, v206
v_add_f32 v249, v249, v204
v_add_f32 v249, v249, v205
v_sub_f32 v207, v207, v254
v_exp_f32 v207, v207
v_add_f32 v249, v249, v206
v_add_f32 v249, v249, v207
v_cvt_pk_bf16_f32 v145, v206, v207
v_cvt_pk_bf16_f32 v144, v204, v205
ds_read_b128 v[204:207], v236 offset:9216
v_add_f32 v248, v248, v250
v_rcp_f32 v251, v248
v_sub_f32 v212, v212, v254
v_fmac_f32 v152, v184, v251
v_fmac_f32 v153, v185, v251
v_fmac_f32 v155, v187, v251
v_fmac_f32 v154, v186, v251
v_fmac_f32 v157, v209, v251
v_fmac_f32 v159, v211, v251
v_fmac_f32 v158, v210, v251
v_fmac_f32 v156, v208, v251
v_exp_f32 v212, v212
v_sub_f32 v213, v213, v254
v_exp_f32 v213, v213
v_sub_f32 v214, v214, v254
v_exp_f32 v214, v214
s_waitcnt lgkmcnt(0)
v_mfma_f32_16x16x32_bf16 v[188:191], a[12:15], v[204:207], v[188:191]
v_sub_f32 v215, v215, v254
v_add_f32 v249, v249, v212
v_mfma_f32_16x16x32_bf16 v[184:187], a[28:31], v[204:207], 0
v_exp_f32 v215, v215
v_mfma_f32_16x16x32_bf16 v[184:187], a[24:27], v[192:195], v[184:187]
v_add_f32 v249, v249, v213
v_add_f32 v249, v249, v214
v_mfma_f32_16x16x32_bf16 v[184:187], a[20:23], v[220:223], v[184:187]
v_add_f32 v249, v249, v215
v_cvt_pk_bf16_f32 v147, v214, v215
v_mfma_f32_16x16x32_bf16 v[184:187], a[16:19], v[216:219], v[184:187]
v_cvt_pk_bf16_f32 v146, v212, v213
v_fmac_f32 v163, v231, v251
v_mfma_f32_16x16x32_bf16 v[208:211], a[32:35], v[216:219], 0
v_fmac_f32 v161, v229, v251
v_cvt_pk_bf16_f32 v152, v152, v153
v_mfma_f32_16x16x32_bf16 v[208:211], a[36:39], v[220:223], v[208:211]
v_fmac_f32 v167, v235, v251
v_fmac_f32 v160, v228, v251
v_mfma_f32_16x16x32_bf16 v[208:211], a[40:43], v[192:195], v[208:211]
v_fmac_f32 v164, v232, v251
v_cvt_pk_bf16_f32 v160, v160, v161
v_mfma_f32_16x16x32_bf16 v[208:211], a[44:47], v[204:207], v[208:211]
v_cvt_pk_bf16_f32 v153, v154, v155
v_cvt_pk_bf16_f32 v154, v156, v157
v_mfma_f32_16x16x32_bf16 v[212:215], a[60:63], v[204:207], 0
v_fmac_f32 v166, v234, v251
v_fmac_f32 v162, v230, v251
v_mfma_f32_16x16x32_bf16 v[212:215], a[56:59], v[192:195], v[212:215]
v_fmac_f32 v165, v233, v251
v_cvt_pk_bf16_f32 v155, v158, v159
v_mfma_f32_16x16x32_bf16 v[212:215], a[52:55], v[220:223], v[212:215]
v_cvt_pk_bf16_f32 v161, v162, v163
v_cvt_pk_bf16_f32 v162, v164, v165
v_mfma_f32_16x16x32_bf16 v[212:215], a[48:51], v[216:219], v[212:215]
v_cvt_pk_bf16_f32 v163, v166, v167
v_pk_max_i16 v162, v162, 0
v_pk_max_i16 v161, v161, 0
v_pk_max_i16 v163, v163, 0
v_pk_max_i16 v153, v153, 0
v_pk_max_i16 v155, v155, 0
v_pk_max_i16 v152, v152, 0
v_pk_max_i16 v160, v160, 0
v_pk_max_i16 v154, v154, 0
buffer_store_dwordx4 v[152:155], v239, s[20:23], s52 offen offset:0 nt
buffer_store_dwordx4 v[160:163], v239, s[20:23], s52 offen offset:64 nt
v_cvt_pk_bf16_f32 v112, v188, v189
v_cvt_pk_bf16_f32 v113, v190, v191
v_cvt_pk_bf16_f32 v114, v184, v185
v_cvt_pk_bf16_f32 v115, v186, v187
v_cvt_pk_bf16_f32 v118, v212, v213
v_cvt_pk_bf16_f32 v119, v214, v215
v_cvt_pk_bf16_f32 v116, v208, v209
v_cvt_pk_bf16_f32 v117, v210, v211
v_mfma_f32_16x16x32_bf16 v[152:155], a[192:195], v[216:219], 0
v_sub_f32 v224, v224, v254
v_cvt_pk_bf16_f32 v142, v200, v201
v_mfma_f32_16x16x32_bf16 v[152:155], a[196:199], v[220:223], v[152:155]
v_exp_f32 v224, v224
v_mfma_f32_16x16x32_bf16 v[152:155], a[200:203], v[192:195], v[152:155]
v_cvt_pk_bf16_f32 v141, v198, v199
v_cvt_pk_bf16_f32 v140, v196, v197
v_mfma_f32_16x16x32_bf16 v[152:155], a[204:207], v[204:207], v[152:155]
v_add_f32 v249, v249, v224
v_cvt_pk_bf16_f32 v143, v202, v203
v_mfma_f32_16x16x32_bf16 v[156:159], a[220:223], v[204:207], 0
ds_swizzle_b32 v250, v249 offset:0x401F
v_cvt_pk_bf16_f32 v148, v224, 0
v_mfma_f32_16x16x32_bf16 v[156:159], a[216:219], v[192:195], v[156:159]
v_mfma_f32_16x16x32_bf16 v[156:159], a[212:215], v[220:223], v[156:159]
v_mfma_f32_16x16x32_bf16 v[156:159], a[208:211], v[216:219], v[156:159]
v_mfma_f32_16x16x32_bf16 v[160:163], a[224:227], v[216:219], 0
v_mfma_f32_16x16x32_bf16 v[160:163], a[228:231], v[220:223], v[160:163]
v_mfma_f32_16x16x32_bf16 v[160:163], a[232:235], v[192:195], v[160:163]
s_waitcnt lgkmcnt(0)
v_add_f32 v249, v249, v250
v_mfma_f32_16x16x32_bf16 v[160:163], a[236:239], v[204:207], v[160:163]
ds_bpermute_b32 v250, v247, v249
v_mfma_f32_16x16x32_bf16 v[164:167], a[252:255], v[204:207], 0
v_mfma_f32_16x16x32_bf16 v[164:167], a[248:251], v[192:195], v[164:167]
v_mfma_f32_16x16x32_bf16 v[164:167], a[244:247], v[220:223], v[164:167]
v_mfma_f32_16x16x32_bf16 v[164:167], a[240:243], v[216:219], v[164:167]
v_mfma_f32_16x16x32_bf16 v[184:187], v[0:3], v[112:115], 0
v_mfma_f32_16x16x32_bf16 v[184:187], v[4:7], v[116:119], v[184:187]
s_waitcnt lgkmcnt(0)
v_add_f32 v249, v249, v250
s_nop 0
v_mfma_f32_16x16x32_bf16 v[188:191], v[12:15], v[116:119], 0
v_rcp_f32 v252, v249
v_mfma_f32_16x16x32_bf16 v[188:191], v[8:11], v[112:115], v[188:191]
s_nop 1
v_max3_f32 v254, v184, v185, v186
v_mfma_f32_16x16x32_bf16 v[192:195], v[16:19], v[112:115], 0
s_nop 2
v_mfma_f32_16x16x32_bf16 v[192:195], v[20:23], v[116:119], v[192:195]
v_max3_f32 v254, v254, v187, v188
v_max3_f32 v254, v254, v189, v190
v_mfma_f32_16x16x32_bf16 v[196:199], v[28:31], v[116:119], 0
s_nop 2
v_mfma_f32_16x16x32_bf16 v[196:199], v[24:27], v[112:115], v[196:199]
s_nop 0
v_max3_f32 v254, v254, v191, v192
v_max3_f32 v254, v254, v193, v194
v_mfma_f32_16x16x32_bf16 v[200:203], v[32:35], v[112:115], 0
s_nop 2
v_mfma_f32_16x16x32_bf16 v[200:203], v[36:39], v[116:119], v[200:203]
v_max3_f32 v254, v254, v195, v196
v_max3_f32 v254, v254, v197, v198
v_mfma_f32_16x16x32_bf16 v[204:207], v[44:47], v[116:119], 0
s_nop 2
v_mfma_f32_16x16x32_bf16 v[204:207], v[40:43], v[112:115], v[204:207]
s_nop 0
v_max3_f32 v254, v254, v199, v200
v_max3_f32 v254, v254, v201, v202
v_mfma_f32_16x16x32_bf16 v[208:211], v[48:51], v[112:115], 0
s_nop 2
v_mfma_f32_16x16x32_bf16 v[208:211], v[52:55], v[116:119], v[208:211]
v_max3_f32 v254, v254, v203, v204
v_max3_f32 v254, v254, v205, v206
v_mfma_f32_16x16x32_bf16 v[212:215], v[56:59], v[136:139], 0
s_nop 2
v_mfma_f32_16x16x32_bf16 v[212:215], v[104:107], v[148:151], v[212:215]
s_nop 0
v_max3_f32 v254, v254, v207, v208
v_mfma_f32_16x16x32_bf16 v[212:215], v[72:75], v[140:143], v[212:215]
ds_swizzle_b32 v255, v254 offset:0x401F
v_mfma_f32_16x16x32_bf16 v[212:215], v[88:91], v[144:147], v[212:215]
s_nop 2
v_mfma_f32_16x16x32_bf16 v[216:219], v[92:95], v[144:147], 0
s_nop 2
v_mfma_f32_16x16x32_bf16 v[216:219], v[76:79], v[140:143], v[216:219]
v_fmac_f32 v169, v213, v252
v_fmac_f32 v168, v212, v252
v_mfma_f32_16x16x32_bf16 v[216:219], v[106:109], v[148:151], v[216:219]
v_fmac_f32 v171, v215, v252
v_fmac_f32 v170, v214, v252
v_mfma_f32_16x16x32_bf16 v[216:219], v[60:63], v[136:139], v[216:219]
ds_read_b128 v[220:223], v236 offset:12672
ds_read_b128 v[224:227], v236 offset:12928
v_mfma_f32_16x16x32_bf16 v[228:231], v[64:67], v[136:139], 0
s_waitcnt lgkmcnt(2)
ds_read_b128 v[212:215], v236 offset:13184
v_cvt_pk_bf16_f32 v168, v168, v169
v_mfma_f32_16x16x32_bf16 v[228:231], v[108:111], v[148:151], v[228:231]
s_nop 0
v_fmac_f32 v172, v216, v252
v_fmac_f32 v174, v218, v252
v_mfma_f32_16x16x32_bf16 v[228:231], v[80:83], v[140:143], v[228:231]
v_fmac_f32 v173, v217, v252
v_fmac_f32 v175, v219, v252
v_mfma_f32_16x16x32_bf16 v[228:231], v[96:99], v[144:147], v[228:231]
ds_read_b128 v[216:219], v236 offset:13440
v_cvt_pk_bf16_f32 v169, v170, v171
v_mfma_f32_16x16x32_bf16 v[232:235], v[100:103], v[144:147], 0
v_cvt_pk_bf16_f32 v170, v172, v173
v_cvt_pk_bf16_f32 v171, v174, v175
v_mfma_f32_16x16x32_bf16 v[232:235], v[84:87], v[140:143], v[232:235]
s_waitcnt lgkmcnt(2)
v_pk_max_i16 v170, v170, 0
v_fmac_f32 v178, v230, v252
v_mfma_f32_16x16x32_bf16 v[232:235], v[110:113], v[148:151], v[232:235]
s_waitcnt lgkmcnt(1)
v_fmac_f32 v179, v231, v252
v_fmac_f32 v176, v228, v252
v_mfma_f32_16x16x32_bf16 v[232:235], v[68:71], v[136:139], v[232:235]
v_fmac_f32 v177, v229, v252
v_cvt_pk_bf16_f32 v176, v176, v177
v_mfma_f32_16x16x32_bf16 v[228:231], a[0:3], v[220:223], 0
v_cvt_pk_bf16_f32 v177, v178, v179
v_pk_max_i16 v169, v169, 0
v_mfma_f32_16x16x32_bf16 v[228:231], a[4:7], v[224:227], v[228:231]
s_waitcnt lgkmcnt(0)
v_pk_max_i16 v171, v171, 0
v_fmac_f32 v182, v234, v252
v_mfma_f32_16x16x32_bf16 v[228:231], a[8:11], v[212:215], v[228:231]
v_fmac_f32 v181, v233, v252
v_fmac_f32 v183, v235, v252
v_mfma_f32_16x16x32_bf16 v[228:231], a[12:15], v[216:219], v[228:231]
v_fmac_f32 v180, v232, v252
v_cvt_pk_bf16_f32 v179, v182, v183
v_mfma_f32_16x16x32_bf16 v[232:235], a[28:31], v[216:219], 0
v_cvt_pk_bf16_f32 v178, v180, v181
v_pk_max_i16 v178, v178, 0
v_mfma_f32_16x16x32_bf16 v[232:235], a[24:27], v[212:215], v[232:235]
v_pk_max_i16 v179, v179, 0
v_pk_max_i16 v176, v176, 0
v_mfma_f32_16x16x32_bf16 v[232:235], a[20:23], v[224:227], v[232:235]
v_cvt_pk_bf16_f32 v113, v230, v231
v_cvt_pk_bf16_f32 v112, v228, v229
v_mfma_f32_16x16x32_bf16 v[232:235], a[16:19], v[220:223], v[232:235]
v_pk_max_i16 v168, v168, 0
v_pk_max_i16 v177, v177, 0
v_mfma_f32_16x16x32_bf16 v[228:231], a[32:35], v[220:223], 0
buffer_store_dwordx4 v[168:171], v239, s[20:23], s53 offen offset:0 nt
buffer_store_dwordx4 v[176:179], v239, s[20:23], s53 offen offset:64 nt
v_add_u32 v236, s56, v236
v_max_f32 v254, v254, v255
s_sub_u32 s56, 0, s56
v_cvt_pk_bf16_f32 v115, v234, v235
v_cvt_pk_bf16_f32 v114, v232, v233
v_mfma_f32_16x16x32_bf16 v[228:231], a[36:39], v[224:227], v[228:231]
ds_bpermute_b32 v255, v247, v254
v_mfma_f32_16x16x32_bf16 v[228:231], a[40:43], v[212:215], v[228:231]
v_mfma_f32_16x16x32_bf16 v[228:231], a[44:47], v[216:219], v[228:231]
s_nop 2
v_mfma_f32_16x16x32_bf16 v[232:235], a[60:63], v[216:219], 0
s_nop 2
v_mfma_f32_16x16x32_bf16 v[232:235], a[56:59], v[212:215], v[232:235]
v_cvt_pk_bf16_f32 v116, v228, v229
v_cvt_pk_bf16_f32 v117, v230, v231
v_mfma_f32_16x16x32_bf16 v[232:235], a[52:55], v[224:227], v[232:235]
v_mfma_f32_16x16x32_bf16 v[232:235], a[48:51], v[220:223], v[232:235]
s_waitcnt lgkmcnt(0)
v_max_f32 v254, v254, v255
v_sub_f32 v184, v184, v254
v_mfma_f32_16x16x32_bf16 v[168:171], a[192:195], v[220:223], 0
v_exp_f32 v184, v184
v_mfma_f32_16x16x32_bf16 v[168:171], a[196:199], v[224:227], v[168:171]
v_sub_f32 v185, v185, v254
v_sub_f32 v186, v186, v254
v_mfma_f32_16x16x32_bf16 v[168:171], a[200:203], v[212:215], v[168:171]
v_cvt_pk_bf16_f32 v119, v234, v235
v_cvt_pk_bf16_f32 v118, v232, v233
v_mfma_f32_16x16x32_bf16 v[168:171], a[204:207], v[216:219], v[168:171]
v_exp_f32 v186, v186
v_mfma_f32_16x16x32_bf16 v[172:175], a[220:223], v[216:219], 0
v_exp_f32 v185, v185
v_mfma_f32_16x16x32_bf16 v[172:175], a[216:219], v[212:215], v[172:175]
v_sub_f32 v189, v189, v254
v_sub_f32 v187, v187, v254
v_mfma_f32_16x16x32_bf16 v[172:175], a[212:215], v[224:227], v[172:175]
v_sub_f32 v188, v188, v254
v_sub_f32 v190, v190, v254
v_mfma_f32_16x16x32_bf16 v[172:175], a[208:211], v[220:223], v[172:175]
s_cmp_lg_u32 s45, 0
s_cbranch_scc1 L_loops
v_mfma_f32_16x16x32_bf16 v[176:179], a[224:227], v[220:223], 0
s_waitcnt vmcnt(8)
s_barrier
v_mfma_f32_16x16x32_bf16 v[176:179], a[228:231], v[224:227], v[176:179]
s_add_u32 s52, s47, 8192
ds_read_b128 v[232:235], v236 offset:0
v_add_f32 v248, v184, v185
v_mfma_f32_16x16x32_bf16 v[176:179], a[232:235], v[212:215], v[176:179]
s_add_u32 s53, s47, 12288
v_exp_f32 v188, v188
v_mfma_f32_16x16x32_bf16 v[176:179], a[236:239], v[216:219], v[176:179]
v_add_f32 v248, v248, v186
v_sub_f32 v191, v191, v254
v_mfma_f32_16x16x32_bf16 v[180:183], a[252:255], v[216:219], 0
v_exp_f32 v187, v187
v_mfma_f32_16x16x32_bf16 v[180:183], a[248:251], v[212:215], v[180:183]
v_exp_f32 v190, v190
v_mfma_f32_16x16x32_bf16 v[180:183], a[244:247], v[224:227], v[180:183]
v_add_f32 v248, v248, v187
v_add_f32 v248, v248, v188
v_mfma_f32_16x16x32_bf16 v[180:183], a[240:243], v[220:223], v[180:183]
s_waitcnt lgkmcnt(0)
v_exp_f32 v189, v189
v_mfma_f32_16x16x32_bf16 v[228:231], v[0:3], v[112:115], 0
v_add_f32 v248, v248, v189
v_add_f32 v248, v248, v190
v_mfma_f32_16x16x32_bf16 v[228:231], v[4:7], v[116:119], v[228:231]
v_exp_f32 v191, v191
v_cvt_pk_bf16_f32 v122, v188, v189
v_add_f32 v248, v248, v191
v_cvt_pk_bf16_f32 v123, v190, v191
v_mfma_f32_16x16x32_bf16 v[188:191], v[12:15], v[116:119], 0
v_sub_f32 v193, v193, v254
v_sub_f32 v194, v194, v254
v_mfma_f32_16x16x32_bf16 v[188:191], v[8:11], v[112:115], v[188:191]
v_sub_f32 v195, v195, v254
v_exp_f32 v194, v194
v_sub_f32 v192, v192, v254
v_exp_f32 v192, v192
v_sub_f32 v196, v196, v254
v_exp_f32 v193, v193
v_sub_f32 v197, v197, v254
v_sub_f32 v199, v199, v254
v_sub_f32 v198, v198, v254
v_exp_f32 v195, v195
v_add_f32 v248, v248, v192
v_add_f32 v248, v248, v193
v_exp_f32 v196, v196
v_exp_f32 v197, v197
v_add_f32 v248, v248, v194
v_add_f32 v248, v248, v195
v_add_f32 v248, v248, v196
v_add_f32 v248, v248, v197
v_exp_f32 v198, v198
v_sub_f32 v200, v200, v254
v_sub_f32 v203, v203, v254
v_exp_f32 v199, v199
v_sub_f32 v201, v201, v254
v_exp_f32 v201, v201
v_sub_f32 v202, v202, v254
v_exp_f32 v202, v202
v_add_f32 v248, v248, v198
v_exp_f32 v200, v200
v_add_f32 v248, v248, v199
v_add_f32 v248, v248, v200
v_add_f32 v248, v248, v201
v_exp_f32 v203, v203
v_add_f32 v248, v248, v202
v_add_f32 v248, v248, v203
v_cvt_pk_bf16_f32 v128, v200, v201
v_cvt_pk_bf16_f32 v129, v202, v203
v_mfma_f32_16x16x32_bf16 v[200:203], v[16:19], v[112:115], 0
v_sub_f32 v204, v204, v254
v_sub_f32 v205, v205, v254
v_mfma_f32_16x16x32_bf16 v[200:203], v[20:23], v[116:119], v[200:203]
v_exp_f32 v204, v204
v_sub_f32 v206, v206, v254
v_add_f32 v248, v248, v204
v_exp_f32 v206, v206
v_sub_f32 v207, v207, v254
v_exp_f32 v205, v205
v_exp_f32 v207, v207
v_add_f32 v248, v248, v205
v_add_f32 v248, v248, v206
v_add_f32 v248, v248, v207
v_cvt_pk_bf16_f32 v130, v204, v205
v_cvt_pk_bf16_f32 v131, v206, v207
v_mfma_f32_16x16x32_bf16 v[204:207], v[28:31], v[116:119], 0
v_sub_f32 v208, v208, v254
v_cvt_pk_bf16_f32 v120, v184, v185
v_mfma_f32_16x16x32_bf16 v[204:207], v[24:27], v[112:115], v[204:207]
v_exp_f32 v208, v208
s_nop 0
v_add_f32 v248, v248, v208
v_cvt_pk_bf16_f32 v132, v208, 0
v_mfma_f32_16x16x32_bf16 v[208:211], v[32:35], v[112:115], 0
ds_swizzle_b32 v250, v248 offset:0x401F
v_cvt_pk_bf16_f32 v121, v186, v187
v_mfma_f32_16x16x32_bf16 v[208:211], v[36:39], v[116:119], v[208:211]
ds_read_b128 v[184:187], v236 offset:256
v_cvt_pk_bf16_f32 v126, v196, v197
v_mfma_f32_16x16x32_bf16 v[212:215], v[44:47], v[116:119], 0
v_cvt_pk_bf16_f32 v125, v194, v195
v_cvt_pk_bf16_f32 v127, v198, v199
v_mfma_f32_16x16x32_bf16 v[212:215], v[40:43], v[112:115], v[212:215]
ds_read_b128 v[196:199], v236 offset:768
v_cvt_pk_bf16_f32 v124, v192, v193
v_mfma_f32_16x16x32_bf16 v[216:219], v[48:51], v[112:115], 0
ds_read_b128 v[192:195], v236 offset:512
v_max3_f32 v254, v228, v229, v230
v_mfma_f32_16x16x32_bf16 v[216:219], v[52:55], v[116:119], v[216:219]
v_max3_f32 v254, v254, v231, v188
v_max3_f32 v254, v254, v189, v190
v_mfma_f32_16x16x32_bf16 v[220:223], v[56:59], v[120:123], 0
s_waitcnt lgkmcnt(3)
v_add_f32 v248, v248, v250
v_max3_f32 v254, v254, v191, v200
v_mfma_f32_16x16x32_bf16 v[220:223], v[104:107], v[132:135], v[220:223]
s_waitcnt lgkmcnt(2)
ds_bpermute_b32 v250, v247, v248
v_mfma_f32_16x16x32_bf16 v[220:223], v[72:75], v[124:127], v[220:223]
v_max3_f32 v254, v254, v201, v202
v_max3_f32 v254, v254, v203, v204
v_mfma_f32_16x16x32_bf16 v[220:223], v[88:91], v[128:131], v[220:223]
s_waitcnt lgkmcnt(2)
v_max3_f32 v254, v254, v205, v206
v_max3_f32 v254, v254, v207, v208
v_mfma_f32_16x16x32_bf16 v[224:227], v[92:95], v[128:131], 0
s_waitcnt lgkmcnt(1)
v_max3_f32 v254, v254, v209, v210
v_max3_f32 v254, v254, v211, v212
v_mfma_f32_16x16x32_bf16 v[224:227], v[76:79], v[124:127], v[224:227]
v_max3_f32 v254, v254, v213, v214
v_max3_f32 v254, v254, v215, v216
v_mfma_f32_16x16x32_bf16 v[224:227], v[106:109], v[132:135], v[224:227]
ds_swizzle_b32 v255, v254 offset:0x401F
v_mbcnt_lo_u32_b32 v242, -1, 0
v_mfma_f32_16x16x32_bf16 v[224:227], v[60:63], v[120:123], v[224:227]
s_waitcnt lgkmcnt(1)
v_add_f32 v248, v248, v250
v_rcp_f32 v251, v248
s_nop 0
v_fmac_f32 v152, v220, v251
v_fmac_f32 v153, v221, v251
v_fmac_f32 v154, v222, v251
v_fmac_f32 v155, v223, v251
v_mfma_f32_16x16x32_bf16 v[220:223], v[64:67], v[120:123], 0
v_fmac_f32 v156, v224, v251
v_fmac_f32 v157, v225, v251
v_mfma_f32_16x16x32_bf16 v[220:223], v[108:111], v[132:135], v[220:223]
v_fmac_f32 v158, v226, v251
v_fmac_f32 v159, v227, v251
v_mfma_f32_16x16x32_bf16 v[220:223], v[80:83], v[124:127], v[220:223]
s_waitcnt lgkmcnt(0)
v_cvt_pk_bf16_f32 v152, v152, v153
v_cvt_pk_bf16_f32 v153, v154, v155
v_mfma_f32_16x16x32_bf16 v[220:223], v[96:99], v[128:131], v[220:223]
v_cvt_pk_bf16_f32 v154, v156, v157
v_cvt_pk_bf16_f32 v155, v158, v159
v_mfma_f32_16x16x32_bf16 v[224:227], v[100:103], v[128:131], 0
v_pk_max_i16 v152, v152, 0
v_pk_max_i16 v153, v153, 0
v_mfma_f32_16x16x32_bf16 v[224:227], v[84:87], v[124:127], v[224:227]
v_max_f32 v254, v254, v255
v_pk_max_i16 v154, v154, 0
v_mfma_f32_16x16x32_bf16 v[224:227], v[110:113], v[132:135], v[224:227]
ds_bpermute_b32 v255, v247, v254
v_mfma_f32_16x16x32_bf16 v[224:227], v[68:71], v[120:123], v[224:227]
v_fmac_f32 v160, v220, v251
v_fmac_f32 v161, v221, v251
v_mfma_f32_16x16x32_bf16 v[0:3], a[192:195], v[232:235], 0
v_fmac_f32 v162, v222, v251
v_fmac_f32 v163, v223, v251
v_mfma_f32_16x16x32_bf16 v[0:3], a[196:199], v[184:187], v[0:3]
v_cvt_pk_bf16_f32 v160, v160, v161
v_cvt_pk_bf16_f32 v161, v162, v163
v_mfma_f32_16x16x32_bf16 v[0:3], a[200:203], v[192:195], v[0:3]
v_fmac_f32 v164, v224, v251
v_fmac_f32 v165, v225, v251
v_mfma_f32_16x16x32_bf16 v[0:3], a[204:207], v[196:199], v[0:3]
v_fmac_f32 v166, v226, v251
v_fmac_f32 v167, v227, v251
v_mfma_f32_16x16x32_bf16 v[4:7], a[220:223], v[196:199], 0
s_waitcnt lgkmcnt(0)
v_max_f32 v254, v254, v255
v_sub_f32 v228, v228, v254
v_mfma_f32_16x16x32_bf16 v[4:7], a[216:219], v[192:195], v[4:7]
v_sub_f32 v229, v229, v254
v_sub_f32 v230, v230, v254
v_mfma_f32_16x16x32_bf16 v[4:7], a[212:215], v[184:187], v[4:7]
v_exp_f32 v228, v228
v_mfma_f32_16x16x32_bf16 v[4:7], a[208:211], v[232:235], v[4:7]
ds_read_b128 v[220:223], v236 offset:4224
v_sub_f32 v231, v231, v254
v_mfma_f32_16x16x32_bf16 v[8:11], a[224:227], v[232:235], 0
v_exp_f32 v229, v229
v_mfma_f32_16x16x32_bf16 v[8:11], a[228:231], v[184:187], v[8:11]
v_exp_f32 v230, v230
v_mfma_f32_16x16x32_bf16 v[8:11], a[232:235], v[192:195], v[8:11]
v_exp_f32 v231, v231
v_mfma_f32_16x16x32_bf16 v[8:11], a[236:239], v[196:199], v[8:11]
v_add_f32 v249, v228, v229
v_add_f32 v249, v249, v230
v_mfma_f32_16x16x32_bf16 v[12:15], a[252:255], v[196:199], 0
ds_read_b128 v[196:199], v236 offset:4736
v_add_f32 v249, v249, v231
v_mfma_f32_16x16x32_bf16 v[12:15], a[248:251], v[192:195], v[12:15]
s_waitcnt lgkmcnt(1)
ds_read_b128 v[192:195], v236 offset:4992
v_cvt_pk_bf16_f32 v136, v228, v229
v_mfma_f32_16x16x32_bf16 v[12:15], a[244:247], v[184:187], v[12:15]
v_cvt_pk_bf16_f32 v137, v230, v231
v_sub_f32 v188, v188, v254
v_mfma_f32_16x16x32_bf16 v[12:15], a[240:243], v[232:235], v[12:15]
ds_read_b128 v[228:231], v236 offset:4480
v_sub_f32 v189, v189, v254
v_mfma_f32_16x16x32_bf16 v[16:19], a[192:195], v[220:223], 0
v_exp_f32 v188, v188
v_exp_f32 v189, v189
v_sub_f32 v190, v190, v254
v_cvt_pk_bf16_f32 v138, v188, v189
v_sub_f32 v191, v191, v254
v_exp_f32 v190, v190
v_exp_f32 v191, v191
v_sub_f32 v216, v216, v254
v_cvt_pk_bf16_f32 v139, v190, v191
v_exp_f32 v216, v216
v_sub_f32 v200, v200, v254
v_cvt_pk_bf16_f32 v148, v216, 0
s_waitcnt lgkmcnt(0)
v_mfma_f32_16x16x32_bf16 v[16:19], a[196:199], v[228:231], v[16:19]
v_sub_f32 v201, v201, v254
v_sub_f32 v202, v202, v254
v_mfma_f32_16x16x32_bf16 v[16:19], a[200:203], v[196:199], v[16:19]
v_exp_f32 v200, v200
v_mfma_f32_16x16x32_bf16 v[16:19], a[204:207], v[192:195], v[16:19]
v_exp_f32 v201, v201
v_mfma_f32_16x16x32_bf16 v[20:23], a[220:223], v[192:195], 0
v_exp_f32 v202, v202
v_mfma_f32_16x16x32_bf16 v[20:23], a[216:219], v[196:199], v[20:23]
v_sub_f32 v203, v203, v254
v_sub_f32 v204, v204, v254
v_mfma_f32_16x16x32_bf16 v[20:23], a[212:215], v[228:231], v[20:23]
v_exp_f32 v203, v203
v_mfma_f32_16x16x32_bf16 v[20:23], a[208:211], v[220:223], v[20:23]
v_exp_f32 v204, v204
v_mfma_f32_16x16x32_bf16 v[24:27], a[224:227], v[220:223], 0
v_sub_f32 v205, v205, v254
v_sub_f32 v206, v206, v254
v_mfma_f32_16x16x32_bf16 v[24:27], a[228:231], v[228:231], v[24:27]
v_exp_f32 v205, v205
v_mfma_f32_16x16x32_bf16 v[24:27], a[232:235], v[196:199], v[24:27]
v_exp_f32 v206, v206
v_mfma_f32_16x16x32_bf16 v[24:27], a[236:239], v[192:195], v[24:27]
v_sub_f32 v207, v207, v254
v_cvt_pk_bf16_f32 v140, v200, v201
v_mfma_f32_16x16x32_bf16 v[28:31], a[252:255], v[192:195], 0
v_exp_f32 v207, v207
v_mfma_f32_16x16x32_bf16 v[28:31], a[248:251], v[196:199], v[28:31]
v_cvt_pk_bf16_f32 v141, v202, v203
v_cvt_pk_bf16_f32 v142, v204, v205
v_mfma_f32_16x16x32_bf16 v[28:31], a[244:247], v[228:231], v[28:31]
v_cvt_pk_bf16_f32 v143, v206, v207
v_sub_f32 v208, v208, v254
v_mfma_f32_16x16x32_bf16 v[28:31], a[240:243], v[220:223], v[28:31]
v_sub_f32 v209, v209, v254
v_sub_f32 v210, v210, v254
v_mfma_f32_16x16x32_bf16 v[228:231], v[56:59], v[136:139], 0
v_exp_f32 v208, v208
v_mfma_f32_16x16x32_bf16 v[228:231], v[104:107], v[148:151], v[228:231]
v_exp_f32 v209, v209
v_mfma_f32_16x16x32_bf16 v[228:231], v[72:75], v[140:143], v[228:231]
v_exp_f32 v210, v210
v_sub_f32 v211, v211, v254
v_exp_f32 v211, v211
v_sub_f32 v212, v212, v254
v_exp_f32 v212, v212
v_sub_f32 v213, v213, v254
v_exp_f32 v213, v213
v_sub_f32 v214, v214, v254
v_exp_f32 v214, v214
v_sub_f32 v215, v215, v254
v_exp_f32 v215, v215
v_cvt_pk_bf16_f32 v144, v208, v209
v_cvt_pk_bf16_f32 v145, v210, v211
v_cvt_pk_bf16_f32 v146, v212, v213
v_cvt_pk_bf16_f32 v147, v214, v215
v_cvt_pk_bf16_f32 v162, v164, v165
v_cvt_pk_bf16_f32 v163, v166, v167
v_mfma_f32_16x16x32_bf16 v[228:231], v[88:91], v[144:147], v[228:231]
v_pk_max_i16 v155, v155, 0
v_pk_max_i16 v160, v160, 0
v_mfma_f32_16x16x32_bf16 v[192:195], v[92:95], v[144:147], 0
v_pk_max_i16 v161, v161, 0
v_pk_max_i16 v162, v162, 0
v_mfma_f32_16x16x32_bf16 v[192:195], v[76:79], v[140:143], v[192:195]
v_pk_max_i16 v163, v163, 0
v_mbcnt_hi_u32_b32 v242, -1, v242
v_mfma_f32_16x16x32_bf16 v[192:195], v[106:109], v[148:151], v[192:195]
buffer_store_dwordx4 v[152:155], v239, s[20:23], s52 offen offset:0 nt
buffer_store_dwordx4 v[160:163], v239, s[20:23], s52 offen offset:64 nt
s_mul_i32 s54, s41, 12288
s_add_u32 s54, s54, 105472
v_mov_b32 v244, s54
v_bfe_u32 v243, v242, 0, 4
v_lshl_add_u32 v244, v243, 7, v244
v_lshlrev_b32 v243, 4, v242
v_xor_b32 v243, v243, v242
v_and_b32 v243, 48, v243
v_mfma_f32_16x16x32_bf16 v[192:195], v[60:63], v[136:139], v[192:195]
v_add_u32 v244, v243, v244
v_add_u32 v244, v243, v244
v_mfma_f32_16x16x32_bf16 v[220:223], v[64:67], v[136:139], 0
ds_read_b128 v[184:187], v244 offset:0
ds_read_b128 v[232:235], v244 offset:16
v_mfma_f32_16x16x32_bf16 v[220:223], v[108:111], v[148:151], v[220:223]
ds_read_b128 v[196:199], v244 offset:2048
v_add_f32 v249, v249, v188
v_mfma_f32_16x16x32_bf16 v[220:223], v[80:83], v[140:143], v[220:223]
ds_read_b32 v188, v244 offset:4096
v_add_f32 v249, v249, v189
v_mfma_f32_16x16x32_bf16 v[220:223], v[96:99], v[144:147], v[220:223]
v_add_f32 v249, v249, v190
v_add_f32 v249, v249, v191
v_mfma_f32_16x16x32_bf16 v[224:227], v[100:103], v[144:147], 0
v_mov_b32 v245, 24576
v_bfe_u32 v243, v242, 0, 2
v_mfma_f32_16x16x32_bf16 v[224:227], v[84:87], v[140:143], v[224:227]
v_lshl_add_u32 v245, v243, 8, v245
v_bfe_u32 v243, v242, 2, 2
v_mfma_f32_16x16x32_bf16 v[224:227], v[110:113], v[148:151], v[224:227]
s_waitcnt lgkmcnt(2)
v_lshlrev_b32 v190, 16, v184
v_lshlrev_b32 v191, 16, v185
v_mfma_f32_16x16x32_bf16 v[224:227], v[68:71], v[136:139], v[224:227]
s_waitcnt lgkmcnt(1)
s_waitcnt lgkmcnt(0)
ds_swizzle_b32 v189, v188 offset:0x401F
v_and_b32 v184, 0xffff0000, v184
v_and_b32 v185, 0xffff0000, v185
v_mul_u32_u24 v243, 13107200, v243
v_add_u32 v245, v243, v245
s_lshl_b32 s48, s43, 7
s_add_u32 s48, s48, s44
s_add_u32 s48, s48, 0
v_bfe_u32 v243, v242, 4, 2
v_lshl_add_u32 v245, v243, 4, v245
v_add_f32 v249, v249, v200
v_add_f32 v249, v249, v201
v_add_f32 v249, v249, v202
v_add_f32 v249, v249, v203
ds_read_b128 v[200:203], v244 offset:2064
v_add_f32 v249, v249, v204
ds_read_b32 v204, v244 offset:6144
v_add_f32 v249, v249, v205
v_add_f32 v249, v249, v206
v_add_f32 v249, v249, v207
v_add_f32 v249, v249, v208
v_add_f32 v249, v249, v209
v_add_f32 v249, v249, v210
v_add_f32 v249, v249, v211
v_add_f32 v249, v249, v212
v_add_f32 v249, v249, v213
v_add_f32 v249, v249, v214
v_add_f32 v249, v249, v215
v_add_f32 v249, v249, v216
ds_swizzle_b32 v250, v249 offset:0x401F
v_lshlrev_b32 v206, 16, v196
v_lshlrev_b32 v207, 16, v197
v_and_b32 v196, 0xffff0000, v196
v_and_b32 v197, 0xffff0000, v197
s_waitcnt lgkmcnt(1)
ds_swizzle_b32 v205, v204 offset:0x401F
v_add_f32 v188, v188, v189
ds_bpermute_b32 v189, v247, v188
s_lshl_b32 s51, s43, 7
s_add_u32 s51, s51, s44
s_add_u32 s51, s51, 52428800
s_waitcnt lgkmcnt(2)
v_add_f32 v249, v249, v250
ds_bpermute_b32 v250, v247, v249
s_waitcnt lgkmcnt(2)
v_add_f32 v204, v204, v205
ds_bpermute_b32 v205, v247, v204
s_waitcnt lgkmcnt(2)
v_add_f32 v188, v188, v189
v_rcp_f32 v189, v188
s_nop 0
v_fmac_f32 v0, v190, v189
v_fmac_f32 v2, v191, v189
v_lshlrev_b32 v190, 16, v186
v_lshlrev_b32 v191, 16, v187
v_fmac_f32 v4, v190, v189
v_fmac_f32 v6, v191, v189
v_lshlrev_b32 v190, 16, v232
v_lshlrev_b32 v191, 16, v233
v_and_b32 v232, 0xffff0000, v232
v_fmac_f32 v8, v190, v189
v_fmac_f32 v10, v191, v189
v_fmac_f32 v1, v184, v189
v_fmac_f32 v9, v232, v189
v_and_b32 v233, 0xffff0000, v233
v_lshlrev_b32 v190, 16, v234
v_lshlrev_b32 v191, 16, v235
v_fmac_f32 v3, v185, v189
v_and_b32 v186, 0xffff0000, v186
v_and_b32 v187, 0xffff0000, v187
v_fmac_f32 v11, v233, v189
v_and_b32 v234, 0xffff0000, v234
v_and_b32 v235, 0xffff0000, v235
v_cvt_pk_bf16_f32 v0, v0, v1
v_cvt_pk_bf16_f32 v8, v8, v9
v_fmac_f32 v5, v186, v189
v_fmac_f32 v7, v187, v189
v_fmac_f32 v12, v190, v189
v_fmac_f32 v13, v234, v189
v_fmac_f32 v14, v191, v189
v_fmac_f32 v15, v235, v189
v_cvt_pk_bf16_f32 v1, v2, v3
v_cvt_pk_bf16_f32 v9, v10, v11
v_cvt_pk_bf16_f32 v2, v4, v5
v_cvt_pk_bf16_f32 v3, v6, v7
v_cvt_pk_bf16_f32 v10, v12, v13
v_cvt_pk_bf16_f32 v11, v14, v15
v_pk_max_i16 v0, v0, 0
v_pk_max_i16 v1, v1, 0
v_pk_max_i16 v2, v2, 0
v_pk_max_i16 v3, v3, 0
v_pk_max_i16 v8, v8, 0
v_pk_max_i16 v9, v9, 0
v_pk_max_i16 v10, v10, 0
v_pk_max_i16 v11, v11, 0
buffer_store_dwordx4 v[0:3], v245, s[20:23], s48 offen offset:0 nt
buffer_store_dwordx4 v[8:11], v245, s[20:23], s48 offen offset:64 nt
s_waitcnt lgkmcnt(1)
v_add_f32 v249, v249, v250
v_rcp_f32 v252, v249
s_nop 0
v_fmac_f32 v168, v228, v252
v_fmac_f32 v169, v229, v252
v_fmac_f32 v176, v220, v252
v_fmac_f32 v177, v221, v252
v_fmac_f32 v170, v230, v252
v_fmac_f32 v171, v231, v252
v_cvt_pk_bf16_f32 v168, v168, v169
v_fmac_f32 v178, v222, v252
v_fmac_f32 v179, v223, v252
v_cvt_pk_bf16_f32 v176, v176, v177
v_fmac_f32 v172, v192, v252
v_fmac_f32 v173, v193, v252
v_fmac_f32 v174, v194, v252
v_fmac_f32 v175, v195, v252
v_cvt_pk_bf16_f32 v169, v170, v171
v_fmac_f32 v180, v224, v252
v_fmac_f32 v181, v225, v252
v_fmac_f32 v182, v226, v252
v_fmac_f32 v183, v227, v252
v_cvt_pk_bf16_f32 v177, v178, v179
v_cvt_pk_bf16_f32 v170, v172, v173
v_cvt_pk_bf16_f32 v171, v174, v175
v_cvt_pk_bf16_f32 v178, v180, v181
v_cvt_pk_bf16_f32 v179, v182, v183
v_pk_max_i16 v168, v168, 0
v_pk_max_i16 v169, v169, 0
v_pk_max_i16 v170, v170, 0
v_pk_max_i16 v171, v171, 0
v_pk_max_i16 v176, v176, 0
v_pk_max_i16 v177, v177, 0
v_pk_max_i16 v178, v178, 0
v_pk_max_i16 v179, v179, 0
buffer_store_dwordx4 v[168:171], v239, s[20:23], s53 offen offset:0 nt
buffer_store_dwordx4 v[176:179], v239, s[20:23], s53 offen offset:64 nt
s_waitcnt lgkmcnt(0)
v_add_f32 v204, v204, v205
v_rcp_f32 v205, v204
s_nop 0
v_fmac_f32 v16, v206, v205
v_fmac_f32 v18, v207, v205
v_lshlrev_b32 v206, 16, v198
v_lshlrev_b32 v207, 16, v199
v_fmac_f32 v20, v206, v205
v_fmac_f32 v22, v207, v205
v_lshlrev_b32 v206, 16, v200
v_lshlrev_b32 v207, 16, v201
v_and_b32 v200, 0xffff0000, v200
v_fmac_f32 v24, v206, v205
v_fmac_f32 v26, v207, v205
v_fmac_f32 v17, v196, v205
v_fmac_f32 v25, v200, v205
v_and_b32 v201, 0xffff0000, v201
v_lshlrev_b32 v206, 16, v202
v_lshlrev_b32 v207, 16, v203
v_fmac_f32 v19, v197, v205
v_and_b32 v198, 0xffff0000, v198
v_and_b32 v199, 0xffff0000, v199
v_fmac_f32 v27, v201, v205
v_and_b32 v202, 0xffff0000, v202
v_and_b32 v203, 0xffff0000, v203
v_cvt_pk_bf16_f32 v16, v16, v17
v_cvt_pk_bf16_f32 v24, v24, v25
v_fmac_f32 v21, v198, v205
v_fmac_f32 v23, v199, v205
v_fmac_f32 v28, v206, v205
v_fmac_f32 v29, v202, v205
v_fmac_f32 v30, v207, v205
v_fmac_f32 v31, v203, v205
v_cvt_pk_bf16_f32 v17, v18, v19
v_cvt_pk_bf16_f32 v25, v26, v27
v_cvt_pk_bf16_f32 v18, v20, v21
v_cvt_pk_bf16_f32 v19, v22, v23
v_cvt_pk_bf16_f32 v26, v28, v29
v_cvt_pk_bf16_f32 v27, v30, v31
v_pk_max_i16 v16, v16, 0
v_pk_max_i16 v17, v17, 0
v_pk_max_i16 v18, v18, 0
v_pk_max_i16 v19, v19, 0
v_pk_max_i16 v24, v24, 0
v_pk_max_i16 v25, v25, 0
v_pk_max_i16 v26, v26, 0
v_pk_max_i16 v27, v27, 0
buffer_store_dwordx4 v[16:19], v245, s[20:23], s51 offen offset:0 nt
buffer_store_dwordx4 v[24:27], v245, s[20:23], s51 offen offset:64 nt
L_end:
s_endpgm
.section .rodata,"a"
.p2align 6
.amdhsa_kernel standalone__attention_interact_autoint__recsys_kernel
  .amdhsa_next_free_vgpr 512
  .amdhsa_next_free_sgpr 102
  .amdhsa_accum_offset 256
  .amdhsa_group_segment_fixed_size 0
  .amdhsa_kernarg_size 64
  .amdhsa_user_sgpr_count 2
  .amdhsa_user_sgpr_kernarg_segment_ptr 1
  .amdhsa_system_sgpr_workgroup_id_x 1
.end_amdhsa_kernel
```

```asm
; @launch grid=(256,1,1) block=(256,1,1) lds=163840
.amdgcn_target "amdgcn-amd-amdhsa--gfx950"
.text
.globl standalone__attention_interact_autoint__recsys_kernel
.p2align 8
.type standalone__attention_interact_autoint__recsys_kernel,@function
standalone__attention_interact_autoint__recsys_kernel:
s_cmp_ge_u32 s2, 256
s_cbranch_scc1 L_end
s_load_dwordx2 s[24:25], s[0:1], 8
s_load_dwordx2 s[16:17], s[0:1], 0
s_load_dwordx2 s[28:29], s[0:1], 16
s_load_dwordx2 s[32:33], s[0:1], 24
s_load_dwordx2 s[36:37], s[0:1], 32
s_load_dwordx2 s[20:21], s[0:1], 40
s_getpc_b64 s[58:59]
L_pc:
s_lshl_b32 s3, s2, 8
s_and_b32 s3, s3, 0x7800
v_lshrrev_b32 v2, 4, v0
v_lshl_add_u32 v2, v2, 7, s3
v_min_u32 v2, L_fast_end-L_pc-4, v2
global_load_dword v96, v2, s[58:59]
v_lshrrev_b32 v1, 6, v0
s_mov_b32 s19, 0x20000
v_readfirstlane_b32 s41, v1
s_mov_b32 s18, 104857600
s_mov_b32 s26, 32768
s_mov_b32 s27, s19
s_lshr_b32 s42, s41, 1
s_and_b32 s43, s41, 1
s_lshl1_add_u32 s44, s2, s42
s_mul_i32 s44, s44, 25600
s_mov_b64 s[30:31], s[26:27]
s_mov_b64 s[34:35], s[26:27]
s_mov_b64 s[38:39], s[26:27]
s_lshl_b32 s54, s41, 13
s_mul_i32 s49, s42, 25344
s_mul_i32 s53, s43, 1056
s_add_u32 s49, s49, s53
s_lshl_b32 s55, s43, 10
s_add_u32 s55, s55, s44
s_lshl_b32 s6, s2, 7
s_and_b32 s6, s6, 0x7c00
s_add_u32 s57, s54, 4096
s_add_u32 m0, s49, 21120
s_add_u32 s48, s55, 20480
v_and_b32 v168, 63, v0
v_lshlrev_b32 v175, 4, v168
v_and_b32 v243, 48, v175
v_and_b32 v169, 48, v168
v_lshl_add_u32 v243, v169, 2, v243
v_and_b32 v169, 12, v168
v_lshl_add_u32 v243, v169, 6, v243
v_lshrrev_b32 v169, 5, v0
v_lshlrev_b32 v169, 7, v169
s_waitcnt lgkmcnt(0)
buffer_load_dword v97, v169, s[24:27], s6 offen
buffer_load_dword v98, v169, s[28:31], s6 offen
buffer_load_dword v99, v169, s[32:35], s6 offen
buffer_load_dword v100, v169, s[36:39], s6 offen
buffer_load_dwordx4 v[104:107], v175, s[24:27], s54 offen offset:0
buffer_load_dwordx4 v[108:111], v175, s[24:27], s54 offen offset:1024
buffer_load_dwordx4 v[112:115], v175, s[24:27], s54 offen offset:2048
buffer_load_dwordx4 v[116:119], v175, s[24:27], s54 offen offset:3072
buffer_load_dwordx4 v[120:123], v175, s[24:27], s57 offen offset:0
buffer_load_dwordx4 v[124:127], v175, s[24:27], s57 offen offset:1024
buffer_load_dwordx4 v[128:131], v175, s[24:27], s57 offen offset:2048
buffer_load_dwordx4 v[132:135], v175, s[24:27], s57 offen offset:3072
s_mov_b32 s40, 0x3e38aa3b
s_mov_b32 s22, s18
s_mov_b32 s23, s19
s_mov_b32 s45, 8
s_mov_b32 s3, 64
s_mov_b32 s46, s44
s_mov_b32 s47, 0x7ff00000
s_mov_b32 s56, 50688
s_mov_b32 s96, 0x3b8265d9
s_mov_b32 s97, 0
s_mov_b32 s14, 0x55555555
s_mov_b32 s15, 0x55555555
s_mul_i32 s98, s42, 25344
s_lshl_b32 s53, s43, 13
s_add_u32 s98, s98, s53
s_add_u32 s53, s98, 4224
v_and_b32 v169, 16, v168
v_mov_b32 v180, v169
v_lshlrev_b32 v169, 1, v169
v_xor_b32 v170, v175, v169
v_add_u32 v172, s53, v170
v_xor_b32 v171, 64, v170
v_add_u32 v173, s53, v171
s_mul_i32 s53, s43, 25344
s_add_u32 s7, s53, 4224
v_lshrrev_b32 v82, 4, v168
v_lshl_add_u32 v176, v82, 10, s7
v_bfe_u32 v83, v168, 2, 2
v_lshl_add_u32 v176, v83, 7, v176
v_bfe_u32 v84, v168, 3, 1
v_lshl_add_u32 v176, v84, 5, v176
v_bfe_u32 v85, v168, 4, 1
v_lshl_add_u32 v176, v85, 6, v176
v_and_b32 v86, 3, v168
v_lshl_add_u32 v176, v86, 3, v176
v_xor_b32 v177, 32, v176
v_xor_b32 v178, 64, v176
s_mul_i32 s53, s42, 25344
v_lshl_add_u32 v242, v86, 6, s53
v_lshl_add_u32 v242, v82, 4, v242
s_mov_b32 s6, 1056
v_mad_u32_u24 v242, v83, s6, v242
v_xor_b32 v179, 96, v176
s_mul_i32 s4, s43, 13107200
s_add_u32 s4, s4, s44
s_add_u32 s4, s4, 24576
s_mul_i32 s5, s43, -52424704
s_add_u32 s5, s5, 104833024
s_add_u32 s99, s4, 0
s_add_u32 s100, s4, 26212288
v_lshrrev_b32 v80, 3, v168
v_lshlrev_b32 v174, 8, v80
v_and_b32 v81, 7, v168
v_lshl_add_u32 v174, v81, 4, v174
v_xor_b32 v174, v174, v180
v_xor_b32 v180, v175, v180
s_mul_i32 s53, s41, 816
s_add_u32 s53, s53, 157696
v_and_b32 v88, 1, v168
v_lshl_add_u32 v249, v83, 6, s53
v_lshl_add_u32 v249, v88, 5, v249
s_add_u32 s8, s53, 256
s_mov_b32 vcc_lo, 0x33333333
s_mov_b32 vcc_hi, 0xcccccccc
v_lshl_add_u32 v249, v85, 4, v249
v_mov_b32 v166, s8
v_cndmask_b32 v249, v166, v249, vcc
s_add_u32 s9, s53, 256
v_lshl_add_u32 v166, v83, 2, s9
s_mov_b32 s8, 272
v_lshl_add_u32 v248, v82, 6, s53
v_mov_b32 v236, 0
v_mad_u32_u24 v166, v86, s8, v166
s_lshl_b32 s53, s41, 8
s_add_u32 s10, s53, 101376
ds_write_b32 v166, v236 offset:0
s_add_u32 s58, s53, 36096
s_xor_b32 s59, s53, 256
s_add_u32 s59, s59, 36096
v_lshl_add_u32 v166, v168, 2, s10
v_bfe_u32 v87, v168, 1, 1
v_lshl_add_u32 v248, v87, 5, v248
v_lshl_add_u32 v248, v83, 3, v248
v_lshl_add_u32 v248, v88, 1, v248
ds_write_b32 v166, v166 offset:0
s_mov_b64 exec, 0
s_cmp_eq_u32 s41, 0
s_cbranch_scc1 L_h0
s_cmp_eq_u32 s41, 1
s_cbranch_scc1 L_h1
s_cmp_eq_u32 s41, 2
s_cbranch_scc1 L_h2
s_branch L_h3
L_ret:
s_mov_b64 exec, -1
buffer_load_dwordx4 v243, s[16:19], s48 offen nt lds
s_add_u32 m0, s49, 23232
s_add_u32 s48, s55, 22528
buffer_load_dwordx4 v243, s[16:19], s48 offen nt lds
s_add_u32 m0, s49, 0
s_add_u32 s48, s55, 0
buffer_load_dwordx4 v243, s[16:19], s48 offen nt lds
s_add_u32 m0, s49, 2112
s_add_u32 s48, s55, 2048
buffer_load_dwordx4 v243, s[16:19], s48 offen nt lds
s_add_u32 m0, s98, 102400
s_waitcnt vmcnt(11)
v_and_b32 v160, 0xffff0000, v104
v_and_b32 v161, 0xffff0000, v105
v_and_b32 v162, 0xffff0000, v106
v_and_b32 v163, 0xffff0000, v107
v_lshlrev_b32 v104, 16, v104
v_lshlrev_b32 v105, 16, v105
v_lshlrev_b32 v106, 16, v106
v_lshlrev_b32 v107, 16, v107
v_mul_f32 v160, s40, v160
v_mul_f32 v104, s40, v104
v_mul_f32 v161, s40, v161
v_mul_f32 v105, s40, v105
v_mul_f32 v162, s40, v162
v_mul_f32 v106, s40, v106
v_mul_f32 v163, s40, v163
v_mul_f32 v107, s40, v107
v_cvt_pk_bf16_f32 v104, v104, v160
v_cvt_pk_bf16_f32 v105, v105, v161
v_cvt_pk_bf16_f32 v106, v106, v162
v_cvt_pk_bf16_f32 v107, v107, v163
ds_write_b128 v172, v[104:107] offset:0
buffer_load_dwordx4 v170, s[28:31], s54 offen offset:0 lds
buffer_load_dwordx4 v171, s[28:31], s54 offen offset:1024 lds
s_waitcnt vmcnt(12)
v_and_b32 v160, 0xffff0000, v108
v_and_b32 v161, 0xffff0000, v109
v_and_b32 v162, 0xffff0000, v110
v_and_b32 v163, 0xffff0000, v111
v_lshlrev_b32 v108, 16, v108
v_lshlrev_b32 v109, 16, v109
v_lshlrev_b32 v110, 16, v110
v_lshlrev_b32 v111, 16, v111
v_mul_f32 v160, s40, v160
v_mul_f32 v108, s40, v108
v_mul_f32 v161, s40, v161
v_mul_f32 v109, s40, v109
v_mul_f32 v162, s40, v162
v_mul_f32 v110, s40, v110
v_mul_f32 v163, s40, v163
v_mul_f32 v111, s40, v111
v_cvt_pk_bf16_f32 v108, v108, v160
v_cvt_pk_bf16_f32 v109, v109, v161
v_cvt_pk_bf16_f32 v110, v110, v162
v_cvt_pk_bf16_f32 v111, v111, v163
ds_write_b128 v173, v[108:111] offset:1024
buffer_load_dwordx4 v170, s[28:31], s54 offen offset:2048 lds
buffer_load_dwordx4 v171, s[28:31], s54 offen offset:3072 lds
s_add_u32 m0, s98, 106496
s_waitcnt vmcnt(13)
v_and_b32 v160, 0xffff0000, v112
v_and_b32 v161, 0xffff0000, v113
v_and_b32 v162, 0xffff0000, v114
v_and_b32 v163, 0xffff0000, v115
v_lshlrev_b32 v112, 16, v112
v_lshlrev_b32 v113, 16, v113
v_lshlrev_b32 v114, 16, v114
v_lshlrev_b32 v115, 16, v115
v_mul_f32 v160, s40, v160
v_mul_f32 v112, s40, v112
v_mul_f32 v161, s40, v161
v_mul_f32 v113, s40, v113
v_mul_f32 v162, s40, v162
v_mul_f32 v114, s40, v114
v_mul_f32 v163, s40, v163
v_mul_f32 v115, s40, v115
v_cvt_pk_bf16_f32 v112, v112, v160
v_cvt_pk_bf16_f32 v113, v113, v161
v_cvt_pk_bf16_f32 v114, v114, v162
v_cvt_pk_bf16_f32 v115, v115, v163
ds_write_b128 v172, v[112:115] offset:2048
buffer_load_dwordx4 v170, s[28:31], s57 offen offset:0 lds
buffer_load_dwordx4 v171, s[28:31], s57 offen offset:1024 lds
s_waitcnt vmcnt(14)
v_and_b32 v160, 0xffff0000, v116
v_and_b32 v161, 0xffff0000, v117
v_and_b32 v162, 0xffff0000, v118
v_and_b32 v163, 0xffff0000, v119
v_lshlrev_b32 v116, 16, v116
v_lshlrev_b32 v117, 16, v117
v_lshlrev_b32 v118, 16, v118
v_lshlrev_b32 v119, 16, v119
v_mul_f32 v160, s40, v160
v_mul_f32 v116, s40, v116
v_mul_f32 v161, s40, v161
v_mul_f32 v117, s40, v117
v_mul_f32 v162, s40, v162
v_mul_f32 v118, s40, v118
v_mul_f32 v163, s40, v163
v_mul_f32 v119, s40, v119
v_cvt_pk_bf16_f32 v116, v116, v160
v_cvt_pk_bf16_f32 v117, v117, v161
v_cvt_pk_bf16_f32 v118, v118, v162
v_cvt_pk_bf16_f32 v119, v119, v163
ds_write_b128 v173, v[116:119] offset:3072
buffer_load_dwordx4 v170, s[28:31], s57 offen offset:2048 lds
buffer_load_dwordx4 v171, s[28:31], s57 offen offset:3072 lds
s_add_u32 m0, s49, 50688
s_waitcnt vmcnt(15)
v_and_b32 v160, 0xffff0000, v120
v_and_b32 v161, 0xffff0000, v121
v_and_b32 v162, 0xffff0000, v122
v_and_b32 v163, 0xffff0000, v123
v_lshlrev_b32 v120, 16, v120
v_lshlrev_b32 v121, 16, v121
v_lshlrev_b32 v122, 16, v122
v_lshlrev_b32 v123, 16, v123
v_mul_f32 v160, s40, v160
v_mul_f32 v120, s40, v120
v_mul_f32 v161, s40, v161
v_mul_f32 v121, s40, v121
v_mul_f32 v162, s40, v162
v_mul_f32 v122, s40, v122
v_mul_f32 v163, s40, v163
v_mul_f32 v123, s40, v123
v_cvt_pk_bf16_f32 v120, v120, v160
v_cvt_pk_bf16_f32 v121, v121, v161
v_cvt_pk_bf16_f32 v122, v122, v162
v_cvt_pk_bf16_f32 v123, v123, v163
ds_write_b128 v172, v[120:123] offset:4096
s_waitcnt vmcnt(14)
v_and_b32 v160, 0xffff0000, v124
v_and_b32 v161, 0xffff0000, v125
v_and_b32 v162, 0xffff0000, v126
v_and_b32 v163, 0xffff0000, v127
v_lshlrev_b32 v124, 16, v124
v_lshlrev_b32 v125, 16, v125
v_lshlrev_b32 v126, 16, v126
v_lshlrev_b32 v127, 16, v127
v_mul_f32 v160, s40, v160
v_mul_f32 v124, s40, v124
v_mul_f32 v161, s40, v161
v_mul_f32 v125, s40, v125
v_mul_f32 v162, s40, v162
v_mul_f32 v126, s40, v126
v_mul_f32 v163, s40, v163
v_mul_f32 v127, s40, v127
v_cvt_pk_bf16_f32 v124, v124, v160
v_cvt_pk_bf16_f32 v125, v125, v161
v_cvt_pk_bf16_f32 v126, v126, v162
v_cvt_pk_bf16_f32 v127, v127, v163
ds_write_b128 v173, v[124:127] offset:5120
s_waitcnt vmcnt(13)
v_and_b32 v160, 0xffff0000, v128
v_and_b32 v161, 0xffff0000, v129
v_and_b32 v162, 0xffff0000, v130
v_and_b32 v163, 0xffff0000, v131
v_lshlrev_b32 v128, 16, v128
v_lshlrev_b32 v129, 16, v129
v_lshlrev_b32 v130, 16, v130
v_lshlrev_b32 v131, 16, v131
v_mul_f32 v160, s40, v160
v_mul_f32 v128, s40, v128
v_mul_f32 v161, s40, v161
v_mul_f32 v129, s40, v129
v_mul_f32 v162, s40, v162
v_mul_f32 v130, s40, v130
v_mul_f32 v163, s40, v163
v_mul_f32 v131, s40, v131
v_cvt_pk_bf16_f32 v128, v128, v160
v_cvt_pk_bf16_f32 v129, v129, v161
v_cvt_pk_bf16_f32 v130, v130, v162
v_cvt_pk_bf16_f32 v131, v131, v163
ds_write_b128 v172, v[128:131] offset:6144
s_waitcnt vmcnt(12)
v_and_b32 v160, 0xffff0000, v132
v_and_b32 v161, 0xffff0000, v133
v_and_b32 v162, 0xffff0000, v134
v_and_b32 v163, 0xffff0000, v135
v_lshlrev_b32 v132, 16, v132
v_lshlrev_b32 v133, 16, v133
v_lshlrev_b32 v134, 16, v134
v_lshlrev_b32 v135, 16, v135
v_mul_f32 v160, s40, v160
v_mul_f32 v132, s40, v132
v_mul_f32 v161, s40, v161
v_mul_f32 v133, s40, v133
v_mul_f32 v162, s40, v162
v_mul_f32 v134, s40, v134
v_mul_f32 v163, s40, v163
v_mul_f32 v135, s40, v135
v_cvt_pk_bf16_f32 v132, v132, v160
v_cvt_pk_bf16_f32 v133, v133, v161
v_cvt_pk_bf16_f32 v134, v134, v162
v_cvt_pk_bf16_f32 v135, v135, v163
ds_write_b128 v173, v[132:135] offset:7168
s_waitcnt vmcnt(10) lgkmcnt(0)
s_barrier
ds_read_b64_tr_b16 a[28:29], v177 offset:12288
ds_read_b128 v[188:191], v242 offset:21120
ds_read_b64_tr_b16 a[30:31], v177 offset:12800
ds_read_b128 v[212:215], v242 offset:21376
ds_read_b64_tr_b16 a[0:1], v176 offset:0
ds_read_b128 v[224:227], v242 offset:21632
ds_read_b64_tr_b16 a[2:3], v176 offset:512
ds_read_b128 v[232:235], v242 offset:21888
ds_read_b64_tr_b16 a[24:25], v177 offset:8192
ds_read_b64_tr_b16 a[26:27], v177 offset:8704
ds_read_b64_tr_b16 a[4:5], v176 offset:4096
ds_read_b64_tr_b16 a[6:7], v176 offset:4608
ds_read_b64_tr_b16 a[20:21], v177 offset:4096
ds_read_b64_tr_b16 a[22:23], v177 offset:4608
ds_read_b64_tr_b16 a[8:9], v176 offset:8192
ds_read_b64_tr_b16 a[10:11], v176 offset:8704
ds_read_b64_tr_b16 a[16:17], v177 offset:0
ds_read_b64_tr_b16 a[18:19], v177 offset:512
ds_read_b64_tr_b16 a[12:13], v176 offset:12288
ds_read_b64_tr_b16 a[14:15], v176 offset:12800
ds_read_b64_tr_b16 a[32:33], v178 offset:0
ds_read_b64_tr_b16 a[34:35], v178 offset:512
ds_read_b64_tr_b16 a[36:37], v178 offset:4096
ds_read_b64_tr_b16 a[38:39], v178 offset:4608
ds_read_b64_tr_b16 a[40:41], v178 offset:8192
ds_read_b64_tr_b16 a[42:43], v178 offset:8704
ds_read_b64_tr_b16 a[44:45], v178 offset:12288
ds_read_b64_tr_b16 a[46:47], v178 offset:12800
s_waitcnt lgkmcnt(15)
v_mfma_f32_16x16x32_bf16 v[192:195], a[0:3], v[188:191], 0
s_waitcnt lgkmcnt(12)
ds_read_b64_tr_b16 a[48:49], v179 offset:0
v_add_u32 v176, 98176, v176
v_mfma_f32_16x16x32_bf16 v[192:195], a[4:7], v[212:215], v[192:195]
s_waitcnt lgkmcnt(9)
ds_read_b64_tr_b16 a[50:51], v179 offset:512
v_add_u32 v177, 98176, v177
v_mfma_f32_16x16x32_bf16 v[192:195], a[8:11], v[224:227], v[192:195]
s_mul_i32 s53, s43, 25344
ds_read_b64_tr_b16 a[52:53], v179 offset:4096
v_add_u32 v178, 98176, v178
v_mfma_f32_16x16x32_bf16 v[192:195], a[12:15], v[232:235], v[192:195]
s_add_u32 s11, s53, 59648
ds_read_b64_tr_b16 a[54:55], v179 offset:4608
v_lshl_add_u32 v182, v82, 10, s11
v_mfma_f32_16x16x32_bf16 v[196:199], a[28:31], v[232:235], 0
s_lshl_b32 s53, s43, 7
ds_read_b64_tr_b16 a[56:57], v179 offset:8192
v_lshl_add_u32 v182, v83, 7, v182
v_mfma_f32_16x16x32_bf16 v[196:199], a[24:27], v[224:227], v[196:199]
s_mov_b32 s51, -32
ds_read_b64_tr_b16 a[58:59], v179 offset:8704
v_cvt_pk_bf16_f32 v152, v192, v193
v_mfma_f32_16x16x32_bf16 v[196:199], a[20:23], v[212:215], v[196:199]
s_waitcnt lgkmcnt(12)
ds_read_b64_tr_b16 a[60:61], v179 offset:12288
v_cvt_pk_bf16_f32 v153, v194, v195
v_mfma_f32_16x16x32_bf16 v[196:199], a[16:19], v[188:191], v[196:199]
s_waitcnt lgkmcnt(11)
ds_read_b64_tr_b16 a[62:63], v179 offset:12800
v_add_u32 v179, 98176, v179
v_mfma_f32_16x16x32_bf16 v[200:203], a[32:35], v[188:191], 0
s_waitcnt lgkmcnt(10)
buffer_load_dwordx4 v243, s[16:19], s99 offen offset:0 nt lds
v_mfma_f32_16x16x32_bf16 v[200:203], a[36:39], v[212:215], v[200:203]
s_waitcnt lgkmcnt(8)
buffer_load_dwordx4 v243, s[16:19], s100 offen offset:2112 nt lds
v_mfma_f32_16x16x32_bf16 v[200:203], a[40:43], v[224:227], v[200:203]
s_add_u32 m0, s49, 54912
s_add_u32 s99, s4, 52428800
s_add_u32 s100, s4, 78641088
v_mfma_f32_16x16x32_bf16 v[200:203], a[44:47], v[232:235], v[200:203]
s_waitcnt lgkmcnt(4)
buffer_load_dwordx4 v243, s[16:19], s99 offen offset:0 nt lds
s_add_u32 s99, s55, 4096
v_cvt_pk_bf16_f32 v154, v196, v197
v_cvt_pk_bf16_f32 v155, v198, v199
s_waitcnt lgkmcnt(0)
v_mfma_f32_16x16x32_bf16 v[204:207], a[60:63], v[232:235], 0
buffer_load_dwordx4 v243, s[16:19], s100 offen offset:2112 nt lds
v_mfma_f32_16x16x32_bf16 v[204:207], a[52:55], v[212:215], v[204:207]
s_waitcnt vmcnt(12)
s_barrier
v_mfma_f32_16x16x32_bf16 v[204:207], a[48:51], v[188:191], v[204:207]
s_add_u32 m0, s98, 59648
ds_read_b128 v[208:211], v242 offset:512
ds_read_b128 v[216:219], v242 offset:768
v_mfma_f32_16x16x32_bf16 v[204:207], a[56:59], v[224:227], v[204:207]
s_add_u32 s100, s55, 4032
ds_read_b128 v[220:223], v242 offset:256
ds_read_b128 v[228:231], v242 offset:0
v_cvt_pk_bf16_f32 v156, v200, v201
v_cvt_pk_bf16_f32 v157, v202, v203
v_lshl_add_u32 v182, v84, 4, v182
v_lshl_add_u32 v182, v86, 5, v182
v_xor_b32 v183, 16, v182
v_bfe_u32 v89, v168, 1, 3
v_cvt_pk_bf16_f32 v158, v204, v205
v_cvt_pk_bf16_f32 v159, v206, v207
v_lshl_add_u32 v244, v89, 9, s53
s_mul_i32 s52, s41, 13824
s_add_u32 s52, s52, 102400
v_lshlrev_b32 v95, 4, v83
s_mov_b32 vcc_lo, 0x33333333
s_mov_b32 vcc_hi, 0x33333333
v_and_b32 v16, 15, v168
s_waitcnt lgkmcnt(3)
v_mfma_f32_16x16x32_bf16 v[192:195], a[56:59], v[208:211], 0
s_waitcnt lgkmcnt(2)
v_mov_b32 v169, 163024
v_lshrrev_b32 v92, 5, v168
v_mfma_f32_16x16x32_bf16 v[192:195], a[60:63], v[216:219], v[192:195]
s_waitcnt lgkmcnt(0)
v_lshl_add_u32 v164, v86, 7, s52
v_lshl_add_u32 v164, v92, 4, v164
v_mfma_f32_16x16x32_bf16 v[192:195], a[52:55], v[220:223], v[192:195]
s_waitcnt vmcnt(4)
s_barrier
v_mfma_f32_16x16x32_bf16 v[192:195], a[48:51], v[228:231], v[192:195]
s_lshl_b32 s53, s41, 9
ds_read_b64_tr_b16 a[64:65], v176 offset:0
v_lshl_add_u32 v164, v85, 3, v164
v_mfma_f32_16x16x32_bf16 v[196:199], a[32:35], v[228:231], 0
s_add_u32 s11, s53, 160960
ds_read_b64_tr_b16 a[66:67], v176 offset:512
v_lshl_add_u32 v167, v16, 4, s11
v_mfma_f32_16x16x32_bf16 v[196:199], a[36:39], v[220:223], v[196:199]
s_add_u32 s13, s52, 512
ds_read_b64_tr_b16 a[68:69], v176 offset:4096
v_cvt_pk_bf16_f32 v102, v192, v193
v_mfma_f32_16x16x32_bf16 v[196:199], a[40:43], v[208:211], v[196:199]
s_add_u32 s7, s52, 1072
ds_read_b64_tr_b16 a[70:71], v176 offset:4608
v_cvt_pk_bf16_f32 v103, v194, v195
v_mfma_f32_16x16x32_bf16 v[196:199], a[44:47], v[216:219], v[196:199]
s_add_u32 s10, s52, 1136
ds_read_b64_tr_b16 a[72:73], v176 offset:8192
v_lshl_add_u32 v247, v83, 7, s13
v_mfma_f32_16x16x32_bf16 v[192:195], a[28:31], v[216:219], 0
s_add_u32 s12, s52, 1136
ds_read_b64_tr_b16 a[74:75], v176 offset:8704
v_lshl_add_u32 v247, v88, 6, v247
v_mfma_f32_16x16x32_bf16 v[192:195], a[24:27], v[208:211], v[192:195]
s_add_u32 s9, s52, 1072
ds_read_b64_tr_b16 a[76:77], v176 offset:12288
v_cvt_pk_bf16_f32 v100, v196, v197
v_mfma_f32_16x16x32_bf16 v[192:195], a[20:23], v[220:223], v[192:195]
ds_read_b64_tr_b16 a[78:79], v176 offset:12800
v_cvt_pk_bf16_f32 v101, v198, v199
v_mfma_f32_16x16x32_bf16 v[192:195], a[16:19], v[228:231], v[192:195]
ds_read_b64_tr_b16 a[80:81], v177 offset:0
v_lshl_add_u32 v247, v82, 4, v247
v_mfma_f32_16x16x32_bf16 v[196:199], a[0:3], v[228:231], 0
ds_read_b64_tr_b16 a[82:83], v177 offset:512
v_mov_b32 v166, s7
v_mfma_f32_16x16x32_bf16 v[196:199], a[4:7], v[220:223], v[196:199]
s_mov_b32 s7, 1728
ds_read_b64_tr_b16 a[84:85], v177 offset:4096
v_cvt_pk_bf16_f32 v98, v192, v193
v_mfma_f32_16x16x32_bf16 v[196:199], a[8:11], v[208:211], v[196:199]
s_waitcnt lgkmcnt(9)
ds_read_b64_tr_b16 a[86:87], v177 offset:4608
v_cvt_pk_bf16_f32 v99, v194, v195
v_mfma_f32_16x16x32_bf16 v[196:199], a[12:15], v[216:219], v[196:199]
L_h0:
s_cbranch_execz L_h4
s_waitcnt lgkmcnt(8)
ds_read_b64_tr_b16 a[88:89], v177 offset:8192
v_xor_b32 v247, v95, v247
v_mfma_f32_16x16x32_bf16 v[192:195], a[64:67], v[188:191], 0
s_waitcnt lgkmcnt(7)
ds_read_b64_tr_b16 a[90:91], v177 offset:8704
v_cndmask_b32 v247, v166, v247, vcc
v_mfma_f32_16x16x32_bf16 v[192:195], a[68:71], v[212:215], v[192:195]
s_waitcnt lgkmcnt(6)
ds_read_b64_tr_b16 a[92:93], v177 offset:12288
v_cvt_pk_bf16_f32 v96, v196, v197
v_mfma_f32_16x16x32_bf16 v[192:195], a[72:75], v[224:227], v[192:195]
ds_read_b64_tr_b16 a[94:95], v177 offset:12800
v_cvt_pk_bf16_f32 v97, v198, v199
v_mfma_f32_16x16x32_bf16 v[192:195], a[76:79], v[232:235], v[192:195]
ds_read_b64_tr_b16 a[96:97], v178 offset:0
v_lshlrev_b32 v17, 4, v86
v_mfma_f32_16x16x32_bf16 v[196:199], a[76:79], v[216:219], 0
ds_read_b64_tr_b16 a[98:99], v178 offset:512
v_mad_u32_u24 v164, v83, s7, v164
v_mfma_f32_16x16x32_bf16 v[196:199], a[64:67], v[228:231], v[196:199]
ds_read_b64_tr_b16 a[100:101], v178 offset:4096
v_lshl_add_u32 v250, v16, 2, s52
v_mfma_f32_16x16x32_bf16 v[196:199], a[68:71], v[220:223], v[196:199]
s_waitcnt lgkmcnt(5)
ds_read_b64_tr_b16 a[102:103], v178 offset:4608
v_cvt_pk_bf16_f32 v40, v192, v193
v_mfma_f32_16x16x32_bf16 v[196:199], a[72:75], v[208:211], v[196:199]
ds_read_b64_tr_b16 a[104:105], v178 offset:8192
v_cvt_pk_bf16_f32 v41, v194, v195
v_mfma_f32_16x16x32_bf16 v[200:203], a[88:91], v[208:211], 0
ds_read_b64_tr_b16 a[106:107], v178 offset:8704
v_lshl_add_u32 v181, v16, 3, s10
v_mfma_f32_16x16x32_bf16 v[200:203], a[84:87], v[220:223], v[200:203]
s_waitcnt lgkmcnt(6)
ds_read_b64_tr_b16 a[108:109], v178 offset:12288
v_cvt_pk_bf16_f32 v0, v196, v197
v_mfma_f32_16x16x32_bf16 v[200:203], a[80:83], v[228:231], v[200:203]
ds_read_b64_tr_b16 a[110:111], v178 offset:12800
v_cvt_pk_bf16_f32 v1, v198, v199
v_mfma_f32_16x16x32_bf16 v[200:203], a[92:95], v[216:219], v[200:203]
ds_read_b64_tr_b16 a[112:113], v179 offset:0
v_xor_b32 v164, v17, v164
v_mfma_f32_16x16x32_bf16 v[192:195], a[92:95], v[232:235], 0
ds_read_b64_tr_b16 a[114:115], v179 offset:512
v_bfe_u32 v90, v168, 3, 2
v_mfma_f32_16x16x32_bf16 v[192:195], a[88:91], v[224:227], v[192:195]
ds_read_b64_tr_b16 a[116:117], v179 offset:4096
v_bfe_u32 v91, v168, 2, 1
v_mfma_f32_16x16x32_bf16 v[192:195], a[84:87], v[212:215], v[192:195]
s_waitcnt lgkmcnt(9)
ds_read_b64_tr_b16 a[118:119], v179 offset:4608
v_cvt_pk_bf16_f32 v2, v200, v201
v_mfma_f32_16x16x32_bf16 v[192:195], a[80:83], v[188:191], v[192:195]
s_waitcnt lgkmcnt(8)
ds_read_b64_tr_b16 a[120:121], v179 offset:8192
v_cvt_pk_bf16_f32 v3, v202, v203
v_mfma_f32_16x16x32_bf16 v[196:199], a[96:99], v[188:191], 0
s_waitcnt lgkmcnt(7)
ds_read_b64_tr_b16 a[122:123], v179 offset:8704
v_lshl_add_u32 v246, v90, 7, s12
v_mfma_f32_16x16x32_bf16 v[196:199], a[100:103], v[212:215], v[196:199]
s_waitcnt lgkmcnt(6)
ds_read_b64_tr_b16 a[124:125], v179 offset:12288
v_cvt_pk_bf16_f32 v42, v192, v193
v_mfma_f32_16x16x32_bf16 v[196:199], a[104:107], v[224:227], v[196:199]
ds_read_b64_tr_b16 a[126:127], v179 offset:12800
v_cvt_pk_bf16_f32 v43, v194, v195
v_mfma_f32_16x16x32_bf16 v[196:199], a[108:111], v[232:235], v[196:199]
buffer_load_dwordx4 v180, s[32:35], s54 offen offset:0 lds
v_mfma_f32_16x16x32_bf16 v[192:195], a[108:111], v[216:219], 0
buffer_load_dwordx4 v180, s[32:35], s54 offen offset:1024 lds
v_mfma_f32_16x16x32_bf16 v[192:195], a[96:99], v[228:231], v[192:195]
s_mov_b32 vcc_lo, 0xf0000f
s_mov_b32 vcc_hi, 0xf0000f00
v_cndmask_b32 v167, v169, v167, vcc
v_mfma_f32_16x16x32_bf16 v[192:195], a[100:103], v[220:223], v[192:195]
s_waitcnt lgkmcnt(2)
buffer_load_dwordx4 v180, s[32:35], s54 offen offset:2048 lds
v_mfma_f32_16x16x32_bf16 v[192:195], a[104:107], v[208:211], v[192:195]
buffer_load_dwordx4 v180, s[32:35], s54 offen offset:3072 lds
v_mfma_f32_16x16x32_bf16 v[200:203], a[120:123], v[208:211], 0
s_add_u32 m0, s98, 63744
v_cvt_pk_bf16_f32 v44, v196, v197
v_cvt_pk_bf16_f32 v45, v198, v199
v_mfma_f32_16x16x32_bf16 v[200:203], a[116:119], v[220:223], v[200:203]
s_waitcnt lgkmcnt(0)
buffer_load_dwordx4 v180, s[32:35], s57 offen offset:0 lds
v_mfma_f32_16x16x32_bf16 v[200:203], a[112:115], v[228:231], v[200:203]
buffer_load_dwordx4 v180, s[32:35], s57 offen offset:1024 lds
v_mfma_f32_16x16x32_bf16 v[200:203], a[124:127], v[216:219], v[200:203]
v_cvt_pk_bf16_f32 v4, v192, v193
v_cvt_pk_bf16_f32 v5, v194, v195
v_mfma_f32_16x16x32_bf16 v[192:195], a[124:127], v[232:235], 0
buffer_load_dwordx4 v180, s[32:35], s57 offen offset:2048 lds
v_mfma_f32_16x16x32_bf16 v[192:195], a[120:123], v[224:227], v[192:195]
buffer_load_dwordx4 v180, s[32:35], s57 offen offset:3072 lds
v_mfma_f32_16x16x32_bf16 v[192:195], a[116:119], v[212:215], v[192:195]
s_add_u32 m0, s49, 4224
s_lshl_b32 s57, s43, 14
s_lshl_b32 s53, s42, 7
s_add_u32 s57, s57, s53
v_mfma_f32_16x16x32_bf16 v[192:195], a[112:115], v[188:191], v[192:195]
v_cvt_pk_bf16_f32 v6, v200, v201
v_cvt_pk_bf16_f32 v7, v202, v203
v_lshl_add_u32 v245, v84, 8, s52
v_lshl_add_u32 v246, v91, 6, v246
v_mfma_f32_16x16x32_bf16 v[196:199], v[4:7], v[156:159], 0
v_lshl_add_u32 v245, v87, 7, v245
v_lshlrev_b32 v94, 4, v87
v_mfma_f32_16x16x32_bf16 v[196:199], v[0:3], v[152:155], v[196:199]
v_cvt_pk_bf16_f32 v46, v192, v193
v_cvt_pk_bf16_f32 v47, v194, v195
v_mfma_f32_16x16x32_bf16 v[192:195], v[40:43], v[152:155], 0
v_lshl_add_u32 v246, v86, 3, v246
v_xor_b32 v165, 32, v164
v_mfma_f32_16x16x32_bf16 v[192:195], v[44:47], v[156:159], v[192:195]
v_lshl_add_u32 v245, v88, 6, v245
v_lshl_add_u32 v245, v82, 4, v245
v_mfma_f32_16x16x32_bf16 v[200:203], v[44:47], v[100:103], 0
v_exp_f32 v196, v196
v_mfma_f32_16x16x32_bf16 v[200:203], v[40:43], v[96:99], v[200:203]
v_exp_f32 v197, v197
v_mfma_f32_16x16x32_bf16 v[204:207], v[0:3], v[96:99], 0
s_nop 0
v_exp_f32 v192, v192
v_mfma_f32_16x16x32_bf16 v[204:207], v[4:7], v[100:103], v[204:207]
v_exp_f32 v193, v193
v_exp_f32 v194, v194
v_exp_f32 v195, v195
v_cvt_pk_bf16_f32 v114, v192, v193
v_cvt_pk_bf16_f32 v115, v194, v195
v_exp_f32 v198, v198
v_exp_f32 v199, v199
v_cvt_pk_bf16_f32 v104, v196, v197
v_cvt_pk_bf16_f32 v105, v198, v199
v_exp_f32 v200, v200
v_exp_f32 v201, v201
v_exp_f32 v202, v202
v_exp_f32 v203, v203
v_cvt_pk_bf16_f32 v130, v200, v201
v_cvt_pk_bf16_f32 v131, v202, v203
v_exp_f32 v204, v204
v_exp_f32 v205, v205
v_exp_f32 v206, v206
v_exp_f32 v207, v207
v_cvt_pk_bf16_f32 v120, v204, v205
v_cvt_pk_bf16_f32 v121, v206, v207
v_lshlrev_b32 v93, 5, v84
v_xor_b32 v245, v93, v245
v_xor_b32 v245, v94, v245
s_mov_b32 vcc_lo, 0x33333333
s_mov_b32 vcc_hi, 0x33333333
v_mov_b32 v184, 0
v_mov_b32 v169, 0x3f803f80
v_cndmask_b32 v184, v184, v169, vcc
s_waitcnt vmcnt(8)
s_barrier
ds_read_b128 v[48:51], v242 offset:50688
ds_read_b128 v[52:55], v242 offset:50944
ds_read_b128 v[56:59], v242 offset:51200
ds_read_b128 v[60:63], v242 offset:51456
ds_read_b128 v[64:67], v242 offset:54912
ds_read_b128 v[68:71], v242 offset:55168
ds_read_b128 v[72:75], v242 offset:55424
ds_read_b128 v[76:79], v242 offset:55680
s_mov_b32 vcc_lo, 0xaaaaaaaa
s_mov_b32 vcc_hi, 0xaaaaaaaa
v_mov_b32 v251, 0x44444444
v_mov_b32 v169, 0xeeeeeeee
v_cndmask_b32 v251, v251, v169, vcc
s_mov_b32 vcc_lo, 0x0
s_mov_b32 vcc_hi, 0xaaaaaaaa
v_mov_b32 v169, 0xe4eeeeee
v_cndmask_b32 v251, v251, v169, vcc
s_mov_b32 vcc_lo, 0xffff
s_mov_b32 vcc_hi, 0xffff
v_mov_b32 v252, 0x0c0c0c0c
v_mov_b32 v169, 0x07060302
s_waitcnt lgkmcnt(7)
v_mfma_f32_16x16x32_bf16 v[192:195], a[64:67], v[48:51], 0
s_waitcnt lgkmcnt(5)
buffer_load_dwordx4 v243, s[16:19], s99 offen offset:0 nt lds
v_mfma_f32_16x16x32_bf16 v[192:195], a[68:71], v[52:55], v[192:195]
s_waitcnt lgkmcnt(4)
buffer_load_dwordx4 v243, s[16:19], s100 offen offset:2112 nt lds
v_mfma_f32_16x16x32_bf16 v[192:195], a[72:75], v[56:59], v[192:195]
s_add_u32 m0, s49, 8448
s_add_u32 s99, s55, 8192
s_add_u32 s100, s55, 8128
v_mfma_f32_16x16x32_bf16 v[192:195], a[76:79], v[60:63], v[192:195]
v_cndmask_b32 v252, v252, v169, vcc
v_mov_b32 v253, 0x0c0c0c0c
v_mfma_f32_16x16x32_bf16 v[196:199], a[92:95], v[60:63], 0
s_mov_b32 vcc_lo, 0xffff0000
s_mov_b32 vcc_hi, 0xffff0000
v_mov_b32 v169, 0x07060302
v_mfma_f32_16x16x32_bf16 v[196:199], a[88:91], v[56:59], v[196:199]
s_nop 0
v_cvt_pk_bf16_f32 v136, v192, v193
v_cvt_pk_bf16_f32 v138, v194, v195
v_mfma_f32_16x16x32_bf16 v[196:199], a[84:87], v[52:55], v[196:199]
v_cndmask_b32 v253, v253, v169, vcc
v_lshl_add_u32 v244, v88, 4, v244
v_mfma_f32_16x16x32_bf16 v[196:199], a[80:83], v[48:51], v[196:199]
buffer_load_dwordx4 v243, s[16:19], s99 offen offset:0 nt lds
v_mfma_f32_16x16x32_bf16 v[200:203], a[96:99], v[48:51], 0
s_add_u32 s99, s55, 12288
buffer_load_dwordx4 v243, s[16:19], s100 offen offset:2112 nt lds
v_mfma_f32_16x16x32_bf16 v[200:203], a[100:103], v[52:55], v[200:203]
s_add_u32 m0, s49, 12672
s_add_u32 s100, s55, 12224
v_mad_u32_u24 v181, v82, s7, v181
v_mfma_f32_16x16x32_bf16 v[200:203], a[104:107], v[56:59], v[200:203]
s_waitcnt lgkmcnt(0)
v_cvt_pk_bf16_f32 v137, v196, v197
v_cvt_pk_bf16_f32 v139, v198, v199
v_mfma_f32_16x16x32_bf16 v[200:203], a[108:111], v[60:63], v[200:203]
ds_write_b64 v164, v[136:137] offset:0
v_mfma_f32_16x16x32_bf16 v[192:195], a[124:127], v[60:63], 0
ds_write_b64 v164, v[138:139] offset:64
v_mfma_f32_16x16x32_bf16 v[192:195], a[116:119], v[52:55], v[192:195]
v_mad_u32_u24 v250, v82, s8, v250
v_lshl_add_u32 v244, v82, 5, v244
v_mfma_f32_16x16x32_bf16 v[192:195], a[112:115], v[48:51], v[192:195]
buffer_load_dwordx4 v243, s[16:19], s99 offen offset:0 nt lds
v_mfma_f32_16x16x32_bf16 v[192:195], a[120:123], v[56:59], v[192:195]
s_add_u32 s99, s55, 16384
buffer_load_dwordx4 v243, s[16:19], s100 offen offset:2112 nt lds
v_mfma_f32_16x16x32_bf16 v[196:199], a[56:59], v[56:59], 0
s_add_u32 m0, s49, 16896
s_add_u32 s100, s55, 16320
v_cvt_pk_bf16_f32 v140, v200, v201
v_mfma_f32_16x16x32_bf16 v[196:199], a[60:63], v[60:63], v[196:199]
s_nop 0
v_cvt_pk_bf16_f32 v141, v192, v193
v_cvt_pk_bf16_f32 v143, v194, v195
v_mfma_f32_16x16x32_bf16 v[196:199], a[52:55], v[52:55], v[196:199]
ds_write_b64 v165, v[140:141] offset:0
v_mfma_f32_16x16x32_bf16 v[196:199], a[48:51], v[48:51], v[196:199]
v_cvt_pk_bf16_f32 v142, v202, v203
v_lshl_add_u32 v166, v90, 2, s9
v_mfma_f32_16x16x32_bf16 v[192:195], a[32:35], v[48:51], 0
ds_write_b64 v165, v[142:143] offset:64
v_mfma_f32_16x16x32_bf16 v[192:195], a[36:39], v[52:55], v[192:195]
buffer_load_dwordx4 v243, s[16:19], s99 offen offset:0 nt lds
v_mfma_f32_16x16x32_bf16 v[192:195], a[40:43], v[56:59], v[192:195]
s_add_u32 s99, s57, 0
buffer_load_dwordx4 v243, s[16:19], s100 offen offset:2112 nt lds
v_mfma_f32_16x16x32_bf16 v[192:195], a[44:47], v[60:63], v[192:195]
s_add_u32 m0, s98, 59648
s_add_u32 s100, s57, 1024
v_cvt_pk_bf16_f32 v149, v196, v197
v_mfma_f32_16x16x32_bf16 v[200:203], a[28:31], v[60:63], 0
ds_read_b128 v[238:241], v245 offset:0
v_cvt_pk_bf16_f32 v151, v198, v199
v_mfma_f32_16x16x32_bf16 v[200:203], a[24:27], v[56:59], v[200:203]
s_nop 0
v_cvt_pk_bf16_f32 v148, v192, v193
v_cvt_pk_bf16_f32 v150, v194, v195
v_mfma_f32_16x16x32_bf16 v[200:203], a[20:23], v[52:55], v[200:203]
s_lshl_b32 s50, s43, 12
s_add_u32 s50, s50, s44
s_add_u32 s50, s50, 13107200
v_mfma_f32_16x16x32_bf16 v[200:203], a[16:19], v[48:51], v[200:203]
s_mul_i32 s48, s43, 3168
s_add_u32 s49, s49, s48
s_add_u32 s49, s49, 50688
s_mov_b32 s48, 8192
v_mfma_f32_16x16x32_bf16 v[192:195], a[0:3], v[48:51], 0
v_mad_u32_u24 v166, v81, s7, v166
v_lshl_add_u32 v246, v92, 2, v246
v_mfma_f32_16x16x32_bf16 v[192:195], a[8:11], v[56:59], v[192:195]
ds_write_b32 v166, v236 offset:0
v_mfma_f32_16x16x32_bf16 v[192:195], a[12:15], v[60:63], v[192:195]
v_cvt_pk_bf16_f32 v145, v200, v201
v_cvt_pk_bf16_f32 v147, v202, v203
v_mfma_f32_16x16x32_bf16 v[192:195], a[4:7], v[52:55], v[192:195]
v_mov_b32 v185, v184
v_mov_b32 v186, v184
v_mfma_f32_16x16x32_bf16 v[196:199], a[4:7], v[68:71], 0
v_mov_b32 v187, v184
v_mov_b32 v118, 0
v_mfma_f32_16x16x32_bf16 v[196:199], a[0:3], v[64:67], v[196:199]
v_mov_b32 v119, 0
v_mov_b32 v255, 0
v_mfma_f32_16x16x32_bf16 v[196:199], a[8:11], v[72:75], v[196:199]
v_cvt_pk_bf16_f32 v144, v192, v193
v_cvt_pk_bf16_f32 v146, v194, v195
v_mfma_f32_16x16x32_bf16 v[196:199], a[12:15], v[76:79], v[196:199]
ds_write_b64 v164, v[144:145] offset:512
v_mfma_f32_16x16x32_bf16 v[192:195], v[136:139], v[144:147], 0
ds_write_b64 v164, v[146:147] offset:576
v_mfma_f32_16x16x32_bf16 v[192:195], v[140:143], v[148:151], v[192:195]
s_waitcnt vmcnt(8)
s_barrier
v_mfma_f32_16x16x32_bf16 v[200:203], a[28:31], v[76:79], 0
s_waitcnt lgkmcnt(3)
ds_read_b64_tr_b16 a[176:177], v183 offset:8
v_cvt_pk_bf16_f32 v32, v196, v197
v_mfma_f32_16x16x32_bf16 v[200:203], a[24:27], v[72:75], v[200:203]
ds_read_b64_tr_b16 a[178:179], v183 offset:520
v_cvt_pk_bf16_f32 v34, v198, v199
v_mfma_f32_16x16x32_bf16 v[200:203], a[20:23], v[68:71], v[200:203]
ds_read_b64_tr_b16 a[180:181], v183 offset:4104
v_mov_b32 v134, 0
v_mfma_f32_16x16x32_bf16 v[200:203], a[16:19], v[64:67], v[200:203]
ds_read_b64_tr_b16 a[182:183], v183 offset:4616
v_mov_b32 v135, 0
v_mfma_f32_16x16x32_bf16 v[196:199], a[32:35], v[64:67], 0
ds_read_b64_tr_b16 a[184:185], v183 offset:8200
s_nop 0
v_mfma_f32_16x16x32_bf16 v[196:199], a[36:39], v[68:71], v[196:199]
ds_read_b64_tr_b16 a[186:187], v183 offset:8712
v_mfma_f32_16x16x32_bf16 v[196:199], a[40:43], v[72:75], v[196:199]
ds_read_b64_tr_b16 a[188:189], v183 offset:12296
v_cvt_pk_bf16_f32 v33, v200, v201
v_mfma_f32_16x16x32_bf16 v[196:199], a[44:47], v[76:79], v[196:199]
ds_read_b64_tr_b16 a[190:191], v183 offset:12808
v_cvt_pk_bf16_f32 v35, v202, v203
v_mfma_f32_16x16x32_bf16 v[200:203], a[60:63], v[76:79], 0
ds_read_b64_tr_b16 a[160:161], v183 offset:0
s_nop 0
v_mfma_f32_16x16x32_bf16 v[200:203], a[52:55], v[68:71], v[200:203]
ds_read_b64_tr_b16 a[162:163], v183 offset:512
v_mfma_f32_16x16x32_bf16 v[200:203], a[48:51], v[64:67], v[200:203]
ds_read_b64_tr_b16 a[164:165], v183 offset:4096
v_cvt_pk_bf16_f32 v36, v196, v197
v_mfma_f32_16x16x32_bf16 v[200:203], a[56:59], v[72:75], v[200:203]
ds_read_b64_tr_b16 a[166:167], v183 offset:4608
v_cvt_pk_bf16_f32 v38, v198, v199
v_mfma_f32_16x16x32_bf16 v[196:199], a[120:123], v[72:75], 0
ds_read_b64_tr_b16 a[168:169], v183 offset:8192
s_nop 0
v_mfma_f32_16x16x32_bf16 v[196:199], a[124:127], v[76:79], v[196:199]
s_waitcnt lgkmcnt(12)
ds_read_b64_tr_b16 a[170:171], v183 offset:8704
v_cvt_pk_bf16_f32 v37, v200, v201
v_mfma_f32_16x16x32_bf16 v[196:199], a[116:119], v[68:71], v[196:199]
s_waitcnt lgkmcnt(12)
ds_read_b64_tr_b16 a[172:173], v183 offset:12288
v_cvt_pk_bf16_f32 v39, v202, v203
v_mfma_f32_16x16x32_bf16 v[196:199], a[112:115], v[64:67], v[196:199]
s_waitcnt lgkmcnt(12)
ds_read_b64_tr_b16 a[174:175], v183 offset:12800
s_nop 0
v_mfma_f32_16x16x32_bf16 v[200:203], a[96:99], v[64:67], 0
s_waitcnt lgkmcnt(12)
ds_read_b64_tr_b16 a[144:145], v182 offset:8
s_nop 0
v_mfma_f32_16x16x32_bf16 v[200:203], a[100:103], v[68:71], v[200:203]
s_waitcnt lgkmcnt(12)
ds_read_b64_tr_b16 a[146:147], v182 offset:520
v_cvt_pk_bf16_f32 v29, v196, v197
v_mfma_f32_16x16x32_bf16 v[200:203], a[104:107], v[72:75], v[200:203]
s_waitcnt lgkmcnt(12)
ds_read_b64_tr_b16 a[148:149], v182 offset:4104
v_cvt_pk_bf16_f32 v31, v198, v199
v_mfma_f32_16x16x32_bf16 v[200:203], a[108:111], v[76:79], v[200:203]
s_waitcnt lgkmcnt(12)
ds_read_b64_tr_b16 a[150:151], v182 offset:4616
s_nop 0
v_mfma_f32_16x16x32_bf16 v[196:199], a[92:95], v[76:79], 0
s_waitcnt lgkmcnt(12)
ds_read_b64_tr_b16 a[152:153], v182 offset:8200
s_nop 0
v_mfma_f32_16x16x32_bf16 v[196:199], a[88:91], v[72:75], v[196:199]
s_waitcnt lgkmcnt(12)
ds_read_b64_tr_b16 a[154:155], v182 offset:8712
v_cvt_pk_bf16_f32 v28, v200, v201
v_mfma_f32_16x16x32_bf16 v[196:199], a[84:87], v[68:71], v[196:199]
s_waitcnt lgkmcnt(12)
ds_read_b64_tr_b16 a[156:157], v182 offset:12296
v_cvt_pk_bf16_f32 v30, v202, v203
v_mfma_f32_16x16x32_bf16 v[196:199], a[80:83], v[64:67], v[196:199]
s_waitcnt lgkmcnt(12)
ds_read_b64_tr_b16 a[158:159], v182 offset:12808
s_nop 0
v_mfma_f32_16x16x32_bf16 v[200:203], a[64:67], v[64:67], 0
s_waitcnt lgkmcnt(12)
ds_read_b64_tr_b16 a[128:129], v182 offset:0
s_nop 0
v_mfma_f32_16x16x32_bf16 v[200:203], a[68:71], v[68:71], v[200:203]
s_waitcnt lgkmcnt(12)
ds_read_b64_tr_b16 a[130:131], v182 offset:512
v_cvt_pk_bf16_f32 v25, v196, v197
v_mfma_f32_16x16x32_bf16 v[200:203], a[72:75], v[72:75], v[200:203]
s_waitcnt lgkmcnt(12)
ds_read_b64_tr_b16 a[132:133], v182 offset:4096
v_cvt_pk_bf16_f32 v27, v198, v199
v_mfma_f32_16x16x32_bf16 v[200:203], a[76:79], v[76:79], v[200:203]
s_waitcnt lgkmcnt(12)
ds_read_b64_tr_b16 a[134:135], v182 offset:4608
s_nop 0
v_mfma_f32_16x16x32_bf16 v[196:199], v[76:79], a[188:191], 0
s_waitcnt lgkmcnt(12)
ds_read_b64_tr_b16 a[136:137], v182 offset:8192
s_nop 0
v_mfma_f32_16x16x32_bf16 v[196:199], v[72:75], a[184:187], v[196:199]
s_waitcnt lgkmcnt(12)
ds_read_b64_tr_b16 a[138:139], v182 offset:8704
v_cvt_pk_bf16_f32 v24, v200, v201
v_mfma_f32_16x16x32_bf16 v[196:199], v[68:71], a[180:183], v[196:199]
s_waitcnt lgkmcnt(12)
ds_read_b64_tr_b16 a[140:141], v182 offset:12288
v_cvt_pk_bf16_f32 v26, v202, v203
v_mfma_f32_16x16x32_bf16 v[196:199], v[64:67], a[176:179], v[196:199]
s_waitcnt lgkmcnt(12)
ds_read_b64_tr_b16 a[142:143], v182 offset:12800
s_nop 0
v_mfma_f32_16x16x32_bf16 v[200:203], v[64:67], a[160:163], 0
s_waitcnt lgkmcnt(12)
ds_write_b64 v165, v[148:149] offset:512
v_mfma_f32_16x16x32_bf16 v[200:203], v[68:71], a[164:167], v[200:203]
s_waitcnt lgkmcnt(12)
ds_write_b64 v165, v[150:151] offset:576
v_mfma_f32_16x16x32_bf16 v[200:203], v[72:75], a[168:171], v[200:203]
s_waitcnt lgkmcnt(12)
ds_write_b64 v164, v[32:33] offset:7424
v_mfma_f32_16x16x32_bf16 v[200:203], v[76:79], a[172:175], v[200:203]
s_waitcnt lgkmcnt(11)
ds_write_b64 v164, v[34:35] offset:7488
v_mfma_f32_16x16x32_bf16 v[204:207], v[24:27], v[32:35], 0
s_waitcnt lgkmcnt(11)
ds_write_b64 v165, v[36:37] offset:7424
v_mfma_f32_16x16x32_bf16 v[204:207], v[28:31], v[36:39], v[204:207]
s_waitcnt lgkmcnt(11)
ds_write_b64 v165, v[38:39] offset:7488
v_mfma_f32_16x16x32_bf16 v[208:211], v[76:79], a[156:159], 0
s_waitcnt lgkmcnt(11)
ds_write_b64 v164, v[24:25] offset:6912
v_mfma_f32_16x16x32_bf16 v[208:211], v[72:75], a[152:155], v[208:211]
s_waitcnt lgkmcnt(10)
ds_write_b64 v164, v[26:27] offset:6976
v_mfma_f32_16x16x32_bf16 v[208:211], v[68:71], a[148:151], v[208:211]
s_waitcnt lgkmcnt(10)
ds_write_b64 v165, v[28:29] offset:6912
v_mfma_f32_16x16x32_bf16 v[208:211], v[64:67], a[144:147], v[208:211]
s_waitcnt lgkmcnt(10)
ds_write_b64 v165, v[30:31] offset:6976
v_mfma_f32_16x16x32_bf16 v[216:219], v[64:67], a[128:131], 0
s_waitcnt lgkmcnt(10)
v_cvt_pk_bf16_f32 v14, v196, v197
v_cvt_pk_bf16_f32 v15, v198, v199
v_mfma_f32_16x16x32_bf16 v[216:219], v[72:75], a[136:139], v[216:219]
ds_write_b64 v181, v[14:15] offset:7296
v_mfma_f32_16x16x32_bf16 v[216:219], v[76:79], a[140:143], v[216:219]
v_cvt_pk_bf16_f32 v12, v200, v201
v_cvt_pk_bf16_f32 v13, v202, v203
v_mfma_f32_16x16x32_bf16 v[216:219], v[68:71], a[132:135], v[216:219]
ds_write_b64 v181, v[12:13] offset:7168
v_mfma_f32_16x16x32_bf16 v[196:199], v[52:55], a[132:135], 0
v_cvt_pk_bf16_f32 v10, v208, v209
v_cvt_pk_bf16_f32 v11, v210, v211
v_mfma_f32_16x16x32_bf16 v[196:199], v[48:51], a[128:131], v[196:199]
ds_write_b64 v181, v[10:11] offset:7040
v_mfma_f32_16x16x32_bf16 v[196:199], v[56:59], a[136:139], v[196:199]
s_nop 0
v_cvt_pk_bf16_f32 v8, v216, v217
v_cvt_pk_bf16_f32 v9, v218, v219
v_mfma_f32_16x16x32_bf16 v[196:199], v[60:63], a[140:143], v[196:199]
ds_write_b64 v181, v[8:9] offset:6912
v_mfma_f32_16x16x32_bf16 v[200:203], v[60:63], a[156:159], 0
v_exp_f32 v192, v192
v_mfma_f32_16x16x32_bf16 v[200:203], v[56:59], a[152:155], v[200:203]
v_exp_f32 v193, v193
v_mfma_f32_16x16x32_bf16 v[200:203], v[52:55], a[148:151], v[200:203]
v_add_f32 v160, v192, v193
v_cvt_pk_bf16_f32 v192, v192, v193
v_mfma_f32_16x16x32_bf16 v[200:203], v[48:51], a[144:147], v[200:203]
ds_write_b32 v167, v192 offset:0
v_mfma_f32_16x16x32_bf16 v[208:211], v[48:51], a[160:163], 0
v_exp_f32 v194, v194
v_mfma_f32_16x16x32_bf16 v[208:211], v[52:55], a[164:167], v[208:211]
v_exp_f32 v195, v195
v_mfma_f32_16x16x32_bf16 v[208:211], v[56:59], a[168:171], v[208:211]
ds_read_b128 v[228:231], v242 offset:256
v_cvt_pk_bf16_f32 v193, v194, v195
v_mfma_f32_16x16x32_bf16 v[208:211], v[60:63], a[172:175], v[208:211]
ds_write_b32 v167, v193 offset:4
v_mfma_f32_16x16x32_bf16 v[220:223], v[60:63], a[188:191], 0
v_mov_b64 v[216:217], s[96:97]
v_mov_b64 v[218:219], s[96:97]
v_mfma_f32_16x16x32_bf16 v[220:223], v[56:59], a[184:187], v[220:223]
v_cvt_pk_bf16_f32 v18, v200, v201
v_cvt_pk_bf16_f32 v19, v202, v203
v_mfma_f32_16x16x32_bf16 v[220:223], v[52:55], a[180:183], v[220:223]
v_mov_b64 v[200:201], s[96:97]
v_mov_b64 v[202:203], s[96:97]
v_mfma_f32_16x16x32_bf16 v[220:223], v[48:51], a[176:179], v[220:223]
v_add_f32 v161, v194, v195
v_add_f32 v194, v160, v161
v_smfmac_f32_16x16x64_bf16 v[216:219], v[238:241], v[152:159], v251
ds_write_b32 v167, v194 offset:8
v_smfmac_f32_16x16x64_bf16 v[200:203], v[238:241], v[96:103], v251
s_nop 0
ds_read_b128 v[192:195], v242 offset:768
v_exp_f32 v204, v204
s_nop 2
v_add_f32 v216, v216, v217
v_add_f32 v218, v218, v219
v_exp_f32 v216, v216
v_exp_f32 v218, v218
s_nop 0
v_perm_b32 v116, v218, v216, v252
v_perm_b32 v117, v218, v216, v253
v_mfma_f32_16x16x32_bf16 v[216:219], v[232:235], a[188:191], 0
v_cvt_pk_bf16_f32 v22, v220, v221
v_cvt_pk_bf16_f32 v23, v222, v223
v_mfma_f32_16x16x32_bf16 v[216:219], v[224:227], a[184:187], v[216:219]
v_exp_f32 v205, v205
v_mfma_f32_16x16x32_bf16 v[216:219], v[212:215], a[180:183], v[216:219]
s_waitcnt lgkmcnt(3)
v_add_f32 v160, v204, v205
v_cvt_pk_bf16_f32 v204, v204, v205
v_mfma_f32_16x16x32_bf16 v[216:219], v[188:191], a[176:179], v[216:219]
ds_write_b32 v167, v204 offset:256
v_mfma_f32_16x16x32_bf16 v[220:223], v[188:191], a[160:163], 0
v_exp_f32 v206, v206
v_mfma_f32_16x16x32_bf16 v[220:223], v[212:215], a[164:167], v[220:223]
v_exp_f32 v207, v207
v_mfma_f32_16x16x32_bf16 v[220:223], v[224:227], a[168:171], v[220:223]
v_cvt_pk_bf16_f32 v205, v206, v207
v_add_f32 v161, v206, v207
v_mfma_f32_16x16x32_bf16 v[220:223], v[232:235], a[172:175], v[220:223]
ds_write_b32 v167, v205 offset:260
v_add_f32 v206, v160, v161
ds_write_b32 v167, v206 offset:264
v_add_f32 v200, v200, v201
v_add_f32 v202, v202, v203
v_mfma_f32_16x16x32_bf16 v[204:207], v[232:235], a[156:159], 0
s_waitcnt lgkmcnt(3)
v_exp_f32 v200, v200
v_mfma_f32_16x16x32_bf16 v[204:207], v[224:227], a[152:155], v[204:207]
v_exp_f32 v202, v202
v_mfma_f32_16x16x32_bf16 v[204:207], v[212:215], a[148:151], v[204:207]
v_perm_b32 v132, v202, v200, v252
v_perm_b32 v133, v202, v200, v253
v_mfma_f32_16x16x32_bf16 v[204:207], v[188:191], a[144:147], v[204:207]
v_cvt_pk_bf16_f32 v16, v196, v197
v_cvt_pk_bf16_f32 v17, v198, v199
v_mfma_f32_16x16x32_bf16 v[200:203], v[188:191], a[128:131], 0
ds_read_b128 v[196:199], v242 offset:0
v_cvt_pk_bf16_f32 v20, v208, v209
v_mfma_f32_16x16x32_bf16 v[200:203], v[224:227], a[136:139], v[200:203]
ds_write_b64 v181, v[16:17] offset:0
v_mfma_f32_16x16x32_bf16 v[200:203], v[232:235], a[140:143], v[200:203]
ds_write_b64 v181, v[18:19] offset:128
v_mfma_f32_16x16x32_bf16 v[200:203], v[212:215], a[132:135], v[200:203]
v_cvt_pk_bf16_f32 v86, v204, v205
v_cvt_pk_bf16_f32 v87, v206, v207
v_mfma_f32_16x16x32_bf16 v[204:207], v[228:231], a[132:135], 0
v_cvt_pk_bf16_f32 v21, v210, v211
v_cvt_pk_bf16_f32 v94, v216, v217
v_cvt_pk_bf16_f32 v95, v218, v219
s_waitcnt lgkmcnt(2)
v_mfma_f32_16x16x32_bf16 v[204:207], v[196:199], a[128:131], v[204:207]
ds_read_b128 v[208:211], v242 offset:512
v_cvt_pk_bf16_f32 v82, v200, v201
v_cvt_pk_bf16_f32 v83, v202, v203
v_cvt_pk_bf16_f32 v90, v220, v221
v_cvt_pk_bf16_f32 v91, v222, v223
ds_write_b64 v181, v[20:21] offset:256
ds_write_b64 v181, v[22:23] offset:384
ds_read2_b32 v[236:237], v246 offset0:0 offset1:8
s_waitcnt lgkmcnt(3)
v_mfma_f32_16x16x32_bf16 v[204:207], v[208:211], a[136:139], v[204:207]
s_waitcnt vmcnt(4)
s_barrier
v_mfma_f32_16x16x32_bf16 v[204:207], v[192:195], a[140:143], v[204:207]
ds_read_b128 v[188:191], v242 offset:4224
ds_read_b128 v[212:215], v242 offset:4480
v_mfma_f32_16x16x32_bf16 v[200:203], v[192:195], a[156:159], 0
ds_read_b128 v[224:227], v242 offset:4736
ds_read_b128 v[232:235], v242 offset:4992
v_mfma_f32_16x16x32_bf16 v[200:203], v[208:211], a[152:155], v[200:203]
s_nop 1
v_cvt_pk_bf16_f32 v48, v204, v205
v_mfma_f32_16x16x32_bf16 v[200:203], v[228:231], a[148:151], v[200:203]
v_cvt_pk_bf16_f32 v49, v206, v207
v_mfma_f32_16x16x32_bf16 v[200:203], v[196:199], a[144:147], v[200:203]
s_nop 2
v_mfma_f32_16x16x32_bf16 v[204:207], v[196:199], a[160:163], 0
buffer_load_dwordx4 v174, s[36:39], s99 offen offset:0 lds
v_mfma_f32_16x16x32_bf16 v[204:207], v[228:231], a[164:167], v[204:207]
s_add_u32 s99, s57, 2048
buffer_load_dwordx4 v174, s[36:39], s100 offen offset:1024 lds
v_mfma_f32_16x16x32_bf16 v[204:207], v[208:211], a[168:171], v[204:207]
s_add_u32 s100, s57, 3072
v_cvt_pk_bf16_f32 v52, v200, v201
v_cvt_pk_bf16_f32 v53, v202, v203
v_mfma_f32_16x16x32_bf16 v[204:207], v[192:195], a[172:175], v[204:207]
L_h1:
s_cbranch_execz L_h5
s_waitcnt lgkmcnt(4)
s_nop 1
v_mfma_f32_16x16x32_bf16 v[200:203], v[192:195], a[188:191], 0
s_nop 2
v_mfma_f32_16x16x32_bf16 v[200:203], v[208:211], a[184:187], v[200:203]
v_cvt_pk_bf16_f32 v56, v204, v205
v_cvt_pk_bf16_f32 v57, v206, v207
v_mfma_f32_16x16x32_bf16 v[200:203], v[228:231], a[180:183], v[200:203]
s_waitcnt lgkmcnt(3)
v_mfma_f32_16x16x32_bf16 v[200:203], v[196:199], a[176:179], v[200:203]
s_waitcnt lgkmcnt(2)
s_nop 1
v_mfma_f32_16x16x32_bf16 v[192:195], a[64:67], v[188:191], 0
s_waitcnt lgkmcnt(1)
s_nop 1
v_mfma_f32_16x16x32_bf16 v[192:195], a[68:71], v[212:215], v[192:195]
s_waitcnt lgkmcnt(0)
v_cvt_pk_bf16_f32 v60, v200, v201
v_cvt_pk_bf16_f32 v61, v202, v203
v_mfma_f32_16x16x32_bf16 v[192:195], a[72:75], v[224:227], v[192:195]
buffer_load_dwordx4 v174, s[36:39], s99 offen offset:2048 lds
v_mfma_f32_16x16x32_bf16 v[192:195], a[76:79], v[232:235], v[192:195]
s_add_u32 s99, s57, 8192
buffer_load_dwordx4 v174, s[36:39], s100 offen offset:3072 lds
v_mfma_f32_16x16x32_bf16 v[196:199], a[92:95], v[232:235], 0
s_add_u32 m0, s98, 63744
s_add_u32 s100, s57, 9216
s_mov_b32 s98, s50
v_mfma_f32_16x16x32_bf16 v[196:199], a[88:91], v[224:227], v[196:199]
s_nop 0
v_cvt_pk_bf16_f32 v8, v192, v193
v_cvt_pk_bf16_f32 v9, v194, v195
v_mfma_f32_16x16x32_bf16 v[196:199], a[84:87], v[212:215], v[196:199]
v_mfma_f32_16x16x32_bf16 v[196:199], a[80:83], v[188:191], v[196:199]
s_nop 2
v_mfma_f32_16x16x32_bf16 v[192:195], a[96:99], v[188:191], 0
s_nop 2
v_mfma_f32_16x16x32_bf16 v[192:195], a[100:103], v[212:215], v[192:195]
v_cvt_pk_bf16_f32 v10, v196, v197
v_cvt_pk_bf16_f32 v11, v198, v199
v_mfma_f32_16x16x32_bf16 v[192:195], a[104:107], v[224:227], v[192:195]
v_mfma_f32_16x16x32_bf16 v[192:195], a[108:111], v[232:235], v[192:195]
s_nop 2
v_mfma_f32_16x16x32_bf16 v[196:199], a[124:127], v[232:235], 0
buffer_load_dwordx4 v174, s[36:39], s99 offen offset:0 lds
v_mfma_f32_16x16x32_bf16 v[196:199], a[120:123], v[224:227], v[196:199]
s_add_u32 s99, s57, 10240
buffer_load_dwordx4 v174, s[36:39], s100 offen offset:1024 lds
v_mfma_f32_16x16x32_bf16 v[196:199], a[116:119], v[212:215], v[196:199]
s_add_u32 s100, s57, 11264
v_cvt_pk_bf16_f32 v12, v192, v193
v_cvt_pk_bf16_f32 v13, v194, v195
v_mfma_f32_16x16x32_bf16 v[196:199], a[112:115], v[188:191], v[196:199]
s_nop 2
v_mfma_f32_16x16x32_bf16 v[192:195], v[188:191], a[128:131], 0
s_nop 2
v_mfma_f32_16x16x32_bf16 v[192:195], v[212:215], a[132:135], v[192:195]
v_cvt_pk_bf16_f32 v14, v196, v197
v_cvt_pk_bf16_f32 v15, v198, v199
v_mfma_f32_16x16x32_bf16 v[192:195], v[224:227], a[136:139], v[192:195]
v_mfma_f32_16x16x32_bf16 v[192:195], v[232:235], a[140:143], v[192:195]
s_nop 2
v_mfma_f32_16x16x32_bf16 v[196:199], v[12:15], v[156:159], 0
s_nop 2
v_mfma_f32_16x16x32_bf16 v[196:199], v[8:11], v[152:155], v[196:199]
v_cvt_pk_bf16_f32 v50, v192, v193
v_cvt_pk_bf16_f32 v51, v194, v195
v_mfma_f32_16x16x32_bf16 v[192:195], v[8:11], v[96:99], 0
buffer_load_dwordx4 v174, s[36:39], s99 offen offset:2048 lds
v_mfma_f32_16x16x32_bf16 v[192:195], v[12:15], v[100:103], v[192:195]
s_add_u32 s99, s98, s51
buffer_load_dwordx4 v174, s[36:39], s100 offen offset:3072 lds
v_mfma_f32_16x16x32_bf16 v[200:203], v[232:235], a[156:159], 0
s_add_u32 s100, s99, s51
ds_read_b128 v[204:207], v242 offset:8448
ds_read_b128 v[208:211], v242 offset:8704
v_mfma_f32_16x16x32_bf16 v[200:203], v[224:227], a[152:155], v[200:203]
s_add_u32 m0, s49, 0
ds_read_b128 v[216:219], v242 offset:8960
ds_read_b128 v[220:223], v242 offset:9216
v_mfma_f32_16x16x32_bf16 v[200:203], v[212:215], a[148:151], v[200:203]
s_add_u32 s101, s100, s51
v_exp_f32 v196, v196
v_mfma_f32_16x16x32_bf16 v[200:203], v[188:191], a[144:147], v[200:203]
v_exp_f32 v197, v197
v_mfma_f32_16x16x32_bf16 v[228:231], v[188:191], a[160:163], 0
v_exp_f32 v198, v198
v_mfma_f32_16x16x32_bf16 v[228:231], v[212:215], a[164:167], v[228:231]
v_exp_f32 v199, v199
v_mfma_f32_16x16x32_bf16 v[228:231], v[224:227], a[168:171], v[228:231]
v_cvt_pk_bf16_f32 v106, v196, v197
v_cvt_pk_bf16_f32 v107, v198, v199
v_mfma_f32_16x16x32_bf16 v[228:231], v[232:235], a[172:175], v[228:231]
v_cvt_pk_bf16_f32 v54, v200, v201
v_cvt_pk_bf16_f32 v55, v202, v203
v_mfma_f32_16x16x32_bf16 v[196:199], v[232:235], a[188:191], 0
v_exp_f32 v192, v192
v_mfma_f32_16x16x32_bf16 v[196:199], v[224:227], a[184:187], v[196:199]
v_exp_f32 v193, v193
v_mfma_f32_16x16x32_bf16 v[196:199], v[212:215], a[180:183], v[196:199]
s_waitcnt lgkmcnt(3)
v_exp_f32 v194, v194
v_mfma_f32_16x16x32_bf16 v[196:199], v[188:191], a[176:179], v[196:199]
s_waitcnt lgkmcnt(2)
v_exp_f32 v195, v195
v_mfma_f32_16x16x32_bf16 v[200:203], a[64:67], v[204:207], 0
s_waitcnt lgkmcnt(1)
v_cvt_pk_bf16_f32 v122, v192, v193
v_cvt_pk_bf16_f32 v123, v194, v195
v_mfma_f32_16x16x32_bf16 v[200:203], a[68:71], v[208:211], v[200:203]
s_waitcnt lgkmcnt(0)
v_cvt_pk_bf16_f32 v62, v196, v197
v_cvt_pk_bf16_f32 v63, v198, v199
v_mfma_f32_16x16x32_bf16 v[200:203], a[72:75], v[216:219], v[200:203]
v_cvt_pk_bf16_f32 v58, v228, v229
v_cvt_pk_bf16_f32 v59, v230, v231
v_mfma_f32_16x16x32_bf16 v[200:203], a[76:79], v[220:223], v[200:203]
s_nop 2
v_mfma_f32_16x16x32_bf16 v[192:195], a[92:95], v[220:223], 0
s_nop 2
v_mfma_f32_16x16x32_bf16 v[192:195], a[88:91], v[216:219], v[192:195]
v_cvt_pk_bf16_f32 v16, v200, v201
v_cvt_pk_bf16_f32 v17, v202, v203
v_mfma_f32_16x16x32_bf16 v[192:195], a[84:87], v[208:211], v[192:195]
v_mfma_f32_16x16x32_bf16 v[192:195], a[80:83], v[204:207], v[192:195]
s_nop 2
v_mfma_f32_16x16x32_bf16 v[196:199], a[96:99], v[204:207], 0
s_nop 2
v_mfma_f32_16x16x32_bf16 v[196:199], a[100:103], v[208:211], v[196:199]
v_cvt_pk_bf16_f32 v18, v192, v193
v_cvt_pk_bf16_f32 v19, v194, v195
v_mfma_f32_16x16x32_bf16 v[196:199], a[104:107], v[216:219], v[196:199]
v_mfma_f32_16x16x32_bf16 v[196:199], a[108:111], v[220:223], v[196:199]
s_nop 2
v_mfma_f32_16x16x32_bf16 v[192:195], a[124:127], v[220:223], 0
s_nop 2
v_mfma_f32_16x16x32_bf16 v[192:195], a[120:123], v[216:219], v[192:195]
v_cvt_pk_bf16_f32 v20, v196, v197
v_cvt_pk_bf16_f32 v21, v198, v199
v_mfma_f32_16x16x32_bf16 v[192:195], a[116:119], v[208:211], v[192:195]
v_mfma_f32_16x16x32_bf16 v[192:195], a[112:115], v[204:207], v[192:195]
s_nop 2
v_mfma_f32_16x16x32_bf16 v[196:199], v[204:207], a[128:131], 0
s_nop 2
v_mfma_f32_16x16x32_bf16 v[196:199], v[208:211], a[132:135], v[196:199]
v_cvt_pk_bf16_f32 v22, v192, v193
v_cvt_pk_bf16_f32 v23, v194, v195
v_mfma_f32_16x16x32_bf16 v[196:199], v[216:219], a[136:139], v[196:199]
v_mfma_f32_16x16x32_bf16 v[196:199], v[220:223], a[140:143], v[196:199]
s_nop 2
v_mfma_f32_16x16x32_bf16 v[192:195], v[20:23], v[156:159], 0
s_nop 2
v_mfma_f32_16x16x32_bf16 v[192:195], v[16:19], v[152:155], v[192:195]
v_cvt_pk_bf16_f32 v64, v196, v197
v_cvt_pk_bf16_f32 v65, v198, v199
v_mfma_f32_16x16x32_bf16 v[196:199], v[16:19], v[96:99], 0
s_nop 2
v_mfma_f32_16x16x32_bf16 v[196:199], v[20:23], v[100:103], v[196:199]
s_nop 0
v_exp_f32 v192, v192
v_mfma_f32_16x16x32_bf16 v[200:203], v[220:223], a[156:159], 0
v_exp_f32 v193, v193
v_mfma_f32_16x16x32_bf16 v[200:203], v[216:219], a[152:155], v[200:203]
v_exp_f32 v194, v194
v_mfma_f32_16x16x32_bf16 v[200:203], v[208:211], a[148:151], v[200:203]
v_exp_f32 v195, v195
v_mfma_f32_16x16x32_bf16 v[200:203], v[204:207], a[144:147], v[200:203]
s_waitcnt vmcnt(0)
s_barrier
v_mfma_f32_16x16x32_bf16 v[228:231], v[204:207], a[160:163], 0
ds_read_b128 v[188:191], v242 offset:16896
v_cvt_pk_bf16_f32 v108, v192, v193
v_mfma_f32_16x16x32_bf16 v[228:231], v[208:211], a[164:167], v[228:231]
ds_read_b128 v[212:215], v242 offset:17152
v_cvt_pk_bf16_f32 v109, v194, v195
v_mfma_f32_16x16x32_bf16 v[228:231], v[216:219], a[168:171], v[228:231]
ds_read_b128 v[224:227], v242 offset:17408
v_cvt_pk_bf16_f32 v68, v200, v201
v_mfma_f32_16x16x32_bf16 v[228:231], v[220:223], a[172:175], v[228:231]
ds_read_b128 v[232:235], v242 offset:17664
v_cvt_pk_bf16_f32 v69, v202, v203
v_mfma_f32_16x16x32_bf16 v[192:195], v[220:223], a[188:191], 0
ds_read_b64_tr_b16 a[192:193], v182 offset:0
s_nop 0
v_mfma_f32_16x16x32_bf16 v[192:195], v[216:219], a[184:187], v[192:195]
ds_read_b64_tr_b16 a[194:195], v182 offset:512
v_mfma_f32_16x16x32_bf16 v[192:195], v[208:211], a[180:183], v[192:195]
s_waitcnt lgkmcnt(5)
ds_read_b64_tr_b16 a[196:197], v182 offset:4096
v_cvt_pk_bf16_f32 v72, v228, v229
v_mfma_f32_16x16x32_bf16 v[192:195], v[204:207], a[176:179], v[192:195]
buffer_load_dwordx4 v243, s[16:19], s98 offen offset:0 nt lds
v_mfma_f32_16x16x32_bf16 v[200:203], a[64:67], v[188:191], 0
s_waitcnt lgkmcnt(4)
ds_read_b64_tr_b16 a[198:199], v182 offset:4608
v_cvt_pk_bf16_f32 v73, v230, v231
v_mfma_f32_16x16x32_bf16 v[200:203], a[68:71], v[212:215], v[200:203]
s_waitcnt lgkmcnt(4)
ds_read_b64_tr_b16 a[200:201], v182 offset:8192
v_cvt_pk_bf16_f32 v76, v192, v193
v_mfma_f32_16x16x32_bf16 v[200:203], a[72:75], v[224:227], v[200:203]
ds_read_b64_tr_b16 a[202:203], v182 offset:8704
v_cvt_pk_bf16_f32 v77, v194, v195
v_mfma_f32_16x16x32_bf16 v[200:203], a[76:79], v[232:235], v[200:203]
ds_read_b64_tr_b16 a[204:205], v182 offset:12288
s_nop 0
v_mfma_f32_16x16x32_bf16 v[192:195], a[92:95], v[232:235], 0
ds_read_b64_tr_b16 a[206:207], v182 offset:12800
s_nop 0
v_mfma_f32_16x16x32_bf16 v[192:195], a[88:91], v[224:227], v[192:195]
ds_read_b64_tr_b16 a[208:209], v182 offset:8
v_mfma_f32_16x16x32_bf16 v[192:195], a[84:87], v[212:215], v[192:195]
ds_read_b64_tr_b16 a[210:211], v182 offset:520
v_cvt_pk_bf16_f32 v32, v200, v201
v_mfma_f32_16x16x32_bf16 v[192:195], a[80:83], v[188:191], v[192:195]
buffer_load_dwordx4 v243, s[16:19], s99 offen offset:1056 nt lds
v_mfma_f32_16x16x32_bf16 v[204:207], a[96:99], v[188:191], 0
ds_read_b64_tr_b16 a[212:213], v182 offset:4104
v_cvt_pk_bf16_f32 v33, v202, v203
v_mfma_f32_16x16x32_bf16 v[204:207], a[100:103], v[212:215], v[204:207]
s_waitcnt lgkmcnt(10)
ds_read_b64_tr_b16 a[214:215], v182 offset:4616
v_mfma_f32_16x16x32_bf16 v[204:207], a[104:107], v[224:227], v[204:207]
s_waitcnt lgkmcnt(10)
ds_read_b64_tr_b16 a[216:217], v182 offset:8200
v_cvt_pk_bf16_f32 v34, v192, v193
v_mfma_f32_16x16x32_bf16 v[204:207], a[108:111], v[232:235], v[204:207]
s_waitcnt lgkmcnt(10)
ds_read_b64_tr_b16 a[218:219], v182 offset:8712
v_cvt_pk_bf16_f32 v35, v194, v195
v_mfma_f32_16x16x32_bf16 v[192:195], a[124:127], v[232:235], 0
ds_read_b64_tr_b16 a[220:221], v182 offset:12296
s_nop 0
v_mfma_f32_16x16x32_bf16 v[192:195], a[120:123], v[224:227], v[192:195]
s_waitcnt lgkmcnt(11)
ds_read_b64_tr_b16 a[222:223], v182 offset:12808
v_cvt_pk_bf16_f32 v36, v204, v205
v_mfma_f32_16x16x32_bf16 v[192:195], a[116:119], v[212:215], v[192:195]
s_waitcnt lgkmcnt(11)
ds_read_b64_tr_b16 a[224:225], v183 offset:0
v_cvt_pk_bf16_f32 v37, v206, v207
v_mfma_f32_16x16x32_bf16 v[192:195], a[112:115], v[188:191], v[192:195]
buffer_load_dwordx4 v243, s[16:19], s100 offen offset:2112 nt lds
v_mfma_f32_16x16x32_bf16 v[200:203], v[188:191], a[128:131], 0
s_waitcnt lgkmcnt(10)
ds_read_b64_tr_b16 a[226:227], v183 offset:512
s_nop 0
v_mfma_f32_16x16x32_bf16 v[200:203], v[212:215], a[132:135], v[200:203]
s_waitcnt lgkmcnt(10)
ds_read_b64_tr_b16 a[228:229], v183 offset:4096
v_cvt_pk_bf16_f32 v38, v192, v193
v_mfma_f32_16x16x32_bf16 v[200:203], v[224:227], a[136:139], v[200:203]
s_waitcnt lgkmcnt(10)
ds_read_b64_tr_b16 a[230:231], v183 offset:4608
v_cvt_pk_bf16_f32 v39, v194, v195
v_mfma_f32_16x16x32_bf16 v[200:203], v[232:235], a[140:143], v[200:203]
s_waitcnt lgkmcnt(10)
ds_read_b64_tr_b16 a[232:233], v183 offset:8192
s_nop 0
v_mfma_f32_16x16x32_bf16 v[192:195], v[36:39], v[156:159], 0
ds_read_b64_tr_b16 a[234:235], v183 offset:8704
s_nop 0
v_mfma_f32_16x16x32_bf16 v[192:195], v[32:35], v[152:155], v[192:195]
s_waitcnt lgkmcnt(11)
ds_read_b64_tr_b16 a[236:237], v183 offset:12288
v_cvt_pk_bf16_f32 v80, v200, v201
v_mfma_f32_16x16x32_bf16 v[204:207], v[32:35], v[96:99], 0
s_waitcnt lgkmcnt(11)
ds_read_b64_tr_b16 a[238:239], v183 offset:12800
v_cvt_pk_bf16_f32 v81, v202, v203
v_mfma_f32_16x16x32_bf16 v[204:207], v[36:39], v[100:103], v[204:207]
s_waitcnt lgkmcnt(11)
ds_read_b64_tr_b16 a[240:241], v183 offset:8
s_nop 0
v_mfma_f32_16x16x32_bf16 v[200:203], v[232:235], a[156:159], 0
s_waitcnt lgkmcnt(11)
ds_read_b64_tr_b16 a[242:243], v183 offset:520
ds_read_b128 v[208:211], v242 offset:12672
v_mfma_f32_16x16x32_bf16 v[200:203], v[224:227], a[152:155], v[200:203]
s_waitcnt lgkmcnt(12)
ds_read_b128 v[216:219], v242 offset:12928
ds_read_b128 v[220:223], v242 offset:13184
v_mfma_f32_16x16x32_bf16 v[200:203], v[212:215], a[148:151], v[200:203]
s_waitcnt lgkmcnt(13)
v_exp_f32 v192, v192
v_mfma_f32_16x16x32_bf16 v[200:203], v[188:191], a[144:147], v[200:203]
buffer_load_dwordx4 v243, s[16:19], s101 offen offset:3168 nt lds
v_mfma_f32_16x16x32_bf16 v[228:231], v[188:191], a[160:163], 0
s_waitcnt lgkmcnt(12)
v_exp_f32 v193, v193
v_mfma_f32_16x16x32_bf16 v[228:231], v[212:215], a[164:167], v[228:231]
s_waitcnt lgkmcnt(11)
v_exp_f32 v194, v194
v_mfma_f32_16x16x32_bf16 v[228:231], v[224:227], a[168:171], v[228:231]
s_waitcnt lgkmcnt(10)
ds_read_b64_tr_b16 a[244:245], v183 offset:4104
v_cvt_pk_bf16_f32 v112, v192, v193
v_mfma_f32_16x16x32_bf16 v[228:231], v[232:235], a[172:175], v[228:231]
s_waitcnt lgkmcnt(10)
ds_read_b64_tr_b16 a[246:247], v183 offset:4616
v_exp_f32 v195, v195
s_nop 0
v_cvt_pk_bf16_f32 v113, v194, v195
v_mfma_f32_16x16x32_bf16 v[192:195], v[232:235], a[188:191], 0
s_waitcnt lgkmcnt(9)
ds_read_b64_tr_b16 a[248:249], v183 offset:8200
v_cvt_pk_bf16_f32 v88, v228, v229
v_mfma_f32_16x16x32_bf16 v[192:195], v[224:227], a[184:187], v[192:195]
s_waitcnt lgkmcnt(9)
ds_read_b64_tr_b16 a[250:251], v183 offset:8712
v_cvt_pk_bf16_f32 v89, v230, v231
v_mfma_f32_16x16x32_bf16 v[192:195], v[212:215], a[180:183], v[192:195]
s_waitcnt lgkmcnt(6)
ds_read_b64_tr_b16 a[252:253], v183 offset:12296
v_cvt_pk_bf16_f32 v84, v200, v201
v_mfma_f32_16x16x32_bf16 v[192:195], v[188:191], a[176:179], v[192:195]
s_waitcnt lgkmcnt(6)
ds_read_b64_tr_b16 a[254:255], v183 offset:12808
v_cvt_pk_bf16_f32 v85, v202, v203
v_mfma_f32_16x16x32_bf16 v[228:231], a[64:67], v[208:211], 0
s_waitcnt lgkmcnt(6)
ds_read_b128 v[200:203], v242 offset:13440
s_nop 0
v_mfma_f32_16x16x32_bf16 v[228:231], a[68:71], v[216:219], v[228:231]
v_cvt_pk_bf16_f32 v92, v192, v193
v_cvt_pk_bf16_f32 v93, v194, v195
v_mfma_f32_16x16x32_bf16 v[228:231], a[72:75], v[220:223], v[228:231]
v_exp_f32 v204, v204
v_exp_f32 v205, v205
v_exp_f32 v206, v206
v_exp_f32 v207, v207
v_cvt_pk_bf16_f32 v128, v204, v205
v_cvt_pk_bf16_f32 v129, v206, v207
v_exp_f32 v196, v196
s_waitcnt lgkmcnt(0)
v_mfma_f32_16x16x32_bf16 v[228:231], a[76:79], v[200:203], v[228:231]
s_barrier
v_mfma_f32_16x16x32_bf16 v[192:195], a[92:95], v[200:203], 0
s_add_u32 s98, s98, s48
v_exp_f32 v197, v197
v_mfma_f32_16x16x32_bf16 v[192:195], a[88:91], v[220:223], v[192:195]
s_add_u32 s99, s98, s51
v_exp_f32 v198, v198
v_mfma_f32_16x16x32_bf16 v[192:195], a[84:87], v[216:219], v[192:195]
s_add_u32 s100, s99, s51
s_add_u32 m0, s49, 8448
s_add_u32 s101, s100, s51
v_mfma_f32_16x16x32_bf16 v[192:195], a[80:83], v[208:211], v[192:195]
buffer_load_dwordx4 v243, s[16:19], s98 offen offset:0 nt lds
v_cvt_pk_bf16_f32 v24, v228, v229
v_cvt_pk_bf16_f32 v25, v230, v231
v_mfma_f32_16x16x32_bf16 v[228:231], a[96:99], v[208:211], 0
s_add_u32 s98, s98, s48
v_exp_f32 v199, v199
v_mfma_f32_16x16x32_bf16 v[228:231], a[100:103], v[216:219], v[228:231]
s_bfe_i32 s57, s3, 0x10000
v_cvt_pk_bf16_f32 v26, v192, v193
v_cvt_pk_bf16_f32 v27, v194, v195
v_mfma_f32_16x16x32_bf16 v[228:231], a[104:107], v[220:223], v[228:231]
s_and_b32 s54, s57, s5
v_cvt_pk_bf16_f32 v124, v196, v197
v_cvt_pk_bf16_f32 v125, v198, v199
v_mfma_f32_16x16x32_bf16 v[228:231], a[108:111], v[200:203], v[228:231]
s_add_u32 s50, s50, 13107200
ds_read_b128 v[196:199], v247 offset:0
v_add_u32 v245, 1728, v245
v_mfma_f32_16x16x32_bf16 v[192:195], a[124:127], v[200:203], 0
s_mov_b32 s47, s46
v_add_u32 v246, 1728, v246
v_add_u32 v247, 1728, v247
v_mfma_f32_16x16x32_bf16 v[192:195], a[120:123], v[220:223], v[192:195]
s_lshr_b32 s3, s3, 1
v_cvt_pk_bf16_f32 v28, v228, v229
v_cvt_pk_bf16_f32 v29, v230, v231
v_mfma_f32_16x16x32_bf16 v[192:195], a[116:119], v[216:219], v[192:195]
s_sub_u32 s45, s45, 1
s_sub_u32 s50, s50, s54
s_add_u32 s52, s46, 20480
v_mfma_f32_16x16x32_bf16 v[192:195], a[112:115], v[208:211], v[192:195]
buffer_load_dwordx4 v243, s[16:19], s99 offen offset:1056 nt lds
v_mfma_f32_16x16x32_bf16 v[204:207], v[208:211], a[128:131], 0
s_add_u32 s99, s98, s51
s_add_u32 s53, s46, 0
s_nop 0
v_mfma_f32_16x16x32_bf16 v[204:207], v[216:219], a[132:135], v[204:207]
s_nop 1
v_cvt_pk_bf16_f32 v30, v192, v193
v_mfma_f32_16x16x32_bf16 v[204:207], v[220:223], a[136:139], v[204:207]
v_cvt_pk_bf16_f32 v31, v194, v195
v_mfma_f32_16x16x32_bf16 v[204:207], v[200:203], a[140:143], v[204:207]
v_mov_b64 v[168:169], 0
v_mov_b64 v[170:171], 0
v_mfma_f32_16x16x32_bf16 v[192:195], v[28:31], v[156:159], 0
v_mov_b64 v[172:173], 0
v_mov_b64 v[174:175], 0
v_mfma_f32_16x16x32_bf16 v[192:195], v[24:27], v[152:155], v[192:195]
v_mov_b64 v[176:177], 0
s_nop 0
v_cvt_pk_bf16_f32 v66, v204, v205
v_cvt_pk_bf16_f32 v67, v206, v207
v_mfma_f32_16x16x32_bf16 v[204:207], v[24:27], v[96:99], 0
s_waitcnt lgkmcnt(0)
v_mov_b64 v[178:179], 0
v_mfma_f32_16x16x32_bf16 v[204:207], v[28:31], v[100:103], v[204:207]
ds_read_b128 v[152:155], v242 offset:21120
ds_read_b128 v[156:159], v242 offset:21376
v_smfmac_f32_16x16x64_bf16 v[168:171], v[196:199], v[0:7], v251
ds_read_b128 v[160:163], v242 offset:21632
ds_read_b128 v[164:167], v242 offset:21888
v_smfmac_f32_16x16x64_bf16 v[172:175], v[196:199], v[16:23], v251
s_nop 2
v_smfmac_f32_16x16x64_bf16 v[176:179], v[196:199], v[32:39], v251
s_nop 0
v_add_f32 v168, v168, v169
v_mfma_f32_16x16x32_bf16 v[228:231], v[200:203], a[156:159], 0
v_exp_f32 v192, v192
v_mfma_f32_16x16x32_bf16 v[228:231], v[220:223], a[152:155], v[228:231]
v_exp_f32 v193, v193
v_mfma_f32_16x16x32_bf16 v[228:231], v[216:219], a[148:151], v[228:231]
v_exp_f32 v194, v194
v_mfma_f32_16x16x32_bf16 v[228:231], v[208:211], a[144:147], v[228:231]
v_exp_f32 v195, v195
v_smfmac_f32_16x16x64_bf16 v[170:173], v[196:199], v[8:15], v251
v_cvt_pk_bf16_f32 v110, v192, v193
v_smfmac_f32_16x16x64_bf16 v[174:177], v[196:199], v[24:31], v251
v_cvt_pk_bf16_f32 v111, v194, v195
v_smfmac_f32_16x16x64_bf16 v[178:181], v[196:199], v[40:47], v251
s_nop 1
v_cvt_pk_bf16_f32 v70, v228, v229
v_mfma_f32_16x16x32_bf16 v[192:195], v[208:211], a[160:163], 0
v_cvt_pk_bf16_f32 v71, v230, v231
v_add_f32 v170, v170, v171
v_mfma_f32_16x16x32_bf16 v[192:195], v[216:219], a[164:167], v[192:195]
v_exp_f32 v204, v204
v_mfma_f32_16x16x32_bf16 v[192:195], v[220:223], a[168:171], v[192:195]
s_waitcnt lgkmcnt(2)
v_exp_f32 v205, v205
v_mfma_f32_16x16x32_bf16 v[192:195], v[200:203], a[172:175], v[192:195]
buffer_load_dwordx4 v243, s[16:19], s100 offen offset:2112 nt lds
v_mfma_f32_16x16x32_bf16 v[196:199], v[200:203], a[188:191], 0
s_waitcnt lgkmcnt(0)
ds_read_b128 v[200:203], v242 offset:0
v_mov_b64 v[228:229], 0
v_mfma_f32_16x16x32_bf16 v[196:199], v[220:223], a[184:187], v[196:199]
s_add_u32 s100, s99, s51
ds_read_b128 v[220:223], v242 offset:256
v_cvt_pk_bf16_f32 v74, v192, v193
v_mfma_f32_16x16x32_bf16 v[196:199], v[216:219], a[180:183], v[196:199]
ds_read_b128 v[216:219], v242 offset:512
v_cvt_pk_bf16_f32 v75, v194, v195
v_mfma_f32_16x16x32_bf16 v[196:199], v[208:211], a[176:179], v[196:199]
ds_read_b128 v[192:195], v242 offset:768
v_cvt_pk_bf16_f32 v126, v204, v205
v_smfmac_f32_16x16x64_bf16 v[228:231], v[184:187], v[104:111], v251
v_add_f32 v172, v172, v173
v_smfmac_f32_16x16x64_bf16 v[228:231], v[184:187], v[112:119], v251 abid:1
v_add_f32 v174, v174, v175
v_mfma_f32_16x16x32_bf16 v[136:139], a[192:195], v[152:155], 0
v_exp_f32 v168, v168
v_mfma_f32_16x16x32_bf16 v[136:139], a[196:199], v[156:159], v[136:139]
v_exp_f32 v170, v170
v_mfma_f32_16x16x32_bf16 v[136:139], a[200:203], v[160:163], v[136:139]
v_exp_f32 v172, v172
v_mfma_f32_16x16x32_bf16 v[136:139], a[204:207], v[164:167], v[136:139]
buffer_load_dwordx4 v243, s[16:19], s101 offen offset:3168 nt lds
v_mfma_f32_16x16x32_bf16 v[140:143], a[220:223], v[164:167], 0
s_add_u32 m0, s49, 16896
v_exp_f32 v174, v174
v_mfma_f32_16x16x32_bf16 v[140:143], a[216:219], v[160:163], v[140:143]
s_add_u32 s101, s100, s51
v_add_f32 v176, v176, v177
v_add_f32 v178, v178, v179
v_mfma_f32_16x16x32_bf16 v[140:143], a[212:215], v[156:159], v[140:143]
s_and_b32 s51, s57, 13106176
v_exp_f32 v176, v176
v_mfma_f32_16x16x32_bf16 v[140:143], a[208:211], v[152:155], v[140:143]
s_waitcnt lgkmcnt(3)
v_add_f32 v180, v168, v170
v_cvt_pk_bf16_f32 v169, v168, v170
v_mfma_f32_16x16x32_bf16 v[144:147], a[224:227], v[152:155], 0
s_waitcnt lgkmcnt(2)
ds_write_b16 v248, v169 offset:0
v_mfma_f32_16x16x32_bf16 v[144:147], a[228:231], v[156:159], v[144:147]
s_waitcnt lgkmcnt(2)
ds_write_b16_d16_hi v248, v169 offset:4
v_mfma_f32_16x16x32_bf16 v[144:147], a[232:235], v[160:163], v[144:147]
s_waitcnt lgkmcnt(2)
v_exp_f32 v178, v178
v_mfma_f32_16x16x32_bf16 v[144:147], a[236:239], v[164:167], v[144:147]
buffer_load_dwordx4 v243, s[16:19], s98 offen offset:0 nt lds
v_mfma_f32_16x16x32_bf16 v[148:151], a[252:255], v[164:167], 0
s_lshl3_add_u32 s48, s51, 8192
v_add_f32 v180, v180, v172
v_add_f32 v180, v180, v174
v_mfma_f32_16x16x32_bf16 v[148:151], a[244:247], v[156:159], v[148:151]
s_sub_u32 s49, s49, s56
v_add_f32 v180, v180, v176
v_add_f32 v180, v180, v178
v_mfma_f32_16x16x32_bf16 v[148:151], a[240:243], v[152:155], v[148:151]
s_sub_u32 s51, s51, 32
v_cvt_pk_bf16_f32 v173, v172, v174
v_add_f32_dpp v180, v180, v180 row_ror:8 row_mask:0xf bank_mask:0xf
v_mfma_f32_16x16x32_bf16 v[148:151], a[248:251], v[160:163], v[148:151]
ds_write_b16 v248, v173 offset:272
v_mfma_f32_16x16x32_bf16 v[164:167], a[248:251], v[216:219], 0
ds_write_b16_d16_hi v248, v173 offset:276
v_mfma_f32_16x16x32_bf16 v[164:167], a[252:255], v[192:195], v[164:167]
v_cvt_pk_bf16_f32 v177, v176, v178
v_add_f32_dpp v180, v180, v180 row_ror:4 row_mask:0xf bank_mask:0xf
v_mfma_f32_16x16x32_bf16 v[164:167], a[244:247], v[220:223], v[164:167]
ds_write_b16 v248, v177 offset:544
v_mfma_f32_16x16x32_bf16 v[164:167], a[240:243], v[200:203], v[164:167]
buffer_load_dwordx4 v243, s[16:19], s99 offen offset:1056 nt lds
v_mfma_f32_16x16x32_bf16 v[160:163], a[224:227], v[200:203], 0
ds_write_b32 v250, v180 offset:256
v_mfma_f32_16x16x32_bf16 v[160:163], a[228:231], v[220:223], v[160:163]
ds_write_b16_d16_hi v248, v177 offset:548
v_mfma_f32_16x16x32_bf16 v[160:163], a[232:235], v[216:219], v[160:163]
ds_read_b128 v[208:211], v249 offset:0
v_add_f32 v228, v228, v229
v_mfma_f32_16x16x32_bf16 v[160:163], a[236:239], v[192:195], v[160:163]
v_exp_f32 v206, v206
v_mfma_f32_32x32x16_bf16 v[168:183], v[236:239], v[116:119], 0
v_exp_f32 v207, v207
v_rcp_f32 v254, v228
v_cvt_pk_bf16_f32 v127, v206, v207
v_cvt_pk_bf16_f32 v78, v196, v197
v_mfma_f32_16x16x32_bf16 v[156:159], a[220:223], v[192:195], 0
v_cvt_pk_bf16_f32 v79, v198, v199
v_max3_f32 v255, v255, v228, v254
v_mfma_f32_16x16x32_bf16 v[156:159], a[216:219], v[216:219], v[156:159]
v_mfma_f32_16x16x32_bf16 v[156:159], a[212:215], v[220:223], v[156:159]
v_mfma_f32_16x16x32_bf16 v[156:159], a[208:211], v[200:203], v[156:159]
buffer_load_dwordx4 v243, s[16:19], s100 offen offset:2112 nt lds
v_mfma_f32_16x16x32_bf16 v[152:155], a[192:195], v[200:203], 0
v_mfma_f32_16x16x32_bf16 v[152:155], a[196:199], v[220:223], v[152:155]
ds_read_b128 v[220:223], v249 offset:544
v_mfma_f32_16x16x32_bf16 v[152:155], a[200:203], v[216:219], v[152:155]
ds_read_b128 v[216:219], v249 offset:272
v_mfma_f32_16x16x32_bf16 v[152:155], a[204:207], v[192:195], v[152:155]
buffer_load_dwordx4 v243, s[16:19], s101 offen offset:3168 nt lds
v_mfma_f32_16x16x32_bf16 v[168:171], v[48:51], v[104:107], v[168:171]
s_mov_b32 m0, s58
v_mfma_f32_16x16x32_bf16 v[168:171], v[64:67], v[108:111], v[168:171]
s_waitcnt lgkmcnt(2)
v_mfma_f32_16x16x32_bf16 v[168:171], v[80:83], v[112:115], v[168:171]
v_mfma_f32_16x16x32_bf16 v[172:175], v[84:87], v[112:115], v[172:175]
v_mfma_f32_16x16x32_bf16 v[172:175], v[52:55], v[104:107], v[172:175]
v_mfma_f32_16x16x32_bf16 v[172:175], v[68:71], v[108:111], v[172:175]
v_mfma_f32_16x16x32_bf16 v[176:179], v[72:75], v[108:111], v[176:179]
v_mfma_f32_16x16x32_bf16 v[176:179], v[88:91], v[112:115], v[176:179]
v_mfma_f32_16x16x32_bf16 v[176:179], v[56:59], v[104:107], v[176:179]
s_branch L_entryf
L_spin:
ds_read_addtid_b32 v192 offset:65280
s_waitcnt lgkmcnt(0)
v_cmp_lt_u32 vcc, s45, v192
s_nop 1
s_cbranch_vccnz L_spin
s_branch L_back
L_spine:
ds_read_addtid_b32 v188 offset:65280
s_waitcnt lgkmcnt(0)
v_cmp_lt_u32 vcc, s45, v188
s_nop 1
s_cbranch_vccnz L_spine
s_branch L_backe
.p2align 12
.fill 498, 4, 0xbf800000
L_h3:
s_cbranch_execz L_ret
L_loopf:
v_mfma_f32_16x16x32_bf16 v[152:155], a[192:195], v[188:191], 0
s_mov_b32 m0, s59
v_cvt_pk_bf16_f32 v102, v232, v233
v_cvt_pk_bf16_f32 v103, v234, v235
v_mfma_f32_16x16x32_bf16 v[152:155], a[196:199], v[208:211], v[152:155]
s_add_u32 s52, s47, 8192
ds_read_addtid_b32 v192 offset:65280
v_cvt_pk_bf16_f32 v106, v204, v205
v_mfma_f32_16x16x32_bf16 v[152:155], a[200:203], v[212:215], v[152:155]
s_add_u32 s53, s47, 12288
v_exp_f32 v221, v221
v_mfma_f32_16x16x32_bf16 v[152:155], a[204:207], v[216:219], v[152:155]
s_bfe_i32 s57, s3, 0x10000
v_exp_f32 v222, v222
v_mfma_f32_16x16x32_bf16 v[156:159], a[220:223], v[216:219], 0
s_mov_b32 s47, s46
v_exp_f32 v223, v223
v_mfma_f32_16x16x32_bf16 v[156:159], a[216:219], v[212:215], v[156:159]
s_and_b32 s54, s57, s5
v_cvt_pk_bf16_f32 v110, v220, v221
v_cvt_pk_bf16_f32 v111, v222, v223
v_mfma_f32_16x16x32_bf16 v[156:159], a[212:215], v[208:211], v[156:159]
s_lshr_b32 s3, s3, 1
v_exp_f32 v196, v196
v_mfma_f32_16x16x32_bf16 v[156:159], a[208:211], v[188:191], v[156:159]
s_waitcnt lgkmcnt(0)
v_cmp_lt_u32 vcc, s45, v192
v_cvt_pk_bf16_f32 v107, v206, v207
v_mfma_f32_16x16x32_bf16 v[160:163], a[224:227], v[188:191], 0
v_exp_f32 v197, v197
v_mfma_f32_16x16x32_bf16 v[160:163], a[228:231], v[208:211], v[160:163]
v_exp_f32 v198, v198
v_mfma_f32_16x16x32_bf16 v[160:163], a[232:235], v[212:215], v[160:163]
s_cbranch_vccnz L_spin
L_back:
v_exp_f32 v199, v199
v_mfma_f32_16x16x32_bf16 v[160:163], a[236:239], v[216:219], v[160:163]
s_mov_b32 s98, s50
ds_read_b128 v[192:195], v242 offset:0
v_cvt_pk_bf16_f32 v104, v196, v197
v_mfma_f32_16x16x32_bf16 v[164:167], a[252:255], v[216:219], 0
s_add_u32 s99, s98, s51
ds_read_b128 v[216:219], v242 offset:512
v_cvt_pk_bf16_f32 v105, v198, v199
v_mfma_f32_16x16x32_bf16 v[164:167], a[248:251], v[212:215], v[164:167]
s_add_u32 s100, s99, s51
ds_read_b128 v[196:199], v242 offset:256
v_mov_b64 v[212:213], s[96:97]
v_mfma_f32_16x16x32_bf16 v[164:167], a[244:247], v[208:211], v[164:167]
s_add_u32 m0, s49, 0
ds_read_b128 v[204:207], v242 offset:768
v_mov_b64 v[214:215], s[96:97]
v_mfma_f32_16x16x32_bf16 v[164:167], a[240:243], v[188:191], v[164:167]
s_add_u32 s101, s100, s51
v_exp_f32 v224, v224
v_mfma_f32_16x16x32_bf16 v[188:191], v[12:15], v[100:103], 0
s_sub_u32 s45, s45, 1
v_exp_f32 v225, v225
v_mfma_f32_16x16x32_bf16 v[188:191], v[8:11], v[96:99], v[188:191]
s_waitcnt lgkmcnt(3)
v_exp_f32 v226, v226
v_smfmac_f32_16x16x64_bf16 v[212:215], v[238:241], v[96:103], v251
s_add_u32 s50, s50, 13107200
s_sub_u32 s50, s50, s54
v_cvt_pk_bf16_f32 v108, v224, v225
v_mfma_f32_16x16x32_bf16 v[208:211], v[0:3], v[96:99], 0
v_exp_f32 v227, v227
v_mfma_f32_16x16x32_bf16 v[208:211], v[4:7], v[100:103], v[208:211]
s_waitcnt lgkmcnt(1)
v_cvt_pk_bf16_f32 v109, v226, v227
v_add_f32 v212, v212, v213
v_mfma_f32_16x16x32_bf16 v[220:223], a[64:67], v[192:195], 0
v_exp_f32 v200, v200
v_mfma_f32_16x16x32_bf16 v[220:223], a[68:71], v[196:199], v[220:223]
s_waitcnt lgkmcnt(0)
v_exp_f32 v201, v201
v_mfma_f32_16x16x32_bf16 v[220:223], a[72:75], v[216:219], v[220:223]
v_exp_f32 v202, v202
v_mfma_f32_16x16x32_bf16 v[220:223], a[76:79], v[204:207], v[220:223]
v_exp_f32 v203, v203
v_mfma_f32_16x16x32_bf16 v[224:227], a[92:95], v[204:207], 0
v_cvt_pk_bf16_f32 v112, v200, v201
v_cvt_pk_bf16_f32 v113, v202, v203
v_mfma_f32_16x16x32_bf16 v[224:227], a[88:91], v[216:219], v[224:227]
v_exp_f32 v228, v228
v_mfma_f32_16x16x32_bf16 v[224:227], a[84:87], v[196:199], v[224:227]
s_nop 0
v_cvt_pk_bf16_f32 v0, v220, v221
v_cvt_pk_bf16_f32 v1, v222, v223
v_mfma_f32_16x16x32_bf16 v[224:227], a[80:83], v[192:195], v[224:227]
buffer_load_dwordx4 v243, s[16:19], s98 offen offset:0 nt lds
v_mfma_f32_16x16x32_bf16 v[200:203], a[96:99], v[192:195], 0
s_add_u32 s98, s98, s48
v_exp_f32 v229, v229
v_mfma_f32_16x16x32_bf16 v[200:203], a[100:103], v[196:199], v[200:203]
v_exp_f32 v230, v230
v_mfma_f32_16x16x32_bf16 v[200:203], a[104:107], v[216:219], v[200:203]
v_exp_f32 v231, v231
v_mfma_f32_16x16x32_bf16 v[200:203], a[108:111], v[204:207], v[200:203]
v_mov_b64 v[220:221], 0
v_cvt_pk_bf16_f32 v114, v228, v229
v_mfma_f32_16x16x32_bf16 v[232:235], a[124:127], v[204:207], 0
v_cvt_pk_bf16_f32 v115, v230, v231
v_cvt_pk_bf16_f32 v2, v224, v225
v_mfma_f32_16x16x32_bf16 v[232:235], a[120:123], v[216:219], v[232:235]
v_exp_f32 v188, v188
v_mfma_f32_16x16x32_bf16 v[232:235], a[116:119], v[196:199], v[232:235]
v_cvt_pk_bf16_f32 v4, v200, v201
v_cvt_pk_bf16_f32 v5, v202, v203
v_mfma_f32_16x16x32_bf16 v[232:235], a[112:115], v[192:195], v[232:235]
v_exp_f32 v189, v189
v_smfmac_f32_16x16x64_bf16 v[220:223], v[184:187], v[104:111], v251
ds_read_b128 v[192:195], v242 offset:4992
v_cvt_pk_bf16_f32 v122, v188, v189
v_smfmac_f32_16x16x64_bf16 v[220:223], v[184:187], v[112:119], v251 abid:1
ds_read_b128 v[196:199], v242 offset:4736
ds_read_b128 v[204:207], v242 offset:4480
v_mfma_f32_16x16x32_bf16 v[168:171], v[80:83], v[112:115], v[168:171]
ds_read_b128 v[216:219], v242 offset:4224
v_cvt_pk_bf16_f32 v3, v226, v227
v_mfma_f32_16x16x32_bf16 v[168:171], v[64:67], v[108:111], v[168:171]
v_exp_f32 v190, v190
v_mfma_f32_16x16x32_bf16 v[168:171], v[48:51], v[104:107], v[168:171]
v_exp_f32 v191, v191
v_mfma_f32_16x16x32_bf16 v[172:175], v[52:55], v[104:107], v[172:175]
v_cvt_pk_bf16_f32 v123, v190, v191
v_add_f32 v220, v220, v221
v_mfma_f32_16x16x32_bf16 v[172:175], v[68:71], v[108:111], v[172:175]
s_waitcnt lgkmcnt(3)
v_rcp_f32 v254, v220
v_mfma_f32_16x16x32_bf16 v[172:175], v[84:87], v[112:115], v[172:175]
v_max3_f32 v255, v255, v220, v254
v_cvt_pk_bf16_f32 v6, v232, v233
v_mfma_f32_16x16x32_bf16 v[200:203], v[40:43], v[96:99], 0
v_exp_f32 v208, v208
v_mfma_f32_16x16x32_bf16 v[200:203], v[44:47], v[100:103], v[200:203]
v_exp_f32 v209, v209
v_mfma_f32_16x16x32_bf16 v[176:179], v[56:59], v[104:107], v[176:179]
v_exp_f32 v210, v210
v_mfma_f32_16x16x32_bf16 v[176:179], v[72:75], v[108:111], v[176:179]
v_exp_f32 v211, v211
v_mfma_f32_16x16x32_bf16 v[176:179], v[88:91], v[112:115], v[176:179]
v_cvt_pk_bf16_f32 v120, v208, v209
v_cvt_pk_bf16_f32 v121, v210, v211
v_mfma_f32_16x16x32_bf16 v[180:183], v[92:95], v[112:115], v[180:183]
v_cvt_pk_bf16_f32 v7, v234, v235
v_add_f32 v214, v214, v215
v_mfma_f32_16x16x32_bf16 v[180:183], v[76:79], v[108:111], v[180:183]
s_waitcnt lgkmcnt(1)
v_exp_f32 v212, v212
v_mfma_f32_16x16x32_bf16 v[180:183], v[60:63], v[104:107], v[180:183]
s_waitcnt lgkmcnt(0)
v_exp_f32 v214, v214
v_mfma_f32_16x16x32_bf16 v[188:191], v[16:19], v[96:99], 0
s_mov_b64 vcc, s[14:15]
v_perm_b32 v132, v214, v212, v252
v_perm_b32 v133, v214, v212, v253
v_mfma_f32_16x16x32_bf16 v[188:191], v[20:23], v[100:103], v[188:191]
v_exp_f32 v200, v200
v_mfma_f32_16x16x32_bf16 v[220:223], a[124:127], v[192:195], 0
v_exp_f32 v201, v201
v_mfma_f32_16x16x32_bf16 v[220:223], a[120:123], v[196:199], v[220:223]
v_exp_f32 v202, v202
v_mfma_f32_16x16x32_bf16 v[220:223], a[116:119], v[204:207], v[220:223]
v_exp_f32 v203, v203
v_mfma_f32_16x16x32_bf16 v[220:223], a[112:115], v[216:219], v[220:223]
buffer_load_dwordx4 v243, s[16:19], s99 offen offset:1056 nt lds
v_mfma_f32_16x16x32_bf16 v[224:227], a[96:99], v[216:219], 0
s_add_u32 s99, s98, s51
v_exp_f32 v188, v188
v_mfma_f32_16x16x32_bf16 v[224:227], a[100:103], v[204:207], v[224:227]
v_exp_f32 v189, v189
v_mfma_f32_16x16x32_bf16 v[224:227], a[104:107], v[196:199], v[224:227]
v_exp_f32 v190, v190
v_mfma_f32_16x16x32_bf16 v[224:227], a[108:111], v[192:195], v[224:227]
v_exp_f32 v191, v191
v_mfma_f32_16x16x32_bf16 v[228:231], a[92:95], v[192:195], 0
v_cvt_pk_bf16_f32 v124, v188, v189
v_cvt_pk_bf16_f32 v125, v190, v191
v_mfma_f32_16x16x32_bf16 v[228:231], a[88:91], v[196:199], v[228:231]
v_cvt_pk_bf16_f32 v14, v220, v221
v_cvt_pk_bf16_f32 v15, v222, v223
v_mfma_f32_16x16x32_bf16 v[228:231], a[84:87], v[204:207], v[228:231]
ds_read_b128 v[220:223], v242 offset:16896
v_cvt_pk_bf16_f32 v12, v224, v225
v_mfma_f32_16x16x32_bf16 v[228:231], a[80:83], v[216:219], v[228:231]
v_cvt_pk_bf16_f32 v13, v226, v227
v_cvt_pk_bf16_f32 v130, v200, v201
v_mfma_f32_16x16x32_bf16 v[208:211], a[64:67], v[216:219], 0
ds_read_b128 v[224:227], v242 offset:17152
ds_read_b128 v[216:219], v242 offset:17408
v_mfma_f32_16x16x32_bf16 v[208:211], a[68:71], v[204:207], v[208:211]
v_cvt_pk_bf16_f32 v131, v202, v203
v_fmac_f32 v136, v168, v254
v_mfma_f32_16x16x32_bf16 v[208:211], a[72:75], v[196:199], v[208:211]
v_cvt_pk_bf16_f32 v10, v228, v229
v_cvt_pk_bf16_f32 v11, v230, v231
v_mfma_f32_16x16x32_bf16 v[208:211], a[76:79], v[192:195], v[208:211]
ds_read_b128 v[228:231], v242 offset:17664
v_fmac_f32 v137, v169, v254
v_mfma_f32_16x16x32_bf16 v[188:191], v[28:31], v[100:103], 0
v_fmac_f32 v138, v170, v254
v_fmac_f32 v139, v171, v254
v_mfma_f32_16x16x32_bf16 v[188:191], v[24:27], v[96:99], v[188:191]
v_fmac_f32 v140, v172, v254
v_fmac_f32 v141, v173, v254
v_mfma_f32_16x16x32_bf16 v[192:195], v[32:35], v[96:99], 0
s_waitcnt lgkmcnt(3)
v_fmac_f32 v142, v174, v254
v_fmac_f32 v143, v175, v254
v_mfma_f32_16x16x32_bf16 v[192:195], v[36:39], v[100:103], v[192:195]
s_waitcnt lgkmcnt(2)
v_exp_f32 v188, v188
v_mfma_f32_16x16x32_bf16 v[196:199], a[64:67], v[220:223], 0
s_waitcnt lgkmcnt(1)
v_exp_f32 v189, v189
v_mfma_f32_16x16x32_bf16 v[196:199], a[68:71], v[224:227], v[196:199]
s_waitcnt lgkmcnt(0)
v_exp_f32 v190, v190
v_mfma_f32_16x16x32_bf16 v[196:199], a[72:75], v[216:219], v[196:199]
v_exp_f32 v191, v191
v_mfma_f32_16x16x32_bf16 v[196:199], a[76:79], v[228:231], v[196:199]
buffer_load_dwordx4 v243, s[16:19], s100 offen offset:2112 nt lds
v_mfma_f32_16x16x32_bf16 v[204:207], a[92:95], v[228:231], 0
s_add_u32 s100, s99, s51
ds_read_b128 v[212:215], v242 offset:8960
ds_read_b128 v[200:203], v242 offset:9216
v_mfma_f32_16x16x32_bf16 v[204:207], a[88:91], v[216:219], v[204:207]
ds_read_b128 v[232:235], v242 offset:8704
v_cvt_pk_bf16_f32 v126, v188, v189
v_mfma_f32_16x16x32_bf16 v[204:207], a[84:87], v[224:227], v[204:207]
v_cvt_pk_bf16_f32 v32, v196, v197
v_cvt_pk_bf16_f32 v33, v198, v199
v_mfma_f32_16x16x32_bf16 v[204:207], a[80:83], v[220:223], v[204:207]
v_cvt_pk_bf16_f32 v127, v190, v191
v_fmac_f32 v144, v176, v254
v_mfma_f32_16x16x32_bf16 v[196:199], a[96:99], v[220:223], 0
ds_read_b128 v[188:191], v242 offset:8448
v_fmac_f32 v145, v177, v254
v_mfma_f32_16x16x32_bf16 v[196:199], a[100:103], v[224:227], v[196:199]
v_exp_f32 v192, v192
v_mfma_f32_16x16x32_bf16 v[196:199], a[104:107], v[216:219], v[196:199]
v_cvt_pk_bf16_f32 v34, v204, v205
v_cvt_pk_bf16_f32 v35, v206, v207
v_mfma_f32_16x16x32_bf16 v[196:199], a[108:111], v[228:231], v[196:199]
s_waitcnt lgkmcnt(1)
v_exp_f32 v193, v193
v_mfma_f32_16x16x32_bf16 v[204:207], a[124:127], v[228:231], 0
v_exp_f32 v194, v194
v_mfma_f32_16x16x32_bf16 v[204:207], a[116:119], v[224:227], v[204:207]
v_exp_f32 v195, v195
v_mfma_f32_16x16x32_bf16 v[204:207], a[112:115], v[220:223], v[204:207]
v_cvt_pk_bf16_f32 v128, v192, v193
v_cvt_pk_bf16_f32 v129, v194, v195
v_mfma_f32_16x16x32_bf16 v[204:207], a[120:123], v[216:219], v[204:207]
v_cvt_pk_bf16_f32 v36, v196, v197
v_cvt_pk_bf16_f32 v37, v198, v199
v_mfma_f32_16x16x32_bf16 v[216:219], a[120:123], v[212:215], 0
v_fmac_f32 v146, v178, v254
v_fmac_f32 v147, v179, v254
v_mfma_f32_16x16x32_bf16 v[216:219], a[124:127], v[200:203], v[216:219]
s_waitcnt lgkmcnt(0)
v_fmac_f32 v148, v180, v254
v_fmac_f32 v149, v181, v254
v_mfma_f32_16x16x32_bf16 v[216:219], a[116:119], v[232:235], v[216:219]
v_fmac_f32 v150, v182, v254
v_fmac_f32 v151, v183, v254
v_mfma_f32_16x16x32_bf16 v[216:219], a[112:115], v[188:191], v[216:219]
v_cvt_pk_bf16_f32 v136, v136, v137
v_cvt_pk_bf16_f32 v144, v144, v145
v_mfma_f32_16x16x32_bf16 v[192:195], a[96:99], v[188:191], 0
v_cvt_pk_bf16_f32 v137, v138, v139
v_cvt_pk_bf16_f32 v145, v146, v147
v_mfma_f32_16x16x32_bf16 v[192:195], a[100:103], v[232:235], v[192:195]
v_cvt_pk_bf16_f32 v138, v140, v141
v_cvt_pk_bf16_f32 v139, v142, v143
v_mfma_f32_16x16x32_bf16 v[192:195], a[104:107], v[212:215], v[192:195]
v_cvt_pk_bf16_f32 v146, v148, v149
v_cvt_pk_bf16_f32 v147, v150, v151
v_mfma_f32_16x16x32_bf16 v[192:195], a[108:111], v[200:203], v[192:195]
v_pk_max_i16 v136, v136, 0
v_pk_max_i16 v137, v137, 0
v_mfma_f32_16x16x32_bf16 v[196:199], a[92:95], v[200:203], 0
v_pk_max_i16 v138, v138, 0
v_pk_max_i16 v139, v139, 0
v_mfma_f32_16x16x32_bf16 v[196:199], a[88:91], v[212:215], v[196:199]
v_pk_max_i16 v144, v144, 0
v_pk_max_i16 v145, v145, 0
v_mfma_f32_16x16x32_bf16 v[196:199], a[84:87], v[232:235], v[196:199]
v_cvt_pk_bf16_f32 v20, v192, v193
v_cvt_pk_bf16_f32 v21, v194, v195
v_mfma_f32_16x16x32_bf16 v[196:199], a[80:83], v[188:191], v[196:199]
v_pk_max_i16 v146, v146, 0
v_pk_max_i16 v147, v147, 0
v_mfma_f32_16x16x32_bf16 v[192:195], a[64:67], v[188:191], 0
v_cndmask_b32_dpp v140, v144, v136, vcc quad_perm:[1,0,3,2] row_mask:0xf bank_mask:0xf
v_cndmask_b32_dpp v141, v145, v137, vcc quad_perm:[1,0,3,2] row_mask:0xf bank_mask:0xf
v_mfma_f32_16x16x32_bf16 v[192:195], a[68:71], v[232:235], v[192:195]
v_cndmask_b32_dpp v142, v146, v138, vcc quad_perm:[1,0,3,2] row_mask:0xf bank_mask:0xf
v_cndmask_b32_dpp v143, v147, v139, vcc quad_perm:[1,0,3,2] row_mask:0xf bank_mask:0xf
v_mfma_f32_16x16x32_bf16 v[192:195], a[72:75], v[212:215], v[192:195]
s_not_b64 vcc, vcc
ds_read_b128 v[220:223], v242 offset:13440
v_cndmask_b32_dpp v144, v136, v144, vcc quad_perm:[1,0,3,2] row_mask:0xf bank_mask:0xf
v_mfma_f32_16x16x32_bf16 v[192:195], a[76:79], v[200:203], v[192:195]
v_cndmask_b32_dpp v145, v137, v145, vcc quad_perm:[1,0,3,2] row_mask:0xf bank_mask:0xf
v_cndmask_b32_dpp v146, v138, v146, vcc quad_perm:[1,0,3,2] row_mask:0xf bank_mask:0xf
v_cndmask_b32_dpp v147, v139, v147, vcc quad_perm:[1,0,3,2] row_mask:0xf bank_mask:0xf
v_mfma_f32_32x32x16_bf16 v[168:183], v[236:239], v[132:135], 0
buffer_store_dwordx4 v[140:143], v244, s[20:23], s52 offen offset:0 nt
buffer_store_dwordx4 v[144:147], v244, s[20:23], s52 offen offset:256 nt
v_cvt_pk_bf16_f32 v38, v204, v205
v_mov_b64 v[204:205], 0
v_cvt_pk_bf16_f32 v39, v206, v207
v_cvt_pk_bf16_f32 v16, v192, v193
v_smfmac_f32_16x16x64_bf16 v[204:207], v[184:187], v[120:127], v251
s_add_u32 s52, s46, 20480
v_cvt_pk_bf16_f32 v17, v194, v195
v_smfmac_f32_16x16x64_bf16 v[204:207], v[184:187], v[128:135], v251 abid:1
L_h4:
s_cbranch_execz L_ret
v_cvt_pk_bf16_f32 v22, v216, v217
v_mfma_f32_16x16x32_bf16 v[168:171], v[80:83], v[128:131], v[168:171]
v_cvt_pk_bf16_f32 v23, v218, v219
v_cvt_pk_bf16_f32 v8, v208, v209
v_mfma_f32_16x16x32_bf16 v[168:171], v[64:67], v[124:127], v[168:171]
ds_read_b128 v[216:219], v242 offset:13184
v_cvt_pk_bf16_f32 v9, v210, v211
v_mfma_f32_16x16x32_bf16 v[168:171], v[48:51], v[120:123], v[168:171]
ds_read_b128 v[208:211], v242 offset:12928
v_add_f32 v204, v204, v205
v_mfma_f32_16x16x32_bf16 v[172:175], v[52:55], v[120:123], v[172:175]
ds_read_b128 v[238:241], v245 offset:0
v_cvt_pk_bf16_f32 v18, v196, v197
v_mfma_f32_16x16x32_bf16 v[172:175], v[68:71], v[124:127], v[172:175]
ds_read2_b32 v[236:237], v246 offset0:0 offset1:8
v_cvt_pk_bf16_f32 v19, v198, v199
v_mfma_f32_16x16x32_bf16 v[172:175], v[84:87], v[128:131], v[172:175]
ds_read_b128 v[196:199], v242 offset:12672
v_add_u32 v245, 1728, v245
v_mfma_f32_16x16x32_bf16 v[176:179], v[88:91], v[128:131], v[176:179]
s_waitcnt lgkmcnt(5)
v_rcp_f32 v254, v204
v_mfma_f32_16x16x32_bf16 v[176:179], v[72:75], v[124:127], v[176:179]
v_max3_f32 v255, v255, v204, v254
v_fmac_f32 v152, v168, v254
v_mfma_f32_16x16x32_bf16 v[176:179], v[56:59], v[120:123], v[176:179]
v_fmac_f32 v153, v169, v254
v_fmac_f32 v154, v170, v254
v_mfma_f32_16x16x32_bf16 v[180:183], v[60:63], v[120:123], v[180:183]
v_fmac_f32 v155, v171, v254
v_fmac_f32 v156, v172, v254
v_mfma_f32_16x16x32_bf16 v[180:183], v[76:79], v[124:127], v[180:183]
v_fmac_f32 v157, v173, v254
v_fmac_f32 v158, v174, v254
v_mfma_f32_16x16x32_bf16 v[180:183], v[92:95], v[128:131], v[180:183]
s_mov_b64 vcc, s[14:15]
v_fmac_f32 v159, v175, v254
v_fmac_f32 v160, v176, v254
v_mfma_f32_16x16x32_bf16 v[192:195], v[188:191], a[128:131], 0
v_fmac_f32 v161, v177, v254
v_fmac_f32 v162, v178, v254
v_mfma_f32_16x16x32_bf16 v[192:195], v[232:235], a[132:135], v[192:195]
v_fmac_f32 v163, v179, v254
v_fmac_f32 v164, v180, v254
v_mfma_f32_16x16x32_bf16 v[192:195], v[212:215], a[136:139], v[192:195]
s_waitcnt lgkmcnt(4)
v_fmac_f32 v165, v181, v254
v_cvt_pk_bf16_f32 v152, v152, v153
v_mfma_f32_16x16x32_bf16 v[192:195], v[200:203], a[140:143], v[192:195]
s_waitcnt lgkmcnt(3)
v_cvt_pk_bf16_f32 v160, v160, v161
v_cvt_pk_bf16_f32 v153, v154, v155
v_mfma_f32_16x16x32_bf16 v[204:207], v[200:203], a[156:159], 0
s_waitcnt lgkmcnt(2)
v_fmac_f32 v166, v182, v254
v_fmac_f32 v167, v183, v254
v_mfma_f32_16x16x32_bf16 v[204:207], v[212:215], a[152:155], v[204:207]
s_waitcnt lgkmcnt(1)
v_cvt_pk_bf16_f32 v64, v192, v193
v_cvt_pk_bf16_f32 v65, v194, v195
v_mfma_f32_16x16x32_bf16 v[204:207], v[232:235], a[148:151], v[204:207]
s_waitcnt lgkmcnt(0)
v_cvt_pk_bf16_f32 v161, v162, v163
v_cvt_pk_bf16_f32 v154, v156, v157
v_mfma_f32_16x16x32_bf16 v[204:207], v[188:191], a[144:147], v[204:207]
v_cvt_pk_bf16_f32 v155, v158, v159
v_cvt_pk_bf16_f32 v162, v164, v165
v_mfma_f32_16x16x32_bf16 v[224:227], v[188:191], a[160:163], 0
v_cvt_pk_bf16_f32 v163, v166, v167
v_pk_max_i16 v152, v152, 0
v_mfma_f32_16x16x32_bf16 v[224:227], v[232:235], a[164:167], v[224:227]
v_pk_max_i16 v153, v153, 0
v_pk_max_i16 v154, v154, 0
v_mfma_f32_16x16x32_bf16 v[224:227], v[212:215], a[168:171], v[224:227]
v_cvt_pk_bf16_f32 v68, v204, v205
v_cvt_pk_bf16_f32 v69, v206, v207
v_mfma_f32_16x16x32_bf16 v[224:227], v[200:203], a[172:175], v[224:227]
buffer_load_dwordx4 v243, s[16:19], s101 offen offset:3168 nt lds
v_mfma_f32_16x16x32_bf16 v[192:195], v[200:203], a[188:191], 0
s_add_u32 m0, s49, 8448
v_pk_max_i16 v155, v155, 0
v_pk_max_i16 v160, v160, 0
v_mfma_f32_16x16x32_bf16 v[192:195], v[232:235], a[180:183], v[192:195]
s_add_u32 s101, s100, s51
v_pk_max_i16 v161, v161, 0
v_cvt_pk_bf16_f32 v72, v224, v225
v_mfma_f32_16x16x32_bf16 v[192:195], v[188:191], a[176:179], v[192:195]
v_cvt_pk_bf16_f32 v73, v226, v227
v_pk_max_i16 v162, v162, 0
v_mfma_f32_16x16x32_bf16 v[192:195], v[212:215], a[184:187], v[192:195]
v_pk_max_i16 v163, v163, 0
v_cndmask_b32_dpp v156, v160, v152, vcc quad_perm:[1,0,3,2] row_mask:0xf bank_mask:0xf
v_mfma_f32_16x16x32_bf16 v[188:191], v[216:219], a[184:187], 0
v_cndmask_b32_dpp v157, v161, v153, vcc quad_perm:[1,0,3,2] row_mask:0xf bank_mask:0xf
v_cndmask_b32_dpp v158, v162, v154, vcc quad_perm:[1,0,3,2] row_mask:0xf bank_mask:0xf
v_mfma_f32_16x16x32_bf16 v[188:191], v[220:223], a[188:191], v[188:191]
v_cndmask_b32_dpp v159, v163, v155, vcc quad_perm:[1,0,3,2] row_mask:0xf bank_mask:0xf
v_add_u32 v246, 1728, v246
v_mfma_f32_16x16x32_bf16 v[188:191], v[208:211], a[180:183], v[188:191]
s_not_b64 vcc, vcc
v_cvt_pk_bf16_f32 v76, v192, v193
v_cvt_pk_bf16_f32 v77, v194, v195
v_mfma_f32_16x16x32_bf16 v[188:191], v[196:199], a[176:179], v[188:191]
v_cndmask_b32_dpp v160, v152, v160, vcc quad_perm:[1,0,3,2] row_mask:0xf bank_mask:0xf
v_cndmask_b32_dpp v161, v153, v161, vcc quad_perm:[1,0,3,2] row_mask:0xf bank_mask:0xf
v_mfma_f32_16x16x32_bf16 v[192:195], v[196:199], a[160:163], 0
v_cndmask_b32_dpp v162, v154, v162, vcc quad_perm:[1,0,3,2] row_mask:0xf bank_mask:0xf
v_cndmask_b32_dpp v163, v155, v163, vcc quad_perm:[1,0,3,2] row_mask:0xf bank_mask:0xf
v_mfma_f32_16x16x32_bf16 v[192:195], v[208:211], a[164:167], v[192:195]
s_nop 1
v_cvt_pk_bf16_f32 v78, v188, v189
v_mfma_f32_16x16x32_bf16 v[192:195], v[216:219], a[168:171], v[192:195]
v_cvt_pk_bf16_f32 v79, v190, v191
v_mfma_f32_16x16x32_bf16 v[192:195], v[220:223], a[172:175], v[192:195]
s_nop 2
v_mfma_f32_16x16x32_bf16 v[188:191], v[220:223], a[156:159], 0
s_nop 2
v_mfma_f32_16x16x32_bf16 v[188:191], v[216:219], a[152:155], v[188:191]
v_cvt_pk_bf16_f32 v74, v192, v193
v_cvt_pk_bf16_f32 v75, v194, v195
v_mfma_f32_16x16x32_bf16 v[188:191], v[208:211], a[148:151], v[188:191]
v_mfma_f32_16x16x32_bf16 v[188:191], v[196:199], a[144:147], v[188:191]
s_nop 2
v_mfma_f32_16x16x32_bf16 v[192:195], v[196:199], a[128:131], 0
s_nop 2
v_mfma_f32_16x16x32_bf16 v[192:195], v[208:211], a[132:135], v[192:195]
v_cvt_pk_bf16_f32 v70, v188, v189
v_cvt_pk_bf16_f32 v71, v190, v191
v_mfma_f32_16x16x32_bf16 v[192:195], v[216:219], a[136:139], v[192:195]
v_mfma_f32_16x16x32_bf16 v[192:195], v[220:223], a[140:143], v[192:195]
s_nop 2
v_mfma_f32_16x16x32_bf16 v[188:191], a[64:67], v[196:199], 0
s_nop 2
v_mfma_f32_16x16x32_bf16 v[188:191], a[68:71], v[208:211], v[188:191]
v_cvt_pk_bf16_f32 v66, v192, v193
v_cvt_pk_bf16_f32 v67, v194, v195
v_mfma_f32_16x16x32_bf16 v[188:191], a[72:75], v[216:219], v[188:191]
v_mfma_f32_16x16x32_bf16 v[188:191], a[76:79], v[220:223], v[188:191]
buffer_load_dwordx4 v243, s[16:19], s98 offen offset:0 nt lds
v_mfma_f32_16x16x32_bf16 v[192:195], a[92:95], v[220:223], 0
s_add_u32 s98, s98, s48
ds_read_b128 v[200:203], v242 offset:21632
ds_read_b128 v[204:207], v242 offset:21888
v_mfma_f32_16x16x32_bf16 v[192:195], a[88:91], v[216:219], v[192:195]
ds_read_b128 v[212:215], v242 offset:21376
ds_read_b128 v[224:227], v242 offset:21120
v_mfma_f32_16x16x32_bf16 v[192:195], a[84:87], v[208:211], v[192:195]
v_cvt_pk_bf16_f32 v24, v188, v189
v_cvt_pk_bf16_f32 v25, v190, v191
v_mfma_f32_16x16x32_bf16 v[192:195], a[80:83], v[196:199], v[192:195]
s_nop 2
v_mfma_f32_16x16x32_bf16 v[188:191], a[96:99], v[196:199], 0
s_nop 2
v_mfma_f32_16x16x32_bf16 v[188:191], a[100:103], v[208:211], v[188:191]
v_cvt_pk_bf16_f32 v26, v192, v193
v_cvt_pk_bf16_f32 v27, v194, v195
v_mfma_f32_16x16x32_bf16 v[188:191], a[104:107], v[216:219], v[188:191]
v_mfma_f32_16x16x32_bf16 v[188:191], a[108:111], v[220:223], v[188:191]
s_nop 2
v_mfma_f32_16x16x32_bf16 v[192:195], a[124:127], v[220:223], 0
s_nop 2
v_mfma_f32_16x16x32_bf16 v[192:195], a[116:119], v[208:211], v[192:195]
v_cvt_pk_bf16_f32 v28, v188, v189
v_cvt_pk_bf16_f32 v29, v190, v191
v_mfma_f32_16x16x32_bf16 v[192:195], a[112:115], v[196:199], v[192:195]
s_waitcnt lgkmcnt(3)
v_mfma_f32_16x16x32_bf16 v[192:195], a[120:123], v[216:219], v[192:195]
s_waitcnt lgkmcnt(2)
s_nop 1
v_mfma_f32_16x16x32_bf16 v[188:191], a[120:123], v[200:203], 0
s_waitcnt lgkmcnt(1)
s_nop 1
v_mfma_f32_16x16x32_bf16 v[188:191], a[124:127], v[204:207], v[188:191]
s_waitcnt lgkmcnt(0)
v_cvt_pk_bf16_f32 v30, v192, v193
v_cvt_pk_bf16_f32 v31, v194, v195
v_mfma_f32_16x16x32_bf16 v[188:191], a[116:119], v[212:215], v[188:191]
v_mfma_f32_16x16x32_bf16 v[188:191], a[112:115], v[224:227], v[188:191]
s_nop 2
v_mfma_f32_16x16x32_bf16 v[192:195], a[96:99], v[224:227], 0
s_nop 2
v_mfma_f32_16x16x32_bf16 v[192:195], a[100:103], v[212:215], v[192:195]
v_cvt_pk_bf16_f32 v46, v188, v189
v_cvt_pk_bf16_f32 v47, v190, v191
v_mfma_f32_16x16x32_bf16 v[192:195], a[104:107], v[200:203], v[192:195]
v_mfma_f32_16x16x32_bf16 v[192:195], a[108:111], v[204:207], v[192:195]
buffer_load_dwordx4 v243, s[16:19], s99 offen offset:1056 nt lds
v_mfma_f32_16x16x32_bf16 v[188:191], a[92:95], v[204:207], 0
s_add_u32 s99, s98, s51
s_nop 1
v_mfma_f32_16x16x32_bf16 v[188:191], a[88:91], v[200:203], v[188:191]
s_nop 1
v_cvt_pk_bf16_f32 v44, v192, v193
v_mfma_f32_16x16x32_bf16 v[188:191], a[84:87], v[212:215], v[188:191]
v_cvt_pk_bf16_f32 v45, v194, v195
v_mfma_f32_16x16x32_bf16 v[188:191], a[80:83], v[224:227], v[188:191]
s_nop 2
v_mfma_f32_16x16x32_bf16 v[192:195], a[64:67], v[224:227], 0
s_nop 2
v_mfma_f32_16x16x32_bf16 v[192:195], a[72:75], v[200:203], v[192:195]
v_cvt_pk_bf16_f32 v42, v188, v189
v_cvt_pk_bf16_f32 v43, v190, v191
v_mfma_f32_16x16x32_bf16 v[192:195], a[76:79], v[204:207], v[192:195]
v_mfma_f32_16x16x32_bf16 v[192:195], a[68:71], v[212:215], v[192:195]
s_nop 2
v_mfma_f32_16x16x32_bf16 v[188:191], a[4:7], v[212:215], 0
s_nop 2
v_mfma_f32_16x16x32_bf16 v[188:191], a[0:3], v[224:227], v[188:191]
v_cvt_pk_bf16_f32 v40, v192, v193
v_cvt_pk_bf16_f32 v41, v194, v195
v_mfma_f32_16x16x32_bf16 v[188:191], a[8:11], v[200:203], v[188:191]
v_mfma_f32_16x16x32_bf16 v[188:191], a[12:15], v[204:207], v[188:191]
s_nop 2
v_mfma_f32_16x16x32_bf16 v[192:195], a[28:31], v[204:207], 0
s_nop 2
v_mfma_f32_16x16x32_bf16 v[192:195], a[24:27], v[200:203], v[192:195]
v_cvt_pk_bf16_f32 v96, v188, v189
v_cvt_pk_bf16_f32 v97, v190, v191
v_mfma_f32_16x16x32_bf16 v[192:195], a[20:23], v[212:215], v[192:195]
v_mfma_f32_16x16x32_bf16 v[192:195], a[16:19], v[224:227], v[192:195]
ds_read_b128 v[188:191], v247 offset:0
v_add_u32 v247, 1728, v247
v_mfma_f32_16x16x32_bf16 v[196:199], a[32:35], v[224:227], 0
s_nop 2
v_mfma_f32_16x16x32_bf16 v[196:199], a[36:39], v[212:215], v[196:199]
s_nop 0
v_cvt_pk_bf16_f32 v98, v192, v193
v_cvt_pk_bf16_f32 v99, v194, v195
v_mfma_f32_16x16x32_bf16 v[196:199], a[40:43], v[200:203], v[196:199]
v_mfma_f32_16x16x32_bf16 v[196:199], a[44:47], v[204:207], v[196:199]
v_mov_b64 v[168:169], 0
v_mov_b64 v[170:171], 0
v_mfma_f32_16x16x32_bf16 v[192:195], a[60:63], v[204:207], 0
v_mov_b64 v[172:173], 0
v_mov_b64 v[174:175], 0
v_mfma_f32_16x16x32_bf16 v[192:195], a[56:59], v[200:203], v[192:195]
v_mov_b64 v[176:177], 0
v_mov_b64 v[178:179], 0
v_mfma_f32_16x16x32_bf16 v[192:195], a[52:55], v[212:215], v[192:195]
s_waitcnt lgkmcnt(0)
v_cvt_pk_bf16_f32 v100, v196, v197
v_cvt_pk_bf16_f32 v101, v198, v199
v_mfma_f32_16x16x32_bf16 v[192:195], a[48:51], v[224:227], v[192:195]
s_nop 2
v_smfmac_f32_16x16x64_bf16 v[168:171], v[188:191], v[0:7], v251
s_nop 2
v_smfmac_f32_16x16x64_bf16 v[172:175], v[188:191], v[16:23], v251
v_cvt_pk_bf16_f32 v102, v192, v193
v_smfmac_f32_16x16x64_bf16 v[176:179], v[188:191], v[32:39], v251
v_cvt_pk_bf16_f32 v103, v194, v195
v_mfma_f32_16x16x32_bf16 v[136:139], a[192:195], v[224:227], 0
v_add_f32 v168, v168, v169
v_mfma_f32_16x16x32_bf16 v[136:139], a[196:199], v[212:215], v[136:139]
v_exp_f32 v168, v168
v_mfma_f32_16x16x32_bf16 v[136:139], a[200:203], v[200:203], v[136:139]
v_mfma_f32_16x16x32_bf16 v[136:139], a[204:207], v[204:207], v[136:139]
buffer_load_dwordx4 v243, s[16:19], s100 offen offset:2112 nt lds
v_mfma_f32_16x16x32_bf16 v[140:143], a[220:223], v[204:207], 0
s_add_u32 s100, s99, s51
v_mfma_f32_16x16x32_bf16 v[140:143], a[216:219], v[200:203], v[140:143]
v_mfma_f32_16x16x32_bf16 v[140:143], a[212:215], v[212:215], v[140:143]
v_mfma_f32_16x16x32_bf16 v[140:143], a[208:211], v[224:227], v[140:143]
v_mfma_f32_16x16x32_bf16 v[144:147], a[224:227], v[224:227], 0
v_mfma_f32_16x16x32_bf16 v[144:147], a[228:231], v[212:215], v[144:147]
v_mfma_f32_16x16x32_bf16 v[144:147], a[232:235], v[200:203], v[144:147]
v_mfma_f32_16x16x32_bf16 v[144:147], a[236:239], v[204:207], v[144:147]
v_mfma_f32_16x16x32_bf16 v[148:151], a[252:255], v[204:207], 0
v_mfma_f32_16x16x32_bf16 v[148:151], a[248:251], v[200:203], v[148:151]
v_mfma_f32_16x16x32_bf16 v[148:151], a[244:247], v[212:215], v[148:151]
v_mfma_f32_16x16x32_bf16 v[148:151], a[240:243], v[224:227], v[148:151]
v_smfmac_f32_16x16x64_bf16 v[170:173], v[188:191], v[8:15], v251
v_mov_b64 v[192:193], s[96:97]
v_smfmac_f32_16x16x64_bf16 v[174:177], v[188:191], v[24:31], v251
v_mov_b64 v[194:195], s[96:97]
v_smfmac_f32_16x16x64_bf16 v[178:181], v[188:191], v[40:47], v251
s_nop 2
v_mfma_f32_16x16x32_bf16 v[188:191], v[4:7], v[100:103], 0
v_add_f32 v170, v170, v171
v_add_f32 v172, v172, v173
v_mfma_f32_16x16x32_bf16 v[188:191], v[0:3], v[96:99], v[188:191]
v_exp_f32 v170, v170
v_smfmac_f32_16x16x64_bf16 v[192:195], v[238:241], v[96:103], v251
v_add_f32 v174, v174, v175
v_mfma_f32_16x16x32_bf16 v[196:199], v[224:227], a[128:131], 0
v_exp_f32 v172, v172
v_mfma_f32_16x16x32_bf16 v[196:199], v[212:215], a[132:135], v[196:199]
v_exp_f32 v174, v174
v_mfma_f32_16x16x32_bf16 v[196:199], v[200:203], a[136:139], v[196:199]
v_add_f32 v176, v176, v177
v_add_f32 v178, v178, v179
v_mfma_f32_16x16x32_bf16 v[196:199], v[204:207], a[140:143], v[196:199]
buffer_load_dwordx4 v243, s[16:19], s101 offen offset:3168 nt lds
v_mfma_f32_16x16x32_bf16 v[208:211], v[204:207], a[156:159], 0
s_add_u32 m0, s49, 16896
ds_read_b128 v[216:219], v242 offset:512
ds_read_b128 v[220:223], v242 offset:256
v_mfma_f32_16x16x32_bf16 v[208:211], v[200:203], a[152:155], v[208:211]
s_add_u32 s101, s100, s51
ds_read_b128 v[228:231], v242 offset:0
v_cvt_pk_bf16_f32 v82, v196, v197
v_mfma_f32_16x16x32_bf16 v[208:211], v[212:215], a[148:151], v[208:211]
s_and_b32 s51, s57, 13106176
v_cvt_pk_bf16_f32 v83, v198, v199
v_add_f32 v192, v192, v193
v_mfma_f32_16x16x32_bf16 v[208:211], v[224:227], a[144:147], v[208:211]
s_sub_u32 s49, s49, s56
ds_read_b128 v[196:199], v242 offset:768
v_add_f32 v194, v194, v195
v_mfma_f32_16x16x32_bf16 v[232:235], v[224:227], a[160:163], 0
s_lshl3_add_u32 s48, s51, 8192
v_exp_f32 v192, v192
v_mfma_f32_16x16x32_bf16 v[232:235], v[212:215], a[164:167], v[232:235]
s_sub_u32 s51, s51, 32
v_cvt_pk_bf16_f32 v86, v208, v209
v_cvt_pk_bf16_f32 v87, v210, v211
v_mfma_f32_16x16x32_bf16 v[232:235], v[200:203], a[168:171], v[232:235]
v_exp_f32 v194, v194
v_mfma_f32_16x16x32_bf16 v[232:235], v[204:207], a[172:175], v[232:235]
v_perm_b32 v116, v194, v192, v252
v_perm_b32 v117, v194, v192, v253
v_mfma_f32_16x16x32_bf16 v[208:211], v[204:207], a[188:191], 0
v_add_f32 v180, v168, v170
v_cvt_pk_bf16_f32 v169, v168, v170
v_mfma_f32_16x16x32_bf16 v[208:211], v[212:215], a[180:183], v[208:211]
ds_write_b16 v248, v169 offset:0
v_mfma_f32_16x16x32_bf16 v[208:211], v[224:227], a[176:179], v[208:211]
s_waitcnt lgkmcnt(4)
ds_write_b16_d16_hi v248, v169 offset:4
v_mfma_f32_16x16x32_bf16 v[208:211], v[200:203], a[184:187], v[208:211]
s_waitcnt lgkmcnt(2)
v_exp_f32 v176, v176
v_mfma_f32_16x16x32_bf16 v[200:203], v[216:219], a[184:187], 0
v_exp_f32 v178, v178
v_mfma_f32_16x16x32_bf16 v[200:203], v[196:199], a[188:191], v[200:203]
v_add_f32 v180, v180, v172
v_add_f32 v180, v180, v174
v_mfma_f32_16x16x32_bf16 v[200:203], v[220:223], a[180:183], v[200:203]
v_cvt_pk_bf16_f32 v94, v208, v209
v_cvt_pk_bf16_f32 v95, v210, v211
v_mfma_f32_16x16x32_bf16 v[200:203], v[228:231], a[176:179], v[200:203]
v_add_f32 v180, v180, v176
v_add_f32 v180, v180, v178
v_mfma_f32_16x16x32_bf16 v[204:207], v[228:231], a[160:163], 0
v_cvt_pk_bf16_f32 v173, v172, v174
v_add_f32_dpp v180, v180, v180 row_ror:8 row_mask:0xf bank_mask:0xf
v_mfma_f32_16x16x32_bf16 v[204:207], v[220:223], a[164:167], v[204:207]
ds_write_b16 v248, v173 offset:272
v_mfma_f32_16x16x32_bf16 v[204:207], v[216:219], a[168:171], v[204:207]
ds_write_b16_d16_hi v248, v173 offset:276
v_mfma_f32_16x16x32_bf16 v[204:207], v[196:199], a[172:175], v[204:207]
v_cvt_pk_bf16_f32 v60, v200, v201
v_cvt_pk_bf16_f32 v61, v202, v203
v_mfma_f32_16x16x32_bf16 v[212:215], v[24:27], v[96:99], 0
v_cvt_pk_bf16_f32 v177, v176, v178
v_add_f32_dpp v180, v180, v180 row_ror:4 row_mask:0xf bank_mask:0xf
v_mfma_f32_16x16x32_bf16 v[212:215], v[28:31], v[100:103], v[212:215]
ds_write_b16 v248, v177 offset:544
v_mfma_f32_16x16x32_bf16 v[192:195], v[36:39], v[100:103], 0
ds_write_b32 v250, v180 offset:256
v_mfma_f32_16x16x32_bf16 v[192:195], v[32:35], v[96:99], v[192:195]
ds_write_b16_d16_hi v248, v177 offset:548
v_mfma_f32_16x16x32_bf16 v[200:203], v[40:43], v[96:99], 0
v_cvt_pk_bf16_f32 v56, v204, v205
v_cvt_pk_bf16_f32 v57, v206, v207
v_mfma_f32_16x16x32_bf16 v[200:203], v[44:47], v[100:103], v[200:203]
v_cvt_pk_bf16_f32 v90, v232, v233
v_cvt_pk_bf16_f32 v91, v234, v235
v_mfma_f32_16x16x32_bf16 v[204:207], v[12:15], v[100:103], 0
v_exp_f32 v192, v192
v_mfma_f32_16x16x32_bf16 v[204:207], v[8:11], v[96:99], v[204:207]
v_exp_f32 v193, v193
v_mfma_f32_16x16x32_bf16 v[208:211], v[16:19], v[96:99], 0
v_exp_f32 v194, v194
v_mfma_f32_16x16x32_bf16 v[208:211], v[20:23], v[100:103], v[208:211]
v_exp_f32 v195, v195
v_mfma_f32_32x32x16_bf16 v[168:183], v[236:239], v[116:119], 0
buffer_store_dwordx4 v[156:159], v244, s[20:23], s53 offen offset:0 nt
buffer_store_dwordx4 v[160:163], v244, s[20:23], s53 offen offset:256 nt
v_exp_f32 v204, v204
v_exp_f32 v205, v205
v_mfma_f32_16x16x32_bf16 v[224:227], v[196:199], a[156:159], 0
s_add_u32 s53, s46, 0
v_exp_f32 v206, v206
v_mfma_f32_16x16x32_bf16 v[224:227], v[216:219], a[152:155], v[224:227]
v_exp_f32 v207, v207
v_mfma_f32_16x16x32_bf16 v[224:227], v[220:223], a[148:151], v[224:227]
v_cvt_pk_bf16_f32 v106, v204, v205
v_cvt_pk_bf16_f32 v107, v206, v207
v_mfma_f32_16x16x32_bf16 v[224:227], v[228:231], a[144:147], v[224:227]
v_exp_f32 v208, v208
v_mfma_f32_16x16x32_bf16 v[232:235], v[228:231], a[128:131], 0
v_exp_f32 v209, v209
v_mfma_f32_16x16x32_bf16 v[232:235], v[220:223], a[132:135], v[232:235]
v_exp_f32 v210, v210
v_mfma_f32_16x16x32_bf16 v[232:235], v[216:219], a[136:139], v[232:235]
v_exp_f32 v211, v211
v_mfma_f32_16x16x32_bf16 v[232:235], v[196:199], a[140:143], v[232:235]
v_cvt_pk_bf16_f32 v108, v208, v209
v_cvt_pk_bf16_f32 v109, v210, v211
v_mfma_f32_16x16x32_bf16 v[204:207], a[0:3], v[228:231], 0
v_cvt_pk_bf16_f32 v112, v192, v193
v_cvt_pk_bf16_f32 v113, v194, v195
v_mfma_f32_16x16x32_bf16 v[204:207], a[4:7], v[220:223], v[204:207]
v_exp_f32 v200, v200
v_mfma_f32_16x16x32_bf16 v[204:207], a[8:11], v[216:219], v[204:207]
v_exp_f32 v201, v201
v_mfma_f32_16x16x32_bf16 v[204:207], a[12:15], v[196:199], v[204:207]
buffer_load_dwordx4 v243, s[16:19], s98 offen offset:0 nt lds
v_mfma_f32_16x16x32_bf16 v[208:211], a[28:31], v[196:199], 0
v_exp_f32 v202, v202
v_mfma_f32_16x16x32_bf16 v[208:211], a[24:27], v[216:219], v[208:211]
v_exp_f32 v203, v203
v_mfma_f32_16x16x32_bf16 v[208:211], a[20:23], v[220:223], v[208:211]
v_cvt_pk_bf16_f32 v114, v200, v201
v_cvt_pk_bf16_f32 v115, v202, v203
v_mfma_f32_16x16x32_bf16 v[208:211], a[16:19], v[228:231], v[208:211]
v_cvt_pk_bf16_f32 v96, v204, v205
v_cvt_pk_bf16_f32 v97, v206, v207
v_mfma_f32_16x16x32_bf16 v[204:207], a[32:35], v[228:231], 0
v_exp_f32 v188, v188
v_mfma_f32_16x16x32_bf16 v[204:207], a[36:39], v[220:223], v[204:207]
v_exp_f32 v189, v189
v_mfma_f32_16x16x32_bf16 v[204:207], a[40:43], v[216:219], v[204:207]
s_nop 0
v_cvt_pk_bf16_f32 v98, v208, v209
v_cvt_pk_bf16_f32 v99, v210, v211
v_mfma_f32_16x16x32_bf16 v[204:207], a[44:47], v[196:199], v[204:207]
v_exp_f32 v190, v190
v_mfma_f32_16x16x32_bf16 v[192:195], a[60:63], v[196:199], 0
v_exp_f32 v191, v191
v_mfma_f32_16x16x32_bf16 v[192:195], a[56:59], v[216:219], v[192:195]
v_cvt_pk_bf16_f32 v104, v188, v189
v_cvt_pk_bf16_f32 v105, v190, v191
v_mfma_f32_16x16x32_bf16 v[192:195], a[52:55], v[220:223], v[192:195]
ds_read_b128 v[188:191], v242 offset:16896
v_cvt_pk_bf16_f32 v100, v204, v205
v_mfma_f32_16x16x32_bf16 v[192:195], a[48:51], v[228:231], v[192:195]
v_cvt_pk_bf16_f32 v101, v206, v207
v_cvt_pk_bf16_f32 v52, v224, v225
v_mfma_f32_16x16x32_bf16 v[152:155], a[192:195], v[228:231], 0
v_exp_f32 v212, v212
v_mfma_f32_16x16x32_bf16 v[152:155], a[196:199], v[220:223], v[152:155]
v_exp_f32 v213, v213
v_mfma_f32_16x16x32_bf16 v[152:155], a[200:203], v[216:219], v[152:155]
s_nop 0
v_cvt_pk_bf16_f32 v102, v192, v193
v_cvt_pk_bf16_f32 v103, v194, v195
v_mfma_f32_16x16x32_bf16 v[152:155], a[204:207], v[196:199], v[152:155]
v_exp_f32 v214, v214
v_mfma_f32_16x16x32_bf16 v[156:159], a[220:223], v[196:199], 0
v_exp_f32 v215, v215
v_mfma_f32_16x16x32_bf16 v[156:159], a[216:219], v[216:219], v[156:159]
v_cvt_pk_bf16_f32 v110, v212, v213
v_cvt_pk_bf16_f32 v111, v214, v215
v_mfma_f32_16x16x32_bf16 v[156:159], a[212:215], v[220:223], v[156:159]
ds_read_b128 v[192:195], v242 offset:4224
ds_read_b128 v[200:203], v242 offset:4480
v_mfma_f32_16x16x32_bf16 v[156:159], a[208:211], v[228:231], v[156:159]
buffer_load_dwordx4 v243, s[16:19], s99 offen offset:1056 nt lds
v_mfma_f32_16x16x32_bf16 v[160:163], a[224:227], v[228:231], 0
ds_read_b128 v[204:207], v242 offset:4736
ds_read_b128 v[212:215], v242 offset:17152
v_mfma_f32_16x16x32_bf16 v[160:163], a[228:231], v[220:223], v[160:163]
v_cvt_pk_bf16_f32 v53, v226, v227
v_cvt_pk_bf16_f32 v48, v232, v233
v_mfma_f32_16x16x32_bf16 v[160:163], a[232:235], v[216:219], v[160:163]
ds_read_b128 v[224:227], v242 offset:17408
v_cvt_pk_bf16_f32 v49, v234, v235
v_mfma_f32_16x16x32_bf16 v[160:163], a[236:239], v[196:199], v[160:163]
s_waitcnt lgkmcnt(5)
ds_read_b128 v[232:235], v242 offset:17664
v_mfma_f32_16x16x32_bf16 v[208:211], v[8:11], v[96:99], 0
s_waitcnt lgkmcnt(5)
v_mfma_f32_16x16x32_bf16 v[208:211], v[12:15], v[100:103], v[208:211]
s_nop 2
v_mfma_f32_16x16x32_bf16 v[164:167], a[252:255], v[196:199], 0
ds_read_b128 v[196:199], v242 offset:4992
s_nop 0
v_mfma_f32_16x16x32_bf16 v[164:167], a[248:251], v[216:219], v[164:167]
v_mov_b64 v[216:217], s[96:97]
v_mov_b64 v[218:219], s[96:97]
v_mfma_f32_16x16x32_bf16 v[164:167], a[244:247], v[220:223], v[164:167]
v_exp_f32 v208, v208
v_mfma_f32_16x16x32_bf16 v[164:167], a[240:243], v[228:231], v[164:167]
s_waitcnt lgkmcnt(1)
v_exp_f32 v209, v209
v_mfma_f32_16x16x32_bf16 v[220:223], v[4:7], v[100:103], 0
v_exp_f32 v210, v210
v_mfma_f32_16x16x32_bf16 v[220:223], v[0:3], v[96:99], v[220:223]
v_exp_f32 v211, v211
v_smfmac_f32_16x16x64_bf16 v[216:219], v[238:241], v[96:103], v251
v_cvt_pk_bf16_f32 v122, v208, v209
v_mfma_f32_16x16x32_bf16 v[228:231], v[192:195], a[128:131], 0
v_cvt_pk_bf16_f32 v123, v210, v211
s_nop 0
v_mfma_f32_16x16x32_bf16 v[228:231], v[200:203], a[132:135], v[228:231]
s_waitcnt lgkmcnt(0)
v_exp_f32 v220, v220
v_mfma_f32_16x16x32_bf16 v[228:231], v[204:207], a[136:139], v[228:231]
v_exp_f32 v221, v221
v_mfma_f32_16x16x32_bf16 v[228:231], v[196:199], a[140:143], v[228:231]
v_exp_f32 v222, v222
v_mfma_f32_16x16x32_bf16 v[208:211], v[196:199], a[156:159], 0
v_exp_f32 v223, v223
v_mfma_f32_16x16x32_bf16 v[208:211], v[204:207], a[152:155], v[208:211]
v_cvt_pk_bf16_f32 v120, v220, v221
v_cvt_pk_bf16_f32 v121, v222, v223
v_mfma_f32_16x16x32_bf16 v[208:211], v[200:203], a[148:151], v[208:211]
v_add_f32 v216, v216, v217
v_add_f32 v218, v218, v219
v_mfma_f32_16x16x32_bf16 v[208:211], v[192:195], a[144:147], v[208:211]
v_exp_f32 v216, v216
v_mfma_f32_16x16x32_bf16 v[220:223], v[192:195], a[160:163], 0
v_exp_f32 v218, v218
v_mfma_f32_16x16x32_bf16 v[220:223], v[200:203], a[164:167], v[220:223]
v_perm_b32 v132, v218, v216, v252
v_perm_b32 v133, v218, v216, v253
v_mfma_f32_16x16x32_bf16 v[220:223], v[204:207], a[168:171], v[220:223]
s_nop 0
v_cvt_pk_bf16_f32 v54, v208, v209
v_cvt_pk_bf16_f32 v55, v210, v211
v_mfma_f32_16x16x32_bf16 v[220:223], v[196:199], a[172:175], v[220:223]
buffer_load_dwordx4 v243, s[16:19], s100 offen offset:2112 nt lds
v_mfma_f32_16x16x32_bf16 v[208:211], v[196:199], a[188:191], 0
v_cvt_pk_bf16_f32 v50, v228, v229
v_cvt_pk_bf16_f32 v51, v230, v231
v_mfma_f32_16x16x32_bf16 v[208:211], v[204:207], a[184:187], v[208:211]
s_nop 1
v_mfma_f32_16x16x32_bf16 v[208:211], v[200:203], a[180:183], v[208:211]
v_cvt_pk_bf16_f32 v58, v220, v221
v_cvt_pk_bf16_f32 v59, v222, v223
v_mfma_f32_16x16x32_bf16 v[208:211], v[192:195], a[176:179], v[208:211]
s_nop 2
v_mfma_f32_16x16x32_bf16 v[192:195], v[16:19], v[96:99], 0
s_nop 2
v_mfma_f32_16x16x32_bf16 v[192:195], v[20:23], v[100:103], v[192:195]
v_mov_b64 v[196:197], 0
v_cvt_pk_bf16_f32 v62, v208, v209
v_mfma_f32_16x16x32_bf16 v[200:203], v[36:39], v[100:103], 0
v_cvt_pk_bf16_f32 v63, v210, v211
s_nop 0
v_mfma_f32_16x16x32_bf16 v[200:203], v[32:35], v[96:99], v[200:203]
s_nop 2
v_mfma_f32_16x16x32_bf16 v[204:207], v[24:27], v[96:99], 0
v_exp_f32 v192, v192
v_mfma_f32_16x16x32_bf16 v[204:207], v[28:31], v[100:103], v[204:207]
v_exp_f32 v193, v193
v_smfmac_f32_16x16x64_bf16 v[196:199], v[184:187], v[104:111], v251
v_cvt_pk_bf16_f32 v124, v192, v193
v_smfmac_f32_16x16x64_bf16 v[196:199], v[184:187], v[112:119], v251 abid:1
s_nop 2
v_mfma_f32_16x16x32_bf16 v[208:211], v[232:235], a[188:191], 0
v_exp_f32 v194, v194
v_mfma_f32_16x16x32_bf16 v[208:211], v[224:227], a[184:187], v[208:211]
v_exp_f32 v195, v195
v_mfma_f32_16x16x32_bf16 v[208:211], v[212:215], a[180:183], v[208:211]
v_cvt_pk_bf16_f32 v125, v194, v195
v_add_f32 v196, v196, v197
v_mfma_f32_16x16x32_bf16 v[208:211], v[188:191], a[176:179], v[208:211]
v_exp_f32 v204, v204
v_mfma_f32_16x16x32_bf16 v[192:195], v[188:191], a[160:163], 0
v_exp_f32 v205, v205
v_mfma_f32_16x16x32_bf16 v[192:195], v[212:215], a[164:167], v[192:195]
v_exp_f32 v206, v206
v_mfma_f32_16x16x32_bf16 v[192:195], v[224:227], a[168:171], v[192:195]
v_exp_f32 v207, v207
v_mfma_f32_16x16x32_bf16 v[192:195], v[232:235], a[172:175], v[192:195]
buffer_load_dwordx4 v243, s[16:19], s101 offen offset:3168 nt lds
v_mfma_f32_16x16x32_bf16 v[216:219], v[232:235], a[156:159], 0
s_mov_b32 m0, s58
v_cvt_pk_bf16_f32 v126, v204, v205
v_cvt_pk_bf16_f32 v127, v206, v207
v_mfma_f32_16x16x32_bf16 v[216:219], v[224:227], a[152:155], v[216:219]
v_cvt_pk_bf16_f32 v92, v208, v209
v_cvt_pk_bf16_f32 v93, v210, v211
v_mfma_f32_16x16x32_bf16 v[216:219], v[212:215], a[148:151], v[216:219]
v_cvt_pk_bf16_f32 v88, v192, v193
v_cvt_pk_bf16_f32 v89, v194, v195
v_mfma_f32_16x16x32_bf16 v[216:219], v[188:191], a[144:147], v[216:219]
v_rcp_f32 v254, v196
v_mfma_f32_16x16x32_bf16 v[192:195], v[188:191], a[128:131], 0
v_max3_f32 v255, v255, v196, v254
s_nop 0
v_mfma_f32_16x16x32_bf16 v[192:195], v[212:215], a[132:135], v[192:195]
v_exp_f32 v200, v200
v_mfma_f32_16x16x32_bf16 v[192:195], v[224:227], a[136:139], v[192:195]
s_nop 0
v_cvt_pk_bf16_f32 v84, v216, v217
v_cvt_pk_bf16_f32 v85, v218, v219
v_mfma_f32_16x16x32_bf16 v[192:195], v[232:235], a[140:143], v[192:195]
L_h2:
s_cbranch_execz L_ret
v_exp_f32 v201, v201
v_mfma_f32_16x16x32_bf16 v[204:207], v[40:43], v[96:99], 0
ds_read_b128 v[208:211], v249 offset:0
ds_read_b128 v[216:219], v249 offset:272
v_mfma_f32_16x16x32_bf16 v[204:207], v[44:47], v[100:103], v[204:207]
ds_read_b128 v[220:223], v249 offset:544
v_cvt_pk_bf16_f32 v128, v200, v201
v_mfma_f32_16x16x32_bf16 v[168:171], v[48:51], v[104:107], v[168:171]
v_cvt_pk_bf16_f32 v80, v192, v193
v_cvt_pk_bf16_f32 v81, v194, v195
v_mfma_f32_16x16x32_bf16 v[168:171], v[64:67], v[108:111], v[168:171]
v_exp_f32 v202, v202
v_mfma_f32_16x16x32_bf16 v[168:171], v[80:83], v[112:115], v[168:171]
v_exp_f32 v203, v203
v_mfma_f32_16x16x32_bf16 v[172:175], v[84:87], v[112:115], v[172:175]
v_cvt_pk_bf16_f32 v129, v202, v203
s_nop 0
v_mfma_f32_16x16x32_bf16 v[172:175], v[52:55], v[104:107], v[172:175]
v_exp_f32 v204, v204
v_mfma_f32_16x16x32_bf16 v[172:175], v[68:71], v[108:111], v[172:175]
v_exp_f32 v205, v205
v_mfma_f32_16x16x32_bf16 v[176:179], v[72:75], v[108:111], v[176:179]
v_exp_f32 v206, v206
v_mfma_f32_16x16x32_bf16 v[176:179], v[88:91], v[112:115], v[176:179]
v_exp_f32 v207, v207
v_mfma_f32_16x16x32_bf16 v[176:179], v[56:59], v[104:107], v[176:179]
v_cvt_pk_bf16_f32 v130, v204, v205
v_cvt_pk_bf16_f32 v131, v206, v207
L_entryf:
v_mfma_f32_16x16x32_bf16 v[180:183], v[60:63], v[104:107], v[180:183]
v_fmac_f32 v136, v168, v254
v_fmac_f32 v137, v169, v254
v_mfma_f32_16x16x32_bf16 v[180:183], v[76:79], v[108:111], v[180:183]
v_fmac_f32 v138, v170, v254
v_fmac_f32 v139, v171, v254
v_mfma_f32_16x16x32_bf16 v[180:183], v[92:95], v[112:115], v[180:183]
s_waitcnt lgkmcnt(1)
v_fmac_f32 v144, v176, v254
v_fmac_f32 v145, v177, v254
v_mfma_f32_16x16x32_bf16 v[192:195], a[0:3], v[188:191], 0
s_waitcnt lgkmcnt(0)
v_fmac_f32 v146, v178, v254
v_fmac_f32 v147, v179, v254
v_mfma_f32_16x16x32_bf16 v[192:195], a[4:7], v[212:215], v[192:195]
s_mov_b64 vcc, s[14:15]
v_cvt_pk_bf16_f32 v144, v144, v145
v_fmac_f32 v148, v180, v254
v_mfma_f32_16x16x32_bf16 v[192:195], a[8:11], v[224:227], v[192:195]
v_fmac_f32 v149, v181, v254
v_fmac_f32 v150, v182, v254
v_mfma_f32_16x16x32_bf16 v[192:195], a[12:15], v[232:235], v[192:195]
v_fmac_f32 v151, v183, v254
v_cvt_pk_bf16_f32 v145, v146, v147
v_mfma_f32_16x16x32_bf16 v[196:199], a[28:31], v[232:235], 0
v_cvt_pk_bf16_f32 v146, v148, v149
v_cvt_pk_bf16_f32 v147, v150, v151
v_mfma_f32_16x16x32_bf16 v[196:199], a[24:27], v[224:227], v[196:199]
v_cvt_pk_bf16_f32 v136, v136, v137
v_fmac_f32 v140, v172, v254
v_mfma_f32_16x16x32_bf16 v[196:199], a[20:23], v[212:215], v[196:199]
v_cvt_pk_bf16_f32 v96, v192, v193
v_cvt_pk_bf16_f32 v97, v194, v195
v_mfma_f32_16x16x32_bf16 v[196:199], a[16:19], v[188:191], v[196:199]
v_fmac_f32 v141, v173, v254
v_fmac_f32 v142, v174, v254
v_mfma_f32_16x16x32_bf16 v[192:195], a[32:35], v[188:191], 0
v_fmac_f32 v143, v175, v254
v_cvt_pk_bf16_f32 v137, v138, v139
v_mfma_f32_16x16x32_bf16 v[192:195], a[36:39], v[212:215], v[192:195]
v_cvt_pk_bf16_f32 v138, v140, v141
v_cvt_pk_bf16_f32 v139, v142, v143
v_mfma_f32_16x16x32_bf16 v[192:195], a[40:43], v[224:227], v[192:195]
v_cvt_pk_bf16_f32 v98, v196, v197
v_cvt_pk_bf16_f32 v99, v198, v199
v_mfma_f32_16x16x32_bf16 v[192:195], a[44:47], v[232:235], v[192:195]
v_mov_b64 v[196:197], 0
v_mov_b64 v[198:199], 0
v_mfma_f32_16x16x32_bf16 v[200:203], a[60:63], v[232:235], 0
v_pk_max_i16 v136, v136, 0
v_pk_max_i16 v137, v137, 0
v_mfma_f32_16x16x32_bf16 v[200:203], a[56:59], v[224:227], v[200:203]
v_pk_max_i16 v138, v138, 0
v_pk_max_i16 v139, v139, 0
v_mfma_f32_16x16x32_bf16 v[200:203], a[52:55], v[212:215], v[200:203]
v_mov_b64 v[204:205], 0
v_mov_b64 v[206:207], 0
v_mfma_f32_16x16x32_bf16 v[200:203], a[48:51], v[188:191], v[200:203]
v_cvt_pk_bf16_f32 v100, v192, v193
v_cvt_pk_bf16_f32 v101, v194, v195
v_smfmac_f32_16x16x64_bf16 v[196:199], v[208:211], v[48:55], v251
v_pk_max_i16 v144, v144, 0
v_smfmac_f32_16x16x64_bf16 v[196:199], v[216:219], v[64:71], v251
v_pk_max_i16 v145, v145, 0
v_smfmac_f32_16x16x64_bf16 v[196:199], v[220:223], v[80:87], v251
s_nop 0
v_cvt_pk_bf16_f32 v102, v200, v201
v_smfmac_f32_16x16x64_bf16 v[204:207], v[220:223], v[88:95], v251
v_cvt_pk_bf16_f32 v103, v202, v203
v_smfmac_f32_16x16x64_bf16 v[204:207], v[216:219], v[72:79], v251
v_mov_b64 v[192:193], s[96:97]
v_smfmac_f32_16x16x64_bf16 v[204:207], v[208:211], v[56:63], v251
v_mov_b64 v[194:195], s[96:97]
v_mfma_f32_16x16x32_bf16 v[200:203], v[4:7], v[100:103], 0
v_pk_max_i16 v146, v146, 0
v_pk_max_i16 v147, v147, 0
v_mfma_f32_16x16x32_bf16 v[200:203], v[0:3], v[96:99], v[200:203]
v_cndmask_b32_dpp v140, v144, v136, vcc quad_perm:[1,0,3,2] row_mask:0xf bank_mask:0xf
v_cndmask_b32_dpp v141, v145, v137, vcc quad_perm:[1,0,3,2] row_mask:0xf bank_mask:0xf
v_smfmac_f32_16x16x64_bf16 v[192:195], v[238:241], v[96:103], v251
v_cndmask_b32_dpp v142, v146, v138, vcc quad_perm:[1,0,3,2] row_mask:0xf bank_mask:0xf
v_mfma_f32_16x16x32_bf16 v[208:211], v[16:19], v[96:99], 0
v_cndmask_b32_dpp v143, v147, v139, vcc quad_perm:[1,0,3,2] row_mask:0xf bank_mask:0xf
v_add_f32 v196, v196, v197
v_mfma_f32_16x16x32_bf16 v[208:211], v[20:23], v[100:103], v[208:211]
s_not_b64 vcc, vcc
ds_write_b32 v250, v196 offset:0
v_mfma_f32_16x16x32_bf16 v[216:219], v[12:15], v[100:103], 0
v_cndmask_b32_dpp v144, v136, v144, vcc quad_perm:[1,0,3,2] row_mask:0xf bank_mask:0xf
v_cndmask_b32_dpp v145, v137, v145, vcc quad_perm:[1,0,3,2] row_mask:0xf bank_mask:0xf
v_mfma_f32_16x16x32_bf16 v[216:219], v[8:11], v[96:99], v[216:219]
v_cndmask_b32_dpp v146, v138, v146, vcc quad_perm:[1,0,3,2] row_mask:0xf bank_mask:0xf
v_cndmask_b32_dpp v147, v139, v147, vcc quad_perm:[1,0,3,2] row_mask:0xf bank_mask:0xf
v_mfma_f32_16x16x32_bf16 v[220:223], v[24:27], v[96:99], 0
v_add_f32 v198, v198, v199
v_add_f32 v192, v192, v193
v_mfma_f32_16x16x32_bf16 v[220:223], v[28:31], v[100:103], v[220:223]
ds_write_b32 v250, v198 offset:64
v_mfma_f32_32x32x16_bf16 v[168:183], v[236:239], v[132:135], 0
buffer_store_dwordx4 v[140:143], v244, s[20:23], s52 offen offset:0 nt
buffer_store_dwordx4 v[144:147], v244, s[20:23], s52 offen offset:256 nt
v_exp_f32 v200, v200
v_exp_f32 v201, v201
v_mfma_f32_16x16x32_bf16 v[136:139], a[192:195], v[188:191], 0
s_add_u32 s52, s46, 16384
v_exp_f32 v202, v202
v_mfma_f32_16x16x32_bf16 v[136:139], a[196:199], v[212:215], v[136:139]
v_exp_f32 v203, v203
v_mfma_f32_16x16x32_bf16 v[136:139], a[200:203], v[224:227], v[136:139]
v_exp_f32 v216, v216
v_mfma_f32_16x16x32_bf16 v[136:139], a[204:207], v[232:235], v[136:139]
v_exp_f32 v217, v217
v_mfma_f32_16x16x32_bf16 v[140:143], a[220:223], v[232:235], 0
v_exp_f32 v218, v218
v_mfma_f32_16x16x32_bf16 v[140:143], a[216:219], v[224:227], v[140:143]
v_exp_f32 v219, v219
v_mfma_f32_16x16x32_bf16 v[140:143], a[212:215], v[212:215], v[140:143]
v_cvt_pk_bf16_f32 v104, v200, v201
v_cvt_pk_bf16_f32 v105, v202, v203
v_mfma_f32_16x16x32_bf16 v[140:143], a[208:211], v[188:191], v[140:143]
v_cvt_pk_bf16_f32 v106, v216, v217
v_cvt_pk_bf16_f32 v107, v218, v219
v_mfma_f32_16x16x32_bf16 v[144:147], a[224:227], v[188:191], 0
v_add_f32 v194, v194, v195
v_add_f32 v204, v204, v205
v_mfma_f32_16x16x32_bf16 v[144:147], a[228:231], v[212:215], v[144:147]
ds_write_b32 v250, v204 offset:128
v_mfma_f32_16x16x32_bf16 v[144:147], a[232:235], v[224:227], v[144:147]
v_exp_f32 v192, v192
v_mfma_f32_16x16x32_bf16 v[144:147], a[236:239], v[232:235], v[144:147]
v_exp_f32 v194, v194
v_mfma_f32_16x16x32_bf16 v[148:151], a[252:255], v[232:235], 0
v_perm_b32 v116, v194, v192, v252
v_perm_b32 v117, v194, v192, v253
v_mfma_f32_16x16x32_bf16 v[148:151], a[248:251], v[224:227], v[148:151]
v_mov_b64 v[196:197], 0
v_add_f32 v206, v206, v207
v_mfma_f32_16x16x32_bf16 v[148:151], a[244:247], v[212:215], v[148:151]
ds_write_b32 v250, v206 offset:192
v_mfma_f32_16x16x32_bf16 v[148:151], a[240:243], v[188:191], v[148:151]
v_exp_f32 v220, v220
v_mfma_f32_16x16x32_bf16 v[188:191], v[40:43], v[96:99], 0
v_exp_f32 v221, v221
v_mfma_f32_16x16x32_bf16 v[188:191], v[44:47], v[100:103], v[188:191]
v_exp_f32 v222, v222
v_smfmac_f32_16x16x64_bf16 v[196:199], v[184:187], v[120:127], v251
ds_read_b128 v[200:203], v242 offset:4224
v_cvt_pk_bf16_f32 v110, v220, v221
v_smfmac_f32_16x16x64_bf16 v[196:199], v[184:187], v[128:135], v251 abid:1
ds_read_b128 v[212:215], v242 offset:4736
ds_read_b128 v[216:219], v242 offset:4992
v_mfma_f32_16x16x32_bf16 v[168:171], v[80:83], v[128:131], v[168:171]
v_exp_f32 v223, v223
v_mfma_f32_16x16x32_bf16 v[168:171], v[64:67], v[124:127], v[168:171]
v_cvt_pk_bf16_f32 v111, v222, v223
v_add_u32 v250, 1728, v250
v_mfma_f32_16x16x32_bf16 v[168:171], v[48:51], v[120:123], v[168:171]
v_exp_f32 v208, v208
v_mfma_f32_16x16x32_bf16 v[172:175], v[52:55], v[120:123], v[172:175]
v_exp_f32 v209, v209
v_mfma_f32_16x16x32_bf16 v[172:175], v[68:71], v[124:127], v[172:175]
v_exp_f32 v210, v210
v_mfma_f32_16x16x32_bf16 v[172:175], v[84:87], v[128:131], v[172:175]
v_exp_f32 v211, v211
v_mfma_f32_16x16x32_bf16 v[176:179], v[88:91], v[128:131], v[176:179]
v_cvt_pk_bf16_f32 v108, v208, v209
v_cvt_pk_bf16_f32 v109, v210, v211
v_mfma_f32_16x16x32_bf16 v[176:179], v[72:75], v[124:127], v[176:179]
ds_read_b128 v[208:211], v242 offset:4480
v_add_f32 v196, v196, v197
v_mfma_f32_16x16x32_bf16 v[176:179], v[56:59], v[120:123], v[176:179]
v_rcp_f32 v254, v196
v_mfma_f32_16x16x32_bf16 v[180:183], v[60:63], v[120:123], v[180:183]
v_max3_f32 v255, v255, v196, v254
v_fmac_f32 v152, v168, v254
v_mfma_f32_16x16x32_bf16 v[180:183], v[76:79], v[124:127], v[180:183]
v_fmac_f32 v153, v169, v254
v_fmac_f32 v154, v170, v254
v_mfma_f32_16x16x32_bf16 v[180:183], v[92:95], v[128:131], v[180:183]
s_waitcnt lgkmcnt(3)
v_fmac_f32 v160, v176, v254
v_fmac_f32 v161, v177, v254
v_mfma_f32_16x16x32_bf16 v[192:195], v[32:35], v[96:99], 0
s_waitcnt lgkmcnt(1)
v_fmac_f32 v155, v171, v254
v_cvt_pk_bf16_f32 v152, v152, v153
v_mfma_f32_16x16x32_bf16 v[192:195], v[36:39], v[100:103], v[192:195]
s_waitcnt lgkmcnt(0)
v_fmac_f32 v162, v178, v254
v_fmac_f32 v163, v179, v254
v_mfma_f32_16x16x32_bf16 v[220:223], a[0:3], v[200:203], 0
s_mov_b64 vcc, s[14:15]
v_cvt_pk_bf16_f32 v160, v160, v161
v_fmac_f32 v156, v172, v254
v_mfma_f32_16x16x32_bf16 v[220:223], a[4:7], v[208:211], v[220:223]
v_fmac_f32 v157, v173, v254
v_fmac_f32 v158, v174, v254
v_mfma_f32_16x16x32_bf16 v[220:223], a[8:11], v[212:215], v[220:223]
v_fmac_f32 v159, v175, v254
v_cvt_pk_bf16_f32 v153, v154, v155
v_mfma_f32_16x16x32_bf16 v[220:223], a[12:15], v[216:219], v[220:223]
v_fmac_f32 v164, v180, v254
v_fmac_f32 v165, v181, v254
v_mfma_f32_16x16x32_bf16 v[224:227], a[28:31], v[216:219], 0
v_fmac_f32 v166, v182, v254
v_fmac_f32 v167, v183, v254
v_mfma_f32_16x16x32_bf16 v[224:227], a[24:27], v[212:215], v[224:227]
v_cvt_pk_bf16_f32 v161, v162, v163
v_cvt_pk_bf16_f32 v154, v156, v157
v_mfma_f32_16x16x32_bf16 v[224:227], a[20:23], v[208:211], v[224:227]
v_cvt_pk_bf16_f32 v155, v158, v159
v_cvt_pk_bf16_f32 v162, v164, v165
v_mfma_f32_16x16x32_bf16 v[224:227], a[16:19], v[200:203], v[224:227]
v_cvt_pk_bf16_f32 v163, v166, v167
v_pk_max_i16 v152, v152, 0
v_mfma_f32_16x16x32_bf16 v[228:231], a[32:35], v[200:203], 0
v_pk_max_i16 v153, v153, 0
v_pk_max_i16 v154, v154, 0
v_mfma_f32_16x16x32_bf16 v[228:231], a[36:39], v[208:211], v[228:231]
v_pk_max_i16 v155, v155, 0
v_pk_max_i16 v160, v160, 0
v_mfma_f32_16x16x32_bf16 v[228:231], a[40:43], v[212:215], v[228:231]
v_pk_max_i16 v161, v161, 0
v_pk_max_i16 v162, v162, 0
v_mfma_f32_16x16x32_bf16 v[228:231], a[44:47], v[216:219], v[228:231]
v_pk_max_i16 v163, v163, 0
v_cndmask_b32_dpp v156, v160, v152, vcc quad_perm:[1,0,3,2] row_mask:0xf bank_mask:0xf
v_mfma_f32_16x16x32_bf16 v[196:199], a[60:63], v[216:219], 0
v_cndmask_b32_dpp v157, v161, v153, vcc quad_perm:[1,0,3,2] row_mask:0xf bank_mask:0xf
v_cndmask_b32_dpp v158, v162, v154, vcc quad_perm:[1,0,3,2] row_mask:0xf bank_mask:0xf
v_mfma_f32_16x16x32_bf16 v[196:199], a[56:59], v[212:215], v[196:199]
v_cndmask_b32_dpp v159, v163, v155, vcc quad_perm:[1,0,3,2] row_mask:0xf bank_mask:0xf
v_cvt_pk_bf16_f32 v96, v220, v221
v_mfma_f32_16x16x32_bf16 v[196:199], a[52:55], v[208:211], v[196:199]
s_not_b64 vcc, vcc
v_cndmask_b32_dpp v160, v152, v160, vcc quad_perm:[1,0,3,2] row_mask:0xf bank_mask:0xf
v_cndmask_b32_dpp v161, v153, v161, vcc quad_perm:[1,0,3,2] row_mask:0xf bank_mask:0xf
v_mfma_f32_16x16x32_bf16 v[196:199], a[48:51], v[200:203], v[196:199]
v_cndmask_b32_dpp v162, v154, v162, vcc quad_perm:[1,0,3,2] row_mask:0xf bank_mask:0xf
v_cndmask_b32_dpp v163, v155, v163, vcc quad_perm:[1,0,3,2] row_mask:0xf bank_mask:0xf
v_mfma_f32_32x32x16_bf16 v[168:183], v[236:239], v[116:119], 0
buffer_store_dwordx4 v[156:159], v244, s[20:23], s53 offen offset:0 nt
buffer_store_dwordx4 v[160:163], v244, s[20:23], s53 offen offset:256 nt
v_cvt_pk_bf16_f32 v100, v228, v229
v_cvt_pk_bf16_f32 v101, v230, v231
v_exp_f32 v188, v188
v_mfma_f32_16x16x32_bf16 v[152:155], a[192:195], v[200:203], 0
s_add_u32 s53, s46, 4096
v_cvt_pk_bf16_f32 v102, v196, v197
v_cvt_pk_bf16_f32 v103, v198, v199
v_mfma_f32_16x16x32_bf16 v[152:155], a[196:199], v[208:211], v[152:155]
s_add_u32 s46, s46, 13107200
v_exp_f32 v189, v189
v_mfma_f32_16x16x32_bf16 v[152:155], a[200:203], v[212:215], v[152:155]
v_exp_f32 v190, v190
v_mfma_f32_16x16x32_bf16 v[152:155], a[204:207], v[216:219], v[152:155]
v_exp_f32 v191, v191
v_mfma_f32_16x16x32_bf16 v[156:159], a[220:223], v[216:219], 0
v_cvt_pk_bf16_f32 v114, v188, v189
v_cvt_pk_bf16_f32 v115, v190, v191
v_mfma_f32_16x16x32_bf16 v[156:159], a[216:219], v[212:215], v[156:159]
v_cvt_pk_bf16_f32 v97, v222, v223
v_cvt_pk_bf16_f32 v98, v224, v225
v_mfma_f32_16x16x32_bf16 v[156:159], a[212:215], v[208:211], v[156:159]
v_cvt_pk_bf16_f32 v99, v226, v227
v_mfma_f32_16x16x32_bf16 v[156:159], a[208:211], v[200:203], v[156:159]
v_exp_f32 v192, v192
v_mfma_f32_16x16x32_bf16 v[160:163], a[224:227], v[200:203], 0
v_exp_f32 v193, v193
v_mfma_f32_16x16x32_bf16 v[160:163], a[228:231], v[208:211], v[160:163]
v_exp_f32 v194, v194
v_mfma_f32_16x16x32_bf16 v[160:163], a[232:235], v[212:215], v[160:163]
v_exp_f32 v195, v195
v_mfma_f32_16x16x32_bf16 v[160:163], a[236:239], v[216:219], v[160:163]
v_cvt_pk_bf16_f32 v112, v192, v193
v_cvt_pk_bf16_f32 v113, v194, v195
v_mfma_f32_16x16x32_bf16 v[188:191], v[36:39], v[100:103], 0
ds_read_b128 v[192:195], v242 offset:8448
ds_read_b128 v[204:207], v242 offset:8704
v_mfma_f32_16x16x32_bf16 v[188:191], v[32:35], v[96:99], v[188:191]
ds_read_b128 v[220:223], v242 offset:8960
ds_read_b128 v[196:199], v242 offset:9216
v_mfma_f32_16x16x32_bf16 v[224:227], v[8:11], v[96:99], 0
s_nop 2
v_mfma_f32_16x16x32_bf16 v[224:227], v[12:15], v[100:103], v[224:227]
v_mov_b64 v[228:229], 0
s_nop 0
v_mfma_f32_16x16x32_bf16 v[164:167], a[252:255], v[216:219], 0
v_exp_f32 v188, v188
v_mfma_f32_16x16x32_bf16 v[164:167], a[248:251], v[212:215], v[164:167]
v_exp_f32 v189, v189
v_mfma_f32_16x16x32_bf16 v[164:167], a[244:247], v[208:211], v[164:167]
s_waitcnt lgkmcnt(3)
v_exp_f32 v224, v224
v_mfma_f32_16x16x32_bf16 v[164:167], a[240:243], v[200:203], v[164:167]
v_mov_b64 v[200:201], s[96:97]
v_mov_b64 v[202:203], s[96:97]
v_smfmac_f32_16x16x64_bf16 v[228:231], v[184:187], v[104:111], v251
v_cvt_pk_bf16_f32 v128, v188, v189
v_smfmac_f32_16x16x64_bf16 v[228:231], v[184:187], v[112:119], v251 abid:1
s_nop 2
v_mfma_f32_16x16x32_bf16 v[208:211], v[4:7], v[100:103], 0
v_exp_f32 v225, v225
v_mfma_f32_16x16x32_bf16 v[208:211], v[0:3], v[96:99], v[208:211]
v_exp_f32 v226, v226
v_smfmac_f32_16x16x64_bf16 v[200:203], v[238:241], v[96:103], v251
v_add_f32 v228, v228, v229
v_mfma_f32_16x16x32_bf16 v[168:171], v[48:51], v[104:107], v[168:171]
s_waitcnt lgkmcnt(2)
v_rcp_f32 v254, v228
v_mfma_f32_16x16x32_bf16 v[168:171], v[64:67], v[108:111], v[168:171]
s_waitcnt lgkmcnt(0)
v_max3_f32 v255, v255, v228, v254
v_cvt_pk_bf16_f32 v122, v224, v225
v_mfma_f32_16x16x32_bf16 v[168:171], v[80:83], v[112:115], v[168:171]
v_add_f32 v200, v200, v201
v_add_f32 v202, v202, v203
v_mfma_f32_16x16x32_bf16 v[212:215], v[24:27], v[96:99], 0
v_exp_f32 v200, v200
v_mfma_f32_16x16x32_bf16 v[212:215], v[28:31], v[100:103], v[212:215]
v_exp_f32 v202, v202
v_mfma_f32_16x16x32_bf16 v[216:219], v[44:47], v[100:103], 0
v_perm_b32 v132, v202, v200, v252
v_perm_b32 v133, v202, v200, v253
v_mfma_f32_16x16x32_bf16 v[216:219], v[40:43], v[96:99], v[216:219]
v_exp_f32 v227, v227
v_mfma_f32_16x16x32_bf16 v[228:231], v[16:19], v[96:99], 0
v_cvt_pk_bf16_f32 v123, v226, v227
v_fmac_f32 v136, v168, v254
v_mfma_f32_16x16x32_bf16 v[228:231], v[20:23], v[100:103], v[228:231]
v_exp_f32 v208, v208
v_mfma_f32_16x16x32_bf16 v[172:175], v[52:55], v[104:107], v[172:175]
v_exp_f32 v209, v209
v_mfma_f32_16x16x32_bf16 v[172:175], v[68:71], v[108:111], v[172:175]
v_exp_f32 v210, v210
v_mfma_f32_16x16x32_bf16 v[172:175], v[84:87], v[112:115], v[172:175]
v_exp_f32 v211, v211
v_mfma_f32_16x16x32_bf16 v[176:179], v[88:91], v[112:115], v[176:179]
v_cvt_pk_bf16_f32 v120, v208, v209
v_cvt_pk_bf16_f32 v121, v210, v211
v_mfma_f32_16x16x32_bf16 v[176:179], v[72:75], v[108:111], v[176:179]
v_fmac_f32 v137, v169, v254
v_fmac_f32 v138, v170, v254
v_mfma_f32_16x16x32_bf16 v[176:179], v[56:59], v[104:107], v[176:179]
v_fmac_f32 v139, v171, v254
v_cvt_pk_bf16_f32 v136, v136, v137
v_mfma_f32_16x16x32_bf16 v[180:183], v[60:63], v[104:107], v[180:183]
v_cvt_pk_bf16_f32 v137, v138, v139
v_fmac_f32 v140, v172, v254
v_mfma_f32_16x16x32_bf16 v[180:183], v[76:79], v[108:111], v[180:183]
v_fmac_f32 v141, v173, v254
v_fmac_f32 v142, v174, v254
v_mfma_f32_16x16x32_bf16 v[180:183], v[92:95], v[112:115], v[180:183]
s_mov_b64 vcc, s[14:15]
v_fmac_f32 v144, v176, v254
v_fmac_f32 v145, v177, v254
v_mfma_f32_16x16x32_bf16 v[200:203], a[0:3], v[192:195], 0
v_fmac_f32 v146, v178, v254
v_fmac_f32 v147, v179, v254
v_mfma_f32_16x16x32_bf16 v[200:203], a[4:7], v[204:207], v[200:203]
v_cvt_pk_bf16_f32 v144, v144, v145
v_fmac_f32 v143, v175, v254
v_mfma_f32_16x16x32_bf16 v[200:203], a[8:11], v[220:223], v[200:203]
v_fmac_f32 v148, v180, v254
v_fmac_f32 v149, v181, v254
v_mfma_f32_16x16x32_bf16 v[200:203], a[12:15], v[196:199], v[200:203]
v_fmac_f32 v150, v182, v254
v_fmac_f32 v151, v183, v254
v_mfma_f32_16x16x32_bf16 v[224:227], a[28:31], v[196:199], 0
v_cvt_pk_bf16_f32 v145, v146, v147
v_cvt_pk_bf16_f32 v138, v140, v141
v_mfma_f32_16x16x32_bf16 v[224:227], a[24:27], v[220:223], v[224:227]
v_cvt_pk_bf16_f32 v139, v142, v143
v_cvt_pk_bf16_f32 v146, v148, v149
v_mfma_f32_16x16x32_bf16 v[224:227], a[20:23], v[204:207], v[224:227]
v_cvt_pk_bf16_f32 v96, v200, v201
v_cvt_pk_bf16_f32 v97, v202, v203
v_mfma_f32_16x16x32_bf16 v[224:227], a[16:19], v[192:195], v[224:227]
v_cvt_pk_bf16_f32 v147, v150, v151
v_pk_max_i16 v136, v136, 0
v_mfma_f32_16x16x32_bf16 v[200:203], a[32:35], v[192:195], 0
v_pk_max_i16 v137, v137, 0
v_pk_max_i16 v138, v138, 0
v_mfma_f32_16x16x32_bf16 v[200:203], a[36:39], v[204:207], v[200:203]
v_pk_max_i16 v139, v139, 0
v_pk_max_i16 v144, v144, 0
v_mfma_f32_16x16x32_bf16 v[200:203], a[40:43], v[220:223], v[200:203]
v_pk_max_i16 v145, v145, 0
v_pk_max_i16 v146, v146, 0
v_mfma_f32_16x16x32_bf16 v[200:203], a[44:47], v[196:199], v[200:203]
v_pk_max_i16 v147, v147, 0
v_cndmask_b32_dpp v140, v144, v136, vcc quad_perm:[1,0,3,2] row_mask:0xf bank_mask:0xf
v_mfma_f32_16x16x32_bf16 v[208:211], a[60:63], v[196:199], 0
v_cndmask_b32_dpp v141, v145, v137, vcc quad_perm:[1,0,3,2] row_mask:0xf bank_mask:0xf
v_cndmask_b32_dpp v142, v146, v138, vcc quad_perm:[1,0,3,2] row_mask:0xf bank_mask:0xf
v_mfma_f32_16x16x32_bf16 v[208:211], a[56:59], v[220:223], v[208:211]
v_cndmask_b32_dpp v143, v147, v139, vcc quad_perm:[1,0,3,2] row_mask:0xf bank_mask:0xf
v_cvt_pk_bf16_f32 v98, v224, v225
v_mfma_f32_16x16x32_bf16 v[208:211], a[52:55], v[204:207], v[208:211]
s_not_b64 vcc, vcc
v_cndmask_b32_dpp v144, v136, v144, vcc quad_perm:[1,0,3,2] row_mask:0xf bank_mask:0xf
v_cndmask_b32_dpp v145, v137, v145, vcc quad_perm:[1,0,3,2] row_mask:0xf bank_mask:0xf
v_mfma_f32_16x16x32_bf16 v[208:211], a[48:51], v[192:195], v[208:211]
v_cndmask_b32_dpp v146, v138, v146, vcc quad_perm:[1,0,3,2] row_mask:0xf bank_mask:0xf
v_cndmask_b32_dpp v147, v139, v147, vcc quad_perm:[1,0,3,2] row_mask:0xf bank_mask:0xf
v_mfma_f32_32x32x16_bf16 v[168:183], v[236:239], v[132:135], 0
buffer_store_dwordx4 v[140:143], v244, s[20:23], s52 offen offset:0 nt
buffer_store_dwordx4 v[144:147], v244, s[20:23], s52 offen offset:256 nt
v_cvt_pk_bf16_f32 v100, v200, v201
v_cvt_pk_bf16_f32 v101, v202, v203
v_cvt_pk_bf16_f32 v99, v226, v227
v_cvt_pk_bf16_f32 v102, v208, v209
v_mfma_f32_16x16x32_bf16 v[136:139], a[192:195], v[192:195], 0
v_cvt_pk_bf16_f32 v103, v210, v211
v_mfma_f32_16x16x32_bf16 v[136:139], a[196:199], v[204:207], v[136:139]
v_exp_f32 v212, v212
v_mfma_f32_16x16x32_bf16 v[136:139], a[200:203], v[220:223], v[136:139]
v_exp_f32 v213, v213
v_mfma_f32_16x16x32_bf16 v[136:139], a[204:207], v[196:199], v[136:139]
v_exp_f32 v214, v214
v_mfma_f32_16x16x32_bf16 v[140:143], a[220:223], v[196:199], 0
v_exp_f32 v215, v215
v_mfma_f32_16x16x32_bf16 v[140:143], a[216:219], v[220:223], v[140:143]
v_exp_f32 v228, v228
v_mfma_f32_16x16x32_bf16 v[140:143], a[212:215], v[204:207], v[140:143]
v_exp_f32 v229, v229
v_mfma_f32_16x16x32_bf16 v[140:143], a[208:211], v[192:195], v[140:143]
v_exp_f32 v230, v230
v_mfma_f32_16x16x32_bf16 v[144:147], a[224:227], v[192:195], 0
v_exp_f32 v231, v231
v_mfma_f32_16x16x32_bf16 v[144:147], a[228:231], v[204:207], v[144:147]
v_cvt_pk_bf16_f32 v126, v212, v213
v_cvt_pk_bf16_f32 v127, v214, v215
v_mfma_f32_16x16x32_bf16 v[144:147], a[232:235], v[220:223], v[144:147]
v_cvt_pk_bf16_f32 v124, v228, v229
v_cvt_pk_bf16_f32 v125, v230, v231
v_mfma_f32_16x16x32_bf16 v[144:147], a[236:239], v[196:199], v[144:147]
v_mov_b64 v[200:201], s[96:97]
v_mov_b64 v[202:203], s[96:97]
v_mfma_f32_16x16x32_bf16 v[148:151], a[252:255], v[196:199], 0
v_exp_f32 v190, v190
v_mfma_f32_16x16x32_bf16 v[148:151], a[248:251], v[220:223], v[148:151]
v_exp_f32 v191, v191
v_mfma_f32_16x16x32_bf16 v[148:151], a[244:247], v[204:207], v[148:151]
v_exp_f32 v216, v216
v_mfma_f32_16x16x32_bf16 v[148:151], a[240:243], v[192:195], v[148:151]
v_exp_f32 v217, v217
v_smfmac_f32_16x16x64_bf16 v[200:203], v[238:241], v[96:103], v251
v_mov_b64 v[192:193], 0
v_mfma_f32_16x16x32_bf16 v[196:199], v[0:3], v[96:99], 0
v_exp_f32 v218, v218
v_mfma_f32_16x16x32_bf16 v[196:199], v[4:7], v[100:103], v[196:199]
v_exp_f32 v219, v219
v_mfma_f32_16x16x32_bf16 v[204:207], v[12:15], v[100:103], 0
v_cvt_pk_bf16_f32 v129, v190, v191
v_cvt_pk_bf16_f32 v130, v216, v217
v_mfma_f32_16x16x32_bf16 v[204:207], v[8:11], v[96:99], v[204:207]
v_cvt_pk_bf16_f32 v131, v218, v219
v_add_f32 v200, v200, v201
v_smfmac_f32_16x16x64_bf16 v[192:195], v[184:187], v[120:127], v251
ds_read_b128 v[188:191], v242 offset:12672
v_add_f32 v202, v202, v203
v_smfmac_f32_16x16x64_bf16 v[192:195], v[184:187], v[128:135], v251 abid:1
ds_read_b128 v[208:211], v242 offset:12928
ds_read_b128 v[212:215], v242 offset:13184
v_mfma_f32_16x16x32_bf16 v[168:171], v[80:83], v[128:131], v[168:171]
ds_read_b128 v[216:219], v242 offset:13440
v_add_u32 v242, s56, v242
v_mfma_f32_16x16x32_bf16 v[168:171], v[64:67], v[124:127], v[168:171]
s_sub_u32 s56, 0, s56
v_exp_f32 v200, v200
v_mfma_f32_16x16x32_bf16 v[168:171], v[48:51], v[120:123], v[168:171]
v_exp_f32 v202, v202
v_mfma_f32_16x16x32_bf16 v[172:175], v[52:55], v[120:123], v[172:175]
v_perm_b32 v116, v202, v200, v252
v_perm_b32 v117, v202, v200, v253
v_mfma_f32_16x16x32_bf16 v[172:175], v[68:71], v[124:127], v[172:175]
v_add_f32 v192, v192, v193
v_mfma_f32_16x16x32_bf16 v[172:175], v[84:87], v[128:131], v[172:175]
v_rcp_f32 v254, v192
v_mfma_f32_16x16x32_bf16 v[176:179], v[88:91], v[128:131], v[176:179]
v_max3_f32 v255, v255, v192, v254
v_fmac_f32 v152, v168, v254
v_mfma_f32_16x16x32_bf16 v[176:179], v[72:75], v[124:127], v[176:179]
v_fmac_f32 v153, v169, v254
v_fmac_f32 v154, v170, v254
v_mfma_f32_16x16x32_bf16 v[176:179], v[56:59], v[120:123], v[176:179]
v_fmac_f32 v155, v171, v254
v_cvt_pk_bf16_f32 v152, v152, v153
v_mfma_f32_16x16x32_bf16 v[180:183], v[60:63], v[120:123], v[180:183]
v_fmac_f32 v156, v172, v254
v_fmac_f32 v157, v173, v254
v_mfma_f32_16x16x32_bf16 v[180:183], v[76:79], v[124:127], v[180:183]
v_fmac_f32 v158, v174, v254
v_fmac_f32 v159, v175, v254
v_mfma_f32_16x16x32_bf16 v[180:183], v[92:95], v[128:131], v[180:183]
s_waitcnt lgkmcnt(3)
v_fmac_f32 v160, v176, v254
v_fmac_f32 v161, v177, v254
v_mfma_f32_16x16x32_bf16 v[200:203], v[36:39], v[100:103], 0
s_waitcnt lgkmcnt(1)
v_fmac_f32 v162, v178, v254
v_fmac_f32 v163, v179, v254
v_mfma_f32_16x16x32_bf16 v[200:203], v[32:35], v[96:99], v[200:203]
s_waitcnt lgkmcnt(0)
v_cvt_pk_bf16_f32 v160, v160, v161
v_cvt_pk_bf16_f32 v153, v154, v155
v_mfma_f32_16x16x32_bf16 v[220:223], v[24:27], v[96:99], 0
s_mov_b64 vcc, s[14:15]
v_fmac_f32 v164, v180, v254
v_fmac_f32 v165, v181, v254
v_mfma_f32_16x16x32_bf16 v[220:223], v[28:31], v[100:103], v[220:223]
v_fmac_f32 v166, v182, v254
v_fmac_f32 v167, v183, v254
v_mfma_f32_16x16x32_bf16 v[224:227], v[20:23], v[100:103], 0
v_cvt_pk_bf16_f32 v161, v162, v163
v_cvt_pk_bf16_f32 v154, v156, v157
v_mfma_f32_16x16x32_bf16 v[224:227], v[16:19], v[96:99], v[224:227]
v_mov_b32 v232, s45
v_cvt_pk_bf16_f32 v155, v158, v159
v_mfma_f32_16x16x32_bf16 v[228:231], v[40:43], v[96:99], 0
s_waitcnt vmcnt(6)
ds_write_addtid_b32 v232 offset:65280
v_mfma_f32_16x16x32_bf16 v[228:231], v[44:47], v[100:103], v[228:231]
v_cvt_pk_bf16_f32 v162, v164, v165
v_cvt_pk_bf16_f32 v163, v166, v167
v_mfma_f32_16x16x32_bf16 v[192:195], a[0:3], v[188:191], 0
v_pk_max_i16 v152, v152, 0
v_pk_max_i16 v153, v153, 0
v_mfma_f32_16x16x32_bf16 v[192:195], a[4:7], v[208:211], v[192:195]
v_pk_max_i16 v154, v154, 0
v_pk_max_i16 v155, v155, 0
v_mfma_f32_16x16x32_bf16 v[192:195], a[8:11], v[212:215], v[192:195]
v_pk_max_i16 v160, v160, 0
v_pk_max_i16 v161, v161, 0
v_mfma_f32_16x16x32_bf16 v[192:195], a[12:15], v[216:219], v[192:195]
v_pk_max_i16 v162, v162, 0
v_pk_max_i16 v163, v163, 0
v_mfma_f32_16x16x32_bf16 v[232:235], a[28:31], v[216:219], 0
v_cndmask_b32_dpp v156, v160, v152, vcc quad_perm:[1,0,3,2] row_mask:0xf bank_mask:0xf
v_cndmask_b32_dpp v157, v161, v153, vcc quad_perm:[1,0,3,2] row_mask:0xf bank_mask:0xf
v_mfma_f32_16x16x32_bf16 v[232:235], a[24:27], v[212:215], v[232:235]
v_cndmask_b32_dpp v158, v162, v154, vcc quad_perm:[1,0,3,2] row_mask:0xf bank_mask:0xf
v_cndmask_b32_dpp v159, v163, v155, vcc quad_perm:[1,0,3,2] row_mask:0xf bank_mask:0xf
v_mfma_f32_16x16x32_bf16 v[232:235], a[20:23], v[208:211], v[232:235]
s_not_b64 vcc, vcc
v_cvt_pk_bf16_f32 v96, v192, v193
v_cvt_pk_bf16_f32 v97, v194, v195
v_mfma_f32_16x16x32_bf16 v[232:235], a[16:19], v[188:191], v[232:235]
v_cndmask_b32_dpp v160, v152, v160, vcc quad_perm:[1,0,3,2] row_mask:0xf bank_mask:0xf
v_cndmask_b32_dpp v161, v153, v161, vcc quad_perm:[1,0,3,2] row_mask:0xf bank_mask:0xf
v_mfma_f32_16x16x32_bf16 v[192:195], a[32:35], v[188:191], 0
v_cndmask_b32_dpp v162, v154, v162, vcc quad_perm:[1,0,3,2] row_mask:0xf bank_mask:0xf
v_cndmask_b32_dpp v163, v155, v163, vcc quad_perm:[1,0,3,2] row_mask:0xf bank_mask:0xf
v_mfma_f32_16x16x32_bf16 v[192:195], a[36:39], v[208:211], v[192:195]
v_exp_f32 v204, v204
v_mfma_f32_16x16x32_bf16 v[192:195], a[40:43], v[212:215], v[192:195]
v_cvt_pk_bf16_f32 v98, v232, v233
v_cvt_pk_bf16_f32 v99, v234, v235
v_mfma_f32_16x16x32_bf16 v[192:195], a[44:47], v[216:219], v[192:195]
v_exp_f32 v205, v205
v_mfma_f32_16x16x32_bf16 v[232:235], a[60:63], v[216:219], 0
v_exp_f32 v206, v206
v_mfma_f32_16x16x32_bf16 v[232:235], a[56:59], v[212:215], v[232:235]
v_exp_f32 v207, v207
v_mfma_f32_16x16x32_bf16 v[232:235], a[52:55], v[208:211], v[232:235]
v_exp_f32 v220, v220
v_mfma_f32_16x16x32_bf16 v[232:235], a[48:51], v[188:191], v[232:235]
v_cvt_pk_bf16_f32 v100, v192, v193
v_cvt_pk_bf16_f32 v101, v194, v195
v_mfma_f32_32x32x16_bf16 v[168:183], v[236:239], v[116:119], 0
s_cmp_lg_u32 s45, 0
buffer_store_dwordx4 v[156:159], v244, s[20:23], s53 offen offset:0 nt
buffer_store_dwordx4 v[160:163], v244, s[20:23], s53 offen offset:256 nt
s_cbranch_scc1 L_loopf
v_mfma_f32_16x16x32_bf16 v[152:155], a[192:195], v[188:191], 0
s_mov_b32 m0, s59
v_cvt_pk_bf16_f32 v102, v232, v233
v_cvt_pk_bf16_f32 v103, v234, v235
v_mfma_f32_16x16x32_bf16 v[152:155], a[196:199], v[208:211], v[152:155]
s_mul_i32 s54, s41, 13824
v_mov_b64 v[192:193], s[96:97]
v_mov_b64 v[194:195], s[96:97]
v_mfma_f32_16x16x32_bf16 v[152:155], a[200:203], v[212:215], v[152:155]
L_h5:
s_cbranch_execz L_ret
s_add_u32 s7, s54, 102400
v_exp_f32 v196, v196
v_mfma_f32_16x16x32_bf16 v[152:155], a[204:207], v[216:219], v[152:155]
s_mov_b32 s6, 1728
v_exp_f32 v197, v197
v_mfma_f32_16x16x32_bf16 v[156:159], a[220:223], v[216:219], 0
s_lshl_b32 s55, s41, 9
v_exp_f32 v198, v198
v_mfma_f32_16x16x32_bf16 v[156:159], a[216:219], v[212:215], v[156:159]
s_mov_b32 s13, 272
v_exp_f32 v199, v199
v_mfma_f32_16x16x32_bf16 v[156:159], a[212:215], v[208:211], v[156:159]
s_add_u32 s8, s54, 103536
v_cvt_pk_bf16_f32 v104, v196, v197
v_cvt_pk_bf16_f32 v105, v198, v199
v_mfma_f32_16x16x32_bf16 v[156:159], a[208:211], v[188:191], v[156:159]
s_add_u32 s9, s55, 160960
v_cvt_pk_bf16_f32 v106, v204, v205
v_cvt_pk_bf16_f32 v107, v206, v207
v_mfma_f32_16x16x32_bf16 v[160:163], a[224:227], v[188:191], 0
s_add_u32 s52, s47, 8192
v_exp_f32 v200, v200
v_mfma_f32_16x16x32_bf16 v[160:163], a[228:231], v[208:211], v[160:163]
s_mov_b32 s57, 13106176
v_exp_f32 v201, v201
v_mfma_f32_16x16x32_bf16 v[160:163], a[232:235], v[212:215], v[160:163]
s_add_u32 s98, s44, 24576
v_exp_f32 v202, v202
v_mfma_f32_16x16x32_bf16 v[160:163], a[236:239], v[216:219], v[160:163]
s_add_u32 s99, s44, 52453376
v_exp_f32 v203, v203
v_mfma_f32_16x16x32_bf16 v[164:167], a[252:255], v[216:219], 0
s_add_u32 s53, s47, 12288
v_cvt_pk_bf16_f32 v112, v200, v201
v_cvt_pk_bf16_f32 v113, v202, v203
v_mfma_f32_16x16x32_bf16 v[164:167], a[248:251], v[212:215], v[164:167]
v_mbcnt_lo_u32_b32 v245, -1, 0
v_mbcnt_hi_u32_b32 v245, -1, v245
v_mfma_f32_16x16x32_bf16 v[164:167], a[244:247], v[208:211], v[164:167]
v_mov_b32 v243, s7
v_bfe_u32 v246, v245, 2, 2
v_mfma_f32_16x16x32_bf16 v[164:167], a[240:243], v[188:191], v[164:167]
ds_read_addtid_b32 v188 offset:65280
v_and_b32 v200, 3, v245
v_smfmac_f32_16x16x64_bf16 v[192:195], v[238:241], v[96:103], v251
v_and_b32 v202, 15, v245
v_mfma_f32_16x16x32_bf16 v[196:199], v[0:3], v[96:99], 0
v_mad_u32_u24 v243, v246, s6, v243
v_lshrrev_b32 v201, 4, v245
v_mfma_f32_16x16x32_bf16 v[196:199], v[4:7], v[100:103], v[196:199]
v_mad_u32_u24 v243, v200, s13, v243
v_lshl_add_u32 v249, v202, 3, s8
v_mfma_f32_16x16x32_bf16 v[204:207], v[12:15], v[100:103], 0
v_lshl_add_u32 v250, v202, 4, s9
v_lshl_add_u32 v247, v201, 4, v243
v_mfma_f32_16x16x32_bf16 v[204:207], v[8:11], v[96:99], v[204:207]
v_mad_u32_u24 v249, v201, s6, v249
v_add_f32 v192, v192, v193
v_mfma_f32_16x16x32_bf16 v[208:211], v[16:19], v[96:99], 0
s_waitcnt lgkmcnt(0)
v_exp_f32 v224, v224
v_mfma_f32_16x16x32_bf16 v[208:211], v[20:23], v[100:103], v[208:211]
v_exp_f32 v225, v225
v_mfma_f32_16x16x32_bf16 v[212:215], v[28:31], v[100:103], 0
v_exp_f32 v226, v226
v_mfma_f32_16x16x32_bf16 v[212:215], v[24:27], v[96:99], v[212:215]
v_exp_f32 v227, v227
v_mfma_f32_16x16x32_bf16 v[200:203], v[32:35], v[96:99], 0
ds_read_b64 v[32:33], v249 offset:0
v_cvt_pk_bf16_f32 v108, v224, v225
v_mfma_f32_16x16x32_bf16 v[200:203], v[36:39], v[100:103], v[200:203]
ds_read_b64 v[34:35], v249 offset:6912
v_cvt_pk_bf16_f32 v109, v226, v227
v_mfma_f32_16x16x32_bf16 v[224:227], v[44:47], v[100:103], 0
ds_read_b64 v[36:37], v249 offset:128
v_cmp_lt_u32 vcc, s45, v188
v_mfma_f32_16x16x32_bf16 v[224:227], v[40:43], v[96:99], v[224:227]
ds_read_b64 v[96:97], v250 offset:0
v_exp_f32 v221, v221
v_exp_f32 v222, v222
v_exp_f32 v223, v223
s_cbranch_vccnz L_spine
L_backe:
v_cvt_pk_bf16_f32 v110, v220, v221
v_cvt_pk_bf16_f32 v111, v222, v223
v_mov_b64 v[188:189], 0
v_exp_f32 v228, v228
v_add_f32 v194, v194, v195
v_smfmac_f32_16x16x64_bf16 v[188:191], v[184:187], v[104:111], v251
ds_read_b128 v[216:219], v242 offset:0
v_exp_f32 v229, v229
v_exp_f32 v230, v230
v_exp_f32 v231, v231
v_cvt_pk_bf16_f32 v114, v228, v229
v_cvt_pk_bf16_f32 v115, v230, v231
v_exp_f32 v192, v192
v_mad_u32_u24 v248, v246, s57, v244
v_smfmac_f32_16x16x64_bf16 v[188:191], v[184:187], v[112:119], v251 abid:1
s_waitcnt lgkmcnt(1)
ds_read_b128 v[220:223], v242 offset:256
ds_read_b128 v[228:231], v242 offset:512
v_mfma_f32_16x16x32_bf16 v[168:171], v[80:83], v[112:115], v[168:171]
ds_read_b128 v[232:235], v242 offset:768
ds_read_b64 v[40:41], v249 offset:256
v_mfma_f32_16x16x32_bf16 v[168:171], v[64:67], v[108:111], v[168:171]
ds_read_b64 v[42:43], v249 offset:7168
v_add_f32 v188, v188, v189
v_mfma_f32_16x16x32_bf16 v[168:171], v[48:51], v[104:107], v[168:171]
ds_read_b64 v[38:39], v249 offset:7040
ds_read_b64 v[44:45], v249 offset:384
v_mfma_f32_16x16x32_bf16 v[172:175], v[52:55], v[104:107], v[172:175]
ds_read_b64 v[46:47], v249 offset:7296
ds_read_b32 v102, v250 offset:8
v_mfma_f32_16x16x32_bf16 v[172:175], v[68:71], v[108:111], v[172:175]
ds_read_b64 v[100:101], v250 offset:256
ds_read_b32 v103, v250 offset:264
v_mfma_f32_16x16x32_bf16 v[172:175], v[84:87], v[112:115], v[172:175]
v_exp_f32 v196, v196
v_mfma_f32_16x16x32_bf16 v[176:179], v[88:91], v[112:115], v[176:179]
v_exp_f32 v197, v197
v_mfma_f32_16x16x32_bf16 v[176:179], v[72:75], v[108:111], v[176:179]
v_exp_f32 v198, v198
v_mfma_f32_16x16x32_bf16 v[176:179], v[56:59], v[104:107], v[176:179]
v_exp_f32 v199, v199
v_mfma_f32_16x16x32_bf16 v[180:183], v[60:63], v[104:107], v[180:183]
s_waitcnt lgkmcnt(2)
v_cvt_pk_bf16_f32 v120, v196, v197
v_cvt_pk_bf16_f32 v121, v198, v199
v_mfma_f32_16x16x32_bf16 v[180:183], v[76:79], v[108:111], v[180:183]
s_waitcnt lgkmcnt(0)
v_exp_f32 v194, v194
v_mfma_f32_16x16x32_bf16 v[180:183], v[92:95], v[112:115], v[180:183]
s_mov_b64 vcc, s[14:15]
v_perm_b32 v132, v194, v192, v252
v_perm_b32 v133, v194, v192, v253
v_mfma_f32_16x16x32_bf16 v[0:3], a[192:195], v[216:219], 0
v_rcp_f32 v254, v188
v_mfma_f32_16x16x32_bf16 v[0:3], a[196:199], v[220:223], v[0:3]
v_max3_f32 v255, v255, v188, v254
v_fmac_f32 v136, v168, v254
v_mfma_f32_16x16x32_bf16 v[0:3], a[200:203], v[228:231], v[0:3]
v_fmac_f32 v137, v169, v254
v_fmac_f32 v144, v176, v254
v_mfma_f32_16x16x32_bf16 v[0:3], a[204:207], v[232:235], v[0:3]
v_fmac_f32 v145, v177, v254
v_fmac_f32 v138, v170, v254
v_mfma_f32_16x16x32_bf16 v[4:7], a[220:223], v[232:235], 0
ds_read_b128 v[196:199], v242 offset:4736
ds_read_b128 v[192:195], v242 offset:4480
v_mfma_f32_16x16x32_bf16 v[4:7], a[216:219], v[228:231], v[4:7]
ds_read_b128 v[188:191], v242 offset:4224
v_fmac_f32 v139, v171, v254
v_mfma_f32_16x16x32_bf16 v[4:7], a[212:215], v[220:223], v[4:7]
v_cvt_pk_bf16_f32 v136, v136, v137
v_fmac_f32 v146, v178, v254
v_mfma_f32_16x16x32_bf16 v[4:7], a[208:211], v[216:219], v[4:7]
v_fmac_f32 v147, v179, v254
v_cvt_pk_bf16_f32 v144, v144, v145
v_mfma_f32_16x16x32_bf16 v[8:11], a[224:227], v[216:219], 0
v_fmac_f32 v140, v172, v254
v_fmac_f32 v141, v173, v254
v_mfma_f32_16x16x32_bf16 v[8:11], a[228:231], v[220:223], v[8:11]
ds_read_b128 v[104:107], v247 offset:0
v_fmac_f32 v142, v174, v254
v_mfma_f32_16x16x32_bf16 v[8:11], a[232:235], v[228:231], v[8:11]
ds_read_b128 v[108:111], v247 offset:64
v_fmac_f32 v143, v175, v254
v_mfma_f32_16x16x32_bf16 v[8:11], a[236:239], v[232:235], v[8:11]
ds_read_b128 v[112:115], v247 offset:128
v_cvt_pk_bf16_f32 v137, v138, v139
v_mfma_f32_16x16x32_bf16 v[12:15], a[252:255], v[232:235], 0
ds_read_b128 v[232:235], v242 offset:4992
v_fmac_f32 v148, v180, v254
v_mfma_f32_16x16x32_bf16 v[12:15], a[244:247], v[220:223], v[12:15]
ds_read_b128 v[116:119], v247 offset:192
v_fmac_f32 v149, v181, v254
v_mfma_f32_16x16x32_bf16 v[12:15], a[240:243], v[216:219], v[12:15]
s_waitcnt lgkmcnt(7)
ds_read_b128 v[220:223], v243 offset:256
v_fmac_f32 v150, v182, v254
v_mfma_f32_16x16x32_bf16 v[12:15], a[248:251], v[228:231], v[12:15]
v_fmac_f32 v151, v183, v254
v_cvt_pk_bf16_f32 v145, v146, v147
v_mfma_f32_16x16x32_bf16 v[28:31], a[248:251], v[196:199], 0
s_waitcnt lgkmcnt(7)
v_cvt_pk_bf16_f32 v138, v140, v141
v_cvt_pk_bf16_f32 v139, v142, v143
v_cvt_pk_bf16_f32 v146, v148, v149
v_cvt_pk_bf16_f32 v147, v150, v151
v_pk_max_i16 v136, v136, 0
s_waitcnt lgkmcnt(2)
v_mfma_f32_16x16x32_bf16 v[28:31], a[252:255], v[232:235], v[28:31]
v_pk_max_i16 v137, v137, 0
v_pk_max_i16 v138, v138, 0
v_mfma_f32_16x16x32_bf16 v[28:31], a[244:247], v[192:195], v[28:31]
v_pk_max_i16 v139, v139, 0
v_pk_max_i16 v144, v144, 0
v_mfma_f32_16x16x32_bf16 v[28:31], a[240:243], v[188:191], v[28:31]
s_waitcnt lgkmcnt(0)
v_pk_max_i16 v145, v145, 0
v_pk_max_i16 v146, v146, 0
v_pk_max_i16 v147, v147, 0
v_cndmask_b32_dpp v140, v144, v136, vcc quad_perm:[1,0,3,2] row_mask:0xf bank_mask:0xf
v_cndmask_b32_dpp v141, v145, v137, vcc quad_perm:[1,0,3,2] row_mask:0xf bank_mask:0xf
v_cndmask_b32_dpp v142, v146, v138, vcc quad_perm:[1,0,3,2] row_mask:0xf bank_mask:0xf
v_cndmask_b32_dpp v143, v147, v139, vcc quad_perm:[1,0,3,2] row_mask:0xf bank_mask:0xf
s_not_b64 vcc, vcc
v_cndmask_b32_dpp v144, v136, v144, vcc quad_perm:[1,0,3,2] row_mask:0xf bank_mask:0xf
v_cndmask_b32_dpp v145, v137, v145, vcc quad_perm:[1,0,3,2] row_mask:0xf bank_mask:0xf
v_cndmask_b32_dpp v146, v138, v146, vcc quad_perm:[1,0,3,2] row_mask:0xf bank_mask:0xf
v_cndmask_b32_dpp v147, v139, v147, vcc quad_perm:[1,0,3,2] row_mask:0xf bank_mask:0xf
s_mov_b32 vcc_lo, 0xf0000f
s_mov_b32 vcc_hi, 0xf0000f00
v_mov_b64 v[98:99], 0
v_cndmask_b32 v96, 0, v96, vcc
v_cndmask_b32 v97, 0, v97, vcc
v_exp_f32 v204, v204
v_add_f32 v220, v220, v221
v_mfma_f32_16x16x32_bf16 v[104:107], v[32:35], v[96:99], v[104:107]
v_exp_f32 v205, v205
v_mfma_f32_16x16x32_bf16 v[108:111], v[36:39], v[96:99], v[108:111]
v_exp_f32 v206, v206
v_mfma_f32_16x16x32_bf16 v[112:115], v[40:43], v[96:99], v[112:115]
v_exp_f32 v207, v207
v_mfma_f32_16x16x32_bf16 v[116:119], v[44:47], v[96:99], v[116:119]
v_cvt_pk_bf16_f32 v122, v204, v205
v_cvt_pk_bf16_f32 v123, v206, v207
v_mfma_f32_16x16x32_bf16 v[24:27], a[224:227], v[188:191], 0
v_exp_f32 v208, v208
v_mfma_f32_16x16x32_bf16 v[24:27], a[228:231], v[192:195], v[24:27]
v_exp_f32 v209, v209
v_mfma_f32_16x16x32_bf16 v[24:27], a[232:235], v[196:199], v[24:27]
v_exp_f32 v210, v210
v_mfma_f32_16x16x32_bf16 v[24:27], a[236:239], v[232:235], v[24:27]
v_exp_f32 v211, v211
v_mfma_f32_32x32x16_bf16 v[168:183], v[236:239], v[132:135], 0
buffer_store_dwordx4 v[140:143], v244, s[20:23], s52 offen offset:0 nt
buffer_store_dwordx4 v[144:147], v244, s[20:23], s52 offen offset:256 nt
v_exp_f32 v212, v212
v_exp_f32 v213, v213
v_mfma_f32_16x16x32_bf16 v[20:23], a[220:223], v[232:235], 0
v_exp_f32 v214, v214
v_mfma_f32_16x16x32_bf16 v[20:23], a[216:219], v[196:199], v[20:23]
v_exp_f32 v215, v215
v_mfma_f32_16x16x32_bf16 v[20:23], a[212:215], v[192:195], v[20:23]
v_cvt_pk_bf16_f32 v124, v208, v209
v_cvt_pk_bf16_f32 v125, v210, v211
v_mfma_f32_16x16x32_bf16 v[20:23], a[208:211], v[188:191], v[20:23]
v_cvt_pk_bf16_f32 v126, v212, v213
v_cvt_pk_bf16_f32 v127, v214, v215
v_mfma_f32_16x16x32_bf16 v[16:19], a[192:195], v[188:191], 0
v_mov_b64 v[188:189], 0
v_cndmask_b32 v100, 0, v100, vcc
v_mfma_f32_16x16x32_bf16 v[16:19], a[196:199], v[192:195], v[16:19]
ds_read_b128 v[192:195], v247 offset:6912
v_cndmask_b32 v101, 0, v101, vcc
v_mfma_f32_16x16x32_bf16 v[16:19], a[200:203], v[196:199], v[16:19]
ds_read_b128 v[196:199], v247 offset:6976
ds_read_b128 v[204:207], v247 offset:7040
v_mfma_f32_16x16x32_bf16 v[16:19], a[204:207], v[232:235], v[16:19]
ds_read_b128 v[208:211], v247 offset:7104
v_add_f32 v222, v222, v223
v_smfmac_f32_16x16x64_bf16 v[188:191], v[184:187], v[120:127], v251
ds_read_b128 v[212:215], v243 offset:7168
v_exp_f32 v200, v200
v_exp_f32 v201, v201
v_exp_f32 v202, v202
v_exp_f32 v203, v203
v_exp_f32 v224, v224
v_exp_f32 v225, v225
v_exp_f32 v226, v226
v_exp_f32 v227, v227
v_cvt_pk_bf16_f32 v128, v200, v201
v_cvt_pk_bf16_f32 v129, v202, v203
v_cvt_pk_bf16_f32 v130, v224, v225
v_cvt_pk_bf16_f32 v131, v226, v227
v_add_f32 v220, v220, v102
v_add_f32 v220, v220, v222
v_smfmac_f32_16x16x64_bf16 v[188:191], v[184:187], v[128:135], v251 abid:1
s_waitcnt lgkmcnt(0)
v_add_f32 v212, v212, v213
v_mfma_f32_16x16x32_bf16 v[168:171], v[80:83], v[128:131], v[168:171]
v_rcp_f32 v252, v220
v_mfma_f32_16x16x32_bf16 v[168:171], v[64:67], v[124:127], v[168:171]
v_fmac_f32 v0, v104, v252
v_fmac_f32 v1, v105, v252
v_mfma_f32_16x16x32_bf16 v[168:171], v[48:51], v[120:123], v[168:171]
v_fmac_f32 v8, v112, v252
v_fmac_f32 v9, v113, v252
v_mfma_f32_16x16x32_bf16 v[172:175], v[52:55], v[120:123], v[172:175]
v_fmac_f32 v2, v106, v252
v_fmac_f32 v3, v107, v252
v_mfma_f32_16x16x32_bf16 v[172:175], v[68:71], v[124:127], v[172:175]
v_cvt_pk_bf16_f32 v0, v0, v1
v_fmac_f32 v10, v114, v252
v_mfma_f32_16x16x32_bf16 v[172:175], v[84:87], v[128:131], v[172:175]
v_fmac_f32 v11, v115, v252
v_cvt_pk_bf16_f32 v8, v8, v9
v_mfma_f32_16x16x32_bf16 v[192:195], v[32:35], v[98:101], v[192:195]
v_fmac_f32 v4, v108, v252
v_fmac_f32 v5, v109, v252
v_mfma_f32_16x16x32_bf16 v[196:199], v[36:39], v[98:101], v[196:199]
v_fmac_f32 v6, v110, v252
v_fmac_f32 v7, v111, v252
v_mfma_f32_16x16x32_bf16 v[204:207], v[40:43], v[98:101], v[204:207]
v_cvt_pk_bf16_f32 v1, v2, v3
v_fmac_f32 v12, v116, v252
v_mfma_f32_16x16x32_bf16 v[208:211], v[44:47], v[98:101], v[208:211]
v_fmac_f32 v13, v117, v252
v_fmac_f32 v14, v118, v252
v_mfma_f32_16x16x32_bf16 v[176:179], v[72:75], v[124:127], v[176:179]
v_fmac_f32 v15, v119, v252
v_cvt_pk_bf16_f32 v9, v10, v11
v_mfma_f32_16x16x32_bf16 v[176:179], v[88:91], v[128:131], v[176:179]
v_cvt_pk_bf16_f32 v2, v4, v5
v_cvt_pk_bf16_f32 v3, v6, v7
v_mfma_f32_16x16x32_bf16 v[176:179], v[56:59], v[120:123], v[176:179]
v_cvt_pk_bf16_f32 v10, v12, v13
v_cvt_pk_bf16_f32 v11, v14, v15
v_mfma_f32_16x16x32_bf16 v[180:183], v[60:63], v[120:123], v[180:183]
v_pk_max_i16 v0, v0, 0
v_pk_max_i16 v1, v1, 0
v_mfma_f32_16x16x32_bf16 v[180:183], v[76:79], v[124:127], v[180:183]
v_pk_max_i16 v2, v2, 0
v_pk_max_i16 v3, v3, 0
v_mfma_f32_16x16x32_bf16 v[180:183], v[92:95], v[128:131], v[180:183]
s_mov_b64 vcc, s[14:15]
v_pk_max_i16 v8, v8, 0
v_pk_max_i16 v9, v9, 0
v_pk_max_i16 v10, v10, 0
v_pk_max_i16 v11, v11, 0
v_cndmask_b32_dpp v4, v8, v0, vcc quad_perm:[1,0,3,2] row_mask:0xf bank_mask:0xf
v_cndmask_b32_dpp v5, v9, v1, vcc quad_perm:[1,0,3,2] row_mask:0xf bank_mask:0xf
v_cndmask_b32_dpp v6, v10, v2, vcc quad_perm:[1,0,3,2] row_mask:0xf bank_mask:0xf
v_cndmask_b32_dpp v7, v11, v3, vcc quad_perm:[1,0,3,2] row_mask:0xf bank_mask:0xf
s_not_b64 vcc, vcc
v_cndmask_b32_dpp v8, v0, v8, vcc quad_perm:[1,0,3,2] row_mask:0xf bank_mask:0xf
v_cndmask_b32_dpp v9, v1, v9, vcc quad_perm:[1,0,3,2] row_mask:0xf bank_mask:0xf
v_cndmask_b32_dpp v10, v2, v10, vcc quad_perm:[1,0,3,2] row_mask:0xf bank_mask:0xf
v_cndmask_b32_dpp v11, v3, v11, vcc quad_perm:[1,0,3,2] row_mask:0xf bank_mask:0xf
buffer_store_dwordx4 v[4:7], v248, s[20:23], s98 offen offset:0 nt
buffer_store_dwordx4 v[8:11], v248, s[20:23], s98 offen offset:256 nt
v_add_f32 v214, v214, v215
v_add_f32 v212, v212, v103
v_add_f32 v212, v212, v214
v_rcp_f32 v240, v212
s_mov_b64 vcc, s[14:15]
v_pk_fma_f32 v[16:17], v[192:193], v[240:241], v[16:17] op_sel_hi:[1,0,1]
v_pk_fma_f32 v[24:25], v[204:205], v[240:241], v[24:25] op_sel_hi:[1,0,1]
v_pk_fma_f32 v[18:19], v[194:195], v[240:241], v[18:19] op_sel_hi:[1,0,1]
v_cvt_pk_bf16_f32 v16, v16, v17
v_pk_fma_f32 v[26:27], v[206:207], v[240:241], v[26:27] op_sel_hi:[1,0,1]
v_cvt_pk_bf16_f32 v24, v24, v25
v_pk_fma_f32 v[20:21], v[196:197], v[240:241], v[20:21] op_sel_hi:[1,0,1]
v_pk_fma_f32 v[22:23], v[198:199], v[240:241], v[22:23] op_sel_hi:[1,0,1]
v_cvt_pk_bf16_f32 v17, v18, v19
v_pk_fma_f32 v[28:29], v[208:209], v[240:241], v[28:29] op_sel_hi:[1,0,1]
v_pk_fma_f32 v[30:31], v[210:211], v[240:241], v[30:31] op_sel_hi:[1,0,1]
v_cvt_pk_bf16_f32 v25, v26, v27
v_cvt_pk_bf16_f32 v18, v20, v21
v_cvt_pk_bf16_f32 v19, v22, v23
v_cvt_pk_bf16_f32 v26, v28, v29
v_cvt_pk_bf16_f32 v27, v30, v31
v_pk_max_i16 v16, v16, 0
v_pk_max_i16 v17, v17, 0
v_pk_max_i16 v18, v18, 0
v_pk_max_i16 v19, v19, 0
v_pk_max_i16 v24, v24, 0
v_pk_max_i16 v25, v25, 0
v_pk_max_i16 v26, v26, 0
v_pk_max_i16 v27, v27, 0
v_cndmask_b32_dpp v20, v24, v16, vcc quad_perm:[1,0,3,2] row_mask:0xf bank_mask:0xf
v_cndmask_b32_dpp v21, v25, v17, vcc quad_perm:[1,0,3,2] row_mask:0xf bank_mask:0xf
v_cndmask_b32_dpp v22, v26, v18, vcc quad_perm:[1,0,3,2] row_mask:0xf bank_mask:0xf
v_cndmask_b32_dpp v23, v27, v19, vcc quad_perm:[1,0,3,2] row_mask:0xf bank_mask:0xf
s_not_b64 vcc, vcc
v_cndmask_b32_dpp v24, v16, v24, vcc quad_perm:[1,0,3,2] row_mask:0xf bank_mask:0xf
v_cndmask_b32_dpp v25, v17, v25, vcc quad_perm:[1,0,3,2] row_mask:0xf bank_mask:0xf
v_cndmask_b32_dpp v26, v18, v26, vcc quad_perm:[1,0,3,2] row_mask:0xf bank_mask:0xf
v_cndmask_b32_dpp v27, v19, v27, vcc quad_perm:[1,0,3,2] row_mask:0xf bank_mask:0xf
buffer_store_dwordx4 v[20:23], v248, s[20:23], s99 offen offset:0 nt
buffer_store_dwordx4 v[24:27], v248, s[20:23], s99 offen offset:256 nt
v_add_f32 v188, v188, v189
v_rcp_f32 v254, v188
s_mov_b64 vcc, s[14:15]
v_pk_fma_f32 v[152:153], v[168:169], v[254:255], v[152:153] op_sel_hi:[1,0,1]
v_pk_fma_f32 v[160:161], v[176:177], v[254:255], v[160:161] op_sel_hi:[1,0,1]
v_pk_fma_f32 v[154:155], v[170:171], v[254:255], v[154:155] op_sel_hi:[1,0,1]
v_cvt_pk_bf16_f32 v152, v152, v153
v_pk_fma_f32 v[162:163], v[178:179], v[254:255], v[162:163] op_sel_hi:[1,0,1]
v_cvt_pk_bf16_f32 v160, v160, v161
v_pk_fma_f32 v[156:157], v[172:173], v[254:255], v[156:157] op_sel_hi:[1,0,1]
v_pk_fma_f32 v[158:159], v[174:175], v[254:255], v[158:159] op_sel_hi:[1,0,1]
v_cvt_pk_bf16_f32 v153, v154, v155
v_pk_fma_f32 v[164:165], v[180:181], v[254:255], v[164:165] op_sel_hi:[1,0,1]
v_pk_fma_f32 v[166:167], v[182:183], v[254:255], v[166:167] op_sel_hi:[1,0,1]
v_cvt_pk_bf16_f32 v161, v162, v163
v_cvt_pk_bf16_f32 v154, v156, v157
v_cvt_pk_bf16_f32 v155, v158, v159
v_cvt_pk_bf16_f32 v162, v164, v165
v_cvt_pk_bf16_f32 v163, v166, v167
v_pk_max_i16 v152, v152, 0
v_pk_max_i16 v153, v153, 0
v_pk_max_i16 v154, v154, 0
v_pk_max_i16 v155, v155, 0
v_pk_max_i16 v160, v160, 0
v_pk_max_i16 v161, v161, 0
v_pk_max_i16 v162, v162, 0
v_pk_max_i16 v163, v163, 0
v_cndmask_b32_dpp v156, v160, v152, vcc quad_perm:[1,0,3,2] row_mask:0xf bank_mask:0xf
v_cndmask_b32_dpp v157, v161, v153, vcc quad_perm:[1,0,3,2] row_mask:0xf bank_mask:0xf
v_cndmask_b32_dpp v158, v162, v154, vcc quad_perm:[1,0,3,2] row_mask:0xf bank_mask:0xf
v_cndmask_b32_dpp v159, v163, v155, vcc quad_perm:[1,0,3,2] row_mask:0xf bank_mask:0xf
s_not_b64 vcc, vcc
v_cndmask_b32_dpp v160, v152, v160, vcc quad_perm:[1,0,3,2] row_mask:0xf bank_mask:0xf
v_cndmask_b32_dpp v161, v153, v161, vcc quad_perm:[1,0,3,2] row_mask:0xf bank_mask:0xf
v_cndmask_b32_dpp v162, v154, v162, vcc quad_perm:[1,0,3,2] row_mask:0xf bank_mask:0xf
v_cndmask_b32_dpp v163, v155, v163, vcc quad_perm:[1,0,3,2] row_mask:0xf bank_mask:0xf
buffer_store_dwordx4 v[156:159], v244, s[20:23], s53 offen offset:0 nt
buffer_store_dwordx4 v[160:163], v244, s[20:23], s53 offen offset:256 nt
v_max3_f32 v255, v255, v220, v252
v_max3_f32 v255, v255, v188, v254
v_max3_f32 v255, v255, v212, v240
v_mov_b32 v1, 0x53800000
v_cmp_nle_f32 vcc, v255, v1
s_lshl_b32 s52, s41, 2
s_add_u32 s52, s52, 163008
s_or_b32 s3, vcc_lo, vcc_hi
v_mov_b32 v2, s52
v_mov_b32 v3, s3
ds_write_b32 v2, v3
v_mov_b32 v2, 163008
s_waitcnt lgkmcnt(0)
s_barrier
ds_read_b128 v[4:7], v2
s_waitcnt lgkmcnt(0)
v_or_b32 v4, v4, v5
v_or3_b32 v4, v4, v6, v7
s_nop 0
v_readfirstlane_b32 s3, v4
s_nop 3
s_cmp_eq_u32 s3, 0
s_cbranch_scc0 L_fast_end
s_endpgm
L_fast_end:
s_waitcnt vmcnt(0)
s_barrier
s_mov_b32 s45, 8
s_mov_b32 s3, 64
s_mov_b32 s46, s44
s_mov_b32 s47, 0x7ff00000
s_mov_b32 s56, 50688
v_mbcnt_lo_u32_b32 v48, -1, 0
v_mbcnt_hi_u32_b32 v48, -1, v48
v_lshlrev_b32 v53, 4, v48
s_lshl_b32 s54, s41, 13
s_add_u32 s57, s54, 4096
v_and_b32 v49, 16, v48
v_lshlrev_b32 v52, 2, v49
v_lshlrev_b32 v49, 1, v49
v_xor_b32 v50, v53, v49
s_mul_i32 s49, s42, 25344
s_mul_i32 s53, s43, 1056
s_add_u32 s49, s49, s53
s_add_u32 m0, s49, 0
s_lshl_b32 s55, s43, 10
s_add_u32 s55, s55, s44
s_add_u32 s48, s55, 0
v_mov_b32 v237, 0
v_bfe_u32 v49, v48, 0, 2
v_lshl_add_u32 v237, v49, 4, v237
v_bfe_u32 v49, v48, 4, 2
v_lshl_add_u32 v237, v49, 6, v237
v_bfe_u32 v49, v48, 2, 2
v_lshl_add_u32 v237, v49, 8, v237
v_xor_b32 v51, 64, v50
s_lshl_b32 s53, s43, 14
v_mov_b32 v248, s53
v_add_u32 v248, 50688, v248
v_bfe_u32 v49, v48, 4, 2
v_lshl_add_u32 v248, v49, 10, v248
v_bfe_u32 v49, v48, 2, 2
v_lshl_add_u32 v248, v49, 7, v248
v_bfe_u32 v49, v48, 3, 1
v_lshl_add_u32 v248, v49, 5, v248
v_bfe_u32 v49, v48, 4, 1
v_lshl_add_u32 v248, v49, 6, v248
v_bfe_u32 v49, v48, 0, 2
v_lshl_add_u32 v248, v49, 3, v248
v_mov_b32 v252, s53
v_add_u32 v252, 116224, v252
v_bfe_u32 v49, v48, 4, 2
v_lshl_add_u32 v252, v49, 10, v252
v_bfe_u32 v49, v48, 2, 2
v_lshl_add_u32 v252, v49, 7, v252
v_bfe_u32 v49, v48, 3, 1
v_lshl_add_u32 v252, v49, 6, v252
v_bfe_u32 v49, v48, 0, 2
v_lshl_add_u32 v252, v49, 4, v252
s_mul_i32 s53, s42, 25344
v_bfe_u32 v49, v48, 2, 2
v_mov_b32 v236, s53
v_mul_u32_u24 v49, 1056, v49
v_add_u32 v236, v49, v236
v_bfe_u32 v49, v48, 0, 2
s_add_u32 s53, s54, 83456
v_lshl_add_u32 v236, v49, 6, v236
v_add_u32 v104, s53, v50
v_add_u32 v105, s53, v51
v_bfe_u32 v49, v48, 4, 2
s_lshl_b32 s53, s41, 12
v_lshl_add_u32 v236, v49, 4, v236
v_mov_b32 v54, s53
v_add_u32 v54, 50688, v54
v_bfe_u32 v49, v48, 3, 1
v_lshl_add_u32 v54, v49, 14, v54
v_bfe_u32 v49, v48, 4, 2
v_lshl_add_u32 v54, v49, 7, v54
v_bfe_u32 v49, v48, 2, 1
v_lshl_add_u32 v54, v49, 6, v54
v_bfe_u32 v49, v48, 5, 1
v_lshl_add_u32 v54, v49, 5, v54
v_bfe_u32 v49, v48, 0, 2
v_lshl_add_u32 v54, v49, 3, v54
s_lshl_b32 s53, s43, 7
v_mov_b32 v239, s53
v_bfe_u32 v49, v48, 0, 4
v_lshl_add_u32 v239, v49, 8, v239
s_mul_i32 s52, s41, 12288
s_add_u32 s52, s52, 101376
v_bfe_u32 v49, v48, 4, 2
v_lshl_add_u32 v239, v49, 4, v239
v_mov_b32 v241, s52
v_add_u32 v241, 8192, v241
v_bfe_u32 v49, v48, 4, 2
v_lshl_add_u32 v241, v49, 1, v241
v_bfe_u32 v49, v48, 0, 4
v_lshl_add_u32 v241, v49, 3, v241
buffer_load_dwordx4 v[152:155], v53, s[24:27], s54 offen offset:0
v_mov_b32 v240, s52
v_bfe_u32 v49, v48, 2, 2
v_lshl_add_u32 v240, v49, 7, v240
buffer_load_dwordx4 v[156:159], v53, s[24:27], s54 offen offset:1024
v_lshlrev_b32 v49, 2, v48
v_xor_b32 v49, v49, v48
v_and_b32 v49, 48, v49
buffer_load_dwordx4 v[160:163], v53, s[24:27], s54 offen offset:2048
s_lshl_b32 s53, s41, 10
v_add_u32 v240, v49, v240
v_mov_b32 v254, s53
v_add_u32 v254, 150528, v254
buffer_load_dwordx4 v[164:167], v53, s[24:27], s54 offen offset:3072
v_bfe_u32 v49, v48, 0, 6
v_mov_b32 v40, 0
v_mov_b32 v41, 0
buffer_load_dwordx4 v[168:171], v53, s[24:27], s57 offen offset:0
v_mov_b32 v42, 0
v_mov_b32 v43, 0
v_lshl_add_u32 v254, v49, 4, v254
buffer_load_dwordx4 v[172:175], v53, s[24:27], s57 offen offset:1024
ds_write_b128 v254, v[40:43] offset:0
buffer_load_dwordx4 v[176:179], v53, s[24:27], s57 offen offset:2048
ds_write_b128 v254, v[40:43] offset:256
buffer_load_dwordx4 v[180:183], v53, s[24:27], s57 offen offset:3072
buffer_load_dwordx4 v237, s[16:19], s48 offen nt lds
s_add_u32 m0, s49, 2112
s_add_u32 s48, s55, 2048
v_mov_b32 v245, s52
v_add_u32 v245, 4096, v245
buffer_load_dwordx4 v237, s[16:19], s48 offen nt lds
s_add_u32 m0, s49, 4224
s_add_u32 s48, s55, 4096
v_bfe_u32 v49, v48, 0, 2
buffer_load_dwordx4 v237, s[16:19], s48 offen nt lds
s_add_u32 m0, s49, 6336
s_add_u32 s48, s55, 6144
s_mov_b32 vcc_lo, 0x11111111
s_mov_b32 vcc_hi, 0x11111111
buffer_load_dwordx4 v237, s[16:19], s48 offen nt lds
s_add_u32 m0, s54, 50688
v_lshl_add_u32 v245, v49, 7, v245
v_mov_b32 v254, 150528
v_lshlrev_b32 v49, 4, v48
buffer_load_dwordx4 v50, s[28:31], s54 offen offset:0 lds
v_cndmask_b32 v240, v254, v240, vcc
v_xor_b32 v49, v49, v48
v_and_b32 v49, 48, v49
buffer_load_dwordx4 v51, s[28:31], s54 offen offset:1024 lds
s_mov_b32 vcc_lo, 0xf000f
s_mov_b32 vcc_hi, 0xf000f
v_add_u32 v245, v49, v245
buffer_load_dwordx4 v50, s[28:31], s54 offen offset:2048 lds
v_cndmask_b32 v242, v254, v245, vcc
s_mov_b32 vcc_lo, 0xf000f0
s_mov_b32 vcc_hi, 0xf000f0
buffer_load_dwordx4 v51, s[28:31], s54 offen offset:3072 lds
s_add_u32 m0, s57, 50688
v_cndmask_b32 v243, v254, v245, vcc
s_mov_b32 vcc_lo, 0xf000f00
s_mov_b32 vcc_hi, 0xf000f00
buffer_load_dwordx4 v50, s[28:31], s57 offen offset:0 lds
v_cndmask_b32 v244, v254, v245, vcc
s_mov_b32 vcc_lo, 0xf000f000
s_mov_b32 vcc_hi, 0xf000f000
v_mov_b32 v246, s52
buffer_load_dwordx4 v51, s[28:31], s57 offen offset:1024 lds
v_add_u32 v246, 4096, v246
v_bfe_u32 v49, v48, 0, 2
v_cndmask_b32 v245, v254, v245, vcc
buffer_load_dwordx4 v50, s[28:31], s57 offen offset:2048 lds
v_lshl_add_u32 v246, v49, 7, v246
v_mov_b32 v254, 154880
v_bfe_u32 v49, v48, 2, 2
buffer_load_dwordx4 v51, s[28:31], s57 offen offset:3072 lds
s_add_u32 m0, s49, 16896
s_mov_b32 vcc_lo, 0xf000f
s_mov_b32 vcc_hi, 0xf000f
v_lshl_add_u32 v254, v49, 3, v254
v_cndmask_b32 v246, v254, v246, vcc
v_xor_b32 v249, 32, v248
v_xor_b32 v250, 64, v248
v_xor_b32 v251, 96, v248
s_mul_i32 s4, s43, 13107200
s_add_u32 s4, s4, s44
s_add_u32 s4, s4, 24576
s_add_u32 s5, s55, 104857600
s_sub_u32 s5, s5, s4
s_add_u32 s48, s4, 0
v_xor_b32 v52, v53, v52
v_xor_b32 v55, 96, v54
v_xor_b32 v253, 64, v252
v_lshlrev_b32 v49, 4, v48
v_xor_b32 v49, v49, v48
v_and_b32 v49, 48, v49
v_add_u32 v246, v49, v246
v_add_u32 v246, v49, v246
v_mov_b32 v50, s52
v_bfe_u32 v49, v48, 0, 4
v_lshl_add_u32 v50, v49, 7, v50
v_lshlrev_b32 v49, 4, v48
v_xor_b32 v49, v49, v48
v_and_b32 v49, 48, v49
v_add_u32 v50, v49, v50
v_mov_b32 v51, s52
v_add_u32 v51, 8192, v51
v_bfe_u32 v49, v48, 4, 2
v_lshl_add_u32 v51, v49, 9, v51
v_bfe_u32 v49, v48, 0, 4
v_lshl_add_u32 v51, v49, 3, v51
s_add_u32 s50, s55, 13107200
s_mov_b32 s51, 2048
v_xor_b32 v247, 32, v48
s_mov_b32 s52, 0x7ff00000
v_lshlrev_b32 v247, 2, v247
s_waitcnt vmcnt(19)
v_and_b32 v254, 0xffff0000, v152
buffer_load_dwordx4 v237, s[16:19], s48 offen nt lds
s_add_u32 m0, s49, 19008
s_add_u32 s48, s4, 26214400
v_and_b32 v255, 0xffff0000, v153
v_lshlrev_b32 v152, 16, v152
v_lshlrev_b32 v153, 16, v153
v_mul_f32 v254, s40, v254
v_mul_f32 v152, s40, v152
v_mul_f32 v255, s40, v255
v_mul_f32 v153, s40, v153
v_cvt_pk_bf16_f32 v152, v152, v254
v_cvt_pk_bf16_f32 v153, v153, v255
v_and_b32 v254, 0xffff0000, v154
v_and_b32 v255, 0xffff0000, v155
v_lshlrev_b32 v154, 16, v154
v_lshlrev_b32 v155, 16, v155
v_mul_f32 v254, s40, v254
v_mul_f32 v154, s40, v154
v_mul_f32 v255, s40, v255
v_mul_f32 v155, s40, v155
v_cvt_pk_bf16_f32 v154, v154, v254
v_cvt_pk_bf16_f32 v155, v155, v255
s_waitcnt vmcnt(19)
v_and_b32 v254, 0xffff0000, v156
v_and_b32 v255, 0xffff0000, v157
v_lshlrev_b32 v156, 16, v156
v_lshlrev_b32 v157, 16, v157
v_mul_f32 v254, s40, v254
v_mul_f32 v156, s40, v156
v_mul_f32 v255, s40, v255
v_mul_f32 v157, s40, v157
v_cvt_pk_bf16_f32 v156, v156, v254
buffer_load_dwordx4 v237, s[16:19], s48 offen nt lds
s_add_u32 m0, s49, 21120
s_add_u32 s48, s4, 52428800
v_cvt_pk_bf16_f32 v157, v157, v255
v_and_b32 v254, 0xffff0000, v158
v_and_b32 v255, 0xffff0000, v159
v_lshlrev_b32 v158, 16, v158
v_lshlrev_b32 v159, 16, v159
v_mul_f32 v254, s40, v254
v_mul_f32 v158, s40, v158
v_mul_f32 v255, s40, v255
v_mul_f32 v159, s40, v159
v_cvt_pk_bf16_f32 v158, v158, v254
v_cvt_pk_bf16_f32 v159, v159, v255
s_waitcnt vmcnt(19)
v_and_b32 v254, 0xffff0000, v160
v_and_b32 v255, 0xffff0000, v161
v_lshlrev_b32 v160, 16, v160
v_lshlrev_b32 v161, 16, v161
v_mul_f32 v254, s40, v254
v_mul_f32 v160, s40, v160
v_mul_f32 v255, s40, v255
v_mul_f32 v161, s40, v161
v_cvt_pk_bf16_f32 v160, v160, v254
v_cvt_pk_bf16_f32 v161, v161, v255
v_and_b32 v254, 0xffff0000, v162
v_and_b32 v255, 0xffff0000, v163
v_lshlrev_b32 v162, 16, v162
v_lshlrev_b32 v163, 16, v163
v_mul_f32 v254, s40, v254
v_mul_f32 v162, s40, v162
v_mul_f32 v255, s40, v255
v_mul_f32 v163, s40, v163
v_cvt_pk_bf16_f32 v162, v162, v254
buffer_load_dwordx4 v237, s[16:19], s48 offen nt lds
s_add_u32 m0, s49, 23232
s_add_u32 s48, s4, 78643200
ds_write_b128 v104, v[152:155] offset:0
ds_write_b128 v105, v[156:159] offset:1024
v_cvt_pk_bf16_f32 v163, v163, v255
s_waitcnt vmcnt(19)
v_and_b32 v254, 0xffff0000, v164
v_and_b32 v255, 0xffff0000, v165
v_lshlrev_b32 v164, 16, v164
v_lshlrev_b32 v165, 16, v165
v_mul_f32 v254, s40, v254
v_mul_f32 v164, s40, v164
v_mul_f32 v255, s40, v255
v_mul_f32 v165, s40, v165
v_cvt_pk_bf16_f32 v164, v164, v254
v_cvt_pk_bf16_f32 v165, v165, v255
v_and_b32 v254, 0xffff0000, v166
v_and_b32 v255, 0xffff0000, v167
v_lshlrev_b32 v166, 16, v166
v_lshlrev_b32 v167, 16, v167
v_mul_f32 v254, s40, v254
buffer_load_dwordx4 v237, s[16:19], s48 offen nt lds
s_add_u32 m0, s54, 116224
s_add_u32 s48, s55, 8192
ds_write_b128 v104, v[160:163] offset:2048
v_mul_f32 v166, s40, v166
v_mul_f32 v255, s40, v255
v_mul_f32 v167, s40, v167
v_cvt_pk_bf16_f32 v166, v166, v254
v_cvt_pk_bf16_f32 v167, v167, v255
s_waitcnt vmcnt(19)
v_and_b32 v254, 0xffff0000, v168
v_and_b32 v255, 0xffff0000, v169
v_lshlrev_b32 v168, 16, v168
v_lshlrev_b32 v169, 16, v169
v_mul_f32 v254, s40, v254
v_mul_f32 v168, s40, v168
v_mul_f32 v255, s40, v255
v_mul_f32 v169, s40, v169
v_cvt_pk_bf16_f32 v168, v168, v254
v_cvt_pk_bf16_f32 v169, v169, v255
v_and_b32 v254, 0xffff0000, v170
v_and_b32 v255, 0xffff0000, v171
v_lshlrev_b32 v170, 16, v170
v_lshlrev_b32 v171, 16, v171
v_mul_f32 v254, s40, v254
v_mul_f32 v170, s40, v170
v_mul_f32 v255, s40, v255
v_mul_f32 v171, s40, v171
buffer_load_dwordx4 v52, s[32:35], s54 offen offset:0 lds
ds_write_b128 v105, v[164:167] offset:3072
v_cvt_pk_bf16_f32 v170, v170, v254
v_cvt_pk_bf16_f32 v171, v171, v255
s_waitcnt vmcnt(19)
v_and_b32 v254, 0xffff0000, v172
v_and_b32 v255, 0xffff0000, v173
v_lshlrev_b32 v172, 16, v172
v_lshlrev_b32 v173, 16, v173
v_mul_f32 v254, s40, v254
v_mul_f32 v172, s40, v172
v_mul_f32 v255, s40, v255
v_mul_f32 v173, s40, v173
v_cvt_pk_bf16_f32 v172, v172, v254
v_cvt_pk_bf16_f32 v173, v173, v255
v_and_b32 v254, 0xffff0000, v174
v_and_b32 v255, 0xffff0000, v175
v_lshlrev_b32 v174, 16, v174
v_lshlrev_b32 v175, 16, v175
v_mul_f32 v254, s40, v254
v_mul_f32 v174, s40, v174
v_mul_f32 v255, s40, v255
v_mul_f32 v175, s40, v175
v_cvt_pk_bf16_f32 v174, v174, v254
v_cvt_pk_bf16_f32 v175, v175, v255
s_waitcnt vmcnt(18)
v_and_b32 v254, 0xffff0000, v176
v_and_b32 v255, 0xffff0000, v177
v_lshlrev_b32 v176, 16, v176
buffer_load_dwordx4 v52, s[32:35], s54 offen offset:1024 lds
ds_write_b128 v104, v[168:171] offset:4096
v_lshlrev_b32 v177, 16, v177
v_mul_f32 v254, s40, v254
v_mul_f32 v176, s40, v176
v_mul_f32 v255, s40, v255
v_mul_f32 v177, s40, v177
v_cvt_pk_bf16_f32 v176, v176, v254
v_cvt_pk_bf16_f32 v177, v177, v255
v_and_b32 v254, 0xffff0000, v178
v_and_b32 v255, 0xffff0000, v179
v_lshlrev_b32 v178, 16, v178
v_lshlrev_b32 v179, 16, v179
v_mul_f32 v254, s40, v254
v_mul_f32 v178, s40, v178
v_mul_f32 v255, s40, v255
v_mul_f32 v179, s40, v179
v_cvt_pk_bf16_f32 v178, v178, v254
v_cvt_pk_bf16_f32 v179, v179, v255
s_waitcnt vmcnt(18)
v_and_b32 v254, 0xffff0000, v180
v_and_b32 v255, 0xffff0000, v181
v_lshlrev_b32 v180, 16, v180
v_lshlrev_b32 v181, 16, v181
v_mul_f32 v254, s40, v254
v_mul_f32 v180, s40, v180
v_mul_f32 v255, s40, v255
v_mul_f32 v181, s40, v181
buffer_load_dwordx4 v52, s[32:35], s54 offen offset:2048 lds
ds_write_b128 v105, v[172:175] offset:5120
ds_write_b128 v104, v[176:179] offset:6144
v_cvt_pk_bf16_f32 v180, v180, v254
v_cvt_pk_bf16_f32 v181, v181, v255
v_and_b32 v254, 0xffff0000, v182
v_and_b32 v255, 0xffff0000, v183
v_lshlrev_b32 v182, 16, v182
v_lshlrev_b32 v183, 16, v183
v_mul_f32 v254, s40, v254
v_mul_f32 v182, s40, v182
v_mul_f32 v255, s40, v255
v_mul_f32 v183, s40, v183
v_cvt_pk_bf16_f32 v182, v182, v254
v_cvt_pk_bf16_f32 v183, v183, v255
ds_write_b128 v105, v[180:183] offset:7168
buffer_load_dwordx4 v52, s[32:35], s54 offen offset:3072 lds
s_add_u32 m0, s57, 116224
v_xor_b32 v254, 32, v54
v_xor_b32 v255, 64, v54
s_mov_b32 s53, 0x7ff00000
buffer_load_dwordx4 v52, s[32:35], s57 offen offset:0 lds
buffer_load_dwordx4 v52, s[32:35], s57 offen offset:1024 lds
s_waitcnt vmcnt(10) lgkmcnt(0)
s_barrier
ds_read_b64_tr_b16 a[64:65], v248 offset:0
ds_read_b64_tr_b16 a[66:67], v248 offset:512
ds_read_b128 v[188:191], v236 offset:0
ds_read_b64_tr_b16 a[68:69], v248 offset:4096
ds_read_b64_tr_b16 a[70:71], v248 offset:4608
buffer_load_dwordx4 v52, s[32:35], s57 offen offset:2048 lds
ds_read_b128 v[196:199], v236 offset:256
ds_read_b64_tr_b16 a[72:73], v248 offset:8192
ds_read_b64_tr_b16 a[74:75], v248 offset:8704
ds_read_b128 v[200:203], v236 offset:512
ds_read_b64_tr_b16 a[76:77], v248 offset:12288
ds_read_b64_tr_b16 a[78:79], v248 offset:12800
ds_read_b128 v[204:207], v236 offset:768
ds_read_b64_tr_b16 a[92:93], v249 offset:12288
ds_read_b64_tr_b16 a[94:95], v249 offset:12800
ds_read_b64_tr_b16 a[88:89], v249 offset:8192
ds_read_b64_tr_b16 a[90:91], v249 offset:8704
ds_read_b64_tr_b16 a[84:85], v249 offset:4096
ds_read_b64_tr_b16 a[86:87], v249 offset:4608
ds_read_b64_tr_b16 a[80:81], v249 offset:0
ds_read_b64_tr_b16 a[82:83], v249 offset:512
s_waitcnt lgkmcnt(15)
v_mfma_f32_16x16x32_bf16 v[192:195], a[64:67], v[188:191], 0
ds_read_b64_tr_b16 a[96:97], v250 offset:0
ds_read_b64_tr_b16 a[98:99], v250 offset:512
s_waitcnt lgkmcnt(15)
v_mfma_f32_16x16x32_bf16 v[192:195], a[68:71], v[196:199], v[192:195]
s_waitcnt lgkmcnt(14)
ds_read_b64_tr_b16 a[100:101], v250 offset:4096
s_waitcnt lgkmcnt(14)
v_mfma_f32_16x16x32_bf16 v[192:195], a[72:75], v[200:203], v[192:195]
s_waitcnt lgkmcnt(11)
ds_read_b64_tr_b16 a[102:103], v250 offset:4608
ds_read_b64_tr_b16 a[104:105], v250 offset:8192
v_mfma_f32_16x16x32_bf16 v[192:195], a[76:79], v[204:207], v[192:195]
s_waitcnt lgkmcnt(9)
ds_read_b64_tr_b16 a[106:107], v250 offset:8704
ds_read_b64_tr_b16 a[108:109], v250 offset:12288
v_mfma_f32_16x16x32_bf16 v[208:211], a[92:95], v[204:207], 0
s_waitcnt lgkmcnt(7)
buffer_load_dwordx4 v52, s[32:35], s57 offen offset:3072 lds
s_add_u32 m0, s49, 8448
v_mfma_f32_16x16x32_bf16 v[208:211], a[88:91], v[200:203], v[208:211]
ds_read_b64_tr_b16 a[110:111], v250 offset:12800
v_cvt_pk_bf16_f32 v0, v192, v193
v_mfma_f32_16x16x32_bf16 v[208:211], a[84:87], v[196:199], v[208:211]
s_waitcnt lgkmcnt(6)
ds_read_b64_tr_b16 a[124:125], v251 offset:12288
v_cvt_pk_bf16_f32 v1, v194, v195
v_mfma_f32_16x16x32_bf16 v[208:211], a[80:83], v[188:191], v[208:211]
s_waitcnt lgkmcnt(6)
ds_read_b64_tr_b16 a[126:127], v251 offset:12800
ds_read_b64_tr_b16 a[120:121], v251 offset:8192
v_mfma_f32_16x16x32_bf16 v[192:195], a[96:99], v[188:191], 0
s_waitcnt lgkmcnt(6)
ds_read_b64_tr_b16 a[122:123], v251 offset:8704
ds_read_b64_tr_b16 a[116:117], v251 offset:4096
v_mfma_f32_16x16x32_bf16 v[192:195], a[100:103], v[196:199], v[192:195]
s_waitcnt lgkmcnt(6)
ds_read_b64_tr_b16 a[118:119], v251 offset:4608
v_cvt_pk_bf16_f32 v2, v208, v209
v_mfma_f32_16x16x32_bf16 v[192:195], a[104:107], v[200:203], v[192:195]
ds_read_b64_tr_b16 a[112:113], v251 offset:0
s_waitcnt lgkmcnt(7)
v_mfma_f32_16x16x32_bf16 v[192:195], a[108:111], v[204:207], v[192:195]
ds_read_b64_tr_b16 a[114:115], v251 offset:512
v_cvt_pk_bf16_f32 v3, v210, v211
ds_read_b128 v[184:187], v236 offset:4992
s_waitcnt lgkmcnt(7)
v_mfma_f32_16x16x32_bf16 v[208:211], a[124:127], v[204:207], 0
s_waitcnt lgkmcnt(6)
buffer_load_dwordx4 v[120:123], v53, s[36:39], s54 offen offset:0
s_waitcnt lgkmcnt(5)
v_mfma_f32_16x16x32_bf16 v[208:211], a[120:123], v[200:203], v[208:211]
s_waitcnt lgkmcnt(4)
ds_read_b128 v[216:219], v236 offset:4736
s_waitcnt lgkmcnt(4)
v_mfma_f32_16x16x32_bf16 v[208:211], a[116:119], v[196:199], v[208:211]
ds_read_b128 v[204:207], v236 offset:4480
v_cvt_pk_bf16_f32 v5, v194, v195
v_cvt_pk_bf16_f32 v4, v192, v193
s_waitcnt lgkmcnt(3)
v_mfma_f32_16x16x32_bf16 v[208:211], a[112:115], v[188:191], v[208:211]
ds_read_b128 v[192:195], v236 offset:4224
s_waitcnt lgkmcnt(3)
v_mfma_f32_16x16x32_bf16 v[200:203], a[124:127], v[184:187], 0
ds_read_b64_tr_b16 a[0:1], v248 offset:32768
ds_read_b64_tr_b16 a[2:3], v248 offset:33280
v_mfma_f32_16x16x32_bf16 v[220:223], a[92:95], v[184:187], 0
ds_read_b64_tr_b16 a[4:5], v248 offset:36864
s_waitcnt lgkmcnt(5)
v_mfma_f32_16x16x32_bf16 v[200:203], a[120:123], v[216:219], v[200:203]
ds_read_b64_tr_b16 a[6:7], v248 offset:37376
s_waitcnt lgkmcnt(5)
v_mfma_f32_16x16x32_bf16 v[200:203], a[116:119], v[204:207], v[200:203]
ds_read_b64_tr_b16 a[8:9], v248 offset:40960
v_cvt_pk_bf16_f32 v6, v208, v209
v_mfma_f32_16x16x32_bf16 v[220:223], a[88:91], v[216:219], v[220:223]
buffer_load_dwordx4 v[124:127], v53, s[36:39], s54 offen offset:1024
s_waitcnt lgkmcnt(5)
v_mfma_f32_16x16x32_bf16 v[200:203], a[112:115], v[192:195], v[200:203]
ds_read_b64_tr_b16 a[10:11], v248 offset:41472
v_cvt_pk_bf16_f32 v7, v210, v211
v_mfma_f32_16x16x32_bf16 v[208:211], a[96:99], v[192:195], 0
s_waitcnt lgkmcnt(4)
ds_read_b64_tr_b16 a[12:13], v248 offset:45056
ds_read_b64_tr_b16 a[14:15], v248 offset:45568
v_mfma_f32_16x16x32_bf16 v[208:211], a[100:103], v[204:207], v[208:211]
s_waitcnt lgkmcnt(5)
ds_read_b64_tr_b16 a[16:17], v249 offset:32768
ds_read_b64_tr_b16 a[18:19], v249 offset:33280
v_mfma_f32_16x16x32_bf16 v[208:211], a[104:107], v[216:219], v[208:211]
s_waitcnt lgkmcnt(6)
ds_read_b64_tr_b16 a[20:21], v249 offset:36864
ds_read_b64_tr_b16 a[22:23], v249 offset:37376
v_mfma_f32_16x16x32_bf16 v[208:211], a[108:111], v[184:187], v[208:211]
s_waitcnt lgkmcnt(7)
ds_read_b64_tr_b16 a[24:25], v249 offset:40960
ds_read_b64_tr_b16 a[26:27], v249 offset:41472
v_mfma_f32_16x16x32_bf16 v[220:223], a[84:87], v[204:207], v[220:223]
ds_read_b64_tr_b16 a[28:29], v249 offset:45056
ds_read_b64_tr_b16 a[30:31], v249 offset:45568
v_mfma_f32_16x16x32_bf16 v[220:223], a[80:83], v[192:195], v[220:223]
s_waitcnt lgkmcnt(10)
ds_read_b64_tr_b16 a[32:33], v250 offset:32768
ds_read_b64_tr_b16 a[34:35], v250 offset:33280
v_mfma_f32_16x16x32_bf16 v[188:191], a[64:67], v[192:195], 0
s_waitcnt lgkmcnt(10)
ds_read_b64_tr_b16 a[36:37], v250 offset:36864
ds_read_b64_tr_b16 a[38:39], v250 offset:37376
v_mfma_f32_16x16x32_bf16 v[188:191], a[72:75], v[216:219], v[188:191]
s_waitcnt lgkmcnt(10)
buffer_load_dwordx4 v[128:131], v53, s[36:39], s54 offen offset:2048
ds_read_b64_tr_b16 a[40:41], v250 offset:40960
v_mfma_f32_16x16x32_bf16 v[188:191], a[76:79], v[184:187], v[188:191]
s_waitcnt lgkmcnt(9)
ds_read_b64_tr_b16 a[42:43], v250 offset:41472
ds_read_b64_tr_b16 a[44:45], v250 offset:45056
v_mfma_f32_16x16x32_bf16 v[188:191], a[68:71], v[204:207], v[188:191]
s_waitcnt lgkmcnt(9)
ds_read_b64_tr_b16 a[46:47], v250 offset:45568
ds_read_b64_tr_b16 a[48:49], v251 offset:32768
ds_read_b64_tr_b16 a[50:51], v251 offset:33280
ds_read_b64_tr_b16 a[52:53], v251 offset:36864
ds_read_b64_tr_b16 a[54:55], v251 offset:37376
ds_read_b64_tr_b16 a[56:57], v251 offset:40960
ds_read_b64_tr_b16 a[58:59], v251 offset:41472
s_waitcnt vmcnt(11)
s_barrier
ds_read_b128 v[56:59], v236 offset:16896
ds_read_b128 v[60:63], v236 offset:17152
ds_read_b128 v[64:67], v236 offset:17408
ds_read_b128 v[68:71], v236 offset:17664
ds_read_b128 v[72:75], v236 offset:21120
ds_read_b128 v[76:79], v236 offset:21376
ds_read_b128 v[80:83], v236 offset:21632
ds_read_b128 v[84:87], v236 offset:21888
ds_read_b64_tr_b16 a[60:61], v251 offset:45056
ds_read_b64_tr_b16 a[62:63], v251 offset:45568
v_cvt_pk_bf16_f32 v14, v200, v201
buffer_load_dwordx4 v[132:135], v53, s[36:39], s54 offen offset:3072
v_cvt_pk_bf16_f32 v15, v202, v203
v_cvt_pk_bf16_f32 v9, v190, v191
v_cvt_pk_bf16_f32 v8, v188, v189
v_cvt_pk_bf16_f32 v13, v210, v211
v_cvt_pk_bf16_f32 v12, v208, v209
v_cvt_pk_bf16_f32 v10, v220, v221
v_cvt_pk_bf16_f32 v11, v222, v223
s_waitcnt lgkmcnt(9)
v_mfma_f32_16x16x32_bf16 v[156:159], a[64:67], v[56:59], 0
s_waitcnt lgkmcnt(7)
v_mfma_f32_16x16x32_bf16 v[156:159], a[68:71], v[60:63], v[156:159]
s_waitcnt lgkmcnt(3)
v_mfma_f32_16x16x32_bf16 v[156:159], a[72:75], v[64:67], v[156:159]
s_waitcnt lgkmcnt(0)
v_mfma_f32_16x16x32_bf16 v[156:159], a[76:79], v[68:71], v[156:159]
s_nop 2
v_mfma_f32_16x16x32_bf16 v[160:163], a[92:95], v[68:71], 0
s_nop 2
v_mfma_f32_16x16x32_bf16 v[160:163], a[88:91], v[64:67], v[160:163]
s_waitcnt vmcnt(4)
s_barrier
v_mfma_f32_16x16x32_bf16 v[160:163], a[84:87], v[60:63], v[160:163]
buffer_load_dwordx4 v[136:139], v53, s[36:39], s57 offen offset:0
ds_read_b64_tr_b16 a[128:129], v252 offset:0
v_mfma_f32_16x16x32_bf16 v[160:163], a[80:83], v[56:59], v[160:163]
ds_read_b64_tr_b16 a[130:131], v252 offset:512
ds_read_b64_tr_b16 a[132:133], v252 offset:4096
v_mfma_f32_16x16x32_bf16 v[164:167], a[96:99], v[56:59], 0
ds_read_b64_tr_b16 a[134:135], v252 offset:4608
ds_read_b64_tr_b16 a[136:137], v252 offset:8192
v_mfma_f32_16x16x32_bf16 v[164:167], a[100:103], v[60:63], v[164:167]
ds_read_b64_tr_b16 a[138:139], v252 offset:8704
ds_read_b64_tr_b16 a[140:141], v252 offset:12288
v_mfma_f32_16x16x32_bf16 v[164:167], a[104:107], v[64:67], v[164:167]
ds_read_b64_tr_b16 a[142:143], v252 offset:12800
ds_read_b64_tr_b16 a[144:145], v252 offset:8
v_mfma_f32_16x16x32_bf16 v[164:167], a[108:111], v[68:71], v[164:167]
ds_read_b64_tr_b16 a[146:147], v252 offset:520
ds_read_b64_tr_b16 a[148:149], v252 offset:4104
v_mfma_f32_16x16x32_bf16 v[168:171], a[124:127], v[68:71], 0
s_waitcnt lgkmcnt(10)
ds_read_b64_tr_b16 a[150:151], v252 offset:4616
v_cvt_pk_bf16_f32 v88, v156, v157
v_mfma_f32_16x16x32_bf16 v[168:171], a[120:123], v[64:67], v[168:171]
s_waitcnt lgkmcnt(9)
ds_read_b64_tr_b16 a[152:153], v252 offset:8200
v_cvt_pk_bf16_f32 v89, v158, v159
v_mfma_f32_16x16x32_bf16 v[168:171], a[116:119], v[60:63], v[168:171]
s_waitcnt lgkmcnt(8)
ds_read_b64_tr_b16 a[154:155], v252 offset:8712
ds_read_b64_tr_b16 a[156:157], v252 offset:12296
v_mfma_f32_16x16x32_bf16 v[168:171], a[112:115], v[56:59], v[168:171]
s_waitcnt lgkmcnt(8)
buffer_load_dwordx4 v[140:143], v53, s[36:39], s57 offen offset:1024
ds_read_b64_tr_b16 a[158:159], v252 offset:12808
v_mfma_f32_16x16x32_bf16 v[172:175], a[64:67], v[72:75], 0
s_waitcnt lgkmcnt(7)
ds_read_b64_tr_b16 a[160:161], v253 offset:0
v_cvt_pk_bf16_f32 v90, v160, v161
v_mfma_f32_16x16x32_bf16 v[172:175], a[68:71], v[76:79], v[172:175]
s_waitcnt lgkmcnt(6)
ds_read_b64_tr_b16 a[162:163], v253 offset:512
v_cvt_pk_bf16_f32 v91, v162, v163
v_mfma_f32_16x16x32_bf16 v[172:175], a[72:75], v[80:83], v[172:175]
s_waitcnt lgkmcnt(6)
ds_read_b64_tr_b16 a[164:165], v253 offset:4096
ds_read_b64_tr_b16 a[166:167], v253 offset:4608
v_mfma_f32_16x16x32_bf16 v[172:175], a[76:79], v[84:87], v[172:175]
s_waitcnt lgkmcnt(7)
ds_read_b64_tr_b16 a[168:169], v253 offset:8192
ds_read_b64_tr_b16 a[170:171], v253 offset:8704
v_mfma_f32_16x16x32_bf16 v[176:179], a[92:95], v[84:87], 0
s_waitcnt lgkmcnt(7)
ds_read_b64_tr_b16 a[172:173], v253 offset:12288
v_cvt_pk_bf16_f32 v92, v164, v165
v_mfma_f32_16x16x32_bf16 v[176:179], a[88:91], v[80:83], v[176:179]
s_waitcnt lgkmcnt(7)
ds_read_b64_tr_b16 a[174:175], v253 offset:12800
v_cvt_pk_bf16_f32 v93, v166, v167
v_mfma_f32_16x16x32_bf16 v[176:179], a[84:87], v[76:79], v[176:179]
s_waitcnt lgkmcnt(7)
ds_read_b64_tr_b16 a[176:177], v253 offset:8
ds_read_b64_tr_b16 a[178:179], v253 offset:520
v_mfma_f32_16x16x32_bf16 v[176:179], a[80:83], v[72:75], v[176:179]
s_waitcnt lgkmcnt(8)
ds_read_b64_tr_b16 a[180:181], v253 offset:4104
ds_read_b64_tr_b16 a[182:183], v253 offset:4616
v_mfma_f32_16x16x32_bf16 v[180:183], a[96:99], v[72:75], 0
s_waitcnt lgkmcnt(8)
buffer_load_dwordx4 v[144:147], v53, s[36:39], s57 offen offset:2048
v_cvt_pk_bf16_f32 v94, v168, v169
v_mfma_f32_16x16x32_bf16 v[180:183], a[100:103], v[76:79], v[180:183]
s_waitcnt lgkmcnt(6)
ds_read_b64_tr_b16 a[184:185], v253 offset:8200
v_cvt_pk_bf16_f32 v95, v170, v171
v_mfma_f32_16x16x32_bf16 v[180:183], a[104:107], v[80:83], v[180:183]
s_waitcnt lgkmcnt(6)
ds_read_b64_tr_b16 a[186:187], v253 offset:8712
ds_read_b64_tr_b16 a[188:189], v253 offset:12296
v_mfma_f32_16x16x32_bf16 v[180:183], a[108:111], v[84:87], v[180:183]
s_waitcnt lgkmcnt(7)
ds_read_b64_tr_b16 a[190:191], v253 offset:12808
v_cvt_pk_bf16_f32 v96, v172, v173
v_mfma_f32_16x16x32_bf16 v[152:155], a[124:127], v[84:87], 0
s_waitcnt lgkmcnt(6)
v_cvt_pk_bf16_f32 v97, v174, v175
v_cvt_pk_bf16_f32 v98, v176, v177
v_mfma_f32_16x16x32_bf16 v[152:155], a[120:123], v[80:83], v[152:155]
s_waitcnt lgkmcnt(4)
v_cvt_pk_bf16_f32 v99, v178, v179
v_cvt_pk_bf16_f32 v100, v180, v181
v_mfma_f32_16x16x32_bf16 v[152:155], a[116:119], v[76:79], v[152:155]
v_cvt_pk_bf16_f32 v101, v182, v183
v_mov_b32 v253, 0
v_mfma_f32_16x16x32_bf16 v[152:155], a[112:115], v[72:75], v[152:155]
s_waitcnt lgkmcnt(3)
v_mov_b32 v252, 1.0
s_nop 0
v_mfma_f32_16x16x32_bf16 v[156:159], a[0:3], v[56:59], 0
s_waitcnt lgkmcnt(1)
s_nop 1
v_mfma_f32_16x16x32_bf16 v[156:159], a[4:7], v[60:63], v[156:159]
s_waitcnt lgkmcnt(0)
buffer_load_dwordx4 v[148:151], v53, s[36:39], s57 offen offset:3072
v_cvt_pk_bf16_f32 v102, v152, v153
v_mfma_f32_16x16x32_bf16 v[156:159], a[8:11], v[64:67], v[156:159]
v_cvt_pk_bf16_f32 v103, v154, v155
v_mfma_f32_16x16x32_bf16 v[156:159], a[12:15], v[68:71], v[156:159]
s_nop 2
v_mfma_f32_16x16x32_bf16 v[160:163], a[28:31], v[68:71], 0
s_nop 2
v_mfma_f32_16x16x32_bf16 v[160:163], a[24:27], v[64:67], v[160:163]
v_cvt_pk_bf16_f32 v104, v156, v157
v_cvt_pk_bf16_f32 v105, v158, v159
v_mfma_f32_16x16x32_bf16 v[160:163], a[20:23], v[60:63], v[160:163]
v_mfma_f32_16x16x32_bf16 v[160:163], a[16:19], v[56:59], v[160:163]
s_nop 2
v_mfma_f32_16x16x32_bf16 v[164:167], a[32:35], v[56:59], 0
s_nop 2
v_mfma_f32_16x16x32_bf16 v[164:167], a[36:39], v[60:63], v[164:167]
v_cvt_pk_bf16_f32 v106, v160, v161
v_cvt_pk_bf16_f32 v107, v162, v163
v_mfma_f32_16x16x32_bf16 v[164:167], a[40:43], v[64:67], v[164:167]
buffer_load_dwordx4 v237, s[16:19], s48 offen nt lds
s_add_u32 m0, s49, 10560
v_mfma_f32_16x16x32_bf16 v[164:167], a[44:47], v[68:71], v[164:167]
s_add_u32 s48, s55, 10240
s_nop 1
v_mfma_f32_16x16x32_bf16 v[168:171], a[60:63], v[68:71], 0
s_nop 2
v_mfma_f32_16x16x32_bf16 v[168:171], a[56:59], v[64:67], v[168:171]
v_cvt_pk_bf16_f32 v108, v164, v165
v_cvt_pk_bf16_f32 v109, v166, v167
v_mfma_f32_16x16x32_bf16 v[168:171], a[52:55], v[60:63], v[168:171]
v_mfma_f32_16x16x32_bf16 v[168:171], a[48:51], v[56:59], v[168:171]
s_nop 2
v_mfma_f32_16x16x32_bf16 v[172:175], a[0:3], v[72:75], 0
s_waitcnt vmcnt(8)
ds_write_b64 v54, v[120:121] offset:0
v_mfma_f32_16x16x32_bf16 v[172:175], a[4:7], v[76:79], v[172:175]
ds_write_b64 v254, v[122:123] offset:0
v_mfma_f32_16x16x32_bf16 v[172:175], a[8:11], v[80:83], v[172:175]
buffer_load_dwordx4 v237, s[16:19], s48 offen nt lds
v_mfma_f32_16x16x32_bf16 v[172:175], a[12:15], v[84:87], v[172:175]
s_add_u32 m0, s49, 12672
s_add_u32 s48, s55, 12288
v_cvt_pk_bf16_f32 v110, v168, v169
v_mfma_f32_16x16x32_bf16 v[176:179], a[28:31], v[84:87], 0
s_waitcnt vmcnt(8)
ds_write_b64 v54, v[124:125] offset:512
v_mfma_f32_16x16x32_bf16 v[176:179], a[24:27], v[80:83], v[176:179]
ds_write_b64 v254, v[126:127] offset:512
v_mfma_f32_16x16x32_bf16 v[176:179], a[20:23], v[76:79], v[176:179]
s_waitcnt vmcnt(7)
ds_write_b64 v255, v[128:129] offset:1024
v_mfma_f32_16x16x32_bf16 v[176:179], a[16:19], v[72:75], v[176:179]
ds_write_b64 v55, v[130:131] offset:1024
v_mfma_f32_16x16x32_bf16 v[180:183], a[32:35], v[72:75], 0
s_waitcnt vmcnt(6)
ds_write_b64 v255, v[132:133] offset:1536
v_mfma_f32_16x16x32_bf16 v[180:183], a[36:39], v[76:79], v[180:183]
ds_write_b64 v55, v[134:135] offset:1536
v_mfma_f32_16x16x32_bf16 v[180:183], a[40:43], v[80:83], v[180:183]
buffer_load_dwordx4 v237, s[16:19], s48 offen nt lds
s_add_u32 m0, s49, 14784
v_mfma_f32_16x16x32_bf16 v[180:183], a[44:47], v[84:87], v[180:183]
s_add_u32 s48, s55, 14336
v_cvt_pk_bf16_f32 v111, v170, v171
v_cvt_pk_bf16_f32 v112, v172, v173
v_mfma_f32_16x16x32_bf16 v[152:155], a[60:63], v[84:87], 0
s_waitcnt vmcnt(6)
ds_write_b64 v54, v[136:137] offset:2048
v_mfma_f32_16x16x32_bf16 v[152:155], a[56:59], v[80:83], v[152:155]
ds_write_b64 v254, v[138:139] offset:2048
v_mfma_f32_16x16x32_bf16 v[152:155], a[52:55], v[76:79], v[152:155]
s_waitcnt vmcnt(5)
ds_write_b64 v54, v[140:141] offset:2560
v_mfma_f32_16x16x32_bf16 v[152:155], a[48:51], v[72:75], v[152:155]
ds_write_b64 v254, v[142:143] offset:2560
v_mfma_f32_16x16x32_bf16 v[156:159], v[56:59], a[128:131], 0
s_waitcnt vmcnt(4)
ds_write_b64 v255, v[144:145] offset:3072
v_mfma_f32_16x16x32_bf16 v[156:159], v[60:63], a[132:135], v[156:159]
ds_write_b64 v55, v[146:147] offset:3072
v_mfma_f32_16x16x32_bf16 v[156:159], v[64:67], a[136:139], v[156:159]
buffer_load_dwordx4 v237, s[16:19], s48 offen nt lds
s_add_u32 m0, s49, 16896
v_mfma_f32_16x16x32_bf16 v[156:159], v[68:71], a[140:143], v[156:159]
s_add_u32 s48, s55, 16384
buffer_load_dwordx4 v237, s[16:19], s48 offen nt lds
s_add_u32 m0, s49, 19008
v_mfma_f32_16x16x32_bf16 v[160:163], v[68:71], a[156:159], 0
s_add_u32 s48, s55, 18432
buffer_load_dwordx4 v237, s[16:19], s48 offen nt lds
s_add_u32 m0, s49, 21120
v_mfma_f32_16x16x32_bf16 v[160:163], v[64:67], a[152:155], v[160:163]
s_add_u32 s48, s55, 20480
buffer_load_dwordx4 v237, s[16:19], s48 offen nt lds
s_add_u32 m0, s49, 23232
v_mfma_f32_16x16x32_bf16 v[160:163], v[60:63], a[148:151], v[160:163]
s_add_u32 s48, s55, 22528
buffer_load_dwordx4 v237, s[16:19], s48 offen nt lds
v_cvt_pk_bf16_f32 v113, v174, v175
v_mfma_f32_16x16x32_bf16 v[160:163], v[56:59], a[144:147], v[160:163]
s_add_u32 s49, s49, 50688
v_cvt_pk_bf16_f32 v114, v176, v177
v_cvt_pk_bf16_f32 v115, v178, v179
v_mfma_f32_16x16x32_bf16 v[164:167], v[56:59], a[160:163], 0
s_waitcnt vmcnt(8)
ds_write_b64 v255, v[148:149] offset:3584
v_mfma_f32_16x16x32_bf16 v[164:167], v[60:63], a[164:167], v[164:167]
ds_write_b64 v55, v[150:151] offset:3584
v_mfma_f32_16x16x32_bf16 v[164:167], v[64:67], a[168:171], v[164:167]
v_cvt_pk_bf16_f32 v116, v180, v181
v_cvt_pk_bf16_f32 v117, v182, v183
v_mfma_f32_16x16x32_bf16 v[164:167], v[68:71], a[172:175], v[164:167]
v_cvt_pk_bf16_f32 v118, v152, v153
v_cvt_pk_bf16_f32 v119, v154, v155
v_mfma_f32_16x16x32_bf16 v[168:171], v[68:71], a[188:191], 0
v_cvt_pk_bf16_f32 v156, v156, v157
v_cvt_pk_bf16_f32 v157, v158, v159
v_mfma_f32_16x16x32_bf16 v[168:171], v[64:67], a[184:187], v[168:171]
v_cvt_pk_bf16_f32 v160, v160, v161
v_cvt_pk_bf16_f32 v161, v162, v163
v_mfma_f32_16x16x32_bf16 v[168:171], v[60:63], a[180:183], v[168:171]
s_waitcnt lgkmcnt(0)
s_barrier
v_mfma_f32_16x16x32_bf16 v[168:171], v[56:59], a[176:179], v[168:171]
ds_read_b64_tr_b16 a[192:193], v248 offset:0
ds_read_b64_tr_b16 a[194:195], v248 offset:512
v_mfma_f32_16x16x32_bf16 v[172:175], v[72:75], a[128:131], 0
ds_read_b64_tr_b16 a[196:197], v248 offset:4096
ds_read_b64_tr_b16 a[198:199], v248 offset:4608
v_mfma_f32_16x16x32_bf16 v[172:175], v[76:79], a[132:135], v[172:175]
ds_read_b64_tr_b16 a[200:201], v248 offset:8192
ds_read_b64_tr_b16 a[202:203], v248 offset:8704
v_mfma_f32_16x16x32_bf16 v[172:175], v[80:83], a[136:139], v[172:175]
ds_read_b64_tr_b16 a[204:205], v248 offset:12288
ds_read_b64_tr_b16 a[206:207], v248 offset:12800
v_mfma_f32_16x16x32_bf16 v[172:175], v[84:87], a[140:143], v[172:175]
ds_read_b64_tr_b16 a[208:209], v249 offset:0
ds_read_b64_tr_b16 a[210:211], v249 offset:512
v_mfma_f32_16x16x32_bf16 v[176:179], v[84:87], a[156:159], 0
ds_read_b64_tr_b16 a[212:213], v249 offset:4096
ds_read_b64_tr_b16 a[214:215], v249 offset:4608
v_mfma_f32_16x16x32_bf16 v[176:179], v[80:83], a[152:155], v[176:179]
s_waitcnt lgkmcnt(10)
ds_read_b64_tr_b16 a[216:217], v249 offset:8192
ds_read_b64_tr_b16 a[218:219], v249 offset:8704
v_mfma_f32_16x16x32_bf16 v[176:179], v[76:79], a[148:151], v[176:179]
s_waitcnt lgkmcnt(10)
ds_read_b64_tr_b16 a[220:221], v249 offset:12288
ds_read_b64_tr_b16 a[222:223], v249 offset:12800
v_mfma_f32_16x16x32_bf16 v[176:179], v[72:75], a[144:147], v[176:179]
s_waitcnt lgkmcnt(10)
ds_read_b64_tr_b16 a[224:225], v250 offset:0
ds_read_b64_tr_b16 a[226:227], v250 offset:512
v_mfma_f32_16x16x32_bf16 v[180:183], v[72:75], a[160:163], 0
s_waitcnt lgkmcnt(10)
ds_read_b64_tr_b16 a[228:229], v250 offset:4096
ds_read_b64_tr_b16 a[230:231], v250 offset:4608
v_mfma_f32_16x16x32_bf16 v[180:183], v[76:79], a[164:167], v[180:183]
s_waitcnt lgkmcnt(10)
ds_read_b64_tr_b16 a[232:233], v250 offset:8192
ds_read_b64_tr_b16 a[234:235], v250 offset:8704
v_mfma_f32_16x16x32_bf16 v[180:183], v[80:83], a[168:171], v[180:183]
s_waitcnt lgkmcnt(10)
ds_read_b64_tr_b16 a[236:237], v250 offset:12288
ds_read_b64_tr_b16 a[238:239], v250 offset:12800
v_mfma_f32_16x16x32_bf16 v[180:183], v[84:87], a[172:175], v[180:183]
s_waitcnt lgkmcnt(10)
ds_read_b64_tr_b16 a[240:241], v251 offset:0
ds_read_b64_tr_b16 a[242:243], v251 offset:512
v_mfma_f32_16x16x32_bf16 v[152:155], v[84:87], a[188:191], 0
s_waitcnt lgkmcnt(10)
ds_read_b64_tr_b16 a[244:245], v251 offset:4096
ds_read_b64_tr_b16 a[246:247], v251 offset:4608
v_mfma_f32_16x16x32_bf16 v[152:155], v[80:83], a[184:187], v[152:155]
s_waitcnt lgkmcnt(10)
ds_read_b64_tr_b16 a[248:249], v251 offset:8192
ds_read_b64_tr_b16 a[250:251], v251 offset:8704
v_mfma_f32_16x16x32_bf16 v[152:155], v[76:79], a[180:183], v[152:155]
s_waitcnt lgkmcnt(10)
ds_read_b64_tr_b16 a[252:253], v251 offset:12288
ds_read_b64_tr_b16 a[254:255], v251 offset:12800
v_mfma_f32_16x16x32_bf16 v[152:155], v[72:75], a[176:179], v[152:155]
s_waitcnt lgkmcnt(10)
ds_write_b128 v50, v[88:91] offset:0
ds_write_b128 v50, v[104:107] offset:4096
ds_write_b64 v51, v[156:157] offset:0
ds_write_b128 v50, v[92:95] offset:64
ds_write_b128 v50, v[108:111] offset:4160
ds_write_b64 v51, v[160:161] offset:128
v_cvt_pk_bf16_f32 v164, v164, v165
v_cvt_pk_bf16_f32 v165, v166, v167
v_cvt_pk_bf16_f32 v168, v168, v169
v_cvt_pk_bf16_f32 v169, v170, v171
v_cvt_pk_bf16_f32 v172, v172, v173
v_cvt_pk_bf16_f32 v173, v174, v175
v_cvt_pk_bf16_f32 v176, v176, v177
v_cvt_pk_bf16_f32 v177, v178, v179
v_cvt_pk_bf16_f32 v180, v180, v181
v_cvt_pk_bf16_f32 v181, v182, v183
v_cvt_pk_bf16_f32 v152, v152, v153
v_cvt_pk_bf16_f32 v153, v154, v155
v_mov_b32 v105, 0
v_mov_b32 v107, 0
v_mov_b32 v109, 0
v_mov_b32 v111, 0
v_mov_b32 v133, 0
v_mov_b32 v134, 0
v_mov_b32 v135, 0
v_mov_b32 v149, 0
v_mov_b32 v150, 0
v_mov_b32 v151, 0
v_mov_b32 v248, 1.0
v_mov_b32 v249, 1.0
v_mov_b32 v251, 1.0
ds_write_b64 v51, v[164:165] offset:256
ds_write_b64 v51, v[168:169] offset:384
ds_write_b128 v50, v[96:99] offset:2048
ds_write_b128 v50, v[112:115] offset:6144
ds_write_b64 v51, v[172:173] offset:2048
ds_write_b64 v51, v[176:177] offset:2176
s_waitcnt vmcnt(4)
s_barrier
ds_read_b128 v[200:203], v236 offset:8704
ds_read_b128 v[212:215], v236 offset:8448
ds_read_b128 v[224:227], v236 offset:8960
ds_read_b128 v[228:231], v236 offset:9216
ds_read_b128 v[192:195], v236 offset:13440
ds_read_b128 v[204:207], v236 offset:12928
ds_read_b128 v[208:211], v236 offset:12672
ds_write_b128 v50, v[100:103] offset:2112
ds_write_b128 v50, v[116:119] offset:6208
s_waitcnt lgkmcnt(8)
v_mfma_f32_16x16x32_bf16 v[184:187], a[68:71], v[200:203], 0
s_waitcnt lgkmcnt(6)
ds_write_b64 v51, v[180:181] offset:2304
v_mfma_f32_16x16x32_bf16 v[184:187], a[64:67], v[212:215], v[184:187]
s_waitcnt lgkmcnt(2)
ds_write_b64 v51, v[152:153] offset:2432
v_mfma_f32_16x16x32_bf16 v[184:187], a[72:75], v[224:227], v[184:187]
v_mfma_f32_16x16x32_bf16 v[184:187], a[76:79], v[228:231], v[184:187]
s_nop 2
v_mfma_f32_16x16x32_bf16 v[188:191], a[92:95], v[228:231], 0
s_nop 2
v_mfma_f32_16x16x32_bf16 v[188:191], a[88:91], v[224:227], v[188:191]
v_cvt_pk_bf16_f32 v16, v184, v185
v_cvt_pk_bf16_f32 v17, v186, v187
v_mfma_f32_16x16x32_bf16 v[188:191], a[84:87], v[200:203], v[188:191]
ds_read_b128 v[184:187], v236 offset:13184
v_mfma_f32_16x16x32_bf16 v[188:191], a[80:83], v[212:215], v[188:191]
s_nop 2
v_mfma_f32_16x16x32_bf16 v[196:199], a[96:99], v[212:215], 0
s_nop 2
v_mfma_f32_16x16x32_bf16 v[196:199], a[100:103], v[200:203], v[196:199]
v_cvt_pk_bf16_f32 v18, v188, v189
v_cvt_pk_bf16_f32 v19, v190, v191
v_mfma_f32_16x16x32_bf16 v[196:199], a[104:107], v[224:227], v[196:199]
v_mfma_f32_16x16x32_bf16 v[196:199], a[108:111], v[228:231], v[196:199]
s_nop 2
v_mfma_f32_16x16x32_bf16 v[188:191], a[124:127], v[228:231], 0
s_waitcnt lgkmcnt(0)
s_nop 1
v_mfma_f32_16x16x32_bf16 v[188:191], a[116:119], v[200:203], v[188:191]
v_cvt_pk_bf16_f32 v21, v198, v199
v_cvt_pk_bf16_f32 v20, v196, v197
v_mfma_f32_16x16x32_bf16 v[188:191], a[112:115], v[212:215], v[188:191]
v_mfma_f32_16x16x32_bf16 v[188:191], a[120:123], v[224:227], v[188:191]
s_nop 2
v_mfma_f32_16x16x32_bf16 v[196:199], a[120:123], v[184:187], 0
s_nop 2
v_mfma_f32_16x16x32_bf16 v[196:199], a[124:127], v[192:195], v[196:199]
v_cvt_pk_bf16_f32 v23, v190, v191
v_cvt_pk_bf16_f32 v22, v188, v189
v_mfma_f32_16x16x32_bf16 v[196:199], a[116:119], v[204:207], v[196:199]
v_mfma_f32_16x16x32_bf16 v[196:199], a[112:115], v[208:211], v[196:199]
s_nop 2
v_mfma_f32_16x16x32_bf16 v[188:191], a[96:99], v[208:211], 0
s_nop 2
v_mfma_f32_16x16x32_bf16 v[188:191], a[100:103], v[204:207], v[188:191]
v_cvt_pk_bf16_f32 v30, v196, v197
v_cvt_pk_bf16_f32 v31, v198, v199
v_mfma_f32_16x16x32_bf16 v[188:191], a[104:107], v[184:187], v[188:191]
v_mfma_f32_16x16x32_bf16 v[188:191], a[108:111], v[192:195], v[188:191]
s_nop 2
v_mfma_f32_16x16x32_bf16 v[212:215], a[92:95], v[192:195], 0
s_nop 2
v_mfma_f32_16x16x32_bf16 v[212:215], a[88:91], v[184:187], v[212:215]
v_cvt_pk_bf16_f32 v29, v190, v191
v_cvt_pk_bf16_f32 v28, v188, v189
v_mfma_f32_16x16x32_bf16 v[212:215], a[84:87], v[204:207], v[212:215]
v_mfma_f32_16x16x32_bf16 v[212:215], a[80:83], v[208:211], v[212:215]
s_nop 2
v_mfma_f32_16x16x32_bf16 v[188:191], a[64:67], v[208:211], 0
s_nop 2
v_mfma_f32_16x16x32_bf16 v[188:191], a[72:75], v[184:187], v[188:191]
v_cvt_pk_bf16_f32 v27, v214, v215
v_cvt_pk_bf16_f32 v26, v212, v213
v_mfma_f32_16x16x32_bf16 v[188:191], a[76:79], v[192:195], v[188:191]
s_waitcnt vmcnt(0)
s_barrier
v_mfma_f32_16x16x32_bf16 v[188:191], a[68:71], v[204:207], v[188:191]
s_mov_b32 s48, s50
ds_read_b128 v[196:199], v236 offset:17152
ds_read_b128 v[200:203], v236 offset:16896
ds_read_b128 v[216:219], v236 offset:17408
ds_read_b128 v[220:223], v236 offset:17664
ds_read_u16 v108, v241 offset:256
ds_read_b128 v[204:207], v236 offset:21376
ds_read_b128 v[208:211], v236 offset:21120
ds_read_b128 v[52:55], v240 offset:64
v_cvt_pk_bf16_f32 v24, v188, v189
v_cvt_pk_bf16_f32 v25, v190, v191
s_add_u32 m0, s49, 0
s_add_u32 s50, s50, 13107200
buffer_load_dwordx4 v237, s[16:19], s48 offen nt lds
ds_read_b128 v[192:195], v236 offset:21888
ds_read_b128 v[48:51], v240 offset:0
ds_read_u16 v110, v241 offset:384
v_add_u32 v240, 0x200, v240
s_add_u32 s48, s48, s51
s_add_u32 m0, s49, 2112
ds_read_u16 v106, v241 offset:128
buffer_load_dwordx4 v237, s[16:19], s48 offen nt lds
s_waitcnt lgkmcnt(11)
v_mfma_f32_16x16x32_bf16 v[184:187], a[68:71], v[196:199], 0
s_waitcnt lgkmcnt(9)
ds_read_u16 v104, v241 offset:0
s_add_u32 m0, s49, 4224
v_mfma_f32_16x16x32_bf16 v[184:187], a[64:67], v[200:203], v[184:187]
s_waitcnt lgkmcnt(6)
s_add_u32 s48, s48, s51
buffer_load_dwordx4 v237, s[16:19], s48 offen nt lds
v_mfma_f32_16x16x32_bf16 v[184:187], a[72:75], v[216:219], v[184:187]
s_add_u32 m0, s49, 6336
s_add_u32 s48, s48, s51
buffer_load_dwordx4 v237, s[16:19], s48 offen nt lds
v_mfma_f32_16x16x32_bf16 v[184:187], a[76:79], v[220:223], v[184:187]
s_add_u32 m0, s49, 8448
s_add_u32 s48, s48, s51
buffer_load_dwordx4 v237, s[16:19], s48 offen nt lds
v_mfma_f32_16x16x32_bf16 v[188:191], a[92:95], v[220:223], 0
s_add_u32 m0, s49, 10560
s_mov_b32 s47, s46
s_add_u32 s48, s48, s51
v_mfma_f32_16x16x32_bf16 v[188:191], a[88:91], v[216:219], v[188:191]
s_bfe_i32 s57, s3, 0x10000
buffer_load_dwordx4 v237, s[16:19], s48 offen nt lds
v_cvt_pk_bf16_f32 v32, v184, v185
v_mfma_f32_16x16x32_bf16 v[188:191], a[84:87], v[196:199], v[188:191]
s_and_b32 s54, s57, s5
v_cvt_pk_bf16_f32 v33, v186, v187
s_sub_u32 s45, s45, 1
v_mfma_f32_16x16x32_bf16 v[188:191], a[80:83], v[200:203], v[188:191]
s_sub_u32 s50, s50, s54
s_add_u32 s52, s46, 20480
s_lshr_b32 s3, s3, 1
v_mfma_f32_16x16x32_bf16 v[184:187], a[96:99], v[200:203], 0
s_waitcnt lgkmcnt(0)
s_nop 1
v_mfma_f32_16x16x32_bf16 v[184:187], a[100:103], v[196:199], v[184:187]
v_cvt_pk_bf16_f32 v35, v190, v191
v_cvt_pk_bf16_f32 v34, v188, v189
v_mfma_f32_16x16x32_bf16 v[184:187], a[104:107], v[216:219], v[184:187]
v_mfma_f32_16x16x32_bf16 v[184:187], a[108:111], v[220:223], v[184:187]
s_nop 2
v_mfma_f32_16x16x32_bf16 v[188:191], a[124:127], v[220:223], 0
s_nop 2
v_mfma_f32_16x16x32_bf16 v[188:191], a[120:123], v[216:219], v[188:191]
v_cvt_pk_bf16_f32 v37, v186, v187
v_cvt_pk_bf16_f32 v36, v184, v185
v_mfma_f32_16x16x32_bf16 v[188:191], a[116:119], v[196:199], v[188:191]
ds_read_b128 v[196:199], v236 offset:21632
v_mfma_f32_16x16x32_bf16 v[188:191], a[112:115], v[200:203], v[188:191]
s_nop 7
v_cvt_pk_bf16_f32 v39, v190, v191
v_cvt_pk_bf16_f32 v38, v188, v189
s_nop 7
s_waitcnt lgkmcnt(0)
s_branch L_entrys
.p2align 6
L_loops:
s_waitcnt vmcnt(8)
s_barrier
v_mfma_f32_16x16x32_bf16 v[176:179], a[224:227], v[220:223], 0
s_add_u32 s52, s47, 8192
v_exp_f32 v187, v187
v_mfma_f32_16x16x32_bf16 v[176:179], a[228:231], v[224:227], v[176:179]
s_add_u32 s53, s47, 12288
v_add_f32 v248, v184, v185
v_add_f32 v248, v248, v186
v_mfma_f32_16x16x32_bf16 v[176:179], a[232:235], v[212:215], v[176:179]
s_mov_b32 s47, s46
v_add_f32 v248, v248, v187
v_cvt_pk_bf16_f32 v120, v184, v185
v_mfma_f32_16x16x32_bf16 v[176:179], a[236:239], v[216:219], v[176:179]
s_bfe_i32 s57, s3, 0x10000
v_cvt_pk_bf16_f32 v121, v186, v187
v_sub_f32 v193, v193, v254
v_mfma_f32_16x16x32_bf16 v[180:183], a[252:255], v[216:219], 0
s_and_b32 s54, s57, s5
v_exp_f32 v188, v188
v_mfma_f32_16x16x32_bf16 v[180:183], a[248:251], v[212:215], v[180:183]
s_sub_u32 s45, s45, 1
v_exp_f32 v190, v190
v_mfma_f32_16x16x32_bf16 v[180:183], a[244:247], v[224:227], v[180:183]
s_lshr_b32 s3, s3, 1
v_sub_f32 v194, v194, v254
v_add_f32 v248, v248, v188
v_mfma_f32_16x16x32_bf16 v[180:183], a[240:243], v[220:223], v[180:183]
v_exp_f32 v189, v189
v_mfma_f32_16x16x32_bf16 v[212:215], v[0:3], v[112:115], 0
v_add_f32 v248, v248, v189
v_sub_f32 v191, v191, v254
v_mfma_f32_16x16x32_bf16 v[212:215], v[4:7], v[116:119], v[212:215]
v_exp_f32 v191, v191
v_mfma_f32_16x16x32_bf16 v[216:219], v[12:15], v[116:119], 0
v_sub_f32 v195, v195, v254
v_sub_f32 v192, v192, v254
v_mfma_f32_16x16x32_bf16 v[216:219], v[8:11], v[112:115], v[216:219]
v_exp_f32 v192, v192
v_mfma_f32_16x16x32_bf16 v[220:223], v[16:19], v[112:115], 0
v_exp_f32 v194, v194
v_mfma_f32_16x16x32_bf16 v[220:223], v[20:23], v[116:119], v[220:223]
v_exp_f32 v193, v193
v_mfma_f32_16x16x32_bf16 v[224:227], v[28:31], v[116:119], 0
v_add_f32 v248, v248, v190
v_add_f32 v248, v248, v191
v_mfma_f32_16x16x32_bf16 v[224:227], v[24:27], v[112:115], v[224:227]
v_exp_f32 v195, v195
v_mfma_f32_16x16x32_bf16 v[228:231], v[32:35], v[112:115], 0
v_add_f32 v248, v248, v192
v_add_f32 v248, v248, v193
v_mfma_f32_16x16x32_bf16 v[228:231], v[36:39], v[116:119], v[228:231]
v_add_f32 v248, v248, v194
v_add_f32 v248, v248, v195
v_mfma_f32_16x16x32_bf16 v[232:235], v[44:47], v[116:119], 0
v_cvt_pk_bf16_f32 v123, v190, v191
v_cvt_pk_bf16_f32 v122, v188, v189
v_mfma_f32_16x16x32_bf16 v[232:235], v[40:43], v[112:115], v[232:235]
s_mov_b32 s48, s50
ds_read_b128 v[188:191], v236 offset:0
v_cvt_pk_bf16_f32 v125, v194, v195
v_mfma_f32_16x16x32_bf16 v[184:187], v[48:51], v[112:115], 0
s_add_u32 m0, s49, 0
ds_read_b128 v[48:51], v240 offset:0
v_cvt_pk_bf16_f32 v124, v192, v193
v_mfma_f32_16x16x32_bf16 v[184:187], v[52:55], v[116:119], v[184:187]
s_add_u32 s50, s50, 13107200
buffer_load_dwordx4 v237, s[16:19], s48 offen nt lds
v_sub_f32 v196, v196, v254
v_sub_f32 v197, v197, v254
v_sub_f32 v199, v199, v254
v_sub_f32 v198, v198, v254
v_exp_f32 v196, v196
v_exp_f32 v197, v197
v_add_f32 v248, v248, v196
v_add_f32 v248, v248, v197
v_exp_f32 v198, v198
s_waitcnt lgkmcnt(1)
v_mfma_f32_16x16x32_bf16 v[192:195], a[64:67], v[188:191], 0
s_sub_u32 s50, s50, s54
ds_read_b128 v[52:55], v240 offset:64
v_exp_f32 v199, v199
v_add_f32 v248, v248, v198
v_add_f32 v248, v248, v199
v_cvt_pk_bf16_f32 v126, v196, v197
v_cvt_pk_bf16_f32 v127, v198, v199
ds_read_b128 v[196:199], v236 offset:256
v_sub_f32 v200, v200, v254
v_sub_f32 v203, v203, v254
v_sub_f32 v201, v201, v254
v_exp_f32 v201, v201
v_sub_f32 v202, v202, v254
v_exp_f32 v202, v202
v_exp_f32 v200, v200
v_exp_f32 v203, v203
v_add_f32 v248, v248, v200
v_add_f32 v248, v248, v201
v_add_f32 v248, v248, v202
v_add_f32 v248, v248, v203
v_cvt_pk_bf16_f32 v128, v200, v201
v_cvt_pk_bf16_f32 v129, v202, v203
v_sub_f32 v204, v204, v254
v_sub_f32 v205, v205, v254
s_waitcnt lgkmcnt(0)
v_mfma_f32_16x16x32_bf16 v[192:195], a[68:71], v[196:199], v[192:195]
ds_read_b128 v[200:203], v236 offset:512
v_exp_f32 v204, v204
v_sub_f32 v206, v206, v254
v_add_f32 v248, v248, v204
v_exp_f32 v206, v206
v_sub_f32 v207, v207, v254
v_exp_f32 v205, v205
v_exp_f32 v207, v207
v_add_f32 v248, v248, v205
v_cvt_pk_bf16_f32 v130, v204, v205
v_add_f32 v248, v248, v206
v_add_f32 v248, v248, v207
v_cvt_pk_bf16_f32 v131, v206, v207
v_sub_f32 v208, v208, v254
v_exp_f32 v208, v208
v_max3_f32 v254, v212, v213, v214
s_waitcnt lgkmcnt(0)
v_mfma_f32_16x16x32_bf16 v[192:195], a[72:75], v[200:203], v[192:195]
ds_read_b128 v[204:207], v236 offset:768
v_add_f32 v248, v248, v208
v_cvt_pk_bf16_f32 v132, v208, 0
v_max3_f32 v254, v254, v215, v216
v_max3_f32 v254, v254, v217, v218
v_max3_f32 v254, v254, v219, v220
v_max3_f32 v254, v254, v221, v222
v_max3_f32 v254, v254, v223, v224
v_max3_f32 v254, v254, v225, v226
v_max3_f32 v254, v254, v227, v228
v_max3_f32 v254, v254, v229, v230
v_max3_f32 v254, v254, v231, v232
v_max3_f32 v254, v254, v233, v234
v_max3_f32 v254, v254, v235, v184
v_add_u32 v240, 0x200, v240
ds_swizzle_b32 v250, v248 offset:0x401F
ds_swizzle_b32 v255, v254 offset:0x401F
s_waitcnt lgkmcnt(2)
v_mfma_f32_16x16x32_bf16 v[192:195], a[76:79], v[204:207], v[192:195]
s_nop 2
v_mfma_f32_16x16x32_bf16 v[208:211], a[92:95], v[204:207], 0
s_nop 2
v_mfma_f32_16x16x32_bf16 v[208:211], a[88:91], v[200:203], v[208:211]
v_cvt_pk_bf16_f32 v0, v192, v193
v_cvt_pk_bf16_f32 v1, v194, v195
v_mfma_f32_16x16x32_bf16 v[208:211], a[84:87], v[196:199], v[208:211]
v_mfma_f32_16x16x32_bf16 v[208:211], a[80:83], v[188:191], v[208:211]
s_waitcnt lgkmcnt(0)
v_add_f32 v248, v248, v250
v_max_f32 v254, v254, v255
v_mfma_f32_16x16x32_bf16 v[192:195], a[96:99], v[188:191], 0
ds_bpermute_b32 v250, v247, v248
v_mfma_f32_16x16x32_bf16 v[192:195], a[100:103], v[196:199], v[192:195]
ds_bpermute_b32 v255, v247, v254
v_mfma_f32_16x16x32_bf16 v[192:195], a[104:107], v[200:203], v[192:195]
v_cvt_pk_bf16_f32 v2, v208, v209
v_cvt_pk_bf16_f32 v3, v210, v211
v_mfma_f32_16x16x32_bf16 v[192:195], a[108:111], v[204:207], v[192:195]
s_nop 2
v_mfma_f32_16x16x32_bf16 v[208:211], a[124:127], v[204:207], 0
s_nop 2
v_mfma_f32_16x16x32_bf16 v[208:211], a[120:123], v[200:203], v[208:211]
v_cvt_pk_bf16_f32 v5, v194, v195
v_cvt_pk_bf16_f32 v4, v192, v193
v_mfma_f32_16x16x32_bf16 v[208:211], a[116:119], v[196:199], v[208:211]
s_waitcnt lgkmcnt(1)
v_add_f32 v248, v248, v250
v_mfma_f32_16x16x32_bf16 v[208:211], a[112:115], v[188:191], v[208:211]
s_waitcnt lgkmcnt(0)
v_rcp_f32 v251, v248
v_mfma_f32_16x16x32_bf16 v[188:191], v[56:59], v[120:123], 0
v_max_f32 v254, v254, v255
v_sub_f32 v214, v214, v254
v_mfma_f32_16x16x32_bf16 v[188:191], v[104:107], v[132:135], v[188:191]
s_add_u32 s48, s48, s51
v_sub_f32 v215, v215, v254
v_cvt_pk_bf16_f32 v6, v208, v209
v_mfma_f32_16x16x32_bf16 v[188:191], v[72:75], v[124:127], v[188:191]
s_add_u32 m0, s49, 2112
v_cvt_pk_bf16_f32 v7, v210, v211
v_sub_f32 v212, v212, v254
v_mfma_f32_16x16x32_bf16 v[188:191], v[88:91], v[128:131], v[188:191]
buffer_load_dwordx4 v237, s[16:19], s48 offen nt lds
v_sub_f32 v213, v213, v254
v_mfma_f32_16x16x32_bf16 v[196:199], v[92:95], v[128:131], 0
v_exp_f32 v212, v212
v_mfma_f32_16x16x32_bf16 v[196:199], v[76:79], v[124:127], v[196:199]
v_exp_f32 v214, v214
v_mfma_f32_16x16x32_bf16 v[196:199], v[106:109], v[132:135], v[196:199]
v_exp_f32 v213, v213
v_mfma_f32_16x16x32_bf16 v[196:199], v[60:63], v[120:123], v[196:199]
ds_read_b128 v[204:207], v236 offset:4480
v_sub_f32 v216, v216, v254
v_mfma_f32_16x16x32_bf16 v[200:203], v[64:67], v[120:123], 0
ds_read_b128 v[192:195], v236 offset:4224
v_sub_f32 v217, v217, v254
v_mfma_f32_16x16x32_bf16 v[200:203], v[108:111], v[132:135], v[200:203]
v_exp_f32 v215, v215
v_mfma_f32_16x16x32_bf16 v[200:203], v[80:83], v[124:127], v[200:203]
v_exp_f32 v217, v217
v_mfma_f32_16x16x32_bf16 v[200:203], v[96:99], v[128:131], v[200:203]
v_sub_f32 v218, v218, v254
v_add_f32 v249, v212, v213
v_mfma_f32_16x16x32_bf16 v[208:211], v[100:103], v[128:131], 0
v_add_f32 v249, v249, v214
v_add_f32 v249, v249, v215
v_mfma_f32_16x16x32_bf16 v[208:211], v[84:87], v[124:127], v[208:211]
s_waitcnt lgkmcnt(1)
v_exp_f32 v216, v216
v_mfma_f32_16x16x32_bf16 v[208:211], v[110:113], v[132:135], v[208:211]
s_waitcnt lgkmcnt(0)
v_sub_f32 v219, v219, v254
v_sub_f32 v220, v220, v254
v_mfma_f32_16x16x32_bf16 v[208:211], v[68:71], v[120:123], v[208:211]
v_exp_f32 v218, v218
v_sub_f32 v223, v223, v254
v_add_f32 v249, v249, v216
v_add_f32 v249, v249, v217
v_exp_f32 v219, v219
v_add_f32 v249, v249, v218
v_add_f32 v249, v249, v219
v_exp_f32 v220, v220
v_sub_f32 v224, v224, v254
v_exp_f32 v223, v223
v_sub_f32 v221, v221, v254
v_exp_f32 v224, v224
v_exp_f32 v221, v221
v_sub_f32 v222, v222, v254
v_sub_f32 v225, v225, v254
v_add_f32 v249, v249, v220
v_add_f32 v249, v249, v221
v_exp_f32 v222, v222
v_exp_f32 v225, v225
v_add_f32 v249, v249, v222
v_add_f32 v249, v249, v223
v_add_f32 v249, v249, v224
v_sub_f32 v226, v226, v254
v_add_f32 v249, v249, v225
v_exp_f32 v226, v226
v_sub_f32 v227, v227, v254
v_exp_f32 v227, v227
v_sub_f32 v228, v228, v254
v_exp_f32 v228, v228
v_add_f32 v249, v249, v226
v_sub_f32 v232, v232, v254
v_sub_f32 v229, v229, v254
v_sub_f32 v230, v230, v254
v_exp_f32 v230, v230
v_exp_f32 v229, v229
v_add_f32 v249, v249, v227
v_add_f32 v249, v249, v228
v_add_f32 v249, v249, v229
v_exp_f32 v232, v232
v_sub_f32 v233, v233, v254
v_exp_f32 v233, v233
v_sub_f32 v231, v231, v254
v_exp_f32 v231, v231
v_sub_f32 v234, v234, v254
v_sub_f32 v235, v235, v254
v_add_f32 v249, v249, v230
v_add_f32 v249, v249, v231
v_add_f32 v249, v249, v232
v_exp_f32 v234, v234
v_exp_f32 v235, v235
v_sub_f32 v184, v184, v254
v_exp_f32 v184, v184
v_add_f32 v249, v249, v233
v_cvt_pk_bf16_f32 v148, v184, 0
v_add_f32 v249, v249, v234
v_add_f32 v249, v249, v235
v_add_f32 v249, v249, v184
v_fmac_f32 v161, v201, v251
v_fmac_f32 v163, v203, v251
v_fmac_f32 v160, v200, v251
v_fmac_f32 v162, v202, v251
ds_read_b128 v[184:187], v236 offset:4992
v_cvt_pk_bf16_f32 v138, v216, v217
v_cvt_pk_bf16_f32 v139, v218, v219
v_fmac_f32 v167, v211, v251
v_fmac_f32 v165, v209, v251
v_fmac_f32 v166, v210, v251
v_fmac_f32 v164, v208, v251
v_cvt_pk_bf16_f32 v140, v220, v221
v_cvt_pk_bf16_f32 v141, v222, v223
v_fmac_f32 v155, v191, v251
v_fmac_f32 v154, v190, v251
v_fmac_f32 v152, v188, v251
v_fmac_f32 v153, v189, v251
v_cvt_pk_bf16_f32 v137, v214, v215
v_cvt_pk_bf16_f32 v136, v212, v213
v_cvt_pk_bf16_f32 v143, v226, v227
v_cvt_pk_bf16_f32 v142, v224, v225
v_cvt_pk_bf16_f32 v145, v230, v231
v_cvt_pk_bf16_f32 v144, v228, v229
v_fmac_f32 v156, v196, v251
v_fmac_f32 v157, v197, v251
s_waitcnt lgkmcnt(0)
v_mfma_f32_16x16x32_bf16 v[200:203], a[124:127], v[184:187], 0
ds_read_b128 v[216:219], v236 offset:4736
v_fmac_f32 v158, v198, v251
v_fmac_f32 v159, v199, v251
v_cvt_pk_bf16_f32 v147, v234, v235
v_cvt_pk_bf16_f32 v146, v232, v233
v_cvt_pk_bf16_f32 v160, v160, v161
v_cvt_pk_bf16_f32 v161, v162, v163
v_cvt_pk_bf16_f32 v163, v166, v167
v_cvt_pk_bf16_f32 v162, v164, v165
v_cvt_pk_bf16_f32 v152, v152, v153
v_cvt_pk_bf16_f32 v153, v154, v155
v_pk_max_i16 v160, v160, 0
v_pk_max_i16 v162, v162, 0
v_pk_max_i16 v153, v153, 0
v_pk_max_i16 v161, v161, 0
v_pk_max_i16 v163, v163, 0
v_cvt_pk_bf16_f32 v155, v158, v159
v_pk_max_i16 v155, v155, 0
v_pk_max_i16 v152, v152, 0
v_cvt_pk_bf16_f32 v154, v156, v157
v_pk_max_i16 v154, v154, 0
s_waitcnt lgkmcnt(0)
v_mfma_f32_16x16x32_bf16 v[200:203], a[120:123], v[216:219], v[200:203]
ds_swizzle_b32 v250, v249 offset:0x401F
buffer_store_dwordx4 v[152:155], v239, s[20:23], s52 offen offset:0 nt
buffer_store_dwordx4 v[160:163], v239, s[20:23], s52 offen offset:64 nt
s_add_u32 s52, s46, 20480
v_mfma_f32_16x16x32_bf16 v[200:203], a[116:119], v[204:207], v[200:203]
v_mfma_f32_16x16x32_bf16 v[200:203], a[112:115], v[192:195], v[200:203]
s_nop 2
v_mfma_f32_16x16x32_bf16 v[208:211], a[96:99], v[192:195], 0
s_waitcnt lgkmcnt(0)
v_add_f32 v249, v249, v250
v_mfma_f32_16x16x32_bf16 v[208:211], a[100:103], v[204:207], v[208:211]
s_add_u32 m0, s49, 4224
ds_bpermute_b32 v250, v247, v249
v_mfma_f32_16x16x32_bf16 v[208:211], a[104:107], v[216:219], v[208:211]
s_add_u32 s48, s48, s51
buffer_load_dwordx4 v237, s[16:19], s48 offen nt lds
v_cvt_pk_bf16_f32 v14, v200, v201
v_mfma_f32_16x16x32_bf16 v[208:211], a[108:111], v[184:187], v[208:211]
ds_read_b128 v[212:215], v236 offset:8448
v_cvt_pk_bf16_f32 v15, v202, v203
v_mfma_f32_16x16x32_bf16 v[220:223], a[92:95], v[184:187], 0
ds_read_b128 v[200:203], v236 offset:8704
ds_read_b128 v[224:227], v236 offset:8960
v_mfma_f32_16x16x32_bf16 v[220:223], a[88:91], v[216:219], v[220:223]
ds_read_b128 v[228:231], v236 offset:9216
v_mfma_f32_16x16x32_bf16 v[220:223], a[84:87], v[204:207], v[220:223]
v_cvt_pk_bf16_f32 v13, v210, v211
v_cvt_pk_bf16_f32 v12, v208, v209
v_mfma_f32_16x16x32_bf16 v[220:223], a[80:83], v[192:195], v[220:223]
s_waitcnt lgkmcnt(4)
v_add_f32 v249, v249, v250
s_nop 0
v_mfma_f32_16x16x32_bf16 v[188:191], a[64:67], v[192:195], 0
v_rcp_f32 v252, v249
v_mfma_f32_16x16x32_bf16 v[188:191], a[72:75], v[216:219], v[188:191]
s_waitcnt lgkmcnt(3)
s_nop 0
v_cvt_pk_bf16_f32 v10, v220, v221
v_mfma_f32_16x16x32_bf16 v[188:191], a[76:79], v[184:187], v[188:191]
s_waitcnt lgkmcnt(1)
v_cvt_pk_bf16_f32 v11, v222, v223
v_mfma_f32_16x16x32_bf16 v[188:191], a[68:71], v[204:207], v[188:191]
s_waitcnt lgkmcnt(0)
s_nop 1
v_mfma_f32_16x16x32_bf16 v[184:187], a[68:71], v[200:203], 0
s_nop 2
v_mfma_f32_16x16x32_bf16 v[184:187], a[64:67], v[212:215], v[184:187]
v_cvt_pk_bf16_f32 v9, v190, v191
v_cvt_pk_bf16_f32 v8, v188, v189
v_mfma_f32_16x16x32_bf16 v[184:187], a[72:75], v[224:227], v[184:187]
v_mfma_f32_16x16x32_bf16 v[184:187], a[76:79], v[228:231], v[184:187]
s_nop 2
v_mfma_f32_16x16x32_bf16 v[188:191], a[92:95], v[228:231], 0
s_nop 2
v_mfma_f32_16x16x32_bf16 v[188:191], a[88:91], v[224:227], v[188:191]
v_cvt_pk_bf16_f32 v16, v184, v185
v_cvt_pk_bf16_f32 v17, v186, v187
v_mfma_f32_16x16x32_bf16 v[188:191], a[84:87], v[200:203], v[188:191]
v_mfma_f32_16x16x32_bf16 v[188:191], a[80:83], v[212:215], v[188:191]
ds_read_b128 v[184:187], v236 offset:13184
ds_read_b128 v[192:195], v236 offset:13440
v_mfma_f32_16x16x32_bf16 v[196:199], a[96:99], v[212:215], 0
ds_read_b128 v[204:207], v236 offset:12928
ds_read_b128 v[208:211], v236 offset:12672
v_mfma_f32_16x16x32_bf16 v[196:199], a[100:103], v[200:203], v[196:199]
s_add_u32 m0, s49, 6336
s_add_u32 s48, s48, s51
v_cvt_pk_bf16_f32 v18, v188, v189
v_mfma_f32_16x16x32_bf16 v[196:199], a[104:107], v[224:227], v[196:199]
buffer_load_dwordx4 v237, s[16:19], s48 offen nt lds
v_cvt_pk_bf16_f32 v19, v190, v191
v_mfma_f32_16x16x32_bf16 v[196:199], a[108:111], v[228:231], v[196:199]
s_nop 2
v_mfma_f32_16x16x32_bf16 v[188:191], a[124:127], v[228:231], 0
s_nop 2
v_mfma_f32_16x16x32_bf16 v[188:191], a[116:119], v[200:203], v[188:191]
s_waitcnt lgkmcnt(2)
v_cvt_pk_bf16_f32 v21, v198, v199
v_cvt_pk_bf16_f32 v20, v196, v197
v_mfma_f32_16x16x32_bf16 v[188:191], a[112:115], v[212:215], v[188:191]
s_waitcnt lgkmcnt(0)
v_mfma_f32_16x16x32_bf16 v[188:191], a[120:123], v[224:227], v[188:191]
s_nop 2
v_mfma_f32_16x16x32_bf16 v[196:199], a[120:123], v[184:187], 0
s_nop 2
v_mfma_f32_16x16x32_bf16 v[196:199], a[124:127], v[192:195], v[196:199]
v_cvt_pk_bf16_f32 v23, v190, v191
v_cvt_pk_bf16_f32 v22, v188, v189
v_mfma_f32_16x16x32_bf16 v[196:199], a[116:119], v[204:207], v[196:199]
v_mfma_f32_16x16x32_bf16 v[196:199], a[112:115], v[208:211], v[196:199]
s_nop 2
v_mfma_f32_16x16x32_bf16 v[188:191], a[96:99], v[208:211], 0
s_nop 2
v_mfma_f32_16x16x32_bf16 v[188:191], a[100:103], v[204:207], v[188:191]
v_cvt_pk_bf16_f32 v30, v196, v197
v_cvt_pk_bf16_f32 v31, v198, v199
v_mfma_f32_16x16x32_bf16 v[188:191], a[104:107], v[184:187], v[188:191]
v_mfma_f32_16x16x32_bf16 v[188:191], a[108:111], v[192:195], v[188:191]
ds_read_b128 v[196:199], v236 offset:17152
ds_read_b128 v[200:203], v236 offset:16896
v_mfma_f32_16x16x32_bf16 v[212:215], a[92:95], v[192:195], 0
ds_read_b128 v[216:219], v236 offset:17408
ds_read_b128 v[220:223], v236 offset:17664
v_mfma_f32_16x16x32_bf16 v[212:215], a[88:91], v[184:187], v[212:215]
s_nop 1
v_cvt_pk_bf16_f32 v29, v190, v191
v_mfma_f32_16x16x32_bf16 v[212:215], a[84:87], v[204:207], v[212:215]
v_cvt_pk_bf16_f32 v28, v188, v189
v_mfma_f32_16x16x32_bf16 v[212:215], a[80:83], v[208:211], v[212:215]
s_nop 2
v_mfma_f32_16x16x32_bf16 v[188:191], a[64:67], v[208:211], 0
s_nop 2
v_mfma_f32_16x16x32_bf16 v[188:191], a[72:75], v[184:187], v[188:191]
s_add_u32 m0, s49, 8448
v_cvt_pk_bf16_f32 v27, v214, v215
v_cvt_pk_bf16_f32 v26, v212, v213
v_mfma_f32_16x16x32_bf16 v[188:191], a[76:79], v[192:195], v[188:191]
s_add_u32 s48, s48, s51
buffer_load_dwordx4 v237, s[16:19], s48 offen nt lds
v_mfma_f32_16x16x32_bf16 v[188:191], a[68:71], v[204:207], v[188:191]
s_waitcnt lgkmcnt(0)
s_nop 1
v_mfma_f32_16x16x32_bf16 v[184:187], a[68:71], v[196:199], 0
s_nop 2
v_mfma_f32_16x16x32_bf16 v[184:187], a[64:67], v[200:203], v[184:187]
v_cvt_pk_bf16_f32 v24, v188, v189
v_cvt_pk_bf16_f32 v25, v190, v191
v_mfma_f32_16x16x32_bf16 v[184:187], a[72:75], v[216:219], v[184:187]
v_mfma_f32_16x16x32_bf16 v[184:187], a[76:79], v[220:223], v[184:187]
s_nop 2
v_mfma_f32_16x16x32_bf16 v[188:191], a[92:95], v[220:223], 0
s_nop 2
v_mfma_f32_16x16x32_bf16 v[188:191], a[88:91], v[216:219], v[188:191]
v_cvt_pk_bf16_f32 v32, v184, v185
v_cvt_pk_bf16_f32 v33, v186, v187
v_mfma_f32_16x16x32_bf16 v[188:191], a[84:87], v[196:199], v[188:191]
v_mfma_f32_16x16x32_bf16 v[188:191], a[80:83], v[200:203], v[188:191]
s_nop 2
v_mfma_f32_16x16x32_bf16 v[184:187], a[96:99], v[200:203], 0
s_nop 2
v_mfma_f32_16x16x32_bf16 v[184:187], a[100:103], v[196:199], v[184:187]
v_cvt_pk_bf16_f32 v35, v190, v191
v_cvt_pk_bf16_f32 v34, v188, v189
v_mfma_f32_16x16x32_bf16 v[184:187], a[104:107], v[216:219], v[184:187]
v_mfma_f32_16x16x32_bf16 v[184:187], a[108:111], v[220:223], v[184:187]
s_nop 2
v_mfma_f32_16x16x32_bf16 v[188:191], a[124:127], v[220:223], 0
s_nop 2
v_mfma_f32_16x16x32_bf16 v[188:191], a[120:123], v[216:219], v[188:191]
v_cvt_pk_bf16_f32 v37, v186, v187
v_cvt_pk_bf16_f32 v36, v184, v185
v_mfma_f32_16x16x32_bf16 v[188:191], a[116:119], v[196:199], v[188:191]
v_mfma_f32_16x16x32_bf16 v[188:191], a[112:115], v[200:203], v[188:191]
s_nop 2
v_mfma_f32_16x16x32_bf16 v[184:187], v[56:59], v[136:139], 0
s_nop 2
v_mfma_f32_16x16x32_bf16 v[184:187], v[104:107], v[148:151], v[184:187]
s_add_u32 m0, s49, 10560
ds_read_u16 v104, v241 offset:0
v_cvt_pk_bf16_f32 v39, v190, v191
v_mfma_f32_16x16x32_bf16 v[184:187], v[72:75], v[140:143], v[184:187]
s_add_u32 s48, s48, s51
buffer_load_dwordx4 v237, s[16:19], s48 offen nt lds
v_cvt_pk_bf16_f32 v38, v188, v189
v_mfma_f32_16x16x32_bf16 v[184:187], v[88:91], v[144:147], v[184:187]
s_nop 2
v_mfma_f32_16x16x32_bf16 v[188:191], v[92:95], v[144:147], 0
s_nop 2
v_mfma_f32_16x16x32_bf16 v[188:191], v[76:79], v[140:143], v[188:191]
v_fmac_f32 v170, v186, v252
v_fmac_f32 v168, v184, v252
v_mfma_f32_16x16x32_bf16 v[188:191], v[106:109], v[148:151], v[188:191]
ds_read_u16 v106, v241 offset:128
v_fmac_f32 v171, v187, v252
v_mfma_f32_16x16x32_bf16 v[188:191], v[60:63], v[136:139], v[188:191]
s_waitcnt lgkmcnt(1)
ds_read_b128 v[192:195], v236 offset:21888
v_fmac_f32 v169, v185, v252
v_mfma_f32_16x16x32_bf16 v[200:203], v[64:67], v[136:139], 0
ds_read_b128 v[196:199], v236 offset:21632
ds_read_b128 v[204:207], v236 offset:21376
v_mfma_f32_16x16x32_bf16 v[200:203], v[108:111], v[148:151], v[200:203]
ds_read_b128 v[208:211], v236 offset:21120
v_fmac_f32 v174, v190, v252
v_mfma_f32_16x16x32_bf16 v[200:203], v[80:83], v[140:143], v[200:203]
ds_read_u16 v108, v241 offset:256
v_fmac_f32 v175, v191, v252
v_mfma_f32_16x16x32_bf16 v[200:203], v[96:99], v[144:147], v[200:203]
v_fmac_f32 v172, v188, v252
v_fmac_f32 v173, v189, v252
v_mfma_f32_16x16x32_bf16 v[184:187], v[100:103], v[144:147], 0
s_waitcnt lgkmcnt(5)
v_cvt_pk_bf16_f32 v168, v168, v169
v_cvt_pk_bf16_f32 v169, v170, v171
v_mfma_f32_16x16x32_bf16 v[184:187], v[84:87], v[140:143], v[184:187]
s_waitcnt lgkmcnt(4)
v_fmac_f32 v178, v202, v252
v_fmac_f32 v176, v200, v252
v_mfma_f32_16x16x32_bf16 v[184:187], v[110:113], v[148:151], v[184:187]
s_waitcnt lgkmcnt(2)
ds_read_u16 v110, v241 offset:384
v_fmac_f32 v177, v201, v252
v_mfma_f32_16x16x32_bf16 v[184:187], v[68:71], v[136:139], v[184:187]
L_entrys:
s_waitcnt lgkmcnt(2)
v_fmac_f32 v179, v203, v252
v_cvt_pk_bf16_f32 v176, v176, v177
v_mfma_f32_16x16x32_bf16 v[188:191], a[124:127], v[192:195], 0
s_waitcnt lgkmcnt(1)
v_cvt_pk_bf16_f32 v177, v178, v179
v_cvt_pk_bf16_f32 v171, v174, v175
v_mfma_f32_16x16x32_bf16 v[188:191], a[120:123], v[196:199], v[188:191]
v_fmac_f32 v180, v184, v252
v_fmac_f32 v181, v185, v252
v_mfma_f32_16x16x32_bf16 v[188:191], a[116:119], v[204:207], v[188:191]
v_fmac_f32 v183, v187, v252
v_fmac_f32 v182, v186, v252
v_mfma_f32_16x16x32_bf16 v[188:191], a[112:115], v[208:211], v[188:191]
v_cvt_pk_bf16_f32 v178, v180, v181
v_cvt_pk_bf16_f32 v170, v172, v173
v_mfma_f32_16x16x32_bf16 v[184:187], a[96:99], v[208:211], 0
s_waitcnt lgkmcnt(0)
v_cvt_pk_bf16_f32 v179, v182, v183
v_pk_max_i16 v168, v168, 0
v_mfma_f32_16x16x32_bf16 v[184:187], a[100:103], v[204:207], v[184:187]
s_add_u32 s48, s48, s51
v_cvt_pk_bf16_f32 v46, v188, v189
v_cvt_pk_bf16_f32 v47, v190, v191
v_mfma_f32_16x16x32_bf16 v[184:187], a[104:107], v[196:199], v[184:187]
s_add_u32 m0, s49, 12672
v_pk_max_i16 v176, v176, 0
v_pk_max_i16 v170, v170, 0
v_mfma_f32_16x16x32_bf16 v[184:187], a[108:111], v[192:195], v[184:187]
buffer_load_dwordx4 v237, s[16:19], s48 offen nt lds
v_pk_max_i16 v179, v179, 0
v_mfma_f32_16x16x32_bf16 v[188:191], a[92:95], v[192:195], 0
v_pk_max_i16 v178, v178, 0
v_pk_max_i16 v169, v169, 0
v_mfma_f32_16x16x32_bf16 v[188:191], a[88:91], v[196:199], v[188:191]
v_pk_max_i16 v177, v177, 0
v_pk_max_i16 v171, v171, 0
v_mfma_f32_16x16x32_bf16 v[188:191], a[84:87], v[204:207], v[188:191]
buffer_store_dwordx4 v[168:171], v239, s[20:23], s53 offen offset:0 nt
buffer_store_dwordx4 v[176:179], v239, s[20:23], s53 offen offset:64 nt
v_cvt_pk_bf16_f32 v44, v184, v185
v_cvt_pk_bf16_f32 v45, v186, v187
v_add_u32 v241, 0x200, v241
s_add_u32 s53, s46, 0
v_mfma_f32_16x16x32_bf16 v[188:191], a[80:83], v[208:211], v[188:191]
s_nop 2
v_mfma_f32_16x16x32_bf16 v[184:187], a[64:67], v[208:211], 0
s_nop 2
v_mfma_f32_16x16x32_bf16 v[184:187], a[72:75], v[196:199], v[184:187]
v_cvt_pk_bf16_f32 v42, v188, v189
v_cvt_pk_bf16_f32 v43, v190, v191
v_mfma_f32_16x16x32_bf16 v[184:187], a[76:79], v[192:195], v[184:187]
v_mfma_f32_16x16x32_bf16 v[184:187], a[68:71], v[204:207], v[184:187]
s_nop 2
v_mfma_f32_16x16x32_bf16 v[188:191], a[4:7], v[204:207], 0
s_nop 2
v_mfma_f32_16x16x32_bf16 v[188:191], a[0:3], v[208:211], v[188:191]
v_cvt_pk_bf16_f32 v41, v186, v187
v_cvt_pk_bf16_f32 v40, v184, v185
v_mfma_f32_16x16x32_bf16 v[188:191], a[8:11], v[196:199], v[188:191]
v_mfma_f32_16x16x32_bf16 v[188:191], a[12:15], v[192:195], v[188:191]
s_nop 2
v_mfma_f32_16x16x32_bf16 v[184:187], a[28:31], v[192:195], 0
s_nop 2
v_mfma_f32_16x16x32_bf16 v[184:187], a[24:27], v[196:199], v[184:187]
v_cvt_pk_bf16_f32 v112, v188, v189
v_cvt_pk_bf16_f32 v113, v190, v191
v_mfma_f32_16x16x32_bf16 v[184:187], a[20:23], v[204:207], v[184:187]
v_mfma_f32_16x16x32_bf16 v[184:187], a[16:19], v[208:211], v[184:187]
s_nop 2
v_mfma_f32_16x16x32_bf16 v[188:191], a[32:35], v[208:211], 0
s_nop 2
v_mfma_f32_16x16x32_bf16 v[188:191], a[36:39], v[204:207], v[188:191]
s_add_u32 m0, s49, 14784
v_cvt_pk_bf16_f32 v114, v184, v185
v_cvt_pk_bf16_f32 v115, v186, v187
v_mfma_f32_16x16x32_bf16 v[188:191], a[40:43], v[196:199], v[188:191]
s_add_u32 s48, s48, s51
buffer_load_dwordx4 v237, s[16:19], s48 offen nt lds
v_mfma_f32_16x16x32_bf16 v[188:191], a[44:47], v[192:195], v[188:191]
s_nop 2
v_mfma_f32_16x16x32_bf16 v[184:187], a[60:63], v[192:195], 0
s_nop 2
v_mfma_f32_16x16x32_bf16 v[184:187], a[56:59], v[196:199], v[184:187]
v_cvt_pk_bf16_f32 v116, v188, v189
v_cvt_pk_bf16_f32 v117, v190, v191
v_mfma_f32_16x16x32_bf16 v[184:187], a[52:55], v[204:207], v[184:187]
v_mfma_f32_16x16x32_bf16 v[184:187], a[48:51], v[208:211], v[184:187]
s_nop 2
v_mfma_f32_16x16x32_bf16 v[152:155], a[192:195], v[208:211], 0
s_nop 2
v_mfma_f32_16x16x32_bf16 v[152:155], a[196:199], v[204:207], v[152:155]
v_cvt_pk_bf16_f32 v118, v184, v185
v_cvt_pk_bf16_f32 v119, v186, v187
v_mfma_f32_16x16x32_bf16 v[152:155], a[200:203], v[196:199], v[152:155]
v_mfma_f32_16x16x32_bf16 v[152:155], a[204:207], v[192:195], v[152:155]
v_mfma_f32_16x16x32_bf16 v[156:159], a[220:223], v[192:195], 0
v_mfma_f32_16x16x32_bf16 v[156:159], a[216:219], v[196:199], v[156:159]
v_mfma_f32_16x16x32_bf16 v[156:159], a[212:215], v[204:207], v[156:159]
v_mfma_f32_16x16x32_bf16 v[156:159], a[208:211], v[208:211], v[156:159]
v_mfma_f32_16x16x32_bf16 v[160:163], a[224:227], v[208:211], 0
v_mfma_f32_16x16x32_bf16 v[160:163], a[228:231], v[204:207], v[160:163]
v_mfma_f32_16x16x32_bf16 v[160:163], a[232:235], v[196:199], v[160:163]
v_mfma_f32_16x16x32_bf16 v[160:163], a[236:239], v[192:195], v[160:163]
v_mfma_f32_16x16x32_bf16 v[164:167], a[252:255], v[192:195], 0
v_mfma_f32_16x16x32_bf16 v[164:167], a[248:251], v[196:199], v[164:167]
s_add_u32 s48, s48, s51
s_add_u32 m0, s49, 16896
v_mfma_f32_16x16x32_bf16 v[164:167], a[244:247], v[204:207], v[164:167]
buffer_load_dwordx4 v237, s[16:19], s48 offen nt lds
v_mfma_f32_16x16x32_bf16 v[164:167], a[240:243], v[208:211], v[164:167]
v_mfma_f32_16x16x32_bf16 v[184:187], v[0:3], v[112:115], 0
v_mfma_f32_16x16x32_bf16 v[184:187], v[4:7], v[116:119], v[184:187]
s_nop 2
v_mfma_f32_16x16x32_bf16 v[188:191], v[12:15], v[116:119], 0
s_nop 2
v_mfma_f32_16x16x32_bf16 v[188:191], v[8:11], v[112:115], v[188:191]
v_max3_f32 v254, v184, v185, v186
s_nop 0
v_mfma_f32_16x16x32_bf16 v[200:203], v[16:19], v[112:115], 0
s_nop 2
v_mfma_f32_16x16x32_bf16 v[200:203], v[20:23], v[116:119], v[200:203]
s_nop 0
v_max3_f32 v254, v254, v187, v188
v_max3_f32 v254, v254, v189, v190
v_mfma_f32_16x16x32_bf16 v[212:215], v[28:31], v[116:119], 0
s_nop 2
v_mfma_f32_16x16x32_bf16 v[212:215], v[24:27], v[112:115], v[212:215]
v_max3_f32 v254, v254, v191, v200
v_max3_f32 v254, v254, v201, v202
v_mfma_f32_16x16x32_bf16 v[216:219], v[32:35], v[112:115], 0
s_nop 2
v_mfma_f32_16x16x32_bf16 v[216:219], v[36:39], v[116:119], v[216:219]
s_nop 0
v_max3_f32 v254, v254, v203, v212
v_max3_f32 v254, v254, v213, v214
v_mfma_f32_16x16x32_bf16 v[220:223], v[44:47], v[116:119], 0
s_nop 2
v_mfma_f32_16x16x32_bf16 v[220:223], v[40:43], v[112:115], v[220:223]
v_max3_f32 v254, v254, v215, v216
v_max3_f32 v254, v254, v217, v218
v_mfma_f32_16x16x32_bf16 v[224:227], v[48:51], v[112:115], 0
s_nop 2
v_mfma_f32_16x16x32_bf16 v[224:227], v[52:55], v[116:119], v[224:227]
s_nop 0
v_max3_f32 v254, v254, v219, v220
v_max3_f32 v254, v254, v221, v222
v_mfma_f32_16x16x32_bf16 v[228:231], v[208:211], a[128:131], 0
s_nop 2
v_mfma_f32_16x16x32_bf16 v[228:231], v[204:207], a[132:135], v[228:231]
v_max3_f32 v254, v254, v223, v224
v_mfma_f32_16x16x32_bf16 v[228:231], v[196:199], a[136:139], v[228:231]
ds_swizzle_b32 v255, v254 offset:0x401F
v_mfma_f32_16x16x32_bf16 v[228:231], v[192:195], a[140:143], v[228:231]
s_add_u32 m0, s49, 19008
s_add_u32 s48, s48, s51
buffer_load_dwordx4 v237, s[16:19], s48 offen nt lds
v_mfma_f32_16x16x32_bf16 v[232:235], v[192:195], a[156:159], 0
s_nop 2
v_mfma_f32_16x16x32_bf16 v[232:235], v[196:199], a[152:155], v[232:235]
v_cvt_pk_bf16_f32 v91, v230, v231
v_cvt_pk_bf16_f32 v90, v228, v229
v_mfma_f32_16x16x32_bf16 v[232:235], v[204:207], a[148:151], v[232:235]
v_mfma_f32_16x16x32_bf16 v[232:235], v[208:211], a[144:147], v[232:235]
s_nop 2
v_mfma_f32_16x16x32_bf16 v[228:231], v[208:211], a[160:163], 0
s_waitcnt lgkmcnt(0)
v_max_f32 v254, v254, v255
s_nop 0
v_mfma_f32_16x16x32_bf16 v[228:231], v[204:207], a[164:167], v[228:231]
ds_bpermute_b32 v255, v247, v254
v_mfma_f32_16x16x32_bf16 v[228:231], v[196:199], a[168:171], v[228:231]
v_cvt_pk_bf16_f32 v95, v234, v235
v_cvt_pk_bf16_f32 v94, v232, v233
v_mfma_f32_16x16x32_bf16 v[228:231], v[192:195], a[172:175], v[228:231]
s_nop 2
v_mfma_f32_16x16x32_bf16 v[232:235], v[192:195], a[188:191], 0
ds_read_b128 v[192:195], v236 offset:4224
s_nop 0
v_mfma_f32_16x16x32_bf16 v[232:235], v[204:207], a[180:183], v[232:235]
ds_read_b128 v[204:207], v236 offset:4480
v_cvt_pk_bf16_f32 v99, v230, v231
v_mfma_f32_16x16x32_bf16 v[232:235], v[208:211], a[176:179], v[232:235]
ds_read_b128 v[208:211], v236 offset:4736
v_cvt_pk_bf16_f32 v98, v228, v229
v_mfma_f32_16x16x32_bf16 v[232:235], v[196:199], a[184:187], v[232:235]
s_waitcnt lgkmcnt(3)
ds_read_b128 v[196:199], v236 offset:4992
v_max_f32 v254, v254, v255
v_sub_f32 v184, v184, v254
v_sub_f32 v185, v185, v254
v_exp_f32 v184, v184
v_exp_f32 v185, v185
v_sub_f32 v187, v187, v254
v_cvt_pk_bf16_f32 v103, v234, v235
v_cvt_pk_bf16_f32 v102, v232, v233
v_add_f32 v248, v184, v185
v_sub_f32 v186, v186, v254
v_exp_f32 v186, v186
v_cvt_pk_bf16_f32 v120, v184, v185
v_add_f32 v248, v248, v186
s_waitcnt lgkmcnt(1)
v_mfma_f32_16x16x32_bf16 v[228:231], v[208:211], a[184:187], 0
v_sub_f32 v188, v188, v254
s_waitcnt lgkmcnt(0)
v_mfma_f32_16x16x32_bf16 v[228:231], v[196:199], a[188:191], v[228:231]
v_exp_f32 v187, v187
v_mfma_f32_16x16x32_bf16 v[228:231], v[204:207], a[180:183], v[228:231]
v_cvt_pk_bf16_f32 v121, v186, v187
v_add_f32 v248, v248, v187
v_mfma_f32_16x16x32_bf16 v[228:231], v[192:195], a[176:179], v[228:231]
v_sub_f32 v189, v189, v254
v_sub_f32 v190, v190, v254
v_mfma_f32_16x16x32_bf16 v[232:235], v[192:195], a[160:163], 0
v_exp_f32 v189, v189
v_mfma_f32_16x16x32_bf16 v[232:235], v[204:207], a[164:167], v[232:235]
v_exp_f32 v190, v190
v_mfma_f32_16x16x32_bf16 v[232:235], v[208:211], a[168:171], v[232:235]
s_nop 0
v_cvt_pk_bf16_f32 v71, v230, v231
v_cvt_pk_bf16_f32 v70, v228, v229
v_mfma_f32_16x16x32_bf16 v[232:235], v[196:199], a[172:175], v[232:235]
s_add_u32 s48, s48, s51
v_exp_f32 v188, v188
v_mfma_f32_16x16x32_bf16 v[228:231], v[196:199], a[156:159], 0
s_add_u32 m0, s49, 21120
v_add_f32 v248, v248, v188
v_sub_f32 v191, v191, v254
v_mfma_f32_16x16x32_bf16 v[228:231], v[208:211], a[152:155], v[228:231]
buffer_load_dwordx4 v237, s[16:19], s48 offen nt lds
v_cvt_pk_bf16_f32 v66, v232, v233
v_mfma_f32_16x16x32_bf16 v[228:231], v[204:207], a[148:151], v[228:231]
v_cvt_pk_bf16_f32 v67, v234, v235
v_add_f32 v248, v248, v189
v_mfma_f32_16x16x32_bf16 v[228:231], v[192:195], a[144:147], v[228:231]
v_exp_f32 v191, v191
v_mfma_f32_16x16x32_bf16 v[232:235], v[192:195], a[128:131], 0
ds_read_b128 v[192:195], v236 offset:0
v_cvt_pk_bf16_f32 v122, v188, v189
v_mfma_f32_16x16x32_bf16 v[232:235], v[208:211], a[136:139], v[232:235]
ds_read_b128 v[208:211], v236 offset:256
v_add_f32 v248, v248, v190
v_mfma_f32_16x16x32_bf16 v[232:235], v[196:199], a[140:143], v[232:235]
ds_read_b128 v[196:199], v236 offset:512
v_cvt_pk_bf16_f32 v62, v228, v229
v_mfma_f32_16x16x32_bf16 v[232:235], v[204:207], a[132:135], v[232:235]
ds_read_b128 v[204:207], v236 offset:768
v_cvt_pk_bf16_f32 v63, v230, v231
v_add_f32 v248, v248, v191
v_cvt_pk_bf16_f32 v123, v190, v191
v_sub_f32 v200, v200, v254
v_exp_f32 v200, v200
v_sub_f32 v201, v201, v254
v_exp_f32 v201, v201
v_cvt_pk_bf16_f32 v59, v234, v235
v_cvt_pk_bf16_f32 v58, v232, v233
v_sub_f32 v203, v203, v254
s_waitcnt lgkmcnt(2)
v_mfma_f32_16x16x32_bf16 v[228:231], v[208:211], a[132:135], 0
ds_read_b128 v[188:191], v242 offset:64
v_sub_f32 v202, v202, v254
v_mfma_f32_16x16x32_bf16 v[228:231], v[192:195], a[128:131], v[228:231]
s_waitcnt lgkmcnt(2)
v_exp_f32 v203, v203
v_mfma_f32_16x16x32_bf16 v[228:231], v[196:199], a[136:139], v[228:231]
s_waitcnt lgkmcnt(1)
v_exp_f32 v202, v202
v_mfma_f32_16x16x32_bf16 v[228:231], v[204:207], a[140:143], v[228:231]
v_add_f32 v248, v248, v200
v_add_f32 v248, v248, v201
v_mfma_f32_16x16x32_bf16 v[184:187], v[204:207], a[156:159], 0
v_add_f32 v248, v248, v202
v_add_f32 v248, v248, v203
v_mfma_f32_16x16x32_bf16 v[184:187], v[196:199], a[152:155], v[184:187]
v_cvt_pk_bf16_f32 v124, v200, v201
v_cvt_pk_bf16_f32 v125, v202, v203
v_mfma_f32_16x16x32_bf16 v[184:187], v[208:211], a[148:151], v[184:187]
s_waitcnt lgkmcnt(0)
v_cvt_pk_bf16_f32 v56, v228, v229
v_cvt_pk_bf16_f32 v57, v230, v231
v_mfma_f32_16x16x32_bf16 v[184:187], v[192:195], a[144:147], v[184:187]
v_sub_f32 v212, v212, v254
v_sub_f32 v213, v213, v254
v_mfma_f32_16x16x32_bf16 v[228:231], v[192:195], a[160:163], 0
v_exp_f32 v212, v212
v_mfma_f32_16x16x32_bf16 v[228:231], v[208:211], a[164:167], v[228:231]
v_sub_f32 v214, v214, v254
v_add_f32 v248, v248, v212
v_mfma_f32_16x16x32_bf16 v[228:231], v[196:199], a[168:171], v[228:231]
v_cvt_pk_bf16_f32 v60, v184, v185
v_cvt_pk_bf16_f32 v61, v186, v187
v_mfma_f32_16x16x32_bf16 v[228:231], v[204:207], a[172:175], v[228:231]
s_add_u32 m0, s49, 23232
ds_read_b128 v[184:187], v242 offset:0
v_sub_f32 v215, v215, v254
v_mfma_f32_16x16x32_bf16 v[232:235], v[204:207], a[188:191], 0
s_add_u32 s48, s48, s51
buffer_load_dwordx4 v237, s[16:19], s48 offen nt lds
v_sub_f32 v216, v216, v254
v_mfma_f32_16x16x32_bf16 v[232:235], v[196:199], a[184:187], v[232:235]
s_sub_u32 s49, s49, s56
v_exp_f32 v213, v213
v_mfma_f32_16x16x32_bf16 v[232:235], v[208:211], a[180:183], v[232:235]
s_and_b32 s51, s57, 26212352
v_exp_f32 v214, v214
v_mfma_f32_16x16x32_bf16 v[232:235], v[192:195], a[176:179], v[232:235]
s_add_u32 s51, s51, 2048
v_cvt_pk_bf16_f32 v126, v212, v213
v_add_f32 v248, v248, v213
v_mfma_f32_16x16x32_bf16 v[200:203], v[4:7], v[188:191], 0
v_add_f32 v248, v248, v214
s_waitcnt lgkmcnt(0)
v_mfma_f32_16x16x32_bf16 v[200:203], v[0:3], v[184:187], v[200:203]
s_nop 0
v_cvt_pk_bf16_f32 v69, v234, v235
v_cvt_pk_bf16_f32 v68, v232, v233
v_mfma_f32_16x16x32_bf16 v[232:235], v[32:35], v[184:187], 0
ds_read_b128 v[184:187], v245 offset:64
v_sub_f32 v218, v218, v254
v_mfma_f32_16x16x32_bf16 v[232:235], v[36:39], v[188:191], v[232:235]
ds_read_b128 v[188:191], v243 offset:0
v_exp_f32 v215, v215
s_nop 0
v_add_f32 v248, v248, v215
v_cvt_pk_bf16_f32 v127, v214, v215
ds_read_b128 v[212:215], v243 offset:64
v_exp_f32 v216, v216
v_sub_f32 v217, v217, v254
v_add_f32 v248, v248, v216
v_exp_f32 v218, v218
v_sub_f32 v219, v219, v254
v_exp_f32 v217, v217
v_exp_f32 v219, v219
v_cvt_pk_bf16_f32 v128, v216, v217
v_cvt_pk_bf16_f32 v129, v218, v219
v_add_f32 v248, v248, v217
v_add_f32 v248, v248, v218
v_add_f32 v248, v248, v219
v_cvt_pk_bf16_f32 v64, v228, v229
v_cvt_pk_bf16_f32 v65, v230, v231
v_sub_f32 v220, v220, v254
v_sub_f32 v221, v221, v254
s_waitcnt lgkmcnt(0)
v_mfma_f32_16x16x32_bf16 v[200:203], v[12:15], v[212:215], v[200:203]
ds_read_b128 v[216:219], v244 offset:0
ds_read_b128 v[228:231], v245 offset:0
v_mfma_f32_16x16x32_bf16 v[200:203], v[8:11], v[188:191], v[200:203]
v_exp_f32 v220, v220
v_mfma_f32_16x16x32_bf16 v[232:235], v[40:43], v[188:191], v[232:235]
ds_read_b128 v[188:191], v244 offset:64
v_add_f32 v248, v248, v220
v_mfma_f32_16x16x32_bf16 v[232:235], v[44:47], v[212:215], v[232:235]
v_exp_f32 v221, v221
v_sub_f32 v223, v223, v254
v_add_f32 v248, v248, v221
v_exp_f32 v223, v223
v_sub_f32 v222, v222, v254
v_exp_f32 v222, v222
v_cvt_pk_bf16_f32 v130, v220, v221
v_mov_b32 v221, 0xff800000
v_add_f32 v248, v248, v222
v_cvt_pk_bf16_f32 v131, v222, v223
v_add_f32 v248, v248, v223
v_sub_f32 v224, v224, v254
v_exp_f32 v224, v224
s_waitcnt lgkmcnt(0)
v_mfma_f32_16x16x32_bf16 v[200:203], v[20:23], v[188:191], v[200:203]
v_cvt_pk_bf16_f32 v132, v224, 0
v_add_f32 v248, v248, v224
v_mfma_f32_16x16x32_bf16 v[200:203], v[16:19], v[216:219], v[200:203]
ds_swizzle_b32 v250, v248 offset:0x401F
v_add_u32 v245, 0x200, v245
v_mfma_f32_16x16x32_bf16 v[232:235], v[48:51], v[216:219], v[232:235]
v_add_u32 v244, 0x200, v244
v_add_u32 v243, 0x200, v243
v_mfma_f32_16x16x32_bf16 v[232:235], v[52:55], v[188:191], v[232:235]
v_add_u32 v242, 0x200, v242
s_nop 0
v_mfma_f32_16x16x32_bf16 v[200:203], v[24:27], v[228:231], v[200:203]
s_nop 2
v_mfma_f32_16x16x32_bf16 v[200:203], v[28:31], v[184:187], v[200:203]
s_nop 0
v_mov_b32_dpp v233, v221 quad_perm:[0,1,2,3] row_mask:0xf bank_mask:0xc
v_mov_b32_dpp v232, v221 quad_perm:[0,1,2,3] row_mask:0xf bank_mask:0x8
v_mfma_f32_16x16x32_bf16 v[184:187], a[0:3], v[192:195], 0
v_mov_b32_dpp v234, v221 quad_perm:[0,1,2,3] row_mask:0xf bank_mask:0xc
v_mov_b32_dpp v235, v221 quad_perm:[0,1,2,3] row_mask:0xf bank_mask:0xc
v_mfma_f32_16x16x32_bf16 v[184:187], a[4:7], v[208:211], v[184:187]
s_waitcnt lgkmcnt(0)
v_max3_f32 v223, v200, v201, v202
v_max3_f32 v223, v223, v203, v232
v_mfma_f32_16x16x32_bf16 v[184:187], a[8:11], v[196:199], v[184:187]
v_max3_f32 v223, v223, v233, v234
v_max_f32 v223, v223, v235
v_mfma_f32_16x16x32_bf16 v[184:187], a[12:15], v[204:207], v[184:187]
s_nop 0
v_max_f32_dpp v223, v223, v223 row_ror:8 row_mask:0xf bank_mask:0xf
v_add_f32 v248, v248, v250
v_mfma_f32_16x16x32_bf16 v[188:191], a[28:31], v[204:207], 0
ds_bpermute_b32 v250, v247, v248
v_mfma_f32_16x16x32_bf16 v[188:191], a[24:27], v[196:199], v[188:191]
v_max_f32_dpp v223, v223, v223 row_ror:4 row_mask:0xf bank_mask:0xf
v_mfma_f32_16x16x32_bf16 v[188:191], a[20:23], v[208:211], v[188:191]
ds_swizzle_b32 v221, v223 offset:0x401F
v_cvt_pk_bf16_f32 v113, v186, v187
v_mfma_f32_16x16x32_bf16 v[188:191], a[16:19], v[192:195], v[188:191]
v_cvt_pk_bf16_f32 v112, v184, v185
s_nop 0
v_mfma_f32_16x16x32_bf16 v[184:187], a[32:35], v[192:195], 0
s_nop 2
v_mfma_f32_16x16x32_bf16 v[184:187], a[36:39], v[208:211], v[184:187]
s_nop 0
v_cvt_pk_bf16_f32 v115, v190, v191
v_cvt_pk_bf16_f32 v114, v188, v189
v_mfma_f32_16x16x32_bf16 v[184:187], a[40:43], v[196:199], v[184:187]
s_waitcnt lgkmcnt(1)
v_add_f32 v248, v248, v250
v_mfma_f32_16x16x32_bf16 v[184:187], a[44:47], v[204:207], v[184:187]
v_rcp_f32 v251, v248
v_mfma_f32_16x16x32_bf16 v[188:191], a[60:63], v[204:207], 0
s_waitcnt lgkmcnt(0)
v_max_f32 v223, v223, v221
s_nop 0
v_mfma_f32_16x16x32_bf16 v[188:191], a[56:59], v[196:199], v[188:191]
ds_bpermute_b32 v221, v247, v223
v_mfma_f32_16x16x32_bf16 v[188:191], a[52:55], v[208:211], v[188:191]
v_cvt_pk_bf16_f32 v117, v186, v187
v_cvt_pk_bf16_f32 v116, v184, v185
v_mfma_f32_16x16x32_bf16 v[188:191], a[48:51], v[192:195], v[188:191]
s_nop 2
v_mfma_f32_16x16x32_bf16 v[168:171], a[192:195], v[192:195], 0
s_nop 2
v_mfma_f32_16x16x32_bf16 v[168:171], a[196:199], v[208:211], v[168:171]
v_cvt_pk_bf16_f32 v119, v190, v191
v_cvt_pk_bf16_f32 v118, v188, v189
v_mfma_f32_16x16x32_bf16 v[168:171], a[200:203], v[196:199], v[168:171]
v_mfma_f32_16x16x32_bf16 v[168:171], a[204:207], v[204:207], v[168:171]
s_waitcnt lgkmcnt(0)
v_max_f32 v223, v223, v221
v_sub_f32 v200, v200, v223
v_mfma_f32_16x16x32_bf16 v[172:175], a[220:223], v[204:207], 0
v_exp_f32 v200, v200
v_mfma_f32_16x16x32_bf16 v[172:175], a[216:219], v[196:199], v[172:175]
v_sub_f32 v201, v201, v223
v_sub_f32 v202, v202, v223
v_mfma_f32_16x16x32_bf16 v[172:175], a[212:215], v[208:211], v[172:175]
v_exp_f32 v202, v202
v_mfma_f32_16x16x32_bf16 v[172:175], a[208:211], v[192:195], v[172:175]
v_exp_f32 v201, v201
v_mfma_f32_16x16x32_bf16 v[176:179], a[224:227], v[192:195], 0
v_add_f32 v220, v200, v201
v_add_f32 v220, v220, v202
v_mfma_f32_16x16x32_bf16 v[176:179], a[228:231], v[208:211], v[176:179]
v_sub_f32 v203, v203, v223
v_sub_f32 v233, v233, v223
v_mfma_f32_16x16x32_bf16 v[176:179], a[232:235], v[196:199], v[176:179]
v_exp_f32 v233, v233
v_mfma_f32_16x16x32_bf16 v[176:179], a[236:239], v[204:207], v[176:179]
v_exp_f32 v203, v203
v_mfma_f32_16x16x32_bf16 v[180:183], a[252:255], v[204:207], 0
v_sub_f32 v232, v232, v223
v_sub_f32 v234, v234, v223
v_mfma_f32_16x16x32_bf16 v[180:183], a[248:251], v[196:199], v[180:183]
v_exp_f32 v232, v232
v_mfma_f32_16x16x32_bf16 v[180:183], a[244:247], v[208:211], v[180:183]
v_exp_f32 v234, v234
v_mfma_f32_16x16x32_bf16 v[180:183], a[240:243], v[192:195], v[180:183]
v_add_f32 v220, v220, v203
v_add_f32 v220, v220, v232
v_mfma_f32_16x16x32_bf16 v[184:187], v[0:3], v[112:115], 0
v_add_f32 v220, v220, v233
v_add_f32 v220, v220, v234
v_mfma_f32_16x16x32_bf16 v[184:187], v[4:7], v[116:119], v[184:187]
v_sub_f32 v235, v235, v223
v_cvt_pk_bf16_f32 v200, v200, v201
v_mfma_f32_16x16x32_bf16 v[188:191], v[12:15], v[116:119], 0
v_exp_f32 v235, v235
v_mfma_f32_16x16x32_bf16 v[188:191], v[8:11], v[112:115], v[188:191]
v_add_f32 v220, v220, v235
v_cvt_pk_bf16_f32 v201, v202, v203
v_mfma_f32_16x16x32_bf16 v[192:195], v[16:19], v[112:115], 0
v_cvt_pk_bf16_f32 v202, v232, v233
v_cvt_pk_bf16_f32 v203, v234, v235
v_mfma_f32_16x16x32_bf16 v[192:195], v[20:23], v[116:119], v[192:195]
ds_read_b128 v[196:199], v236 offset:8448
v_add_f32_dpp v220, v220, v220 row_ror:8 row_mask:0xf bank_mask:0xf
v_mfma_f32_16x16x32_bf16 v[208:211], v[28:31], v[116:119], 0
ds_read_b128 v[204:207], v236 offset:8704
v_add_f32_dpp v220, v220, v220 row_ror:4 row_mask:0xf bank_mask:0xf
v_mfma_f32_16x16x32_bf16 v[208:211], v[24:27], v[112:115], v[208:211]
ds_write_b32 v246, v220 offset:4096
ds_read_b128 v[212:215], v236 offset:8960
v_mfma_f32_16x16x32_bf16 v[216:219], v[32:35], v[112:115], 0
ds_read_b128 v[224:227], v236 offset:9216
v_max3_f32 v254, v184, v185, v186
v_mfma_f32_16x16x32_bf16 v[216:219], v[36:39], v[116:119], v[216:219]
v_max3_f32 v254, v254, v187, v188
v_max3_f32 v254, v254, v189, v190
v_mfma_f32_16x16x32_bf16 v[228:231], v[44:47], v[116:119], 0
v_max3_f32 v254, v254, v191, v192
v_max3_f32 v254, v254, v193, v194
v_mfma_f32_16x16x32_bf16 v[228:231], v[40:43], v[112:115], v[228:231]
s_waitcnt lgkmcnt(4)
v_max3_f32 v254, v254, v195, v208
v_max3_f32 v254, v254, v209, v210
v_mfma_f32_16x16x32_bf16 v[232:235], v[48:51], v[112:115], 0
s_waitcnt lgkmcnt(3)
v_max3_f32 v254, v254, v211, v216
v_max3_f32 v254, v254, v217, v218
v_mfma_f32_16x16x32_bf16 v[232:235], v[52:55], v[116:119], v[232:235]
s_waitcnt lgkmcnt(1)
v_max3_f32 v254, v254, v219, v228
v_max3_f32 v254, v254, v229, v230
v_mfma_f32_16x16x32_bf16 v[220:223], v[196:199], a[128:131], 0
s_waitcnt lgkmcnt(0)
s_nop 1
v_mfma_f32_16x16x32_bf16 v[220:223], v[204:207], a[132:135], v[220:223]
v_max3_f32 v254, v254, v231, v232
v_mfma_f32_16x16x32_bf16 v[220:223], v[212:215], a[136:139], v[220:223]
ds_swizzle_b32 v255, v254 offset:0x401F
v_mfma_f32_16x16x32_bf16 v[220:223], v[224:227], a[140:143], v[220:223]
s_nop 7
v_cvt_pk_bf16_f32 v73, v222, v223
v_cvt_pk_bf16_f32 v72, v220, v221
v_mfma_f32_16x16x32_bf16 v[220:223], v[224:227], a[156:159], 0
v_mfma_f32_16x16x32_bf16 v[220:223], v[212:215], a[152:155], v[220:223]
v_mfma_f32_16x16x32_bf16 v[220:223], v[204:207], a[148:151], v[220:223]
s_waitcnt lgkmcnt(0)
v_max_f32 v254, v254, v255
v_mfma_f32_16x16x32_bf16 v[220:223], v[196:199], a[144:147], v[220:223]
ds_bpermute_b32 v255, v247, v254
s_nop 6
v_cvt_pk_bf16_f32 v76, v220, v221
v_cvt_pk_bf16_f32 v77, v222, v223
v_mfma_f32_16x16x32_bf16 v[220:223], v[196:199], a[160:163], 0
v_mfma_f32_16x16x32_bf16 v[220:223], v[204:207], a[164:167], v[220:223]
v_mfma_f32_16x16x32_bf16 v[220:223], v[212:215], a[168:171], v[220:223]
s_waitcnt lgkmcnt(0)
v_max_f32 v254, v254, v255
v_mfma_f32_16x16x32_bf16 v[220:223], v[224:227], a[172:175], v[220:223]
v_sub_f32 v184, v184, v254
v_exp_f32 v184, v184
v_sub_f32 v185, v185, v254
v_sub_f32 v187, v187, v254
v_exp_f32 v185, v185
s_nop 2
v_cvt_pk_bf16_f32 v81, v222, v223
v_cvt_pk_bf16_f32 v80, v220, v221
v_mfma_f32_16x16x32_bf16 v[220:223], v[224:227], a[188:191], 0
ds_read_b128 v[224:227], v236 offset:12672
v_add_f32 v249, v184, v185
v_mfma_f32_16x16x32_bf16 v[220:223], v[204:207], a[180:183], v[220:223]
ds_read_b128 v[204:207], v236 offset:12928
v_sub_f32 v186, v186, v254
v_mfma_f32_16x16x32_bf16 v[220:223], v[196:199], a[176:179], v[220:223]
ds_read_b128 v[196:199], v236 offset:13184
v_cvt_pk_bf16_f32 v136, v184, v185
v_mfma_f32_16x16x32_bf16 v[220:223], v[212:215], a[184:187], v[220:223]
ds_read_b128 v[212:215], v236 offset:13440
v_exp_f32 v186, v186
v_exp_f32 v187, v187
v_add_f32 v249, v249, v186
v_add_f32 v249, v249, v187
v_cvt_pk_bf16_f32 v137, v186, v187
v_sub_f32 v189, v189, v254
v_sub_f32 v188, v188, v254
v_cvt_pk_bf16_f32 v84, v220, v221
v_cvt_pk_bf16_f32 v85, v222, v223
v_exp_f32 v188, v188
v_exp_f32 v189, v189
v_sub_f32 v191, v191, v254
s_waitcnt lgkmcnt(1)
v_mfma_f32_16x16x32_bf16 v[184:187], v[196:199], a[184:187], 0
v_sub_f32 v190, v190, v254
s_waitcnt lgkmcnt(0)
v_mfma_f32_16x16x32_bf16 v[184:187], v[212:215], a[188:191], v[184:187]
v_exp_f32 v190, v190
v_mfma_f32_16x16x32_bf16 v[184:187], v[204:207], a[180:183], v[184:187]
v_exp_f32 v191, v191
v_mfma_f32_16x16x32_bf16 v[184:187], v[224:227], a[176:179], v[184:187]
v_add_f32 v249, v249, v188
v_add_f32 v249, v249, v189
v_mfma_f32_16x16x32_bf16 v[220:223], v[224:227], a[160:163], 0
v_add_f32 v249, v249, v190
v_cvt_pk_bf16_f32 v139, v190, v191
v_mfma_f32_16x16x32_bf16 v[220:223], v[204:207], a[164:167], v[220:223]
v_cvt_pk_bf16_f32 v138, v188, v189
v_add_f32 v249, v249, v191
v_mfma_f32_16x16x32_bf16 v[220:223], v[196:199], a[168:171], v[220:223]
v_cvt_pk_bf16_f32 v86, v184, v185
v_cvt_pk_bf16_f32 v87, v186, v187
v_mfma_f32_16x16x32_bf16 v[220:223], v[212:215], a[172:175], v[220:223]
v_sub_f32 v192, v192, v254
v_sub_f32 v194, v194, v254
v_mfma_f32_16x16x32_bf16 v[184:187], v[212:215], a[156:159], 0
v_exp_f32 v192, v192
v_mfma_f32_16x16x32_bf16 v[184:187], v[196:199], a[152:155], v[184:187]
v_add_f32 v249, v249, v192
v_sub_f32 v193, v193, v254
v_mfma_f32_16x16x32_bf16 v[184:187], v[204:207], a[148:151], v[184:187]
v_cvt_pk_bf16_f32 v83, v222, v223
v_cvt_pk_bf16_f32 v82, v220, v221
v_mfma_f32_16x16x32_bf16 v[184:187], v[224:227], a[144:147], v[184:187]
v_exp_f32 v193, v193
v_mfma_f32_16x16x32_bf16 v[220:223], v[224:227], a[128:131], 0
ds_read_b128 v[224:227], v236 offset:16896
v_sub_f32 v209, v209, v254
v_mfma_f32_16x16x32_bf16 v[220:223], v[196:199], a[136:139], v[220:223]
ds_read_b128 v[196:199], v236 offset:17152
v_sub_f32 v208, v208, v254
v_mfma_f32_16x16x32_bf16 v[220:223], v[212:215], a[140:143], v[220:223]
ds_read_b128 v[212:215], v236 offset:17408
v_cvt_pk_bf16_f32 v79, v186, v187
v_mfma_f32_16x16x32_bf16 v[220:223], v[204:207], a[132:135], v[220:223]
ds_read_b128 v[204:207], v236 offset:17664
v_cvt_pk_bf16_f32 v78, v184, v185
v_exp_f32 v208, v208
v_exp_f32 v209, v209
v_exp_f32 v194, v194
v_add_f32 v249, v249, v193
v_add_f32 v249, v249, v194
v_sub_f32 v195, v195, v254
v_cvt_pk_bf16_f32 v74, v220, v221
v_cvt_pk_bf16_f32 v75, v222, v223
s_waitcnt lgkmcnt(2)
v_mfma_f32_16x16x32_bf16 v[184:187], v[196:199], a[132:135], 0
v_exp_f32 v195, v195
v_mfma_f32_16x16x32_bf16 v[184:187], v[224:227], a[128:131], v[184:187]
s_waitcnt lgkmcnt(1)
v_sub_f32 v216, v216, v254
v_sub_f32 v211, v211, v254
v_mfma_f32_16x16x32_bf16 v[184:187], v[212:215], a[136:139], v[184:187]
s_waitcnt lgkmcnt(0)
v_sub_f32 v210, v210, v254
v_add_f32 v249, v249, v195
v_mfma_f32_16x16x32_bf16 v[184:187], v[204:207], a[140:143], v[184:187]
v_exp_f32 v211, v211
v_mfma_f32_16x16x32_bf16 v[220:223], v[204:207], a[156:159], 0
v_exp_f32 v210, v210
v_mfma_f32_16x16x32_bf16 v[220:223], v[212:215], a[152:155], v[220:223]
v_add_f32 v249, v249, v208
v_sub_f32 v219, v219, v254
v_mfma_f32_16x16x32_bf16 v[220:223], v[196:199], a[148:151], v[220:223]
s_nop 0
v_cvt_pk_bf16_f32 v89, v186, v187
v_cvt_pk_bf16_f32 v88, v184, v185
v_mfma_f32_16x16x32_bf16 v[220:223], v[224:227], a[144:147], v[220:223]
v_exp_f32 v216, v216
v_mfma_f32_16x16x32_bf16 v[184:187], v[224:227], a[160:163], 0
v_sub_f32 v217, v217, v254
v_add_f32 v249, v249, v209
v_mfma_f32_16x16x32_bf16 v[184:187], v[196:199], a[164:167], v[184:187]
v_sub_f32 v228, v228, v254
v_add_f32 v249, v249, v210
v_mfma_f32_16x16x32_bf16 v[184:187], v[212:215], a[168:171], v[184:187]
v_exp_f32 v217, v217
v_mfma_f32_16x16x32_bf16 v[184:187], v[204:207], a[172:175], v[184:187]
v_sub_f32 v229, v229, v254
v_sub_f32 v218, v218, v254
v_mfma_f32_16x16x32_bf16 v[188:191], v[204:207], a[188:191], 0
v_exp_f32 v218, v218
v_mfma_f32_16x16x32_bf16 v[188:191], v[212:215], a[184:187], v[188:191]
v_add_f32 v249, v249, v211
v_add_f32 v249, v249, v216
v_mfma_f32_16x16x32_bf16 v[188:191], v[196:199], a[180:183], v[188:191]
v_cvt_pk_bf16_f32 v96, v184, v185
v_cvt_pk_bf16_f32 v97, v186, v187
v_mfma_f32_16x16x32_bf16 v[188:191], v[224:227], a[176:179], v[188:191]
v_exp_f32 v219, v219
v_mfma_f32_16x16x32_bf16 v[184:187], a[0:3], v[224:227], 0
v_add_f32 v249, v249, v217
v_add_f32 v249, v249, v218
v_mfma_f32_16x16x32_bf16 v[184:187], a[4:7], v[196:199], v[184:187]
v_add_f32 v249, v249, v219
v_cvt_pk_bf16_f32 v144, v216, v217
v_mfma_f32_16x16x32_bf16 v[184:187], a[8:11], v[212:215], v[184:187]
v_cvt_pk_bf16_f32 v100, v188, v189
v_cvt_pk_bf16_f32 v101, v190, v191
v_mfma_f32_16x16x32_bf16 v[184:187], a[12:15], v[204:207], v[184:187]
v_cvt_pk_bf16_f32 v145, v218, v219
v_cvt_pk_bf16_f32 v92, v220, v221
v_mfma_f32_16x16x32_bf16 v[188:191], a[28:31], v[204:207], 0
v_cvt_pk_bf16_f32 v93, v222, v223
v_sub_f32 v232, v232, v254
v_mfma_f32_16x16x32_bf16 v[188:191], a[24:27], v[212:215], v[188:191]
v_exp_f32 v228, v228
v_mfma_f32_16x16x32_bf16 v[188:191], a[20:23], v[196:199], v[188:191]
v_cvt_pk_bf16_f32 v112, v184, v185
v_cvt_pk_bf16_f32 v113, v186, v187
v_mfma_f32_16x16x32_bf16 v[188:191], a[16:19], v[224:227], v[188:191]
v_exp_f32 v229, v229
v_mfma_f32_16x16x32_bf16 v[184:187], a[32:35], v[224:227], 0
v_add_f32 v249, v249, v228
v_sub_f32 v231, v231, v254
v_mfma_f32_16x16x32_bf16 v[184:187], a[36:39], v[196:199], v[184:187]
v_exp_f32 v232, v232
v_mfma_f32_16x16x32_bf16 v[184:187], a[40:43], v[212:215], v[184:187]
s_nop 0
v_cvt_pk_bf16_f32 v115, v190, v191
v_cvt_pk_bf16_f32 v114, v188, v189
v_mfma_f32_16x16x32_bf16 v[184:187], a[44:47], v[204:207], v[184:187]
v_sub_f32 v230, v230, v254
v_add_f32 v249, v249, v229
v_mfma_f32_16x16x32_bf16 v[188:191], a[60:63], v[204:207], 0
v_cvt_pk_bf16_f32 v140, v192, v193
v_mov_b32 v192, v202
v_mfma_f32_16x16x32_bf16 v[188:191], a[56:59], v[212:215], v[188:191]
v_cvt_pk_bf16_f32 v142, v208, v209
v_mov_b32_dpp v209, v201 row_ror:8 row_mask:0xf bank_mask:0xf
v_mfma_f32_16x16x32_bf16 v[188:191], a[52:55], v[196:199], v[188:191]
v_cvt_pk_bf16_f32 v116, v184, v185
v_cvt_pk_bf16_f32 v117, v186, v187
v_mfma_f32_16x16x32_bf16 v[188:191], a[48:51], v[224:227], v[188:191]
v_mov_b32_dpp v208, v200 row_ror:8 row_mask:0xf bank_mask:0xf
v_cvt_pk_bf16_f32 v143, v210, v211
v_mfma_f32_16x16x32_bf16 v[216:219], v[56:59], v[120:123], 0
v_mov_b32_dpp v211, v201 row_ror:4 row_mask:0xf bank_mask:0xf
v_mov_b32_dpp v210, v200 row_ror:4 row_mask:0xf bank_mask:0xf
v_mfma_f32_16x16x32_bf16 v[216:219], v[104:107], v[132:135], v[216:219]
v_cvt_pk_bf16_f32 v141, v194, v195
v_mov_b32_dpp v194, v202 row_ror:12 row_mask:0xf bank_mask:0xf
v_mfma_f32_16x16x32_bf16 v[216:219], v[72:75], v[124:127], v[216:219]
v_cvt_pk_bf16_f32 v118, v188, v189
v_cvt_pk_bf16_f32 v119, v190, v191
v_mfma_f32_16x16x32_bf16 v[216:219], v[88:91], v[128:131], v[216:219]
v_mov_b32_dpp v195, v203 row_ror:12 row_mask:0xf bank_mask:0xf
v_mov_b32 v193, v203
v_mfma_f32_16x16x32_bf16 v[220:223], v[92:95], v[128:131], 0
v_mov_b32_dpp v203, v201 row_ror:12 row_mask:0xf bank_mask:0xf
v_mov_b32_dpp v202, v200 row_ror:12 row_mask:0xf bank_mask:0xf
v_mfma_f32_16x16x32_bf16 v[220:223], v[76:79], v[124:127], v[220:223]
v_exp_f32 v230, v230
v_mfma_f32_16x16x32_bf16 v[220:223], v[106:109], v[132:135], v[220:223]
v_fmac_f32 v154, v218, v251
v_fmac_f32 v152, v216, v251
v_mfma_f32_16x16x32_bf16 v[220:223], v[60:63], v[120:123], v[220:223]
v_fmac_f32 v155, v219, v251
v_fmac_f32 v153, v217, v251
v_mfma_f32_16x16x32_bf16 v[188:191], v[64:67], v[120:123], 0
v_exp_f32 v231, v231
v_mfma_f32_16x16x32_bf16 v[188:191], v[108:111], v[132:135], v[188:191]
v_add_f32 v249, v249, v230
v_add_f32 v249, v249, v231
v_mfma_f32_16x16x32_bf16 v[188:191], v[80:83], v[124:127], v[188:191]
v_cvt_pk_bf16_f32 v146, v228, v229
v_cvt_pk_bf16_f32 v147, v230, v231
v_mfma_f32_16x16x32_bf16 v[188:191], v[96:99], v[128:131], v[188:191]
v_add_f32 v249, v249, v232
v_fmac_f32 v156, v220, v251
v_mfma_f32_16x16x32_bf16 v[184:187], v[100:103], v[128:131], 0
ds_swizzle_b32 v250, v249 offset:0x401F
v_fmac_f32 v158, v222, v251
v_mfma_f32_16x16x32_bf16 v[184:187], v[84:87], v[124:127], v[184:187]
v_fmac_f32 v157, v221, v251
v_fmac_f32 v159, v223, v251
v_mfma_f32_16x16x32_bf16 v[184:187], v[68:71], v[120:123], v[184:187]
v_fmac_f32 v161, v189, v251
v_fmac_f32 v160, v188, v251
v_mfma_f32_16x16x32_bf16 v[184:187], v[110:113], v[132:135], v[184:187]
v_mov_b32_dpp v132, v192 row_ror:8 row_mask:0xf bank_mask:0xf
v_fmac_f32 v163, v191, v251
v_fmac_f32 v162, v190, v251
v_mfma_f32_16x16x32_bf16 v[216:219], v[110:113], v[132:135], 0
v_cvt_pk_bf16_f32 v152, v152, v153
v_cvt_pk_bf16_f32 v153, v154, v155
v_mfma_f32_16x16x32_bf16 v[216:219], v[84:87], v[208:211], v[216:219]
s_nop 0
v_fmac_f32 v167, v187, v251
v_fmac_f32 v164, v184, v251
v_mfma_f32_16x16x32_bf16 v[216:219], v[100:103], v[192:195], v[216:219]
s_waitcnt lgkmcnt(0)
v_fmac_f32 v165, v185, v251
v_fmac_f32 v166, v186, v251
v_mfma_f32_16x16x32_bf16 v[216:219], v[68:71], v[200:203], v[216:219]
v_add_f32 v249, v249, v250
v_pk_max_i16 v153, v153, 0
v_mfma_f32_16x16x32_bf16 v[188:191], v[64:67], v[200:203], 0
ds_bpermute_b32 v250, v247, v249
v_mfma_f32_16x16x32_bf16 v[188:191], v[80:83], v[208:211], v[188:191]
v_cvt_pk_bf16_f32 v160, v160, v161
v_cvt_pk_bf16_f32 v161, v162, v163
v_mfma_f32_16x16x32_bf16 v[188:191], v[96:99], v[192:195], v[188:191]
v_cvt_pk_bf16_f32 v216, v216, v217
v_cvt_pk_bf16_f32 v217, v218, v219
v_mfma_f32_16x16x32_bf16 v[188:191], v[108:111], v[132:135], v[188:191]
ds_write_b64 v246, v[216:217] offset:24
v_mfma_f32_16x16x32_bf16 v[228:231], v[106:109], v[132:135], 0
v_cvt_pk_bf16_f32 v162, v164, v165
v_pk_max_i16 v160, v160, 0
v_mfma_f32_16x16x32_bf16 v[228:231], v[76:79], v[208:211], v[228:231]
v_pk_max_i16 v161, v161, 0
v_cvt_pk_bf16_f32 v163, v166, v167
v_mfma_f32_16x16x32_bf16 v[228:231], v[92:95], v[192:195], v[228:231]
s_waitcnt lgkmcnt(1)
v_cvt_pk_bf16_f32 v188, v188, v189
v_cvt_pk_bf16_f32 v189, v190, v191
v_mfma_f32_16x16x32_bf16 v[228:231], v[60:63], v[200:203], v[228:231]
ds_write_b64 v246, v[188:189] offset:16
v_mfma_f32_16x16x32_bf16 v[184:187], v[56:59], v[200:203], 0
v_pk_max_i16 v163, v163, 0
v_cvt_pk_bf16_f32 v155, v158, v159
v_mfma_f32_16x16x32_bf16 v[184:187], v[72:75], v[208:211], v[184:187]
v_pk_max_i16 v162, v162, 0
v_cvt_pk_bf16_f32 v154, v156, v157
v_mfma_f32_16x16x32_bf16 v[184:187], v[88:91], v[192:195], v[184:187]
v_cvt_pk_bf16_f32 v228, v228, v229
v_cvt_pk_bf16_f32 v229, v230, v231
v_mfma_f32_16x16x32_bf16 v[184:187], v[104:107], v[132:135], v[184:187]
ds_write_b64 v246, v[228:229] offset:8
v_mfma_f32_16x16x32_bf16 v[188:191], v[0:3], v[112:115], 0
v_pk_max_i16 v154, v154, 0
v_pk_max_i16 v152, v152, 0
v_mfma_f32_16x16x32_bf16 v[188:191], v[4:7], v[116:119], v[188:191]
v_pk_max_i16 v155, v155, 0
v_add_f32 v249, v249, v250
v_mfma_f32_16x16x32_bf16 v[192:195], v[12:15], v[116:119], 0
buffer_store_dwordx4 v[152:155], v239, s[20:23], s52 offen offset:0 nt
buffer_store_dwordx4 v[160:163], v239, s[20:23], s52 offen offset:64 nt
v_cvt_pk_bf16_f32 v184, v184, v185
v_cvt_pk_bf16_f32 v185, v186, v187
v_rcp_f32 v252, v249
v_max3_f32 v254, v188, v189, v190
v_cvt_pk_bf16_f32 v148, v232, 0
s_add_u32 s52, s46, 16384
v_mfma_f32_16x16x32_bf16 v[192:195], v[8:11], v[112:115], v[192:195]
ds_write_b64 v246, v[184:185] offset:0
v_mfma_f32_16x16x32_bf16 v[200:203], v[16:19], v[112:115], 0
s_nop 0
v_add_u32 v246, 0x200, v246
s_nop 0
v_mfma_f32_16x16x32_bf16 v[200:203], v[20:23], v[116:119], v[200:203]
s_nop 1
v_max3_f32 v254, v254, v191, v192
v_mfma_f32_16x16x32_bf16 v[184:187], v[28:31], v[116:119], 0
v_max3_f32 v254, v254, v193, v194
s_nop 0
v_mfma_f32_16x16x32_bf16 v[184:187], v[24:27], v[112:115], v[184:187]
s_nop 0
v_max3_f32 v254, v254, v195, v200
v_max3_f32 v254, v254, v201, v202
v_mfma_f32_16x16x32_bf16 v[208:211], v[32:35], v[112:115], 0
s_nop 2
v_mfma_f32_16x16x32_bf16 v[208:211], v[36:39], v[116:119], v[208:211]
v_max3_f32 v254, v254, v203, v184
v_max3_f32 v254, v254, v185, v186
v_mfma_f32_16x16x32_bf16 v[216:219], v[44:47], v[116:119], 0
s_nop 2
v_mfma_f32_16x16x32_bf16 v[216:219], v[40:43], v[112:115], v[216:219]
s_nop 0
v_max3_f32 v254, v254, v187, v208
v_max3_f32 v254, v254, v209, v210
v_mfma_f32_16x16x32_bf16 v[220:223], v[48:51], v[112:115], 0
s_nop 2
v_mfma_f32_16x16x32_bf16 v[220:223], v[52:55], v[116:119], v[220:223]
v_max3_f32 v254, v254, v211, v216
v_max3_f32 v254, v254, v217, v218
v_mfma_f32_16x16x32_bf16 v[152:155], a[192:195], v[224:227], 0
s_nop 2
v_mfma_f32_16x16x32_bf16 v[152:155], a[196:199], v[196:199], v[152:155]
s_nop 0
v_max3_f32 v254, v254, v219, v220
v_mfma_f32_16x16x32_bf16 v[152:155], a[200:203], v[212:215], v[152:155]
ds_swizzle_b32 v255, v254 offset:0x401F
v_mfma_f32_16x16x32_bf16 v[152:155], a[204:207], v[204:207], v[152:155]
v_mfma_f32_16x16x32_bf16 v[156:159], a[220:223], v[204:207], 0
v_mfma_f32_16x16x32_bf16 v[156:159], a[216:219], v[212:215], v[156:159]
v_mfma_f32_16x16x32_bf16 v[156:159], a[212:215], v[196:199], v[156:159]
v_mfma_f32_16x16x32_bf16 v[156:159], a[208:211], v[224:227], v[156:159]
v_mfma_f32_16x16x32_bf16 v[160:163], a[224:227], v[224:227], 0
s_waitcnt lgkmcnt(0)
v_max_f32 v254, v254, v255
v_mfma_f32_16x16x32_bf16 v[160:163], a[228:231], v[196:199], v[160:163]
ds_bpermute_b32 v255, v247, v254
v_mfma_f32_16x16x32_bf16 v[160:163], a[232:235], v[212:215], v[160:163]
v_mfma_f32_16x16x32_bf16 v[160:163], a[236:239], v[204:207], v[160:163]
v_mfma_f32_16x16x32_bf16 v[164:167], a[252:255], v[204:207], 0
v_mfma_f32_16x16x32_bf16 v[164:167], a[248:251], v[212:215], v[164:167]
v_mfma_f32_16x16x32_bf16 v[164:167], a[244:247], v[196:199], v[164:167]
v_mfma_f32_16x16x32_bf16 v[164:167], a[240:243], v[224:227], v[164:167]
s_waitcnt lgkmcnt(0)
v_max_f32 v254, v254, v255
v_sub_f32 v188, v188, v254
v_mfma_f32_16x16x32_bf16 v[196:199], v[56:59], v[136:139], 0
v_sub_f32 v190, v190, v254
v_sub_f32 v189, v189, v254
v_mfma_f32_16x16x32_bf16 v[196:199], v[104:107], v[148:151], v[196:199]
v_exp_f32 v189, v189
v_mfma_f32_16x16x32_bf16 v[196:199], v[72:75], v[140:143], v[196:199]
v_exp_f32 v188, v188
v_mfma_f32_16x16x32_bf16 v[196:199], v[88:91], v[144:147], v[196:199]
v_add_f32 v248, v188, v189
v_sub_f32 v191, v191, v254
v_mfma_f32_16x16x32_bf16 v[204:207], v[92:95], v[144:147], 0
v_exp_f32 v191, v191
v_mfma_f32_16x16x32_bf16 v[204:207], v[76:79], v[140:143], v[204:207]
v_exp_f32 v190, v190
v_mfma_f32_16x16x32_bf16 v[204:207], v[106:109], v[148:151], v[204:207]
v_cvt_pk_bf16_f32 v120, v188, v189
v_add_f32 v248, v248, v190
v_mfma_f32_16x16x32_bf16 v[204:207], v[60:63], v[136:139], v[204:207]
ds_read_b128 v[212:215], v236 offset:4224
v_add_f32 v248, v248, v191
v_mfma_f32_16x16x32_bf16 v[228:231], v[64:67], v[136:139], 0
ds_read_b128 v[224:227], v236 offset:4480
v_cvt_pk_bf16_f32 v121, v190, v191
v_mfma_f32_16x16x32_bf16 v[228:231], v[108:111], v[148:151], v[228:231]
v_fmac_f32 v170, v198, v252
v_fmac_f32 v171, v199, v252
v_mfma_f32_16x16x32_bf16 v[228:231], v[80:83], v[140:143], v[228:231]
v_fmac_f32 v168, v196, v252
v_fmac_f32 v169, v197, v252
v_mfma_f32_16x16x32_bf16 v[228:231], v[96:99], v[144:147], v[228:231]
ds_read_b128 v[196:199], v236 offset:4736
v_fmac_f32 v175, v207, v252
v_mfma_f32_16x16x32_bf16 v[232:235], v[100:103], v[144:147], 0
v_fmac_f32 v172, v204, v252
v_fmac_f32 v174, v206, v252
v_mfma_f32_16x16x32_bf16 v[232:235], v[84:87], v[140:143], v[232:235]
s_waitcnt lgkmcnt(2)
v_fmac_f32 v173, v205, v252
v_fmac_f32 v177, v229, v252
v_mfma_f32_16x16x32_bf16 v[232:235], v[110:113], v[148:151], v[232:235]
s_waitcnt lgkmcnt(1)
ds_read_b128 v[204:207], v236 offset:4992
v_fmac_f32 v176, v228, v252
v_mfma_f32_16x16x32_bf16 v[232:235], v[68:71], v[136:139], v[232:235]
v_fmac_f32 v178, v230, v252
v_fmac_f32 v179, v231, v252
v_mfma_f32_16x16x32_bf16 v[188:191], a[0:3], v[212:215], 0
v_cvt_pk_bf16_f32 v176, v176, v177
v_cvt_pk_bf16_f32 v168, v168, v169
v_mfma_f32_16x16x32_bf16 v[188:191], a[4:7], v[224:227], v[188:191]
s_waitcnt lgkmcnt(1)
v_cvt_pk_bf16_f32 v169, v170, v171
v_fmac_f32 v181, v233, v252
v_mfma_f32_16x16x32_bf16 v[188:191], a[8:11], v[196:199], v[188:191]
v_fmac_f32 v182, v234, v252
v_fmac_f32 v180, v232, v252
v_fmac_f32 v183, v235, v252
v_cvt_pk_bf16_f32 v170, v172, v173
v_pk_max_i16 v170, v170, 0
s_waitcnt lgkmcnt(0)
v_mfma_f32_16x16x32_bf16 v[188:191], a[12:15], v[204:207], v[188:191]
v_cvt_pk_bf16_f32 v171, v174, v175
v_pk_max_i16 v176, v176, 0
v_mfma_f32_16x16x32_bf16 v[232:235], a[28:31], v[204:207], 0
v_pk_max_i16 v171, v171, 0
v_cvt_pk_bf16_f32 v177, v178, v179
v_mfma_f32_16x16x32_bf16 v[232:235], a[24:27], v[196:199], v[232:235]
v_cvt_pk_bf16_f32 v178, v180, v181
v_pk_max_i16 v177, v177, 0
v_mfma_f32_16x16x32_bf16 v[232:235], a[20:23], v[224:227], v[232:235]
v_cvt_pk_bf16_f32 v112, v188, v189
v_cvt_pk_bf16_f32 v113, v190, v191
v_mfma_f32_16x16x32_bf16 v[232:235], a[16:19], v[212:215], v[232:235]
v_pk_max_i16 v168, v168, 0
v_cvt_pk_bf16_f32 v179, v182, v183
v_mfma_f32_16x16x32_bf16 v[188:191], a[32:35], v[212:215], 0
v_pk_max_i16 v179, v179, 0
v_pk_max_i16 v169, v169, 0
v_mfma_f32_16x16x32_bf16 v[188:191], a[36:39], v[224:227], v[188:191]
v_pk_max_i16 v178, v178, 0
v_sub_f32 v192, v192, v254
v_mfma_f32_16x16x32_bf16 v[188:191], a[40:43], v[196:199], v[188:191]
buffer_store_dwordx4 v[168:171], v239, s[20:23], s53 offen offset:0 nt
buffer_store_dwordx4 v[176:179], v239, s[20:23], s53 offen offset:64 nt
v_sub_f32 v193, v193, v254
v_exp_f32 v192, v192
v_exp_f32 v193, v193
v_sub_f32 v195, v195, v254
v_exp_f32 v195, v195
v_mfma_f32_16x16x32_bf16 v[188:191], a[44:47], v[204:207], v[188:191]
s_add_u32 s53, s46, 4096
v_add_f32 v248, v248, v192
v_sub_f32 v194, v194, v254
v_mfma_f32_16x16x32_bf16 v[228:231], a[60:63], v[204:207], 0
s_add_u32 s46, s46, 13107200
v_cvt_pk_bf16_f32 v114, v232, v233
v_cvt_pk_bf16_f32 v115, v234, v235
v_mfma_f32_16x16x32_bf16 v[228:231], a[56:59], v[196:199], v[228:231]
v_cvt_pk_bf16_f32 v117, v190, v191
v_cvt_pk_bf16_f32 v116, v188, v189
v_mfma_f32_16x16x32_bf16 v[228:231], a[52:55], v[224:227], v[228:231]
v_exp_f32 v194, v194
v_mfma_f32_16x16x32_bf16 v[228:231], a[48:51], v[212:215], v[228:231]
v_add_f32 v248, v248, v193
v_add_f32 v248, v248, v194
v_mfma_f32_16x16x32_bf16 v[168:171], a[192:195], v[212:215], 0
v_add_f32 v248, v248, v195
v_cvt_pk_bf16_f32 v122, v192, v193
v_mfma_f32_16x16x32_bf16 v[168:171], a[196:199], v[224:227], v[168:171]
v_cvt_pk_bf16_f32 v123, v194, v195
v_sub_f32 v201, v201, v254
v_mfma_f32_16x16x32_bf16 v[168:171], a[200:203], v[196:199], v[168:171]
v_cvt_pk_bf16_f32 v119, v230, v231
v_cvt_pk_bf16_f32 v118, v228, v229
v_mfma_f32_16x16x32_bf16 v[168:171], a[204:207], v[204:207], v[168:171]
v_sub_f32 v202, v202, v254
v_sub_f32 v200, v200, v254
v_mfma_f32_16x16x32_bf16 v[172:175], a[220:223], v[204:207], 0
v_exp_f32 v200, v200
v_mfma_f32_16x16x32_bf16 v[172:175], a[216:219], v[196:199], v[172:175]
v_exp_f32 v202, v202
v_mfma_f32_16x16x32_bf16 v[172:175], a[212:215], v[224:227], v[172:175]
v_exp_f32 v201, v201
v_mfma_f32_16x16x32_bf16 v[172:175], a[208:211], v[212:215], v[172:175]
v_sub_f32 v203, v203, v254
v_add_f32 v248, v248, v200
v_mfma_f32_16x16x32_bf16 v[176:179], a[224:227], v[212:215], 0
v_exp_f32 v203, v203
v_mfma_f32_16x16x32_bf16 v[176:179], a[228:231], v[224:227], v[176:179]
v_cvt_pk_bf16_f32 v125, v202, v203
v_add_f32 v248, v248, v201
v_mfma_f32_16x16x32_bf16 v[176:179], a[232:235], v[196:199], v[176:179]
v_add_f32 v248, v248, v202
v_cvt_pk_bf16_f32 v124, v200, v201
v_mfma_f32_16x16x32_bf16 v[176:179], a[236:239], v[204:207], v[176:179]
v_add_f32 v248, v248, v203
v_sub_f32 v184, v184, v254
v_mfma_f32_16x16x32_bf16 v[180:183], a[252:255], v[204:207], 0
v_sub_f32 v185, v185, v254
v_sub_f32 v187, v187, v254
v_mfma_f32_16x16x32_bf16 v[180:183], a[248:251], v[196:199], v[180:183]
v_sub_f32 v186, v186, v254
v_sub_f32 v220, v220, v254
v_mfma_f32_16x16x32_bf16 v[180:183], a[244:247], v[224:227], v[180:183]
v_exp_f32 v184, v184
v_mfma_f32_16x16x32_bf16 v[180:183], a[240:243], v[212:215], v[180:183]
v_add_f32 v248, v248, v184
v_sub_f32 v216, v216, v254
v_mfma_f32_16x16x32_bf16 v[188:191], v[0:3], v[112:115], 0
v_exp_f32 v187, v187
v_mfma_f32_16x16x32_bf16 v[188:191], v[4:7], v[116:119], v[188:191]
v_exp_f32 v186, v186
v_mfma_f32_16x16x32_bf16 v[192:195], v[12:15], v[116:119], 0
v_exp_f32 v185, v185
v_mfma_f32_16x16x32_bf16 v[192:195], v[8:11], v[112:115], v[192:195]
v_add_f32 v248, v248, v185
v_add_f32 v248, v248, v186
v_mfma_f32_16x16x32_bf16 v[196:199], v[16:19], v[112:115], 0
v_add_f32 v248, v248, v187
v_cvt_pk_bf16_f32 v127, v186, v187
v_mfma_f32_16x16x32_bf16 v[196:199], v[20:23], v[116:119], v[196:199]
v_cvt_pk_bf16_f32 v126, v184, v185
v_sub_f32 v218, v218, v254
v_mfma_f32_16x16x32_bf16 v[200:203], v[28:31], v[116:119], 0
v_exp_f32 v220, v220
v_mfma_f32_16x16x32_bf16 v[200:203], v[24:27], v[112:115], v[200:203]
v_cvt_pk_bf16_f32 v132, v220, 0
v_sub_f32 v217, v217, v254
v_mfma_f32_16x16x32_bf16 v[204:207], v[32:35], v[112:115], 0
v_sub_f32 v211, v211, v254
v_sub_f32 v210, v210, v254
v_mfma_f32_16x16x32_bf16 v[204:207], v[36:39], v[116:119], v[204:207]
v_sub_f32 v219, v219, v254
v_sub_f32 v208, v208, v254
v_mfma_f32_16x16x32_bf16 v[212:215], v[44:47], v[116:119], 0
v_sub_f32 v209, v209, v254
v_max3_f32 v254, v188, v189, v190
v_mfma_f32_16x16x32_bf16 v[212:215], v[40:43], v[112:115], v[212:215]
v_exp_f32 v209, v209
v_mfma_f32_16x16x32_bf16 v[224:227], v[48:51], v[112:115], 0
v_exp_f32 v208, v208
v_mfma_f32_16x16x32_bf16 v[224:227], v[52:55], v[116:119], v[224:227]
v_exp_f32 v217, v217
v_mfma_f32_16x16x32_bf16 v[184:187], v[56:59], v[120:123], 0
v_exp_f32 v210, v210
v_mfma_f32_16x16x32_bf16 v[184:187], v[104:107], v[132:135], v[184:187]
v_exp_f32 v218, v218
v_mfma_f32_16x16x32_bf16 v[184:187], v[72:75], v[124:127], v[184:187]
v_exp_f32 v211, v211
v_exp_f32 v216, v216
v_exp_f32 v219, v219
v_cvt_pk_bf16_f32 v129, v210, v211
v_cvt_pk_bf16_f32 v131, v218, v219
v_cvt_pk_bf16_f32 v130, v216, v217
v_cvt_pk_bf16_f32 v128, v208, v209
v_add_f32 v248, v248, v208
v_add_f32 v248, v248, v209
v_mfma_f32_16x16x32_bf16 v[184:187], v[88:91], v[128:131], v[184:187]
v_add_f32 v248, v248, v210
v_add_f32 v248, v248, v211
v_mfma_f32_16x16x32_bf16 v[208:211], v[92:95], v[128:131], 0
v_max3_f32 v254, v254, v191, v192
v_max3_f32 v254, v254, v193, v194
v_mfma_f32_16x16x32_bf16 v[208:211], v[76:79], v[124:127], v[208:211]
v_max3_f32 v254, v254, v195, v196
v_max3_f32 v254, v254, v197, v198
v_mfma_f32_16x16x32_bf16 v[208:211], v[106:109], v[132:135], v[208:211]
v_max3_f32 v254, v254, v199, v200
v_max3_f32 v254, v254, v201, v202
v_mfma_f32_16x16x32_bf16 v[208:211], v[60:63], v[120:123], v[208:211]
v_max3_f32 v254, v254, v203, v204
v_max3_f32 v254, v254, v205, v206
v_mfma_f32_16x16x32_bf16 v[228:231], v[64:67], v[120:123], 0
v_max3_f32 v254, v254, v207, v212
v_max3_f32 v254, v254, v213, v214
v_mfma_f32_16x16x32_bf16 v[228:231], v[108:111], v[132:135], v[228:231]
v_max3_f32 v254, v254, v215, v224
v_add_f32 v248, v248, v216
v_mfma_f32_16x16x32_bf16 v[228:231], v[80:83], v[124:127], v[228:231]
ds_swizzle_b32 v255, v254 offset:0x401F
v_add_f32 v248, v248, v217
v_mfma_f32_16x16x32_bf16 v[228:231], v[96:99], v[128:131], v[228:231]
v_add_f32 v248, v248, v218
v_add_f32 v248, v248, v219
v_mfma_f32_16x16x32_bf16 v[232:235], v[100:103], v[128:131], 0
ds_read_b128 v[216:219], v236 offset:8448
v_add_f32 v248, v248, v220
v_mfma_f32_16x16x32_bf16 v[232:235], v[84:87], v[124:127], v[232:235]
ds_read_b128 v[220:223], v236 offset:8704
ds_swizzle_b32 v250, v248 offset:0x401F
v_mfma_f32_16x16x32_bf16 v[232:235], v[110:113], v[132:135], v[232:235]
v_mfma_f32_16x16x32_bf16 v[232:235], v[68:71], v[120:123], v[232:235]
s_waitcnt lgkmcnt(3)
v_max_f32 v254, v254, v255
ds_bpermute_b32 v255, v247, v254
s_waitcnt lgkmcnt(1)
v_add_f32 v248, v248, v250
ds_bpermute_b32 v250, v247, v248
s_waitcnt lgkmcnt(1)
v_max_f32 v254, v254, v255
v_sub_f32 v188, v188, v254
v_exp_f32 v188, v188
v_sub_f32 v189, v189, v254
v_sub_f32 v190, v190, v254
v_sub_f32 v191, v191, v254
v_exp_f32 v189, v189
v_exp_f32 v191, v191
v_exp_f32 v190, v190
v_add_f32 v249, v188, v189
v_add_f32 v249, v249, v190
v_add_f32 v249, v249, v191
v_cvt_pk_bf16_f32 v137, v190, v191
v_cvt_pk_bf16_f32 v136, v188, v189
v_mfma_f32_16x16x32_bf16 v[188:191], a[0:3], v[216:219], 0
s_waitcnt lgkmcnt(0)
v_sub_f32 v192, v192, v254
v_sub_f32 v195, v195, v254
v_mfma_f32_16x16x32_bf16 v[188:191], a[4:7], v[220:223], v[188:191]
v_exp_f32 v192, v192
v_sub_f32 v193, v193, v254
v_sub_f32 v194, v194, v254
v_exp_f32 v195, v195
v_exp_f32 v193, v193
v_exp_f32 v194, v194
v_add_f32 v249, v249, v192
v_add_f32 v249, v249, v193
v_add_f32 v249, v249, v194
v_add_f32 v249, v249, v195
v_cvt_pk_bf16_f32 v139, v194, v195
v_cvt_pk_bf16_f32 v138, v192, v193
ds_read_b128 v[192:195], v236 offset:8960
v_sub_f32 v198, v198, v254
v_sub_f32 v197, v197, v254
v_sub_f32 v196, v196, v254
v_exp_f32 v196, v196
v_exp_f32 v198, v198
v_sub_f32 v202, v202, v254
v_sub_f32 v200, v200, v254
v_exp_f32 v197, v197
v_sub_f32 v201, v201, v254
v_sub_f32 v199, v199, v254
v_exp_f32 v199, v199
v_exp_f32 v200, v200
v_add_f32 v249, v249, v196
v_add_f32 v249, v249, v197
v_add_f32 v249, v249, v198
s_waitcnt lgkmcnt(0)
v_mfma_f32_16x16x32_bf16 v[188:191], a[8:11], v[192:195], v[188:191]
v_sub_f32 v203, v203, v254
v_add_f32 v249, v249, v199
v_add_f32 v249, v249, v200
v_exp_f32 v201, v201
v_exp_f32 v202, v202
v_exp_f32 v203, v203
v_sub_f32 v204, v204, v254
v_exp_f32 v204, v204
v_add_f32 v249, v249, v201
v_add_f32 v249, v249, v202
v_add_f32 v249, v249, v203
v_sub_f32 v205, v205, v254
v_sub_f32 v206, v206, v254
v_exp_f32 v205, v205
v_exp_f32 v206, v206
v_add_f32 v249, v249, v204
v_add_f32 v249, v249, v205
v_sub_f32 v207, v207, v254
v_exp_f32 v207, v207
v_add_f32 v249, v249, v206
v_add_f32 v249, v249, v207
v_cvt_pk_bf16_f32 v145, v206, v207
v_cvt_pk_bf16_f32 v144, v204, v205
ds_read_b128 v[204:207], v236 offset:9216
v_add_f32 v248, v248, v250
v_rcp_f32 v251, v248
v_sub_f32 v212, v212, v254
v_fmac_f32 v152, v184, v251
v_fmac_f32 v153, v185, v251
v_fmac_f32 v155, v187, v251
v_fmac_f32 v154, v186, v251
v_fmac_f32 v157, v209, v251
v_fmac_f32 v159, v211, v251
v_fmac_f32 v158, v210, v251
v_fmac_f32 v156, v208, v251
v_exp_f32 v212, v212
v_sub_f32 v213, v213, v254
v_exp_f32 v213, v213
v_sub_f32 v214, v214, v254
v_exp_f32 v214, v214
s_waitcnt lgkmcnt(0)
v_mfma_f32_16x16x32_bf16 v[188:191], a[12:15], v[204:207], v[188:191]
v_sub_f32 v215, v215, v254
v_add_f32 v249, v249, v212
v_mfma_f32_16x16x32_bf16 v[184:187], a[28:31], v[204:207], 0
v_exp_f32 v215, v215
v_mfma_f32_16x16x32_bf16 v[184:187], a[24:27], v[192:195], v[184:187]
v_add_f32 v249, v249, v213
v_add_f32 v249, v249, v214
v_mfma_f32_16x16x32_bf16 v[184:187], a[20:23], v[220:223], v[184:187]
v_add_f32 v249, v249, v215
v_cvt_pk_bf16_f32 v147, v214, v215
v_mfma_f32_16x16x32_bf16 v[184:187], a[16:19], v[216:219], v[184:187]
v_cvt_pk_bf16_f32 v146, v212, v213
v_fmac_f32 v163, v231, v251
v_mfma_f32_16x16x32_bf16 v[208:211], a[32:35], v[216:219], 0
v_fmac_f32 v161, v229, v251
v_cvt_pk_bf16_f32 v152, v152, v153
v_mfma_f32_16x16x32_bf16 v[208:211], a[36:39], v[220:223], v[208:211]
v_fmac_f32 v167, v235, v251
v_fmac_f32 v160, v228, v251
v_mfma_f32_16x16x32_bf16 v[208:211], a[40:43], v[192:195], v[208:211]
v_fmac_f32 v164, v232, v251
v_cvt_pk_bf16_f32 v160, v160, v161
v_mfma_f32_16x16x32_bf16 v[208:211], a[44:47], v[204:207], v[208:211]
v_cvt_pk_bf16_f32 v153, v154, v155
v_cvt_pk_bf16_f32 v154, v156, v157
v_mfma_f32_16x16x32_bf16 v[212:215], a[60:63], v[204:207], 0
v_fmac_f32 v166, v234, v251
v_fmac_f32 v162, v230, v251
v_mfma_f32_16x16x32_bf16 v[212:215], a[56:59], v[192:195], v[212:215]
v_fmac_f32 v165, v233, v251
v_cvt_pk_bf16_f32 v155, v158, v159
v_mfma_f32_16x16x32_bf16 v[212:215], a[52:55], v[220:223], v[212:215]
v_cvt_pk_bf16_f32 v161, v162, v163
v_cvt_pk_bf16_f32 v162, v164, v165
v_mfma_f32_16x16x32_bf16 v[212:215], a[48:51], v[216:219], v[212:215]
v_cvt_pk_bf16_f32 v163, v166, v167
v_pk_max_i16 v162, v162, 0
v_pk_max_i16 v161, v161, 0
v_pk_max_i16 v163, v163, 0
v_pk_max_i16 v153, v153, 0
v_pk_max_i16 v155, v155, 0
v_pk_max_i16 v152, v152, 0
v_pk_max_i16 v160, v160, 0
v_pk_max_i16 v154, v154, 0
buffer_store_dwordx4 v[152:155], v239, s[20:23], s52 offen offset:0 nt
buffer_store_dwordx4 v[160:163], v239, s[20:23], s52 offen offset:64 nt
v_cvt_pk_bf16_f32 v112, v188, v189
v_cvt_pk_bf16_f32 v113, v190, v191
v_cvt_pk_bf16_f32 v114, v184, v185
v_cvt_pk_bf16_f32 v115, v186, v187
v_cvt_pk_bf16_f32 v118, v212, v213
v_cvt_pk_bf16_f32 v119, v214, v215
v_cvt_pk_bf16_f32 v116, v208, v209
v_cvt_pk_bf16_f32 v117, v210, v211
v_mfma_f32_16x16x32_bf16 v[152:155], a[192:195], v[216:219], 0
v_sub_f32 v224, v224, v254
v_cvt_pk_bf16_f32 v142, v200, v201
v_mfma_f32_16x16x32_bf16 v[152:155], a[196:199], v[220:223], v[152:155]
v_exp_f32 v224, v224
v_mfma_f32_16x16x32_bf16 v[152:155], a[200:203], v[192:195], v[152:155]
v_cvt_pk_bf16_f32 v141, v198, v199
v_cvt_pk_bf16_f32 v140, v196, v197
v_mfma_f32_16x16x32_bf16 v[152:155], a[204:207], v[204:207], v[152:155]
v_add_f32 v249, v249, v224
v_cvt_pk_bf16_f32 v143, v202, v203
v_mfma_f32_16x16x32_bf16 v[156:159], a[220:223], v[204:207], 0
ds_swizzle_b32 v250, v249 offset:0x401F
v_cvt_pk_bf16_f32 v148, v224, 0
v_mfma_f32_16x16x32_bf16 v[156:159], a[216:219], v[192:195], v[156:159]
v_mfma_f32_16x16x32_bf16 v[156:159], a[212:215], v[220:223], v[156:159]
v_mfma_f32_16x16x32_bf16 v[156:159], a[208:211], v[216:219], v[156:159]
v_mfma_f32_16x16x32_bf16 v[160:163], a[224:227], v[216:219], 0
v_mfma_f32_16x16x32_bf16 v[160:163], a[228:231], v[220:223], v[160:163]
v_mfma_f32_16x16x32_bf16 v[160:163], a[232:235], v[192:195], v[160:163]
s_waitcnt lgkmcnt(0)
v_add_f32 v249, v249, v250
v_mfma_f32_16x16x32_bf16 v[160:163], a[236:239], v[204:207], v[160:163]
ds_bpermute_b32 v250, v247, v249
v_mfma_f32_16x16x32_bf16 v[164:167], a[252:255], v[204:207], 0
v_mfma_f32_16x16x32_bf16 v[164:167], a[248:251], v[192:195], v[164:167]
v_mfma_f32_16x16x32_bf16 v[164:167], a[244:247], v[220:223], v[164:167]
v_mfma_f32_16x16x32_bf16 v[164:167], a[240:243], v[216:219], v[164:167]
v_mfma_f32_16x16x32_bf16 v[184:187], v[0:3], v[112:115], 0
v_mfma_f32_16x16x32_bf16 v[184:187], v[4:7], v[116:119], v[184:187]
s_waitcnt lgkmcnt(0)
v_add_f32 v249, v249, v250
s_nop 0
v_mfma_f32_16x16x32_bf16 v[188:191], v[12:15], v[116:119], 0
v_rcp_f32 v252, v249
v_mfma_f32_16x16x32_bf16 v[188:191], v[8:11], v[112:115], v[188:191]
s_nop 1
v_max3_f32 v254, v184, v185, v186
v_mfma_f32_16x16x32_bf16 v[192:195], v[16:19], v[112:115], 0
s_nop 2
v_mfma_f32_16x16x32_bf16 v[192:195], v[20:23], v[116:119], v[192:195]
v_max3_f32 v254, v254, v187, v188
v_max3_f32 v254, v254, v189, v190
v_mfma_f32_16x16x32_bf16 v[196:199], v[28:31], v[116:119], 0
s_nop 2
v_mfma_f32_16x16x32_bf16 v[196:199], v[24:27], v[112:115], v[196:199]
s_nop 0
v_max3_f32 v254, v254, v191, v192
v_max3_f32 v254, v254, v193, v194
v_mfma_f32_16x16x32_bf16 v[200:203], v[32:35], v[112:115], 0
s_nop 2
v_mfma_f32_16x16x32_bf16 v[200:203], v[36:39], v[116:119], v[200:203]
v_max3_f32 v254, v254, v195, v196
v_max3_f32 v254, v254, v197, v198
v_mfma_f32_16x16x32_bf16 v[204:207], v[44:47], v[116:119], 0
s_nop 2
v_mfma_f32_16x16x32_bf16 v[204:207], v[40:43], v[112:115], v[204:207]
s_nop 0
v_max3_f32 v254, v254, v199, v200
v_max3_f32 v254, v254, v201, v202
v_mfma_f32_16x16x32_bf16 v[208:211], v[48:51], v[112:115], 0
s_nop 2
v_mfma_f32_16x16x32_bf16 v[208:211], v[52:55], v[116:119], v[208:211]
v_max3_f32 v254, v254, v203, v204
v_max3_f32 v254, v254, v205, v206
v_mfma_f32_16x16x32_bf16 v[212:215], v[56:59], v[136:139], 0
s_nop 2
v_mfma_f32_16x16x32_bf16 v[212:215], v[104:107], v[148:151], v[212:215]
s_nop 0
v_max3_f32 v254, v254, v207, v208
v_mfma_f32_16x16x32_bf16 v[212:215], v[72:75], v[140:143], v[212:215]
ds_swizzle_b32 v255, v254 offset:0x401F
v_mfma_f32_16x16x32_bf16 v[212:215], v[88:91], v[144:147], v[212:215]
s_nop 2
v_mfma_f32_16x16x32_bf16 v[216:219], v[92:95], v[144:147], 0
s_nop 2
v_mfma_f32_16x16x32_bf16 v[216:219], v[76:79], v[140:143], v[216:219]
v_fmac_f32 v169, v213, v252
v_fmac_f32 v168, v212, v252
v_mfma_f32_16x16x32_bf16 v[216:219], v[106:109], v[148:151], v[216:219]
v_fmac_f32 v171, v215, v252
v_fmac_f32 v170, v214, v252
v_mfma_f32_16x16x32_bf16 v[216:219], v[60:63], v[136:139], v[216:219]
ds_read_b128 v[220:223], v236 offset:12672
ds_read_b128 v[224:227], v236 offset:12928
v_mfma_f32_16x16x32_bf16 v[228:231], v[64:67], v[136:139], 0
s_waitcnt lgkmcnt(2)
ds_read_b128 v[212:215], v236 offset:13184
v_cvt_pk_bf16_f32 v168, v168, v169
v_mfma_f32_16x16x32_bf16 v[228:231], v[108:111], v[148:151], v[228:231]
s_nop 0
v_fmac_f32 v172, v216, v252
v_fmac_f32 v174, v218, v252
v_mfma_f32_16x16x32_bf16 v[228:231], v[80:83], v[140:143], v[228:231]
v_fmac_f32 v173, v217, v252
v_fmac_f32 v175, v219, v252
v_mfma_f32_16x16x32_bf16 v[228:231], v[96:99], v[144:147], v[228:231]
ds_read_b128 v[216:219], v236 offset:13440
v_cvt_pk_bf16_f32 v169, v170, v171
v_mfma_f32_16x16x32_bf16 v[232:235], v[100:103], v[144:147], 0
v_cvt_pk_bf16_f32 v170, v172, v173
v_cvt_pk_bf16_f32 v171, v174, v175
v_mfma_f32_16x16x32_bf16 v[232:235], v[84:87], v[140:143], v[232:235]
s_waitcnt lgkmcnt(2)
v_pk_max_i16 v170, v170, 0
v_fmac_f32 v178, v230, v252
v_mfma_f32_16x16x32_bf16 v[232:235], v[110:113], v[148:151], v[232:235]
s_waitcnt lgkmcnt(1)
v_fmac_f32 v179, v231, v252
v_fmac_f32 v176, v228, v252
v_mfma_f32_16x16x32_bf16 v[232:235], v[68:71], v[136:139], v[232:235]
v_fmac_f32 v177, v229, v252
v_cvt_pk_bf16_f32 v176, v176, v177
v_mfma_f32_16x16x32_bf16 v[228:231], a[0:3], v[220:223], 0
v_cvt_pk_bf16_f32 v177, v178, v179
v_pk_max_i16 v169, v169, 0
v_mfma_f32_16x16x32_bf16 v[228:231], a[4:7], v[224:227], v[228:231]
s_waitcnt lgkmcnt(0)
v_pk_max_i16 v171, v171, 0
v_fmac_f32 v182, v234, v252
v_mfma_f32_16x16x32_bf16 v[228:231], a[8:11], v[212:215], v[228:231]
v_fmac_f32 v181, v233, v252
v_fmac_f32 v183, v235, v252
v_mfma_f32_16x16x32_bf16 v[228:231], a[12:15], v[216:219], v[228:231]
v_fmac_f32 v180, v232, v252
v_cvt_pk_bf16_f32 v179, v182, v183
v_mfma_f32_16x16x32_bf16 v[232:235], a[28:31], v[216:219], 0
v_cvt_pk_bf16_f32 v178, v180, v181
v_pk_max_i16 v178, v178, 0
v_mfma_f32_16x16x32_bf16 v[232:235], a[24:27], v[212:215], v[232:235]
v_pk_max_i16 v179, v179, 0
v_pk_max_i16 v176, v176, 0
v_mfma_f32_16x16x32_bf16 v[232:235], a[20:23], v[224:227], v[232:235]
v_cvt_pk_bf16_f32 v113, v230, v231
v_cvt_pk_bf16_f32 v112, v228, v229
v_mfma_f32_16x16x32_bf16 v[232:235], a[16:19], v[220:223], v[232:235]
v_pk_max_i16 v168, v168, 0
v_pk_max_i16 v177, v177, 0
v_mfma_f32_16x16x32_bf16 v[228:231], a[32:35], v[220:223], 0
buffer_store_dwordx4 v[168:171], v239, s[20:23], s53 offen offset:0 nt
buffer_store_dwordx4 v[176:179], v239, s[20:23], s53 offen offset:64 nt
v_add_u32 v236, s56, v236
v_max_f32 v254, v254, v255
s_sub_u32 s56, 0, s56
v_cvt_pk_bf16_f32 v115, v234, v235
v_cvt_pk_bf16_f32 v114, v232, v233
v_mfma_f32_16x16x32_bf16 v[228:231], a[36:39], v[224:227], v[228:231]
ds_bpermute_b32 v255, v247, v254
v_mfma_f32_16x16x32_bf16 v[228:231], a[40:43], v[212:215], v[228:231]
v_mfma_f32_16x16x32_bf16 v[228:231], a[44:47], v[216:219], v[228:231]
s_nop 2
v_mfma_f32_16x16x32_bf16 v[232:235], a[60:63], v[216:219], 0
s_nop 2
v_mfma_f32_16x16x32_bf16 v[232:235], a[56:59], v[212:215], v[232:235]
v_cvt_pk_bf16_f32 v116, v228, v229
v_cvt_pk_bf16_f32 v117, v230, v231
v_mfma_f32_16x16x32_bf16 v[232:235], a[52:55], v[224:227], v[232:235]
v_mfma_f32_16x16x32_bf16 v[232:235], a[48:51], v[220:223], v[232:235]
s_waitcnt lgkmcnt(0)
v_max_f32 v254, v254, v255
v_sub_f32 v184, v184, v254
v_mfma_f32_16x16x32_bf16 v[168:171], a[192:195], v[220:223], 0
v_exp_f32 v184, v184
v_mfma_f32_16x16x32_bf16 v[168:171], a[196:199], v[224:227], v[168:171]
v_sub_f32 v185, v185, v254
v_sub_f32 v186, v186, v254
v_mfma_f32_16x16x32_bf16 v[168:171], a[200:203], v[212:215], v[168:171]
v_cvt_pk_bf16_f32 v119, v234, v235
v_cvt_pk_bf16_f32 v118, v232, v233
v_mfma_f32_16x16x32_bf16 v[168:171], a[204:207], v[216:219], v[168:171]
v_exp_f32 v186, v186
v_mfma_f32_16x16x32_bf16 v[172:175], a[220:223], v[216:219], 0
v_exp_f32 v185, v185
v_mfma_f32_16x16x32_bf16 v[172:175], a[216:219], v[212:215], v[172:175]
v_sub_f32 v189, v189, v254
v_sub_f32 v187, v187, v254
v_mfma_f32_16x16x32_bf16 v[172:175], a[212:215], v[224:227], v[172:175]
v_sub_f32 v188, v188, v254
v_sub_f32 v190, v190, v254
v_mfma_f32_16x16x32_bf16 v[172:175], a[208:211], v[220:223], v[172:175]
s_cmp_lg_u32 s45, 0
s_cbranch_scc1 L_loops
v_mfma_f32_16x16x32_bf16 v[176:179], a[224:227], v[220:223], 0
s_waitcnt vmcnt(8)
s_barrier
v_mfma_f32_16x16x32_bf16 v[176:179], a[228:231], v[224:227], v[176:179]
s_add_u32 s52, s47, 8192
ds_read_b128 v[232:235], v236 offset:0
v_add_f32 v248, v184, v185
v_mfma_f32_16x16x32_bf16 v[176:179], a[232:235], v[212:215], v[176:179]
s_add_u32 s53, s47, 12288
v_exp_f32 v188, v188
v_mfma_f32_16x16x32_bf16 v[176:179], a[236:239], v[216:219], v[176:179]
v_add_f32 v248, v248, v186
v_sub_f32 v191, v191, v254
v_mfma_f32_16x16x32_bf16 v[180:183], a[252:255], v[216:219], 0
v_exp_f32 v187, v187
v_mfma_f32_16x16x32_bf16 v[180:183], a[248:251], v[212:215], v[180:183]
v_exp_f32 v190, v190
v_mfma_f32_16x16x32_bf16 v[180:183], a[244:247], v[224:227], v[180:183]
v_add_f32 v248, v248, v187
v_add_f32 v248, v248, v188
v_mfma_f32_16x16x32_bf16 v[180:183], a[240:243], v[220:223], v[180:183]
s_waitcnt lgkmcnt(0)
v_exp_f32 v189, v189
v_mfma_f32_16x16x32_bf16 v[228:231], v[0:3], v[112:115], 0
v_add_f32 v248, v248, v189
v_add_f32 v248, v248, v190
v_mfma_f32_16x16x32_bf16 v[228:231], v[4:7], v[116:119], v[228:231]
v_exp_f32 v191, v191
v_cvt_pk_bf16_f32 v122, v188, v189
v_add_f32 v248, v248, v191
v_cvt_pk_bf16_f32 v123, v190, v191
v_mfma_f32_16x16x32_bf16 v[188:191], v[12:15], v[116:119], 0
v_sub_f32 v193, v193, v254
v_sub_f32 v194, v194, v254
v_mfma_f32_16x16x32_bf16 v[188:191], v[8:11], v[112:115], v[188:191]
v_sub_f32 v195, v195, v254
v_exp_f32 v194, v194
v_sub_f32 v192, v192, v254
v_exp_f32 v192, v192
v_sub_f32 v196, v196, v254
v_exp_f32 v193, v193
v_sub_f32 v197, v197, v254
v_sub_f32 v199, v199, v254
v_sub_f32 v198, v198, v254
v_exp_f32 v195, v195
v_add_f32 v248, v248, v192
v_add_f32 v248, v248, v193
v_exp_f32 v196, v196
v_exp_f32 v197, v197
v_add_f32 v248, v248, v194
v_add_f32 v248, v248, v195
v_add_f32 v248, v248, v196
v_add_f32 v248, v248, v197
v_exp_f32 v198, v198
v_sub_f32 v200, v200, v254
v_sub_f32 v203, v203, v254
v_exp_f32 v199, v199
v_sub_f32 v201, v201, v254
v_exp_f32 v201, v201
v_sub_f32 v202, v202, v254
v_exp_f32 v202, v202
v_add_f32 v248, v248, v198
v_exp_f32 v200, v200
v_add_f32 v248, v248, v199
v_add_f32 v248, v248, v200
v_add_f32 v248, v248, v201
v_exp_f32 v203, v203
v_add_f32 v248, v248, v202
v_add_f32 v248, v248, v203
v_cvt_pk_bf16_f32 v128, v200, v201
v_cvt_pk_bf16_f32 v129, v202, v203
v_mfma_f32_16x16x32_bf16 v[200:203], v[16:19], v[112:115], 0
v_sub_f32 v204, v204, v254
v_sub_f32 v205, v205, v254
v_mfma_f32_16x16x32_bf16 v[200:203], v[20:23], v[116:119], v[200:203]
v_exp_f32 v204, v204
v_sub_f32 v206, v206, v254
v_add_f32 v248, v248, v204
v_exp_f32 v206, v206
v_sub_f32 v207, v207, v254
v_exp_f32 v205, v205
v_exp_f32 v207, v207
v_add_f32 v248, v248, v205
v_add_f32 v248, v248, v206
v_add_f32 v248, v248, v207
v_cvt_pk_bf16_f32 v130, v204, v205
v_cvt_pk_bf16_f32 v131, v206, v207
v_mfma_f32_16x16x32_bf16 v[204:207], v[28:31], v[116:119], 0
v_sub_f32 v208, v208, v254
v_cvt_pk_bf16_f32 v120, v184, v185
v_mfma_f32_16x16x32_bf16 v[204:207], v[24:27], v[112:115], v[204:207]
v_exp_f32 v208, v208
s_nop 0
v_add_f32 v248, v248, v208
v_cvt_pk_bf16_f32 v132, v208, 0
v_mfma_f32_16x16x32_bf16 v[208:211], v[32:35], v[112:115], 0
ds_swizzle_b32 v250, v248 offset:0x401F
v_cvt_pk_bf16_f32 v121, v186, v187
v_mfma_f32_16x16x32_bf16 v[208:211], v[36:39], v[116:119], v[208:211]
ds_read_b128 v[184:187], v236 offset:256
v_cvt_pk_bf16_f32 v126, v196, v197
v_mfma_f32_16x16x32_bf16 v[212:215], v[44:47], v[116:119], 0
v_cvt_pk_bf16_f32 v125, v194, v195
v_cvt_pk_bf16_f32 v127, v198, v199
v_mfma_f32_16x16x32_bf16 v[212:215], v[40:43], v[112:115], v[212:215]
ds_read_b128 v[196:199], v236 offset:768
v_cvt_pk_bf16_f32 v124, v192, v193
v_mfma_f32_16x16x32_bf16 v[216:219], v[48:51], v[112:115], 0
ds_read_b128 v[192:195], v236 offset:512
v_max3_f32 v254, v228, v229, v230
v_mfma_f32_16x16x32_bf16 v[216:219], v[52:55], v[116:119], v[216:219]
v_max3_f32 v254, v254, v231, v188
v_max3_f32 v254, v254, v189, v190
v_mfma_f32_16x16x32_bf16 v[220:223], v[56:59], v[120:123], 0
s_waitcnt lgkmcnt(3)
v_add_f32 v248, v248, v250
v_max3_f32 v254, v254, v191, v200
v_mfma_f32_16x16x32_bf16 v[220:223], v[104:107], v[132:135], v[220:223]
s_waitcnt lgkmcnt(2)
ds_bpermute_b32 v250, v247, v248
v_mfma_f32_16x16x32_bf16 v[220:223], v[72:75], v[124:127], v[220:223]
v_max3_f32 v254, v254, v201, v202
v_max3_f32 v254, v254, v203, v204
v_mfma_f32_16x16x32_bf16 v[220:223], v[88:91], v[128:131], v[220:223]
s_waitcnt lgkmcnt(2)
v_max3_f32 v254, v254, v205, v206
v_max3_f32 v254, v254, v207, v208
v_mfma_f32_16x16x32_bf16 v[224:227], v[92:95], v[128:131], 0
s_waitcnt lgkmcnt(1)
v_max3_f32 v254, v254, v209, v210
v_max3_f32 v254, v254, v211, v212
v_mfma_f32_16x16x32_bf16 v[224:227], v[76:79], v[124:127], v[224:227]
v_max3_f32 v254, v254, v213, v214
v_max3_f32 v254, v254, v215, v216
v_mfma_f32_16x16x32_bf16 v[224:227], v[106:109], v[132:135], v[224:227]
ds_swizzle_b32 v255, v254 offset:0x401F
v_mbcnt_lo_u32_b32 v242, -1, 0
v_mfma_f32_16x16x32_bf16 v[224:227], v[60:63], v[120:123], v[224:227]
s_waitcnt lgkmcnt(1)
v_add_f32 v248, v248, v250
v_rcp_f32 v251, v248
s_nop 0
v_fmac_f32 v152, v220, v251
v_fmac_f32 v153, v221, v251
v_fmac_f32 v154, v222, v251
v_fmac_f32 v155, v223, v251
v_mfma_f32_16x16x32_bf16 v[220:223], v[64:67], v[120:123], 0
v_fmac_f32 v156, v224, v251
v_fmac_f32 v157, v225, v251
v_mfma_f32_16x16x32_bf16 v[220:223], v[108:111], v[132:135], v[220:223]
v_fmac_f32 v158, v226, v251
v_fmac_f32 v159, v227, v251
v_mfma_f32_16x16x32_bf16 v[220:223], v[80:83], v[124:127], v[220:223]
s_waitcnt lgkmcnt(0)
v_cvt_pk_bf16_f32 v152, v152, v153
v_cvt_pk_bf16_f32 v153, v154, v155
v_mfma_f32_16x16x32_bf16 v[220:223], v[96:99], v[128:131], v[220:223]
v_cvt_pk_bf16_f32 v154, v156, v157
v_cvt_pk_bf16_f32 v155, v158, v159
v_mfma_f32_16x16x32_bf16 v[224:227], v[100:103], v[128:131], 0
v_pk_max_i16 v152, v152, 0
v_pk_max_i16 v153, v153, 0
v_mfma_f32_16x16x32_bf16 v[224:227], v[84:87], v[124:127], v[224:227]
v_max_f32 v254, v254, v255
v_pk_max_i16 v154, v154, 0
v_mfma_f32_16x16x32_bf16 v[224:227], v[110:113], v[132:135], v[224:227]
ds_bpermute_b32 v255, v247, v254
v_mfma_f32_16x16x32_bf16 v[224:227], v[68:71], v[120:123], v[224:227]
v_fmac_f32 v160, v220, v251
v_fmac_f32 v161, v221, v251
v_mfma_f32_16x16x32_bf16 v[0:3], a[192:195], v[232:235], 0
v_fmac_f32 v162, v222, v251
v_fmac_f32 v163, v223, v251
v_mfma_f32_16x16x32_bf16 v[0:3], a[196:199], v[184:187], v[0:3]
v_cvt_pk_bf16_f32 v160, v160, v161
v_cvt_pk_bf16_f32 v161, v162, v163
v_mfma_f32_16x16x32_bf16 v[0:3], a[200:203], v[192:195], v[0:3]
v_fmac_f32 v164, v224, v251
v_fmac_f32 v165, v225, v251
v_mfma_f32_16x16x32_bf16 v[0:3], a[204:207], v[196:199], v[0:3]
v_fmac_f32 v166, v226, v251
v_fmac_f32 v167, v227, v251
v_mfma_f32_16x16x32_bf16 v[4:7], a[220:223], v[196:199], 0
s_waitcnt lgkmcnt(0)
v_max_f32 v254, v254, v255
v_sub_f32 v228, v228, v254
v_mfma_f32_16x16x32_bf16 v[4:7], a[216:219], v[192:195], v[4:7]
v_sub_f32 v229, v229, v254
v_sub_f32 v230, v230, v254
v_mfma_f32_16x16x32_bf16 v[4:7], a[212:215], v[184:187], v[4:7]
v_exp_f32 v228, v228
v_mfma_f32_16x16x32_bf16 v[4:7], a[208:211], v[232:235], v[4:7]
ds_read_b128 v[220:223], v236 offset:4224
v_sub_f32 v231, v231, v254
v_mfma_f32_16x16x32_bf16 v[8:11], a[224:227], v[232:235], 0
v_exp_f32 v229, v229
v_mfma_f32_16x16x32_bf16 v[8:11], a[228:231], v[184:187], v[8:11]
v_exp_f32 v230, v230
v_mfma_f32_16x16x32_bf16 v[8:11], a[232:235], v[192:195], v[8:11]
v_exp_f32 v231, v231
v_mfma_f32_16x16x32_bf16 v[8:11], a[236:239], v[196:199], v[8:11]
v_add_f32 v249, v228, v229
v_add_f32 v249, v249, v230
v_mfma_f32_16x16x32_bf16 v[12:15], a[252:255], v[196:199], 0
ds_read_b128 v[196:199], v236 offset:4736
v_add_f32 v249, v249, v231
v_mfma_f32_16x16x32_bf16 v[12:15], a[248:251], v[192:195], v[12:15]
s_waitcnt lgkmcnt(1)
ds_read_b128 v[192:195], v236 offset:4992
v_cvt_pk_bf16_f32 v136, v228, v229
v_mfma_f32_16x16x32_bf16 v[12:15], a[244:247], v[184:187], v[12:15]
v_cvt_pk_bf16_f32 v137, v230, v231
v_sub_f32 v188, v188, v254
v_mfma_f32_16x16x32_bf16 v[12:15], a[240:243], v[232:235], v[12:15]
ds_read_b128 v[228:231], v236 offset:4480
v_sub_f32 v189, v189, v254
v_mfma_f32_16x16x32_bf16 v[16:19], a[192:195], v[220:223], 0
v_exp_f32 v188, v188
v_exp_f32 v189, v189
v_sub_f32 v190, v190, v254
v_cvt_pk_bf16_f32 v138, v188, v189
v_sub_f32 v191, v191, v254
v_exp_f32 v190, v190
v_exp_f32 v191, v191
v_sub_f32 v216, v216, v254
v_cvt_pk_bf16_f32 v139, v190, v191
v_exp_f32 v216, v216
v_sub_f32 v200, v200, v254
v_cvt_pk_bf16_f32 v148, v216, 0
s_waitcnt lgkmcnt(0)
v_mfma_f32_16x16x32_bf16 v[16:19], a[196:199], v[228:231], v[16:19]
v_sub_f32 v201, v201, v254
v_sub_f32 v202, v202, v254
v_mfma_f32_16x16x32_bf16 v[16:19], a[200:203], v[196:199], v[16:19]
v_exp_f32 v200, v200
v_mfma_f32_16x16x32_bf16 v[16:19], a[204:207], v[192:195], v[16:19]
v_exp_f32 v201, v201
v_mfma_f32_16x16x32_bf16 v[20:23], a[220:223], v[192:195], 0
v_exp_f32 v202, v202
v_mfma_f32_16x16x32_bf16 v[20:23], a[216:219], v[196:199], v[20:23]
v_sub_f32 v203, v203, v254
v_sub_f32 v204, v204, v254
v_mfma_f32_16x16x32_bf16 v[20:23], a[212:215], v[228:231], v[20:23]
v_exp_f32 v203, v203
v_mfma_f32_16x16x32_bf16 v[20:23], a[208:211], v[220:223], v[20:23]
v_exp_f32 v204, v204
v_mfma_f32_16x16x32_bf16 v[24:27], a[224:227], v[220:223], 0
v_sub_f32 v205, v205, v254
v_sub_f32 v206, v206, v254
v_mfma_f32_16x16x32_bf16 v[24:27], a[228:231], v[228:231], v[24:27]
v_exp_f32 v205, v205
v_mfma_f32_16x16x32_bf16 v[24:27], a[232:235], v[196:199], v[24:27]
v_exp_f32 v206, v206
v_mfma_f32_16x16x32_bf16 v[24:27], a[236:239], v[192:195], v[24:27]
v_sub_f32 v207, v207, v254
v_cvt_pk_bf16_f32 v140, v200, v201
v_mfma_f32_16x16x32_bf16 v[28:31], a[252:255], v[192:195], 0
v_exp_f32 v207, v207
v_mfma_f32_16x16x32_bf16 v[28:31], a[248:251], v[196:199], v[28:31]
v_cvt_pk_bf16_f32 v141, v202, v203
v_cvt_pk_bf16_f32 v142, v204, v205
v_mfma_f32_16x16x32_bf16 v[28:31], a[244:247], v[228:231], v[28:31]
v_cvt_pk_bf16_f32 v143, v206, v207
v_sub_f32 v208, v208, v254
v_mfma_f32_16x16x32_bf16 v[28:31], a[240:243], v[220:223], v[28:31]
v_sub_f32 v209, v209, v254
v_sub_f32 v210, v210, v254
v_mfma_f32_16x16x32_bf16 v[228:231], v[56:59], v[136:139], 0
v_exp_f32 v208, v208
v_mfma_f32_16x16x32_bf16 v[228:231], v[104:107], v[148:151], v[228:231]
v_exp_f32 v209, v209
v_mfma_f32_16x16x32_bf16 v[228:231], v[72:75], v[140:143], v[228:231]
v_exp_f32 v210, v210
v_sub_f32 v211, v211, v254
v_exp_f32 v211, v211
v_sub_f32 v212, v212, v254
v_exp_f32 v212, v212
v_sub_f32 v213, v213, v254
v_exp_f32 v213, v213
v_sub_f32 v214, v214, v254
v_exp_f32 v214, v214
v_sub_f32 v215, v215, v254
v_exp_f32 v215, v215
v_cvt_pk_bf16_f32 v144, v208, v209
v_cvt_pk_bf16_f32 v145, v210, v211
v_cvt_pk_bf16_f32 v146, v212, v213
v_cvt_pk_bf16_f32 v147, v214, v215
v_cvt_pk_bf16_f32 v162, v164, v165
v_cvt_pk_bf16_f32 v163, v166, v167
v_mfma_f32_16x16x32_bf16 v[228:231], v[88:91], v[144:147], v[228:231]
v_pk_max_i16 v155, v155, 0
v_pk_max_i16 v160, v160, 0
v_mfma_f32_16x16x32_bf16 v[192:195], v[92:95], v[144:147], 0
v_pk_max_i16 v161, v161, 0
v_pk_max_i16 v162, v162, 0
v_mfma_f32_16x16x32_bf16 v[192:195], v[76:79], v[140:143], v[192:195]
v_pk_max_i16 v163, v163, 0
v_mbcnt_hi_u32_b32 v242, -1, v242
v_mfma_f32_16x16x32_bf16 v[192:195], v[106:109], v[148:151], v[192:195]
buffer_store_dwordx4 v[152:155], v239, s[20:23], s52 offen offset:0 nt
buffer_store_dwordx4 v[160:163], v239, s[20:23], s52 offen offset:64 nt
s_mul_i32 s54, s41, 12288
s_add_u32 s54, s54, 105472
v_mov_b32 v244, s54
v_bfe_u32 v243, v242, 0, 4
v_lshl_add_u32 v244, v243, 7, v244
v_lshlrev_b32 v243, 4, v242
v_xor_b32 v243, v243, v242
v_and_b32 v243, 48, v243
v_mfma_f32_16x16x32_bf16 v[192:195], v[60:63], v[136:139], v[192:195]
v_add_u32 v244, v243, v244
v_add_u32 v244, v243, v244
v_mfma_f32_16x16x32_bf16 v[220:223], v[64:67], v[136:139], 0
ds_read_b128 v[184:187], v244 offset:0
ds_read_b128 v[232:235], v244 offset:16
v_mfma_f32_16x16x32_bf16 v[220:223], v[108:111], v[148:151], v[220:223]
ds_read_b128 v[196:199], v244 offset:2048
v_add_f32 v249, v249, v188
v_mfma_f32_16x16x32_bf16 v[220:223], v[80:83], v[140:143], v[220:223]
ds_read_b32 v188, v244 offset:4096
v_add_f32 v249, v249, v189
v_mfma_f32_16x16x32_bf16 v[220:223], v[96:99], v[144:147], v[220:223]
v_add_f32 v249, v249, v190
v_add_f32 v249, v249, v191
v_mfma_f32_16x16x32_bf16 v[224:227], v[100:103], v[144:147], 0
v_mov_b32 v245, 24576
v_bfe_u32 v243, v242, 0, 2
v_mfma_f32_16x16x32_bf16 v[224:227], v[84:87], v[140:143], v[224:227]
v_lshl_add_u32 v245, v243, 8, v245
v_bfe_u32 v243, v242, 2, 2
v_mfma_f32_16x16x32_bf16 v[224:227], v[110:113], v[148:151], v[224:227]
s_waitcnt lgkmcnt(2)
v_lshlrev_b32 v190, 16, v184
v_lshlrev_b32 v191, 16, v185
v_mfma_f32_16x16x32_bf16 v[224:227], v[68:71], v[136:139], v[224:227]
s_waitcnt lgkmcnt(1)
s_waitcnt lgkmcnt(0)
ds_swizzle_b32 v189, v188 offset:0x401F
v_and_b32 v184, 0xffff0000, v184
v_and_b32 v185, 0xffff0000, v185
v_mul_u32_u24 v243, 13107200, v243
v_add_u32 v245, v243, v245
s_lshl_b32 s48, s43, 7
s_add_u32 s48, s48, s44
s_add_u32 s48, s48, 0
v_bfe_u32 v243, v242, 4, 2
v_lshl_add_u32 v245, v243, 4, v245
v_add_f32 v249, v249, v200
v_add_f32 v249, v249, v201
v_add_f32 v249, v249, v202
v_add_f32 v249, v249, v203
ds_read_b128 v[200:203], v244 offset:2064
v_add_f32 v249, v249, v204
ds_read_b32 v204, v244 offset:6144
v_add_f32 v249, v249, v205
v_add_f32 v249, v249, v206
v_add_f32 v249, v249, v207
v_add_f32 v249, v249, v208
v_add_f32 v249, v249, v209
v_add_f32 v249, v249, v210
v_add_f32 v249, v249, v211
v_add_f32 v249, v249, v212
v_add_f32 v249, v249, v213
v_add_f32 v249, v249, v214
v_add_f32 v249, v249, v215
v_add_f32 v249, v249, v216
ds_swizzle_b32 v250, v249 offset:0x401F
v_lshlrev_b32 v206, 16, v196
v_lshlrev_b32 v207, 16, v197
v_and_b32 v196, 0xffff0000, v196
v_and_b32 v197, 0xffff0000, v197
s_waitcnt lgkmcnt(1)
ds_swizzle_b32 v205, v204 offset:0x401F
v_add_f32 v188, v188, v189
ds_bpermute_b32 v189, v247, v188
s_lshl_b32 s51, s43, 7
s_add_u32 s51, s51, s44
s_add_u32 s51, s51, 52428800
s_waitcnt lgkmcnt(2)
v_add_f32 v249, v249, v250
ds_bpermute_b32 v250, v247, v249
s_waitcnt lgkmcnt(2)
v_add_f32 v204, v204, v205
ds_bpermute_b32 v205, v247, v204
s_waitcnt lgkmcnt(2)
v_add_f32 v188, v188, v189
v_rcp_f32 v189, v188
s_nop 0
v_fmac_f32 v0, v190, v189
v_fmac_f32 v2, v191, v189
v_lshlrev_b32 v190, 16, v186
v_lshlrev_b32 v191, 16, v187
v_fmac_f32 v4, v190, v189
v_fmac_f32 v6, v191, v189
v_lshlrev_b32 v190, 16, v232
v_lshlrev_b32 v191, 16, v233
v_and_b32 v232, 0xffff0000, v232
v_fmac_f32 v8, v190, v189
v_fmac_f32 v10, v191, v189
v_fmac_f32 v1, v184, v189
v_fmac_f32 v9, v232, v189
v_and_b32 v233, 0xffff0000, v233
v_lshlrev_b32 v190, 16, v234
v_lshlrev_b32 v191, 16, v235
v_fmac_f32 v3, v185, v189
v_and_b32 v186, 0xffff0000, v186
v_and_b32 v187, 0xffff0000, v187
v_fmac_f32 v11, v233, v189
v_and_b32 v234, 0xffff0000, v234
v_and_b32 v235, 0xffff0000, v235
v_cvt_pk_bf16_f32 v0, v0, v1
v_cvt_pk_bf16_f32 v8, v8, v9
v_fmac_f32 v5, v186, v189
v_fmac_f32 v7, v187, v189
v_fmac_f32 v12, v190, v189
v_fmac_f32 v13, v234, v189
v_fmac_f32 v14, v191, v189
v_fmac_f32 v15, v235, v189
v_cvt_pk_bf16_f32 v1, v2, v3
v_cvt_pk_bf16_f32 v9, v10, v11
v_cvt_pk_bf16_f32 v2, v4, v5
v_cvt_pk_bf16_f32 v3, v6, v7
v_cvt_pk_bf16_f32 v10, v12, v13
v_cvt_pk_bf16_f32 v11, v14, v15
v_pk_max_i16 v0, v0, 0
v_pk_max_i16 v1, v1, 0
v_pk_max_i16 v2, v2, 0
v_pk_max_i16 v3, v3, 0
v_pk_max_i16 v8, v8, 0
v_pk_max_i16 v9, v9, 0
v_pk_max_i16 v10, v10, 0
v_pk_max_i16 v11, v11, 0
buffer_store_dwordx4 v[0:3], v245, s[20:23], s48 offen offset:0 nt
buffer_store_dwordx4 v[8:11], v245, s[20:23], s48 offen offset:64 nt
s_waitcnt lgkmcnt(1)
v_add_f32 v249, v249, v250
v_rcp_f32 v252, v249
s_nop 0
v_fmac_f32 v168, v228, v252
v_fmac_f32 v169, v229, v252
v_fmac_f32 v176, v220, v252
v_fmac_f32 v177, v221, v252
v_fmac_f32 v170, v230, v252
v_fmac_f32 v171, v231, v252
v_cvt_pk_bf16_f32 v168, v168, v169
v_fmac_f32 v178, v222, v252
v_fmac_f32 v179, v223, v252
v_cvt_pk_bf16_f32 v176, v176, v177
v_fmac_f32 v172, v192, v252
v_fmac_f32 v173, v193, v252
v_fmac_f32 v174, v194, v252
v_fmac_f32 v175, v195, v252
v_cvt_pk_bf16_f32 v169, v170, v171
v_fmac_f32 v180, v224, v252
v_fmac_f32 v181, v225, v252
v_fmac_f32 v182, v226, v252
v_fmac_f32 v183, v227, v252
v_cvt_pk_bf16_f32 v177, v178, v179
v_cvt_pk_bf16_f32 v170, v172, v173
v_cvt_pk_bf16_f32 v171, v174, v175
v_cvt_pk_bf16_f32 v178, v180, v181
v_cvt_pk_bf16_f32 v179, v182, v183
v_pk_max_i16 v168, v168, 0
v_pk_max_i16 v169, v169, 0
v_pk_max_i16 v170, v170, 0
v_pk_max_i16 v171, v171, 0
v_pk_max_i16 v176, v176, 0
v_pk_max_i16 v177, v177, 0
v_pk_max_i16 v178, v178, 0
v_pk_max_i16 v179, v179, 0
buffer_store_dwordx4 v[168:171], v239, s[20:23], s53 offen offset:0 nt
buffer_store_dwordx4 v[176:179], v239, s[20:23], s53 offen offset:64 nt
s_waitcnt lgkmcnt(0)
v_add_f32 v204, v204, v205
v_rcp_f32 v205, v204
s_nop 0
v_fmac_f32 v16, v206, v205
v_fmac_f32 v18, v207, v205
v_lshlrev_b32 v206, 16, v198
v_lshlrev_b32 v207, 16, v199
v_fmac_f32 v20, v206, v205
v_fmac_f32 v22, v207, v205
v_lshlrev_b32 v206, 16, v200
v_lshlrev_b32 v207, 16, v201
v_and_b32 v200, 0xffff0000, v200
v_fmac_f32 v24, v206, v205
v_fmac_f32 v26, v207, v205
v_fmac_f32 v17, v196, v205
v_fmac_f32 v25, v200, v205
v_and_b32 v201, 0xffff0000, v201
v_lshlrev_b32 v206, 16, v202
v_lshlrev_b32 v207, 16, v203
v_fmac_f32 v19, v197, v205
v_and_b32 v198, 0xffff0000, v198
v_and_b32 v199, 0xffff0000, v199
v_fmac_f32 v27, v201, v205
v_and_b32 v202, 0xffff0000, v202
v_and_b32 v203, 0xffff0000, v203
v_cvt_pk_bf16_f32 v16, v16, v17
v_cvt_pk_bf16_f32 v24, v24, v25
v_fmac_f32 v21, v198, v205
v_fmac_f32 v23, v199, v205
v_fmac_f32 v28, v206, v205
v_fmac_f32 v29, v202, v205
v_fmac_f32 v30, v207, v205
v_fmac_f32 v31, v203, v205
v_cvt_pk_bf16_f32 v17, v18, v19
v_cvt_pk_bf16_f32 v25, v26, v27
v_cvt_pk_bf16_f32 v18, v20, v21
v_cvt_pk_bf16_f32 v19, v22, v23
v_cvt_pk_bf16_f32 v26, v28, v29
v_cvt_pk_bf16_f32 v27, v30, v31
v_pk_max_i16 v16, v16, 0
v_pk_max_i16 v17, v17, 0
v_pk_max_i16 v18, v18, 0
v_pk_max_i16 v19, v19, 0
v_pk_max_i16 v24, v24, 0
v_pk_max_i16 v25, v25, 0
v_pk_max_i16 v26, v26, 0
v_pk_max_i16 v27, v27, 0
buffer_store_dwordx4 v[16:19], v245, s[20:23], s51 offen offset:0 nt
buffer_store_dwordx4 v[24:27], v245, s[20:23], s51 offen offset:64 nt
L_end:
s_endpgm
.section .rodata,"a"
.p2align 6
.amdhsa_kernel standalone__attention_interact_autoint__recsys_kernel
  .amdhsa_next_free_vgpr 512
  .amdhsa_next_free_sgpr 102
  .amdhsa_accum_offset 256
  .amdhsa_group_segment_fixed_size 0
  .amdhsa_kernarg_size 64
  .amdhsa_user_sgpr_count 2
  .amdhsa_user_sgpr_kernarg_segment_ptr 1
  .amdhsa_system_sgpr_workgroup_id_x 1
.end_amdhsa_kernel
```

```asm
; @launch grid=(256,1,1) block=(256,1,1) lds=163840
.amdgcn_target "amdgcn-amd-amdhsa--gfx950"
.text
.globl standalone__attention_interact_autoint__recsys_kernel
.p2align 8
.type standalone__attention_interact_autoint__recsys_kernel,@function
standalone__attention_interact_autoint__recsys_kernel:
s_cmp_ge_u32 s2, 256
s_cbranch_scc1 L_end
s_load_dwordx2 s[24:25], s[0:1], 8
s_load_dwordx2 s[28:29], s[0:1], 16
s_load_dwordx2 s[32:33], s[0:1], 24
s_load_dwordx2 s[36:37], s[0:1], 32
s_getpc_b64 s[58:59]
L_pc:
s_lshl_b32 s3, s2, 8
s_and_b32 s3, s3, 0x7800
v_lshrrev_b32 v2, 4, v0
v_lshl_add_u32 v2, v2, 7, s3
v_min_u32 v2, L_fast_end-L_pc-4, v2
global_load_dword v96, v2, s[58:59]
v_lshrrev_b32 v1, 6, v0
s_mov_b32 s27, 0x20000
v_readfirstlane_b32 s41, v1
s_mov_b32 s26, 32768
s_mov_b64 s[30:31], s[26:27]
s_mov_b64 s[34:35], s[26:27]
s_mov_b64 s[38:39], s[26:27]
s_lshl_b32 s54, s41, 13
s_lshl_b32 s6, s2, 7
s_and_b32 s6, s6, 0x7c00
s_add_u32 s57, s54, 4096
v_and_b32 v168, 63, v0
v_lshrrev_b32 v169, 5, v0
v_lshlrev_b32 v175, 4, v168
v_lshlrev_b32 v169, 7, v169
s_waitcnt lgkmcnt(0)
buffer_load_dword v97, v169, s[24:27], s6 offen
buffer_load_dword v98, v169, s[28:31], s6 offen
buffer_load_dword v99, v169, s[32:35], s6 offen
buffer_load_dword v100, v169, s[36:39], s6 offen
buffer_load_dwordx4 v[104:107], v175, s[24:27], s54 offen offset:0
buffer_load_dwordx4 v[108:111], v175, s[24:27], s54 offen offset:1024
buffer_load_dwordx4 v[112:115], v175, s[24:27], s54 offen offset:2048
buffer_load_dwordx4 v[116:119], v175, s[24:27], s54 offen offset:3072
buffer_load_dwordx4 v[120:123], v175, s[24:27], s57 offen offset:0
buffer_load_dwordx4 v[124:127], v175, s[24:27], s57 offen offset:1024
buffer_load_dwordx4 v[128:131], v175, s[24:27], s57 offen offset:2048
buffer_load_dwordx4 v[132:135], v175, s[24:27], s57 offen offset:3072
s_load_dwordx2 s[16:17], s[0:1], 0
s_load_dwordx2 s[20:21], s[0:1], 40
s_mov_b32 s18, 104857600
s_mov_b32 s19, s27
s_lshr_b32 s42, s41, 1
s_and_b32 s43, s41, 1
s_lshl1_add_u32 s44, s2, s42
s_mul_i32 s44, s44, 25600
s_mov_b32 s40, 0x3e38aa3b
s_mov_b64 s[22:23], s[18:19]
s_mov_b32 s45, 8
s_mov_b32 s3, 64
s_mov_b32 s46, s44
s_mov_b32 s47, 0x7ff00000
s_mov_b32 s56, 50688
s_mov_b32 s96, 0x3b8265d9
s_mov_b32 s97, 0
s_mov_b32 s14, 0x55555555
s_mov_b32 s15, 0x55555555
s_mul_i32 s49, s42, 25344
s_mul_i32 s53, s43, 1056
s_add_u32 s49, s49, s53
s_lshl_b32 s55, s43, 10
s_add_u32 s55, s55, s44
s_waitcnt lgkmcnt(0)
s_add_u32 m0, s49, 21120
s_add_u32 s48, s55, 20480
s_mul_i32 s98, s42, 25344
s_lshl_b32 s53, s43, 13
s_add_u32 s98, s98, s53
s_add_u32 s53, s98, 4224
v_and_b32 v243, 48, v175
v_and_b32 v169, 48, v168
v_lshl_add_u32 v243, v169, 2, v243
v_and_b32 v169, 12, v168
v_lshl_add_u32 v243, v169, 6, v243
buffer_load_dwordx4 v243, s[16:19], s48 offen nt lds
s_add_u32 m0, s49, 23232
s_add_u32 s48, s55, 22528
buffer_load_dwordx4 v243, s[16:19], s48 offen nt lds
s_add_u32 m0, s49, 0
s_add_u32 s48, s55, 0
s_mov_b64 exec, 0
s_cmp_eq_u32 s41, 0
s_cbranch_scc1 L_h0
s_cmp_eq_u32 s41, 1
s_cbranch_scc1 L_h1
s_cmp_eq_u32 s41, 2
s_cbranch_scc1 L_h2
s_branch L_h3
L_ret:
s_mov_b64 exec, -1
buffer_load_dwordx4 v243, s[16:19], s48 offen nt lds
s_add_u32 m0, s49, 2112
s_add_u32 s48, s55, 2048
buffer_load_dwordx4 v243, s[16:19], s48 offen nt lds
s_add_u32 m0, s98, 102400
v_and_b32 v169, 16, v168
v_mov_b32 v180, v169
v_lshlrev_b32 v169, 1, v169
v_xor_b32 v170, v175, v169
v_add_u32 v172, s53, v170
v_xor_b32 v171, 64, v170
v_add_u32 v173, s53, v171
s_mul_i32 s53, s43, 25344
s_add_u32 s7, s53, 4224
v_lshrrev_b32 v82, 4, v168
v_lshl_add_u32 v176, v82, 10, s7
v_bfe_u32 v83, v168, 2, 2
v_lshl_add_u32 v176, v83, 7, v176
v_bfe_u32 v84, v168, 3, 1
v_lshl_add_u32 v176, v84, 5, v176
v_bfe_u32 v85, v168, 4, 1
v_lshl_add_u32 v176, v85, 6, v176
v_and_b32 v86, 3, v168
v_lshl_add_u32 v176, v86, 3, v176
v_xor_b32 v177, 32, v176
v_xor_b32 v178, 64, v176
s_mul_i32 s53, s42, 25344
v_lshl_add_u32 v242, v86, 6, s53
v_lshl_add_u32 v242, v82, 4, v242
s_mov_b32 s6, 1056
v_mad_u32_u24 v242, v83, s6, v242
v_xor_b32 v179, 96, v176
s_mul_i32 s4, s43, 13107200
s_add_u32 s4, s4, s44
s_add_u32 s4, s4, 24576
s_mul_i32 s5, s43, -52424704
s_add_u32 s5, s5, 104833024
s_add_u32 s99, s4, 0
s_add_u32 s100, s4, 26212288
v_lshrrev_b32 v80, 3, v168
v_lshlrev_b32 v174, 8, v80
v_and_b32 v81, 7, v168
v_lshl_add_u32 v174, v81, 4, v174
v_xor_b32 v174, v174, v180
v_xor_b32 v180, v175, v180
s_mul_i32 s53, s41, 816
s_add_u32 s53, s53, 157696
v_and_b32 v88, 1, v168
v_lshl_add_u32 v249, v83, 6, s53
v_lshl_add_u32 v249, v88, 5, v249
s_add_u32 s8, s53, 256
s_mov_b32 vcc_lo, 0x33333333
s_mov_b32 vcc_hi, 0xcccccccc
v_lshl_add_u32 v249, v85, 4, v249
v_mov_b32 v166, s8
v_cndmask_b32 v249, v166, v249, vcc
s_add_u32 s9, s53, 256
v_lshl_add_u32 v166, v83, 2, s9
s_mov_b32 s8, 272
v_lshl_add_u32 v248, v82, 6, s53
v_mov_b32 v236, 0
v_mad_u32_u24 v166, v86, s8, v166
s_lshl_b32 s53, s41, 8
s_add_u32 s10, s53, 101376
ds_write_b32 v166, v236 offset:0
s_add_u32 s58, s53, 36096
s_xor_b32 s59, s53, 256
s_add_u32 s59, s59, 36096
v_lshl_add_u32 v166, v168, 2, s10
v_bfe_u32 v87, v168, 1, 1
v_lshl_add_u32 v248, v87, 5, v248
v_lshl_add_u32 v248, v83, 3, v248
v_lshl_add_u32 v248, v88, 1, v248
ds_write_b32 v166, v166 offset:0
s_waitcnt vmcnt(11)
v_and_b32 v160, 0xffff0000, v104
v_and_b32 v161, 0xffff0000, v105
v_and_b32 v162, 0xffff0000, v106
v_and_b32 v163, 0xffff0000, v107
v_lshlrev_b32 v104, 16, v104
v_lshlrev_b32 v105, 16, v105
v_lshlrev_b32 v106, 16, v106
v_lshlrev_b32 v107, 16, v107
v_mul_f32 v160, s40, v160
v_mul_f32 v104, s40, v104
v_mul_f32 v161, s40, v161
v_mul_f32 v105, s40, v105
v_mul_f32 v162, s40, v162
v_mul_f32 v106, s40, v106
v_mul_f32 v163, s40, v163
v_mul_f32 v107, s40, v107
v_cvt_pk_bf16_f32 v104, v104, v160
v_cvt_pk_bf16_f32 v105, v105, v161
v_cvt_pk_bf16_f32 v106, v106, v162
v_cvt_pk_bf16_f32 v107, v107, v163
ds_write_b128 v172, v[104:107] offset:0
buffer_load_dwordx4 v170, s[28:31], s54 offen offset:0 lds
s_waitcnt vmcnt(11)
v_and_b32 v160, 0xffff0000, v108
v_and_b32 v161, 0xffff0000, v109
v_and_b32 v162, 0xffff0000, v110
v_and_b32 v163, 0xffff0000, v111
v_lshlrev_b32 v108, 16, v108
v_lshlrev_b32 v109, 16, v109
v_lshlrev_b32 v110, 16, v110
v_lshlrev_b32 v111, 16, v111
v_mul_f32 v160, s40, v160
v_mul_f32 v108, s40, v108
v_mul_f32 v161, s40, v161
v_mul_f32 v109, s40, v109
v_mul_f32 v162, s40, v162
v_mul_f32 v110, s40, v110
v_mul_f32 v163, s40, v163
v_mul_f32 v111, s40, v111
v_cvt_pk_bf16_f32 v108, v108, v160
v_cvt_pk_bf16_f32 v109, v109, v161
v_cvt_pk_bf16_f32 v110, v110, v162
v_cvt_pk_bf16_f32 v111, v111, v163
ds_write_b128 v173, v[108:111] offset:1024
buffer_load_dwordx4 v171, s[28:31], s54 offen offset:1024 lds
s_waitcnt vmcnt(11)
v_and_b32 v160, 0xffff0000, v112
v_and_b32 v161, 0xffff0000, v113
v_and_b32 v162, 0xffff0000, v114
v_and_b32 v163, 0xffff0000, v115
v_lshlrev_b32 v112, 16, v112
v_lshlrev_b32 v113, 16, v113
v_lshlrev_b32 v114, 16, v114
v_lshlrev_b32 v115, 16, v115
v_mul_f32 v160, s40, v160
v_mul_f32 v112, s40, v112
v_mul_f32 v161, s40, v161
v_mul_f32 v113, s40, v113
v_mul_f32 v162, s40, v162
v_mul_f32 v114, s40, v114
v_mul_f32 v163, s40, v163
v_mul_f32 v115, s40, v115
v_cvt_pk_bf16_f32 v112, v112, v160
v_cvt_pk_bf16_f32 v113, v113, v161
v_cvt_pk_bf16_f32 v114, v114, v162
v_cvt_pk_bf16_f32 v115, v115, v163
ds_write_b128 v172, v[112:115] offset:2048
buffer_load_dwordx4 v170, s[28:31], s54 offen offset:2048 lds
s_waitcnt vmcnt(11)
v_and_b32 v160, 0xffff0000, v116
v_and_b32 v161, 0xffff0000, v117
v_and_b32 v162, 0xffff0000, v118
v_and_b32 v163, 0xffff0000, v119
v_lshlrev_b32 v116, 16, v116
v_lshlrev_b32 v117, 16, v117
v_lshlrev_b32 v118, 16, v118
v_lshlrev_b32 v119, 16, v119
v_mul_f32 v160, s40, v160
v_mul_f32 v116, s40, v116
v_mul_f32 v161, s40, v161
v_mul_f32 v117, s40, v117
v_mul_f32 v162, s40, v162
v_mul_f32 v118, s40, v118
v_mul_f32 v163, s40, v163
v_mul_f32 v119, s40, v119
v_cvt_pk_bf16_f32 v116, v116, v160
v_cvt_pk_bf16_f32 v117, v117, v161
v_cvt_pk_bf16_f32 v118, v118, v162
v_cvt_pk_bf16_f32 v119, v119, v163
ds_write_b128 v173, v[116:119] offset:3072
buffer_load_dwordx4 v171, s[28:31], s54 offen offset:3072 lds
s_add_u32 m0, s98, 106496
s_waitcnt vmcnt(11)
v_and_b32 v160, 0xffff0000, v120
v_and_b32 v161, 0xffff0000, v121
v_and_b32 v162, 0xffff0000, v122
v_and_b32 v163, 0xffff0000, v123
v_lshlrev_b32 v120, 16, v120
v_lshlrev_b32 v121, 16, v121
v_lshlrev_b32 v122, 16, v122
v_lshlrev_b32 v123, 16, v123
v_mul_f32 v160, s40, v160
v_mul_f32 v120, s40, v120
v_mul_f32 v161, s40, v161
v_mul_f32 v121, s40, v121
v_mul_f32 v162, s40, v162
v_mul_f32 v122, s40, v122
v_mul_f32 v163, s40, v163
v_mul_f32 v123, s40, v123
v_cvt_pk_bf16_f32 v120, v120, v160
v_cvt_pk_bf16_f32 v121, v121, v161
v_cvt_pk_bf16_f32 v122, v122, v162
v_cvt_pk_bf16_f32 v123, v123, v163
ds_write_b128 v172, v[120:123] offset:4096
buffer_load_dwordx4 v170, s[28:31], s57 offen offset:0 lds
s_waitcnt vmcnt(11)
v_and_b32 v160, 0xffff0000, v124
v_and_b32 v161, 0xffff0000, v125
v_and_b32 v162, 0xffff0000, v126
v_and_b32 v163, 0xffff0000, v127
v_lshlrev_b32 v124, 16, v124
v_lshlrev_b32 v125, 16, v125
v_lshlrev_b32 v126, 16, v126
v_lshlrev_b32 v127, 16, v127
v_mul_f32 v160, s40, v160
v_mul_f32 v124, s40, v124
v_mul_f32 v161, s40, v161
v_mul_f32 v125, s40, v125
v_mul_f32 v162, s40, v162
v_mul_f32 v126, s40, v126
v_mul_f32 v163, s40, v163
v_mul_f32 v127, s40, v127
v_cvt_pk_bf16_f32 v124, v124, v160
v_cvt_pk_bf16_f32 v125, v125, v161
v_cvt_pk_bf16_f32 v126, v126, v162
v_cvt_pk_bf16_f32 v127, v127, v163
ds_write_b128 v173, v[124:127] offset:5120
buffer_load_dwordx4 v171, s[28:31], s57 offen offset:1024 lds
s_waitcnt vmcnt(11)
v_and_b32 v160, 0xffff0000, v128
v_and_b32 v161, 0xffff0000, v129
v_and_b32 v162, 0xffff0000, v130
v_and_b32 v163, 0xffff0000, v131
v_lshlrev_b32 v128, 16, v128
v_lshlrev_b32 v129, 16, v129
v_lshlrev_b32 v130, 16, v130
v_lshlrev_b32 v131, 16, v131
v_mul_f32 v160, s40, v160
v_mul_f32 v128, s40, v128
v_mul_f32 v161, s40, v161
v_mul_f32 v129, s40, v129
v_mul_f32 v162, s40, v162
v_mul_f32 v130, s40, v130
v_mul_f32 v163, s40, v163
v_mul_f32 v131, s40, v131
v_cvt_pk_bf16_f32 v128, v128, v160
v_cvt_pk_bf16_f32 v129, v129, v161
v_cvt_pk_bf16_f32 v130, v130, v162
v_cvt_pk_bf16_f32 v131, v131, v163
ds_write_b128 v172, v[128:131] offset:6144
buffer_load_dwordx4 v170, s[28:31], s57 offen offset:2048 lds
s_waitcnt vmcnt(11)
v_and_b32 v160, 0xffff0000, v132
v_and_b32 v161, 0xffff0000, v133
v_and_b32 v162, 0xffff0000, v134
v_and_b32 v163, 0xffff0000, v135
v_lshlrev_b32 v132, 16, v132
v_lshlrev_b32 v133, 16, v133
v_lshlrev_b32 v134, 16, v134
v_lshlrev_b32 v135, 16, v135
v_mul_f32 v160, s40, v160
v_mul_f32 v132, s40, v132
v_mul_f32 v161, s40, v161
v_mul_f32 v133, s40, v133
v_mul_f32 v162, s40, v162
v_mul_f32 v134, s40, v134
v_mul_f32 v163, s40, v163
v_mul_f32 v135, s40, v135
v_cvt_pk_bf16_f32 v132, v132, v160
v_cvt_pk_bf16_f32 v133, v133, v161
v_cvt_pk_bf16_f32 v134, v134, v162
v_cvt_pk_bf16_f32 v135, v135, v163
ds_write_b128 v173, v[132:135] offset:7168
buffer_load_dwordx4 v171, s[28:31], s57 offen offset:3072 lds
s_add_u32 m0, s49, 50688
s_waitcnt vmcnt(10) lgkmcnt(0)
s_barrier
ds_read_b64_tr_b16 a[28:29], v177 offset:12288
ds_read_b128 v[188:191], v242 offset:21120
ds_read_b64_tr_b16 a[30:31], v177 offset:12800
ds_read_b128 v[212:215], v242 offset:21376
ds_read_b64_tr_b16 a[0:1], v176 offset:0
ds_read_b128 v[224:227], v242 offset:21632
ds_read_b64_tr_b16 a[2:3], v176 offset:512
ds_read_b128 v[232:235], v242 offset:21888
ds_read_b64_tr_b16 a[24:25], v177 offset:8192
ds_read_b64_tr_b16 a[26:27], v177 offset:8704
ds_read_b64_tr_b16 a[4:5], v176 offset:4096
ds_read_b64_tr_b16 a[6:7], v176 offset:4608
ds_read_b64_tr_b16 a[20:21], v177 offset:4096
ds_read_b64_tr_b16 a[22:23], v177 offset:4608
ds_read_b64_tr_b16 a[8:9], v176 offset:8192
ds_read_b64_tr_b16 a[10:11], v176 offset:8704
ds_read_b64_tr_b16 a[16:17], v177 offset:0
ds_read_b64_tr_b16 a[18:19], v177 offset:512
ds_read_b64_tr_b16 a[12:13], v176 offset:12288
ds_read_b64_tr_b16 a[14:15], v176 offset:12800
ds_read_b64_tr_b16 a[32:33], v178 offset:0
ds_read_b64_tr_b16 a[34:35], v178 offset:512
ds_read_b64_tr_b16 a[36:37], v178 offset:4096
ds_read_b64_tr_b16 a[38:39], v178 offset:4608
ds_read_b64_tr_b16 a[40:41], v178 offset:8192
ds_read_b64_tr_b16 a[42:43], v178 offset:8704
ds_read_b64_tr_b16 a[44:45], v178 offset:12288
ds_read_b64_tr_b16 a[46:47], v178 offset:12800
s_waitcnt lgkmcnt(15)
v_mfma_f32_16x16x32_bf16 v[192:195], a[0:3], v[188:191], 0
s_waitcnt lgkmcnt(12)
ds_read_b64_tr_b16 a[48:49], v179 offset:0
v_add_u32 v176, 98176, v176
v_mfma_f32_16x16x32_bf16 v[192:195], a[4:7], v[212:215], v[192:195]
s_waitcnt lgkmcnt(9)
ds_read_b64_tr_b16 a[50:51], v179 offset:512
v_add_u32 v177, 98176, v177
v_mfma_f32_16x16x32_bf16 v[192:195], a[8:11], v[224:227], v[192:195]
s_mul_i32 s53, s43, 25344
ds_read_b64_tr_b16 a[52:53], v179 offset:4096
v_add_u32 v178, 98176, v178
v_mfma_f32_16x16x32_bf16 v[192:195], a[12:15], v[232:235], v[192:195]
s_add_u32 s11, s53, 59648
ds_read_b64_tr_b16 a[54:55], v179 offset:4608
v_lshl_add_u32 v182, v82, 10, s11
v_mfma_f32_16x16x32_bf16 v[196:199], a[28:31], v[232:235], 0
s_lshl_b32 s53, s43, 7
ds_read_b64_tr_b16 a[56:57], v179 offset:8192
v_lshl_add_u32 v182, v83, 7, v182
v_mfma_f32_16x16x32_bf16 v[196:199], a[24:27], v[224:227], v[196:199]
s_mov_b32 s51, -32
ds_read_b64_tr_b16 a[58:59], v179 offset:8704
v_cvt_pk_bf16_f32 v152, v192, v193
v_mfma_f32_16x16x32_bf16 v[196:199], a[20:23], v[212:215], v[196:199]
s_waitcnt lgkmcnt(12)
ds_read_b64_tr_b16 a[60:61], v179 offset:12288
v_cvt_pk_bf16_f32 v153, v194, v195
v_mfma_f32_16x16x32_bf16 v[196:199], a[16:19], v[188:191], v[196:199]
s_waitcnt lgkmcnt(11)
ds_read_b64_tr_b16 a[62:63], v179 offset:12800
v_add_u32 v179, 98176, v179
v_mfma_f32_16x16x32_bf16 v[200:203], a[32:35], v[188:191], 0
s_waitcnt lgkmcnt(10)
buffer_load_dwordx4 v243, s[16:19], s99 offen offset:0 nt lds
v_mfma_f32_16x16x32_bf16 v[200:203], a[36:39], v[212:215], v[200:203]
s_waitcnt lgkmcnt(8)
buffer_load_dwordx4 v243, s[16:19], s100 offen offset:2112 nt lds
v_mfma_f32_16x16x32_bf16 v[200:203], a[40:43], v[224:227], v[200:203]
s_add_u32 m0, s49, 54912
s_add_u32 s99, s4, 52428800
s_add_u32 s100, s4, 78641088
v_mfma_f32_16x16x32_bf16 v[200:203], a[44:47], v[232:235], v[200:203]
s_waitcnt lgkmcnt(4)
buffer_load_dwordx4 v243, s[16:19], s99 offen offset:0 nt lds
s_add_u32 s99, s55, 4096
v_cvt_pk_bf16_f32 v154, v196, v197
v_cvt_pk_bf16_f32 v155, v198, v199
s_waitcnt lgkmcnt(0)
v_mfma_f32_16x16x32_bf16 v[204:207], a[60:63], v[232:235], 0
buffer_load_dwordx4 v243, s[16:19], s100 offen offset:2112 nt lds
v_mfma_f32_16x16x32_bf16 v[204:207], a[52:55], v[212:215], v[204:207]
s_waitcnt vmcnt(12)
s_barrier
v_mfma_f32_16x16x32_bf16 v[204:207], a[48:51], v[188:191], v[204:207]
s_add_u32 m0, s98, 59648
ds_read_b128 v[208:211], v242 offset:512
ds_read_b128 v[216:219], v242 offset:768
v_mfma_f32_16x16x32_bf16 v[204:207], a[56:59], v[224:227], v[204:207]
s_add_u32 s100, s55, 4032
ds_read_b128 v[220:223], v242 offset:256
ds_read_b128 v[228:231], v242 offset:0
v_cvt_pk_bf16_f32 v156, v200, v201
v_cvt_pk_bf16_f32 v157, v202, v203
v_lshl_add_u32 v182, v84, 4, v182
v_lshl_add_u32 v182, v86, 5, v182
v_xor_b32 v183, 16, v182
v_bfe_u32 v89, v168, 1, 3
v_cvt_pk_bf16_f32 v158, v204, v205
v_cvt_pk_bf16_f32 v159, v206, v207
v_lshl_add_u32 v244, v89, 9, s53
s_mul_i32 s52, s41, 13824
s_add_u32 s52, s52, 102400
v_lshlrev_b32 v95, 4, v83
s_mov_b32 vcc_lo, 0x33333333
s_mov_b32 vcc_hi, 0x33333333
v_and_b32 v16, 15, v168
s_waitcnt lgkmcnt(3)
v_mfma_f32_16x16x32_bf16 v[192:195], a[56:59], v[208:211], 0
s_waitcnt lgkmcnt(2)
v_mov_b32 v169, 163024
v_bfe_u32 v90, v168, 3, 2
v_mfma_f32_16x16x32_bf16 v[192:195], a[60:63], v[216:219], v[192:195]
s_waitcnt lgkmcnt(0)
v_bfe_u32 v91, v168, 2, 1
v_lshl_add_u32 v245, v84, 8, s52
v_mfma_f32_16x16x32_bf16 v[192:195], a[52:55], v[220:223], v[192:195]
s_waitcnt vmcnt(4)
s_barrier
v_mfma_f32_16x16x32_bf16 v[192:195], a[48:51], v[228:231], v[192:195]
s_lshl_b32 s53, s41, 9
ds_read_b64_tr_b16 a[64:65], v176 offset:0
v_lshl_add_u32 v164, v86, 7, s52
v_mfma_f32_16x16x32_bf16 v[196:199], a[32:35], v[228:231], 0
s_add_u32 s11, s53, 160960
ds_read_b64_tr_b16 a[66:67], v176 offset:512
v_lshl_add_u32 v167, v16, 4, s11
v_mfma_f32_16x16x32_bf16 v[196:199], a[36:39], v[220:223], v[196:199]
s_add_u32 s13, s52, 512
ds_read_b64_tr_b16 a[68:69], v176 offset:4096
v_cvt_pk_bf16_f32 v102, v192, v193
v_mfma_f32_16x16x32_bf16 v[196:199], a[40:43], v[208:211], v[196:199]
s_add_u32 s7, s52, 1072
ds_read_b64_tr_b16 a[70:71], v176 offset:4608
v_cvt_pk_bf16_f32 v103, v194, v195
v_mfma_f32_16x16x32_bf16 v[196:199], a[44:47], v[216:219], v[196:199]
s_add_u32 s12, s52, 1136
ds_read_b64_tr_b16 a[72:73], v176 offset:8192
v_lshl_add_u32 v247, v83, 7, s13
v_mfma_f32_16x16x32_bf16 v[192:195], a[28:31], v[216:219], 0
s_add_u32 s10, s52, 1136
ds_read_b64_tr_b16 a[74:75], v176 offset:8704
v_lshl_add_u32 v247, v88, 6, v247
v_mfma_f32_16x16x32_bf16 v[192:195], a[24:27], v[208:211], v[192:195]
s_add_u32 s9, s52, 1072
ds_read_b64_tr_b16 a[76:77], v176 offset:12288
v_cvt_pk_bf16_f32 v100, v196, v197
v_mfma_f32_16x16x32_bf16 v[192:195], a[20:23], v[220:223], v[192:195]
ds_read_b64_tr_b16 a[78:79], v176 offset:12800
v_cvt_pk_bf16_f32 v101, v198, v199
v_mfma_f32_16x16x32_bf16 v[192:195], a[16:19], v[228:231], v[192:195]
ds_read_b64_tr_b16 a[80:81], v177 offset:0
v_lshl_add_u32 v247, v82, 4, v247
v_mfma_f32_16x16x32_bf16 v[196:199], a[0:3], v[228:231], 0
ds_read_b64_tr_b16 a[82:83], v177 offset:512
v_mov_b32 v166, s7
v_mfma_f32_16x16x32_bf16 v[196:199], a[4:7], v[220:223], v[196:199]
s_mov_b32 s7, 1728
ds_read_b64_tr_b16 a[84:85], v177 offset:4096
v_cvt_pk_bf16_f32 v98, v192, v193
v_mfma_f32_16x16x32_bf16 v[196:199], a[8:11], v[208:211], v[196:199]
L_h0:
s_cbranch_execz L_h4
s_waitcnt lgkmcnt(9)
ds_read_b64_tr_b16 a[86:87], v177 offset:4608
v_cvt_pk_bf16_f32 v99, v194, v195
v_mfma_f32_16x16x32_bf16 v[196:199], a[12:15], v[216:219], v[196:199]
s_waitcnt lgkmcnt(8)
ds_read_b64_tr_b16 a[88:89], v177 offset:8192
v_xor_b32 v247, v95, v247
v_mfma_f32_16x16x32_bf16 v[192:195], a[64:67], v[188:191], 0
s_waitcnt lgkmcnt(7)
ds_read_b64_tr_b16 a[90:91], v177 offset:8704
v_cndmask_b32 v247, v166, v247, vcc
v_mfma_f32_16x16x32_bf16 v[192:195], a[68:71], v[212:215], v[192:195]
s_waitcnt lgkmcnt(6)
ds_read_b64_tr_b16 a[92:93], v177 offset:12288
v_cvt_pk_bf16_f32 v96, v196, v197
v_mfma_f32_16x16x32_bf16 v[192:195], a[72:75], v[224:227], v[192:195]
ds_read_b64_tr_b16 a[94:95], v177 offset:12800
v_cvt_pk_bf16_f32 v97, v198, v199
v_mfma_f32_16x16x32_bf16 v[192:195], a[76:79], v[232:235], v[192:195]
ds_read_b64_tr_b16 a[96:97], v178 offset:0
v_lshl_add_u32 v246, v90, 7, s12
v_mfma_f32_16x16x32_bf16 v[196:199], a[76:79], v[216:219], 0
ds_read_b64_tr_b16 a[98:99], v178 offset:512
v_lshl_add_u32 v246, v91, 6, v246
v_mfma_f32_16x16x32_bf16 v[196:199], a[64:67], v[228:231], v[196:199]
ds_read_b64_tr_b16 a[100:101], v178 offset:4096
v_lshlrev_b32 v17, 4, v86
v_mfma_f32_16x16x32_bf16 v[196:199], a[68:71], v[220:223], v[196:199]
s_waitcnt lgkmcnt(5)
ds_read_b64_tr_b16 a[102:103], v178 offset:4608
v_cvt_pk_bf16_f32 v40, v192, v193
v_mfma_f32_16x16x32_bf16 v[196:199], a[72:75], v[208:211], v[196:199]
ds_read_b64_tr_b16 a[104:105], v178 offset:8192
v_cvt_pk_bf16_f32 v41, v194, v195
v_mfma_f32_16x16x32_bf16 v[200:203], a[88:91], v[208:211], 0
ds_read_b64_tr_b16 a[106:107], v178 offset:8704
v_lshl_add_u32 v245, v87, 7, v245
v_mfma_f32_16x16x32_bf16 v[200:203], a[84:87], v[220:223], v[200:203]
s_waitcnt lgkmcnt(6)
ds_read_b64_tr_b16 a[108:109], v178 offset:12288
v_cvt_pk_bf16_f32 v0, v196, v197
v_mfma_f32_16x16x32_bf16 v[200:203], a[80:83], v[228:231], v[200:203]
ds_read_b64_tr_b16 a[110:111], v178 offset:12800
v_cvt_pk_bf16_f32 v1, v198, v199
v_mfma_f32_16x16x32_bf16 v[200:203], a[92:95], v[216:219], v[200:203]
ds_read_b64_tr_b16 a[112:113], v179 offset:0
v_lshlrev_b32 v94, 4, v87
v_mfma_f32_16x16x32_bf16 v[192:195], a[92:95], v[232:235], 0
ds_read_b64_tr_b16 a[114:115], v179 offset:512
v_lshl_add_u32 v246, v86, 3, v246
v_mfma_f32_16x16x32_bf16 v[192:195], a[88:91], v[224:227], v[192:195]
ds_read_b64_tr_b16 a[116:117], v179 offset:4096
v_lshrrev_b32 v92, 5, v168
v_mfma_f32_16x16x32_bf16 v[192:195], a[84:87], v[212:215], v[192:195]
s_waitcnt lgkmcnt(9)
ds_read_b64_tr_b16 a[118:119], v179 offset:4608
v_cvt_pk_bf16_f32 v2, v200, v201
v_mfma_f32_16x16x32_bf16 v[192:195], a[80:83], v[188:191], v[192:195]
s_waitcnt lgkmcnt(8)
ds_read_b64_tr_b16 a[120:121], v179 offset:8192
v_cvt_pk_bf16_f32 v3, v202, v203
v_mfma_f32_16x16x32_bf16 v[196:199], a[96:99], v[188:191], 0
s_waitcnt lgkmcnt(7)
ds_read_b64_tr_b16 a[122:123], v179 offset:8704
v_lshl_add_u32 v164, v92, 4, v164
v_mfma_f32_16x16x32_bf16 v[196:199], a[100:103], v[212:215], v[196:199]
s_waitcnt lgkmcnt(6)
ds_read_b64_tr_b16 a[124:125], v179 offset:12288
v_cvt_pk_bf16_f32 v42, v192, v193
v_mfma_f32_16x16x32_bf16 v[196:199], a[104:107], v[224:227], v[196:199]
ds_read_b64_tr_b16 a[126:127], v179 offset:12800
v_cvt_pk_bf16_f32 v43, v194, v195
v_mfma_f32_16x16x32_bf16 v[196:199], a[108:111], v[232:235], v[196:199]
buffer_load_dwordx4 v180, s[32:35], s54 offen offset:0 lds
v_mfma_f32_16x16x32_bf16 v[192:195], a[108:111], v[216:219], 0
buffer_load_dwordx4 v180, s[32:35], s54 offen offset:1024 lds
v_mfma_f32_16x16x32_bf16 v[192:195], a[96:99], v[228:231], v[192:195]
s_mov_b32 vcc_lo, 0xf0000f
s_mov_b32 vcc_hi, 0xf0000f00
v_cndmask_b32 v167, v169, v167, vcc
v_mfma_f32_16x16x32_bf16 v[192:195], a[100:103], v[220:223], v[192:195]
s_waitcnt lgkmcnt(2)
buffer_load_dwordx4 v180, s[32:35], s54 offen offset:2048 lds
v_mfma_f32_16x16x32_bf16 v[192:195], a[104:107], v[208:211], v[192:195]
buffer_load_dwordx4 v180, s[32:35], s54 offen offset:3072 lds
v_mfma_f32_16x16x32_bf16 v[200:203], a[120:123], v[208:211], 0
s_add_u32 m0, s98, 63744
v_cvt_pk_bf16_f32 v44, v196, v197
v_cvt_pk_bf16_f32 v45, v198, v199
v_mfma_f32_16x16x32_bf16 v[200:203], a[116:119], v[220:223], v[200:203]
s_waitcnt lgkmcnt(0)
buffer_load_dwordx4 v180, s[32:35], s57 offen offset:0 lds
v_mfma_f32_16x16x32_bf16 v[200:203], a[112:115], v[228:231], v[200:203]
buffer_load_dwordx4 v180, s[32:35], s57 offen offset:1024 lds
v_mfma_f32_16x16x32_bf16 v[200:203], a[124:127], v[216:219], v[200:203]
v_cvt_pk_bf16_f32 v4, v192, v193
v_cvt_pk_bf16_f32 v5, v194, v195
v_mfma_f32_16x16x32_bf16 v[192:195], a[124:127], v[232:235], 0
buffer_load_dwordx4 v180, s[32:35], s57 offen offset:2048 lds
v_mfma_f32_16x16x32_bf16 v[192:195], a[120:123], v[224:227], v[192:195]
buffer_load_dwordx4 v180, s[32:35], s57 offen offset:3072 lds
v_mfma_f32_16x16x32_bf16 v[192:195], a[116:119], v[212:215], v[192:195]
s_add_u32 m0, s49, 4224
s_lshl_b32 s57, s43, 14
s_lshl_b32 s53, s42, 7
s_add_u32 s57, s57, s53
v_mfma_f32_16x16x32_bf16 v[192:195], a[112:115], v[188:191], v[192:195]
v_cvt_pk_bf16_f32 v6, v200, v201
v_cvt_pk_bf16_f32 v7, v202, v203
v_lshl_add_u32 v164, v85, 3, v164
v_mad_u32_u24 v164, v83, s7, v164
v_mfma_f32_16x16x32_bf16 v[196:199], v[4:7], v[156:159], 0
v_xor_b32 v164, v17, v164
v_xor_b32 v165, 32, v164
v_mfma_f32_16x16x32_bf16 v[196:199], v[0:3], v[152:155], v[196:199]
v_cvt_pk_bf16_f32 v46, v192, v193
v_cvt_pk_bf16_f32 v47, v194, v195
v_mfma_f32_16x16x32_bf16 v[192:195], v[40:43], v[152:155], 0
v_lshl_add_u32 v245, v88, 6, v245
v_lshl_add_u32 v245, v82, 4, v245
v_mfma_f32_16x16x32_bf16 v[192:195], v[44:47], v[156:159], v[192:195]
v_lshlrev_b32 v93, 5, v84
v_xor_b32 v245, v93, v245
v_mfma_f32_16x16x32_bf16 v[200:203], v[44:47], v[100:103], 0
v_exp_f32 v196, v196
v_mfma_f32_16x16x32_bf16 v[200:203], v[40:43], v[96:99], v[200:203]
v_exp_f32 v197, v197
v_mfma_f32_16x16x32_bf16 v[204:207], v[0:3], v[96:99], 0
s_nop 0
v_exp_f32 v192, v192
v_mfma_f32_16x16x32_bf16 v[204:207], v[4:7], v[100:103], v[204:207]
v_exp_f32 v193, v193
v_exp_f32 v194, v194
v_exp_f32 v195, v195
v_cvt_pk_bf16_f32 v114, v192, v193
v_cvt_pk_bf16_f32 v115, v194, v195
v_exp_f32 v198, v198
v_exp_f32 v199, v199
v_cvt_pk_bf16_f32 v104, v196, v197
v_cvt_pk_bf16_f32 v105, v198, v199
v_exp_f32 v200, v200
v_exp_f32 v201, v201
v_exp_f32 v202, v202
v_exp_f32 v203, v203
v_cvt_pk_bf16_f32 v130, v200, v201
v_cvt_pk_bf16_f32 v131, v202, v203
v_xor_b32 v245, v94, v245
s_mov_b32 vcc_lo, 0x33333333
s_mov_b32 vcc_hi, 0x33333333
v_mov_b32 v184, 0
v_mov_b32 v169, 0x3f803f80
v_cndmask_b32 v184, v184, v169, vcc
s_mov_b32 vcc_lo, 0xaaaaaaaa
s_mov_b32 vcc_hi, 0xaaaaaaaa
v_mov_b32 v251, 0x44444444
v_mov_b32 v169, 0xeeeeeeee
v_cndmask_b32 v251, v251, v169, vcc
s_mov_b32 vcc_lo, 0x0
s_mov_b32 vcc_hi, 0xaaaaaaaa
v_mov_b32 v169, 0xe4eeeeee
v_cndmask_b32 v251, v251, v169, vcc
s_mov_b32 vcc_lo, 0xffff
s_mov_b32 vcc_hi, 0xffff
v_mov_b32 v252, 0x0c0c0c0c
v_mov_b32 v169, 0x07060302
v_cndmask_b32 v252, v252, v169, vcc
s_mov_b32 vcc_lo, 0xffff0000
s_mov_b32 vcc_hi, 0xffff0000
s_waitcnt vmcnt(8)
s_barrier
ds_read_b128 v[48:51], v242 offset:50688
ds_read_b128 v[52:55], v242 offset:50944
ds_read_b128 v[56:59], v242 offset:51200
ds_read_b128 v[60:63], v242 offset:51456
ds_read_b128 v[64:67], v242 offset:54912
ds_read_b128 v[68:71], v242 offset:55168
ds_read_b128 v[72:75], v242 offset:55424
ds_read_b128 v[76:79], v242 offset:55680
v_mov_b32 v253, 0x0c0c0c0c
v_mov_b32 v169, 0x07060302
v_cndmask_b32 v253, v253, v169, vcc
v_lshl_add_u32 v250, v16, 2, s52
v_lshl_add_u32 v181, v16, 3, s10
v_exp_f32 v204, v204
v_exp_f32 v205, v205
v_exp_f32 v206, v206
v_exp_f32 v207, v207
s_waitcnt lgkmcnt(7)
v_mfma_f32_16x16x32_bf16 v[192:195], a[64:67], v[48:51], 0
s_waitcnt lgkmcnt(5)
buffer_load_dwordx4 v243, s[16:19], s99 offen offset:0 nt lds
v_mfma_f32_16x16x32_bf16 v[192:195], a[68:71], v[52:55], v[192:195]
s_waitcnt lgkmcnt(4)
buffer_load_dwordx4 v243, s[16:19], s100 offen offset:2112 nt lds
v_mfma_f32_16x16x32_bf16 v[192:195], a[72:75], v[56:59], v[192:195]
s_add_u32 s99, s55, 8192
s_add_u32 m0, s49, 8448
s_add_u32 s100, s55, 8128
v_mfma_f32_16x16x32_bf16 v[192:195], a[76:79], v[60:63], v[192:195]
v_cvt_pk_bf16_f32 v120, v204, v205
v_cvt_pk_bf16_f32 v121, v206, v207
v_mfma_f32_16x16x32_bf16 v[196:199], a[92:95], v[60:63], 0
v_lshl_add_u32 v166, v90, 2, s9
v_mad_u32_u24 v181, v82, s7, v181
v_mfma_f32_16x16x32_bf16 v[196:199], a[88:91], v[56:59], v[196:199]
v_lshl_add_u32 v244, v88, 4, v244
v_mad_u32_u24 v250, v82, s8, v250
v_mfma_f32_16x16x32_bf16 v[196:199], a[84:87], v[52:55], v[196:199]
v_cvt_pk_bf16_f32 v136, v192, v193
v_cvt_pk_bf16_f32 v138, v194, v195
v_mfma_f32_16x16x32_bf16 v[196:199], a[80:83], v[48:51], v[196:199]
v_lshl_add_u32 v244, v82, 5, v244
v_mad_u32_u24 v166, v81, s7, v166
v_mfma_f32_16x16x32_bf16 v[192:195], a[96:99], v[48:51], 0
s_waitcnt lgkmcnt(2)
ds_write_b32 v166, v236 offset:0
v_mfma_f32_16x16x32_bf16 v[192:195], a[100:103], v[52:55], v[192:195]
s_waitcnt lgkmcnt(1)
s_lshl_b32 s50, s43, 12
s_add_u32 s50, s50, s44
s_add_u32 s50, s50, 13107200
v_mfma_f32_16x16x32_bf16 v[192:195], a[104:107], v[56:59], v[192:195]
v_cvt_pk_bf16_f32 v137, v196, v197
v_cvt_pk_bf16_f32 v139, v198, v199
v_mfma_f32_16x16x32_bf16 v[192:195], a[108:111], v[60:63], v[192:195]
ds_write_b64 v164, v[136:137] offset:0
v_mfma_f32_16x16x32_bf16 v[196:199], a[124:127], v[60:63], 0
ds_write_b64 v164, v[138:139] offset:64
v_mfma_f32_16x16x32_bf16 v[196:199], a[116:119], v[52:55], v[196:199]
v_lshl_add_u32 v246, v92, 2, v246
v_mov_b32 v185, v184
v_mfma_f32_16x16x32_bf16 v[196:199], a[112:115], v[48:51], v[196:199]
s_nop 0
v_cvt_pk_bf16_f32 v140, v192, v193
v_cvt_pk_bf16_f32 v142, v194, v195
v_mfma_f32_16x16x32_bf16 v[196:199], a[120:123], v[56:59], v[196:199]
v_mov_b32 v186, v184
v_mov_b32 v187, v184
v_mfma_f32_16x16x32_bf16 v[192:195], a[56:59], v[56:59], 0
buffer_load_dwordx4 v243, s[16:19], s99 offen offset:0 nt lds
v_mfma_f32_16x16x32_bf16 v[192:195], a[60:63], v[60:63], v[192:195]
s_add_u32 s99, s55, 12288
buffer_load_dwordx4 v243, s[16:19], s100 offen offset:2112 nt lds
v_mfma_f32_16x16x32_bf16 v[192:195], a[52:55], v[52:55], v[192:195]
s_add_u32 m0, s49, 12672
s_add_u32 s100, s55, 12224
v_cvt_pk_bf16_f32 v141, v196, v197
v_mfma_f32_16x16x32_bf16 v[192:195], a[48:51], v[48:51], v[192:195]
ds_write_b64 v165, v[140:141] offset:0
v_mfma_f32_16x16x32_bf16 v[200:203], a[32:35], v[48:51], 0
v_cvt_pk_bf16_f32 v143, v198, v199
v_mov_b32 v118, 0
v_mfma_f32_16x16x32_bf16 v[200:203], a[36:39], v[52:55], v[200:203]
ds_write_b64 v165, v[142:143] offset:64
v_mfma_f32_16x16x32_bf16 v[200:203], a[40:43], v[56:59], v[200:203]
ds_read_b128 v[238:241], v245 offset:0
v_cvt_pk_bf16_f32 v149, v192, v193
v_mfma_f32_16x16x32_bf16 v[200:203], a[44:47], v[60:63], v[200:203]
v_cvt_pk_bf16_f32 v151, v194, v195
v_mov_b32 v119, 0
v_mfma_f32_16x16x32_bf16 v[192:195], a[28:31], v[60:63], 0
v_mov_b32 v255, 0
v_mov_b32 v134, 0
v_mfma_f32_16x16x32_bf16 v[192:195], a[24:27], v[56:59], v[192:195]
v_mov_b32 v135, 0
v_mfma_f32_16x16x32_bf16 v[192:195], a[20:23], v[52:55], v[192:195]
v_cvt_pk_bf16_f32 v148, v200, v201
v_cvt_pk_bf16_f32 v150, v202, v203
v_mfma_f32_16x16x32_bf16 v[192:195], a[16:19], v[48:51], v[192:195]
s_nop 2
v_mfma_f32_16x16x32_bf16 v[196:199], a[0:3], v[48:51], 0
s_nop 2
v_mfma_f32_16x16x32_bf16 v[196:199], a[8:11], v[56:59], v[196:199]
v_cvt_pk_bf16_f32 v145, v192, v193
v_cvt_pk_bf16_f32 v147, v194, v195
v_mfma_f32_16x16x32_bf16 v[196:199], a[12:15], v[60:63], v[196:199]
v_mfma_f32_16x16x32_bf16 v[196:199], a[4:7], v[52:55], v[196:199]
s_nop 2
v_mfma_f32_16x16x32_bf16 v[192:195], a[4:7], v[68:71], 0
s_nop 2
v_mfma_f32_16x16x32_bf16 v[192:195], a[0:3], v[64:67], v[192:195]
v_cvt_pk_bf16_f32 v144, v196, v197
v_cvt_pk_bf16_f32 v146, v198, v199
v_mfma_f32_16x16x32_bf16 v[192:195], a[8:11], v[72:75], v[192:195]
ds_write_b64 v164, v[144:145] offset:512
v_mfma_f32_16x16x32_bf16 v[192:195], a[12:15], v[76:79], v[192:195]
s_waitcnt lgkmcnt(1)
ds_write_b64 v164, v[146:147] offset:576
v_mfma_f32_16x16x32_bf16 v[196:199], v[136:139], v[144:147], 0
ds_write_b64 v165, v[148:149] offset:512
v_mfma_f32_16x16x32_bf16 v[196:199], v[140:143], v[148:151], v[196:199]
s_waitcnt vmcnt(4)
s_barrier
v_mfma_f32_16x16x32_bf16 v[200:203], a[28:31], v[76:79], 0
ds_read_b64_tr_b16 a[176:177], v183 offset:8
v_cvt_pk_bf16_f32 v32, v192, v193
v_mfma_f32_16x16x32_bf16 v[200:203], a[24:27], v[72:75], v[200:203]
ds_read_b64_tr_b16 a[178:179], v183 offset:520
v_cvt_pk_bf16_f32 v34, v194, v195
v_mfma_f32_16x16x32_bf16 v[200:203], a[20:23], v[68:71], v[200:203]
ds_read_b64_tr_b16 a[180:181], v183 offset:4104
v_mfma_f32_16x16x32_bf16 v[200:203], a[16:19], v[64:67], v[200:203]
ds_read_b64_tr_b16 a[182:183], v183 offset:4616
s_nop 0
v_mfma_f32_16x16x32_bf16 v[192:195], a[32:35], v[64:67], 0
ds_read_b64_tr_b16 a[184:185], v183 offset:8200
s_nop 0
v_mfma_f32_16x16x32_bf16 v[192:195], a[36:39], v[68:71], v[192:195]
ds_read_b64_tr_b16 a[186:187], v183 offset:8712
v_mfma_f32_16x16x32_bf16 v[192:195], a[40:43], v[72:75], v[192:195]
ds_read_b64_tr_b16 a[188:189], v183 offset:12296
v_cvt_pk_bf16_f32 v33, v200, v201
v_mfma_f32_16x16x32_bf16 v[192:195], a[44:47], v[76:79], v[192:195]
ds_read_b64_tr_b16 a[190:191], v183 offset:12808
v_cvt_pk_bf16_f32 v35, v202, v203
v_mfma_f32_16x16x32_bf16 v[200:203], a[60:63], v[76:79], 0
ds_read_b64_tr_b16 a[160:161], v183 offset:0
s_nop 0
v_mfma_f32_16x16x32_bf16 v[200:203], a[52:55], v[68:71], v[200:203]
ds_read_b64_tr_b16 a[162:163], v183 offset:512
v_mfma_f32_16x16x32_bf16 v[200:203], a[48:51], v[64:67], v[200:203]
ds_read_b64_tr_b16 a[164:165], v183 offset:4096
v_cvt_pk_bf16_f32 v36, v192, v193
v_mfma_f32_16x16x32_bf16 v[200:203], a[56:59], v[72:75], v[200:203]
ds_read_b64_tr_b16 a[166:167], v183 offset:4608
v_cvt_pk_bf16_f32 v38, v194, v195
v_mfma_f32_16x16x32_bf16 v[192:195], a[120:123], v[72:75], 0
ds_read_b64_tr_b16 a[168:169], v183 offset:8192
s_nop 0
v_mfma_f32_16x16x32_bf16 v[192:195], a[124:127], v[76:79], v[192:195]
s_waitcnt lgkmcnt(12)
ds_read_b64_tr_b16 a[170:171], v183 offset:8704
v_cvt_pk_bf16_f32 v37, v200, v201
v_mfma_f32_16x16x32_bf16 v[192:195], a[116:119], v[68:71], v[192:195]
s_waitcnt lgkmcnt(12)
ds_read_b64_tr_b16 a[172:173], v183 offset:12288
v_cvt_pk_bf16_f32 v39, v202, v203
v_mfma_f32_16x16x32_bf16 v[192:195], a[112:115], v[64:67], v[192:195]
s_waitcnt lgkmcnt(12)
ds_read_b64_tr_b16 a[174:175], v183 offset:12800
s_nop 0
v_mfma_f32_16x16x32_bf16 v[200:203], a[96:99], v[64:67], 0
s_waitcnt lgkmcnt(12)
ds_read_b64_tr_b16 a[144:145], v182 offset:8
s_nop 0
v_mfma_f32_16x16x32_bf16 v[200:203], a[100:103], v[68:71], v[200:203]
s_waitcnt lgkmcnt(12)
ds_read_b64_tr_b16 a[146:147], v182 offset:520
v_cvt_pk_bf16_f32 v29, v192, v193
v_mfma_f32_16x16x32_bf16 v[200:203], a[104:107], v[72:75], v[200:203]
s_waitcnt lgkmcnt(12)
ds_read_b64_tr_b16 a[148:149], v182 offset:4104
v_cvt_pk_bf16_f32 v31, v194, v195
v_mfma_f32_16x16x32_bf16 v[200:203], a[108:111], v[76:79], v[200:203]
s_waitcnt lgkmcnt(12)
ds_read_b64_tr_b16 a[150:151], v182 offset:4616
s_nop 0
v_mfma_f32_16x16x32_bf16 v[192:195], a[92:95], v[76:79], 0
s_waitcnt lgkmcnt(12)
ds_read_b64_tr_b16 a[152:153], v182 offset:8200
s_nop 0
v_mfma_f32_16x16x32_bf16 v[192:195], a[88:91], v[72:75], v[192:195]
s_waitcnt lgkmcnt(12)
ds_read_b64_tr_b16 a[154:155], v182 offset:8712
v_cvt_pk_bf16_f32 v28, v200, v201
v_mfma_f32_16x16x32_bf16 v[192:195], a[84:87], v[68:71], v[192:195]
s_waitcnt lgkmcnt(12)
ds_read_b64_tr_b16 a[156:157], v182 offset:12296
v_cvt_pk_bf16_f32 v30, v202, v203
v_mfma_f32_16x16x32_bf16 v[192:195], a[80:83], v[64:67], v[192:195]
s_waitcnt lgkmcnt(12)
ds_read_b64_tr_b16 a[158:159], v182 offset:12808
s_nop 0
v_mfma_f32_16x16x32_bf16 v[200:203], a[64:67], v[64:67], 0
s_waitcnt lgkmcnt(12)
ds_read_b64_tr_b16 a[128:129], v182 offset:0
s_nop 0
v_mfma_f32_16x16x32_bf16 v[200:203], a[68:71], v[68:71], v[200:203]
s_waitcnt lgkmcnt(12)
ds_read_b64_tr_b16 a[130:131], v182 offset:512
v_cvt_pk_bf16_f32 v25, v192, v193
v_mfma_f32_16x16x32_bf16 v[200:203], a[72:75], v[72:75], v[200:203]
s_waitcnt lgkmcnt(12)
ds_read_b64_tr_b16 a[132:133], v182 offset:4096
v_cvt_pk_bf16_f32 v27, v194, v195
v_mfma_f32_16x16x32_bf16 v[200:203], a[76:79], v[76:79], v[200:203]
s_waitcnt lgkmcnt(12)
ds_read_b64_tr_b16 a[134:135], v182 offset:4608
s_nop 0
v_mfma_f32_16x16x32_bf16 v[192:195], v[76:79], a[188:191], 0
s_waitcnt lgkmcnt(12)
ds_read_b64_tr_b16 a[136:137], v182 offset:8192
s_nop 0
v_mfma_f32_16x16x32_bf16 v[192:195], v[72:75], a[184:187], v[192:195]
s_waitcnt lgkmcnt(12)
ds_read_b64_tr_b16 a[138:139], v182 offset:8704
v_cvt_pk_bf16_f32 v24, v200, v201
v_mfma_f32_16x16x32_bf16 v[192:195], v[68:71], a[180:183], v[192:195]
s_waitcnt lgkmcnt(12)
ds_read_b64_tr_b16 a[140:141], v182 offset:12288
v_cvt_pk_bf16_f32 v26, v202, v203
v_mfma_f32_16x16x32_bf16 v[192:195], v[64:67], a[176:179], v[192:195]
s_waitcnt lgkmcnt(12)
ds_read_b64_tr_b16 a[142:143], v182 offset:12800
s_nop 0
v_mfma_f32_16x16x32_bf16 v[200:203], v[64:67], a[160:163], 0
s_waitcnt lgkmcnt(12)
ds_write_b64 v165, v[150:151] offset:576
v_mfma_f32_16x16x32_bf16 v[200:203], v[68:71], a[164:167], v[200:203]
s_waitcnt lgkmcnt(12)
ds_write_b64 v164, v[32:33] offset:7424
v_mfma_f32_16x16x32_bf16 v[200:203], v[72:75], a[168:171], v[200:203]
s_waitcnt lgkmcnt(12)
ds_write_b64 v164, v[34:35] offset:7488
v_mfma_f32_16x16x32_bf16 v[200:203], v[76:79], a[172:175], v[200:203]
s_waitcnt lgkmcnt(11)
ds_write_b64 v165, v[36:37] offset:7424
v_mfma_f32_16x16x32_bf16 v[204:207], v[24:27], v[32:35], 0
s_waitcnt lgkmcnt(11)
ds_write_b64 v165, v[38:39] offset:7488
v_mfma_f32_16x16x32_bf16 v[204:207], v[28:31], v[36:39], v[204:207]
s_waitcnt lgkmcnt(11)
ds_write_b64 v164, v[24:25] offset:6912
v_mfma_f32_16x16x32_bf16 v[208:211], v[76:79], a[156:159], 0
s_waitcnt lgkmcnt(11)
ds_write_b64 v164, v[26:27] offset:6976
v_mfma_f32_16x16x32_bf16 v[208:211], v[72:75], a[152:155], v[208:211]
s_waitcnt lgkmcnt(10)
ds_write_b64 v165, v[28:29] offset:6912
v_mfma_f32_16x16x32_bf16 v[208:211], v[68:71], a[148:151], v[208:211]
s_waitcnt lgkmcnt(10)
ds_write_b64 v165, v[30:31] offset:6976
v_mfma_f32_16x16x32_bf16 v[208:211], v[64:67], a[144:147], v[208:211]
s_waitcnt lgkmcnt(10)
v_cvt_pk_bf16_f32 v14, v192, v193
v_cvt_pk_bf16_f32 v15, v194, v195
v_mfma_f32_16x16x32_bf16 v[192:195], v[64:67], a[128:131], 0
s_waitcnt lgkmcnt(9)
buffer_load_dwordx4 v243, s[16:19], s99 offen offset:0 nt lds
v_mfma_f32_16x16x32_bf16 v[192:195], v[72:75], a[136:139], v[192:195]
s_add_u32 s99, s55, 16384
buffer_load_dwordx4 v243, s[16:19], s100 offen offset:2112 nt lds
v_mfma_f32_16x16x32_bf16 v[192:195], v[76:79], a[140:143], v[192:195]
s_add_u32 m0, s49, 16896
s_add_u32 s100, s55, 16320
v_cvt_pk_bf16_f32 v12, v200, v201
v_mfma_f32_16x16x32_bf16 v[192:195], v[68:71], a[132:135], v[192:195]
ds_write_b64 v181, v[14:15] offset:7296
v_mfma_f32_16x16x32_bf16 v[216:219], v[52:55], a[132:135], 0
v_cvt_pk_bf16_f32 v13, v202, v203
v_cvt_pk_bf16_f32 v10, v208, v209
v_mfma_f32_16x16x32_bf16 v[216:219], v[48:51], a[128:131], v[216:219]
ds_write_b64 v181, v[12:13] offset:7168
v_mfma_f32_16x16x32_bf16 v[216:219], v[56:59], a[136:139], v[216:219]
s_nop 0
v_cvt_pk_bf16_f32 v8, v192, v193
v_cvt_pk_bf16_f32 v9, v194, v195
v_mfma_f32_16x16x32_bf16 v[216:219], v[60:63], a[140:143], v[216:219]
v_exp_f32 v196, v196
v_mfma_f32_16x16x32_bf16 v[200:203], v[60:63], a[156:159], 0
buffer_load_dwordx4 v243, s[16:19], s99 offen offset:0 nt lds
v_mfma_f32_16x16x32_bf16 v[200:203], v[56:59], a[152:155], v[200:203]
s_add_u32 s99, s57, 0
buffer_load_dwordx4 v243, s[16:19], s100 offen offset:2112 nt lds
v_mfma_f32_16x16x32_bf16 v[200:203], v[52:55], a[148:151], v[200:203]
s_add_u32 m0, s98, 59648
s_add_u32 s100, s57, 1024
v_cvt_pk_bf16_f32 v16, v216, v217
v_mfma_f32_16x16x32_bf16 v[200:203], v[48:51], a[144:147], v[200:203]
v_cvt_pk_bf16_f32 v17, v218, v219
v_cvt_pk_bf16_f32 v11, v210, v211
v_mfma_f32_16x16x32_bf16 v[192:195], v[48:51], a[160:163], 0
ds_write_b64 v181, v[10:11] offset:7040
v_mfma_f32_16x16x32_bf16 v[192:195], v[52:55], a[164:167], v[192:195]
ds_write_b64 v181, v[8:9] offset:6912
v_mfma_f32_16x16x32_bf16 v[192:195], v[56:59], a[168:171], v[192:195]
ds_read_b128 v[208:211], v242 offset:0
v_cvt_pk_bf16_f32 v18, v200, v201
v_mfma_f32_16x16x32_bf16 v[192:195], v[60:63], a[172:175], v[192:195]
ds_write_b64 v181, v[16:17] offset:0
v_mfma_f32_16x16x32_bf16 v[216:219], v[60:63], a[188:191], 0
v_mov_b64 v[220:221], s[96:97]
v_mov_b64 v[222:223], s[96:97]
v_mfma_f32_16x16x32_bf16 v[216:219], v[56:59], a[184:187], v[216:219]
v_mov_b64 v[228:229], s[96:97]
v_mov_b64 v[230:231], s[96:97]
v_mfma_f32_16x16x32_bf16 v[216:219], v[52:55], a[180:183], v[216:219]
v_exp_f32 v197, v197
v_mfma_f32_16x16x32_bf16 v[216:219], v[48:51], a[176:179], v[216:219]
v_add_f32 v160, v196, v197
v_cvt_pk_bf16_f32 v196, v196, v197
v_smfmac_f32_16x16x64_bf16 v[220:223], v[238:241], v[152:159], v251
ds_write_b32 v167, v196 offset:0
v_smfmac_f32_16x16x64_bf16 v[228:231], v[238:241], v[96:103], v251
s_mul_i32 s48, s43, 3168
s_add_u32 s49, s49, s48
s_add_u32 s49, s49, 50688
s_mov_b32 s48, 8192
v_cvt_pk_bf16_f32 v22, v216, v217
v_cvt_pk_bf16_f32 v23, v218, v219
v_mfma_f32_16x16x32_bf16 v[216:219], v[232:235], a[188:191], 0
v_exp_f32 v198, v198
v_mfma_f32_16x16x32_bf16 v[216:219], v[224:227], a[184:187], v[216:219]
v_exp_f32 v199, v199
v_mfma_f32_16x16x32_bf16 v[216:219], v[212:215], a[180:183], v[216:219]
v_cvt_pk_bf16_f32 v197, v198, v199
v_add_f32 v161, v198, v199
v_mfma_f32_16x16x32_bf16 v[216:219], v[188:191], a[176:179], v[216:219]
ds_write_b32 v167, v197 offset:4
v_add_f32 v198, v160, v161
v_cvt_pk_bf16_f32 v19, v202, v203
v_cvt_pk_bf16_f32 v20, v192, v193
v_cvt_pk_bf16_f32 v21, v194, v195
s_nop 2
v_cvt_pk_bf16_f32 v94, v216, v217
v_cvt_pk_bf16_f32 v95, v218, v219
v_mfma_f32_16x16x32_bf16 v[216:219], v[188:191], a[160:163], 0
s_waitcnt lgkmcnt(2)
ds_write_b32 v167, v198 offset:8
v_mfma_f32_16x16x32_bf16 v[216:219], v[212:215], a[164:167], v[216:219]
ds_read_b128 v[200:203], v242 offset:256
ds_read_b128 v[192:195], v242 offset:512
v_mfma_f32_16x16x32_bf16 v[216:219], v[224:227], a[168:171], v[216:219]
ds_write_b64 v181, v[18:19] offset:128
v_mfma_f32_16x16x32_bf16 v[216:219], v[232:235], a[172:175], v[216:219]
ds_write_b64 v181, v[20:21] offset:256
v_mfma_f32_16x16x32_bf16 v[196:199], v[232:235], a[156:159], 0
ds_write_b64 v181, v[22:23] offset:384
v_mfma_f32_16x16x32_bf16 v[196:199], v[224:227], a[152:155], v[196:199]
ds_read2_b32 v[236:237], v246 offset0:0 offset1:8
v_add_f32 v220, v220, v221
v_mfma_f32_16x16x32_bf16 v[196:199], v[212:215], a[148:151], v[196:199]
s_nop 0
v_cvt_pk_bf16_f32 v90, v216, v217
v_cvt_pk_bf16_f32 v91, v218, v219
v_mfma_f32_16x16x32_bf16 v[196:199], v[188:191], a[144:147], v[196:199]
v_add_f32 v222, v222, v223
v_add_f32 v228, v228, v229
v_mfma_f32_16x16x32_bf16 v[216:219], v[188:191], a[128:131], 0
v_exp_f32 v220, v220
v_mfma_f32_16x16x32_bf16 v[216:219], v[224:227], a[136:139], v[216:219]
v_exp_f32 v222, v222
v_mfma_f32_16x16x32_bf16 v[216:219], v[232:235], a[140:143], v[216:219]
s_waitcnt lgkmcnt(5)
v_cvt_pk_bf16_f32 v86, v196, v197
v_cvt_pk_bf16_f32 v87, v198, v199
v_mfma_f32_16x16x32_bf16 v[216:219], v[212:215], a[132:135], v[216:219]
v_perm_b32 v116, v222, v220, v252
v_perm_b32 v117, v222, v220, v253
v_mfma_f32_16x16x32_bf16 v[196:199], v[200:203], a[132:135], 0
s_waitcnt lgkmcnt(4)
ds_read_b128 v[220:223], v242 offset:768
v_add_f32 v230, v230, v231
v_mfma_f32_16x16x32_bf16 v[196:199], v[208:211], a[128:131], v[196:199]
v_exp_f32 v204, v204
v_mfma_f32_16x16x32_bf16 v[196:199], v[192:195], a[136:139], v[196:199]
s_waitcnt vmcnt(4)
s_barrier
ds_read_b128 v[188:191], v242 offset:4224
v_exp_f32 v205, v205
v_exp_f32 v206, v206
v_add_f32 v160, v204, v205
v_cvt_pk_bf16_f32 v204, v204, v205
s_waitcnt lgkmcnt(1)
v_mfma_f32_16x16x32_bf16 v[196:199], v[220:223], a[140:143], v[196:199]
ds_write_b32 v167, v204 offset:256
v_exp_f32 v207, v207
s_nop 0
v_cvt_pk_bf16_f32 v205, v206, v207
v_add_f32 v161, v206, v207
v_add_f32 v206, v160, v161
ds_write_b32 v167, v205 offset:260
ds_write_b32 v167, v206 offset:264
v_cvt_pk_bf16_f32 v48, v196, v197
v_cvt_pk_bf16_f32 v49, v198, v199
v_mfma_f32_16x16x32_bf16 v[204:207], v[220:223], a[156:159], 0
ds_read_b128 v[212:215], v242 offset:4480
ds_read_b128 v[224:227], v242 offset:4736
v_mfma_f32_16x16x32_bf16 v[204:207], v[192:195], a[152:155], v[204:207]
ds_read_b128 v[232:235], v242 offset:4992
v_cvt_pk_bf16_f32 v82, v216, v217
v_mfma_f32_16x16x32_bf16 v[204:207], v[200:203], a[148:151], v[204:207]
v_cvt_pk_bf16_f32 v83, v218, v219
v_mfma_f32_16x16x32_bf16 v[204:207], v[208:211], a[144:147], v[204:207]
v_exp_f32 v228, v228
v_mfma_f32_16x16x32_bf16 v[196:199], v[208:211], a[160:163], 0
buffer_load_dwordx4 v174, s[36:39], s99 offen offset:0 lds
v_mfma_f32_16x16x32_bf16 v[196:199], v[200:203], a[164:167], v[196:199]
s_add_u32 s99, s57, 2048
buffer_load_dwordx4 v174, s[36:39], s100 offen offset:1024 lds
v_mfma_f32_16x16x32_bf16 v[196:199], v[192:195], a[168:171], v[196:199]
s_waitcnt lgkmcnt(6)
s_add_u32 s100, s57, 3072
v_cvt_pk_bf16_f32 v52, v204, v205
v_mfma_f32_16x16x32_bf16 v[196:199], v[220:223], a[172:175], v[196:199]
L_h1:
s_cbranch_execz L_h5
v_cvt_pk_bf16_f32 v53, v206, v207
s_nop 0
v_mfma_f32_16x16x32_bf16 v[204:207], v[220:223], a[188:191], 0
v_exp_f32 v230, v230
v_mfma_f32_16x16x32_bf16 v[204:207], v[192:195], a[184:187], v[204:207]
v_perm_b32 v132, v230, v228, v252
v_perm_b32 v133, v230, v228, v253
v_mfma_f32_16x16x32_bf16 v[204:207], v[200:203], a[180:183], v[204:207]
v_cvt_pk_bf16_f32 v56, v196, v197
v_cvt_pk_bf16_f32 v57, v198, v199
v_mfma_f32_16x16x32_bf16 v[204:207], v[208:211], a[176:179], v[204:207]
s_waitcnt lgkmcnt(2)
s_nop 1
v_mfma_f32_16x16x32_bf16 v[192:195], a[64:67], v[188:191], 0
s_waitcnt lgkmcnt(1)
s_nop 1
v_mfma_f32_16x16x32_bf16 v[192:195], a[68:71], v[212:215], v[192:195]
s_waitcnt lgkmcnt(0)
v_cvt_pk_bf16_f32 v60, v204, v205
v_cvt_pk_bf16_f32 v61, v206, v207
v_mfma_f32_16x16x32_bf16 v[192:195], a[72:75], v[224:227], v[192:195]
buffer_load_dwordx4 v174, s[36:39], s99 offen offset:2048 lds
v_mfma_f32_16x16x32_bf16 v[192:195], a[76:79], v[232:235], v[192:195]
s_add_u32 s99, s57, 8192
buffer_load_dwordx4 v174, s[36:39], s100 offen offset:3072 lds
v_mfma_f32_16x16x32_bf16 v[196:199], a[92:95], v[232:235], 0
s_add_u32 m0, s98, 63744
s_add_u32 s100, s57, 9216
s_mov_b32 s98, s50
v_mfma_f32_16x16x32_bf16 v[196:199], a[88:91], v[224:227], v[196:199]
s_nop 0
v_cvt_pk_bf16_f32 v8, v192, v193
v_cvt_pk_bf16_f32 v9, v194, v195
v_mfma_f32_16x16x32_bf16 v[196:199], a[84:87], v[212:215], v[196:199]
v_mfma_f32_16x16x32_bf16 v[196:199], a[80:83], v[188:191], v[196:199]
s_nop 2
v_mfma_f32_16x16x32_bf16 v[192:195], a[96:99], v[188:191], 0
s_nop 2
v_mfma_f32_16x16x32_bf16 v[192:195], a[100:103], v[212:215], v[192:195]
v_cvt_pk_bf16_f32 v10, v196, v197
v_cvt_pk_bf16_f32 v11, v198, v199
v_mfma_f32_16x16x32_bf16 v[192:195], a[104:107], v[224:227], v[192:195]
v_mfma_f32_16x16x32_bf16 v[192:195], a[108:111], v[232:235], v[192:195]
s_nop 2
v_mfma_f32_16x16x32_bf16 v[196:199], a[124:127], v[232:235], 0
buffer_load_dwordx4 v174, s[36:39], s99 offen offset:0 lds
v_mfma_f32_16x16x32_bf16 v[196:199], a[120:123], v[224:227], v[196:199]
s_add_u32 s99, s57, 10240
buffer_load_dwordx4 v174, s[36:39], s100 offen offset:1024 lds
v_mfma_f32_16x16x32_bf16 v[196:199], a[116:119], v[212:215], v[196:199]
s_add_u32 s100, s57, 11264
v_cvt_pk_bf16_f32 v12, v192, v193
v_cvt_pk_bf16_f32 v13, v194, v195
v_mfma_f32_16x16x32_bf16 v[196:199], a[112:115], v[188:191], v[196:199]
s_nop 2
v_mfma_f32_16x16x32_bf16 v[192:195], v[188:191], a[128:131], 0
s_nop 2
v_mfma_f32_16x16x32_bf16 v[192:195], v[212:215], a[132:135], v[192:195]
v_cvt_pk_bf16_f32 v14, v196, v197
v_cvt_pk_bf16_f32 v15, v198, v199
v_mfma_f32_16x16x32_bf16 v[192:195], v[224:227], a[136:139], v[192:195]
v_mfma_f32_16x16x32_bf16 v[192:195], v[232:235], a[140:143], v[192:195]
s_nop 2
v_mfma_f32_16x16x32_bf16 v[196:199], v[12:15], v[156:159], 0
s_nop 2
v_mfma_f32_16x16x32_bf16 v[196:199], v[8:11], v[152:155], v[196:199]
v_cvt_pk_bf16_f32 v50, v192, v193
v_cvt_pk_bf16_f32 v51, v194, v195
v_mfma_f32_16x16x32_bf16 v[192:195], v[8:11], v[96:99], 0
buffer_load_dwordx4 v174, s[36:39], s99 offen offset:2048 lds
v_mfma_f32_16x16x32_bf16 v[192:195], v[12:15], v[100:103], v[192:195]
s_add_u32 s99, s98, s51
buffer_load_dwordx4 v174, s[36:39], s100 offen offset:3072 lds
v_mfma_f32_16x16x32_bf16 v[200:203], v[232:235], a[156:159], 0
s_add_u32 s100, s99, s51
ds_read_b128 v[204:207], v242 offset:8448
ds_read_b128 v[208:211], v242 offset:8704
v_mfma_f32_16x16x32_bf16 v[200:203], v[224:227], a[152:155], v[200:203]
s_add_u32 m0, s49, 0
ds_read_b128 v[216:219], v242 offset:8960
ds_read_b128 v[220:223], v242 offset:9216
v_mfma_f32_16x16x32_bf16 v[200:203], v[212:215], a[148:151], v[200:203]
s_add_u32 s101, s100, s51
v_exp_f32 v196, v196
v_mfma_f32_16x16x32_bf16 v[200:203], v[188:191], a[144:147], v[200:203]
v_exp_f32 v197, v197
v_mfma_f32_16x16x32_bf16 v[228:231], v[188:191], a[160:163], 0
v_exp_f32 v198, v198
v_mfma_f32_16x16x32_bf16 v[228:231], v[212:215], a[164:167], v[228:231]
v_exp_f32 v199, v199
v_mfma_f32_16x16x32_bf16 v[228:231], v[224:227], a[168:171], v[228:231]
v_cvt_pk_bf16_f32 v106, v196, v197
v_cvt_pk_bf16_f32 v107, v198, v199
v_mfma_f32_16x16x32_bf16 v[228:231], v[232:235], a[172:175], v[228:231]
v_cvt_pk_bf16_f32 v54, v200, v201
v_cvt_pk_bf16_f32 v55, v202, v203
v_mfma_f32_16x16x32_bf16 v[196:199], v[232:235], a[188:191], 0
v_exp_f32 v192, v192
v_mfma_f32_16x16x32_bf16 v[196:199], v[224:227], a[184:187], v[196:199]
v_exp_f32 v193, v193
v_mfma_f32_16x16x32_bf16 v[196:199], v[212:215], a[180:183], v[196:199]
s_waitcnt lgkmcnt(3)
v_exp_f32 v194, v194
v_mfma_f32_16x16x32_bf16 v[196:199], v[188:191], a[176:179], v[196:199]
s_waitcnt lgkmcnt(2)
v_exp_f32 v195, v195
v_mfma_f32_16x16x32_bf16 v[200:203], a[64:67], v[204:207], 0
s_waitcnt lgkmcnt(1)
v_cvt_pk_bf16_f32 v122, v192, v193
v_cvt_pk_bf16_f32 v123, v194, v195
v_mfma_f32_16x16x32_bf16 v[200:203], a[68:71], v[208:211], v[200:203]
s_waitcnt lgkmcnt(0)
v_cvt_pk_bf16_f32 v62, v196, v197
v_cvt_pk_bf16_f32 v63, v198, v199
v_mfma_f32_16x16x32_bf16 v[200:203], a[72:75], v[216:219], v[200:203]
v_cvt_pk_bf16_f32 v58, v228, v229
v_cvt_pk_bf16_f32 v59, v230, v231
v_mfma_f32_16x16x32_bf16 v[200:203], a[76:79], v[220:223], v[200:203]
s_nop 2
v_mfma_f32_16x16x32_bf16 v[192:195], a[92:95], v[220:223], 0
s_nop 2
v_mfma_f32_16x16x32_bf16 v[192:195], a[88:91], v[216:219], v[192:195]
v_cvt_pk_bf16_f32 v16, v200, v201
v_cvt_pk_bf16_f32 v17, v202, v203
v_mfma_f32_16x16x32_bf16 v[192:195], a[84:87], v[208:211], v[192:195]
v_mfma_f32_16x16x32_bf16 v[192:195], a[80:83], v[204:207], v[192:195]
s_nop 2
v_mfma_f32_16x16x32_bf16 v[196:199], a[96:99], v[204:207], 0
s_nop 2
v_mfma_f32_16x16x32_bf16 v[196:199], a[100:103], v[208:211], v[196:199]
v_cvt_pk_bf16_f32 v18, v192, v193
v_cvt_pk_bf16_f32 v19, v194, v195
v_mfma_f32_16x16x32_bf16 v[196:199], a[104:107], v[216:219], v[196:199]
v_mfma_f32_16x16x32_bf16 v[196:199], a[108:111], v[220:223], v[196:199]
s_nop 2
v_mfma_f32_16x16x32_bf16 v[192:195], a[124:127], v[220:223], 0
s_nop 2
v_mfma_f32_16x16x32_bf16 v[192:195], a[120:123], v[216:219], v[192:195]
v_cvt_pk_bf16_f32 v20, v196, v197
v_cvt_pk_bf16_f32 v21, v198, v199
v_mfma_f32_16x16x32_bf16 v[192:195], a[116:119], v[208:211], v[192:195]
v_mfma_f32_16x16x32_bf16 v[192:195], a[112:115], v[204:207], v[192:195]
s_nop 2
v_mfma_f32_16x16x32_bf16 v[196:199], v[204:207], a[128:131], 0
s_nop 2
v_mfma_f32_16x16x32_bf16 v[196:199], v[208:211], a[132:135], v[196:199]
v_cvt_pk_bf16_f32 v22, v192, v193
v_cvt_pk_bf16_f32 v23, v194, v195
v_mfma_f32_16x16x32_bf16 v[196:199], v[216:219], a[136:139], v[196:199]
v_mfma_f32_16x16x32_bf16 v[196:199], v[220:223], a[140:143], v[196:199]
s_nop 2
v_mfma_f32_16x16x32_bf16 v[192:195], v[20:23], v[156:159], 0
s_nop 2
v_mfma_f32_16x16x32_bf16 v[192:195], v[16:19], v[152:155], v[192:195]
v_cvt_pk_bf16_f32 v64, v196, v197
v_cvt_pk_bf16_f32 v65, v198, v199
v_mfma_f32_16x16x32_bf16 v[196:199], v[16:19], v[96:99], 0
s_nop 2
v_mfma_f32_16x16x32_bf16 v[196:199], v[20:23], v[100:103], v[196:199]
s_nop 0
v_exp_f32 v192, v192
v_mfma_f32_16x16x32_bf16 v[200:203], v[220:223], a[156:159], 0
v_exp_f32 v193, v193
v_mfma_f32_16x16x32_bf16 v[200:203], v[216:219], a[152:155], v[200:203]
v_exp_f32 v194, v194
v_mfma_f32_16x16x32_bf16 v[200:203], v[208:211], a[148:151], v[200:203]
v_exp_f32 v195, v195
v_mfma_f32_16x16x32_bf16 v[200:203], v[204:207], a[144:147], v[200:203]
s_waitcnt vmcnt(0)
s_barrier
v_mfma_f32_16x16x32_bf16 v[228:231], v[204:207], a[160:163], 0
ds_read_b128 v[188:191], v242 offset:16896
v_cvt_pk_bf16_f32 v108, v192, v193
v_mfma_f32_16x16x32_bf16 v[228:231], v[208:211], a[164:167], v[228:231]
ds_read_b128 v[212:215], v242 offset:17152
v_cvt_pk_bf16_f32 v109, v194, v195
v_mfma_f32_16x16x32_bf16 v[228:231], v[216:219], a[168:171], v[228:231]
ds_read_b128 v[224:227], v242 offset:17408
v_cvt_pk_bf16_f32 v68, v200, v201
v_mfma_f32_16x16x32_bf16 v[228:231], v[220:223], a[172:175], v[228:231]
ds_read_b128 v[232:235], v242 offset:17664
v_cvt_pk_bf16_f32 v69, v202, v203
v_mfma_f32_16x16x32_bf16 v[192:195], v[220:223], a[188:191], 0
ds_read_b64_tr_b16 a[192:193], v182 offset:0
s_nop 0
v_mfma_f32_16x16x32_bf16 v[192:195], v[216:219], a[184:187], v[192:195]
ds_read_b64_tr_b16 a[194:195], v182 offset:512
v_mfma_f32_16x16x32_bf16 v[192:195], v[208:211], a[180:183], v[192:195]
s_waitcnt lgkmcnt(5)
ds_read_b64_tr_b16 a[196:197], v182 offset:4096
v_cvt_pk_bf16_f32 v72, v228, v229
v_mfma_f32_16x16x32_bf16 v[192:195], v[204:207], a[176:179], v[192:195]
buffer_load_dwordx4 v243, s[16:19], s98 offen offset:0 nt lds
v_mfma_f32_16x16x32_bf16 v[200:203], a[64:67], v[188:191], 0
s_waitcnt lgkmcnt(4)
ds_read_b64_tr_b16 a[198:199], v182 offset:4608
v_cvt_pk_bf16_f32 v73, v230, v231
v_mfma_f32_16x16x32_bf16 v[200:203], a[68:71], v[212:215], v[200:203]
s_waitcnt lgkmcnt(4)
ds_read_b64_tr_b16 a[200:201], v182 offset:8192
v_cvt_pk_bf16_f32 v76, v192, v193
v_mfma_f32_16x16x32_bf16 v[200:203], a[72:75], v[224:227], v[200:203]
ds_read_b64_tr_b16 a[202:203], v182 offset:8704
v_cvt_pk_bf16_f32 v77, v194, v195
v_mfma_f32_16x16x32_bf16 v[200:203], a[76:79], v[232:235], v[200:203]
ds_read_b64_tr_b16 a[204:205], v182 offset:12288
s_nop 0
v_mfma_f32_16x16x32_bf16 v[192:195], a[92:95], v[232:235], 0
ds_read_b64_tr_b16 a[206:207], v182 offset:12800
s_nop 0
v_mfma_f32_16x16x32_bf16 v[192:195], a[88:91], v[224:227], v[192:195]
ds_read_b64_tr_b16 a[208:209], v182 offset:8
v_mfma_f32_16x16x32_bf16 v[192:195], a[84:87], v[212:215], v[192:195]
ds_read_b64_tr_b16 a[210:211], v182 offset:520
v_cvt_pk_bf16_f32 v32, v200, v201
v_mfma_f32_16x16x32_bf16 v[192:195], a[80:83], v[188:191], v[192:195]
buffer_load_dwordx4 v243, s[16:19], s99 offen offset:1056 nt lds
v_mfma_f32_16x16x32_bf16 v[204:207], a[96:99], v[188:191], 0
ds_read_b64_tr_b16 a[212:213], v182 offset:4104
v_cvt_pk_bf16_f32 v33, v202, v203
v_mfma_f32_16x16x32_bf16 v[204:207], a[100:103], v[212:215], v[204:207]
s_waitcnt lgkmcnt(10)
ds_read_b64_tr_b16 a[214:215], v182 offset:4616
v_mfma_f32_16x16x32_bf16 v[204:207], a[104:107], v[224:227], v[204:207]
s_waitcnt lgkmcnt(10)
ds_read_b64_tr_b16 a[216:217], v182 offset:8200
v_cvt_pk_bf16_f32 v34, v192, v193
v_mfma_f32_16x16x32_bf16 v[204:207], a[108:111], v[232:235], v[204:207]
s_waitcnt lgkmcnt(10)
ds_read_b64_tr_b16 a[218:219], v182 offset:8712
v_cvt_pk_bf16_f32 v35, v194, v195
v_mfma_f32_16x16x32_bf16 v[192:195], a[124:127], v[232:235], 0
ds_read_b64_tr_b16 a[220:221], v182 offset:12296
s_nop 0
v_mfma_f32_16x16x32_bf16 v[192:195], a[120:123], v[224:227], v[192:195]
s_waitcnt lgkmcnt(11)
ds_read_b64_tr_b16 a[222:223], v182 offset:12808
v_cvt_pk_bf16_f32 v36, v204, v205
v_mfma_f32_16x16x32_bf16 v[192:195], a[116:119], v[212:215], v[192:195]
s_waitcnt lgkmcnt(11)
ds_read_b64_tr_b16 a[224:225], v183 offset:0
v_cvt_pk_bf16_f32 v37, v206, v207
v_mfma_f32_16x16x32_bf16 v[192:195], a[112:115], v[188:191], v[192:195]
buffer_load_dwordx4 v243, s[16:19], s100 offen offset:2112 nt lds
v_mfma_f32_16x16x32_bf16 v[200:203], v[188:191], a[128:131], 0
s_waitcnt lgkmcnt(10)
ds_read_b64_tr_b16 a[226:227], v183 offset:512
s_nop 0
v_mfma_f32_16x16x32_bf16 v[200:203], v[212:215], a[132:135], v[200:203]
s_waitcnt lgkmcnt(10)
ds_read_b64_tr_b16 a[228:229], v183 offset:4096
v_cvt_pk_bf16_f32 v38, v192, v193
v_mfma_f32_16x16x32_bf16 v[200:203], v[224:227], a[136:139], v[200:203]
s_waitcnt lgkmcnt(10)
ds_read_b64_tr_b16 a[230:231], v183 offset:4608
v_cvt_pk_bf16_f32 v39, v194, v195
v_mfma_f32_16x16x32_bf16 v[200:203], v[232:235], a[140:143], v[200:203]
s_waitcnt lgkmcnt(10)
ds_read_b64_tr_b16 a[232:233], v183 offset:8192
s_nop 0
v_mfma_f32_16x16x32_bf16 v[192:195], v[36:39], v[156:159], 0
ds_read_b64_tr_b16 a[234:235], v183 offset:8704
s_nop 0
v_mfma_f32_16x16x32_bf16 v[192:195], v[32:35], v[152:155], v[192:195]
s_waitcnt lgkmcnt(11)
ds_read_b64_tr_b16 a[236:237], v183 offset:12288
v_cvt_pk_bf16_f32 v80, v200, v201
v_mfma_f32_16x16x32_bf16 v[204:207], v[32:35], v[96:99], 0
s_waitcnt lgkmcnt(11)
ds_read_b64_tr_b16 a[238:239], v183 offset:12800
v_cvt_pk_bf16_f32 v81, v202, v203
v_mfma_f32_16x16x32_bf16 v[204:207], v[36:39], v[100:103], v[204:207]
s_waitcnt lgkmcnt(11)
ds_read_b64_tr_b16 a[240:241], v183 offset:8
s_nop 0
v_mfma_f32_16x16x32_bf16 v[200:203], v[232:235], a[156:159], 0
s_waitcnt lgkmcnt(11)
ds_read_b64_tr_b16 a[242:243], v183 offset:520
ds_read_b128 v[208:211], v242 offset:12672
v_mfma_f32_16x16x32_bf16 v[200:203], v[224:227], a[152:155], v[200:203]
s_waitcnt lgkmcnt(12)
ds_read_b128 v[216:219], v242 offset:12928
ds_read_b128 v[220:223], v242 offset:13184
v_mfma_f32_16x16x32_bf16 v[200:203], v[212:215], a[148:151], v[200:203]
s_waitcnt lgkmcnt(13)
v_exp_f32 v192, v192
v_mfma_f32_16x16x32_bf16 v[200:203], v[188:191], a[144:147], v[200:203]
buffer_load_dwordx4 v243, s[16:19], s101 offen offset:3168 nt lds
v_mfma_f32_16x16x32_bf16 v[228:231], v[188:191], a[160:163], 0
s_waitcnt lgkmcnt(12)
v_exp_f32 v193, v193
v_mfma_f32_16x16x32_bf16 v[228:231], v[212:215], a[164:167], v[228:231]
s_waitcnt lgkmcnt(11)
v_exp_f32 v194, v194
v_mfma_f32_16x16x32_bf16 v[228:231], v[224:227], a[168:171], v[228:231]
s_waitcnt lgkmcnt(10)
ds_read_b64_tr_b16 a[244:245], v183 offset:4104
v_cvt_pk_bf16_f32 v112, v192, v193
v_mfma_f32_16x16x32_bf16 v[228:231], v[232:235], a[172:175], v[228:231]
s_waitcnt lgkmcnt(10)
ds_read_b64_tr_b16 a[246:247], v183 offset:4616
v_exp_f32 v195, v195
s_nop 0
v_cvt_pk_bf16_f32 v113, v194, v195
v_mfma_f32_16x16x32_bf16 v[192:195], v[232:235], a[188:191], 0
s_waitcnt lgkmcnt(9)
ds_read_b64_tr_b16 a[248:249], v183 offset:8200
v_cvt_pk_bf16_f32 v88, v228, v229
v_mfma_f32_16x16x32_bf16 v[192:195], v[224:227], a[184:187], v[192:195]
s_waitcnt lgkmcnt(9)
ds_read_b64_tr_b16 a[250:251], v183 offset:8712
v_cvt_pk_bf16_f32 v89, v230, v231
v_mfma_f32_16x16x32_bf16 v[192:195], v[212:215], a[180:183], v[192:195]
s_waitcnt lgkmcnt(6)
ds_read_b64_tr_b16 a[252:253], v183 offset:12296
v_cvt_pk_bf16_f32 v84, v200, v201
v_mfma_f32_16x16x32_bf16 v[192:195], v[188:191], a[176:179], v[192:195]
s_waitcnt lgkmcnt(6)
ds_read_b64_tr_b16 a[254:255], v183 offset:12808
v_cvt_pk_bf16_f32 v85, v202, v203
v_mfma_f32_16x16x32_bf16 v[228:231], a[64:67], v[208:211], 0
s_waitcnt lgkmcnt(6)
ds_read_b128 v[200:203], v242 offset:13440
s_nop 0
v_mfma_f32_16x16x32_bf16 v[228:231], a[68:71], v[216:219], v[228:231]
v_cvt_pk_bf16_f32 v92, v192, v193
v_cvt_pk_bf16_f32 v93, v194, v195
v_mfma_f32_16x16x32_bf16 v[228:231], a[72:75], v[220:223], v[228:231]
v_exp_f32 v204, v204
v_exp_f32 v205, v205
v_exp_f32 v206, v206
v_exp_f32 v207, v207
v_cvt_pk_bf16_f32 v128, v204, v205
v_cvt_pk_bf16_f32 v129, v206, v207
v_exp_f32 v196, v196
s_waitcnt lgkmcnt(0)
v_mfma_f32_16x16x32_bf16 v[228:231], a[76:79], v[200:203], v[228:231]
s_barrier
v_mfma_f32_16x16x32_bf16 v[192:195], a[92:95], v[200:203], 0
s_add_u32 s98, s98, s48
v_exp_f32 v197, v197
v_mfma_f32_16x16x32_bf16 v[192:195], a[88:91], v[220:223], v[192:195]
s_add_u32 s99, s98, s51
v_exp_f32 v198, v198
v_mfma_f32_16x16x32_bf16 v[192:195], a[84:87], v[216:219], v[192:195]
s_add_u32 s100, s99, s51
s_add_u32 m0, s49, 8448
s_add_u32 s101, s100, s51
v_mfma_f32_16x16x32_bf16 v[192:195], a[80:83], v[208:211], v[192:195]
buffer_load_dwordx4 v243, s[16:19], s98 offen offset:0 nt lds
v_cvt_pk_bf16_f32 v24, v228, v229
v_cvt_pk_bf16_f32 v25, v230, v231
v_mfma_f32_16x16x32_bf16 v[228:231], a[96:99], v[208:211], 0
s_add_u32 s98, s98, s48
v_exp_f32 v199, v199
v_mfma_f32_16x16x32_bf16 v[228:231], a[100:103], v[216:219], v[228:231]
s_bfe_i32 s57, s3, 0x10000
v_cvt_pk_bf16_f32 v26, v192, v193
v_cvt_pk_bf16_f32 v27, v194, v195
v_mfma_f32_16x16x32_bf16 v[228:231], a[104:107], v[220:223], v[228:231]
s_and_b32 s54, s57, s5
v_cvt_pk_bf16_f32 v124, v196, v197
v_cvt_pk_bf16_f32 v125, v198, v199
v_mfma_f32_16x16x32_bf16 v[228:231], a[108:111], v[200:203], v[228:231]
s_add_u32 s50, s50, 13107200
ds_read_b128 v[196:199], v247 offset:0
v_add_u32 v245, 1728, v245
v_mfma_f32_16x16x32_bf16 v[192:195], a[124:127], v[200:203], 0
s_mov_b32 s47, s46
v_add_u32 v246, 1728, v246
v_add_u32 v247, 1728, v247
v_mfma_f32_16x16x32_bf16 v[192:195], a[120:123], v[220:223], v[192:195]
s_lshr_b32 s3, s3, 1
v_cvt_pk_bf16_f32 v28, v228, v229
v_cvt_pk_bf16_f32 v29, v230, v231
v_mfma_f32_16x16x32_bf16 v[192:195], a[116:119], v[216:219], v[192:195]
s_sub_u32 s45, s45, 1
s_sub_u32 s50, s50, s54
s_add_u32 s52, s46, 20480
v_mfma_f32_16x16x32_bf16 v[192:195], a[112:115], v[208:211], v[192:195]
buffer_load_dwordx4 v243, s[16:19], s99 offen offset:1056 nt lds
v_mfma_f32_16x16x32_bf16 v[204:207], v[208:211], a[128:131], 0
s_add_u32 s99, s98, s51
s_add_u32 s53, s46, 0
s_nop 0
v_mfma_f32_16x16x32_bf16 v[204:207], v[216:219], a[132:135], v[204:207]
s_nop 1
v_cvt_pk_bf16_f32 v30, v192, v193
v_mfma_f32_16x16x32_bf16 v[204:207], v[220:223], a[136:139], v[204:207]
v_cvt_pk_bf16_f32 v31, v194, v195
v_mfma_f32_16x16x32_bf16 v[204:207], v[200:203], a[140:143], v[204:207]
v_mov_b64 v[168:169], 0
v_mov_b64 v[170:171], 0
v_mfma_f32_16x16x32_bf16 v[192:195], v[28:31], v[156:159], 0
v_mov_b64 v[172:173], 0
v_mov_b64 v[174:175], 0
v_mfma_f32_16x16x32_bf16 v[192:195], v[24:27], v[152:155], v[192:195]
v_mov_b64 v[176:177], 0
s_nop 0
v_cvt_pk_bf16_f32 v66, v204, v205
v_cvt_pk_bf16_f32 v67, v206, v207
v_mfma_f32_16x16x32_bf16 v[204:207], v[24:27], v[96:99], 0
s_waitcnt lgkmcnt(0)
v_mov_b64 v[178:179], 0
v_mfma_f32_16x16x32_bf16 v[204:207], v[28:31], v[100:103], v[204:207]
ds_read_b128 v[152:155], v242 offset:21120
ds_read_b128 v[156:159], v242 offset:21376
v_smfmac_f32_16x16x64_bf16 v[168:171], v[196:199], v[0:7], v251
ds_read_b128 v[160:163], v242 offset:21632
ds_read_b128 v[164:167], v242 offset:21888
v_smfmac_f32_16x16x64_bf16 v[172:175], v[196:199], v[16:23], v251
s_nop 2
v_smfmac_f32_16x16x64_bf16 v[176:179], v[196:199], v[32:39], v251
s_nop 0
v_add_f32 v168, v168, v169
v_mfma_f32_16x16x32_bf16 v[228:231], v[200:203], a[156:159], 0
v_exp_f32 v192, v192
v_mfma_f32_16x16x32_bf16 v[228:231], v[220:223], a[152:155], v[228:231]
v_exp_f32 v193, v193
v_mfma_f32_16x16x32_bf16 v[228:231], v[216:219], a[148:151], v[228:231]
v_exp_f32 v194, v194
v_mfma_f32_16x16x32_bf16 v[228:231], v[208:211], a[144:147], v[228:231]
v_exp_f32 v195, v195
v_smfmac_f32_16x16x64_bf16 v[170:173], v[196:199], v[8:15], v251
v_cvt_pk_bf16_f32 v110, v192, v193
v_smfmac_f32_16x16x64_bf16 v[174:177], v[196:199], v[24:31], v251
v_cvt_pk_bf16_f32 v111, v194, v195
v_smfmac_f32_16x16x64_bf16 v[178:181], v[196:199], v[40:47], v251
s_nop 1
v_cvt_pk_bf16_f32 v70, v228, v229
v_mfma_f32_16x16x32_bf16 v[192:195], v[208:211], a[160:163], 0
v_cvt_pk_bf16_f32 v71, v230, v231
v_add_f32 v170, v170, v171
v_mfma_f32_16x16x32_bf16 v[192:195], v[216:219], a[164:167], v[192:195]
v_exp_f32 v204, v204
v_mfma_f32_16x16x32_bf16 v[192:195], v[220:223], a[168:171], v[192:195]
s_waitcnt lgkmcnt(2)
v_exp_f32 v205, v205
v_mfma_f32_16x16x32_bf16 v[192:195], v[200:203], a[172:175], v[192:195]
buffer_load_dwordx4 v243, s[16:19], s100 offen offset:2112 nt lds
v_mfma_f32_16x16x32_bf16 v[196:199], v[200:203], a[188:191], 0
s_waitcnt lgkmcnt(0)
ds_read_b128 v[200:203], v242 offset:0
v_mov_b64 v[228:229], 0
v_mfma_f32_16x16x32_bf16 v[196:199], v[220:223], a[184:187], v[196:199]
s_add_u32 s100, s99, s51
ds_read_b128 v[220:223], v242 offset:256
v_cvt_pk_bf16_f32 v74, v192, v193
v_mfma_f32_16x16x32_bf16 v[196:199], v[216:219], a[180:183], v[196:199]
ds_read_b128 v[216:219], v242 offset:512
v_cvt_pk_bf16_f32 v75, v194, v195
v_mfma_f32_16x16x32_bf16 v[196:199], v[208:211], a[176:179], v[196:199]
ds_read_b128 v[192:195], v242 offset:768
v_cvt_pk_bf16_f32 v126, v204, v205
v_smfmac_f32_16x16x64_bf16 v[228:231], v[184:187], v[104:111], v251
v_add_f32 v172, v172, v173
v_smfmac_f32_16x16x64_bf16 v[228:231], v[184:187], v[112:119], v251 abid:1
v_add_f32 v174, v174, v175
v_mfma_f32_16x16x32_bf16 v[136:139], a[192:195], v[152:155], 0
v_exp_f32 v168, v168
v_mfma_f32_16x16x32_bf16 v[136:139], a[196:199], v[156:159], v[136:139]
v_exp_f32 v170, v170
v_mfma_f32_16x16x32_bf16 v[136:139], a[200:203], v[160:163], v[136:139]
v_exp_f32 v172, v172
v_mfma_f32_16x16x32_bf16 v[136:139], a[204:207], v[164:167], v[136:139]
buffer_load_dwordx4 v243, s[16:19], s101 offen offset:3168 nt lds
v_mfma_f32_16x16x32_bf16 v[140:143], a[220:223], v[164:167], 0
s_add_u32 m0, s49, 16896
v_exp_f32 v174, v174
v_mfma_f32_16x16x32_bf16 v[140:143], a[216:219], v[160:163], v[140:143]
s_add_u32 s101, s100, s51
v_add_f32 v176, v176, v177
v_add_f32 v178, v178, v179
v_mfma_f32_16x16x32_bf16 v[140:143], a[212:215], v[156:159], v[140:143]
s_and_b32 s51, s57, 13106176
v_exp_f32 v176, v176
v_mfma_f32_16x16x32_bf16 v[140:143], a[208:211], v[152:155], v[140:143]
s_waitcnt lgkmcnt(3)
v_add_f32 v180, v168, v170
v_cvt_pk_bf16_f32 v169, v168, v170
v_mfma_f32_16x16x32_bf16 v[144:147], a[224:227], v[152:155], 0
s_waitcnt lgkmcnt(2)
ds_write_b16 v248, v169 offset:0
v_mfma_f32_16x16x32_bf16 v[144:147], a[228:231], v[156:159], v[144:147]
s_waitcnt lgkmcnt(2)
ds_write_b16_d16_hi v248, v169 offset:4
v_mfma_f32_16x16x32_bf16 v[144:147], a[232:235], v[160:163], v[144:147]
s_waitcnt lgkmcnt(2)
v_exp_f32 v178, v178
v_mfma_f32_16x16x32_bf16 v[144:147], a[236:239], v[164:167], v[144:147]
buffer_load_dwordx4 v243, s[16:19], s98 offen offset:0 nt lds
v_mfma_f32_16x16x32_bf16 v[148:151], a[252:255], v[164:167], 0
s_lshl3_add_u32 s48, s51, 8192
v_add_f32 v180, v180, v172
v_add_f32 v180, v180, v174
v_mfma_f32_16x16x32_bf16 v[148:151], a[244:247], v[156:159], v[148:151]
s_sub_u32 s49, s49, s56
v_add_f32 v180, v180, v176
v_add_f32 v180, v180, v178
v_mfma_f32_16x16x32_bf16 v[148:151], a[240:243], v[152:155], v[148:151]
s_sub_u32 s51, s51, 32
v_cvt_pk_bf16_f32 v173, v172, v174
v_add_f32_dpp v180, v180, v180 row_ror:8 row_mask:0xf bank_mask:0xf
v_mfma_f32_16x16x32_bf16 v[148:151], a[248:251], v[160:163], v[148:151]
ds_write_b16 v248, v173 offset:272
v_mfma_f32_16x16x32_bf16 v[164:167], a[248:251], v[216:219], 0
ds_write_b16_d16_hi v248, v173 offset:276
v_mfma_f32_16x16x32_bf16 v[164:167], a[252:255], v[192:195], v[164:167]
v_cvt_pk_bf16_f32 v177, v176, v178
v_add_f32_dpp v180, v180, v180 row_ror:4 row_mask:0xf bank_mask:0xf
v_mfma_f32_16x16x32_bf16 v[164:167], a[244:247], v[220:223], v[164:167]
ds_write_b16 v248, v177 offset:544
v_mfma_f32_16x16x32_bf16 v[164:167], a[240:243], v[200:203], v[164:167]
buffer_load_dwordx4 v243, s[16:19], s99 offen offset:1056 nt lds
v_mfma_f32_16x16x32_bf16 v[160:163], a[224:227], v[200:203], 0
ds_write_b32 v250, v180 offset:256
v_mfma_f32_16x16x32_bf16 v[160:163], a[228:231], v[220:223], v[160:163]
ds_write_b16_d16_hi v248, v177 offset:548
v_mfma_f32_16x16x32_bf16 v[160:163], a[232:235], v[216:219], v[160:163]
ds_read_b128 v[208:211], v249 offset:0
v_add_f32 v228, v228, v229
v_mfma_f32_16x16x32_bf16 v[160:163], a[236:239], v[192:195], v[160:163]
v_exp_f32 v206, v206
v_mfma_f32_32x32x16_bf16 v[168:183], v[236:239], v[116:119], 0
v_exp_f32 v207, v207
v_rcp_f32 v254, v228
v_cvt_pk_bf16_f32 v127, v206, v207
v_cvt_pk_bf16_f32 v78, v196, v197
v_mfma_f32_16x16x32_bf16 v[156:159], a[220:223], v[192:195], 0
v_cvt_pk_bf16_f32 v79, v198, v199
v_max3_f32 v255, v255, v228, v254
v_mfma_f32_16x16x32_bf16 v[156:159], a[216:219], v[216:219], v[156:159]
v_mfma_f32_16x16x32_bf16 v[156:159], a[212:215], v[220:223], v[156:159]
v_mfma_f32_16x16x32_bf16 v[156:159], a[208:211], v[200:203], v[156:159]
buffer_load_dwordx4 v243, s[16:19], s100 offen offset:2112 nt lds
v_mfma_f32_16x16x32_bf16 v[152:155], a[192:195], v[200:203], 0
v_mfma_f32_16x16x32_bf16 v[152:155], a[196:199], v[220:223], v[152:155]
ds_read_b128 v[220:223], v249 offset:544
v_mfma_f32_16x16x32_bf16 v[152:155], a[200:203], v[216:219], v[152:155]
ds_read_b128 v[216:219], v249 offset:272
v_mfma_f32_16x16x32_bf16 v[152:155], a[204:207], v[192:195], v[152:155]
buffer_load_dwordx4 v243, s[16:19], s101 offen offset:3168 nt lds
v_mfma_f32_16x16x32_bf16 v[168:171], v[48:51], v[104:107], v[168:171]
s_mov_b32 m0, s58
v_mfma_f32_16x16x32_bf16 v[168:171], v[64:67], v[108:111], v[168:171]
s_waitcnt lgkmcnt(2)
v_mfma_f32_16x16x32_bf16 v[168:171], v[80:83], v[112:115], v[168:171]
v_mfma_f32_16x16x32_bf16 v[172:175], v[84:87], v[112:115], v[172:175]
v_mfma_f32_16x16x32_bf16 v[172:175], v[52:55], v[104:107], v[172:175]
v_mfma_f32_16x16x32_bf16 v[172:175], v[68:71], v[108:111], v[172:175]
v_mfma_f32_16x16x32_bf16 v[176:179], v[72:75], v[108:111], v[176:179]
v_mfma_f32_16x16x32_bf16 v[176:179], v[88:91], v[112:115], v[176:179]
v_mfma_f32_16x16x32_bf16 v[176:179], v[56:59], v[104:107], v[176:179]
s_branch L_entryf
L_spin:
ds_read_addtid_b32 v192 offset:65280
s_waitcnt lgkmcnt(0)
v_cmp_lt_u32 vcc, s45, v192
s_nop 1
s_cbranch_vccnz L_spin
s_branch L_back
L_spine:
ds_read_addtid_b32 v188 offset:65280
s_waitcnt lgkmcnt(0)
v_cmp_lt_u32 vcc, s45, v188
s_nop 1
s_cbranch_vccnz L_spine
s_branch L_backe
.p2align 12
.fill 498, 4, 0xbf800000
L_h3:
s_cbranch_execz L_ret
L_loopf:
v_mfma_f32_16x16x32_bf16 v[152:155], a[192:195], v[188:191], 0
s_mov_b32 m0, s59
v_cvt_pk_bf16_f32 v102, v232, v233
v_cvt_pk_bf16_f32 v103, v234, v235
v_mfma_f32_16x16x32_bf16 v[152:155], a[196:199], v[208:211], v[152:155]
s_add_u32 s52, s47, 8192
ds_read_addtid_b32 v192 offset:65280
v_cvt_pk_bf16_f32 v106, v204, v205
v_mfma_f32_16x16x32_bf16 v[152:155], a[200:203], v[212:215], v[152:155]
s_add_u32 s53, s47, 12288
v_exp_f32 v221, v221
v_mfma_f32_16x16x32_bf16 v[152:155], a[204:207], v[216:219], v[152:155]
s_bfe_i32 s57, s3, 0x10000
v_exp_f32 v222, v222
v_mfma_f32_16x16x32_bf16 v[156:159], a[220:223], v[216:219], 0
s_mov_b32 s47, s46
v_exp_f32 v223, v223
v_mfma_f32_16x16x32_bf16 v[156:159], a[216:219], v[212:215], v[156:159]
s_and_b32 s54, s57, s5
v_cvt_pk_bf16_f32 v110, v220, v221
v_cvt_pk_bf16_f32 v111, v222, v223
v_mfma_f32_16x16x32_bf16 v[156:159], a[212:215], v[208:211], v[156:159]
s_lshr_b32 s3, s3, 1
v_exp_f32 v196, v196
v_mfma_f32_16x16x32_bf16 v[156:159], a[208:211], v[188:191], v[156:159]
s_waitcnt lgkmcnt(0)
v_cmp_lt_u32 vcc, s45, v192
v_cvt_pk_bf16_f32 v107, v206, v207
v_mfma_f32_16x16x32_bf16 v[160:163], a[224:227], v[188:191], 0
v_exp_f32 v197, v197
v_mfma_f32_16x16x32_bf16 v[160:163], a[228:231], v[208:211], v[160:163]
v_exp_f32 v198, v198
v_mfma_f32_16x16x32_bf16 v[160:163], a[232:235], v[212:215], v[160:163]
s_cbranch_vccnz L_spin
L_back:
v_exp_f32 v199, v199
v_mfma_f32_16x16x32_bf16 v[160:163], a[236:239], v[216:219], v[160:163]
s_mov_b32 s98, s50
ds_read_b128 v[192:195], v242 offset:0
v_cvt_pk_bf16_f32 v104, v196, v197
v_mfma_f32_16x16x32_bf16 v[164:167], a[252:255], v[216:219], 0
s_add_u32 s99, s98, s51
ds_read_b128 v[216:219], v242 offset:512
v_cvt_pk_bf16_f32 v105, v198, v199
v_mfma_f32_16x16x32_bf16 v[164:167], a[248:251], v[212:215], v[164:167]
s_add_u32 s100, s99, s51
ds_read_b128 v[196:199], v242 offset:256
v_mov_b64 v[212:213], s[96:97]
v_mfma_f32_16x16x32_bf16 v[164:167], a[244:247], v[208:211], v[164:167]
s_add_u32 m0, s49, 0
ds_read_b128 v[204:207], v242 offset:768
v_mov_b64 v[214:215], s[96:97]
v_mfma_f32_16x16x32_bf16 v[164:167], a[240:243], v[188:191], v[164:167]
s_add_u32 s101, s100, s51
v_exp_f32 v224, v224
v_mfma_f32_16x16x32_bf16 v[188:191], v[12:15], v[100:103], 0
s_sub_u32 s45, s45, 1
v_exp_f32 v225, v225
v_mfma_f32_16x16x32_bf16 v[188:191], v[8:11], v[96:99], v[188:191]
s_waitcnt lgkmcnt(3)
v_exp_f32 v226, v226
v_smfmac_f32_16x16x64_bf16 v[212:215], v[238:241], v[96:103], v251
s_add_u32 s50, s50, 13107200
s_sub_u32 s50, s50, s54
v_cvt_pk_bf16_f32 v108, v224, v225
v_mfma_f32_16x16x32_bf16 v[208:211], v[0:3], v[96:99], 0
v_exp_f32 v227, v227
v_mfma_f32_16x16x32_bf16 v[208:211], v[4:7], v[100:103], v[208:211]
s_waitcnt lgkmcnt(1)
v_cvt_pk_bf16_f32 v109, v226, v227
v_add_f32 v212, v212, v213
v_mfma_f32_16x16x32_bf16 v[220:223], a[64:67], v[192:195], 0
v_exp_f32 v200, v200
v_mfma_f32_16x16x32_bf16 v[220:223], a[68:71], v[196:199], v[220:223]
s_waitcnt lgkmcnt(0)
v_exp_f32 v201, v201
v_mfma_f32_16x16x32_bf16 v[220:223], a[72:75], v[216:219], v[220:223]
v_exp_f32 v202, v202
v_mfma_f32_16x16x32_bf16 v[220:223], a[76:79], v[204:207], v[220:223]
v_exp_f32 v203, v203
v_mfma_f32_16x16x32_bf16 v[224:227], a[92:95], v[204:207], 0
v_cvt_pk_bf16_f32 v112, v200, v201
v_cvt_pk_bf16_f32 v113, v202, v203
v_mfma_f32_16x16x32_bf16 v[224:227], a[88:91], v[216:219], v[224:227]
v_exp_f32 v228, v228
v_mfma_f32_16x16x32_bf16 v[224:227], a[84:87], v[196:199], v[224:227]
s_nop 0
v_cvt_pk_bf16_f32 v0, v220, v221
v_cvt_pk_bf16_f32 v1, v222, v223
v_mfma_f32_16x16x32_bf16 v[224:227], a[80:83], v[192:195], v[224:227]
buffer_load_dwordx4 v243, s[16:19], s98 offen offset:0 nt lds
v_mfma_f32_16x16x32_bf16 v[200:203], a[96:99], v[192:195], 0
s_add_u32 s98, s98, s48
v_exp_f32 v229, v229
v_mfma_f32_16x16x32_bf16 v[200:203], a[100:103], v[196:199], v[200:203]
v_exp_f32 v230, v230
v_mfma_f32_16x16x32_bf16 v[200:203], a[104:107], v[216:219], v[200:203]
v_exp_f32 v231, v231
v_mfma_f32_16x16x32_bf16 v[200:203], a[108:111], v[204:207], v[200:203]
v_mov_b64 v[220:221], 0
v_cvt_pk_bf16_f32 v114, v228, v229
v_mfma_f32_16x16x32_bf16 v[232:235], a[124:127], v[204:207], 0
v_cvt_pk_bf16_f32 v115, v230, v231
v_cvt_pk_bf16_f32 v2, v224, v225
v_mfma_f32_16x16x32_bf16 v[232:235], a[120:123], v[216:219], v[232:235]
v_exp_f32 v188, v188
v_mfma_f32_16x16x32_bf16 v[232:235], a[116:119], v[196:199], v[232:235]
v_cvt_pk_bf16_f32 v4, v200, v201
v_cvt_pk_bf16_f32 v5, v202, v203
v_mfma_f32_16x16x32_bf16 v[232:235], a[112:115], v[192:195], v[232:235]
v_exp_f32 v189, v189
v_smfmac_f32_16x16x64_bf16 v[220:223], v[184:187], v[104:111], v251
ds_read_b128 v[192:195], v242 offset:4992
v_cvt_pk_bf16_f32 v122, v188, v189
v_smfmac_f32_16x16x64_bf16 v[220:223], v[184:187], v[112:119], v251 abid:1
ds_read_b128 v[196:199], v242 offset:4736
ds_read_b128 v[204:207], v242 offset:4480
v_mfma_f32_16x16x32_bf16 v[168:171], v[80:83], v[112:115], v[168:171]
ds_read_b128 v[216:219], v242 offset:4224
v_cvt_pk_bf16_f32 v3, v226, v227
v_mfma_f32_16x16x32_bf16 v[168:171], v[64:67], v[108:111], v[168:171]
v_exp_f32 v190, v190
v_mfma_f32_16x16x32_bf16 v[168:171], v[48:51], v[104:107], v[168:171]
v_exp_f32 v191, v191
v_mfma_f32_16x16x32_bf16 v[172:175], v[52:55], v[104:107], v[172:175]
v_cvt_pk_bf16_f32 v123, v190, v191
v_add_f32 v220, v220, v221
v_mfma_f32_16x16x32_bf16 v[172:175], v[68:71], v[108:111], v[172:175]
s_waitcnt lgkmcnt(3)
v_rcp_f32 v254, v220
v_mfma_f32_16x16x32_bf16 v[172:175], v[84:87], v[112:115], v[172:175]
v_max3_f32 v255, v255, v220, v254
v_cvt_pk_bf16_f32 v6, v232, v233
v_mfma_f32_16x16x32_bf16 v[200:203], v[40:43], v[96:99], 0
v_exp_f32 v208, v208
v_mfma_f32_16x16x32_bf16 v[200:203], v[44:47], v[100:103], v[200:203]
v_exp_f32 v209, v209
v_mfma_f32_16x16x32_bf16 v[176:179], v[56:59], v[104:107], v[176:179]
v_exp_f32 v210, v210
v_mfma_f32_16x16x32_bf16 v[176:179], v[72:75], v[108:111], v[176:179]
v_exp_f32 v211, v211
v_mfma_f32_16x16x32_bf16 v[176:179], v[88:91], v[112:115], v[176:179]
v_cvt_pk_bf16_f32 v120, v208, v209
v_cvt_pk_bf16_f32 v121, v210, v211
v_mfma_f32_16x16x32_bf16 v[180:183], v[92:95], v[112:115], v[180:183]
v_cvt_pk_bf16_f32 v7, v234, v235
v_add_f32 v214, v214, v215
v_mfma_f32_16x16x32_bf16 v[180:183], v[76:79], v[108:111], v[180:183]
s_waitcnt lgkmcnt(1)
v_exp_f32 v212, v212
v_mfma_f32_16x16x32_bf16 v[180:183], v[60:63], v[104:107], v[180:183]
s_waitcnt lgkmcnt(0)
v_exp_f32 v214, v214
v_mfma_f32_16x16x32_bf16 v[188:191], v[16:19], v[96:99], 0
s_mov_b64 vcc, s[14:15]
v_perm_b32 v132, v214, v212, v252
v_perm_b32 v133, v214, v212, v253
v_mfma_f32_16x16x32_bf16 v[188:191], v[20:23], v[100:103], v[188:191]
v_exp_f32 v200, v200
v_mfma_f32_16x16x32_bf16 v[220:223], a[124:127], v[192:195], 0
v_exp_f32 v201, v201
v_mfma_f32_16x16x32_bf16 v[220:223], a[120:123], v[196:199], v[220:223]
v_exp_f32 v202, v202
v_mfma_f32_16x16x32_bf16 v[220:223], a[116:119], v[204:207], v[220:223]
v_exp_f32 v203, v203
v_mfma_f32_16x16x32_bf16 v[220:223], a[112:115], v[216:219], v[220:223]
buffer_load_dwordx4 v243, s[16:19], s99 offen offset:1056 nt lds
v_mfma_f32_16x16x32_bf16 v[224:227], a[96:99], v[216:219], 0
s_add_u32 s99, s98, s51
v_exp_f32 v188, v188
v_mfma_f32_16x16x32_bf16 v[224:227], a[100:103], v[204:207], v[224:227]
v_exp_f32 v189, v189
v_mfma_f32_16x16x32_bf16 v[224:227], a[104:107], v[196:199], v[224:227]
v_exp_f32 v190, v190
v_mfma_f32_16x16x32_bf16 v[224:227], a[108:111], v[192:195], v[224:227]
v_exp_f32 v191, v191
v_mfma_f32_16x16x32_bf16 v[228:231], a[92:95], v[192:195], 0
v_cvt_pk_bf16_f32 v124, v188, v189
v_cvt_pk_bf16_f32 v125, v190, v191
v_mfma_f32_16x16x32_bf16 v[228:231], a[88:91], v[196:199], v[228:231]
v_cvt_pk_bf16_f32 v14, v220, v221
v_cvt_pk_bf16_f32 v15, v222, v223
v_mfma_f32_16x16x32_bf16 v[228:231], a[84:87], v[204:207], v[228:231]
ds_read_b128 v[220:223], v242 offset:16896
v_cvt_pk_bf16_f32 v12, v224, v225
v_mfma_f32_16x16x32_bf16 v[228:231], a[80:83], v[216:219], v[228:231]
v_cvt_pk_bf16_f32 v13, v226, v227
v_cvt_pk_bf16_f32 v130, v200, v201
v_mfma_f32_16x16x32_bf16 v[208:211], a[64:67], v[216:219], 0
ds_read_b128 v[224:227], v242 offset:17152
ds_read_b128 v[216:219], v242 offset:17408
v_mfma_f32_16x16x32_bf16 v[208:211], a[68:71], v[204:207], v[208:211]
v_cvt_pk_bf16_f32 v131, v202, v203
v_fmac_f32 v136, v168, v254
v_mfma_f32_16x16x32_bf16 v[208:211], a[72:75], v[196:199], v[208:211]
v_cvt_pk_bf16_f32 v10, v228, v229
v_cvt_pk_bf16_f32 v11, v230, v231
v_mfma_f32_16x16x32_bf16 v[208:211], a[76:79], v[192:195], v[208:211]
ds_read_b128 v[228:231], v242 offset:17664
v_fmac_f32 v137, v169, v254
v_mfma_f32_16x16x32_bf16 v[188:191], v[28:31], v[100:103], 0
v_fmac_f32 v138, v170, v254
v_fmac_f32 v139, v171, v254
v_mfma_f32_16x16x32_bf16 v[188:191], v[24:27], v[96:99], v[188:191]
v_fmac_f32 v140, v172, v254
v_fmac_f32 v141, v173, v254
v_mfma_f32_16x16x32_bf16 v[192:195], v[32:35], v[96:99], 0
s_waitcnt lgkmcnt(3)
v_fmac_f32 v142, v174, v254
v_fmac_f32 v143, v175, v254
v_mfma_f32_16x16x32_bf16 v[192:195], v[36:39], v[100:103], v[192:195]
s_waitcnt lgkmcnt(2)
v_exp_f32 v188, v188
v_mfma_f32_16x16x32_bf16 v[196:199], a[64:67], v[220:223], 0
s_waitcnt lgkmcnt(1)
v_exp_f32 v189, v189
v_mfma_f32_16x16x32_bf16 v[196:199], a[68:71], v[224:227], v[196:199]
s_waitcnt lgkmcnt(0)
v_exp_f32 v190, v190
v_mfma_f32_16x16x32_bf16 v[196:199], a[72:75], v[216:219], v[196:199]
v_exp_f32 v191, v191
v_mfma_f32_16x16x32_bf16 v[196:199], a[76:79], v[228:231], v[196:199]
buffer_load_dwordx4 v243, s[16:19], s100 offen offset:2112 nt lds
v_mfma_f32_16x16x32_bf16 v[204:207], a[92:95], v[228:231], 0
s_add_u32 s100, s99, s51
ds_read_b128 v[212:215], v242 offset:8960
ds_read_b128 v[200:203], v242 offset:9216
v_mfma_f32_16x16x32_bf16 v[204:207], a[88:91], v[216:219], v[204:207]
ds_read_b128 v[232:235], v242 offset:8704
v_cvt_pk_bf16_f32 v126, v188, v189
v_mfma_f32_16x16x32_bf16 v[204:207], a[84:87], v[224:227], v[204:207]
v_cvt_pk_bf16_f32 v32, v196, v197
v_cvt_pk_bf16_f32 v33, v198, v199
v_mfma_f32_16x16x32_bf16 v[204:207], a[80:83], v[220:223], v[204:207]
v_cvt_pk_bf16_f32 v127, v190, v191
v_fmac_f32 v144, v176, v254
v_mfma_f32_16x16x32_bf16 v[196:199], a[96:99], v[220:223], 0
ds_read_b128 v[188:191], v242 offset:8448
v_fmac_f32 v145, v177, v254
v_mfma_f32_16x16x32_bf16 v[196:199], a[100:103], v[224:227], v[196:199]
v_exp_f32 v192, v192
v_mfma_f32_16x16x32_bf16 v[196:199], a[104:107], v[216:219], v[196:199]
v_cvt_pk_bf16_f32 v34, v204, v205
v_cvt_pk_bf16_f32 v35, v206, v207
v_mfma_f32_16x16x32_bf16 v[196:199], a[108:111], v[228:231], v[196:199]
s_waitcnt lgkmcnt(1)
v_exp_f32 v193, v193
v_mfma_f32_16x16x32_bf16 v[204:207], a[124:127], v[228:231], 0
v_exp_f32 v194, v194
v_mfma_f32_16x16x32_bf16 v[204:207], a[116:119], v[224:227], v[204:207]
v_exp_f32 v195, v195
v_mfma_f32_16x16x32_bf16 v[204:207], a[112:115], v[220:223], v[204:207]
v_cvt_pk_bf16_f32 v128, v192, v193
v_cvt_pk_bf16_f32 v129, v194, v195
v_mfma_f32_16x16x32_bf16 v[204:207], a[120:123], v[216:219], v[204:207]
v_cvt_pk_bf16_f32 v36, v196, v197
v_cvt_pk_bf16_f32 v37, v198, v199
v_mfma_f32_16x16x32_bf16 v[216:219], a[120:123], v[212:215], 0
v_fmac_f32 v146, v178, v254
v_fmac_f32 v147, v179, v254
v_mfma_f32_16x16x32_bf16 v[216:219], a[124:127], v[200:203], v[216:219]
s_waitcnt lgkmcnt(0)
v_fmac_f32 v148, v180, v254
v_fmac_f32 v149, v181, v254
v_mfma_f32_16x16x32_bf16 v[216:219], a[116:119], v[232:235], v[216:219]
v_fmac_f32 v150, v182, v254
v_fmac_f32 v151, v183, v254
v_mfma_f32_16x16x32_bf16 v[216:219], a[112:115], v[188:191], v[216:219]
v_cvt_pk_bf16_f32 v136, v136, v137
v_cvt_pk_bf16_f32 v144, v144, v145
v_mfma_f32_16x16x32_bf16 v[192:195], a[96:99], v[188:191], 0
v_cvt_pk_bf16_f32 v137, v138, v139
v_cvt_pk_bf16_f32 v145, v146, v147
v_mfma_f32_16x16x32_bf16 v[192:195], a[100:103], v[232:235], v[192:195]
v_cvt_pk_bf16_f32 v138, v140, v141
v_cvt_pk_bf16_f32 v139, v142, v143
v_mfma_f32_16x16x32_bf16 v[192:195], a[104:107], v[212:215], v[192:195]
v_cvt_pk_bf16_f32 v146, v148, v149
v_cvt_pk_bf16_f32 v147, v150, v151
v_mfma_f32_16x16x32_bf16 v[192:195], a[108:111], v[200:203], v[192:195]
v_pk_max_i16 v136, v136, 0
v_pk_max_i16 v137, v137, 0
v_mfma_f32_16x16x32_bf16 v[196:199], a[92:95], v[200:203], 0
v_pk_max_i16 v138, v138, 0
v_pk_max_i16 v139, v139, 0
v_mfma_f32_16x16x32_bf16 v[196:199], a[88:91], v[212:215], v[196:199]
v_pk_max_i16 v144, v144, 0
v_pk_max_i16 v145, v145, 0
v_mfma_f32_16x16x32_bf16 v[196:199], a[84:87], v[232:235], v[196:199]
v_cvt_pk_bf16_f32 v20, v192, v193
v_cvt_pk_bf16_f32 v21, v194, v195
v_mfma_f32_16x16x32_bf16 v[196:199], a[80:83], v[188:191], v[196:199]
v_pk_max_i16 v146, v146, 0
v_pk_max_i16 v147, v147, 0
v_mfma_f32_16x16x32_bf16 v[192:195], a[64:67], v[188:191], 0
v_cndmask_b32_dpp v140, v144, v136, vcc quad_perm:[1,0,3,2] row_mask:0xf bank_mask:0xf
v_cndmask_b32_dpp v141, v145, v137, vcc quad_perm:[1,0,3,2] row_mask:0xf bank_mask:0xf
v_mfma_f32_16x16x32_bf16 v[192:195], a[68:71], v[232:235], v[192:195]
v_cndmask_b32_dpp v142, v146, v138, vcc quad_perm:[1,0,3,2] row_mask:0xf bank_mask:0xf
v_cndmask_b32_dpp v143, v147, v139, vcc quad_perm:[1,0,3,2] row_mask:0xf bank_mask:0xf
v_mfma_f32_16x16x32_bf16 v[192:195], a[72:75], v[212:215], v[192:195]
s_not_b64 vcc, vcc
ds_read_b128 v[220:223], v242 offset:13440
v_cndmask_b32_dpp v144, v136, v144, vcc quad_perm:[1,0,3,2] row_mask:0xf bank_mask:0xf
v_mfma_f32_16x16x32_bf16 v[192:195], a[76:79], v[200:203], v[192:195]
v_cndmask_b32_dpp v145, v137, v145, vcc quad_perm:[1,0,3,2] row_mask:0xf bank_mask:0xf
v_cndmask_b32_dpp v146, v138, v146, vcc quad_perm:[1,0,3,2] row_mask:0xf bank_mask:0xf
v_cndmask_b32_dpp v147, v139, v147, vcc quad_perm:[1,0,3,2] row_mask:0xf bank_mask:0xf
v_mfma_f32_32x32x16_bf16 v[168:183], v[236:239], v[132:135], 0
buffer_store_dwordx4 v[140:143], v244, s[20:23], s52 offen offset:0 nt
buffer_store_dwordx4 v[144:147], v244, s[20:23], s52 offen offset:256 nt
v_cvt_pk_bf16_f32 v38, v204, v205
v_mov_b64 v[204:205], 0
v_cvt_pk_bf16_f32 v39, v206, v207
v_cvt_pk_bf16_f32 v16, v192, v193
v_smfmac_f32_16x16x64_bf16 v[204:207], v[184:187], v[120:127], v251
s_add_u32 s52, s46, 20480
v_cvt_pk_bf16_f32 v17, v194, v195
v_smfmac_f32_16x16x64_bf16 v[204:207], v[184:187], v[128:135], v251 abid:1
L_h4:
s_cbranch_execz L_ret
v_cvt_pk_bf16_f32 v22, v216, v217
v_mfma_f32_16x16x32_bf16 v[168:171], v[80:83], v[128:131], v[168:171]
v_cvt_pk_bf16_f32 v23, v218, v219
v_cvt_pk_bf16_f32 v8, v208, v209
v_mfma_f32_16x16x32_bf16 v[168:171], v[64:67], v[124:127], v[168:171]
ds_read_b128 v[216:219], v242 offset:13184
v_cvt_pk_bf16_f32 v9, v210, v211
v_mfma_f32_16x16x32_bf16 v[168:171], v[48:51], v[120:123], v[168:171]
ds_read_b128 v[208:211], v242 offset:12928
v_add_f32 v204, v204, v205
v_mfma_f32_16x16x32_bf16 v[172:175], v[52:55], v[120:123], v[172:175]
ds_read_b128 v[238:241], v245 offset:0
v_cvt_pk_bf16_f32 v18, v196, v197
v_mfma_f32_16x16x32_bf16 v[172:175], v[68:71], v[124:127], v[172:175]
ds_read2_b32 v[236:237], v246 offset0:0 offset1:8
v_cvt_pk_bf16_f32 v19, v198, v199
v_mfma_f32_16x16x32_bf16 v[172:175], v[84:87], v[128:131], v[172:175]
ds_read_b128 v[196:199], v242 offset:12672
v_add_u32 v245, 1728, v245
v_mfma_f32_16x16x32_bf16 v[176:179], v[88:91], v[128:131], v[176:179]
s_waitcnt lgkmcnt(5)
v_rcp_f32 v254, v204
v_mfma_f32_16x16x32_bf16 v[176:179], v[72:75], v[124:127], v[176:179]
v_max3_f32 v255, v255, v204, v254
v_fmac_f32 v152, v168, v254
v_mfma_f32_16x16x32_bf16 v[176:179], v[56:59], v[120:123], v[176:179]
v_fmac_f32 v153, v169, v254
v_fmac_f32 v154, v170, v254
v_mfma_f32_16x16x32_bf16 v[180:183], v[60:63], v[120:123], v[180:183]
v_fmac_f32 v155, v171, v254
v_fmac_f32 v156, v172, v254
v_mfma_f32_16x16x32_bf16 v[180:183], v[76:79], v[124:127], v[180:183]
v_fmac_f32 v157, v173, v254
v_fmac_f32 v158, v174, v254
v_mfma_f32_16x16x32_bf16 v[180:183], v[92:95], v[128:131], v[180:183]
s_mov_b64 vcc, s[14:15]
v_fmac_f32 v159, v175, v254
v_fmac_f32 v160, v176, v254
v_mfma_f32_16x16x32_bf16 v[192:195], v[188:191], a[128:131], 0
v_fmac_f32 v161, v177, v254
v_fmac_f32 v162, v178, v254
v_mfma_f32_16x16x32_bf16 v[192:195], v[232:235], a[132:135], v[192:195]
v_fmac_f32 v163, v179, v254
v_fmac_f32 v164, v180, v254
v_mfma_f32_16x16x32_bf16 v[192:195], v[212:215], a[136:139], v[192:195]
s_waitcnt lgkmcnt(4)
v_fmac_f32 v165, v181, v254
v_cvt_pk_bf16_f32 v152, v152, v153
v_mfma_f32_16x16x32_bf16 v[192:195], v[200:203], a[140:143], v[192:195]
s_waitcnt lgkmcnt(3)
v_cvt_pk_bf16_f32 v160, v160, v161
v_cvt_pk_bf16_f32 v153, v154, v155
v_mfma_f32_16x16x32_bf16 v[204:207], v[200:203], a[156:159], 0
s_waitcnt lgkmcnt(2)
v_fmac_f32 v166, v182, v254
v_fmac_f32 v167, v183, v254
v_mfma_f32_16x16x32_bf16 v[204:207], v[212:215], a[152:155], v[204:207]
s_waitcnt lgkmcnt(1)
v_cvt_pk_bf16_f32 v64, v192, v193
v_cvt_pk_bf16_f32 v65, v194, v195
v_mfma_f32_16x16x32_bf16 v[204:207], v[232:235], a[148:151], v[204:207]
s_waitcnt lgkmcnt(0)
v_cvt_pk_bf16_f32 v161, v162, v163
v_cvt_pk_bf16_f32 v154, v156, v157
v_mfma_f32_16x16x32_bf16 v[204:207], v[188:191], a[144:147], v[204:207]
v_cvt_pk_bf16_f32 v155, v158, v159
v_cvt_pk_bf16_f32 v162, v164, v165
v_mfma_f32_16x16x32_bf16 v[224:227], v[188:191], a[160:163], 0
v_cvt_pk_bf16_f32 v163, v166, v167
v_pk_max_i16 v152, v152, 0
v_mfma_f32_16x16x32_bf16 v[224:227], v[232:235], a[164:167], v[224:227]
v_pk_max_i16 v153, v153, 0
v_pk_max_i16 v154, v154, 0
v_mfma_f32_16x16x32_bf16 v[224:227], v[212:215], a[168:171], v[224:227]
v_cvt_pk_bf16_f32 v68, v204, v205
v_cvt_pk_bf16_f32 v69, v206, v207
v_mfma_f32_16x16x32_bf16 v[224:227], v[200:203], a[172:175], v[224:227]
buffer_load_dwordx4 v243, s[16:19], s101 offen offset:3168 nt lds
v_mfma_f32_16x16x32_bf16 v[192:195], v[200:203], a[188:191], 0
s_add_u32 m0, s49, 8448
v_pk_max_i16 v155, v155, 0
v_pk_max_i16 v160, v160, 0
v_mfma_f32_16x16x32_bf16 v[192:195], v[232:235], a[180:183], v[192:195]
s_add_u32 s101, s100, s51
v_pk_max_i16 v161, v161, 0
v_cvt_pk_bf16_f32 v72, v224, v225
v_mfma_f32_16x16x32_bf16 v[192:195], v[188:191], a[176:179], v[192:195]
v_cvt_pk_bf16_f32 v73, v226, v227
v_pk_max_i16 v162, v162, 0
v_mfma_f32_16x16x32_bf16 v[192:195], v[212:215], a[184:187], v[192:195]
v_pk_max_i16 v163, v163, 0
v_cndmask_b32_dpp v156, v160, v152, vcc quad_perm:[1,0,3,2] row_mask:0xf bank_mask:0xf
v_mfma_f32_16x16x32_bf16 v[188:191], v[216:219], a[184:187], 0
v_cndmask_b32_dpp v157, v161, v153, vcc quad_perm:[1,0,3,2] row_mask:0xf bank_mask:0xf
v_cndmask_b32_dpp v158, v162, v154, vcc quad_perm:[1,0,3,2] row_mask:0xf bank_mask:0xf
v_mfma_f32_16x16x32_bf16 v[188:191], v[220:223], a[188:191], v[188:191]
v_cndmask_b32_dpp v159, v163, v155, vcc quad_perm:[1,0,3,2] row_mask:0xf bank_mask:0xf
v_add_u32 v246, 1728, v246
v_mfma_f32_16x16x32_bf16 v[188:191], v[208:211], a[180:183], v[188:191]
s_not_b64 vcc, vcc
v_cvt_pk_bf16_f32 v76, v192, v193
v_cvt_pk_bf16_f32 v77, v194, v195
v_mfma_f32_16x16x32_bf16 v[188:191], v[196:199], a[176:179], v[188:191]
v_cndmask_b32_dpp v160, v152, v160, vcc quad_perm:[1,0,3,2] row_mask:0xf bank_mask:0xf
v_cndmask_b32_dpp v161, v153, v161, vcc quad_perm:[1,0,3,2] row_mask:0xf bank_mask:0xf
v_mfma_f32_16x16x32_bf16 v[192:195], v[196:199], a[160:163], 0
v_cndmask_b32_dpp v162, v154, v162, vcc quad_perm:[1,0,3,2] row_mask:0xf bank_mask:0xf
v_cndmask_b32_dpp v163, v155, v163, vcc quad_perm:[1,0,3,2] row_mask:0xf bank_mask:0xf
v_mfma_f32_16x16x32_bf16 v[192:195], v[208:211], a[164:167], v[192:195]
s_nop 1
v_cvt_pk_bf16_f32 v78, v188, v189
v_mfma_f32_16x16x32_bf16 v[192:195], v[216:219], a[168:171], v[192:195]
v_cvt_pk_bf16_f32 v79, v190, v191
v_mfma_f32_16x16x32_bf16 v[192:195], v[220:223], a[172:175], v[192:195]
s_nop 2
v_mfma_f32_16x16x32_bf16 v[188:191], v[220:223], a[156:159], 0
s_nop 2
v_mfma_f32_16x16x32_bf16 v[188:191], v[216:219], a[152:155], v[188:191]
v_cvt_pk_bf16_f32 v74, v192, v193
v_cvt_pk_bf16_f32 v75, v194, v195
v_mfma_f32_16x16x32_bf16 v[188:191], v[208:211], a[148:151], v[188:191]
v_mfma_f32_16x16x32_bf16 v[188:191], v[196:199], a[144:147], v[188:191]
s_nop 2
v_mfma_f32_16x16x32_bf16 v[192:195], v[196:199], a[128:131], 0
s_nop 2
v_mfma_f32_16x16x32_bf16 v[192:195], v[208:211], a[132:135], v[192:195]
v_cvt_pk_bf16_f32 v70, v188, v189
v_cvt_pk_bf16_f32 v71, v190, v191
v_mfma_f32_16x16x32_bf16 v[192:195], v[216:219], a[136:139], v[192:195]
v_mfma_f32_16x16x32_bf16 v[192:195], v[220:223], a[140:143], v[192:195]
s_nop 2
v_mfma_f32_16x16x32_bf16 v[188:191], a[64:67], v[196:199], 0
s_nop 2
v_mfma_f32_16x16x32_bf16 v[188:191], a[68:71], v[208:211], v[188:191]
v_cvt_pk_bf16_f32 v66, v192, v193
v_cvt_pk_bf16_f32 v67, v194, v195
v_mfma_f32_16x16x32_bf16 v[188:191], a[72:75], v[216:219], v[188:191]
v_mfma_f32_16x16x32_bf16 v[188:191], a[76:79], v[220:223], v[188:191]
buffer_load_dwordx4 v243, s[16:19], s98 offen offset:0 nt lds
v_mfma_f32_16x16x32_bf16 v[192:195], a[92:95], v[220:223], 0
s_add_u32 s98, s98, s48
ds_read_b128 v[200:203], v242 offset:21632
ds_read_b128 v[204:207], v242 offset:21888
v_mfma_f32_16x16x32_bf16 v[192:195], a[88:91], v[216:219], v[192:195]
ds_read_b128 v[212:215], v242 offset:21376
ds_read_b128 v[224:227], v242 offset:21120
v_mfma_f32_16x16x32_bf16 v[192:195], a[84:87], v[208:211], v[192:195]
v_cvt_pk_bf16_f32 v24, v188, v189
v_cvt_pk_bf16_f32 v25, v190, v191
v_mfma_f32_16x16x32_bf16 v[192:195], a[80:83], v[196:199], v[192:195]
s_nop 2
v_mfma_f32_16x16x32_bf16 v[188:191], a[96:99], v[196:199], 0
s_nop 2
v_mfma_f32_16x16x32_bf16 v[188:191], a[100:103], v[208:211], v[188:191]
v_cvt_pk_bf16_f32 v26, v192, v193
v_cvt_pk_bf16_f32 v27, v194, v195
v_mfma_f32_16x16x32_bf16 v[188:191], a[104:107], v[216:219], v[188:191]
v_mfma_f32_16x16x32_bf16 v[188:191], a[108:111], v[220:223], v[188:191]
s_nop 2
v_mfma_f32_16x16x32_bf16 v[192:195], a[124:127], v[220:223], 0
s_nop 2
v_mfma_f32_16x16x32_bf16 v[192:195], a[116:119], v[208:211], v[192:195]
v_cvt_pk_bf16_f32 v28, v188, v189
v_cvt_pk_bf16_f32 v29, v190, v191
v_mfma_f32_16x16x32_bf16 v[192:195], a[112:115], v[196:199], v[192:195]
s_waitcnt lgkmcnt(3)
v_mfma_f32_16x16x32_bf16 v[192:195], a[120:123], v[216:219], v[192:195]
s_waitcnt lgkmcnt(2)
s_nop 1
v_mfma_f32_16x16x32_bf16 v[188:191], a[120:123], v[200:203], 0
s_waitcnt lgkmcnt(1)
s_nop 1
v_mfma_f32_16x16x32_bf16 v[188:191], a[124:127], v[204:207], v[188:191]
s_waitcnt lgkmcnt(0)
v_cvt_pk_bf16_f32 v30, v192, v193
v_cvt_pk_bf16_f32 v31, v194, v195
v_mfma_f32_16x16x32_bf16 v[188:191], a[116:119], v[212:215], v[188:191]
v_mfma_f32_16x16x32_bf16 v[188:191], a[112:115], v[224:227], v[188:191]
s_nop 2
v_mfma_f32_16x16x32_bf16 v[192:195], a[96:99], v[224:227], 0
s_nop 2
v_mfma_f32_16x16x32_bf16 v[192:195], a[100:103], v[212:215], v[192:195]
v_cvt_pk_bf16_f32 v46, v188, v189
v_cvt_pk_bf16_f32 v47, v190, v191
v_mfma_f32_16x16x32_bf16 v[192:195], a[104:107], v[200:203], v[192:195]
v_mfma_f32_16x16x32_bf16 v[192:195], a[108:111], v[204:207], v[192:195]
buffer_load_dwordx4 v243, s[16:19], s99 offen offset:1056 nt lds
v_mfma_f32_16x16x32_bf16 v[188:191], a[92:95], v[204:207], 0
s_add_u32 s99, s98, s51
s_nop 1
v_mfma_f32_16x16x32_bf16 v[188:191], a[88:91], v[200:203], v[188:191]
s_nop 1
v_cvt_pk_bf16_f32 v44, v192, v193
v_mfma_f32_16x16x32_bf16 v[188:191], a[84:87], v[212:215], v[188:191]
v_cvt_pk_bf16_f32 v45, v194, v195
v_mfma_f32_16x16x32_bf16 v[188:191], a[80:83], v[224:227], v[188:191]
s_nop 2
v_mfma_f32_16x16x32_bf16 v[192:195], a[64:67], v[224:227], 0
s_nop 2
v_mfma_f32_16x16x32_bf16 v[192:195], a[72:75], v[200:203], v[192:195]
v_cvt_pk_bf16_f32 v42, v188, v189
v_cvt_pk_bf16_f32 v43, v190, v191
v_mfma_f32_16x16x32_bf16 v[192:195], a[76:79], v[204:207], v[192:195]
v_mfma_f32_16x16x32_bf16 v[192:195], a[68:71], v[212:215], v[192:195]
s_nop 2
v_mfma_f32_16x16x32_bf16 v[188:191], a[4:7], v[212:215], 0
s_nop 2
v_mfma_f32_16x16x32_bf16 v[188:191], a[0:3], v[224:227], v[188:191]
v_cvt_pk_bf16_f32 v40, v192, v193
v_cvt_pk_bf16_f32 v41, v194, v195
v_mfma_f32_16x16x32_bf16 v[188:191], a[8:11], v[200:203], v[188:191]
v_mfma_f32_16x16x32_bf16 v[188:191], a[12:15], v[204:207], v[188:191]
s_nop 2
v_mfma_f32_16x16x32_bf16 v[192:195], a[28:31], v[204:207], 0
s_nop 2
v_mfma_f32_16x16x32_bf16 v[192:195], a[24:27], v[200:203], v[192:195]
v_cvt_pk_bf16_f32 v96, v188, v189
v_cvt_pk_bf16_f32 v97, v190, v191
v_mfma_f32_16x16x32_bf16 v[192:195], a[20:23], v[212:215], v[192:195]
v_mfma_f32_16x16x32_bf16 v[192:195], a[16:19], v[224:227], v[192:195]
ds_read_b128 v[188:191], v247 offset:0
v_add_u32 v247, 1728, v247
v_mfma_f32_16x16x32_bf16 v[196:199], a[32:35], v[224:227], 0
s_nop 2
v_mfma_f32_16x16x32_bf16 v[196:199], a[36:39], v[212:215], v[196:199]
s_nop 0
v_cvt_pk_bf16_f32 v98, v192, v193
v_cvt_pk_bf16_f32 v99, v194, v195
v_mfma_f32_16x16x32_bf16 v[196:199], a[40:43], v[200:203], v[196:199]
v_mfma_f32_16x16x32_bf16 v[196:199], a[44:47], v[204:207], v[196:199]
v_mov_b64 v[168:169], 0
v_mov_b64 v[170:171], 0
v_mfma_f32_16x16x32_bf16 v[192:195], a[60:63], v[204:207], 0
v_mov_b64 v[172:173], 0
v_mov_b64 v[174:175], 0
v_mfma_f32_16x16x32_bf16 v[192:195], a[56:59], v[200:203], v[192:195]
v_mov_b64 v[176:177], 0
v_mov_b64 v[178:179], 0
v_mfma_f32_16x16x32_bf16 v[192:195], a[52:55], v[212:215], v[192:195]
s_waitcnt lgkmcnt(0)
v_cvt_pk_bf16_f32 v100, v196, v197
v_cvt_pk_bf16_f32 v101, v198, v199
v_mfma_f32_16x16x32_bf16 v[192:195], a[48:51], v[224:227], v[192:195]
s_nop 2
v_smfmac_f32_16x16x64_bf16 v[168:171], v[188:191], v[0:7], v251
s_nop 2
v_smfmac_f32_16x16x64_bf16 v[172:175], v[188:191], v[16:23], v251
v_cvt_pk_bf16_f32 v102, v192, v193
v_smfmac_f32_16x16x64_bf16 v[176:179], v[188:191], v[32:39], v251
v_cvt_pk_bf16_f32 v103, v194, v195
v_mfma_f32_16x16x32_bf16 v[136:139], a[192:195], v[224:227], 0
v_add_f32 v168, v168, v169
v_mfma_f32_16x16x32_bf16 v[136:139], a[196:199], v[212:215], v[136:139]
v_exp_f32 v168, v168
v_mfma_f32_16x16x32_bf16 v[136:139], a[200:203], v[200:203], v[136:139]
v_mfma_f32_16x16x32_bf16 v[136:139], a[204:207], v[204:207], v[136:139]
buffer_load_dwordx4 v243, s[16:19], s100 offen offset:2112 nt lds
v_mfma_f32_16x16x32_bf16 v[140:143], a[220:223], v[204:207], 0
s_add_u32 s100, s99, s51
v_mfma_f32_16x16x32_bf16 v[140:143], a[216:219], v[200:203], v[140:143]
v_mfma_f32_16x16x32_bf16 v[140:143], a[212:215], v[212:215], v[140:143]
v_mfma_f32_16x16x32_bf16 v[140:143], a[208:211], v[224:227], v[140:143]
v_mfma_f32_16x16x32_bf16 v[144:147], a[224:227], v[224:227], 0
v_mfma_f32_16x16x32_bf16 v[144:147], a[228:231], v[212:215], v[144:147]
v_mfma_f32_16x16x32_bf16 v[144:147], a[232:235], v[200:203], v[144:147]
v_mfma_f32_16x16x32_bf16 v[144:147], a[236:239], v[204:207], v[144:147]
v_mfma_f32_16x16x32_bf16 v[148:151], a[252:255], v[204:207], 0
v_mfma_f32_16x16x32_bf16 v[148:151], a[248:251], v[200:203], v[148:151]
v_mfma_f32_16x16x32_bf16 v[148:151], a[244:247], v[212:215], v[148:151]
v_mfma_f32_16x16x32_bf16 v[148:151], a[240:243], v[224:227], v[148:151]
v_smfmac_f32_16x16x64_bf16 v[170:173], v[188:191], v[8:15], v251
v_mov_b64 v[192:193], s[96:97]
v_smfmac_f32_16x16x64_bf16 v[174:177], v[188:191], v[24:31], v251
v_mov_b64 v[194:195], s[96:97]
v_smfmac_f32_16x16x64_bf16 v[178:181], v[188:191], v[40:47], v251
s_nop 2
v_mfma_f32_16x16x32_bf16 v[188:191], v[4:7], v[100:103], 0
v_add_f32 v170, v170, v171
v_add_f32 v172, v172, v173
v_mfma_f32_16x16x32_bf16 v[188:191], v[0:3], v[96:99], v[188:191]
v_exp_f32 v170, v170
v_smfmac_f32_16x16x64_bf16 v[192:195], v[238:241], v[96:103], v251
v_add_f32 v174, v174, v175
v_mfma_f32_16x16x32_bf16 v[196:199], v[224:227], a[128:131], 0
v_exp_f32 v172, v172
v_mfma_f32_16x16x32_bf16 v[196:199], v[212:215], a[132:135], v[196:199]
v_exp_f32 v174, v174
v_mfma_f32_16x16x32_bf16 v[196:199], v[200:203], a[136:139], v[196:199]
v_add_f32 v176, v176, v177
v_add_f32 v178, v178, v179
v_mfma_f32_16x16x32_bf16 v[196:199], v[204:207], a[140:143], v[196:199]
buffer_load_dwordx4 v243, s[16:19], s101 offen offset:3168 nt lds
v_mfma_f32_16x16x32_bf16 v[208:211], v[204:207], a[156:159], 0
s_add_u32 m0, s49, 16896
ds_read_b128 v[216:219], v242 offset:512
ds_read_b128 v[220:223], v242 offset:256
v_mfma_f32_16x16x32_bf16 v[208:211], v[200:203], a[152:155], v[208:211]
s_add_u32 s101, s100, s51
ds_read_b128 v[228:231], v242 offset:0
v_cvt_pk_bf16_f32 v82, v196, v197
v_mfma_f32_16x16x32_bf16 v[208:211], v[212:215], a[148:151], v[208:211]
s_and_b32 s51, s57, 13106176
v_cvt_pk_bf16_f32 v83, v198, v199
v_add_f32 v192, v192, v193
v_mfma_f32_16x16x32_bf16 v[208:211], v[224:227], a[144:147], v[208:211]
s_sub_u32 s49, s49, s56
ds_read_b128 v[196:199], v242 offset:768
v_add_f32 v194, v194, v195
v_mfma_f32_16x16x32_bf16 v[232:235], v[224:227], a[160:163], 0
s_lshl3_add_u32 s48, s51, 8192
v_exp_f32 v192, v192
v_mfma_f32_16x16x32_bf16 v[232:235], v[212:215], a[164:167], v[232:235]
s_sub_u32 s51, s51, 32
v_cvt_pk_bf16_f32 v86, v208, v209
v_cvt_pk_bf16_f32 v87, v210, v211
v_mfma_f32_16x16x32_bf16 v[232:235], v[200:203], a[168:171], v[232:235]
v_exp_f32 v194, v194
v_mfma_f32_16x16x32_bf16 v[232:235], v[204:207], a[172:175], v[232:235]
v_perm_b32 v116, v194, v192, v252
v_perm_b32 v117, v194, v192, v253
v_mfma_f32_16x16x32_bf16 v[208:211], v[204:207], a[188:191], 0
v_add_f32 v180, v168, v170
v_cvt_pk_bf16_f32 v169, v168, v170
v_mfma_f32_16x16x32_bf16 v[208:211], v[212:215], a[180:183], v[208:211]
ds_write_b16 v248, v169 offset:0
v_mfma_f32_16x16x32_bf16 v[208:211], v[224:227], a[176:179], v[208:211]
s_waitcnt lgkmcnt(4)
ds_write_b16_d16_hi v248, v169 offset:4
v_mfma_f32_16x16x32_bf16 v[208:211], v[200:203], a[184:187], v[208:211]
s_waitcnt lgkmcnt(2)
v_exp_f32 v176, v176
v_mfma_f32_16x16x32_bf16 v[200:203], v[216:219], a[184:187], 0
v_exp_f32 v178, v178
v_mfma_f32_16x16x32_bf16 v[200:203], v[196:199], a[188:191], v[200:203]
v_add_f32 v180, v180, v172
v_add_f32 v180, v180, v174
v_mfma_f32_16x16x32_bf16 v[200:203], v[220:223], a[180:183], v[200:203]
v_cvt_pk_bf16_f32 v94, v208, v209
v_cvt_pk_bf16_f32 v95, v210, v211
v_mfma_f32_16x16x32_bf16 v[200:203], v[228:231], a[176:179], v[200:203]
v_add_f32 v180, v180, v176
v_add_f32 v180, v180, v178
v_mfma_f32_16x16x32_bf16 v[204:207], v[228:231], a[160:163], 0
v_cvt_pk_bf16_f32 v173, v172, v174
v_add_f32_dpp v180, v180, v180 row_ror:8 row_mask:0xf bank_mask:0xf
v_mfma_f32_16x16x32_bf16 v[204:207], v[220:223], a[164:167], v[204:207]
ds_write_b16 v248, v173 offset:272
v_mfma_f32_16x16x32_bf16 v[204:207], v[216:219], a[168:171], v[204:207]
ds_write_b16_d16_hi v248, v173 offset:276
v_mfma_f32_16x16x32_bf16 v[204:207], v[196:199], a[172:175], v[204:207]
v_cvt_pk_bf16_f32 v60, v200, v201
v_cvt_pk_bf16_f32 v61, v202, v203
v_mfma_f32_16x16x32_bf16 v[212:215], v[24:27], v[96:99], 0
v_cvt_pk_bf16_f32 v177, v176, v178
v_add_f32_dpp v180, v180, v180 row_ror:4 row_mask:0xf bank_mask:0xf
v_mfma_f32_16x16x32_bf16 v[212:215], v[28:31], v[100:103], v[212:215]
ds_write_b16 v248, v177 offset:544
v_mfma_f32_16x16x32_bf16 v[192:195], v[36:39], v[100:103], 0
ds_write_b32 v250, v180 offset:256
v_mfma_f32_16x16x32_bf16 v[192:195], v[32:35], v[96:99], v[192:195]
ds_write_b16_d16_hi v248, v177 offset:548
v_mfma_f32_16x16x32_bf16 v[200:203], v[40:43], v[96:99], 0
v_cvt_pk_bf16_f32 v56, v204, v205
v_cvt_pk_bf16_f32 v57, v206, v207
v_mfma_f32_16x16x32_bf16 v[200:203], v[44:47], v[100:103], v[200:203]
v_cvt_pk_bf16_f32 v90, v232, v233
v_cvt_pk_bf16_f32 v91, v234, v235
v_mfma_f32_16x16x32_bf16 v[204:207], v[12:15], v[100:103], 0
v_exp_f32 v192, v192
v_mfma_f32_16x16x32_bf16 v[204:207], v[8:11], v[96:99], v[204:207]
v_exp_f32 v193, v193
v_mfma_f32_16x16x32_bf16 v[208:211], v[16:19], v[96:99], 0
v_exp_f32 v194, v194
v_mfma_f32_16x16x32_bf16 v[208:211], v[20:23], v[100:103], v[208:211]
v_exp_f32 v195, v195
v_mfma_f32_32x32x16_bf16 v[168:183], v[236:239], v[116:119], 0
buffer_store_dwordx4 v[156:159], v244, s[20:23], s53 offen offset:0 nt
buffer_store_dwordx4 v[160:163], v244, s[20:23], s53 offen offset:256 nt
v_exp_f32 v204, v204
v_exp_f32 v205, v205
v_mfma_f32_16x16x32_bf16 v[224:227], v[196:199], a[156:159], 0
s_add_u32 s53, s46, 0
v_exp_f32 v206, v206
v_mfma_f32_16x16x32_bf16 v[224:227], v[216:219], a[152:155], v[224:227]
v_exp_f32 v207, v207
v_mfma_f32_16x16x32_bf16 v[224:227], v[220:223], a[148:151], v[224:227]
v_cvt_pk_bf16_f32 v106, v204, v205
v_cvt_pk_bf16_f32 v107, v206, v207
v_mfma_f32_16x16x32_bf16 v[224:227], v[228:231], a[144:147], v[224:227]
v_exp_f32 v208, v208
v_mfma_f32_16x16x32_bf16 v[232:235], v[228:231], a[128:131], 0
v_exp_f32 v209, v209
v_mfma_f32_16x16x32_bf16 v[232:235], v[220:223], a[132:135], v[232:235]
v_exp_f32 v210, v210
v_mfma_f32_16x16x32_bf16 v[232:235], v[216:219], a[136:139], v[232:235]
v_exp_f32 v211, v211
v_mfma_f32_16x16x32_bf16 v[232:235], v[196:199], a[140:143], v[232:235]
v_cvt_pk_bf16_f32 v108, v208, v209
v_cvt_pk_bf16_f32 v109, v210, v211
v_mfma_f32_16x16x32_bf16 v[204:207], a[0:3], v[228:231], 0
v_cvt_pk_bf16_f32 v112, v192, v193
v_cvt_pk_bf16_f32 v113, v194, v195
v_mfma_f32_16x16x32_bf16 v[204:207], a[4:7], v[220:223], v[204:207]
v_exp_f32 v200, v200
v_mfma_f32_16x16x32_bf16 v[204:207], a[8:11], v[216:219], v[204:207]
v_exp_f32 v201, v201
v_mfma_f32_16x16x32_bf16 v[204:207], a[12:15], v[196:199], v[204:207]
buffer_load_dwordx4 v243, s[16:19], s98 offen offset:0 nt lds
v_mfma_f32_16x16x32_bf16 v[208:211], a[28:31], v[196:199], 0
v_exp_f32 v202, v202
v_mfma_f32_16x16x32_bf16 v[208:211], a[24:27], v[216:219], v[208:211]
v_exp_f32 v203, v203
v_mfma_f32_16x16x32_bf16 v[208:211], a[20:23], v[220:223], v[208:211]
v_cvt_pk_bf16_f32 v114, v200, v201
v_cvt_pk_bf16_f32 v115, v202, v203
v_mfma_f32_16x16x32_bf16 v[208:211], a[16:19], v[228:231], v[208:211]
v_cvt_pk_bf16_f32 v96, v204, v205
v_cvt_pk_bf16_f32 v97, v206, v207
v_mfma_f32_16x16x32_bf16 v[204:207], a[32:35], v[228:231], 0
v_exp_f32 v188, v188
v_mfma_f32_16x16x32_bf16 v[204:207], a[36:39], v[220:223], v[204:207]
v_exp_f32 v189, v189
v_mfma_f32_16x16x32_bf16 v[204:207], a[40:43], v[216:219], v[204:207]
s_nop 0
v_cvt_pk_bf16_f32 v98, v208, v209
v_cvt_pk_bf16_f32 v99, v210, v211
v_mfma_f32_16x16x32_bf16 v[204:207], a[44:47], v[196:199], v[204:207]
v_exp_f32 v190, v190
v_mfma_f32_16x16x32_bf16 v[192:195], a[60:63], v[196:199], 0
v_exp_f32 v191, v191
v_mfma_f32_16x16x32_bf16 v[192:195], a[56:59], v[216:219], v[192:195]
v_cvt_pk_bf16_f32 v104, v188, v189
v_cvt_pk_bf16_f32 v105, v190, v191
v_mfma_f32_16x16x32_bf16 v[192:195], a[52:55], v[220:223], v[192:195]
ds_read_b128 v[188:191], v242 offset:16896
v_cvt_pk_bf16_f32 v100, v204, v205
v_mfma_f32_16x16x32_bf16 v[192:195], a[48:51], v[228:231], v[192:195]
v_cvt_pk_bf16_f32 v101, v206, v207
v_cvt_pk_bf16_f32 v52, v224, v225
v_mfma_f32_16x16x32_bf16 v[152:155], a[192:195], v[228:231], 0
v_exp_f32 v212, v212
v_mfma_f32_16x16x32_bf16 v[152:155], a[196:199], v[220:223], v[152:155]
v_exp_f32 v213, v213
v_mfma_f32_16x16x32_bf16 v[152:155], a[200:203], v[216:219], v[152:155]
s_nop 0
v_cvt_pk_bf16_f32 v102, v192, v193
v_cvt_pk_bf16_f32 v103, v194, v195
v_mfma_f32_16x16x32_bf16 v[152:155], a[204:207], v[196:199], v[152:155]
v_exp_f32 v214, v214
v_mfma_f32_16x16x32_bf16 v[156:159], a[220:223], v[196:199], 0
v_exp_f32 v215, v215
v_mfma_f32_16x16x32_bf16 v[156:159], a[216:219], v[216:219], v[156:159]
v_cvt_pk_bf16_f32 v110, v212, v213
v_cvt_pk_bf16_f32 v111, v214, v215
v_mfma_f32_16x16x32_bf16 v[156:159], a[212:215], v[220:223], v[156:159]
ds_read_b128 v[192:195], v242 offset:4224
ds_read_b128 v[200:203], v242 offset:4480
v_mfma_f32_16x16x32_bf16 v[156:159], a[208:211], v[228:231], v[156:159]
buffer_load_dwordx4 v243, s[16:19], s99 offen offset:1056 nt lds
v_mfma_f32_16x16x32_bf16 v[160:163], a[224:227], v[228:231], 0
ds_read_b128 v[204:207], v242 offset:4736
ds_read_b128 v[212:215], v242 offset:17152
v_mfma_f32_16x16x32_bf16 v[160:163], a[228:231], v[220:223], v[160:163]
v_cvt_pk_bf16_f32 v53, v226, v227
v_cvt_pk_bf16_f32 v48, v232, v233
v_mfma_f32_16x16x32_bf16 v[160:163], a[232:235], v[216:219], v[160:163]
ds_read_b128 v[224:227], v242 offset:17408
v_cvt_pk_bf16_f32 v49, v234, v235
v_mfma_f32_16x16x32_bf16 v[160:163], a[236:239], v[196:199], v[160:163]
s_waitcnt lgkmcnt(5)
ds_read_b128 v[232:235], v242 offset:17664
v_mfma_f32_16x16x32_bf16 v[208:211], v[8:11], v[96:99], 0
s_waitcnt lgkmcnt(5)
v_mfma_f32_16x16x32_bf16 v[208:211], v[12:15], v[100:103], v[208:211]
s_nop 2
v_mfma_f32_16x16x32_bf16 v[164:167], a[252:255], v[196:199], 0
ds_read_b128 v[196:199], v242 offset:4992
s_nop 0
v_mfma_f32_16x16x32_bf16 v[164:167], a[248:251], v[216:219], v[164:167]
v_mov_b64 v[216:217], s[96:97]
v_mov_b64 v[218:219], s[96:97]
v_mfma_f32_16x16x32_bf16 v[164:167], a[244:247], v[220:223], v[164:167]
v_exp_f32 v208, v208
v_mfma_f32_16x16x32_bf16 v[164:167], a[240:243], v[228:231], v[164:167]
s_waitcnt lgkmcnt(1)
v_exp_f32 v209, v209
v_mfma_f32_16x16x32_bf16 v[220:223], v[4:7], v[100:103], 0
v_exp_f32 v210, v210
v_mfma_f32_16x16x32_bf16 v[220:223], v[0:3], v[96:99], v[220:223]
v_exp_f32 v211, v211
v_smfmac_f32_16x16x64_bf16 v[216:219], v[238:241], v[96:103], v251
v_cvt_pk_bf16_f32 v122, v208, v209
v_mfma_f32_16x16x32_bf16 v[228:231], v[192:195], a[128:131], 0
v_cvt_pk_bf16_f32 v123, v210, v211
s_nop 0
v_mfma_f32_16x16x32_bf16 v[228:231], v[200:203], a[132:135], v[228:231]
s_waitcnt lgkmcnt(0)
v_exp_f32 v220, v220
v_mfma_f32_16x16x32_bf16 v[228:231], v[204:207], a[136:139], v[228:231]
v_exp_f32 v221, v221
v_mfma_f32_16x16x32_bf16 v[228:231], v[196:199], a[140:143], v[228:231]
v_exp_f32 v222, v222
v_mfma_f32_16x16x32_bf16 v[208:211], v[196:199], a[156:159], 0
v_exp_f32 v223, v223
v_mfma_f32_16x16x32_bf16 v[208:211], v[204:207], a[152:155], v[208:211]
v_cvt_pk_bf16_f32 v120, v220, v221
v_cvt_pk_bf16_f32 v121, v222, v223
v_mfma_f32_16x16x32_bf16 v[208:211], v[200:203], a[148:151], v[208:211]
v_add_f32 v216, v216, v217
v_add_f32 v218, v218, v219
v_mfma_f32_16x16x32_bf16 v[208:211], v[192:195], a[144:147], v[208:211]
v_exp_f32 v216, v216
v_mfma_f32_16x16x32_bf16 v[220:223], v[192:195], a[160:163], 0
v_exp_f32 v218, v218
v_mfma_f32_16x16x32_bf16 v[220:223], v[200:203], a[164:167], v[220:223]
v_perm_b32 v132, v218, v216, v252
v_perm_b32 v133, v218, v216, v253
v_mfma_f32_16x16x32_bf16 v[220:223], v[204:207], a[168:171], v[220:223]
s_nop 0
v_cvt_pk_bf16_f32 v54, v208, v209
v_cvt_pk_bf16_f32 v55, v210, v211
v_mfma_f32_16x16x32_bf16 v[220:223], v[196:199], a[172:175], v[220:223]
buffer_load_dwordx4 v243, s[16:19], s100 offen offset:2112 nt lds
v_mfma_f32_16x16x32_bf16 v[208:211], v[196:199], a[188:191], 0
v_cvt_pk_bf16_f32 v50, v228, v229
v_cvt_pk_bf16_f32 v51, v230, v231
v_mfma_f32_16x16x32_bf16 v[208:211], v[204:207], a[184:187], v[208:211]
s_nop 1
v_mfma_f32_16x16x32_bf16 v[208:211], v[200:203], a[180:183], v[208:211]
v_cvt_pk_bf16_f32 v58, v220, v221
v_cvt_pk_bf16_f32 v59, v222, v223
v_mfma_f32_16x16x32_bf16 v[208:211], v[192:195], a[176:179], v[208:211]
s_nop 2
v_mfma_f32_16x16x32_bf16 v[192:195], v[16:19], v[96:99], 0
s_nop 2
v_mfma_f32_16x16x32_bf16 v[192:195], v[20:23], v[100:103], v[192:195]
v_mov_b64 v[196:197], 0
v_cvt_pk_bf16_f32 v62, v208, v209
v_mfma_f32_16x16x32_bf16 v[200:203], v[36:39], v[100:103], 0
v_cvt_pk_bf16_f32 v63, v210, v211
s_nop 0
v_mfma_f32_16x16x32_bf16 v[200:203], v[32:35], v[96:99], v[200:203]
s_nop 2
v_mfma_f32_16x16x32_bf16 v[204:207], v[24:27], v[96:99], 0
v_exp_f32 v192, v192
v_mfma_f32_16x16x32_bf16 v[204:207], v[28:31], v[100:103], v[204:207]
v_exp_f32 v193, v193
v_smfmac_f32_16x16x64_bf16 v[196:199], v[184:187], v[104:111], v251
v_cvt_pk_bf16_f32 v124, v192, v193
v_smfmac_f32_16x16x64_bf16 v[196:199], v[184:187], v[112:119], v251 abid:1
s_nop 2
v_mfma_f32_16x16x32_bf16 v[208:211], v[232:235], a[188:191], 0
v_exp_f32 v194, v194
v_mfma_f32_16x16x32_bf16 v[208:211], v[224:227], a[184:187], v[208:211]
v_exp_f32 v195, v195
v_mfma_f32_16x16x32_bf16 v[208:211], v[212:215], a[180:183], v[208:211]
v_cvt_pk_bf16_f32 v125, v194, v195
v_add_f32 v196, v196, v197
v_mfma_f32_16x16x32_bf16 v[208:211], v[188:191], a[176:179], v[208:211]
v_exp_f32 v204, v204
v_mfma_f32_16x16x32_bf16 v[192:195], v[188:191], a[160:163], 0
v_exp_f32 v205, v205
v_mfma_f32_16x16x32_bf16 v[192:195], v[212:215], a[164:167], v[192:195]
v_exp_f32 v206, v206
v_mfma_f32_16x16x32_bf16 v[192:195], v[224:227], a[168:171], v[192:195]
v_exp_f32 v207, v207
v_mfma_f32_16x16x32_bf16 v[192:195], v[232:235], a[172:175], v[192:195]
buffer_load_dwordx4 v243, s[16:19], s101 offen offset:3168 nt lds
v_mfma_f32_16x16x32_bf16 v[216:219], v[232:235], a[156:159], 0
s_mov_b32 m0, s58
v_cvt_pk_bf16_f32 v126, v204, v205
v_cvt_pk_bf16_f32 v127, v206, v207
v_mfma_f32_16x16x32_bf16 v[216:219], v[224:227], a[152:155], v[216:219]
v_cvt_pk_bf16_f32 v92, v208, v209
v_cvt_pk_bf16_f32 v93, v210, v211
v_mfma_f32_16x16x32_bf16 v[216:219], v[212:215], a[148:151], v[216:219]
v_cvt_pk_bf16_f32 v88, v192, v193
v_cvt_pk_bf16_f32 v89, v194, v195
v_mfma_f32_16x16x32_bf16 v[216:219], v[188:191], a[144:147], v[216:219]
v_rcp_f32 v254, v196
v_mfma_f32_16x16x32_bf16 v[192:195], v[188:191], a[128:131], 0
v_max3_f32 v255, v255, v196, v254
s_nop 0
v_mfma_f32_16x16x32_bf16 v[192:195], v[212:215], a[132:135], v[192:195]
v_exp_f32 v200, v200
v_mfma_f32_16x16x32_bf16 v[192:195], v[224:227], a[136:139], v[192:195]
s_nop 0
v_cvt_pk_bf16_f32 v84, v216, v217
v_cvt_pk_bf16_f32 v85, v218, v219
v_mfma_f32_16x16x32_bf16 v[192:195], v[232:235], a[140:143], v[192:195]
L_h2:
s_cbranch_execz L_ret
v_exp_f32 v201, v201
v_mfma_f32_16x16x32_bf16 v[204:207], v[40:43], v[96:99], 0
ds_read_b128 v[208:211], v249 offset:0
ds_read_b128 v[216:219], v249 offset:272
v_mfma_f32_16x16x32_bf16 v[204:207], v[44:47], v[100:103], v[204:207]
ds_read_b128 v[220:223], v249 offset:544
v_cvt_pk_bf16_f32 v128, v200, v201
v_mfma_f32_16x16x32_bf16 v[168:171], v[48:51], v[104:107], v[168:171]
v_cvt_pk_bf16_f32 v80, v192, v193
v_cvt_pk_bf16_f32 v81, v194, v195
v_mfma_f32_16x16x32_bf16 v[168:171], v[64:67], v[108:111], v[168:171]
v_exp_f32 v202, v202
v_mfma_f32_16x16x32_bf16 v[168:171], v[80:83], v[112:115], v[168:171]
v_exp_f32 v203, v203
v_mfma_f32_16x16x32_bf16 v[172:175], v[84:87], v[112:115], v[172:175]
v_cvt_pk_bf16_f32 v129, v202, v203
s_nop 0
v_mfma_f32_16x16x32_bf16 v[172:175], v[52:55], v[104:107], v[172:175]
v_exp_f32 v204, v204
v_mfma_f32_16x16x32_bf16 v[172:175], v[68:71], v[108:111], v[172:175]
v_exp_f32 v205, v205
v_mfma_f32_16x16x32_bf16 v[176:179], v[72:75], v[108:111], v[176:179]
v_exp_f32 v206, v206
v_mfma_f32_16x16x32_bf16 v[176:179], v[88:91], v[112:115], v[176:179]
v_exp_f32 v207, v207
v_mfma_f32_16x16x32_bf16 v[176:179], v[56:59], v[104:107], v[176:179]
v_cvt_pk_bf16_f32 v130, v204, v205
v_cvt_pk_bf16_f32 v131, v206, v207
L_entryf:
v_mfma_f32_16x16x32_bf16 v[180:183], v[60:63], v[104:107], v[180:183]
v_fmac_f32 v136, v168, v254
v_fmac_f32 v137, v169, v254
v_mfma_f32_16x16x32_bf16 v[180:183], v[76:79], v[108:111], v[180:183]
v_fmac_f32 v138, v170, v254
v_fmac_f32 v139, v171, v254
v_mfma_f32_16x16x32_bf16 v[180:183], v[92:95], v[112:115], v[180:183]
s_waitcnt lgkmcnt(1)
v_fmac_f32 v144, v176, v254
v_fmac_f32 v145, v177, v254
v_mfma_f32_16x16x32_bf16 v[192:195], a[0:3], v[188:191], 0
s_waitcnt lgkmcnt(0)
v_fmac_f32 v146, v178, v254
v_fmac_f32 v147, v179, v254
v_mfma_f32_16x16x32_bf16 v[192:195], a[4:7], v[212:215], v[192:195]
s_mov_b64 vcc, s[14:15]
v_cvt_pk_bf16_f32 v144, v144, v145
v_fmac_f32 v148, v180, v254
v_mfma_f32_16x16x32_bf16 v[192:195], a[8:11], v[224:227], v[192:195]
v_fmac_f32 v149, v181, v254
v_fmac_f32 v150, v182, v254
v_mfma_f32_16x16x32_bf16 v[192:195], a[12:15], v[232:235], v[192:195]
v_fmac_f32 v151, v183, v254
v_cvt_pk_bf16_f32 v145, v146, v147
v_mfma_f32_16x16x32_bf16 v[196:199], a[28:31], v[232:235], 0
v_cvt_pk_bf16_f32 v146, v148, v149
v_cvt_pk_bf16_f32 v147, v150, v151
v_mfma_f32_16x16x32_bf16 v[196:199], a[24:27], v[224:227], v[196:199]
v_cvt_pk_bf16_f32 v136, v136, v137
v_fmac_f32 v140, v172, v254
v_mfma_f32_16x16x32_bf16 v[196:199], a[20:23], v[212:215], v[196:199]
v_cvt_pk_bf16_f32 v96, v192, v193
v_cvt_pk_bf16_f32 v97, v194, v195
v_mfma_f32_16x16x32_bf16 v[196:199], a[16:19], v[188:191], v[196:199]
v_fmac_f32 v141, v173, v254
v_fmac_f32 v142, v174, v254
v_mfma_f32_16x16x32_bf16 v[192:195], a[32:35], v[188:191], 0
v_fmac_f32 v143, v175, v254
v_cvt_pk_bf16_f32 v137, v138, v139
v_mfma_f32_16x16x32_bf16 v[192:195], a[36:39], v[212:215], v[192:195]
v_cvt_pk_bf16_f32 v138, v140, v141
v_cvt_pk_bf16_f32 v139, v142, v143
v_mfma_f32_16x16x32_bf16 v[192:195], a[40:43], v[224:227], v[192:195]
v_cvt_pk_bf16_f32 v98, v196, v197
v_cvt_pk_bf16_f32 v99, v198, v199
v_mfma_f32_16x16x32_bf16 v[192:195], a[44:47], v[232:235], v[192:195]
v_mov_b64 v[196:197], 0
v_mov_b64 v[198:199], 0
v_mfma_f32_16x16x32_bf16 v[200:203], a[60:63], v[232:235], 0
v_pk_max_i16 v136, v136, 0
v_pk_max_i16 v137, v137, 0
v_mfma_f32_16x16x32_bf16 v[200:203], a[56:59], v[224:227], v[200:203]
v_pk_max_i16 v138, v138, 0
v_pk_max_i16 v139, v139, 0
v_mfma_f32_16x16x32_bf16 v[200:203], a[52:55], v[212:215], v[200:203]
v_mov_b64 v[204:205], 0
v_mov_b64 v[206:207], 0
v_mfma_f32_16x16x32_bf16 v[200:203], a[48:51], v[188:191], v[200:203]
v_cvt_pk_bf16_f32 v100, v192, v193
v_cvt_pk_bf16_f32 v101, v194, v195
v_smfmac_f32_16x16x64_bf16 v[196:199], v[208:211], v[48:55], v251
v_pk_max_i16 v144, v144, 0
v_smfmac_f32_16x16x64_bf16 v[196:199], v[216:219], v[64:71], v251
v_pk_max_i16 v145, v145, 0
v_smfmac_f32_16x16x64_bf16 v[196:199], v[220:223], v[80:87], v251
s_nop 0
v_cvt_pk_bf16_f32 v102, v200, v201
v_smfmac_f32_16x16x64_bf16 v[204:207], v[220:223], v[88:95], v251
v_cvt_pk_bf16_f32 v103, v202, v203
v_smfmac_f32_16x16x64_bf16 v[204:207], v[216:219], v[72:79], v251
v_mov_b64 v[192:193], s[96:97]
v_smfmac_f32_16x16x64_bf16 v[204:207], v[208:211], v[56:63], v251
v_mov_b64 v[194:195], s[96:97]
v_mfma_f32_16x16x32_bf16 v[200:203], v[4:7], v[100:103], 0
v_pk_max_i16 v146, v146, 0
v_pk_max_i16 v147, v147, 0
v_mfma_f32_16x16x32_bf16 v[200:203], v[0:3], v[96:99], v[200:203]
v_cndmask_b32_dpp v140, v144, v136, vcc quad_perm:[1,0,3,2] row_mask:0xf bank_mask:0xf
v_cndmask_b32_dpp v141, v145, v137, vcc quad_perm:[1,0,3,2] row_mask:0xf bank_mask:0xf
v_smfmac_f32_16x16x64_bf16 v[192:195], v[238:241], v[96:103], v251
v_cndmask_b32_dpp v142, v146, v138, vcc quad_perm:[1,0,3,2] row_mask:0xf bank_mask:0xf
v_mfma_f32_16x16x32_bf16 v[208:211], v[16:19], v[96:99], 0
v_cndmask_b32_dpp v143, v147, v139, vcc quad_perm:[1,0,3,2] row_mask:0xf bank_mask:0xf
v_add_f32 v196, v196, v197
v_mfma_f32_16x16x32_bf16 v[208:211], v[20:23], v[100:103], v[208:211]
s_not_b64 vcc, vcc
ds_write_b32 v250, v196 offset:0
v_mfma_f32_16x16x32_bf16 v[216:219], v[12:15], v[100:103], 0
v_cndmask_b32_dpp v144, v136, v144, vcc quad_perm:[1,0,3,2] row_mask:0xf bank_mask:0xf
v_cndmask_b32_dpp v145, v137, v145, vcc quad_perm:[1,0,3,2] row_mask:0xf bank_mask:0xf
v_mfma_f32_16x16x32_bf16 v[216:219], v[8:11], v[96:99], v[216:219]
v_cndmask_b32_dpp v146, v138, v146, vcc quad_perm:[1,0,3,2] row_mask:0xf bank_mask:0xf
v_cndmask_b32_dpp v147, v139, v147, vcc quad_perm:[1,0,3,2] row_mask:0xf bank_mask:0xf
v_mfma_f32_16x16x32_bf16 v[220:223], v[24:27], v[96:99], 0
v_add_f32 v198, v198, v199
v_add_f32 v192, v192, v193
v_mfma_f32_16x16x32_bf16 v[220:223], v[28:31], v[100:103], v[220:223]
ds_write_b32 v250, v198 offset:64
v_mfma_f32_32x32x16_bf16 v[168:183], v[236:239], v[132:135], 0
buffer_store_dwordx4 v[140:143], v244, s[20:23], s52 offen offset:0 nt
buffer_store_dwordx4 v[144:147], v244, s[20:23], s52 offen offset:256 nt
v_exp_f32 v200, v200
v_exp_f32 v201, v201
v_mfma_f32_16x16x32_bf16 v[136:139], a[192:195], v[188:191], 0
s_add_u32 s52, s46, 16384
v_exp_f32 v202, v202
v_mfma_f32_16x16x32_bf16 v[136:139], a[196:199], v[212:215], v[136:139]
v_exp_f32 v203, v203
v_mfma_f32_16x16x32_bf16 v[136:139], a[200:203], v[224:227], v[136:139]
v_exp_f32 v216, v216
v_mfma_f32_16x16x32_bf16 v[136:139], a[204:207], v[232:235], v[136:139]
v_exp_f32 v217, v217
v_mfma_f32_16x16x32_bf16 v[140:143], a[220:223], v[232:235], 0
v_exp_f32 v218, v218
v_mfma_f32_16x16x32_bf16 v[140:143], a[216:219], v[224:227], v[140:143]
v_exp_f32 v219, v219
v_mfma_f32_16x16x32_bf16 v[140:143], a[212:215], v[212:215], v[140:143]
v_cvt_pk_bf16_f32 v104, v200, v201
v_cvt_pk_bf16_f32 v105, v202, v203
v_mfma_f32_16x16x32_bf16 v[140:143], a[208:211], v[188:191], v[140:143]
v_cvt_pk_bf16_f32 v106, v216, v217
v_cvt_pk_bf16_f32 v107, v218, v219
v_mfma_f32_16x16x32_bf16 v[144:147], a[224:227], v[188:191], 0
v_add_f32 v194, v194, v195
v_add_f32 v204, v204, v205
v_mfma_f32_16x16x32_bf16 v[144:147], a[228:231], v[212:215], v[144:147]
ds_write_b32 v250, v204 offset:128
v_mfma_f32_16x16x32_bf16 v[144:147], a[232:235], v[224:227], v[144:147]
v_exp_f32 v192, v192
v_mfma_f32_16x16x32_bf16 v[144:147], a[236:239], v[232:235], v[144:147]
v_exp_f32 v194, v194
v_mfma_f32_16x16x32_bf16 v[148:151], a[252:255], v[232:235], 0
v_perm_b32 v116, v194, v192, v252
v_perm_b32 v117, v194, v192, v253
v_mfma_f32_16x16x32_bf16 v[148:151], a[248:251], v[224:227], v[148:151]
v_mov_b64 v[196:197], 0
v_add_f32 v206, v206, v207
v_mfma_f32_16x16x32_bf16 v[148:151], a[244:247], v[212:215], v[148:151]
ds_write_b32 v250, v206 offset:192
v_mfma_f32_16x16x32_bf16 v[148:151], a[240:243], v[188:191], v[148:151]
v_exp_f32 v220, v220
v_mfma_f32_16x16x32_bf16 v[188:191], v[40:43], v[96:99], 0
v_exp_f32 v221, v221
v_mfma_f32_16x16x32_bf16 v[188:191], v[44:47], v[100:103], v[188:191]
v_exp_f32 v222, v222
v_smfmac_f32_16x16x64_bf16 v[196:199], v[184:187], v[120:127], v251
ds_read_b128 v[200:203], v242 offset:4224
v_cvt_pk_bf16_f32 v110, v220, v221
v_smfmac_f32_16x16x64_bf16 v[196:199], v[184:187], v[128:135], v251 abid:1
ds_read_b128 v[212:215], v242 offset:4736
ds_read_b128 v[216:219], v242 offset:4992
v_mfma_f32_16x16x32_bf16 v[168:171], v[80:83], v[128:131], v[168:171]
v_exp_f32 v223, v223
v_mfma_f32_16x16x32_bf16 v[168:171], v[64:67], v[124:127], v[168:171]
v_cvt_pk_bf16_f32 v111, v222, v223
v_add_u32 v250, 1728, v250
v_mfma_f32_16x16x32_bf16 v[168:171], v[48:51], v[120:123], v[168:171]
v_exp_f32 v208, v208
v_mfma_f32_16x16x32_bf16 v[172:175], v[52:55], v[120:123], v[172:175]
v_exp_f32 v209, v209
v_mfma_f32_16x16x32_bf16 v[172:175], v[68:71], v[124:127], v[172:175]
v_exp_f32 v210, v210
v_mfma_f32_16x16x32_bf16 v[172:175], v[84:87], v[128:131], v[172:175]
v_exp_f32 v211, v211
v_mfma_f32_16x16x32_bf16 v[176:179], v[88:91], v[128:131], v[176:179]
v_cvt_pk_bf16_f32 v108, v208, v209
v_cvt_pk_bf16_f32 v109, v210, v211
v_mfma_f32_16x16x32_bf16 v[176:179], v[72:75], v[124:127], v[176:179]
ds_read_b128 v[208:211], v242 offset:4480
v_add_f32 v196, v196, v197
v_mfma_f32_16x16x32_bf16 v[176:179], v[56:59], v[120:123], v[176:179]
v_rcp_f32 v254, v196
v_mfma_f32_16x16x32_bf16 v[180:183], v[60:63], v[120:123], v[180:183]
v_max3_f32 v255, v255, v196, v254
v_fmac_f32 v152, v168, v254
v_mfma_f32_16x16x32_bf16 v[180:183], v[76:79], v[124:127], v[180:183]
v_fmac_f32 v153, v169, v254
v_fmac_f32 v154, v170, v254
v_mfma_f32_16x16x32_bf16 v[180:183], v[92:95], v[128:131], v[180:183]
s_waitcnt lgkmcnt(3)
v_fmac_f32 v160, v176, v254
v_fmac_f32 v161, v177, v254
v_mfma_f32_16x16x32_bf16 v[192:195], v[32:35], v[96:99], 0
s_waitcnt lgkmcnt(1)
v_fmac_f32 v155, v171, v254
v_cvt_pk_bf16_f32 v152, v152, v153
v_mfma_f32_16x16x32_bf16 v[192:195], v[36:39], v[100:103], v[192:195]
s_waitcnt lgkmcnt(0)
v_fmac_f32 v162, v178, v254
v_fmac_f32 v163, v179, v254
v_mfma_f32_16x16x32_bf16 v[220:223], a[0:3], v[200:203], 0
s_mov_b64 vcc, s[14:15]
v_cvt_pk_bf16_f32 v160, v160, v161
v_fmac_f32 v156, v172, v254
v_mfma_f32_16x16x32_bf16 v[220:223], a[4:7], v[208:211], v[220:223]
v_fmac_f32 v157, v173, v254
v_fmac_f32 v158, v174, v254
v_mfma_f32_16x16x32_bf16 v[220:223], a[8:11], v[212:215], v[220:223]
v_fmac_f32 v159, v175, v254
v_cvt_pk_bf16_f32 v153, v154, v155
v_mfma_f32_16x16x32_bf16 v[220:223], a[12:15], v[216:219], v[220:223]
v_fmac_f32 v164, v180, v254
v_fmac_f32 v165, v181, v254
v_mfma_f32_16x16x32_bf16 v[224:227], a[28:31], v[216:219], 0
v_fmac_f32 v166, v182, v254
v_fmac_f32 v167, v183, v254
v_mfma_f32_16x16x32_bf16 v[224:227], a[24:27], v[212:215], v[224:227]
v_cvt_pk_bf16_f32 v161, v162, v163
v_cvt_pk_bf16_f32 v154, v156, v157
v_mfma_f32_16x16x32_bf16 v[224:227], a[20:23], v[208:211], v[224:227]
v_cvt_pk_bf16_f32 v155, v158, v159
v_cvt_pk_bf16_f32 v162, v164, v165
v_mfma_f32_16x16x32_bf16 v[224:227], a[16:19], v[200:203], v[224:227]
v_cvt_pk_bf16_f32 v163, v166, v167
v_pk_max_i16 v152, v152, 0
v_mfma_f32_16x16x32_bf16 v[228:231], a[32:35], v[200:203], 0
v_pk_max_i16 v153, v153, 0
v_pk_max_i16 v154, v154, 0
v_mfma_f32_16x16x32_bf16 v[228:231], a[36:39], v[208:211], v[228:231]
v_pk_max_i16 v155, v155, 0
v_pk_max_i16 v160, v160, 0
v_mfma_f32_16x16x32_bf16 v[228:231], a[40:43], v[212:215], v[228:231]
v_pk_max_i16 v161, v161, 0
v_pk_max_i16 v162, v162, 0
v_mfma_f32_16x16x32_bf16 v[228:231], a[44:47], v[216:219], v[228:231]
v_pk_max_i16 v163, v163, 0
v_cndmask_b32_dpp v156, v160, v152, vcc quad_perm:[1,0,3,2] row_mask:0xf bank_mask:0xf
v_mfma_f32_16x16x32_bf16 v[196:199], a[60:63], v[216:219], 0
v_cndmask_b32_dpp v157, v161, v153, vcc quad_perm:[1,0,3,2] row_mask:0xf bank_mask:0xf
v_cndmask_b32_dpp v158, v162, v154, vcc quad_perm:[1,0,3,2] row_mask:0xf bank_mask:0xf
v_mfma_f32_16x16x32_bf16 v[196:199], a[56:59], v[212:215], v[196:199]
v_cndmask_b32_dpp v159, v163, v155, vcc quad_perm:[1,0,3,2] row_mask:0xf bank_mask:0xf
v_cvt_pk_bf16_f32 v96, v220, v221
v_mfma_f32_16x16x32_bf16 v[196:199], a[52:55], v[208:211], v[196:199]
s_not_b64 vcc, vcc
v_cndmask_b32_dpp v160, v152, v160, vcc quad_perm:[1,0,3,2] row_mask:0xf bank_mask:0xf
v_cndmask_b32_dpp v161, v153, v161, vcc quad_perm:[1,0,3,2] row_mask:0xf bank_mask:0xf
v_mfma_f32_16x16x32_bf16 v[196:199], a[48:51], v[200:203], v[196:199]
v_cndmask_b32_dpp v162, v154, v162, vcc quad_perm:[1,0,3,2] row_mask:0xf bank_mask:0xf
v_cndmask_b32_dpp v163, v155, v163, vcc quad_perm:[1,0,3,2] row_mask:0xf bank_mask:0xf
v_mfma_f32_32x32x16_bf16 v[168:183], v[236:239], v[116:119], 0
buffer_store_dwordx4 v[156:159], v244, s[20:23], s53 offen offset:0 nt
buffer_store_dwordx4 v[160:163], v244, s[20:23], s53 offen offset:256 nt
v_cvt_pk_bf16_f32 v100, v228, v229
v_cvt_pk_bf16_f32 v101, v230, v231
v_exp_f32 v188, v188
v_mfma_f32_16x16x32_bf16 v[152:155], a[192:195], v[200:203], 0
s_add_u32 s53, s46, 4096
v_cvt_pk_bf16_f32 v102, v196, v197
v_cvt_pk_bf16_f32 v103, v198, v199
v_mfma_f32_16x16x32_bf16 v[152:155], a[196:199], v[208:211], v[152:155]
s_add_u32 s46, s46, 13107200
v_exp_f32 v189, v189
v_mfma_f32_16x16x32_bf16 v[152:155], a[200:203], v[212:215], v[152:155]
v_exp_f32 v190, v190
v_mfma_f32_16x16x32_bf16 v[152:155], a[204:207], v[216:219], v[152:155]
v_exp_f32 v191, v191
v_mfma_f32_16x16x32_bf16 v[156:159], a[220:223], v[216:219], 0
v_cvt_pk_bf16_f32 v114, v188, v189
v_cvt_pk_bf16_f32 v115, v190, v191
v_mfma_f32_16x16x32_bf16 v[156:159], a[216:219], v[212:215], v[156:159]
v_cvt_pk_bf16_f32 v97, v222, v223
v_cvt_pk_bf16_f32 v98, v224, v225
v_mfma_f32_16x16x32_bf16 v[156:159], a[212:215], v[208:211], v[156:159]
v_cvt_pk_bf16_f32 v99, v226, v227
v_mfma_f32_16x16x32_bf16 v[156:159], a[208:211], v[200:203], v[156:159]
v_exp_f32 v192, v192
v_mfma_f32_16x16x32_bf16 v[160:163], a[224:227], v[200:203], 0
v_exp_f32 v193, v193
v_mfma_f32_16x16x32_bf16 v[160:163], a[228:231], v[208:211], v[160:163]
v_exp_f32 v194, v194
v_mfma_f32_16x16x32_bf16 v[160:163], a[232:235], v[212:215], v[160:163]
v_exp_f32 v195, v195
v_mfma_f32_16x16x32_bf16 v[160:163], a[236:239], v[216:219], v[160:163]
v_cvt_pk_bf16_f32 v112, v192, v193
v_cvt_pk_bf16_f32 v113, v194, v195
v_mfma_f32_16x16x32_bf16 v[188:191], v[36:39], v[100:103], 0
ds_read_b128 v[192:195], v242 offset:8448
ds_read_b128 v[204:207], v242 offset:8704
v_mfma_f32_16x16x32_bf16 v[188:191], v[32:35], v[96:99], v[188:191]
ds_read_b128 v[220:223], v242 offset:8960
ds_read_b128 v[196:199], v242 offset:9216
v_mfma_f32_16x16x32_bf16 v[224:227], v[8:11], v[96:99], 0
s_nop 2
v_mfma_f32_16x16x32_bf16 v[224:227], v[12:15], v[100:103], v[224:227]
v_mov_b64 v[228:229], 0
s_nop 0
v_mfma_f32_16x16x32_bf16 v[164:167], a[252:255], v[216:219], 0
v_exp_f32 v188, v188
v_mfma_f32_16x16x32_bf16 v[164:167], a[248:251], v[212:215], v[164:167]
v_exp_f32 v189, v189
v_mfma_f32_16x16x32_bf16 v[164:167], a[244:247], v[208:211], v[164:167]
s_waitcnt lgkmcnt(3)
v_exp_f32 v224, v224
v_mfma_f32_16x16x32_bf16 v[164:167], a[240:243], v[200:203], v[164:167]
v_mov_b64 v[200:201], s[96:97]
v_mov_b64 v[202:203], s[96:97]
v_smfmac_f32_16x16x64_bf16 v[228:231], v[184:187], v[104:111], v251
v_cvt_pk_bf16_f32 v128, v188, v189
v_smfmac_f32_16x16x64_bf16 v[228:231], v[184:187], v[112:119], v251 abid:1
s_nop 2
v_mfma_f32_16x16x32_bf16 v[208:211], v[4:7], v[100:103], 0
v_exp_f32 v225, v225
v_mfma_f32_16x16x32_bf16 v[208:211], v[0:3], v[96:99], v[208:211]
v_exp_f32 v226, v226
v_smfmac_f32_16x16x64_bf16 v[200:203], v[238:241], v[96:103], v251
v_add_f32 v228, v228, v229
v_mfma_f32_16x16x32_bf16 v[168:171], v[48:51], v[104:107], v[168:171]
s_waitcnt lgkmcnt(2)
v_rcp_f32 v254, v228
v_mfma_f32_16x16x32_bf16 v[168:171], v[64:67], v[108:111], v[168:171]
s_waitcnt lgkmcnt(0)
v_max3_f32 v255, v255, v228, v254
v_cvt_pk_bf16_f32 v122, v224, v225
v_mfma_f32_16x16x32_bf16 v[168:171], v[80:83], v[112:115], v[168:171]
v_add_f32 v200, v200, v201
v_add_f32 v202, v202, v203
v_mfma_f32_16x16x32_bf16 v[212:215], v[24:27], v[96:99], 0
v_exp_f32 v200, v200
v_mfma_f32_16x16x32_bf16 v[212:215], v[28:31], v[100:103], v[212:215]
v_exp_f32 v202, v202
v_mfma_f32_16x16x32_bf16 v[216:219], v[44:47], v[100:103], 0
v_perm_b32 v132, v202, v200, v252
v_perm_b32 v133, v202, v200, v253
v_mfma_f32_16x16x32_bf16 v[216:219], v[40:43], v[96:99], v[216:219]
v_exp_f32 v227, v227
v_mfma_f32_16x16x32_bf16 v[228:231], v[16:19], v[96:99], 0
v_cvt_pk_bf16_f32 v123, v226, v227
v_fmac_f32 v136, v168, v254
v_mfma_f32_16x16x32_bf16 v[228:231], v[20:23], v[100:103], v[228:231]
v_exp_f32 v208, v208
v_mfma_f32_16x16x32_bf16 v[172:175], v[52:55], v[104:107], v[172:175]
v_exp_f32 v209, v209
v_mfma_f32_16x16x32_bf16 v[172:175], v[68:71], v[108:111], v[172:175]
v_exp_f32 v210, v210
v_mfma_f32_16x16x32_bf16 v[172:175], v[84:87], v[112:115], v[172:175]
v_exp_f32 v211, v211
v_mfma_f32_16x16x32_bf16 v[176:179], v[88:91], v[112:115], v[176:179]
v_cvt_pk_bf16_f32 v120, v208, v209
v_cvt_pk_bf16_f32 v121, v210, v211
v_mfma_f32_16x16x32_bf16 v[176:179], v[72:75], v[108:111], v[176:179]
v_fmac_f32 v137, v169, v254
v_fmac_f32 v138, v170, v254
v_mfma_f32_16x16x32_bf16 v[176:179], v[56:59], v[104:107], v[176:179]
v_fmac_f32 v139, v171, v254
v_cvt_pk_bf16_f32 v136, v136, v137
v_mfma_f32_16x16x32_bf16 v[180:183], v[60:63], v[104:107], v[180:183]
v_cvt_pk_bf16_f32 v137, v138, v139
v_fmac_f32 v140, v172, v254
v_mfma_f32_16x16x32_bf16 v[180:183], v[76:79], v[108:111], v[180:183]
v_fmac_f32 v141, v173, v254
v_fmac_f32 v142, v174, v254
v_mfma_f32_16x16x32_bf16 v[180:183], v[92:95], v[112:115], v[180:183]
s_mov_b64 vcc, s[14:15]
v_fmac_f32 v144, v176, v254
v_fmac_f32 v145, v177, v254
v_mfma_f32_16x16x32_bf16 v[200:203], a[0:3], v[192:195], 0
v_fmac_f32 v146, v178, v254
v_fmac_f32 v147, v179, v254
v_mfma_f32_16x16x32_bf16 v[200:203], a[4:7], v[204:207], v[200:203]
v_cvt_pk_bf16_f32 v144, v144, v145
v_fmac_f32 v143, v175, v254
v_mfma_f32_16x16x32_bf16 v[200:203], a[8:11], v[220:223], v[200:203]
v_fmac_f32 v148, v180, v254
v_fmac_f32 v149, v181, v254
v_mfma_f32_16x16x32_bf16 v[200:203], a[12:15], v[196:199], v[200:203]
v_fmac_f32 v150, v182, v254
v_fmac_f32 v151, v183, v254
v_mfma_f32_16x16x32_bf16 v[224:227], a[28:31], v[196:199], 0
v_cvt_pk_bf16_f32 v145, v146, v147
v_cvt_pk_bf16_f32 v138, v140, v141
v_mfma_f32_16x16x32_bf16 v[224:227], a[24:27], v[220:223], v[224:227]
v_cvt_pk_bf16_f32 v139, v142, v143
v_cvt_pk_bf16_f32 v146, v148, v149
v_mfma_f32_16x16x32_bf16 v[224:227], a[20:23], v[204:207], v[224:227]
v_cvt_pk_bf16_f32 v96, v200, v201
v_cvt_pk_bf16_f32 v97, v202, v203
v_mfma_f32_16x16x32_bf16 v[224:227], a[16:19], v[192:195], v[224:227]
v_cvt_pk_bf16_f32 v147, v150, v151
v_pk_max_i16 v136, v136, 0
v_mfma_f32_16x16x32_bf16 v[200:203], a[32:35], v[192:195], 0
v_pk_max_i16 v137, v137, 0
v_pk_max_i16 v138, v138, 0
v_mfma_f32_16x16x32_bf16 v[200:203], a[36:39], v[204:207], v[200:203]
v_pk_max_i16 v139, v139, 0
v_pk_max_i16 v144, v144, 0
v_mfma_f32_16x16x32_bf16 v[200:203], a[40:43], v[220:223], v[200:203]
v_pk_max_i16 v145, v145, 0
v_pk_max_i16 v146, v146, 0
v_mfma_f32_16x16x32_bf16 v[200:203], a[44:47], v[196:199], v[200:203]
v_pk_max_i16 v147, v147, 0
v_cndmask_b32_dpp v140, v144, v136, vcc quad_perm:[1,0,3,2] row_mask:0xf bank_mask:0xf
v_mfma_f32_16x16x32_bf16 v[208:211], a[60:63], v[196:199], 0
v_cndmask_b32_dpp v141, v145, v137, vcc quad_perm:[1,0,3,2] row_mask:0xf bank_mask:0xf
v_cndmask_b32_dpp v142, v146, v138, vcc quad_perm:[1,0,3,2] row_mask:0xf bank_mask:0xf
v_mfma_f32_16x16x32_bf16 v[208:211], a[56:59], v[220:223], v[208:211]
v_cndmask_b32_dpp v143, v147, v139, vcc quad_perm:[1,0,3,2] row_mask:0xf bank_mask:0xf
v_cvt_pk_bf16_f32 v98, v224, v225
v_mfma_f32_16x16x32_bf16 v[208:211], a[52:55], v[204:207], v[208:211]
s_not_b64 vcc, vcc
v_cndmask_b32_dpp v144, v136, v144, vcc quad_perm:[1,0,3,2] row_mask:0xf bank_mask:0xf
v_cndmask_b32_dpp v145, v137, v145, vcc quad_perm:[1,0,3,2] row_mask:0xf bank_mask:0xf
v_mfma_f32_16x16x32_bf16 v[208:211], a[48:51], v[192:195], v[208:211]
v_cndmask_b32_dpp v146, v138, v146, vcc quad_perm:[1,0,3,2] row_mask:0xf bank_mask:0xf
v_cndmask_b32_dpp v147, v139, v147, vcc quad_perm:[1,0,3,2] row_mask:0xf bank_mask:0xf
v_mfma_f32_32x32x16_bf16 v[168:183], v[236:239], v[132:135], 0
buffer_store_dwordx4 v[140:143], v244, s[20:23], s52 offen offset:0 nt
buffer_store_dwordx4 v[144:147], v244, s[20:23], s52 offen offset:256 nt
v_cvt_pk_bf16_f32 v100, v200, v201
v_cvt_pk_bf16_f32 v101, v202, v203
v_cvt_pk_bf16_f32 v99, v226, v227
v_cvt_pk_bf16_f32 v102, v208, v209
v_mfma_f32_16x16x32_bf16 v[136:139], a[192:195], v[192:195], 0
v_cvt_pk_bf16_f32 v103, v210, v211
v_mfma_f32_16x16x32_bf16 v[136:139], a[196:199], v[204:207], v[136:139]
v_exp_f32 v212, v212
v_mfma_f32_16x16x32_bf16 v[136:139], a[200:203], v[220:223], v[136:139]
v_exp_f32 v213, v213
v_mfma_f32_16x16x32_bf16 v[136:139], a[204:207], v[196:199], v[136:139]
v_exp_f32 v214, v214
v_mfma_f32_16x16x32_bf16 v[140:143], a[220:223], v[196:199], 0
v_exp_f32 v215, v215
v_mfma_f32_16x16x32_bf16 v[140:143], a[216:219], v[220:223], v[140:143]
v_exp_f32 v228, v228
v_mfma_f32_16x16x32_bf16 v[140:143], a[212:215], v[204:207], v[140:143]
v_exp_f32 v229, v229
v_mfma_f32_16x16x32_bf16 v[140:143], a[208:211], v[192:195], v[140:143]
v_exp_f32 v230, v230
v_mfma_f32_16x16x32_bf16 v[144:147], a[224:227], v[192:195], 0
v_exp_f32 v231, v231
v_mfma_f32_16x16x32_bf16 v[144:147], a[228:231], v[204:207], v[144:147]
v_cvt_pk_bf16_f32 v126, v212, v213
v_cvt_pk_bf16_f32 v127, v214, v215
v_mfma_f32_16x16x32_bf16 v[144:147], a[232:235], v[220:223], v[144:147]
v_cvt_pk_bf16_f32 v124, v228, v229
v_cvt_pk_bf16_f32 v125, v230, v231
v_mfma_f32_16x16x32_bf16 v[144:147], a[236:239], v[196:199], v[144:147]
v_mov_b64 v[200:201], s[96:97]
v_mov_b64 v[202:203], s[96:97]
v_mfma_f32_16x16x32_bf16 v[148:151], a[252:255], v[196:199], 0
v_exp_f32 v190, v190
v_mfma_f32_16x16x32_bf16 v[148:151], a[248:251], v[220:223], v[148:151]
v_exp_f32 v191, v191
v_mfma_f32_16x16x32_bf16 v[148:151], a[244:247], v[204:207], v[148:151]
v_exp_f32 v216, v216
v_mfma_f32_16x16x32_bf16 v[148:151], a[240:243], v[192:195], v[148:151]
v_exp_f32 v217, v217
v_smfmac_f32_16x16x64_bf16 v[200:203], v[238:241], v[96:103], v251
v_mov_b64 v[192:193], 0
v_mfma_f32_16x16x32_bf16 v[196:199], v[0:3], v[96:99], 0
v_exp_f32 v218, v218
v_mfma_f32_16x16x32_bf16 v[196:199], v[4:7], v[100:103], v[196:199]
v_exp_f32 v219, v219
v_mfma_f32_16x16x32_bf16 v[204:207], v[12:15], v[100:103], 0
v_cvt_pk_bf16_f32 v129, v190, v191
v_cvt_pk_bf16_f32 v130, v216, v217
v_mfma_f32_16x16x32_bf16 v[204:207], v[8:11], v[96:99], v[204:207]
v_cvt_pk_bf16_f32 v131, v218, v219
v_add_f32 v200, v200, v201
v_smfmac_f32_16x16x64_bf16 v[192:195], v[184:187], v[120:127], v251
ds_read_b128 v[188:191], v242 offset:12672
v_add_f32 v202, v202, v203
v_smfmac_f32_16x16x64_bf16 v[192:195], v[184:187], v[128:135], v251 abid:1
ds_read_b128 v[208:211], v242 offset:12928
ds_read_b128 v[212:215], v242 offset:13184
v_mfma_f32_16x16x32_bf16 v[168:171], v[80:83], v[128:131], v[168:171]
ds_read_b128 v[216:219], v242 offset:13440
v_add_u32 v242, s56, v242
v_mfma_f32_16x16x32_bf16 v[168:171], v[64:67], v[124:127], v[168:171]
s_sub_u32 s56, 0, s56
v_exp_f32 v200, v200
v_mfma_f32_16x16x32_bf16 v[168:171], v[48:51], v[120:123], v[168:171]
v_exp_f32 v202, v202
v_mfma_f32_16x16x32_bf16 v[172:175], v[52:55], v[120:123], v[172:175]
v_perm_b32 v116, v202, v200, v252
v_perm_b32 v117, v202, v200, v253
v_mfma_f32_16x16x32_bf16 v[172:175], v[68:71], v[124:127], v[172:175]
v_add_f32 v192, v192, v193
v_mfma_f32_16x16x32_bf16 v[172:175], v[84:87], v[128:131], v[172:175]
v_rcp_f32 v254, v192
v_mfma_f32_16x16x32_bf16 v[176:179], v[88:91], v[128:131], v[176:179]
v_max3_f32 v255, v255, v192, v254
v_fmac_f32 v152, v168, v254
v_mfma_f32_16x16x32_bf16 v[176:179], v[72:75], v[124:127], v[176:179]
v_fmac_f32 v153, v169, v254
v_fmac_f32 v154, v170, v254
v_mfma_f32_16x16x32_bf16 v[176:179], v[56:59], v[120:123], v[176:179]
v_fmac_f32 v155, v171, v254
v_cvt_pk_bf16_f32 v152, v152, v153
v_mfma_f32_16x16x32_bf16 v[180:183], v[60:63], v[120:123], v[180:183]
v_fmac_f32 v156, v172, v254
v_fmac_f32 v157, v173, v254
v_mfma_f32_16x16x32_bf16 v[180:183], v[76:79], v[124:127], v[180:183]
v_fmac_f32 v158, v174, v254
v_fmac_f32 v159, v175, v254
v_mfma_f32_16x16x32_bf16 v[180:183], v[92:95], v[128:131], v[180:183]
s_waitcnt lgkmcnt(3)
v_fmac_f32 v160, v176, v254
v_fmac_f32 v161, v177, v254
v_mfma_f32_16x16x32_bf16 v[200:203], v[36:39], v[100:103], 0
s_waitcnt lgkmcnt(1)
v_fmac_f32 v162, v178, v254
v_fmac_f32 v163, v179, v254
v_mfma_f32_16x16x32_bf16 v[200:203], v[32:35], v[96:99], v[200:203]
s_waitcnt lgkmcnt(0)
v_cvt_pk_bf16_f32 v160, v160, v161
v_cvt_pk_bf16_f32 v153, v154, v155
v_mfma_f32_16x16x32_bf16 v[220:223], v[24:27], v[96:99], 0
s_mov_b64 vcc, s[14:15]
v_fmac_f32 v164, v180, v254
v_fmac_f32 v165, v181, v254
v_mfma_f32_16x16x32_bf16 v[220:223], v[28:31], v[100:103], v[220:223]
v_fmac_f32 v166, v182, v254
v_fmac_f32 v167, v183, v254
v_mfma_f32_16x16x32_bf16 v[224:227], v[20:23], v[100:103], 0
v_cvt_pk_bf16_f32 v161, v162, v163
v_cvt_pk_bf16_f32 v154, v156, v157
v_mfma_f32_16x16x32_bf16 v[224:227], v[16:19], v[96:99], v[224:227]
v_mov_b32 v232, s45
v_cvt_pk_bf16_f32 v155, v158, v159
v_mfma_f32_16x16x32_bf16 v[228:231], v[40:43], v[96:99], 0
s_waitcnt vmcnt(6)
ds_write_addtid_b32 v232 offset:65280
v_mfma_f32_16x16x32_bf16 v[228:231], v[44:47], v[100:103], v[228:231]
v_cvt_pk_bf16_f32 v162, v164, v165
v_cvt_pk_bf16_f32 v163, v166, v167
v_mfma_f32_16x16x32_bf16 v[192:195], a[0:3], v[188:191], 0
v_pk_max_i16 v152, v152, 0
v_pk_max_i16 v153, v153, 0
v_mfma_f32_16x16x32_bf16 v[192:195], a[4:7], v[208:211], v[192:195]
v_pk_max_i16 v154, v154, 0
v_pk_max_i16 v155, v155, 0
v_mfma_f32_16x16x32_bf16 v[192:195], a[8:11], v[212:215], v[192:195]
v_pk_max_i16 v160, v160, 0
v_pk_max_i16 v161, v161, 0
v_mfma_f32_16x16x32_bf16 v[192:195], a[12:15], v[216:219], v[192:195]
v_pk_max_i16 v162, v162, 0
v_pk_max_i16 v163, v163, 0
v_mfma_f32_16x16x32_bf16 v[232:235], a[28:31], v[216:219], 0
v_cndmask_b32_dpp v156, v160, v152, vcc quad_perm:[1,0,3,2] row_mask:0xf bank_mask:0xf
v_cndmask_b32_dpp v157, v161, v153, vcc quad_perm:[1,0,3,2] row_mask:0xf bank_mask:0xf
v_mfma_f32_16x16x32_bf16 v[232:235], a[24:27], v[212:215], v[232:235]
v_cndmask_b32_dpp v158, v162, v154, vcc quad_perm:[1,0,3,2] row_mask:0xf bank_mask:0xf
v_cndmask_b32_dpp v159, v163, v155, vcc quad_perm:[1,0,3,2] row_mask:0xf bank_mask:0xf
v_mfma_f32_16x16x32_bf16 v[232:235], a[20:23], v[208:211], v[232:235]
s_not_b64 vcc, vcc
v_cvt_pk_bf16_f32 v96, v192, v193
v_cvt_pk_bf16_f32 v97, v194, v195
v_mfma_f32_16x16x32_bf16 v[232:235], a[16:19], v[188:191], v[232:235]
v_cndmask_b32_dpp v160, v152, v160, vcc quad_perm:[1,0,3,2] row_mask:0xf bank_mask:0xf
v_cndmask_b32_dpp v161, v153, v161, vcc quad_perm:[1,0,3,2] row_mask:0xf bank_mask:0xf
v_mfma_f32_16x16x32_bf16 v[192:195], a[32:35], v[188:191], 0
v_cndmask_b32_dpp v162, v154, v162, vcc quad_perm:[1,0,3,2] row_mask:0xf bank_mask:0xf
v_cndmask_b32_dpp v163, v155, v163, vcc quad_perm:[1,0,3,2] row_mask:0xf bank_mask:0xf
v_mfma_f32_16x16x32_bf16 v[192:195], a[36:39], v[208:211], v[192:195]
v_exp_f32 v204, v204
v_mfma_f32_16x16x32_bf16 v[192:195], a[40:43], v[212:215], v[192:195]
v_cvt_pk_bf16_f32 v98, v232, v233
v_cvt_pk_bf16_f32 v99, v234, v235
v_mfma_f32_16x16x32_bf16 v[192:195], a[44:47], v[216:219], v[192:195]
v_exp_f32 v205, v205
v_mfma_f32_16x16x32_bf16 v[232:235], a[60:63], v[216:219], 0
v_exp_f32 v206, v206
v_mfma_f32_16x16x32_bf16 v[232:235], a[56:59], v[212:215], v[232:235]
v_exp_f32 v207, v207
v_mfma_f32_16x16x32_bf16 v[232:235], a[52:55], v[208:211], v[232:235]
v_exp_f32 v220, v220
v_mfma_f32_16x16x32_bf16 v[232:235], a[48:51], v[188:191], v[232:235]
v_cvt_pk_bf16_f32 v100, v192, v193
v_cvt_pk_bf16_f32 v101, v194, v195
v_mfma_f32_32x32x16_bf16 v[168:183], v[236:239], v[116:119], 0
s_cmp_lg_u32 s45, 0
buffer_store_dwordx4 v[156:159], v244, s[20:23], s53 offen offset:0 nt
buffer_store_dwordx4 v[160:163], v244, s[20:23], s53 offen offset:256 nt
s_cbranch_scc1 L_loopf
v_mfma_f32_16x16x32_bf16 v[152:155], a[192:195], v[188:191], 0
s_mov_b32 m0, s59
v_cvt_pk_bf16_f32 v102, v232, v233
v_cvt_pk_bf16_f32 v103, v234, v235
v_mfma_f32_16x16x32_bf16 v[152:155], a[196:199], v[208:211], v[152:155]
s_mul_i32 s54, s41, 13824
v_mov_b64 v[192:193], s[96:97]
v_mov_b64 v[194:195], s[96:97]
v_mfma_f32_16x16x32_bf16 v[152:155], a[200:203], v[212:215], v[152:155]
L_h5:
s_cbranch_execz L_ret
s_add_u32 s7, s54, 102400
v_exp_f32 v196, v196
v_mfma_f32_16x16x32_bf16 v[152:155], a[204:207], v[216:219], v[152:155]
s_mov_b32 s6, 1728
v_exp_f32 v197, v197
v_mfma_f32_16x16x32_bf16 v[156:159], a[220:223], v[216:219], 0
s_lshl_b32 s55, s41, 9
v_exp_f32 v198, v198
v_mfma_f32_16x16x32_bf16 v[156:159], a[216:219], v[212:215], v[156:159]
s_mov_b32 s13, 272
v_exp_f32 v199, v199
v_mfma_f32_16x16x32_bf16 v[156:159], a[212:215], v[208:211], v[156:159]
s_add_u32 s8, s54, 103536
v_cvt_pk_bf16_f32 v104, v196, v197
v_cvt_pk_bf16_f32 v105, v198, v199
v_mfma_f32_16x16x32_bf16 v[156:159], a[208:211], v[188:191], v[156:159]
s_add_u32 s9, s55, 160960
v_cvt_pk_bf16_f32 v106, v204, v205
v_cvt_pk_bf16_f32 v107, v206, v207
v_mfma_f32_16x16x32_bf16 v[160:163], a[224:227], v[188:191], 0
s_add_u32 s52, s47, 8192
v_exp_f32 v200, v200
v_mfma_f32_16x16x32_bf16 v[160:163], a[228:231], v[208:211], v[160:163]
s_mov_b32 s57, 13106176
v_exp_f32 v201, v201
v_mfma_f32_16x16x32_bf16 v[160:163], a[232:235], v[212:215], v[160:163]
s_add_u32 s98, s44, 24576
v_exp_f32 v202, v202
v_mfma_f32_16x16x32_bf16 v[160:163], a[236:239], v[216:219], v[160:163]
s_add_u32 s99, s44, 52453376
v_exp_f32 v203, v203
v_mfma_f32_16x16x32_bf16 v[164:167], a[252:255], v[216:219], 0
s_add_u32 s53, s47, 12288
v_cvt_pk_bf16_f32 v112, v200, v201
v_cvt_pk_bf16_f32 v113, v202, v203
v_mfma_f32_16x16x32_bf16 v[164:167], a[248:251], v[212:215], v[164:167]
v_mbcnt_lo_u32_b32 v245, -1, 0
v_mbcnt_hi_u32_b32 v245, -1, v245
v_mfma_f32_16x16x32_bf16 v[164:167], a[244:247], v[208:211], v[164:167]
v_mov_b32 v243, s7
v_bfe_u32 v246, v245, 2, 2
v_mfma_f32_16x16x32_bf16 v[164:167], a[240:243], v[188:191], v[164:167]
ds_read_addtid_b32 v188 offset:65280
v_and_b32 v200, 3, v245
v_smfmac_f32_16x16x64_bf16 v[192:195], v[238:241], v[96:103], v251
v_and_b32 v202, 15, v245
v_mfma_f32_16x16x32_bf16 v[196:199], v[0:3], v[96:99], 0
v_mad_u32_u24 v243, v246, s6, v243
v_lshrrev_b32 v201, 4, v245
v_mfma_f32_16x16x32_bf16 v[196:199], v[4:7], v[100:103], v[196:199]
v_mad_u32_u24 v243, v200, s13, v243
v_lshl_add_u32 v249, v202, 3, s8
v_mfma_f32_16x16x32_bf16 v[204:207], v[12:15], v[100:103], 0
v_lshl_add_u32 v250, v202, 4, s9
v_lshl_add_u32 v247, v201, 4, v243
v_mfma_f32_16x16x32_bf16 v[204:207], v[8:11], v[96:99], v[204:207]
v_mad_u32_u24 v249, v201, s6, v249
v_add_f32 v192, v192, v193
v_mfma_f32_16x16x32_bf16 v[208:211], v[16:19], v[96:99], 0
s_waitcnt lgkmcnt(0)
v_exp_f32 v224, v224
v_mfma_f32_16x16x32_bf16 v[208:211], v[20:23], v[100:103], v[208:211]
v_exp_f32 v225, v225
v_mfma_f32_16x16x32_bf16 v[212:215], v[28:31], v[100:103], 0
v_exp_f32 v226, v226
v_mfma_f32_16x16x32_bf16 v[212:215], v[24:27], v[96:99], v[212:215]
v_exp_f32 v227, v227
v_mfma_f32_16x16x32_bf16 v[200:203], v[32:35], v[96:99], 0
ds_read_b64 v[32:33], v249 offset:0
v_cvt_pk_bf16_f32 v108, v224, v225
v_mfma_f32_16x16x32_bf16 v[200:203], v[36:39], v[100:103], v[200:203]
ds_read_b64 v[34:35], v249 offset:6912
v_cvt_pk_bf16_f32 v109, v226, v227
v_mfma_f32_16x16x32_bf16 v[224:227], v[44:47], v[100:103], 0
ds_read_b64 v[36:37], v249 offset:128
v_cmp_lt_u32 vcc, s45, v188
v_mfma_f32_16x16x32_bf16 v[224:227], v[40:43], v[96:99], v[224:227]
ds_read_b64 v[96:97], v250 offset:0
v_exp_f32 v221, v221
v_exp_f32 v222, v222
v_exp_f32 v223, v223
s_cbranch_vccnz L_spine
L_backe:
v_cvt_pk_bf16_f32 v110, v220, v221
v_cvt_pk_bf16_f32 v111, v222, v223
v_mov_b64 v[188:189], 0
v_exp_f32 v228, v228
v_add_f32 v194, v194, v195
v_smfmac_f32_16x16x64_bf16 v[188:191], v[184:187], v[104:111], v251
ds_read_b128 v[216:219], v242 offset:0
v_exp_f32 v229, v229
v_exp_f32 v230, v230
v_exp_f32 v231, v231
v_cvt_pk_bf16_f32 v114, v228, v229
v_cvt_pk_bf16_f32 v115, v230, v231
v_exp_f32 v192, v192
v_mad_u32_u24 v248, v246, s57, v244
v_smfmac_f32_16x16x64_bf16 v[188:191], v[184:187], v[112:119], v251 abid:1
s_waitcnt lgkmcnt(1)
ds_read_b128 v[220:223], v242 offset:256
ds_read_b128 v[228:231], v242 offset:512
v_mfma_f32_16x16x32_bf16 v[168:171], v[80:83], v[112:115], v[168:171]
ds_read_b128 v[232:235], v242 offset:768
ds_read_b64 v[40:41], v249 offset:256
v_mfma_f32_16x16x32_bf16 v[168:171], v[64:67], v[108:111], v[168:171]
ds_read_b64 v[42:43], v249 offset:7168
v_add_f32 v188, v188, v189
v_mfma_f32_16x16x32_bf16 v[168:171], v[48:51], v[104:107], v[168:171]
ds_read_b64 v[38:39], v249 offset:7040
ds_read_b64 v[44:45], v249 offset:384
v_mfma_f32_16x16x32_bf16 v[172:175], v[52:55], v[104:107], v[172:175]
ds_read_b64 v[46:47], v249 offset:7296
ds_read_b32 v102, v250 offset:8
v_mfma_f32_16x16x32_bf16 v[172:175], v[68:71], v[108:111], v[172:175]
ds_read_b64 v[100:101], v250 offset:256
ds_read_b32 v103, v250 offset:264
v_mfma_f32_16x16x32_bf16 v[172:175], v[84:87], v[112:115], v[172:175]
v_exp_f32 v196, v196
v_mfma_f32_16x16x32_bf16 v[176:179], v[88:91], v[112:115], v[176:179]
v_exp_f32 v197, v197
v_mfma_f32_16x16x32_bf16 v[176:179], v[72:75], v[108:111], v[176:179]
v_exp_f32 v198, v198
v_mfma_f32_16x16x32_bf16 v[176:179], v[56:59], v[104:107], v[176:179]
v_exp_f32 v199, v199
v_mfma_f32_16x16x32_bf16 v[180:183], v[60:63], v[104:107], v[180:183]
s_waitcnt lgkmcnt(2)
v_cvt_pk_bf16_f32 v120, v196, v197
v_cvt_pk_bf16_f32 v121, v198, v199
v_mfma_f32_16x16x32_bf16 v[180:183], v[76:79], v[108:111], v[180:183]
s_waitcnt lgkmcnt(0)
v_exp_f32 v194, v194
v_mfma_f32_16x16x32_bf16 v[180:183], v[92:95], v[112:115], v[180:183]
s_mov_b64 vcc, s[14:15]
v_perm_b32 v132, v194, v192, v252
v_perm_b32 v133, v194, v192, v253
v_mfma_f32_16x16x32_bf16 v[0:3], a[192:195], v[216:219], 0
v_rcp_f32 v254, v188
v_mfma_f32_16x16x32_bf16 v[0:3], a[196:199], v[220:223], v[0:3]
v_max3_f32 v255, v255, v188, v254
v_fmac_f32 v136, v168, v254
v_mfma_f32_16x16x32_bf16 v[0:3], a[200:203], v[228:231], v[0:3]
v_fmac_f32 v137, v169, v254
v_fmac_f32 v144, v176, v254
v_mfma_f32_16x16x32_bf16 v[0:3], a[204:207], v[232:235], v[0:3]
v_fmac_f32 v145, v177, v254
v_fmac_f32 v138, v170, v254
v_mfma_f32_16x16x32_bf16 v[4:7], a[220:223], v[232:235], 0
ds_read_b128 v[196:199], v242 offset:4736
ds_read_b128 v[192:195], v242 offset:4480
v_mfma_f32_16x16x32_bf16 v[4:7], a[216:219], v[228:231], v[4:7]
ds_read_b128 v[188:191], v242 offset:4224
v_fmac_f32 v139, v171, v254
v_mfma_f32_16x16x32_bf16 v[4:7], a[212:215], v[220:223], v[4:7]
v_cvt_pk_bf16_f32 v136, v136, v137
v_fmac_f32 v146, v178, v254
v_mfma_f32_16x16x32_bf16 v[4:7], a[208:211], v[216:219], v[4:7]
v_fmac_f32 v147, v179, v254
v_cvt_pk_bf16_f32 v144, v144, v145
v_mfma_f32_16x16x32_bf16 v[8:11], a[224:227], v[216:219], 0
v_fmac_f32 v140, v172, v254
v_fmac_f32 v141, v173, v254
v_mfma_f32_16x16x32_bf16 v[8:11], a[228:231], v[220:223], v[8:11]
ds_read_b128 v[104:107], v247 offset:0
v_fmac_f32 v142, v174, v254
v_mfma_f32_16x16x32_bf16 v[8:11], a[232:235], v[228:231], v[8:11]
ds_read_b128 v[108:111], v247 offset:64
v_fmac_f32 v143, v175, v254
v_mfma_f32_16x16x32_bf16 v[8:11], a[236:239], v[232:235], v[8:11]
ds_read_b128 v[112:115], v247 offset:128
v_cvt_pk_bf16_f32 v137, v138, v139
v_mfma_f32_16x16x32_bf16 v[12:15], a[252:255], v[232:235], 0
ds_read_b128 v[232:235], v242 offset:4992
v_fmac_f32 v148, v180, v254
v_mfma_f32_16x16x32_bf16 v[12:15], a[244:247], v[220:223], v[12:15]
ds_read_b128 v[116:119], v247 offset:192
v_fmac_f32 v149, v181, v254
v_mfma_f32_16x16x32_bf16 v[12:15], a[240:243], v[216:219], v[12:15]
s_waitcnt lgkmcnt(7)
ds_read_b128 v[220:223], v243 offset:256
v_fmac_f32 v150, v182, v254
v_mfma_f32_16x16x32_bf16 v[12:15], a[248:251], v[228:231], v[12:15]
v_fmac_f32 v151, v183, v254
v_cvt_pk_bf16_f32 v145, v146, v147
v_mfma_f32_16x16x32_bf16 v[28:31], a[248:251], v[196:199], 0
s_waitcnt lgkmcnt(7)
v_cvt_pk_bf16_f32 v138, v140, v141
v_cvt_pk_bf16_f32 v139, v142, v143
v_cvt_pk_bf16_f32 v146, v148, v149
v_cvt_pk_bf16_f32 v147, v150, v151
v_pk_max_i16 v136, v136, 0
s_waitcnt lgkmcnt(2)
v_mfma_f32_16x16x32_bf16 v[28:31], a[252:255], v[232:235], v[28:31]
v_pk_max_i16 v137, v137, 0
v_pk_max_i16 v138, v138, 0
v_mfma_f32_16x16x32_bf16 v[28:31], a[244:247], v[192:195], v[28:31]
v_pk_max_i16 v139, v139, 0
v_pk_max_i16 v144, v144, 0
v_mfma_f32_16x16x32_bf16 v[28:31], a[240:243], v[188:191], v[28:31]
s_waitcnt lgkmcnt(0)
v_pk_max_i16 v145, v145, 0
v_pk_max_i16 v146, v146, 0
v_pk_max_i16 v147, v147, 0
v_cndmask_b32_dpp v140, v144, v136, vcc quad_perm:[1,0,3,2] row_mask:0xf bank_mask:0xf
v_cndmask_b32_dpp v141, v145, v137, vcc quad_perm:[1,0,3,2] row_mask:0xf bank_mask:0xf
v_cndmask_b32_dpp v142, v146, v138, vcc quad_perm:[1,0,3,2] row_mask:0xf bank_mask:0xf
v_cndmask_b32_dpp v143, v147, v139, vcc quad_perm:[1,0,3,2] row_mask:0xf bank_mask:0xf
s_not_b64 vcc, vcc
v_cndmask_b32_dpp v144, v136, v144, vcc quad_perm:[1,0,3,2] row_mask:0xf bank_mask:0xf
v_cndmask_b32_dpp v145, v137, v145, vcc quad_perm:[1,0,3,2] row_mask:0xf bank_mask:0xf
v_cndmask_b32_dpp v146, v138, v146, vcc quad_perm:[1,0,3,2] row_mask:0xf bank_mask:0xf
v_cndmask_b32_dpp v147, v139, v147, vcc quad_perm:[1,0,3,2] row_mask:0xf bank_mask:0xf
s_mov_b32 vcc_lo, 0xf0000f
s_mov_b32 vcc_hi, 0xf0000f00
v_mov_b64 v[98:99], 0
v_cndmask_b32 v96, 0, v96, vcc
v_cndmask_b32 v97, 0, v97, vcc
v_exp_f32 v204, v204
v_add_f32 v220, v220, v221
v_mfma_f32_16x16x32_bf16 v[104:107], v[32:35], v[96:99], v[104:107]
v_exp_f32 v205, v205
v_mfma_f32_16x16x32_bf16 v[108:111], v[36:39], v[96:99], v[108:111]
v_exp_f32 v206, v206
v_mfma_f32_16x16x32_bf16 v[112:115], v[40:43], v[96:99], v[112:115]
v_exp_f32 v207, v207
v_mfma_f32_16x16x32_bf16 v[116:119], v[44:47], v[96:99], v[116:119]
v_cvt_pk_bf16_f32 v122, v204, v205
v_cvt_pk_bf16_f32 v123, v206, v207
v_mfma_f32_16x16x32_bf16 v[24:27], a[224:227], v[188:191], 0
v_exp_f32 v208, v208
v_mfma_f32_16x16x32_bf16 v[24:27], a[228:231], v[192:195], v[24:27]
v_exp_f32 v209, v209
v_mfma_f32_16x16x32_bf16 v[24:27], a[232:235], v[196:199], v[24:27]
v_exp_f32 v210, v210
v_mfma_f32_16x16x32_bf16 v[24:27], a[236:239], v[232:235], v[24:27]
v_exp_f32 v211, v211
v_mfma_f32_32x32x16_bf16 v[168:183], v[236:239], v[132:135], 0
buffer_store_dwordx4 v[140:143], v244, s[20:23], s52 offen offset:0 nt
buffer_store_dwordx4 v[144:147], v244, s[20:23], s52 offen offset:256 nt
v_exp_f32 v212, v212
v_exp_f32 v213, v213
v_mfma_f32_16x16x32_bf16 v[20:23], a[220:223], v[232:235], 0
v_exp_f32 v214, v214
v_mfma_f32_16x16x32_bf16 v[20:23], a[216:219], v[196:199], v[20:23]
v_exp_f32 v215, v215
v_mfma_f32_16x16x32_bf16 v[20:23], a[212:215], v[192:195], v[20:23]
v_cvt_pk_bf16_f32 v124, v208, v209
v_cvt_pk_bf16_f32 v125, v210, v211
v_mfma_f32_16x16x32_bf16 v[20:23], a[208:211], v[188:191], v[20:23]
v_cvt_pk_bf16_f32 v126, v212, v213
v_cvt_pk_bf16_f32 v127, v214, v215
v_mfma_f32_16x16x32_bf16 v[16:19], a[192:195], v[188:191], 0
v_mov_b64 v[188:189], 0
v_cndmask_b32 v100, 0, v100, vcc
v_mfma_f32_16x16x32_bf16 v[16:19], a[196:199], v[192:195], v[16:19]
ds_read_b128 v[192:195], v247 offset:6912
v_cndmask_b32 v101, 0, v101, vcc
v_mfma_f32_16x16x32_bf16 v[16:19], a[200:203], v[196:199], v[16:19]
ds_read_b128 v[196:199], v247 offset:6976
ds_read_b128 v[204:207], v247 offset:7040
v_mfma_f32_16x16x32_bf16 v[16:19], a[204:207], v[232:235], v[16:19]
ds_read_b128 v[208:211], v247 offset:7104
v_add_f32 v222, v222, v223
v_smfmac_f32_16x16x64_bf16 v[188:191], v[184:187], v[120:127], v251
ds_read_b128 v[212:215], v243 offset:7168
v_exp_f32 v200, v200
v_exp_f32 v201, v201
v_exp_f32 v202, v202
v_exp_f32 v203, v203
v_exp_f32 v224, v224
v_exp_f32 v225, v225
v_exp_f32 v226, v226
v_exp_f32 v227, v227
v_cvt_pk_bf16_f32 v128, v200, v201
v_cvt_pk_bf16_f32 v129, v202, v203
v_cvt_pk_bf16_f32 v130, v224, v225
v_cvt_pk_bf16_f32 v131, v226, v227
v_add_f32 v220, v220, v102
v_add_f32 v220, v220, v222
v_smfmac_f32_16x16x64_bf16 v[188:191], v[184:187], v[128:135], v251 abid:1
s_waitcnt lgkmcnt(0)
v_add_f32 v212, v212, v213
v_mfma_f32_16x16x32_bf16 v[168:171], v[80:83], v[128:131], v[168:171]
v_rcp_f32 v252, v220
v_mfma_f32_16x16x32_bf16 v[168:171], v[64:67], v[124:127], v[168:171]
v_fmac_f32 v0, v104, v252
v_fmac_f32 v1, v105, v252
v_mfma_f32_16x16x32_bf16 v[168:171], v[48:51], v[120:123], v[168:171]
v_fmac_f32 v8, v112, v252
v_fmac_f32 v9, v113, v252
v_mfma_f32_16x16x32_bf16 v[172:175], v[52:55], v[120:123], v[172:175]
v_fmac_f32 v2, v106, v252
v_fmac_f32 v3, v107, v252
v_mfma_f32_16x16x32_bf16 v[172:175], v[68:71], v[124:127], v[172:175]
v_cvt_pk_bf16_f32 v0, v0, v1
v_fmac_f32 v10, v114, v252
v_mfma_f32_16x16x32_bf16 v[172:175], v[84:87], v[128:131], v[172:175]
v_fmac_f32 v11, v115, v252
v_cvt_pk_bf16_f32 v8, v8, v9
v_mfma_f32_16x16x32_bf16 v[192:195], v[32:35], v[98:101], v[192:195]
v_fmac_f32 v4, v108, v252
v_fmac_f32 v5, v109, v252
v_mfma_f32_16x16x32_bf16 v[196:199], v[36:39], v[98:101], v[196:199]
v_fmac_f32 v6, v110, v252
v_fmac_f32 v7, v111, v252
v_mfma_f32_16x16x32_bf16 v[204:207], v[40:43], v[98:101], v[204:207]
v_cvt_pk_bf16_f32 v1, v2, v3
v_fmac_f32 v12, v116, v252
v_mfma_f32_16x16x32_bf16 v[208:211], v[44:47], v[98:101], v[208:211]
v_fmac_f32 v13, v117, v252
v_fmac_f32 v14, v118, v252
v_mfma_f32_16x16x32_bf16 v[176:179], v[72:75], v[124:127], v[176:179]
v_fmac_f32 v15, v119, v252
v_cvt_pk_bf16_f32 v9, v10, v11
v_mfma_f32_16x16x32_bf16 v[176:179], v[88:91], v[128:131], v[176:179]
v_cvt_pk_bf16_f32 v2, v4, v5
v_cvt_pk_bf16_f32 v3, v6, v7
v_mfma_f32_16x16x32_bf16 v[176:179], v[56:59], v[120:123], v[176:179]
v_cvt_pk_bf16_f32 v10, v12, v13
v_cvt_pk_bf16_f32 v11, v14, v15
v_mfma_f32_16x16x32_bf16 v[180:183], v[60:63], v[120:123], v[180:183]
v_pk_max_i16 v0, v0, 0
v_pk_max_i16 v1, v1, 0
v_mfma_f32_16x16x32_bf16 v[180:183], v[76:79], v[124:127], v[180:183]
v_pk_max_i16 v2, v2, 0
v_pk_max_i16 v3, v3, 0
v_mfma_f32_16x16x32_bf16 v[180:183], v[92:95], v[128:131], v[180:183]
s_mov_b64 vcc, s[14:15]
v_pk_max_i16 v8, v8, 0
v_pk_max_i16 v9, v9, 0
v_pk_max_i16 v10, v10, 0
v_pk_max_i16 v11, v11, 0
v_cndmask_b32_dpp v4, v8, v0, vcc quad_perm:[1,0,3,2] row_mask:0xf bank_mask:0xf
v_cndmask_b32_dpp v5, v9, v1, vcc quad_perm:[1,0,3,2] row_mask:0xf bank_mask:0xf
v_cndmask_b32_dpp v6, v10, v2, vcc quad_perm:[1,0,3,2] row_mask:0xf bank_mask:0xf
v_cndmask_b32_dpp v7, v11, v3, vcc quad_perm:[1,0,3,2] row_mask:0xf bank_mask:0xf
s_not_b64 vcc, vcc
v_cndmask_b32_dpp v8, v0, v8, vcc quad_perm:[1,0,3,2] row_mask:0xf bank_mask:0xf
v_cndmask_b32_dpp v9, v1, v9, vcc quad_perm:[1,0,3,2] row_mask:0xf bank_mask:0xf
v_cndmask_b32_dpp v10, v2, v10, vcc quad_perm:[1,0,3,2] row_mask:0xf bank_mask:0xf
v_cndmask_b32_dpp v11, v3, v11, vcc quad_perm:[1,0,3,2] row_mask:0xf bank_mask:0xf
buffer_store_dwordx4 v[4:7], v248, s[20:23], s98 offen offset:0 nt
buffer_store_dwordx4 v[8:11], v248, s[20:23], s98 offen offset:256 nt
v_add_f32 v214, v214, v215
v_add_f32 v212, v212, v103
v_add_f32 v212, v212, v214
v_rcp_f32 v240, v212
s_mov_b64 vcc, s[14:15]
v_pk_fma_f32 v[16:17], v[192:193], v[240:241], v[16:17] op_sel_hi:[1,0,1]
v_pk_fma_f32 v[24:25], v[204:205], v[240:241], v[24:25] op_sel_hi:[1,0,1]
v_pk_fma_f32 v[18:19], v[194:195], v[240:241], v[18:19] op_sel_hi:[1,0,1]
v_cvt_pk_bf16_f32 v16, v16, v17
v_pk_fma_f32 v[26:27], v[206:207], v[240:241], v[26:27] op_sel_hi:[1,0,1]
v_cvt_pk_bf16_f32 v24, v24, v25
v_pk_fma_f32 v[20:21], v[196:197], v[240:241], v[20:21] op_sel_hi:[1,0,1]
v_pk_fma_f32 v[22:23], v[198:199], v[240:241], v[22:23] op_sel_hi:[1,0,1]
v_cvt_pk_bf16_f32 v17, v18, v19
v_pk_fma_f32 v[28:29], v[208:209], v[240:241], v[28:29] op_sel_hi:[1,0,1]
v_pk_fma_f32 v[30:31], v[210:211], v[240:241], v[30:31] op_sel_hi:[1,0,1]
v_cvt_pk_bf16_f32 v25, v26, v27
v_cvt_pk_bf16_f32 v18, v20, v21
v_cvt_pk_bf16_f32 v19, v22, v23
v_cvt_pk_bf16_f32 v26, v28, v29
v_cvt_pk_bf16_f32 v27, v30, v31
v_pk_max_i16 v16, v16, 0
v_pk_max_i16 v17, v17, 0
v_pk_max_i16 v18, v18, 0
v_pk_max_i16 v19, v19, 0
v_pk_max_i16 v24, v24, 0
v_pk_max_i16 v25, v25, 0
v_pk_max_i16 v26, v26, 0
v_pk_max_i16 v27, v27, 0
v_cndmask_b32_dpp v20, v24, v16, vcc quad_perm:[1,0,3,2] row_mask:0xf bank_mask:0xf
v_cndmask_b32_dpp v21, v25, v17, vcc quad_perm:[1,0,3,2] row_mask:0xf bank_mask:0xf
v_cndmask_b32_dpp v22, v26, v18, vcc quad_perm:[1,0,3,2] row_mask:0xf bank_mask:0xf
v_cndmask_b32_dpp v23, v27, v19, vcc quad_perm:[1,0,3,2] row_mask:0xf bank_mask:0xf
s_not_b64 vcc, vcc
v_cndmask_b32_dpp v24, v16, v24, vcc quad_perm:[1,0,3,2] row_mask:0xf bank_mask:0xf
v_cndmask_b32_dpp v25, v17, v25, vcc quad_perm:[1,0,3,2] row_mask:0xf bank_mask:0xf
v_cndmask_b32_dpp v26, v18, v26, vcc quad_perm:[1,0,3,2] row_mask:0xf bank_mask:0xf
v_cndmask_b32_dpp v27, v19, v27, vcc quad_perm:[1,0,3,2] row_mask:0xf bank_mask:0xf
buffer_store_dwordx4 v[20:23], v248, s[20:23], s99 offen offset:0 nt
buffer_store_dwordx4 v[24:27], v248, s[20:23], s99 offen offset:256 nt
v_add_f32 v188, v188, v189
v_rcp_f32 v254, v188
s_mov_b64 vcc, s[14:15]
v_pk_fma_f32 v[152:153], v[168:169], v[254:255], v[152:153] op_sel_hi:[1,0,1]
v_pk_fma_f32 v[160:161], v[176:177], v[254:255], v[160:161] op_sel_hi:[1,0,1]
v_pk_fma_f32 v[154:155], v[170:171], v[254:255], v[154:155] op_sel_hi:[1,0,1]
v_cvt_pk_bf16_f32 v152, v152, v153
v_pk_fma_f32 v[162:163], v[178:179], v[254:255], v[162:163] op_sel_hi:[1,0,1]
v_cvt_pk_bf16_f32 v160, v160, v161
v_pk_fma_f32 v[156:157], v[172:173], v[254:255], v[156:157] op_sel_hi:[1,0,1]
v_pk_fma_f32 v[158:159], v[174:175], v[254:255], v[158:159] op_sel_hi:[1,0,1]
v_cvt_pk_bf16_f32 v153, v154, v155
v_pk_fma_f32 v[164:165], v[180:181], v[254:255], v[164:165] op_sel_hi:[1,0,1]
v_pk_fma_f32 v[166:167], v[182:183], v[254:255], v[166:167] op_sel_hi:[1,0,1]
v_cvt_pk_bf16_f32 v161, v162, v163
v_cvt_pk_bf16_f32 v154, v156, v157
v_cvt_pk_bf16_f32 v155, v158, v159
v_cvt_pk_bf16_f32 v162, v164, v165
v_cvt_pk_bf16_f32 v163, v166, v167
v_pk_max_i16 v152, v152, 0
v_pk_max_i16 v153, v153, 0
v_pk_max_i16 v154, v154, 0
v_pk_max_i16 v155, v155, 0
v_pk_max_i16 v160, v160, 0
v_pk_max_i16 v161, v161, 0
v_pk_max_i16 v162, v162, 0
v_pk_max_i16 v163, v163, 0
v_cndmask_b32_dpp v156, v160, v152, vcc quad_perm:[1,0,3,2] row_mask:0xf bank_mask:0xf
v_cndmask_b32_dpp v157, v161, v153, vcc quad_perm:[1,0,3,2] row_mask:0xf bank_mask:0xf
v_cndmask_b32_dpp v158, v162, v154, vcc quad_perm:[1,0,3,2] row_mask:0xf bank_mask:0xf
v_cndmask_b32_dpp v159, v163, v155, vcc quad_perm:[1,0,3,2] row_mask:0xf bank_mask:0xf
s_not_b64 vcc, vcc
v_cndmask_b32_dpp v160, v152, v160, vcc quad_perm:[1,0,3,2] row_mask:0xf bank_mask:0xf
v_cndmask_b32_dpp v161, v153, v161, vcc quad_perm:[1,0,3,2] row_mask:0xf bank_mask:0xf
v_cndmask_b32_dpp v162, v154, v162, vcc quad_perm:[1,0,3,2] row_mask:0xf bank_mask:0xf
v_cndmask_b32_dpp v163, v155, v163, vcc quad_perm:[1,0,3,2] row_mask:0xf bank_mask:0xf
buffer_store_dwordx4 v[156:159], v244, s[20:23], s53 offen offset:0 nt
buffer_store_dwordx4 v[160:163], v244, s[20:23], s53 offen offset:256 nt
v_max3_f32 v255, v255, v220, v252
v_max3_f32 v255, v255, v188, v254
v_max3_f32 v255, v255, v212, v240
v_mov_b32 v1, 0x53800000
v_cmp_nle_f32 vcc, v255, v1
s_lshl_b32 s52, s41, 2
s_add_u32 s52, s52, 163008
s_or_b32 s3, vcc_lo, vcc_hi
v_mov_b32 v2, s52
v_mov_b32 v3, s3
ds_write_b32 v2, v3
v_mov_b32 v2, 163008
s_waitcnt lgkmcnt(0)
s_barrier
ds_read_b128 v[4:7], v2
s_waitcnt lgkmcnt(0)
v_or_b32 v4, v4, v5
v_or3_b32 v4, v4, v6, v7
s_nop 0
v_readfirstlane_b32 s3, v4
s_nop 3
s_cmp_eq_u32 s3, 0
s_cbranch_scc0 L_fast_end
s_endpgm
L_fast_end:
s_waitcnt vmcnt(0)
s_barrier
s_mov_b32 s45, 8
s_mov_b32 s3, 64
s_mov_b32 s46, s44
s_mov_b32 s47, 0x7ff00000
s_mov_b32 s56, 50688
v_mbcnt_lo_u32_b32 v48, -1, 0
v_mbcnt_hi_u32_b32 v48, -1, v48
v_lshlrev_b32 v53, 4, v48
s_lshl_b32 s54, s41, 13
s_add_u32 s57, s54, 4096
v_and_b32 v49, 16, v48
v_lshlrev_b32 v52, 2, v49
v_lshlrev_b32 v49, 1, v49
v_xor_b32 v50, v53, v49
s_mul_i32 s49, s42, 25344
s_mul_i32 s53, s43, 1056
s_add_u32 s49, s49, s53
s_add_u32 m0, s49, 0
s_lshl_b32 s55, s43, 10
s_add_u32 s55, s55, s44
s_add_u32 s48, s55, 0
v_mov_b32 v237, 0
v_bfe_u32 v49, v48, 0, 2
v_lshl_add_u32 v237, v49, 4, v237
v_bfe_u32 v49, v48, 4, 2
v_lshl_add_u32 v237, v49, 6, v237
v_bfe_u32 v49, v48, 2, 2
v_lshl_add_u32 v237, v49, 8, v237
v_xor_b32 v51, 64, v50
s_lshl_b32 s53, s43, 14
v_mov_b32 v248, s53
v_add_u32 v248, 50688, v248
v_bfe_u32 v49, v48, 4, 2
v_lshl_add_u32 v248, v49, 10, v248
v_bfe_u32 v49, v48, 2, 2
v_lshl_add_u32 v248, v49, 7, v248
v_bfe_u32 v49, v48, 3, 1
v_lshl_add_u32 v248, v49, 5, v248
v_bfe_u32 v49, v48, 4, 1
v_lshl_add_u32 v248, v49, 6, v248
v_bfe_u32 v49, v48, 0, 2
v_lshl_add_u32 v248, v49, 3, v248
v_mov_b32 v252, s53
v_add_u32 v252, 116224, v252
v_bfe_u32 v49, v48, 4, 2
v_lshl_add_u32 v252, v49, 10, v252
v_bfe_u32 v49, v48, 2, 2
v_lshl_add_u32 v252, v49, 7, v252
v_bfe_u32 v49, v48, 3, 1
v_lshl_add_u32 v252, v49, 6, v252
v_bfe_u32 v49, v48, 0, 2
v_lshl_add_u32 v252, v49, 4, v252
s_mul_i32 s53, s42, 25344
v_bfe_u32 v49, v48, 2, 2
v_mov_b32 v236, s53
v_mul_u32_u24 v49, 1056, v49
v_add_u32 v236, v49, v236
v_bfe_u32 v49, v48, 0, 2
s_add_u32 s53, s54, 83456
v_lshl_add_u32 v236, v49, 6, v236
v_add_u32 v104, s53, v50
v_add_u32 v105, s53, v51
v_bfe_u32 v49, v48, 4, 2
s_lshl_b32 s53, s41, 12
v_lshl_add_u32 v236, v49, 4, v236
v_mov_b32 v54, s53
v_add_u32 v54, 50688, v54
v_bfe_u32 v49, v48, 3, 1
v_lshl_add_u32 v54, v49, 14, v54
v_bfe_u32 v49, v48, 4, 2
v_lshl_add_u32 v54, v49, 7, v54
v_bfe_u32 v49, v48, 2, 1
v_lshl_add_u32 v54, v49, 6, v54
v_bfe_u32 v49, v48, 5, 1
v_lshl_add_u32 v54, v49, 5, v54
v_bfe_u32 v49, v48, 0, 2
v_lshl_add_u32 v54, v49, 3, v54
s_lshl_b32 s53, s43, 7
v_mov_b32 v239, s53
v_bfe_u32 v49, v48, 0, 4
v_lshl_add_u32 v239, v49, 8, v239
s_mul_i32 s52, s41, 12288
s_add_u32 s52, s52, 101376
v_bfe_u32 v49, v48, 4, 2
v_lshl_add_u32 v239, v49, 4, v239
v_mov_b32 v241, s52
v_add_u32 v241, 8192, v241
v_bfe_u32 v49, v48, 4, 2
v_lshl_add_u32 v241, v49, 1, v241
v_bfe_u32 v49, v48, 0, 4
v_lshl_add_u32 v241, v49, 3, v241
buffer_load_dwordx4 v[152:155], v53, s[24:27], s54 offen offset:0
v_mov_b32 v240, s52
v_bfe_u32 v49, v48, 2, 2
v_lshl_add_u32 v240, v49, 7, v240
buffer_load_dwordx4 v[156:159], v53, s[24:27], s54 offen offset:1024
v_lshlrev_b32 v49, 2, v48
v_xor_b32 v49, v49, v48
v_and_b32 v49, 48, v49
buffer_load_dwordx4 v[160:163], v53, s[24:27], s54 offen offset:2048
s_lshl_b32 s53, s41, 10
v_add_u32 v240, v49, v240
v_mov_b32 v254, s53
v_add_u32 v254, 150528, v254
buffer_load_dwordx4 v[164:167], v53, s[24:27], s54 offen offset:3072
v_bfe_u32 v49, v48, 0, 6
v_mov_b32 v40, 0
v_mov_b32 v41, 0
buffer_load_dwordx4 v[168:171], v53, s[24:27], s57 offen offset:0
v_mov_b32 v42, 0
v_mov_b32 v43, 0
v_lshl_add_u32 v254, v49, 4, v254
buffer_load_dwordx4 v[172:175], v53, s[24:27], s57 offen offset:1024
ds_write_b128 v254, v[40:43] offset:0
buffer_load_dwordx4 v[176:179], v53, s[24:27], s57 offen offset:2048
ds_write_b128 v254, v[40:43] offset:256
buffer_load_dwordx4 v[180:183], v53, s[24:27], s57 offen offset:3072
buffer_load_dwordx4 v237, s[16:19], s48 offen nt lds
s_add_u32 m0, s49, 2112
s_add_u32 s48, s55, 2048
v_mov_b32 v245, s52
v_add_u32 v245, 4096, v245
buffer_load_dwordx4 v237, s[16:19], s48 offen nt lds
s_add_u32 m0, s49, 4224
s_add_u32 s48, s55, 4096
v_bfe_u32 v49, v48, 0, 2
buffer_load_dwordx4 v237, s[16:19], s48 offen nt lds
s_add_u32 m0, s49, 6336
s_add_u32 s48, s55, 6144
s_mov_b32 vcc_lo, 0x11111111
s_mov_b32 vcc_hi, 0x11111111
buffer_load_dwordx4 v237, s[16:19], s48 offen nt lds
s_add_u32 m0, s54, 50688
v_lshl_add_u32 v245, v49, 7, v245
v_mov_b32 v254, 150528
v_lshlrev_b32 v49, 4, v48
buffer_load_dwordx4 v50, s[28:31], s54 offen offset:0 lds
v_cndmask_b32 v240, v254, v240, vcc
v_xor_b32 v49, v49, v48
v_and_b32 v49, 48, v49
buffer_load_dwordx4 v51, s[28:31], s54 offen offset:1024 lds
s_mov_b32 vcc_lo, 0xf000f
s_mov_b32 vcc_hi, 0xf000f
v_add_u32 v245, v49, v245
buffer_load_dwordx4 v50, s[28:31], s54 offen offset:2048 lds
v_cndmask_b32 v242, v254, v245, vcc
s_mov_b32 vcc_lo, 0xf000f0
s_mov_b32 vcc_hi, 0xf000f0
buffer_load_dwordx4 v51, s[28:31], s54 offen offset:3072 lds
s_add_u32 m0, s57, 50688
v_cndmask_b32 v243, v254, v245, vcc
s_mov_b32 vcc_lo, 0xf000f00
s_mov_b32 vcc_hi, 0xf000f00
buffer_load_dwordx4 v50, s[28:31], s57 offen offset:0 lds
v_cndmask_b32 v244, v254, v245, vcc
s_mov_b32 vcc_lo, 0xf000f000
s_mov_b32 vcc_hi, 0xf000f000
v_mov_b32 v246, s52
buffer_load_dwordx4 v51, s[28:31], s57 offen offset:1024 lds
v_add_u32 v246, 4096, v246
v_bfe_u32 v49, v48, 0, 2
v_cndmask_b32 v245, v254, v245, vcc
buffer_load_dwordx4 v50, s[28:31], s57 offen offset:2048 lds
v_lshl_add_u32 v246, v49, 7, v246
v_mov_b32 v254, 154880
v_bfe_u32 v49, v48, 2, 2
buffer_load_dwordx4 v51, s[28:31], s57 offen offset:3072 lds
s_add_u32 m0, s49, 16896
s_mov_b32 vcc_lo, 0xf000f
s_mov_b32 vcc_hi, 0xf000f
v_lshl_add_u32 v254, v49, 3, v254
v_cndmask_b32 v246, v254, v246, vcc
v_xor_b32 v249, 32, v248
v_xor_b32 v250, 64, v248
v_xor_b32 v251, 96, v248
s_mul_i32 s4, s43, 13107200
s_add_u32 s4, s4, s44
s_add_u32 s4, s4, 24576
s_add_u32 s5, s55, 104857600
s_sub_u32 s5, s5, s4
s_add_u32 s48, s4, 0
v_xor_b32 v52, v53, v52
v_xor_b32 v55, 96, v54
v_xor_b32 v253, 64, v252
v_lshlrev_b32 v49, 4, v48
v_xor_b32 v49, v49, v48
v_and_b32 v49, 48, v49
v_add_u32 v246, v49, v246
v_add_u32 v246, v49, v246
v_mov_b32 v50, s52
v_bfe_u32 v49, v48, 0, 4
v_lshl_add_u32 v50, v49, 7, v50
v_lshlrev_b32 v49, 4, v48
v_xor_b32 v49, v49, v48
v_and_b32 v49, 48, v49
v_add_u32 v50, v49, v50
v_mov_b32 v51, s52
v_add_u32 v51, 8192, v51
v_bfe_u32 v49, v48, 4, 2
v_lshl_add_u32 v51, v49, 9, v51
v_bfe_u32 v49, v48, 0, 4
v_lshl_add_u32 v51, v49, 3, v51
s_add_u32 s50, s55, 13107200
s_mov_b32 s51, 2048
v_xor_b32 v247, 32, v48
s_mov_b32 s52, 0x7ff00000
v_lshlrev_b32 v247, 2, v247
s_waitcnt vmcnt(19)
v_and_b32 v254, 0xffff0000, v152
buffer_load_dwordx4 v237, s[16:19], s48 offen nt lds
s_add_u32 m0, s49, 19008
s_add_u32 s48, s4, 26214400
v_and_b32 v255, 0xffff0000, v153
v_lshlrev_b32 v152, 16, v152
v_lshlrev_b32 v153, 16, v153
v_mul_f32 v254, s40, v254
v_mul_f32 v152, s40, v152
v_mul_f32 v255, s40, v255
v_mul_f32 v153, s40, v153
v_cvt_pk_bf16_f32 v152, v152, v254
v_cvt_pk_bf16_f32 v153, v153, v255
v_and_b32 v254, 0xffff0000, v154
v_and_b32 v255, 0xffff0000, v155
v_lshlrev_b32 v154, 16, v154
v_lshlrev_b32 v155, 16, v155
v_mul_f32 v254, s40, v254
v_mul_f32 v154, s40, v154
v_mul_f32 v255, s40, v255
v_mul_f32 v155, s40, v155
v_cvt_pk_bf16_f32 v154, v154, v254
v_cvt_pk_bf16_f32 v155, v155, v255
s_waitcnt vmcnt(19)
v_and_b32 v254, 0xffff0000, v156
v_and_b32 v255, 0xffff0000, v157
v_lshlrev_b32 v156, 16, v156
v_lshlrev_b32 v157, 16, v157
v_mul_f32 v254, s40, v254
v_mul_f32 v156, s40, v156
v_mul_f32 v255, s40, v255
v_mul_f32 v157, s40, v157
v_cvt_pk_bf16_f32 v156, v156, v254
buffer_load_dwordx4 v237, s[16:19], s48 offen nt lds
s_add_u32 m0, s49, 21120
s_add_u32 s48, s4, 52428800
v_cvt_pk_bf16_f32 v157, v157, v255
v_and_b32 v254, 0xffff0000, v158
v_and_b32 v255, 0xffff0000, v159
v_lshlrev_b32 v158, 16, v158
v_lshlrev_b32 v159, 16, v159
v_mul_f32 v254, s40, v254
v_mul_f32 v158, s40, v158
v_mul_f32 v255, s40, v255
v_mul_f32 v159, s40, v159
v_cvt_pk_bf16_f32 v158, v158, v254
v_cvt_pk_bf16_f32 v159, v159, v255
s_waitcnt vmcnt(19)
v_and_b32 v254, 0xffff0000, v160
v_and_b32 v255, 0xffff0000, v161
v_lshlrev_b32 v160, 16, v160
v_lshlrev_b32 v161, 16, v161
v_mul_f32 v254, s40, v254
v_mul_f32 v160, s40, v160
v_mul_f32 v255, s40, v255
v_mul_f32 v161, s40, v161
v_cvt_pk_bf16_f32 v160, v160, v254
v_cvt_pk_bf16_f32 v161, v161, v255
v_and_b32 v254, 0xffff0000, v162
v_and_b32 v255, 0xffff0000, v163
v_lshlrev_b32 v162, 16, v162
v_lshlrev_b32 v163, 16, v163
v_mul_f32 v254, s40, v254
v_mul_f32 v162, s40, v162
v_mul_f32 v255, s40, v255
v_mul_f32 v163, s40, v163
v_cvt_pk_bf16_f32 v162, v162, v254
buffer_load_dwordx4 v237, s[16:19], s48 offen nt lds
s_add_u32 m0, s49, 23232
s_add_u32 s48, s4, 78643200
ds_write_b128 v104, v[152:155] offset:0
ds_write_b128 v105, v[156:159] offset:1024
v_cvt_pk_bf16_f32 v163, v163, v255
s_waitcnt vmcnt(19)
v_and_b32 v254, 0xffff0000, v164
v_and_b32 v255, 0xffff0000, v165
v_lshlrev_b32 v164, 16, v164
v_lshlrev_b32 v165, 16, v165
v_mul_f32 v254, s40, v254
v_mul_f32 v164, s40, v164
v_mul_f32 v255, s40, v255
v_mul_f32 v165, s40, v165
v_cvt_pk_bf16_f32 v164, v164, v254
v_cvt_pk_bf16_f32 v165, v165, v255
v_and_b32 v254, 0xffff0000, v166
v_and_b32 v255, 0xffff0000, v167
v_lshlrev_b32 v166, 16, v166
v_lshlrev_b32 v167, 16, v167
v_mul_f32 v254, s40, v254
buffer_load_dwordx4 v237, s[16:19], s48 offen nt lds
s_add_u32 m0, s54, 116224
s_add_u32 s48, s55, 8192
ds_write_b128 v104, v[160:163] offset:2048
v_mul_f32 v166, s40, v166
v_mul_f32 v255, s40, v255
v_mul_f32 v167, s40, v167
v_cvt_pk_bf16_f32 v166, v166, v254
v_cvt_pk_bf16_f32 v167, v167, v255
s_waitcnt vmcnt(19)
v_and_b32 v254, 0xffff0000, v168
v_and_b32 v255, 0xffff0000, v169
v_lshlrev_b32 v168, 16, v168
v_lshlrev_b32 v169, 16, v169
v_mul_f32 v254, s40, v254
v_mul_f32 v168, s40, v168
v_mul_f32 v255, s40, v255
v_mul_f32 v169, s40, v169
v_cvt_pk_bf16_f32 v168, v168, v254
v_cvt_pk_bf16_f32 v169, v169, v255
v_and_b32 v254, 0xffff0000, v170
v_and_b32 v255, 0xffff0000, v171
v_lshlrev_b32 v170, 16, v170
v_lshlrev_b32 v171, 16, v171
v_mul_f32 v254, s40, v254
v_mul_f32 v170, s40, v170
v_mul_f32 v255, s40, v255
v_mul_f32 v171, s40, v171
buffer_load_dwordx4 v52, s[32:35], s54 offen offset:0 lds
ds_write_b128 v105, v[164:167] offset:3072
v_cvt_pk_bf16_f32 v170, v170, v254
v_cvt_pk_bf16_f32 v171, v171, v255
s_waitcnt vmcnt(19)
v_and_b32 v254, 0xffff0000, v172
v_and_b32 v255, 0xffff0000, v173
v_lshlrev_b32 v172, 16, v172
v_lshlrev_b32 v173, 16, v173
v_mul_f32 v254, s40, v254
v_mul_f32 v172, s40, v172
v_mul_f32 v255, s40, v255
v_mul_f32 v173, s40, v173
v_cvt_pk_bf16_f32 v172, v172, v254
v_cvt_pk_bf16_f32 v173, v173, v255
v_and_b32 v254, 0xffff0000, v174
v_and_b32 v255, 0xffff0000, v175
v_lshlrev_b32 v174, 16, v174
v_lshlrev_b32 v175, 16, v175
v_mul_f32 v254, s40, v254
v_mul_f32 v174, s40, v174
v_mul_f32 v255, s40, v255
v_mul_f32 v175, s40, v175
v_cvt_pk_bf16_f32 v174, v174, v254
v_cvt_pk_bf16_f32 v175, v175, v255
s_waitcnt vmcnt(18)
v_and_b32 v254, 0xffff0000, v176
v_and_b32 v255, 0xffff0000, v177
v_lshlrev_b32 v176, 16, v176
buffer_load_dwordx4 v52, s[32:35], s54 offen offset:1024 lds
ds_write_b128 v104, v[168:171] offset:4096
v_lshlrev_b32 v177, 16, v177
v_mul_f32 v254, s40, v254
v_mul_f32 v176, s40, v176
v_mul_f32 v255, s40, v255
v_mul_f32 v177, s40, v177
v_cvt_pk_bf16_f32 v176, v176, v254
v_cvt_pk_bf16_f32 v177, v177, v255
v_and_b32 v254, 0xffff0000, v178
v_and_b32 v255, 0xffff0000, v179
v_lshlrev_b32 v178, 16, v178
v_lshlrev_b32 v179, 16, v179
v_mul_f32 v254, s40, v254
v_mul_f32 v178, s40, v178
v_mul_f32 v255, s40, v255
v_mul_f32 v179, s40, v179
v_cvt_pk_bf16_f32 v178, v178, v254
v_cvt_pk_bf16_f32 v179, v179, v255
s_waitcnt vmcnt(18)
v_and_b32 v254, 0xffff0000, v180
v_and_b32 v255, 0xffff0000, v181
v_lshlrev_b32 v180, 16, v180
v_lshlrev_b32 v181, 16, v181
v_mul_f32 v254, s40, v254
v_mul_f32 v180, s40, v180
v_mul_f32 v255, s40, v255
v_mul_f32 v181, s40, v181
buffer_load_dwordx4 v52, s[32:35], s54 offen offset:2048 lds
ds_write_b128 v105, v[172:175] offset:5120
ds_write_b128 v104, v[176:179] offset:6144
v_cvt_pk_bf16_f32 v180, v180, v254
v_cvt_pk_bf16_f32 v181, v181, v255
v_and_b32 v254, 0xffff0000, v182
v_and_b32 v255, 0xffff0000, v183
v_lshlrev_b32 v182, 16, v182
v_lshlrev_b32 v183, 16, v183
v_mul_f32 v254, s40, v254
v_mul_f32 v182, s40, v182
v_mul_f32 v255, s40, v255
v_mul_f32 v183, s40, v183
v_cvt_pk_bf16_f32 v182, v182, v254
v_cvt_pk_bf16_f32 v183, v183, v255
ds_write_b128 v105, v[180:183] offset:7168
buffer_load_dwordx4 v52, s[32:35], s54 offen offset:3072 lds
s_add_u32 m0, s57, 116224
v_xor_b32 v254, 32, v54
v_xor_b32 v255, 64, v54
s_mov_b32 s53, 0x7ff00000
buffer_load_dwordx4 v52, s[32:35], s57 offen offset:0 lds
buffer_load_dwordx4 v52, s[32:35], s57 offen offset:1024 lds
s_waitcnt vmcnt(10) lgkmcnt(0)
s_barrier
ds_read_b64_tr_b16 a[64:65], v248 offset:0
ds_read_b64_tr_b16 a[66:67], v248 offset:512
ds_read_b128 v[188:191], v236 offset:0
ds_read_b64_tr_b16 a[68:69], v248 offset:4096
ds_read_b64_tr_b16 a[70:71], v248 offset:4608
buffer_load_dwordx4 v52, s[32:35], s57 offen offset:2048 lds
ds_read_b128 v[196:199], v236 offset:256
ds_read_b64_tr_b16 a[72:73], v248 offset:8192
ds_read_b64_tr_b16 a[74:75], v248 offset:8704
ds_read_b128 v[200:203], v236 offset:512
ds_read_b64_tr_b16 a[76:77], v248 offset:12288
ds_read_b64_tr_b16 a[78:79], v248 offset:12800
ds_read_b128 v[204:207], v236 offset:768
ds_read_b64_tr_b16 a[92:93], v249 offset:12288
ds_read_b64_tr_b16 a[94:95], v249 offset:12800
ds_read_b64_tr_b16 a[88:89], v249 offset:8192
ds_read_b64_tr_b16 a[90:91], v249 offset:8704
ds_read_b64_tr_b16 a[84:85], v249 offset:4096
ds_read_b64_tr_b16 a[86:87], v249 offset:4608
ds_read_b64_tr_b16 a[80:81], v249 offset:0
ds_read_b64_tr_b16 a[82:83], v249 offset:512
s_waitcnt lgkmcnt(15)
v_mfma_f32_16x16x32_bf16 v[192:195], a[64:67], v[188:191], 0
ds_read_b64_tr_b16 a[96:97], v250 offset:0
ds_read_b64_tr_b16 a[98:99], v250 offset:512
s_waitcnt lgkmcnt(15)
v_mfma_f32_16x16x32_bf16 v[192:195], a[68:71], v[196:199], v[192:195]
s_waitcnt lgkmcnt(14)
ds_read_b64_tr_b16 a[100:101], v250 offset:4096
s_waitcnt lgkmcnt(14)
v_mfma_f32_16x16x32_bf16 v[192:195], a[72:75], v[200:203], v[192:195]
s_waitcnt lgkmcnt(11)
ds_read_b64_tr_b16 a[102:103], v250 offset:4608
ds_read_b64_tr_b16 a[104:105], v250 offset:8192
v_mfma_f32_16x16x32_bf16 v[192:195], a[76:79], v[204:207], v[192:195]
s_waitcnt lgkmcnt(9)
ds_read_b64_tr_b16 a[106:107], v250 offset:8704
ds_read_b64_tr_b16 a[108:109], v250 offset:12288
v_mfma_f32_16x16x32_bf16 v[208:211], a[92:95], v[204:207], 0
s_waitcnt lgkmcnt(7)
buffer_load_dwordx4 v52, s[32:35], s57 offen offset:3072 lds
s_add_u32 m0, s49, 8448
v_mfma_f32_16x16x32_bf16 v[208:211], a[88:91], v[200:203], v[208:211]
ds_read_b64_tr_b16 a[110:111], v250 offset:12800
v_cvt_pk_bf16_f32 v0, v192, v193
v_mfma_f32_16x16x32_bf16 v[208:211], a[84:87], v[196:199], v[208:211]
s_waitcnt lgkmcnt(6)
ds_read_b64_tr_b16 a[124:125], v251 offset:12288
v_cvt_pk_bf16_f32 v1, v194, v195
v_mfma_f32_16x16x32_bf16 v[208:211], a[80:83], v[188:191], v[208:211]
s_waitcnt lgkmcnt(6)
ds_read_b64_tr_b16 a[126:127], v251 offset:12800
ds_read_b64_tr_b16 a[120:121], v251 offset:8192
v_mfma_f32_16x16x32_bf16 v[192:195], a[96:99], v[188:191], 0
s_waitcnt lgkmcnt(6)
ds_read_b64_tr_b16 a[122:123], v251 offset:8704
ds_read_b64_tr_b16 a[116:117], v251 offset:4096
v_mfma_f32_16x16x32_bf16 v[192:195], a[100:103], v[196:199], v[192:195]
s_waitcnt lgkmcnt(6)
ds_read_b64_tr_b16 a[118:119], v251 offset:4608
v_cvt_pk_bf16_f32 v2, v208, v209
v_mfma_f32_16x16x32_bf16 v[192:195], a[104:107], v[200:203], v[192:195]
ds_read_b64_tr_b16 a[112:113], v251 offset:0
s_waitcnt lgkmcnt(7)
v_mfma_f32_16x16x32_bf16 v[192:195], a[108:111], v[204:207], v[192:195]
ds_read_b64_tr_b16 a[114:115], v251 offset:512
v_cvt_pk_bf16_f32 v3, v210, v211
ds_read_b128 v[184:187], v236 offset:4992
s_waitcnt lgkmcnt(7)
v_mfma_f32_16x16x32_bf16 v[208:211], a[124:127], v[204:207], 0
s_waitcnt lgkmcnt(6)
buffer_load_dwordx4 v[120:123], v53, s[36:39], s54 offen offset:0
s_waitcnt lgkmcnt(5)
v_mfma_f32_16x16x32_bf16 v[208:211], a[120:123], v[200:203], v[208:211]
s_waitcnt lgkmcnt(4)
ds_read_b128 v[216:219], v236 offset:4736
s_waitcnt lgkmcnt(4)
v_mfma_f32_16x16x32_bf16 v[208:211], a[116:119], v[196:199], v[208:211]
ds_read_b128 v[204:207], v236 offset:4480
v_cvt_pk_bf16_f32 v5, v194, v195
v_cvt_pk_bf16_f32 v4, v192, v193
s_waitcnt lgkmcnt(3)
v_mfma_f32_16x16x32_bf16 v[208:211], a[112:115], v[188:191], v[208:211]
ds_read_b128 v[192:195], v236 offset:4224
s_waitcnt lgkmcnt(3)
v_mfma_f32_16x16x32_bf16 v[200:203], a[124:127], v[184:187], 0
ds_read_b64_tr_b16 a[0:1], v248 offset:32768
ds_read_b64_tr_b16 a[2:3], v248 offset:33280
v_mfma_f32_16x16x32_bf16 v[220:223], a[92:95], v[184:187], 0
ds_read_b64_tr_b16 a[4:5], v248 offset:36864
s_waitcnt lgkmcnt(5)
v_mfma_f32_16x16x32_bf16 v[200:203], a[120:123], v[216:219], v[200:203]
ds_read_b64_tr_b16 a[6:7], v248 offset:37376
s_waitcnt lgkmcnt(5)
v_mfma_f32_16x16x32_bf16 v[200:203], a[116:119], v[204:207], v[200:203]
ds_read_b64_tr_b16 a[8:9], v248 offset:40960
v_cvt_pk_bf16_f32 v6, v208, v209
v_mfma_f32_16x16x32_bf16 v[220:223], a[88:91], v[216:219], v[220:223]
buffer_load_dwordx4 v[124:127], v53, s[36:39], s54 offen offset:1024
s_waitcnt lgkmcnt(5)
v_mfma_f32_16x16x32_bf16 v[200:203], a[112:115], v[192:195], v[200:203]
ds_read_b64_tr_b16 a[10:11], v248 offset:41472
v_cvt_pk_bf16_f32 v7, v210, v211
v_mfma_f32_16x16x32_bf16 v[208:211], a[96:99], v[192:195], 0
s_waitcnt lgkmcnt(4)
ds_read_b64_tr_b16 a[12:13], v248 offset:45056
ds_read_b64_tr_b16 a[14:15], v248 offset:45568
v_mfma_f32_16x16x32_bf16 v[208:211], a[100:103], v[204:207], v[208:211]
s_waitcnt lgkmcnt(5)
ds_read_b64_tr_b16 a[16:17], v249 offset:32768
ds_read_b64_tr_b16 a[18:19], v249 offset:33280
v_mfma_f32_16x16x32_bf16 v[208:211], a[104:107], v[216:219], v[208:211]
s_waitcnt lgkmcnt(6)
ds_read_b64_tr_b16 a[20:21], v249 offset:36864
ds_read_b64_tr_b16 a[22:23], v249 offset:37376
v_mfma_f32_16x16x32_bf16 v[208:211], a[108:111], v[184:187], v[208:211]
s_waitcnt lgkmcnt(7)
ds_read_b64_tr_b16 a[24:25], v249 offset:40960
ds_read_b64_tr_b16 a[26:27], v249 offset:41472
v_mfma_f32_16x16x32_bf16 v[220:223], a[84:87], v[204:207], v[220:223]
ds_read_b64_tr_b16 a[28:29], v249 offset:45056
ds_read_b64_tr_b16 a[30:31], v249 offset:45568
v_mfma_f32_16x16x32_bf16 v[220:223], a[80:83], v[192:195], v[220:223]
s_waitcnt lgkmcnt(10)
ds_read_b64_tr_b16 a[32:33], v250 offset:32768
ds_read_b64_tr_b16 a[34:35], v250 offset:33280
v_mfma_f32_16x16x32_bf16 v[188:191], a[64:67], v[192:195], 0
s_waitcnt lgkmcnt(10)
ds_read_b64_tr_b16 a[36:37], v250 offset:36864
ds_read_b64_tr_b16 a[38:39], v250 offset:37376
v_mfma_f32_16x16x32_bf16 v[188:191], a[72:75], v[216:219], v[188:191]
s_waitcnt lgkmcnt(10)
buffer_load_dwordx4 v[128:131], v53, s[36:39], s54 offen offset:2048
ds_read_b64_tr_b16 a[40:41], v250 offset:40960
v_mfma_f32_16x16x32_bf16 v[188:191], a[76:79], v[184:187], v[188:191]
s_waitcnt lgkmcnt(9)
ds_read_b64_tr_b16 a[42:43], v250 offset:41472
ds_read_b64_tr_b16 a[44:45], v250 offset:45056
v_mfma_f32_16x16x32_bf16 v[188:191], a[68:71], v[204:207], v[188:191]
s_waitcnt lgkmcnt(9)
ds_read_b64_tr_b16 a[46:47], v250 offset:45568
ds_read_b64_tr_b16 a[48:49], v251 offset:32768
ds_read_b64_tr_b16 a[50:51], v251 offset:33280
ds_read_b64_tr_b16 a[52:53], v251 offset:36864
ds_read_b64_tr_b16 a[54:55], v251 offset:37376
ds_read_b64_tr_b16 a[56:57], v251 offset:40960
ds_read_b64_tr_b16 a[58:59], v251 offset:41472
s_waitcnt vmcnt(11)
s_barrier
ds_read_b128 v[56:59], v236 offset:16896
ds_read_b128 v[60:63], v236 offset:17152
ds_read_b128 v[64:67], v236 offset:17408
ds_read_b128 v[68:71], v236 offset:17664
ds_read_b128 v[72:75], v236 offset:21120
ds_read_b128 v[76:79], v236 offset:21376
ds_read_b128 v[80:83], v236 offset:21632
ds_read_b128 v[84:87], v236 offset:21888
ds_read_b64_tr_b16 a[60:61], v251 offset:45056
ds_read_b64_tr_b16 a[62:63], v251 offset:45568
v_cvt_pk_bf16_f32 v14, v200, v201
buffer_load_dwordx4 v[132:135], v53, s[36:39], s54 offen offset:3072
v_cvt_pk_bf16_f32 v15, v202, v203
v_cvt_pk_bf16_f32 v9, v190, v191
v_cvt_pk_bf16_f32 v8, v188, v189
v_cvt_pk_bf16_f32 v13, v210, v211
v_cvt_pk_bf16_f32 v12, v208, v209
v_cvt_pk_bf16_f32 v10, v220, v221
v_cvt_pk_bf16_f32 v11, v222, v223
s_waitcnt lgkmcnt(9)
v_mfma_f32_16x16x32_bf16 v[156:159], a[64:67], v[56:59], 0
s_waitcnt lgkmcnt(7)
v_mfma_f32_16x16x32_bf16 v[156:159], a[68:71], v[60:63], v[156:159]
s_waitcnt lgkmcnt(3)
v_mfma_f32_16x16x32_bf16 v[156:159], a[72:75], v[64:67], v[156:159]
s_waitcnt lgkmcnt(0)
v_mfma_f32_16x16x32_bf16 v[156:159], a[76:79], v[68:71], v[156:159]
s_nop 2
v_mfma_f32_16x16x32_bf16 v[160:163], a[92:95], v[68:71], 0
s_nop 2
v_mfma_f32_16x16x32_bf16 v[160:163], a[88:91], v[64:67], v[160:163]
s_waitcnt vmcnt(4)
s_barrier
v_mfma_f32_16x16x32_bf16 v[160:163], a[84:87], v[60:63], v[160:163]
buffer_load_dwordx4 v[136:139], v53, s[36:39], s57 offen offset:0
ds_read_b64_tr_b16 a[128:129], v252 offset:0
v_mfma_f32_16x16x32_bf16 v[160:163], a[80:83], v[56:59], v[160:163]
ds_read_b64_tr_b16 a[130:131], v252 offset:512
ds_read_b64_tr_b16 a[132:133], v252 offset:4096
v_mfma_f32_16x16x32_bf16 v[164:167], a[96:99], v[56:59], 0
ds_read_b64_tr_b16 a[134:135], v252 offset:4608
ds_read_b64_tr_b16 a[136:137], v252 offset:8192
v_mfma_f32_16x16x32_bf16 v[164:167], a[100:103], v[60:63], v[164:167]
ds_read_b64_tr_b16 a[138:139], v252 offset:8704
ds_read_b64_tr_b16 a[140:141], v252 offset:12288
v_mfma_f32_16x16x32_bf16 v[164:167], a[104:107], v[64:67], v[164:167]
ds_read_b64_tr_b16 a[142:143], v252 offset:12800
ds_read_b64_tr_b16 a[144:145], v252 offset:8
v_mfma_f32_16x16x32_bf16 v[164:167], a[108:111], v[68:71], v[164:167]
ds_read_b64_tr_b16 a[146:147], v252 offset:520
ds_read_b64_tr_b16 a[148:149], v252 offset:4104
v_mfma_f32_16x16x32_bf16 v[168:171], a[124:127], v[68:71], 0
s_waitcnt lgkmcnt(10)
ds_read_b64_tr_b16 a[150:151], v252 offset:4616
v_cvt_pk_bf16_f32 v88, v156, v157
v_mfma_f32_16x16x32_bf16 v[168:171], a[120:123], v[64:67], v[168:171]
s_waitcnt lgkmcnt(9)
ds_read_b64_tr_b16 a[152:153], v252 offset:8200
v_cvt_pk_bf16_f32 v89, v158, v159
v_mfma_f32_16x16x32_bf16 v[168:171], a[116:119], v[60:63], v[168:171]
s_waitcnt lgkmcnt(8)
ds_read_b64_tr_b16 a[154:155], v252 offset:8712
ds_read_b64_tr_b16 a[156:157], v252 offset:12296
v_mfma_f32_16x16x32_bf16 v[168:171], a[112:115], v[56:59], v[168:171]
s_waitcnt lgkmcnt(8)
buffer_load_dwordx4 v[140:143], v53, s[36:39], s57 offen offset:1024
ds_read_b64_tr_b16 a[158:159], v252 offset:12808
v_mfma_f32_16x16x32_bf16 v[172:175], a[64:67], v[72:75], 0
s_waitcnt lgkmcnt(7)
ds_read_b64_tr_b16 a[160:161], v253 offset:0
v_cvt_pk_bf16_f32 v90, v160, v161
v_mfma_f32_16x16x32_bf16 v[172:175], a[68:71], v[76:79], v[172:175]
s_waitcnt lgkmcnt(6)
ds_read_b64_tr_b16 a[162:163], v253 offset:512
v_cvt_pk_bf16_f32 v91, v162, v163
v_mfma_f32_16x16x32_bf16 v[172:175], a[72:75], v[80:83], v[172:175]
s_waitcnt lgkmcnt(6)
ds_read_b64_tr_b16 a[164:165], v253 offset:4096
ds_read_b64_tr_b16 a[166:167], v253 offset:4608
v_mfma_f32_16x16x32_bf16 v[172:175], a[76:79], v[84:87], v[172:175]
s_waitcnt lgkmcnt(7)
ds_read_b64_tr_b16 a[168:169], v253 offset:8192
ds_read_b64_tr_b16 a[170:171], v253 offset:8704
v_mfma_f32_16x16x32_bf16 v[176:179], a[92:95], v[84:87], 0
s_waitcnt lgkmcnt(7)
ds_read_b64_tr_b16 a[172:173], v253 offset:12288
v_cvt_pk_bf16_f32 v92, v164, v165
v_mfma_f32_16x16x32_bf16 v[176:179], a[88:91], v[80:83], v[176:179]
s_waitcnt lgkmcnt(7)
ds_read_b64_tr_b16 a[174:175], v253 offset:12800
v_cvt_pk_bf16_f32 v93, v166, v167
v_mfma_f32_16x16x32_bf16 v[176:179], a[84:87], v[76:79], v[176:179]
s_waitcnt lgkmcnt(7)
ds_read_b64_tr_b16 a[176:177], v253 offset:8
ds_read_b64_tr_b16 a[178:179], v253 offset:520
v_mfma_f32_16x16x32_bf16 v[176:179], a[80:83], v[72:75], v[176:179]
s_waitcnt lgkmcnt(8)
ds_read_b64_tr_b16 a[180:181], v253 offset:4104
ds_read_b64_tr_b16 a[182:183], v253 offset:4616
v_mfma_f32_16x16x32_bf16 v[180:183], a[96:99], v[72:75], 0
s_waitcnt lgkmcnt(8)
buffer_load_dwordx4 v[144:147], v53, s[36:39], s57 offen offset:2048
v_cvt_pk_bf16_f32 v94, v168, v169
v_mfma_f32_16x16x32_bf16 v[180:183], a[100:103], v[76:79], v[180:183]
s_waitcnt lgkmcnt(6)
ds_read_b64_tr_b16 a[184:185], v253 offset:8200
v_cvt_pk_bf16_f32 v95, v170, v171
v_mfma_f32_16x16x32_bf16 v[180:183], a[104:107], v[80:83], v[180:183]
s_waitcnt lgkmcnt(6)
ds_read_b64_tr_b16 a[186:187], v253 offset:8712
ds_read_b64_tr_b16 a[188:189], v253 offset:12296
v_mfma_f32_16x16x32_bf16 v[180:183], a[108:111], v[84:87], v[180:183]
s_waitcnt lgkmcnt(7)
ds_read_b64_tr_b16 a[190:191], v253 offset:12808
v_cvt_pk_bf16_f32 v96, v172, v173
v_mfma_f32_16x16x32_bf16 v[152:155], a[124:127], v[84:87], 0
s_waitcnt lgkmcnt(6)
v_cvt_pk_bf16_f32 v97, v174, v175
v_cvt_pk_bf16_f32 v98, v176, v177
v_mfma_f32_16x16x32_bf16 v[152:155], a[120:123], v[80:83], v[152:155]
s_waitcnt lgkmcnt(4)
v_cvt_pk_bf16_f32 v99, v178, v179
v_cvt_pk_bf16_f32 v100, v180, v181
v_mfma_f32_16x16x32_bf16 v[152:155], a[116:119], v[76:79], v[152:155]
v_cvt_pk_bf16_f32 v101, v182, v183
v_mov_b32 v253, 0
v_mfma_f32_16x16x32_bf16 v[152:155], a[112:115], v[72:75], v[152:155]
s_waitcnt lgkmcnt(3)
v_mov_b32 v252, 1.0
s_nop 0
v_mfma_f32_16x16x32_bf16 v[156:159], a[0:3], v[56:59], 0
s_waitcnt lgkmcnt(1)
s_nop 1
v_mfma_f32_16x16x32_bf16 v[156:159], a[4:7], v[60:63], v[156:159]
s_waitcnt lgkmcnt(0)
buffer_load_dwordx4 v[148:151], v53, s[36:39], s57 offen offset:3072
v_cvt_pk_bf16_f32 v102, v152, v153
v_mfma_f32_16x16x32_bf16 v[156:159], a[8:11], v[64:67], v[156:159]
v_cvt_pk_bf16_f32 v103, v154, v155
v_mfma_f32_16x16x32_bf16 v[156:159], a[12:15], v[68:71], v[156:159]
s_nop 2
v_mfma_f32_16x16x32_bf16 v[160:163], a[28:31], v[68:71], 0
s_nop 2
v_mfma_f32_16x16x32_bf16 v[160:163], a[24:27], v[64:67], v[160:163]
v_cvt_pk_bf16_f32 v104, v156, v157
v_cvt_pk_bf16_f32 v105, v158, v159
v_mfma_f32_16x16x32_bf16 v[160:163], a[20:23], v[60:63], v[160:163]
v_mfma_f32_16x16x32_bf16 v[160:163], a[16:19], v[56:59], v[160:163]
s_nop 2
v_mfma_f32_16x16x32_bf16 v[164:167], a[32:35], v[56:59], 0
s_nop 2
v_mfma_f32_16x16x32_bf16 v[164:167], a[36:39], v[60:63], v[164:167]
v_cvt_pk_bf16_f32 v106, v160, v161
v_cvt_pk_bf16_f32 v107, v162, v163
v_mfma_f32_16x16x32_bf16 v[164:167], a[40:43], v[64:67], v[164:167]
buffer_load_dwordx4 v237, s[16:19], s48 offen nt lds
s_add_u32 m0, s49, 10560
v_mfma_f32_16x16x32_bf16 v[164:167], a[44:47], v[68:71], v[164:167]
s_add_u32 s48, s55, 10240
s_nop 1
v_mfma_f32_16x16x32_bf16 v[168:171], a[60:63], v[68:71], 0
s_nop 2
v_mfma_f32_16x16x32_bf16 v[168:171], a[56:59], v[64:67], v[168:171]
v_cvt_pk_bf16_f32 v108, v164, v165
v_cvt_pk_bf16_f32 v109, v166, v167
v_mfma_f32_16x16x32_bf16 v[168:171], a[52:55], v[60:63], v[168:171]
v_mfma_f32_16x16x32_bf16 v[168:171], a[48:51], v[56:59], v[168:171]
s_nop 2
v_mfma_f32_16x16x32_bf16 v[172:175], a[0:3], v[72:75], 0
s_waitcnt vmcnt(8)
ds_write_b64 v54, v[120:121] offset:0
v_mfma_f32_16x16x32_bf16 v[172:175], a[4:7], v[76:79], v[172:175]
ds_write_b64 v254, v[122:123] offset:0
v_mfma_f32_16x16x32_bf16 v[172:175], a[8:11], v[80:83], v[172:175]
buffer_load_dwordx4 v237, s[16:19], s48 offen nt lds
v_mfma_f32_16x16x32_bf16 v[172:175], a[12:15], v[84:87], v[172:175]
s_add_u32 m0, s49, 12672
s_add_u32 s48, s55, 12288
v_cvt_pk_bf16_f32 v110, v168, v169
v_mfma_f32_16x16x32_bf16 v[176:179], a[28:31], v[84:87], 0
s_waitcnt vmcnt(8)
ds_write_b64 v54, v[124:125] offset:512
v_mfma_f32_16x16x32_bf16 v[176:179], a[24:27], v[80:83], v[176:179]
ds_write_b64 v254, v[126:127] offset:512
v_mfma_f32_16x16x32_bf16 v[176:179], a[20:23], v[76:79], v[176:179]
s_waitcnt vmcnt(7)
ds_write_b64 v255, v[128:129] offset:1024
v_mfma_f32_16x16x32_bf16 v[176:179], a[16:19], v[72:75], v[176:179]
ds_write_b64 v55, v[130:131] offset:1024
v_mfma_f32_16x16x32_bf16 v[180:183], a[32:35], v[72:75], 0
s_waitcnt vmcnt(6)
ds_write_b64 v255, v[132:133] offset:1536
v_mfma_f32_16x16x32_bf16 v[180:183], a[36:39], v[76:79], v[180:183]
ds_write_b64 v55, v[134:135] offset:1536
v_mfma_f32_16x16x32_bf16 v[180:183], a[40:43], v[80:83], v[180:183]
buffer_load_dwordx4 v237, s[16:19], s48 offen nt lds
s_add_u32 m0, s49, 14784
v_mfma_f32_16x16x32_bf16 v[180:183], a[44:47], v[84:87], v[180:183]
s_add_u32 s48, s55, 14336
v_cvt_pk_bf16_f32 v111, v170, v171
v_cvt_pk_bf16_f32 v112, v172, v173
v_mfma_f32_16x16x32_bf16 v[152:155], a[60:63], v[84:87], 0
s_waitcnt vmcnt(6)
ds_write_b64 v54, v[136:137] offset:2048
v_mfma_f32_16x16x32_bf16 v[152:155], a[56:59], v[80:83], v[152:155]
ds_write_b64 v254, v[138:139] offset:2048
v_mfma_f32_16x16x32_bf16 v[152:155], a[52:55], v[76:79], v[152:155]
s_waitcnt vmcnt(5)
ds_write_b64 v54, v[140:141] offset:2560
v_mfma_f32_16x16x32_bf16 v[152:155], a[48:51], v[72:75], v[152:155]
ds_write_b64 v254, v[142:143] offset:2560
v_mfma_f32_16x16x32_bf16 v[156:159], v[56:59], a[128:131], 0
s_waitcnt vmcnt(4)
ds_write_b64 v255, v[144:145] offset:3072
v_mfma_f32_16x16x32_bf16 v[156:159], v[60:63], a[132:135], v[156:159]
ds_write_b64 v55, v[146:147] offset:3072
v_mfma_f32_16x16x32_bf16 v[156:159], v[64:67], a[136:139], v[156:159]
buffer_load_dwordx4 v237, s[16:19], s48 offen nt lds
s_add_u32 m0, s49, 16896
v_mfma_f32_16x16x32_bf16 v[156:159], v[68:71], a[140:143], v[156:159]
s_add_u32 s48, s55, 16384
buffer_load_dwordx4 v237, s[16:19], s48 offen nt lds
s_add_u32 m0, s49, 19008
v_mfma_f32_16x16x32_bf16 v[160:163], v[68:71], a[156:159], 0
s_add_u32 s48, s55, 18432
buffer_load_dwordx4 v237, s[16:19], s48 offen nt lds
s_add_u32 m0, s49, 21120
v_mfma_f32_16x16x32_bf16 v[160:163], v[64:67], a[152:155], v[160:163]
s_add_u32 s48, s55, 20480
buffer_load_dwordx4 v237, s[16:19], s48 offen nt lds
s_add_u32 m0, s49, 23232
v_mfma_f32_16x16x32_bf16 v[160:163], v[60:63], a[148:151], v[160:163]
s_add_u32 s48, s55, 22528
buffer_load_dwordx4 v237, s[16:19], s48 offen nt lds
v_cvt_pk_bf16_f32 v113, v174, v175
v_mfma_f32_16x16x32_bf16 v[160:163], v[56:59], a[144:147], v[160:163]
s_add_u32 s49, s49, 50688
v_cvt_pk_bf16_f32 v114, v176, v177
v_cvt_pk_bf16_f32 v115, v178, v179
v_mfma_f32_16x16x32_bf16 v[164:167], v[56:59], a[160:163], 0
s_waitcnt vmcnt(8)
ds_write_b64 v255, v[148:149] offset:3584
v_mfma_f32_16x16x32_bf16 v[164:167], v[60:63], a[164:167], v[164:167]
ds_write_b64 v55, v[150:151] offset:3584
v_mfma_f32_16x16x32_bf16 v[164:167], v[64:67], a[168:171], v[164:167]
v_cvt_pk_bf16_f32 v116, v180, v181
v_cvt_pk_bf16_f32 v117, v182, v183
v_mfma_f32_16x16x32_bf16 v[164:167], v[68:71], a[172:175], v[164:167]
v_cvt_pk_bf16_f32 v118, v152, v153
v_cvt_pk_bf16_f32 v119, v154, v155
v_mfma_f32_16x16x32_bf16 v[168:171], v[68:71], a[188:191], 0
v_cvt_pk_bf16_f32 v156, v156, v157
v_cvt_pk_bf16_f32 v157, v158, v159
v_mfma_f32_16x16x32_bf16 v[168:171], v[64:67], a[184:187], v[168:171]
v_cvt_pk_bf16_f32 v160, v160, v161
v_cvt_pk_bf16_f32 v161, v162, v163
v_mfma_f32_16x16x32_bf16 v[168:171], v[60:63], a[180:183], v[168:171]
s_waitcnt lgkmcnt(0)
s_barrier
v_mfma_f32_16x16x32_bf16 v[168:171], v[56:59], a[176:179], v[168:171]
ds_read_b64_tr_b16 a[192:193], v248 offset:0
ds_read_b64_tr_b16 a[194:195], v248 offset:512
v_mfma_f32_16x16x32_bf16 v[172:175], v[72:75], a[128:131], 0
ds_read_b64_tr_b16 a[196:197], v248 offset:4096
ds_read_b64_tr_b16 a[198:199], v248 offset:4608
v_mfma_f32_16x16x32_bf16 v[172:175], v[76:79], a[132:135], v[172:175]
ds_read_b64_tr_b16 a[200:201], v248 offset:8192
ds_read_b64_tr_b16 a[202:203], v248 offset:8704
v_mfma_f32_16x16x32_bf16 v[172:175], v[80:83], a[136:139], v[172:175]
ds_read_b64_tr_b16 a[204:205], v248 offset:12288
ds_read_b64_tr_b16 a[206:207], v248 offset:12800
v_mfma_f32_16x16x32_bf16 v[172:175], v[84:87], a[140:143], v[172:175]
ds_read_b64_tr_b16 a[208:209], v249 offset:0
ds_read_b64_tr_b16 a[210:211], v249 offset:512
v_mfma_f32_16x16x32_bf16 v[176:179], v[84:87], a[156:159], 0
ds_read_b64_tr_b16 a[212:213], v249 offset:4096
ds_read_b64_tr_b16 a[214:215], v249 offset:4608
v_mfma_f32_16x16x32_bf16 v[176:179], v[80:83], a[152:155], v[176:179]
s_waitcnt lgkmcnt(10)
ds_read_b64_tr_b16 a[216:217], v249 offset:8192
ds_read_b64_tr_b16 a[218:219], v249 offset:8704
v_mfma_f32_16x16x32_bf16 v[176:179], v[76:79], a[148:151], v[176:179]
s_waitcnt lgkmcnt(10)
ds_read_b64_tr_b16 a[220:221], v249 offset:12288
ds_read_b64_tr_b16 a[222:223], v249 offset:12800
v_mfma_f32_16x16x32_bf16 v[176:179], v[72:75], a[144:147], v[176:179]
s_waitcnt lgkmcnt(10)
ds_read_b64_tr_b16 a[224:225], v250 offset:0
ds_read_b64_tr_b16 a[226:227], v250 offset:512
v_mfma_f32_16x16x32_bf16 v[180:183], v[72:75], a[160:163], 0
s_waitcnt lgkmcnt(10)
ds_read_b64_tr_b16 a[228:229], v250 offset:4096
ds_read_b64_tr_b16 a[230:231], v250 offset:4608
v_mfma_f32_16x16x32_bf16 v[180:183], v[76:79], a[164:167], v[180:183]
s_waitcnt lgkmcnt(10)
ds_read_b64_tr_b16 a[232:233], v250 offset:8192
ds_read_b64_tr_b16 a[234:235], v250 offset:8704
v_mfma_f32_16x16x32_bf16 v[180:183], v[80:83], a[168:171], v[180:183]
s_waitcnt lgkmcnt(10)
ds_read_b64_tr_b16 a[236:237], v250 offset:12288
ds_read_b64_tr_b16 a[238:239], v250 offset:12800
v_mfma_f32_16x16x32_bf16 v[180:183], v[84:87], a[172:175], v[180:183]
s_waitcnt lgkmcnt(10)
ds_read_b64_tr_b16 a[240:241], v251 offset:0
ds_read_b64_tr_b16 a[242:243], v251 offset:512
v_mfma_f32_16x16x32_bf16 v[152:155], v[84:87], a[188:191], 0
s_waitcnt lgkmcnt(10)
ds_read_b64_tr_b16 a[244:245], v251 offset:4096
ds_read_b64_tr_b16 a[246:247], v251 offset:4608
v_mfma_f32_16x16x32_bf16 v[152:155], v[80:83], a[184:187], v[152:155]
s_waitcnt lgkmcnt(10)
ds_read_b64_tr_b16 a[248:249], v251 offset:8192
ds_read_b64_tr_b16 a[250:251], v251 offset:8704
v_mfma_f32_16x16x32_bf16 v[152:155], v[76:79], a[180:183], v[152:155]
s_waitcnt lgkmcnt(10)
ds_read_b64_tr_b16 a[252:253], v251 offset:12288
ds_read_b64_tr_b16 a[254:255], v251 offset:12800
v_mfma_f32_16x16x32_bf16 v[152:155], v[72:75], a[176:179], v[152:155]
s_waitcnt lgkmcnt(10)
ds_write_b128 v50, v[88:91] offset:0
ds_write_b128 v50, v[104:107] offset:4096
ds_write_b64 v51, v[156:157] offset:0
ds_write_b128 v50, v[92:95] offset:64
ds_write_b128 v50, v[108:111] offset:4160
ds_write_b64 v51, v[160:161] offset:128
v_cvt_pk_bf16_f32 v164, v164, v165
v_cvt_pk_bf16_f32 v165, v166, v167
v_cvt_pk_bf16_f32 v168, v168, v169
v_cvt_pk_bf16_f32 v169, v170, v171
v_cvt_pk_bf16_f32 v172, v172, v173
v_cvt_pk_bf16_f32 v173, v174, v175
v_cvt_pk_bf16_f32 v176, v176, v177
v_cvt_pk_bf16_f32 v177, v178, v179
v_cvt_pk_bf16_f32 v180, v180, v181
v_cvt_pk_bf16_f32 v181, v182, v183
v_cvt_pk_bf16_f32 v152, v152, v153
v_cvt_pk_bf16_f32 v153, v154, v155
v_mov_b32 v105, 0
v_mov_b32 v107, 0
v_mov_b32 v109, 0
v_mov_b32 v111, 0
v_mov_b32 v133, 0
v_mov_b32 v134, 0
v_mov_b32 v135, 0
v_mov_b32 v149, 0
v_mov_b32 v150, 0
v_mov_b32 v151, 0
v_mov_b32 v248, 1.0
v_mov_b32 v249, 1.0
v_mov_b32 v251, 1.0
ds_write_b64 v51, v[164:165] offset:256
ds_write_b64 v51, v[168:169] offset:384
ds_write_b128 v50, v[96:99] offset:2048
ds_write_b128 v50, v[112:115] offset:6144
ds_write_b64 v51, v[172:173] offset:2048
ds_write_b64 v51, v[176:177] offset:2176
s_waitcnt vmcnt(4)
s_barrier
ds_read_b128 v[200:203], v236 offset:8704
ds_read_b128 v[212:215], v236 offset:8448
ds_read_b128 v[224:227], v236 offset:8960
ds_read_b128 v[228:231], v236 offset:9216
ds_read_b128 v[192:195], v236 offset:13440
ds_read_b128 v[204:207], v236 offset:12928
ds_read_b128 v[208:211], v236 offset:12672
ds_write_b128 v50, v[100:103] offset:2112
ds_write_b128 v50, v[116:119] offset:6208
s_waitcnt lgkmcnt(8)
v_mfma_f32_16x16x32_bf16 v[184:187], a[68:71], v[200:203], 0
s_waitcnt lgkmcnt(6)
ds_write_b64 v51, v[180:181] offset:2304
v_mfma_f32_16x16x32_bf16 v[184:187], a[64:67], v[212:215], v[184:187]
s_waitcnt lgkmcnt(2)
ds_write_b64 v51, v[152:153] offset:2432
v_mfma_f32_16x16x32_bf16 v[184:187], a[72:75], v[224:227], v[184:187]
v_mfma_f32_16x16x32_bf16 v[184:187], a[76:79], v[228:231], v[184:187]
s_nop 2
v_mfma_f32_16x16x32_bf16 v[188:191], a[92:95], v[228:231], 0
s_nop 2
v_mfma_f32_16x16x32_bf16 v[188:191], a[88:91], v[224:227], v[188:191]
v_cvt_pk_bf16_f32 v16, v184, v185
v_cvt_pk_bf16_f32 v17, v186, v187
v_mfma_f32_16x16x32_bf16 v[188:191], a[84:87], v[200:203], v[188:191]
ds_read_b128 v[184:187], v236 offset:13184
v_mfma_f32_16x16x32_bf16 v[188:191], a[80:83], v[212:215], v[188:191]
s_nop 2
v_mfma_f32_16x16x32_bf16 v[196:199], a[96:99], v[212:215], 0
s_nop 2
v_mfma_f32_16x16x32_bf16 v[196:199], a[100:103], v[200:203], v[196:199]
v_cvt_pk_bf16_f32 v18, v188, v189
v_cvt_pk_bf16_f32 v19, v190, v191
v_mfma_f32_16x16x32_bf16 v[196:199], a[104:107], v[224:227], v[196:199]
v_mfma_f32_16x16x32_bf16 v[196:199], a[108:111], v[228:231], v[196:199]
s_nop 2
v_mfma_f32_16x16x32_bf16 v[188:191], a[124:127], v[228:231], 0
s_waitcnt lgkmcnt(0)
s_nop 1
v_mfma_f32_16x16x32_bf16 v[188:191], a[116:119], v[200:203], v[188:191]
v_cvt_pk_bf16_f32 v21, v198, v199
v_cvt_pk_bf16_f32 v20, v196, v197
v_mfma_f32_16x16x32_bf16 v[188:191], a[112:115], v[212:215], v[188:191]
v_mfma_f32_16x16x32_bf16 v[188:191], a[120:123], v[224:227], v[188:191]
s_nop 2
v_mfma_f32_16x16x32_bf16 v[196:199], a[120:123], v[184:187], 0
s_nop 2
v_mfma_f32_16x16x32_bf16 v[196:199], a[124:127], v[192:195], v[196:199]
v_cvt_pk_bf16_f32 v23, v190, v191
v_cvt_pk_bf16_f32 v22, v188, v189
v_mfma_f32_16x16x32_bf16 v[196:199], a[116:119], v[204:207], v[196:199]
v_mfma_f32_16x16x32_bf16 v[196:199], a[112:115], v[208:211], v[196:199]
s_nop 2
v_mfma_f32_16x16x32_bf16 v[188:191], a[96:99], v[208:211], 0
s_nop 2
v_mfma_f32_16x16x32_bf16 v[188:191], a[100:103], v[204:207], v[188:191]
v_cvt_pk_bf16_f32 v30, v196, v197
v_cvt_pk_bf16_f32 v31, v198, v199
v_mfma_f32_16x16x32_bf16 v[188:191], a[104:107], v[184:187], v[188:191]
v_mfma_f32_16x16x32_bf16 v[188:191], a[108:111], v[192:195], v[188:191]
s_nop 2
v_mfma_f32_16x16x32_bf16 v[212:215], a[92:95], v[192:195], 0
s_nop 2
v_mfma_f32_16x16x32_bf16 v[212:215], a[88:91], v[184:187], v[212:215]
v_cvt_pk_bf16_f32 v29, v190, v191
v_cvt_pk_bf16_f32 v28, v188, v189
v_mfma_f32_16x16x32_bf16 v[212:215], a[84:87], v[204:207], v[212:215]
v_mfma_f32_16x16x32_bf16 v[212:215], a[80:83], v[208:211], v[212:215]
s_nop 2
v_mfma_f32_16x16x32_bf16 v[188:191], a[64:67], v[208:211], 0
s_nop 2
v_mfma_f32_16x16x32_bf16 v[188:191], a[72:75], v[184:187], v[188:191]
v_cvt_pk_bf16_f32 v27, v214, v215
v_cvt_pk_bf16_f32 v26, v212, v213
v_mfma_f32_16x16x32_bf16 v[188:191], a[76:79], v[192:195], v[188:191]
s_waitcnt vmcnt(0)
s_barrier
v_mfma_f32_16x16x32_bf16 v[188:191], a[68:71], v[204:207], v[188:191]
s_mov_b32 s48, s50
ds_read_b128 v[196:199], v236 offset:17152
ds_read_b128 v[200:203], v236 offset:16896
ds_read_b128 v[216:219], v236 offset:17408
ds_read_b128 v[220:223], v236 offset:17664
ds_read_u16 v108, v241 offset:256
ds_read_b128 v[204:207], v236 offset:21376
ds_read_b128 v[208:211], v236 offset:21120
ds_read_b128 v[52:55], v240 offset:64
v_cvt_pk_bf16_f32 v24, v188, v189
v_cvt_pk_bf16_f32 v25, v190, v191
s_add_u32 m0, s49, 0
s_add_u32 s50, s50, 13107200
buffer_load_dwordx4 v237, s[16:19], s48 offen nt lds
ds_read_b128 v[192:195], v236 offset:21888
ds_read_b128 v[48:51], v240 offset:0
ds_read_u16 v110, v241 offset:384
v_add_u32 v240, 0x200, v240
s_add_u32 s48, s48, s51
s_add_u32 m0, s49, 2112
ds_read_u16 v106, v241 offset:128
buffer_load_dwordx4 v237, s[16:19], s48 offen nt lds
s_waitcnt lgkmcnt(11)
v_mfma_f32_16x16x32_bf16 v[184:187], a[68:71], v[196:199], 0
s_waitcnt lgkmcnt(9)
ds_read_u16 v104, v241 offset:0
s_add_u32 m0, s49, 4224
v_mfma_f32_16x16x32_bf16 v[184:187], a[64:67], v[200:203], v[184:187]
s_waitcnt lgkmcnt(6)
s_add_u32 s48, s48, s51
buffer_load_dwordx4 v237, s[16:19], s48 offen nt lds
v_mfma_f32_16x16x32_bf16 v[184:187], a[72:75], v[216:219], v[184:187]
s_add_u32 m0, s49, 6336
s_add_u32 s48, s48, s51
buffer_load_dwordx4 v237, s[16:19], s48 offen nt lds
v_mfma_f32_16x16x32_bf16 v[184:187], a[76:79], v[220:223], v[184:187]
s_add_u32 m0, s49, 8448
s_add_u32 s48, s48, s51
buffer_load_dwordx4 v237, s[16:19], s48 offen nt lds
v_mfma_f32_16x16x32_bf16 v[188:191], a[92:95], v[220:223], 0
s_add_u32 m0, s49, 10560
s_mov_b32 s47, s46
s_add_u32 s48, s48, s51
v_mfma_f32_16x16x32_bf16 v[188:191], a[88:91], v[216:219], v[188:191]
s_bfe_i32 s57, s3, 0x10000
buffer_load_dwordx4 v237, s[16:19], s48 offen nt lds
v_cvt_pk_bf16_f32 v32, v184, v185
v_mfma_f32_16x16x32_bf16 v[188:191], a[84:87], v[196:199], v[188:191]
s_and_b32 s54, s57, s5
v_cvt_pk_bf16_f32 v33, v186, v187
s_sub_u32 s45, s45, 1
v_mfma_f32_16x16x32_bf16 v[188:191], a[80:83], v[200:203], v[188:191]
s_sub_u32 s50, s50, s54
s_add_u32 s52, s46, 20480
s_lshr_b32 s3, s3, 1
v_mfma_f32_16x16x32_bf16 v[184:187], a[96:99], v[200:203], 0
s_waitcnt lgkmcnt(0)
s_nop 1
v_mfma_f32_16x16x32_bf16 v[184:187], a[100:103], v[196:199], v[184:187]
v_cvt_pk_bf16_f32 v35, v190, v191
v_cvt_pk_bf16_f32 v34, v188, v189
v_mfma_f32_16x16x32_bf16 v[184:187], a[104:107], v[216:219], v[184:187]
v_mfma_f32_16x16x32_bf16 v[184:187], a[108:111], v[220:223], v[184:187]
s_nop 2
v_mfma_f32_16x16x32_bf16 v[188:191], a[124:127], v[220:223], 0
s_nop 2
v_mfma_f32_16x16x32_bf16 v[188:191], a[120:123], v[216:219], v[188:191]
v_cvt_pk_bf16_f32 v37, v186, v187
v_cvt_pk_bf16_f32 v36, v184, v185
v_mfma_f32_16x16x32_bf16 v[188:191], a[116:119], v[196:199], v[188:191]
ds_read_b128 v[196:199], v236 offset:21632
v_mfma_f32_16x16x32_bf16 v[188:191], a[112:115], v[200:203], v[188:191]
s_nop 7
v_cvt_pk_bf16_f32 v39, v190, v191
v_cvt_pk_bf16_f32 v38, v188, v189
s_nop 7
s_waitcnt lgkmcnt(0)
s_branch L_entrys
.p2align 6
L_loops:
s_waitcnt vmcnt(8)
s_barrier
v_mfma_f32_16x16x32_bf16 v[176:179], a[224:227], v[220:223], 0
s_add_u32 s52, s47, 8192
v_exp_f32 v187, v187
v_mfma_f32_16x16x32_bf16 v[176:179], a[228:231], v[224:227], v[176:179]
s_add_u32 s53, s47, 12288
v_add_f32 v248, v184, v185
v_add_f32 v248, v248, v186
v_mfma_f32_16x16x32_bf16 v[176:179], a[232:235], v[212:215], v[176:179]
s_mov_b32 s47, s46
v_add_f32 v248, v248, v187
v_cvt_pk_bf16_f32 v120, v184, v185
v_mfma_f32_16x16x32_bf16 v[176:179], a[236:239], v[216:219], v[176:179]
s_bfe_i32 s57, s3, 0x10000
v_cvt_pk_bf16_f32 v121, v186, v187
v_sub_f32 v193, v193, v254
v_mfma_f32_16x16x32_bf16 v[180:183], a[252:255], v[216:219], 0
s_and_b32 s54, s57, s5
v_exp_f32 v188, v188
v_mfma_f32_16x16x32_bf16 v[180:183], a[248:251], v[212:215], v[180:183]
s_sub_u32 s45, s45, 1
v_exp_f32 v190, v190
v_mfma_f32_16x16x32_bf16 v[180:183], a[244:247], v[224:227], v[180:183]
s_lshr_b32 s3, s3, 1
v_sub_f32 v194, v194, v254
v_add_f32 v248, v248, v188
v_mfma_f32_16x16x32_bf16 v[180:183], a[240:243], v[220:223], v[180:183]
v_exp_f32 v189, v189
v_mfma_f32_16x16x32_bf16 v[212:215], v[0:3], v[112:115], 0
v_add_f32 v248, v248, v189
v_sub_f32 v191, v191, v254
v_mfma_f32_16x16x32_bf16 v[212:215], v[4:7], v[116:119], v[212:215]
v_exp_f32 v191, v191
v_mfma_f32_16x16x32_bf16 v[216:219], v[12:15], v[116:119], 0
v_sub_f32 v195, v195, v254
v_sub_f32 v192, v192, v254
v_mfma_f32_16x16x32_bf16 v[216:219], v[8:11], v[112:115], v[216:219]
v_exp_f32 v192, v192
v_mfma_f32_16x16x32_bf16 v[220:223], v[16:19], v[112:115], 0
v_exp_f32 v194, v194
v_mfma_f32_16x16x32_bf16 v[220:223], v[20:23], v[116:119], v[220:223]
v_exp_f32 v193, v193
v_mfma_f32_16x16x32_bf16 v[224:227], v[28:31], v[116:119], 0
v_add_f32 v248, v248, v190
v_add_f32 v248, v248, v191
v_mfma_f32_16x16x32_bf16 v[224:227], v[24:27], v[112:115], v[224:227]
v_exp_f32 v195, v195
v_mfma_f32_16x16x32_bf16 v[228:231], v[32:35], v[112:115], 0
v_add_f32 v248, v248, v192
v_add_f32 v248, v248, v193
v_mfma_f32_16x16x32_bf16 v[228:231], v[36:39], v[116:119], v[228:231]
v_add_f32 v248, v248, v194
v_add_f32 v248, v248, v195
v_mfma_f32_16x16x32_bf16 v[232:235], v[44:47], v[116:119], 0
v_cvt_pk_bf16_f32 v123, v190, v191
v_cvt_pk_bf16_f32 v122, v188, v189
v_mfma_f32_16x16x32_bf16 v[232:235], v[40:43], v[112:115], v[232:235]
s_mov_b32 s48, s50
ds_read_b128 v[188:191], v236 offset:0
v_cvt_pk_bf16_f32 v125, v194, v195
v_mfma_f32_16x16x32_bf16 v[184:187], v[48:51], v[112:115], 0
s_add_u32 m0, s49, 0
ds_read_b128 v[48:51], v240 offset:0
v_cvt_pk_bf16_f32 v124, v192, v193
v_mfma_f32_16x16x32_bf16 v[184:187], v[52:55], v[116:119], v[184:187]
s_add_u32 s50, s50, 13107200
buffer_load_dwordx4 v237, s[16:19], s48 offen nt lds
v_sub_f32 v196, v196, v254
v_sub_f32 v197, v197, v254
v_sub_f32 v199, v199, v254
v_sub_f32 v198, v198, v254
v_exp_f32 v196, v196
v_exp_f32 v197, v197
v_add_f32 v248, v248, v196
v_add_f32 v248, v248, v197
v_exp_f32 v198, v198
s_waitcnt lgkmcnt(1)
v_mfma_f32_16x16x32_bf16 v[192:195], a[64:67], v[188:191], 0
s_sub_u32 s50, s50, s54
ds_read_b128 v[52:55], v240 offset:64
v_exp_f32 v199, v199
v_add_f32 v248, v248, v198
v_add_f32 v248, v248, v199
v_cvt_pk_bf16_f32 v126, v196, v197
v_cvt_pk_bf16_f32 v127, v198, v199
ds_read_b128 v[196:199], v236 offset:256
v_sub_f32 v200, v200, v254
v_sub_f32 v203, v203, v254
v_sub_f32 v201, v201, v254
v_exp_f32 v201, v201
v_sub_f32 v202, v202, v254
v_exp_f32 v202, v202
v_exp_f32 v200, v200
v_exp_f32 v203, v203
v_add_f32 v248, v248, v200
v_add_f32 v248, v248, v201
v_add_f32 v248, v248, v202
v_add_f32 v248, v248, v203
v_cvt_pk_bf16_f32 v128, v200, v201
v_cvt_pk_bf16_f32 v129, v202, v203
v_sub_f32 v204, v204, v254
v_sub_f32 v205, v205, v254
s_waitcnt lgkmcnt(0)
v_mfma_f32_16x16x32_bf16 v[192:195], a[68:71], v[196:199], v[192:195]
ds_read_b128 v[200:203], v236 offset:512
v_exp_f32 v204, v204
v_sub_f32 v206, v206, v254
v_add_f32 v248, v248, v204
v_exp_f32 v206, v206
v_sub_f32 v207, v207, v254
v_exp_f32 v205, v205
v_exp_f32 v207, v207
v_add_f32 v248, v248, v205
v_cvt_pk_bf16_f32 v130, v204, v205
v_add_f32 v248, v248, v206
v_add_f32 v248, v248, v207
v_cvt_pk_bf16_f32 v131, v206, v207
v_sub_f32 v208, v208, v254
v_exp_f32 v208, v208
v_max3_f32 v254, v212, v213, v214
s_waitcnt lgkmcnt(0)
v_mfma_f32_16x16x32_bf16 v[192:195], a[72:75], v[200:203], v[192:195]
ds_read_b128 v[204:207], v236 offset:768
v_add_f32 v248, v248, v208
v_cvt_pk_bf16_f32 v132, v208, 0
v_max3_f32 v254, v254, v215, v216
v_max3_f32 v254, v254, v217, v218
v_max3_f32 v254, v254, v219, v220
v_max3_f32 v254, v254, v221, v222
v_max3_f32 v254, v254, v223, v224
v_max3_f32 v254, v254, v225, v226
v_max3_f32 v254, v254, v227, v228
v_max3_f32 v254, v254, v229, v230
v_max3_f32 v254, v254, v231, v232
v_max3_f32 v254, v254, v233, v234
v_max3_f32 v254, v254, v235, v184
v_add_u32 v240, 0x200, v240
ds_swizzle_b32 v250, v248 offset:0x401F
ds_swizzle_b32 v255, v254 offset:0x401F
s_waitcnt lgkmcnt(2)
v_mfma_f32_16x16x32_bf16 v[192:195], a[76:79], v[204:207], v[192:195]
s_nop 2
v_mfma_f32_16x16x32_bf16 v[208:211], a[92:95], v[204:207], 0
s_nop 2
v_mfma_f32_16x16x32_bf16 v[208:211], a[88:91], v[200:203], v[208:211]
v_cvt_pk_bf16_f32 v0, v192, v193
v_cvt_pk_bf16_f32 v1, v194, v195
v_mfma_f32_16x16x32_bf16 v[208:211], a[84:87], v[196:199], v[208:211]
v_mfma_f32_16x16x32_bf16 v[208:211], a[80:83], v[188:191], v[208:211]
s_waitcnt lgkmcnt(0)
v_add_f32 v248, v248, v250
v_max_f32 v254, v254, v255
v_mfma_f32_16x16x32_bf16 v[192:195], a[96:99], v[188:191], 0
ds_bpermute_b32 v250, v247, v248
v_mfma_f32_16x16x32_bf16 v[192:195], a[100:103], v[196:199], v[192:195]
ds_bpermute_b32 v255, v247, v254
v_mfma_f32_16x16x32_bf16 v[192:195], a[104:107], v[200:203], v[192:195]
v_cvt_pk_bf16_f32 v2, v208, v209
v_cvt_pk_bf16_f32 v3, v210, v211
v_mfma_f32_16x16x32_bf16 v[192:195], a[108:111], v[204:207], v[192:195]
s_nop 2
v_mfma_f32_16x16x32_bf16 v[208:211], a[124:127], v[204:207], 0
s_nop 2
v_mfma_f32_16x16x32_bf16 v[208:211], a[120:123], v[200:203], v[208:211]
v_cvt_pk_bf16_f32 v5, v194, v195
v_cvt_pk_bf16_f32 v4, v192, v193
v_mfma_f32_16x16x32_bf16 v[208:211], a[116:119], v[196:199], v[208:211]
s_waitcnt lgkmcnt(1)
v_add_f32 v248, v248, v250
v_mfma_f32_16x16x32_bf16 v[208:211], a[112:115], v[188:191], v[208:211]
s_waitcnt lgkmcnt(0)
v_rcp_f32 v251, v248
v_mfma_f32_16x16x32_bf16 v[188:191], v[56:59], v[120:123], 0
v_max_f32 v254, v254, v255
v_sub_f32 v214, v214, v254
v_mfma_f32_16x16x32_bf16 v[188:191], v[104:107], v[132:135], v[188:191]
s_add_u32 s48, s48, s51
v_sub_f32 v215, v215, v254
v_cvt_pk_bf16_f32 v6, v208, v209
v_mfma_f32_16x16x32_bf16 v[188:191], v[72:75], v[124:127], v[188:191]
s_add_u32 m0, s49, 2112
v_cvt_pk_bf16_f32 v7, v210, v211
v_sub_f32 v212, v212, v254
v_mfma_f32_16x16x32_bf16 v[188:191], v[88:91], v[128:131], v[188:191]
buffer_load_dwordx4 v237, s[16:19], s48 offen nt lds
v_sub_f32 v213, v213, v254
v_mfma_f32_16x16x32_bf16 v[196:199], v[92:95], v[128:131], 0
v_exp_f32 v212, v212
v_mfma_f32_16x16x32_bf16 v[196:199], v[76:79], v[124:127], v[196:199]
v_exp_f32 v214, v214
v_mfma_f32_16x16x32_bf16 v[196:199], v[106:109], v[132:135], v[196:199]
v_exp_f32 v213, v213
v_mfma_f32_16x16x32_bf16 v[196:199], v[60:63], v[120:123], v[196:199]
ds_read_b128 v[204:207], v236 offset:4480
v_sub_f32 v216, v216, v254
v_mfma_f32_16x16x32_bf16 v[200:203], v[64:67], v[120:123], 0
ds_read_b128 v[192:195], v236 offset:4224
v_sub_f32 v217, v217, v254
v_mfma_f32_16x16x32_bf16 v[200:203], v[108:111], v[132:135], v[200:203]
v_exp_f32 v215, v215
v_mfma_f32_16x16x32_bf16 v[200:203], v[80:83], v[124:127], v[200:203]
v_exp_f32 v217, v217
v_mfma_f32_16x16x32_bf16 v[200:203], v[96:99], v[128:131], v[200:203]
v_sub_f32 v218, v218, v254
v_add_f32 v249, v212, v213
v_mfma_f32_16x16x32_bf16 v[208:211], v[100:103], v[128:131], 0
v_add_f32 v249, v249, v214
v_add_f32 v249, v249, v215
v_mfma_f32_16x16x32_bf16 v[208:211], v[84:87], v[124:127], v[208:211]
s_waitcnt lgkmcnt(1)
v_exp_f32 v216, v216
v_mfma_f32_16x16x32_bf16 v[208:211], v[110:113], v[132:135], v[208:211]
s_waitcnt lgkmcnt(0)
v_sub_f32 v219, v219, v254
v_sub_f32 v220, v220, v254
v_mfma_f32_16x16x32_bf16 v[208:211], v[68:71], v[120:123], v[208:211]
v_exp_f32 v218, v218
v_sub_f32 v223, v223, v254
v_add_f32 v249, v249, v216
v_add_f32 v249, v249, v217
v_exp_f32 v219, v219
v_add_f32 v249, v249, v218
v_add_f32 v249, v249, v219
v_exp_f32 v220, v220
v_sub_f32 v224, v224, v254
v_exp_f32 v223, v223
v_sub_f32 v221, v221, v254
v_exp_f32 v224, v224
v_exp_f32 v221, v221
v_sub_f32 v222, v222, v254
v_sub_f32 v225, v225, v254
v_add_f32 v249, v249, v220
v_add_f32 v249, v249, v221
v_exp_f32 v222, v222
v_exp_f32 v225, v225
v_add_f32 v249, v249, v222
v_add_f32 v249, v249, v223
v_add_f32 v249, v249, v224
v_sub_f32 v226, v226, v254
v_add_f32 v249, v249, v225
v_exp_f32 v226, v226
v_sub_f32 v227, v227, v254
v_exp_f32 v227, v227
v_sub_f32 v228, v228, v254
v_exp_f32 v228, v228
v_add_f32 v249, v249, v226
v_sub_f32 v232, v232, v254
v_sub_f32 v229, v229, v254
v_sub_f32 v230, v230, v254
v_exp_f32 v230, v230
v_exp_f32 v229, v229
v_add_f32 v249, v249, v227
v_add_f32 v249, v249, v228
v_add_f32 v249, v249, v229
v_exp_f32 v232, v232
v_sub_f32 v233, v233, v254
v_exp_f32 v233, v233
v_sub_f32 v231, v231, v254
v_exp_f32 v231, v231
v_sub_f32 v234, v234, v254
v_sub_f32 v235, v235, v254
v_add_f32 v249, v249, v230
v_add_f32 v249, v249, v231
v_add_f32 v249, v249, v232
v_exp_f32 v234, v234
v_exp_f32 v235, v235
v_sub_f32 v184, v184, v254
v_exp_f32 v184, v184
v_add_f32 v249, v249, v233
v_cvt_pk_bf16_f32 v148, v184, 0
v_add_f32 v249, v249, v234
v_add_f32 v249, v249, v235
v_add_f32 v249, v249, v184
v_fmac_f32 v161, v201, v251
v_fmac_f32 v163, v203, v251
v_fmac_f32 v160, v200, v251
v_fmac_f32 v162, v202, v251
ds_read_b128 v[184:187], v236 offset:4992
v_cvt_pk_bf16_f32 v138, v216, v217
v_cvt_pk_bf16_f32 v139, v218, v219
v_fmac_f32 v167, v211, v251
v_fmac_f32 v165, v209, v251
v_fmac_f32 v166, v210, v251
v_fmac_f32 v164, v208, v251
v_cvt_pk_bf16_f32 v140, v220, v221
v_cvt_pk_bf16_f32 v141, v222, v223
v_fmac_f32 v155, v191, v251
v_fmac_f32 v154, v190, v251
v_fmac_f32 v152, v188, v251
v_fmac_f32 v153, v189, v251
v_cvt_pk_bf16_f32 v137, v214, v215
v_cvt_pk_bf16_f32 v136, v212, v213
v_cvt_pk_bf16_f32 v143, v226, v227
v_cvt_pk_bf16_f32 v142, v224, v225
v_cvt_pk_bf16_f32 v145, v230, v231
v_cvt_pk_bf16_f32 v144, v228, v229
v_fmac_f32 v156, v196, v251
v_fmac_f32 v157, v197, v251
s_waitcnt lgkmcnt(0)
v_mfma_f32_16x16x32_bf16 v[200:203], a[124:127], v[184:187], 0
ds_read_b128 v[216:219], v236 offset:4736
v_fmac_f32 v158, v198, v251
v_fmac_f32 v159, v199, v251
v_cvt_pk_bf16_f32 v147, v234, v235
v_cvt_pk_bf16_f32 v146, v232, v233
v_cvt_pk_bf16_f32 v160, v160, v161
v_cvt_pk_bf16_f32 v161, v162, v163
v_cvt_pk_bf16_f32 v163, v166, v167
v_cvt_pk_bf16_f32 v162, v164, v165
v_cvt_pk_bf16_f32 v152, v152, v153
v_cvt_pk_bf16_f32 v153, v154, v155
v_pk_max_i16 v160, v160, 0
v_pk_max_i16 v162, v162, 0
v_pk_max_i16 v153, v153, 0
v_pk_max_i16 v161, v161, 0
v_pk_max_i16 v163, v163, 0
v_cvt_pk_bf16_f32 v155, v158, v159
v_pk_max_i16 v155, v155, 0
v_pk_max_i16 v152, v152, 0
v_cvt_pk_bf16_f32 v154, v156, v157
v_pk_max_i16 v154, v154, 0
s_waitcnt lgkmcnt(0)
v_mfma_f32_16x16x32_bf16 v[200:203], a[120:123], v[216:219], v[200:203]
ds_swizzle_b32 v250, v249 offset:0x401F
buffer_store_dwordx4 v[152:155], v239, s[20:23], s52 offen offset:0 nt
buffer_store_dwordx4 v[160:163], v239, s[20:23], s52 offen offset:64 nt
s_add_u32 s52, s46, 20480
v_mfma_f32_16x16x32_bf16 v[200:203], a[116:119], v[204:207], v[200:203]
v_mfma_f32_16x16x32_bf16 v[200:203], a[112:115], v[192:195], v[200:203]
s_nop 2
v_mfma_f32_16x16x32_bf16 v[208:211], a[96:99], v[192:195], 0
s_waitcnt lgkmcnt(0)
v_add_f32 v249, v249, v250
v_mfma_f32_16x16x32_bf16 v[208:211], a[100:103], v[204:207], v[208:211]
s_add_u32 m0, s49, 4224
ds_bpermute_b32 v250, v247, v249
v_mfma_f32_16x16x32_bf16 v[208:211], a[104:107], v[216:219], v[208:211]
s_add_u32 s48, s48, s51
buffer_load_dwordx4 v237, s[16:19], s48 offen nt lds
v_cvt_pk_bf16_f32 v14, v200, v201
v_mfma_f32_16x16x32_bf16 v[208:211], a[108:111], v[184:187], v[208:211]
ds_read_b128 v[212:215], v236 offset:8448
v_cvt_pk_bf16_f32 v15, v202, v203
v_mfma_f32_16x16x32_bf16 v[220:223], a[92:95], v[184:187], 0
ds_read_b128 v[200:203], v236 offset:8704
ds_read_b128 v[224:227], v236 offset:8960
v_mfma_f32_16x16x32_bf16 v[220:223], a[88:91], v[216:219], v[220:223]
ds_read_b128 v[228:231], v236 offset:9216
v_mfma_f32_16x16x32_bf16 v[220:223], a[84:87], v[204:207], v[220:223]
v_cvt_pk_bf16_f32 v13, v210, v211
v_cvt_pk_bf16_f32 v12, v208, v209
v_mfma_f32_16x16x32_bf16 v[220:223], a[80:83], v[192:195], v[220:223]
s_waitcnt lgkmcnt(4)
v_add_f32 v249, v249, v250
s_nop 0
v_mfma_f32_16x16x32_bf16 v[188:191], a[64:67], v[192:195], 0
v_rcp_f32 v252, v249
v_mfma_f32_16x16x32_bf16 v[188:191], a[72:75], v[216:219], v[188:191]
s_waitcnt lgkmcnt(3)
s_nop 0
v_cvt_pk_bf16_f32 v10, v220, v221
v_mfma_f32_16x16x32_bf16 v[188:191], a[76:79], v[184:187], v[188:191]
s_waitcnt lgkmcnt(1)
v_cvt_pk_bf16_f32 v11, v222, v223
v_mfma_f32_16x16x32_bf16 v[188:191], a[68:71], v[204:207], v[188:191]
s_waitcnt lgkmcnt(0)
s_nop 1
v_mfma_f32_16x16x32_bf16 v[184:187], a[68:71], v[200:203], 0
s_nop 2
v_mfma_f32_16x16x32_bf16 v[184:187], a[64:67], v[212:215], v[184:187]
v_cvt_pk_bf16_f32 v9, v190, v191
v_cvt_pk_bf16_f32 v8, v188, v189
v_mfma_f32_16x16x32_bf16 v[184:187], a[72:75], v[224:227], v[184:187]
v_mfma_f32_16x16x32_bf16 v[184:187], a[76:79], v[228:231], v[184:187]
s_nop 2
v_mfma_f32_16x16x32_bf16 v[188:191], a[92:95], v[228:231], 0
s_nop 2
v_mfma_f32_16x16x32_bf16 v[188:191], a[88:91], v[224:227], v[188:191]
v_cvt_pk_bf16_f32 v16, v184, v185
v_cvt_pk_bf16_f32 v17, v186, v187
v_mfma_f32_16x16x32_bf16 v[188:191], a[84:87], v[200:203], v[188:191]
v_mfma_f32_16x16x32_bf16 v[188:191], a[80:83], v[212:215], v[188:191]
ds_read_b128 v[184:187], v236 offset:13184
ds_read_b128 v[192:195], v236 offset:13440
v_mfma_f32_16x16x32_bf16 v[196:199], a[96:99], v[212:215], 0
ds_read_b128 v[204:207], v236 offset:12928
ds_read_b128 v[208:211], v236 offset:12672
v_mfma_f32_16x16x32_bf16 v[196:199], a[100:103], v[200:203], v[196:199]
s_add_u32 m0, s49, 6336
s_add_u32 s48, s48, s51
v_cvt_pk_bf16_f32 v18, v188, v189
v_mfma_f32_16x16x32_bf16 v[196:199], a[104:107], v[224:227], v[196:199]
buffer_load_dwordx4 v237, s[16:19], s48 offen nt lds
v_cvt_pk_bf16_f32 v19, v190, v191
v_mfma_f32_16x16x32_bf16 v[196:199], a[108:111], v[228:231], v[196:199]
s_nop 2
v_mfma_f32_16x16x32_bf16 v[188:191], a[124:127], v[228:231], 0
s_nop 2
v_mfma_f32_16x16x32_bf16 v[188:191], a[116:119], v[200:203], v[188:191]
s_waitcnt lgkmcnt(2)
v_cvt_pk_bf16_f32 v21, v198, v199
v_cvt_pk_bf16_f32 v20, v196, v197
v_mfma_f32_16x16x32_bf16 v[188:191], a[112:115], v[212:215], v[188:191]
s_waitcnt lgkmcnt(0)
v_mfma_f32_16x16x32_bf16 v[188:191], a[120:123], v[224:227], v[188:191]
s_nop 2
v_mfma_f32_16x16x32_bf16 v[196:199], a[120:123], v[184:187], 0
s_nop 2
v_mfma_f32_16x16x32_bf16 v[196:199], a[124:127], v[192:195], v[196:199]
v_cvt_pk_bf16_f32 v23, v190, v191
v_cvt_pk_bf16_f32 v22, v188, v189
v_mfma_f32_16x16x32_bf16 v[196:199], a[116:119], v[204:207], v[196:199]
v_mfma_f32_16x16x32_bf16 v[196:199], a[112:115], v[208:211], v[196:199]
s_nop 2
v_mfma_f32_16x16x32_bf16 v[188:191], a[96:99], v[208:211], 0
s_nop 2
v_mfma_f32_16x16x32_bf16 v[188:191], a[100:103], v[204:207], v[188:191]
v_cvt_pk_bf16_f32 v30, v196, v197
v_cvt_pk_bf16_f32 v31, v198, v199
v_mfma_f32_16x16x32_bf16 v[188:191], a[104:107], v[184:187], v[188:191]
v_mfma_f32_16x16x32_bf16 v[188:191], a[108:111], v[192:195], v[188:191]
ds_read_b128 v[196:199], v236 offset:17152
ds_read_b128 v[200:203], v236 offset:16896
v_mfma_f32_16x16x32_bf16 v[212:215], a[92:95], v[192:195], 0
ds_read_b128 v[216:219], v236 offset:17408
ds_read_b128 v[220:223], v236 offset:17664
v_mfma_f32_16x16x32_bf16 v[212:215], a[88:91], v[184:187], v[212:215]
s_nop 1
v_cvt_pk_bf16_f32 v29, v190, v191
v_mfma_f32_16x16x32_bf16 v[212:215], a[84:87], v[204:207], v[212:215]
v_cvt_pk_bf16_f32 v28, v188, v189
v_mfma_f32_16x16x32_bf16 v[212:215], a[80:83], v[208:211], v[212:215]
s_nop 2
v_mfma_f32_16x16x32_bf16 v[188:191], a[64:67], v[208:211], 0
s_nop 2
v_mfma_f32_16x16x32_bf16 v[188:191], a[72:75], v[184:187], v[188:191]
s_add_u32 m0, s49, 8448
v_cvt_pk_bf16_f32 v27, v214, v215
v_cvt_pk_bf16_f32 v26, v212, v213
v_mfma_f32_16x16x32_bf16 v[188:191], a[76:79], v[192:195], v[188:191]
s_add_u32 s48, s48, s51
buffer_load_dwordx4 v237, s[16:19], s48 offen nt lds
v_mfma_f32_16x16x32_bf16 v[188:191], a[68:71], v[204:207], v[188:191]
s_waitcnt lgkmcnt(0)
s_nop 1
v_mfma_f32_16x16x32_bf16 v[184:187], a[68:71], v[196:199], 0
s_nop 2
v_mfma_f32_16x16x32_bf16 v[184:187], a[64:67], v[200:203], v[184:187]
v_cvt_pk_bf16_f32 v24, v188, v189
v_cvt_pk_bf16_f32 v25, v190, v191
v_mfma_f32_16x16x32_bf16 v[184:187], a[72:75], v[216:219], v[184:187]
v_mfma_f32_16x16x32_bf16 v[184:187], a[76:79], v[220:223], v[184:187]
s_nop 2
v_mfma_f32_16x16x32_bf16 v[188:191], a[92:95], v[220:223], 0
s_nop 2
v_mfma_f32_16x16x32_bf16 v[188:191], a[88:91], v[216:219], v[188:191]
v_cvt_pk_bf16_f32 v32, v184, v185
v_cvt_pk_bf16_f32 v33, v186, v187
v_mfma_f32_16x16x32_bf16 v[188:191], a[84:87], v[196:199], v[188:191]
v_mfma_f32_16x16x32_bf16 v[188:191], a[80:83], v[200:203], v[188:191]
s_nop 2
v_mfma_f32_16x16x32_bf16 v[184:187], a[96:99], v[200:203], 0
s_nop 2
v_mfma_f32_16x16x32_bf16 v[184:187], a[100:103], v[196:199], v[184:187]
v_cvt_pk_bf16_f32 v35, v190, v191
v_cvt_pk_bf16_f32 v34, v188, v189
v_mfma_f32_16x16x32_bf16 v[184:187], a[104:107], v[216:219], v[184:187]
v_mfma_f32_16x16x32_bf16 v[184:187], a[108:111], v[220:223], v[184:187]
s_nop 2
v_mfma_f32_16x16x32_bf16 v[188:191], a[124:127], v[220:223], 0
s_nop 2
v_mfma_f32_16x16x32_bf16 v[188:191], a[120:123], v[216:219], v[188:191]
v_cvt_pk_bf16_f32 v37, v186, v187
v_cvt_pk_bf16_f32 v36, v184, v185
v_mfma_f32_16x16x32_bf16 v[188:191], a[116:119], v[196:199], v[188:191]
v_mfma_f32_16x16x32_bf16 v[188:191], a[112:115], v[200:203], v[188:191]
s_nop 2
v_mfma_f32_16x16x32_bf16 v[184:187], v[56:59], v[136:139], 0
s_nop 2
v_mfma_f32_16x16x32_bf16 v[184:187], v[104:107], v[148:151], v[184:187]
s_add_u32 m0, s49, 10560
ds_read_u16 v104, v241 offset:0
v_cvt_pk_bf16_f32 v39, v190, v191
v_mfma_f32_16x16x32_bf16 v[184:187], v[72:75], v[140:143], v[184:187]
s_add_u32 s48, s48, s51
buffer_load_dwordx4 v237, s[16:19], s48 offen nt lds
v_cvt_pk_bf16_f32 v38, v188, v189
v_mfma_f32_16x16x32_bf16 v[184:187], v[88:91], v[144:147], v[184:187]
s_nop 2
v_mfma_f32_16x16x32_bf16 v[188:191], v[92:95], v[144:147], 0
s_nop 2
v_mfma_f32_16x16x32_bf16 v[188:191], v[76:79], v[140:143], v[188:191]
v_fmac_f32 v170, v186, v252
v_fmac_f32 v168, v184, v252
v_mfma_f32_16x16x32_bf16 v[188:191], v[106:109], v[148:151], v[188:191]
ds_read_u16 v106, v241 offset:128
v_fmac_f32 v171, v187, v252
v_mfma_f32_16x16x32_bf16 v[188:191], v[60:63], v[136:139], v[188:191]
s_waitcnt lgkmcnt(1)
ds_read_b128 v[192:195], v236 offset:21888
v_fmac_f32 v169, v185, v252
v_mfma_f32_16x16x32_bf16 v[200:203], v[64:67], v[136:139], 0
ds_read_b128 v[196:199], v236 offset:21632
ds_read_b128 v[204:207], v236 offset:21376
v_mfma_f32_16x16x32_bf16 v[200:203], v[108:111], v[148:151], v[200:203]
ds_read_b128 v[208:211], v236 offset:21120
v_fmac_f32 v174, v190, v252
v_mfma_f32_16x16x32_bf16 v[200:203], v[80:83], v[140:143], v[200:203]
ds_read_u16 v108, v241 offset:256
v_fmac_f32 v175, v191, v252
v_mfma_f32_16x16x32_bf16 v[200:203], v[96:99], v[144:147], v[200:203]
v_fmac_f32 v172, v188, v252
v_fmac_f32 v173, v189, v252
v_mfma_f32_16x16x32_bf16 v[184:187], v[100:103], v[144:147], 0
s_waitcnt lgkmcnt(5)
v_cvt_pk_bf16_f32 v168, v168, v169
v_cvt_pk_bf16_f32 v169, v170, v171
v_mfma_f32_16x16x32_bf16 v[184:187], v[84:87], v[140:143], v[184:187]
s_waitcnt lgkmcnt(4)
v_fmac_f32 v178, v202, v252
v_fmac_f32 v176, v200, v252
v_mfma_f32_16x16x32_bf16 v[184:187], v[110:113], v[148:151], v[184:187]
s_waitcnt lgkmcnt(2)
ds_read_u16 v110, v241 offset:384
v_fmac_f32 v177, v201, v252
v_mfma_f32_16x16x32_bf16 v[184:187], v[68:71], v[136:139], v[184:187]
L_entrys:
s_waitcnt lgkmcnt(2)
v_fmac_f32 v179, v203, v252
v_cvt_pk_bf16_f32 v176, v176, v177
v_mfma_f32_16x16x32_bf16 v[188:191], a[124:127], v[192:195], 0
s_waitcnt lgkmcnt(1)
v_cvt_pk_bf16_f32 v177, v178, v179
v_cvt_pk_bf16_f32 v171, v174, v175
v_mfma_f32_16x16x32_bf16 v[188:191], a[120:123], v[196:199], v[188:191]
v_fmac_f32 v180, v184, v252
v_fmac_f32 v181, v185, v252
v_mfma_f32_16x16x32_bf16 v[188:191], a[116:119], v[204:207], v[188:191]
v_fmac_f32 v183, v187, v252
v_fmac_f32 v182, v186, v252
v_mfma_f32_16x16x32_bf16 v[188:191], a[112:115], v[208:211], v[188:191]
v_cvt_pk_bf16_f32 v178, v180, v181
v_cvt_pk_bf16_f32 v170, v172, v173
v_mfma_f32_16x16x32_bf16 v[184:187], a[96:99], v[208:211], 0
s_waitcnt lgkmcnt(0)
v_cvt_pk_bf16_f32 v179, v182, v183
v_pk_max_i16 v168, v168, 0
v_mfma_f32_16x16x32_bf16 v[184:187], a[100:103], v[204:207], v[184:187]
s_add_u32 s48, s48, s51
v_cvt_pk_bf16_f32 v46, v188, v189
v_cvt_pk_bf16_f32 v47, v190, v191
v_mfma_f32_16x16x32_bf16 v[184:187], a[104:107], v[196:199], v[184:187]
s_add_u32 m0, s49, 12672
v_pk_max_i16 v176, v176, 0
v_pk_max_i16 v170, v170, 0
v_mfma_f32_16x16x32_bf16 v[184:187], a[108:111], v[192:195], v[184:187]
buffer_load_dwordx4 v237, s[16:19], s48 offen nt lds
v_pk_max_i16 v179, v179, 0
v_mfma_f32_16x16x32_bf16 v[188:191], a[92:95], v[192:195], 0
v_pk_max_i16 v178, v178, 0
v_pk_max_i16 v169, v169, 0
v_mfma_f32_16x16x32_bf16 v[188:191], a[88:91], v[196:199], v[188:191]
v_pk_max_i16 v177, v177, 0
v_pk_max_i16 v171, v171, 0
v_mfma_f32_16x16x32_bf16 v[188:191], a[84:87], v[204:207], v[188:191]
buffer_store_dwordx4 v[168:171], v239, s[20:23], s53 offen offset:0 nt
buffer_store_dwordx4 v[176:179], v239, s[20:23], s53 offen offset:64 nt
v_cvt_pk_bf16_f32 v44, v184, v185
v_cvt_pk_bf16_f32 v45, v186, v187
v_add_u32 v241, 0x200, v241
s_add_u32 s53, s46, 0
v_mfma_f32_16x16x32_bf16 v[188:191], a[80:83], v[208:211], v[188:191]
s_nop 2
v_mfma_f32_16x16x32_bf16 v[184:187], a[64:67], v[208:211], 0
s_nop 2
v_mfma_f32_16x16x32_bf16 v[184:187], a[72:75], v[196:199], v[184:187]
v_cvt_pk_bf16_f32 v42, v188, v189
v_cvt_pk_bf16_f32 v43, v190, v191
v_mfma_f32_16x16x32_bf16 v[184:187], a[76:79], v[192:195], v[184:187]
v_mfma_f32_16x16x32_bf16 v[184:187], a[68:71], v[204:207], v[184:187]
s_nop 2
v_mfma_f32_16x16x32_bf16 v[188:191], a[4:7], v[204:207], 0
s_nop 2
v_mfma_f32_16x16x32_bf16 v[188:191], a[0:3], v[208:211], v[188:191]
v_cvt_pk_bf16_f32 v41, v186, v187
v_cvt_pk_bf16_f32 v40, v184, v185
v_mfma_f32_16x16x32_bf16 v[188:191], a[8:11], v[196:199], v[188:191]
v_mfma_f32_16x16x32_bf16 v[188:191], a[12:15], v[192:195], v[188:191]
s_nop 2
v_mfma_f32_16x16x32_bf16 v[184:187], a[28:31], v[192:195], 0
s_nop 2
v_mfma_f32_16x16x32_bf16 v[184:187], a[24:27], v[196:199], v[184:187]
v_cvt_pk_bf16_f32 v112, v188, v189
v_cvt_pk_bf16_f32 v113, v190, v191
v_mfma_f32_16x16x32_bf16 v[184:187], a[20:23], v[204:207], v[184:187]
v_mfma_f32_16x16x32_bf16 v[184:187], a[16:19], v[208:211], v[184:187]
s_nop 2
v_mfma_f32_16x16x32_bf16 v[188:191], a[32:35], v[208:211], 0
s_nop 2
v_mfma_f32_16x16x32_bf16 v[188:191], a[36:39], v[204:207], v[188:191]
s_add_u32 m0, s49, 14784
v_cvt_pk_bf16_f32 v114, v184, v185
v_cvt_pk_bf16_f32 v115, v186, v187
v_mfma_f32_16x16x32_bf16 v[188:191], a[40:43], v[196:199], v[188:191]
s_add_u32 s48, s48, s51
buffer_load_dwordx4 v237, s[16:19], s48 offen nt lds
v_mfma_f32_16x16x32_bf16 v[188:191], a[44:47], v[192:195], v[188:191]
s_nop 2
v_mfma_f32_16x16x32_bf16 v[184:187], a[60:63], v[192:195], 0
s_nop 2
v_mfma_f32_16x16x32_bf16 v[184:187], a[56:59], v[196:199], v[184:187]
v_cvt_pk_bf16_f32 v116, v188, v189
v_cvt_pk_bf16_f32 v117, v190, v191
v_mfma_f32_16x16x32_bf16 v[184:187], a[52:55], v[204:207], v[184:187]
v_mfma_f32_16x16x32_bf16 v[184:187], a[48:51], v[208:211], v[184:187]
s_nop 2
v_mfma_f32_16x16x32_bf16 v[152:155], a[192:195], v[208:211], 0
s_nop 2
v_mfma_f32_16x16x32_bf16 v[152:155], a[196:199], v[204:207], v[152:155]
v_cvt_pk_bf16_f32 v118, v184, v185
v_cvt_pk_bf16_f32 v119, v186, v187
v_mfma_f32_16x16x32_bf16 v[152:155], a[200:203], v[196:199], v[152:155]
v_mfma_f32_16x16x32_bf16 v[152:155], a[204:207], v[192:195], v[152:155]
v_mfma_f32_16x16x32_bf16 v[156:159], a[220:223], v[192:195], 0
v_mfma_f32_16x16x32_bf16 v[156:159], a[216:219], v[196:199], v[156:159]
v_mfma_f32_16x16x32_bf16 v[156:159], a[212:215], v[204:207], v[156:159]
v_mfma_f32_16x16x32_bf16 v[156:159], a[208:211], v[208:211], v[156:159]
v_mfma_f32_16x16x32_bf16 v[160:163], a[224:227], v[208:211], 0
v_mfma_f32_16x16x32_bf16 v[160:163], a[228:231], v[204:207], v[160:163]
v_mfma_f32_16x16x32_bf16 v[160:163], a[232:235], v[196:199], v[160:163]
v_mfma_f32_16x16x32_bf16 v[160:163], a[236:239], v[192:195], v[160:163]
v_mfma_f32_16x16x32_bf16 v[164:167], a[252:255], v[192:195], 0
v_mfma_f32_16x16x32_bf16 v[164:167], a[248:251], v[196:199], v[164:167]
s_add_u32 s48, s48, s51
s_add_u32 m0, s49, 16896
v_mfma_f32_16x16x32_bf16 v[164:167], a[244:247], v[204:207], v[164:167]
buffer_load_dwordx4 v237, s[16:19], s48 offen nt lds
v_mfma_f32_16x16x32_bf16 v[164:167], a[240:243], v[208:211], v[164:167]
v_mfma_f32_16x16x32_bf16 v[184:187], v[0:3], v[112:115], 0
v_mfma_f32_16x16x32_bf16 v[184:187], v[4:7], v[116:119], v[184:187]
s_nop 2
v_mfma_f32_16x16x32_bf16 v[188:191], v[12:15], v[116:119], 0
s_nop 2
v_mfma_f32_16x16x32_bf16 v[188:191], v[8:11], v[112:115], v[188:191]
v_max3_f32 v254, v184, v185, v186
s_nop 0
v_mfma_f32_16x16x32_bf16 v[200:203], v[16:19], v[112:115], 0
s_nop 2
v_mfma_f32_16x16x32_bf16 v[200:203], v[20:23], v[116:119], v[200:203]
s_nop 0
v_max3_f32 v254, v254, v187, v188
v_max3_f32 v254, v254, v189, v190
v_mfma_f32_16x16x32_bf16 v[212:215], v[28:31], v[116:119], 0
s_nop 2
v_mfma_f32_16x16x32_bf16 v[212:215], v[24:27], v[112:115], v[212:215]
v_max3_f32 v254, v254, v191, v200
v_max3_f32 v254, v254, v201, v202
v_mfma_f32_16x16x32_bf16 v[216:219], v[32:35], v[112:115], 0
s_nop 2
v_mfma_f32_16x16x32_bf16 v[216:219], v[36:39], v[116:119], v[216:219]
s_nop 0
v_max3_f32 v254, v254, v203, v212
v_max3_f32 v254, v254, v213, v214
v_mfma_f32_16x16x32_bf16 v[220:223], v[44:47], v[116:119], 0
s_nop 2
v_mfma_f32_16x16x32_bf16 v[220:223], v[40:43], v[112:115], v[220:223]
v_max3_f32 v254, v254, v215, v216
v_max3_f32 v254, v254, v217, v218
v_mfma_f32_16x16x32_bf16 v[224:227], v[48:51], v[112:115], 0
s_nop 2
v_mfma_f32_16x16x32_bf16 v[224:227], v[52:55], v[116:119], v[224:227]
s_nop 0
v_max3_f32 v254, v254, v219, v220
v_max3_f32 v254, v254, v221, v222
v_mfma_f32_16x16x32_bf16 v[228:231], v[208:211], a[128:131], 0
s_nop 2
v_mfma_f32_16x16x32_bf16 v[228:231], v[204:207], a[132:135], v[228:231]
v_max3_f32 v254, v254, v223, v224
v_mfma_f32_16x16x32_bf16 v[228:231], v[196:199], a[136:139], v[228:231]
ds_swizzle_b32 v255, v254 offset:0x401F
v_mfma_f32_16x16x32_bf16 v[228:231], v[192:195], a[140:143], v[228:231]
s_add_u32 m0, s49, 19008
s_add_u32 s48, s48, s51
buffer_load_dwordx4 v237, s[16:19], s48 offen nt lds
v_mfma_f32_16x16x32_bf16 v[232:235], v[192:195], a[156:159], 0
s_nop 2
v_mfma_f32_16x16x32_bf16 v[232:235], v[196:199], a[152:155], v[232:235]
v_cvt_pk_bf16_f32 v91, v230, v231
v_cvt_pk_bf16_f32 v90, v228, v229
v_mfma_f32_16x16x32_bf16 v[232:235], v[204:207], a[148:151], v[232:235]
v_mfma_f32_16x16x32_bf16 v[232:235], v[208:211], a[144:147], v[232:235]
s_nop 2
v_mfma_f32_16x16x32_bf16 v[228:231], v[208:211], a[160:163], 0
s_waitcnt lgkmcnt(0)
v_max_f32 v254, v254, v255
s_nop 0
v_mfma_f32_16x16x32_bf16 v[228:231], v[204:207], a[164:167], v[228:231]
ds_bpermute_b32 v255, v247, v254
v_mfma_f32_16x16x32_bf16 v[228:231], v[196:199], a[168:171], v[228:231]
v_cvt_pk_bf16_f32 v95, v234, v235
v_cvt_pk_bf16_f32 v94, v232, v233
v_mfma_f32_16x16x32_bf16 v[228:231], v[192:195], a[172:175], v[228:231]
s_nop 2
v_mfma_f32_16x16x32_bf16 v[232:235], v[192:195], a[188:191], 0
ds_read_b128 v[192:195], v236 offset:4224
s_nop 0
v_mfma_f32_16x16x32_bf16 v[232:235], v[204:207], a[180:183], v[232:235]
ds_read_b128 v[204:207], v236 offset:4480
v_cvt_pk_bf16_f32 v99, v230, v231
v_mfma_f32_16x16x32_bf16 v[232:235], v[208:211], a[176:179], v[232:235]
ds_read_b128 v[208:211], v236 offset:4736
v_cvt_pk_bf16_f32 v98, v228, v229
v_mfma_f32_16x16x32_bf16 v[232:235], v[196:199], a[184:187], v[232:235]
s_waitcnt lgkmcnt(3)
ds_read_b128 v[196:199], v236 offset:4992
v_max_f32 v254, v254, v255
v_sub_f32 v184, v184, v254
v_sub_f32 v185, v185, v254
v_exp_f32 v184, v184
v_exp_f32 v185, v185
v_sub_f32 v187, v187, v254
v_cvt_pk_bf16_f32 v103, v234, v235
v_cvt_pk_bf16_f32 v102, v232, v233
v_add_f32 v248, v184, v185
v_sub_f32 v186, v186, v254
v_exp_f32 v186, v186
v_cvt_pk_bf16_f32 v120, v184, v185
v_add_f32 v248, v248, v186
s_waitcnt lgkmcnt(1)
v_mfma_f32_16x16x32_bf16 v[228:231], v[208:211], a[184:187], 0
v_sub_f32 v188, v188, v254
s_waitcnt lgkmcnt(0)
v_mfma_f32_16x16x32_bf16 v[228:231], v[196:199], a[188:191], v[228:231]
v_exp_f32 v187, v187
v_mfma_f32_16x16x32_bf16 v[228:231], v[204:207], a[180:183], v[228:231]
v_cvt_pk_bf16_f32 v121, v186, v187
v_add_f32 v248, v248, v187
v_mfma_f32_16x16x32_bf16 v[228:231], v[192:195], a[176:179], v[228:231]
v_sub_f32 v189, v189, v254
v_sub_f32 v190, v190, v254
v_mfma_f32_16x16x32_bf16 v[232:235], v[192:195], a[160:163], 0
v_exp_f32 v189, v189
v_mfma_f32_16x16x32_bf16 v[232:235], v[204:207], a[164:167], v[232:235]
v_exp_f32 v190, v190
v_mfma_f32_16x16x32_bf16 v[232:235], v[208:211], a[168:171], v[232:235]
s_nop 0
v_cvt_pk_bf16_f32 v71, v230, v231
v_cvt_pk_bf16_f32 v70, v228, v229
v_mfma_f32_16x16x32_bf16 v[232:235], v[196:199], a[172:175], v[232:235]
s_add_u32 s48, s48, s51
v_exp_f32 v188, v188
v_mfma_f32_16x16x32_bf16 v[228:231], v[196:199], a[156:159], 0
s_add_u32 m0, s49, 21120
v_add_f32 v248, v248, v188
v_sub_f32 v191, v191, v254
v_mfma_f32_16x16x32_bf16 v[228:231], v[208:211], a[152:155], v[228:231]
buffer_load_dwordx4 v237, s[16:19], s48 offen nt lds
v_cvt_pk_bf16_f32 v66, v232, v233
v_mfma_f32_16x16x32_bf16 v[228:231], v[204:207], a[148:151], v[228:231]
v_cvt_pk_bf16_f32 v67, v234, v235
v_add_f32 v248, v248, v189
v_mfma_f32_16x16x32_bf16 v[228:231], v[192:195], a[144:147], v[228:231]
v_exp_f32 v191, v191
v_mfma_f32_16x16x32_bf16 v[232:235], v[192:195], a[128:131], 0
ds_read_b128 v[192:195], v236 offset:0
v_cvt_pk_bf16_f32 v122, v188, v189
v_mfma_f32_16x16x32_bf16 v[232:235], v[208:211], a[136:139], v[232:235]
ds_read_b128 v[208:211], v236 offset:256
v_add_f32 v248, v248, v190
v_mfma_f32_16x16x32_bf16 v[232:235], v[196:199], a[140:143], v[232:235]
ds_read_b128 v[196:199], v236 offset:512
v_cvt_pk_bf16_f32 v62, v228, v229
v_mfma_f32_16x16x32_bf16 v[232:235], v[204:207], a[132:135], v[232:235]
ds_read_b128 v[204:207], v236 offset:768
v_cvt_pk_bf16_f32 v63, v230, v231
v_add_f32 v248, v248, v191
v_cvt_pk_bf16_f32 v123, v190, v191
v_sub_f32 v200, v200, v254
v_exp_f32 v200, v200
v_sub_f32 v201, v201, v254
v_exp_f32 v201, v201
v_cvt_pk_bf16_f32 v59, v234, v235
v_cvt_pk_bf16_f32 v58, v232, v233
v_sub_f32 v203, v203, v254
s_waitcnt lgkmcnt(2)
v_mfma_f32_16x16x32_bf16 v[228:231], v[208:211], a[132:135], 0
ds_read_b128 v[188:191], v242 offset:64
v_sub_f32 v202, v202, v254
v_mfma_f32_16x16x32_bf16 v[228:231], v[192:195], a[128:131], v[228:231]
s_waitcnt lgkmcnt(2)
v_exp_f32 v203, v203
v_mfma_f32_16x16x32_bf16 v[228:231], v[196:199], a[136:139], v[228:231]
s_waitcnt lgkmcnt(1)
v_exp_f32 v202, v202
v_mfma_f32_16x16x32_bf16 v[228:231], v[204:207], a[140:143], v[228:231]
v_add_f32 v248, v248, v200
v_add_f32 v248, v248, v201
v_mfma_f32_16x16x32_bf16 v[184:187], v[204:207], a[156:159], 0
v_add_f32 v248, v248, v202
v_add_f32 v248, v248, v203
v_mfma_f32_16x16x32_bf16 v[184:187], v[196:199], a[152:155], v[184:187]
v_cvt_pk_bf16_f32 v124, v200, v201
v_cvt_pk_bf16_f32 v125, v202, v203
v_mfma_f32_16x16x32_bf16 v[184:187], v[208:211], a[148:151], v[184:187]
s_waitcnt lgkmcnt(0)
v_cvt_pk_bf16_f32 v56, v228, v229
v_cvt_pk_bf16_f32 v57, v230, v231
v_mfma_f32_16x16x32_bf16 v[184:187], v[192:195], a[144:147], v[184:187]
v_sub_f32 v212, v212, v254
v_sub_f32 v213, v213, v254
v_mfma_f32_16x16x32_bf16 v[228:231], v[192:195], a[160:163], 0
v_exp_f32 v212, v212
v_mfma_f32_16x16x32_bf16 v[228:231], v[208:211], a[164:167], v[228:231]
v_sub_f32 v214, v214, v254
v_add_f32 v248, v248, v212
v_mfma_f32_16x16x32_bf16 v[228:231], v[196:199], a[168:171], v[228:231]
v_cvt_pk_bf16_f32 v60, v184, v185
v_cvt_pk_bf16_f32 v61, v186, v187
v_mfma_f32_16x16x32_bf16 v[228:231], v[204:207], a[172:175], v[228:231]
s_add_u32 m0, s49, 23232
ds_read_b128 v[184:187], v242 offset:0
v_sub_f32 v215, v215, v254
v_mfma_f32_16x16x32_bf16 v[232:235], v[204:207], a[188:191], 0
s_add_u32 s48, s48, s51
buffer_load_dwordx4 v237, s[16:19], s48 offen nt lds
v_sub_f32 v216, v216, v254
v_mfma_f32_16x16x32_bf16 v[232:235], v[196:199], a[184:187], v[232:235]
s_sub_u32 s49, s49, s56
v_exp_f32 v213, v213
v_mfma_f32_16x16x32_bf16 v[232:235], v[208:211], a[180:183], v[232:235]
s_and_b32 s51, s57, 26212352
v_exp_f32 v214, v214
v_mfma_f32_16x16x32_bf16 v[232:235], v[192:195], a[176:179], v[232:235]
s_add_u32 s51, s51, 2048
v_cvt_pk_bf16_f32 v126, v212, v213
v_add_f32 v248, v248, v213
v_mfma_f32_16x16x32_bf16 v[200:203], v[4:7], v[188:191], 0
v_add_f32 v248, v248, v214
s_waitcnt lgkmcnt(0)
v_mfma_f32_16x16x32_bf16 v[200:203], v[0:3], v[184:187], v[200:203]
s_nop 0
v_cvt_pk_bf16_f32 v69, v234, v235
v_cvt_pk_bf16_f32 v68, v232, v233
v_mfma_f32_16x16x32_bf16 v[232:235], v[32:35], v[184:187], 0
ds_read_b128 v[184:187], v245 offset:64
v_sub_f32 v218, v218, v254
v_mfma_f32_16x16x32_bf16 v[232:235], v[36:39], v[188:191], v[232:235]
ds_read_b128 v[188:191], v243 offset:0
v_exp_f32 v215, v215
s_nop 0
v_add_f32 v248, v248, v215
v_cvt_pk_bf16_f32 v127, v214, v215
ds_read_b128 v[212:215], v243 offset:64
v_exp_f32 v216, v216
v_sub_f32 v217, v217, v254
v_add_f32 v248, v248, v216
v_exp_f32 v218, v218
v_sub_f32 v219, v219, v254
v_exp_f32 v217, v217
v_exp_f32 v219, v219
v_cvt_pk_bf16_f32 v128, v216, v217
v_cvt_pk_bf16_f32 v129, v218, v219
v_add_f32 v248, v248, v217
v_add_f32 v248, v248, v218
v_add_f32 v248, v248, v219
v_cvt_pk_bf16_f32 v64, v228, v229
v_cvt_pk_bf16_f32 v65, v230, v231
v_sub_f32 v220, v220, v254
v_sub_f32 v221, v221, v254
s_waitcnt lgkmcnt(0)
v_mfma_f32_16x16x32_bf16 v[200:203], v[12:15], v[212:215], v[200:203]
ds_read_b128 v[216:219], v244 offset:0
ds_read_b128 v[228:231], v245 offset:0
v_mfma_f32_16x16x32_bf16 v[200:203], v[8:11], v[188:191], v[200:203]
v_exp_f32 v220, v220
v_mfma_f32_16x16x32_bf16 v[232:235], v[40:43], v[188:191], v[232:235]
ds_read_b128 v[188:191], v244 offset:64
v_add_f32 v248, v248, v220
v_mfma_f32_16x16x32_bf16 v[232:235], v[44:47], v[212:215], v[232:235]
v_exp_f32 v221, v221
v_sub_f32 v223, v223, v254
v_add_f32 v248, v248, v221
v_exp_f32 v223, v223
v_sub_f32 v222, v222, v254
v_exp_f32 v222, v222
v_cvt_pk_bf16_f32 v130, v220, v221
v_mov_b32 v221, 0xff800000
v_add_f32 v248, v248, v222
v_cvt_pk_bf16_f32 v131, v222, v223
v_add_f32 v248, v248, v223
v_sub_f32 v224, v224, v254
v_exp_f32 v224, v224
s_waitcnt lgkmcnt(0)
v_mfma_f32_16x16x32_bf16 v[200:203], v[20:23], v[188:191], v[200:203]
v_cvt_pk_bf16_f32 v132, v224, 0
v_add_f32 v248, v248, v224
v_mfma_f32_16x16x32_bf16 v[200:203], v[16:19], v[216:219], v[200:203]
ds_swizzle_b32 v250, v248 offset:0x401F
v_add_u32 v245, 0x200, v245
v_mfma_f32_16x16x32_bf16 v[232:235], v[48:51], v[216:219], v[232:235]
v_add_u32 v244, 0x200, v244
v_add_u32 v243, 0x200, v243
v_mfma_f32_16x16x32_bf16 v[232:235], v[52:55], v[188:191], v[232:235]
v_add_u32 v242, 0x200, v242
s_nop 0
v_mfma_f32_16x16x32_bf16 v[200:203], v[24:27], v[228:231], v[200:203]
s_nop 2
v_mfma_f32_16x16x32_bf16 v[200:203], v[28:31], v[184:187], v[200:203]
s_nop 0
v_mov_b32_dpp v233, v221 quad_perm:[0,1,2,3] row_mask:0xf bank_mask:0xc
v_mov_b32_dpp v232, v221 quad_perm:[0,1,2,3] row_mask:0xf bank_mask:0x8
v_mfma_f32_16x16x32_bf16 v[184:187], a[0:3], v[192:195], 0
v_mov_b32_dpp v234, v221 quad_perm:[0,1,2,3] row_mask:0xf bank_mask:0xc
v_mov_b32_dpp v235, v221 quad_perm:[0,1,2,3] row_mask:0xf bank_mask:0xc
v_mfma_f32_16x16x32_bf16 v[184:187], a[4:7], v[208:211], v[184:187]
s_waitcnt lgkmcnt(0)
v_max3_f32 v223, v200, v201, v202
v_max3_f32 v223, v223, v203, v232
v_mfma_f32_16x16x32_bf16 v[184:187], a[8:11], v[196:199], v[184:187]
v_max3_f32 v223, v223, v233, v234
v_max_f32 v223, v223, v235
v_mfma_f32_16x16x32_bf16 v[184:187], a[12:15], v[204:207], v[184:187]
s_nop 0
v_max_f32_dpp v223, v223, v223 row_ror:8 row_mask:0xf bank_mask:0xf
v_add_f32 v248, v248, v250
v_mfma_f32_16x16x32_bf16 v[188:191], a[28:31], v[204:207], 0
ds_bpermute_b32 v250, v247, v248
v_mfma_f32_16x16x32_bf16 v[188:191], a[24:27], v[196:199], v[188:191]
v_max_f32_dpp v223, v223, v223 row_ror:4 row_mask:0xf bank_mask:0xf
v_mfma_f32_16x16x32_bf16 v[188:191], a[20:23], v[208:211], v[188:191]
ds_swizzle_b32 v221, v223 offset:0x401F
v_cvt_pk_bf16_f32 v113, v186, v187
v_mfma_f32_16x16x32_bf16 v[188:191], a[16:19], v[192:195], v[188:191]
v_cvt_pk_bf16_f32 v112, v184, v185
s_nop 0
v_mfma_f32_16x16x32_bf16 v[184:187], a[32:35], v[192:195], 0
s_nop 2
v_mfma_f32_16x16x32_bf16 v[184:187], a[36:39], v[208:211], v[184:187]
s_nop 0
v_cvt_pk_bf16_f32 v115, v190, v191
v_cvt_pk_bf16_f32 v114, v188, v189
v_mfma_f32_16x16x32_bf16 v[184:187], a[40:43], v[196:199], v[184:187]
s_waitcnt lgkmcnt(1)
v_add_f32 v248, v248, v250
v_mfma_f32_16x16x32_bf16 v[184:187], a[44:47], v[204:207], v[184:187]
v_rcp_f32 v251, v248
v_mfma_f32_16x16x32_bf16 v[188:191], a[60:63], v[204:207], 0
s_waitcnt lgkmcnt(0)
v_max_f32 v223, v223, v221
s_nop 0
v_mfma_f32_16x16x32_bf16 v[188:191], a[56:59], v[196:199], v[188:191]
ds_bpermute_b32 v221, v247, v223
v_mfma_f32_16x16x32_bf16 v[188:191], a[52:55], v[208:211], v[188:191]
v_cvt_pk_bf16_f32 v117, v186, v187
v_cvt_pk_bf16_f32 v116, v184, v185
v_mfma_f32_16x16x32_bf16 v[188:191], a[48:51], v[192:195], v[188:191]
s_nop 2
v_mfma_f32_16x16x32_bf16 v[168:171], a[192:195], v[192:195], 0
s_nop 2
v_mfma_f32_16x16x32_bf16 v[168:171], a[196:199], v[208:211], v[168:171]
v_cvt_pk_bf16_f32 v119, v190, v191
v_cvt_pk_bf16_f32 v118, v188, v189
v_mfma_f32_16x16x32_bf16 v[168:171], a[200:203], v[196:199], v[168:171]
v_mfma_f32_16x16x32_bf16 v[168:171], a[204:207], v[204:207], v[168:171]
s_waitcnt lgkmcnt(0)
v_max_f32 v223, v223, v221
v_sub_f32 v200, v200, v223
v_mfma_f32_16x16x32_bf16 v[172:175], a[220:223], v[204:207], 0
v_exp_f32 v200, v200
v_mfma_f32_16x16x32_bf16 v[172:175], a[216:219], v[196:199], v[172:175]
v_sub_f32 v201, v201, v223
v_sub_f32 v202, v202, v223
v_mfma_f32_16x16x32_bf16 v[172:175], a[212:215], v[208:211], v[172:175]
v_exp_f32 v202, v202
v_mfma_f32_16x16x32_bf16 v[172:175], a[208:211], v[192:195], v[172:175]
v_exp_f32 v201, v201
v_mfma_f32_16x16x32_bf16 v[176:179], a[224:227], v[192:195], 0
v_add_f32 v220, v200, v201
v_add_f32 v220, v220, v202
v_mfma_f32_16x16x32_bf16 v[176:179], a[228:231], v[208:211], v[176:179]
v_sub_f32 v203, v203, v223
v_sub_f32 v233, v233, v223
v_mfma_f32_16x16x32_bf16 v[176:179], a[232:235], v[196:199], v[176:179]
v_exp_f32 v233, v233
v_mfma_f32_16x16x32_bf16 v[176:179], a[236:239], v[204:207], v[176:179]
v_exp_f32 v203, v203
v_mfma_f32_16x16x32_bf16 v[180:183], a[252:255], v[204:207], 0
v_sub_f32 v232, v232, v223
v_sub_f32 v234, v234, v223
v_mfma_f32_16x16x32_bf16 v[180:183], a[248:251], v[196:199], v[180:183]
v_exp_f32 v232, v232
v_mfma_f32_16x16x32_bf16 v[180:183], a[244:247], v[208:211], v[180:183]
v_exp_f32 v234, v234
v_mfma_f32_16x16x32_bf16 v[180:183], a[240:243], v[192:195], v[180:183]
v_add_f32 v220, v220, v203
v_add_f32 v220, v220, v232
v_mfma_f32_16x16x32_bf16 v[184:187], v[0:3], v[112:115], 0
v_add_f32 v220, v220, v233
v_add_f32 v220, v220, v234
v_mfma_f32_16x16x32_bf16 v[184:187], v[4:7], v[116:119], v[184:187]
v_sub_f32 v235, v235, v223
v_cvt_pk_bf16_f32 v200, v200, v201
v_mfma_f32_16x16x32_bf16 v[188:191], v[12:15], v[116:119], 0
v_exp_f32 v235, v235
v_mfma_f32_16x16x32_bf16 v[188:191], v[8:11], v[112:115], v[188:191]
v_add_f32 v220, v220, v235
v_cvt_pk_bf16_f32 v201, v202, v203
v_mfma_f32_16x16x32_bf16 v[192:195], v[16:19], v[112:115], 0
v_cvt_pk_bf16_f32 v202, v232, v233
v_cvt_pk_bf16_f32 v203, v234, v235
v_mfma_f32_16x16x32_bf16 v[192:195], v[20:23], v[116:119], v[192:195]
ds_read_b128 v[196:199], v236 offset:8448
v_add_f32_dpp v220, v220, v220 row_ror:8 row_mask:0xf bank_mask:0xf
v_mfma_f32_16x16x32_bf16 v[208:211], v[28:31], v[116:119], 0
ds_read_b128 v[204:207], v236 offset:8704
v_add_f32_dpp v220, v220, v220 row_ror:4 row_mask:0xf bank_mask:0xf
v_mfma_f32_16x16x32_bf16 v[208:211], v[24:27], v[112:115], v[208:211]
ds_write_b32 v246, v220 offset:4096
ds_read_b128 v[212:215], v236 offset:8960
v_mfma_f32_16x16x32_bf16 v[216:219], v[32:35], v[112:115], 0
ds_read_b128 v[224:227], v236 offset:9216
v_max3_f32 v254, v184, v185, v186
v_mfma_f32_16x16x32_bf16 v[216:219], v[36:39], v[116:119], v[216:219]
v_max3_f32 v254, v254, v187, v188
v_max3_f32 v254, v254, v189, v190
v_mfma_f32_16x16x32_bf16 v[228:231], v[44:47], v[116:119], 0
v_max3_f32 v254, v254, v191, v192
v_max3_f32 v254, v254, v193, v194
v_mfma_f32_16x16x32_bf16 v[228:231], v[40:43], v[112:115], v[228:231]
s_waitcnt lgkmcnt(4)
v_max3_f32 v254, v254, v195, v208
v_max3_f32 v254, v254, v209, v210
v_mfma_f32_16x16x32_bf16 v[232:235], v[48:51], v[112:115], 0
s_waitcnt lgkmcnt(3)
v_max3_f32 v254, v254, v211, v216
v_max3_f32 v254, v254, v217, v218
v_mfma_f32_16x16x32_bf16 v[232:235], v[52:55], v[116:119], v[232:235]
s_waitcnt lgkmcnt(1)
v_max3_f32 v254, v254, v219, v228
v_max3_f32 v254, v254, v229, v230
v_mfma_f32_16x16x32_bf16 v[220:223], v[196:199], a[128:131], 0
s_waitcnt lgkmcnt(0)
s_nop 1
v_mfma_f32_16x16x32_bf16 v[220:223], v[204:207], a[132:135], v[220:223]
v_max3_f32 v254, v254, v231, v232
v_mfma_f32_16x16x32_bf16 v[220:223], v[212:215], a[136:139], v[220:223]
ds_swizzle_b32 v255, v254 offset:0x401F
v_mfma_f32_16x16x32_bf16 v[220:223], v[224:227], a[140:143], v[220:223]
s_nop 7
v_cvt_pk_bf16_f32 v73, v222, v223
v_cvt_pk_bf16_f32 v72, v220, v221
v_mfma_f32_16x16x32_bf16 v[220:223], v[224:227], a[156:159], 0
v_mfma_f32_16x16x32_bf16 v[220:223], v[212:215], a[152:155], v[220:223]
v_mfma_f32_16x16x32_bf16 v[220:223], v[204:207], a[148:151], v[220:223]
s_waitcnt lgkmcnt(0)
v_max_f32 v254, v254, v255
v_mfma_f32_16x16x32_bf16 v[220:223], v[196:199], a[144:147], v[220:223]
ds_bpermute_b32 v255, v247, v254
s_nop 6
v_cvt_pk_bf16_f32 v76, v220, v221
v_cvt_pk_bf16_f32 v77, v222, v223
v_mfma_f32_16x16x32_bf16 v[220:223], v[196:199], a[160:163], 0
v_mfma_f32_16x16x32_bf16 v[220:223], v[204:207], a[164:167], v[220:223]
v_mfma_f32_16x16x32_bf16 v[220:223], v[212:215], a[168:171], v[220:223]
s_waitcnt lgkmcnt(0)
v_max_f32 v254, v254, v255
v_mfma_f32_16x16x32_bf16 v[220:223], v[224:227], a[172:175], v[220:223]
v_sub_f32 v184, v184, v254
v_exp_f32 v184, v184
v_sub_f32 v185, v185, v254
v_sub_f32 v187, v187, v254
v_exp_f32 v185, v185
s_nop 2
v_cvt_pk_bf16_f32 v81, v222, v223
v_cvt_pk_bf16_f32 v80, v220, v221
v_mfma_f32_16x16x32_bf16 v[220:223], v[224:227], a[188:191], 0
ds_read_b128 v[224:227], v236 offset:12672
v_add_f32 v249, v184, v185
v_mfma_f32_16x16x32_bf16 v[220:223], v[204:207], a[180:183], v[220:223]
ds_read_b128 v[204:207], v236 offset:12928
v_sub_f32 v186, v186, v254
v_mfma_f32_16x16x32_bf16 v[220:223], v[196:199], a[176:179], v[220:223]
ds_read_b128 v[196:199], v236 offset:13184
v_cvt_pk_bf16_f32 v136, v184, v185
v_mfma_f32_16x16x32_bf16 v[220:223], v[212:215], a[184:187], v[220:223]
ds_read_b128 v[212:215], v236 offset:13440
v_exp_f32 v186, v186
v_exp_f32 v187, v187
v_add_f32 v249, v249, v186
v_add_f32 v249, v249, v187
v_cvt_pk_bf16_f32 v137, v186, v187
v_sub_f32 v189, v189, v254
v_sub_f32 v188, v188, v254
v_cvt_pk_bf16_f32 v84, v220, v221
v_cvt_pk_bf16_f32 v85, v222, v223
v_exp_f32 v188, v188
v_exp_f32 v189, v189
v_sub_f32 v191, v191, v254
s_waitcnt lgkmcnt(1)
v_mfma_f32_16x16x32_bf16 v[184:187], v[196:199], a[184:187], 0
v_sub_f32 v190, v190, v254
s_waitcnt lgkmcnt(0)
v_mfma_f32_16x16x32_bf16 v[184:187], v[212:215], a[188:191], v[184:187]
v_exp_f32 v190, v190
v_mfma_f32_16x16x32_bf16 v[184:187], v[204:207], a[180:183], v[184:187]
v_exp_f32 v191, v191
v_mfma_f32_16x16x32_bf16 v[184:187], v[224:227], a[176:179], v[184:187]
v_add_f32 v249, v249, v188
v_add_f32 v249, v249, v189
v_mfma_f32_16x16x32_bf16 v[220:223], v[224:227], a[160:163], 0
v_add_f32 v249, v249, v190
v_cvt_pk_bf16_f32 v139, v190, v191
v_mfma_f32_16x16x32_bf16 v[220:223], v[204:207], a[164:167], v[220:223]
v_cvt_pk_bf16_f32 v138, v188, v189
v_add_f32 v249, v249, v191
v_mfma_f32_16x16x32_bf16 v[220:223], v[196:199], a[168:171], v[220:223]
v_cvt_pk_bf16_f32 v86, v184, v185
v_cvt_pk_bf16_f32 v87, v186, v187
v_mfma_f32_16x16x32_bf16 v[220:223], v[212:215], a[172:175], v[220:223]
v_sub_f32 v192, v192, v254
v_sub_f32 v194, v194, v254
v_mfma_f32_16x16x32_bf16 v[184:187], v[212:215], a[156:159], 0
v_exp_f32 v192, v192
v_mfma_f32_16x16x32_bf16 v[184:187], v[196:199], a[152:155], v[184:187]
v_add_f32 v249, v249, v192
v_sub_f32 v193, v193, v254
v_mfma_f32_16x16x32_bf16 v[184:187], v[204:207], a[148:151], v[184:187]
v_cvt_pk_bf16_f32 v83, v222, v223
v_cvt_pk_bf16_f32 v82, v220, v221
v_mfma_f32_16x16x32_bf16 v[184:187], v[224:227], a[144:147], v[184:187]
v_exp_f32 v193, v193
v_mfma_f32_16x16x32_bf16 v[220:223], v[224:227], a[128:131], 0
ds_read_b128 v[224:227], v236 offset:16896
v_sub_f32 v209, v209, v254
v_mfma_f32_16x16x32_bf16 v[220:223], v[196:199], a[136:139], v[220:223]
ds_read_b128 v[196:199], v236 offset:17152
v_sub_f32 v208, v208, v254
v_mfma_f32_16x16x32_bf16 v[220:223], v[212:215], a[140:143], v[220:223]
ds_read_b128 v[212:215], v236 offset:17408
v_cvt_pk_bf16_f32 v79, v186, v187
v_mfma_f32_16x16x32_bf16 v[220:223], v[204:207], a[132:135], v[220:223]
ds_read_b128 v[204:207], v236 offset:17664
v_cvt_pk_bf16_f32 v78, v184, v185
v_exp_f32 v208, v208
v_exp_f32 v209, v209
v_exp_f32 v194, v194
v_add_f32 v249, v249, v193
v_add_f32 v249, v249, v194
v_sub_f32 v195, v195, v254
v_cvt_pk_bf16_f32 v74, v220, v221
v_cvt_pk_bf16_f32 v75, v222, v223
s_waitcnt lgkmcnt(2)
v_mfma_f32_16x16x32_bf16 v[184:187], v[196:199], a[132:135], 0
v_exp_f32 v195, v195
v_mfma_f32_16x16x32_bf16 v[184:187], v[224:227], a[128:131], v[184:187]
s_waitcnt lgkmcnt(1)
v_sub_f32 v216, v216, v254
v_sub_f32 v211, v211, v254
v_mfma_f32_16x16x32_bf16 v[184:187], v[212:215], a[136:139], v[184:187]
s_waitcnt lgkmcnt(0)
v_sub_f32 v210, v210, v254
v_add_f32 v249, v249, v195
v_mfma_f32_16x16x32_bf16 v[184:187], v[204:207], a[140:143], v[184:187]
v_exp_f32 v211, v211
v_mfma_f32_16x16x32_bf16 v[220:223], v[204:207], a[156:159], 0
v_exp_f32 v210, v210
v_mfma_f32_16x16x32_bf16 v[220:223], v[212:215], a[152:155], v[220:223]
v_add_f32 v249, v249, v208
v_sub_f32 v219, v219, v254
v_mfma_f32_16x16x32_bf16 v[220:223], v[196:199], a[148:151], v[220:223]
s_nop 0
v_cvt_pk_bf16_f32 v89, v186, v187
v_cvt_pk_bf16_f32 v88, v184, v185
v_mfma_f32_16x16x32_bf16 v[220:223], v[224:227], a[144:147], v[220:223]
v_exp_f32 v216, v216
v_mfma_f32_16x16x32_bf16 v[184:187], v[224:227], a[160:163], 0
v_sub_f32 v217, v217, v254
v_add_f32 v249, v249, v209
v_mfma_f32_16x16x32_bf16 v[184:187], v[196:199], a[164:167], v[184:187]
v_sub_f32 v228, v228, v254
v_add_f32 v249, v249, v210
v_mfma_f32_16x16x32_bf16 v[184:187], v[212:215], a[168:171], v[184:187]
v_exp_f32 v217, v217
v_mfma_f32_16x16x32_bf16 v[184:187], v[204:207], a[172:175], v[184:187]
v_sub_f32 v229, v229, v254
v_sub_f32 v218, v218, v254
v_mfma_f32_16x16x32_bf16 v[188:191], v[204:207], a[188:191], 0
v_exp_f32 v218, v218
v_mfma_f32_16x16x32_bf16 v[188:191], v[212:215], a[184:187], v[188:191]
v_add_f32 v249, v249, v211
v_add_f32 v249, v249, v216
v_mfma_f32_16x16x32_bf16 v[188:191], v[196:199], a[180:183], v[188:191]
v_cvt_pk_bf16_f32 v96, v184, v185
v_cvt_pk_bf16_f32 v97, v186, v187
v_mfma_f32_16x16x32_bf16 v[188:191], v[224:227], a[176:179], v[188:191]
v_exp_f32 v219, v219
v_mfma_f32_16x16x32_bf16 v[184:187], a[0:3], v[224:227], 0
v_add_f32 v249, v249, v217
v_add_f32 v249, v249, v218
v_mfma_f32_16x16x32_bf16 v[184:187], a[4:7], v[196:199], v[184:187]
v_add_f32 v249, v249, v219
v_cvt_pk_bf16_f32 v144, v216, v217
v_mfma_f32_16x16x32_bf16 v[184:187], a[8:11], v[212:215], v[184:187]
v_cvt_pk_bf16_f32 v100, v188, v189
v_cvt_pk_bf16_f32 v101, v190, v191
v_mfma_f32_16x16x32_bf16 v[184:187], a[12:15], v[204:207], v[184:187]
v_cvt_pk_bf16_f32 v145, v218, v219
v_cvt_pk_bf16_f32 v92, v220, v221
v_mfma_f32_16x16x32_bf16 v[188:191], a[28:31], v[204:207], 0
v_cvt_pk_bf16_f32 v93, v222, v223
v_sub_f32 v232, v232, v254
v_mfma_f32_16x16x32_bf16 v[188:191], a[24:27], v[212:215], v[188:191]
v_exp_f32 v228, v228
v_mfma_f32_16x16x32_bf16 v[188:191], a[20:23], v[196:199], v[188:191]
v_cvt_pk_bf16_f32 v112, v184, v185
v_cvt_pk_bf16_f32 v113, v186, v187
v_mfma_f32_16x16x32_bf16 v[188:191], a[16:19], v[224:227], v[188:191]
v_exp_f32 v229, v229
v_mfma_f32_16x16x32_bf16 v[184:187], a[32:35], v[224:227], 0
v_add_f32 v249, v249, v228
v_sub_f32 v231, v231, v254
v_mfma_f32_16x16x32_bf16 v[184:187], a[36:39], v[196:199], v[184:187]
v_exp_f32 v232, v232
v_mfma_f32_16x16x32_bf16 v[184:187], a[40:43], v[212:215], v[184:187]
s_nop 0
v_cvt_pk_bf16_f32 v115, v190, v191
v_cvt_pk_bf16_f32 v114, v188, v189
v_mfma_f32_16x16x32_bf16 v[184:187], a[44:47], v[204:207], v[184:187]
v_sub_f32 v230, v230, v254
v_add_f32 v249, v249, v229
v_mfma_f32_16x16x32_bf16 v[188:191], a[60:63], v[204:207], 0
v_cvt_pk_bf16_f32 v140, v192, v193
v_mov_b32 v192, v202
v_mfma_f32_16x16x32_bf16 v[188:191], a[56:59], v[212:215], v[188:191]
v_cvt_pk_bf16_f32 v142, v208, v209
v_mov_b32_dpp v209, v201 row_ror:8 row_mask:0xf bank_mask:0xf
v_mfma_f32_16x16x32_bf16 v[188:191], a[52:55], v[196:199], v[188:191]
v_cvt_pk_bf16_f32 v116, v184, v185
v_cvt_pk_bf16_f32 v117, v186, v187
v_mfma_f32_16x16x32_bf16 v[188:191], a[48:51], v[224:227], v[188:191]
v_mov_b32_dpp v208, v200 row_ror:8 row_mask:0xf bank_mask:0xf
v_cvt_pk_bf16_f32 v143, v210, v211
v_mfma_f32_16x16x32_bf16 v[216:219], v[56:59], v[120:123], 0
v_mov_b32_dpp v211, v201 row_ror:4 row_mask:0xf bank_mask:0xf
v_mov_b32_dpp v210, v200 row_ror:4 row_mask:0xf bank_mask:0xf
v_mfma_f32_16x16x32_bf16 v[216:219], v[104:107], v[132:135], v[216:219]
v_cvt_pk_bf16_f32 v141, v194, v195
v_mov_b32_dpp v194, v202 row_ror:12 row_mask:0xf bank_mask:0xf
v_mfma_f32_16x16x32_bf16 v[216:219], v[72:75], v[124:127], v[216:219]
v_cvt_pk_bf16_f32 v118, v188, v189
v_cvt_pk_bf16_f32 v119, v190, v191
v_mfma_f32_16x16x32_bf16 v[216:219], v[88:91], v[128:131], v[216:219]
v_mov_b32_dpp v195, v203 row_ror:12 row_mask:0xf bank_mask:0xf
v_mov_b32 v193, v203
v_mfma_f32_16x16x32_bf16 v[220:223], v[92:95], v[128:131], 0
v_mov_b32_dpp v203, v201 row_ror:12 row_mask:0xf bank_mask:0xf
v_mov_b32_dpp v202, v200 row_ror:12 row_mask:0xf bank_mask:0xf
v_mfma_f32_16x16x32_bf16 v[220:223], v[76:79], v[124:127], v[220:223]
v_exp_f32 v230, v230
v_mfma_f32_16x16x32_bf16 v[220:223], v[106:109], v[132:135], v[220:223]
v_fmac_f32 v154, v218, v251
v_fmac_f32 v152, v216, v251
v_mfma_f32_16x16x32_bf16 v[220:223], v[60:63], v[120:123], v[220:223]
v_fmac_f32 v155, v219, v251
v_fmac_f32 v153, v217, v251
v_mfma_f32_16x16x32_bf16 v[188:191], v[64:67], v[120:123], 0
v_exp_f32 v231, v231
v_mfma_f32_16x16x32_bf16 v[188:191], v[108:111], v[132:135], v[188:191]
v_add_f32 v249, v249, v230
v_add_f32 v249, v249, v231
v_mfma_f32_16x16x32_bf16 v[188:191], v[80:83], v[124:127], v[188:191]
v_cvt_pk_bf16_f32 v146, v228, v229
v_cvt_pk_bf16_f32 v147, v230, v231
v_mfma_f32_16x16x32_bf16 v[188:191], v[96:99], v[128:131], v[188:191]
v_add_f32 v249, v249, v232
v_fmac_f32 v156, v220, v251
v_mfma_f32_16x16x32_bf16 v[184:187], v[100:103], v[128:131], 0
ds_swizzle_b32 v250, v249 offset:0x401F
v_fmac_f32 v158, v222, v251
v_mfma_f32_16x16x32_bf16 v[184:187], v[84:87], v[124:127], v[184:187]
v_fmac_f32 v157, v221, v251
v_fmac_f32 v159, v223, v251
v_mfma_f32_16x16x32_bf16 v[184:187], v[68:71], v[120:123], v[184:187]
v_fmac_f32 v161, v189, v251
v_fmac_f32 v160, v188, v251
v_mfma_f32_16x16x32_bf16 v[184:187], v[110:113], v[132:135], v[184:187]
v_mov_b32_dpp v132, v192 row_ror:8 row_mask:0xf bank_mask:0xf
v_fmac_f32 v163, v191, v251
v_fmac_f32 v162, v190, v251
v_mfma_f32_16x16x32_bf16 v[216:219], v[110:113], v[132:135], 0
v_cvt_pk_bf16_f32 v152, v152, v153
v_cvt_pk_bf16_f32 v153, v154, v155
v_mfma_f32_16x16x32_bf16 v[216:219], v[84:87], v[208:211], v[216:219]
s_nop 0
v_fmac_f32 v167, v187, v251
v_fmac_f32 v164, v184, v251
v_mfma_f32_16x16x32_bf16 v[216:219], v[100:103], v[192:195], v[216:219]
s_waitcnt lgkmcnt(0)
v_fmac_f32 v165, v185, v251
v_fmac_f32 v166, v186, v251
v_mfma_f32_16x16x32_bf16 v[216:219], v[68:71], v[200:203], v[216:219]
v_add_f32 v249, v249, v250
v_pk_max_i16 v153, v153, 0
v_mfma_f32_16x16x32_bf16 v[188:191], v[64:67], v[200:203], 0
ds_bpermute_b32 v250, v247, v249
v_mfma_f32_16x16x32_bf16 v[188:191], v[80:83], v[208:211], v[188:191]
v_cvt_pk_bf16_f32 v160, v160, v161
v_cvt_pk_bf16_f32 v161, v162, v163
v_mfma_f32_16x16x32_bf16 v[188:191], v[96:99], v[192:195], v[188:191]
v_cvt_pk_bf16_f32 v216, v216, v217
v_cvt_pk_bf16_f32 v217, v218, v219
v_mfma_f32_16x16x32_bf16 v[188:191], v[108:111], v[132:135], v[188:191]
ds_write_b64 v246, v[216:217] offset:24
v_mfma_f32_16x16x32_bf16 v[228:231], v[106:109], v[132:135], 0
v_cvt_pk_bf16_f32 v162, v164, v165
v_pk_max_i16 v160, v160, 0
v_mfma_f32_16x16x32_bf16 v[228:231], v[76:79], v[208:211], v[228:231]
v_pk_max_i16 v161, v161, 0
v_cvt_pk_bf16_f32 v163, v166, v167
v_mfma_f32_16x16x32_bf16 v[228:231], v[92:95], v[192:195], v[228:231]
s_waitcnt lgkmcnt(1)
v_cvt_pk_bf16_f32 v188, v188, v189
v_cvt_pk_bf16_f32 v189, v190, v191
v_mfma_f32_16x16x32_bf16 v[228:231], v[60:63], v[200:203], v[228:231]
ds_write_b64 v246, v[188:189] offset:16
v_mfma_f32_16x16x32_bf16 v[184:187], v[56:59], v[200:203], 0
v_pk_max_i16 v163, v163, 0
v_cvt_pk_bf16_f32 v155, v158, v159
v_mfma_f32_16x16x32_bf16 v[184:187], v[72:75], v[208:211], v[184:187]
v_pk_max_i16 v162, v162, 0
v_cvt_pk_bf16_f32 v154, v156, v157
v_mfma_f32_16x16x32_bf16 v[184:187], v[88:91], v[192:195], v[184:187]
v_cvt_pk_bf16_f32 v228, v228, v229
v_cvt_pk_bf16_f32 v229, v230, v231
v_mfma_f32_16x16x32_bf16 v[184:187], v[104:107], v[132:135], v[184:187]
ds_write_b64 v246, v[228:229] offset:8
v_mfma_f32_16x16x32_bf16 v[188:191], v[0:3], v[112:115], 0
v_pk_max_i16 v154, v154, 0
v_pk_max_i16 v152, v152, 0
v_mfma_f32_16x16x32_bf16 v[188:191], v[4:7], v[116:119], v[188:191]
v_pk_max_i16 v155, v155, 0
v_add_f32 v249, v249, v250
v_mfma_f32_16x16x32_bf16 v[192:195], v[12:15], v[116:119], 0
buffer_store_dwordx4 v[152:155], v239, s[20:23], s52 offen offset:0 nt
buffer_store_dwordx4 v[160:163], v239, s[20:23], s52 offen offset:64 nt
v_cvt_pk_bf16_f32 v184, v184, v185
v_cvt_pk_bf16_f32 v185, v186, v187
v_rcp_f32 v252, v249
v_max3_f32 v254, v188, v189, v190
v_cvt_pk_bf16_f32 v148, v232, 0
s_add_u32 s52, s46, 16384
v_mfma_f32_16x16x32_bf16 v[192:195], v[8:11], v[112:115], v[192:195]
ds_write_b64 v246, v[184:185] offset:0
v_mfma_f32_16x16x32_bf16 v[200:203], v[16:19], v[112:115], 0
s_nop 0
v_add_u32 v246, 0x200, v246
s_nop 0
v_mfma_f32_16x16x32_bf16 v[200:203], v[20:23], v[116:119], v[200:203]
s_nop 1
v_max3_f32 v254, v254, v191, v192
v_mfma_f32_16x16x32_bf16 v[184:187], v[28:31], v[116:119], 0
v_max3_f32 v254, v254, v193, v194
s_nop 0
v_mfma_f32_16x16x32_bf16 v[184:187], v[24:27], v[112:115], v[184:187]
s_nop 0
v_max3_f32 v254, v254, v195, v200
v_max3_f32 v254, v254, v201, v202
v_mfma_f32_16x16x32_bf16 v[208:211], v[32:35], v[112:115], 0
s_nop 2
v_mfma_f32_16x16x32_bf16 v[208:211], v[36:39], v[116:119], v[208:211]
v_max3_f32 v254, v254, v203, v184
v_max3_f32 v254, v254, v185, v186
v_mfma_f32_16x16x32_bf16 v[216:219], v[44:47], v[116:119], 0
s_nop 2
v_mfma_f32_16x16x32_bf16 v[216:219], v[40:43], v[112:115], v[216:219]
s_nop 0
v_max3_f32 v254, v254, v187, v208
v_max3_f32 v254, v254, v209, v210
v_mfma_f32_16x16x32_bf16 v[220:223], v[48:51], v[112:115], 0
s_nop 2
v_mfma_f32_16x16x32_bf16 v[220:223], v[52:55], v[116:119], v[220:223]
v_max3_f32 v254, v254, v211, v216
v_max3_f32 v254, v254, v217, v218
v_mfma_f32_16x16x32_bf16 v[152:155], a[192:195], v[224:227], 0
s_nop 2
v_mfma_f32_16x16x32_bf16 v[152:155], a[196:199], v[196:199], v[152:155]
s_nop 0
v_max3_f32 v254, v254, v219, v220
v_mfma_f32_16x16x32_bf16 v[152:155], a[200:203], v[212:215], v[152:155]
ds_swizzle_b32 v255, v254 offset:0x401F
v_mfma_f32_16x16x32_bf16 v[152:155], a[204:207], v[204:207], v[152:155]
v_mfma_f32_16x16x32_bf16 v[156:159], a[220:223], v[204:207], 0
v_mfma_f32_16x16x32_bf16 v[156:159], a[216:219], v[212:215], v[156:159]
v_mfma_f32_16x16x32_bf16 v[156:159], a[212:215], v[196:199], v[156:159]
v_mfma_f32_16x16x32_bf16 v[156:159], a[208:211], v[224:227], v[156:159]
v_mfma_f32_16x16x32_bf16 v[160:163], a[224:227], v[224:227], 0
s_waitcnt lgkmcnt(0)
v_max_f32 v254, v254, v255
v_mfma_f32_16x16x32_bf16 v[160:163], a[228:231], v[196:199], v[160:163]
ds_bpermute_b32 v255, v247, v254
v_mfma_f32_16x16x32_bf16 v[160:163], a[232:235], v[212:215], v[160:163]
v_mfma_f32_16x16x32_bf16 v[160:163], a[236:239], v[204:207], v[160:163]
v_mfma_f32_16x16x32_bf16 v[164:167], a[252:255], v[204:207], 0
v_mfma_f32_16x16x32_bf16 v[164:167], a[248:251], v[212:215], v[164:167]
v_mfma_f32_16x16x32_bf16 v[164:167], a[244:247], v[196:199], v[164:167]
v_mfma_f32_16x16x32_bf16 v[164:167], a[240:243], v[224:227], v[164:167]
s_waitcnt lgkmcnt(0)
v_max_f32 v254, v254, v255
v_sub_f32 v188, v188, v254
v_mfma_f32_16x16x32_bf16 v[196:199], v[56:59], v[136:139], 0
v_sub_f32 v190, v190, v254
v_sub_f32 v189, v189, v254
v_mfma_f32_16x16x32_bf16 v[196:199], v[104:107], v[148:151], v[196:199]
v_exp_f32 v189, v189
v_mfma_f32_16x16x32_bf16 v[196:199], v[72:75], v[140:143], v[196:199]
v_exp_f32 v188, v188
v_mfma_f32_16x16x32_bf16 v[196:199], v[88:91], v[144:147], v[196:199]
v_add_f32 v248, v188, v189
v_sub_f32 v191, v191, v254
v_mfma_f32_16x16x32_bf16 v[204:207], v[92:95], v[144:147], 0
v_exp_f32 v191, v191
v_mfma_f32_16x16x32_bf16 v[204:207], v[76:79], v[140:143], v[204:207]
v_exp_f32 v190, v190
v_mfma_f32_16x16x32_bf16 v[204:207], v[106:109], v[148:151], v[204:207]
v_cvt_pk_bf16_f32 v120, v188, v189
v_add_f32 v248, v248, v190
v_mfma_f32_16x16x32_bf16 v[204:207], v[60:63], v[136:139], v[204:207]
ds_read_b128 v[212:215], v236 offset:4224
v_add_f32 v248, v248, v191
v_mfma_f32_16x16x32_bf16 v[228:231], v[64:67], v[136:139], 0
ds_read_b128 v[224:227], v236 offset:4480
v_cvt_pk_bf16_f32 v121, v190, v191
v_mfma_f32_16x16x32_bf16 v[228:231], v[108:111], v[148:151], v[228:231]
v_fmac_f32 v170, v198, v252
v_fmac_f32 v171, v199, v252
v_mfma_f32_16x16x32_bf16 v[228:231], v[80:83], v[140:143], v[228:231]
v_fmac_f32 v168, v196, v252
v_fmac_f32 v169, v197, v252
v_mfma_f32_16x16x32_bf16 v[228:231], v[96:99], v[144:147], v[228:231]
ds_read_b128 v[196:199], v236 offset:4736
v_fmac_f32 v175, v207, v252
v_mfma_f32_16x16x32_bf16 v[232:235], v[100:103], v[144:147], 0
v_fmac_f32 v172, v204, v252
v_fmac_f32 v174, v206, v252
v_mfma_f32_16x16x32_bf16 v[232:235], v[84:87], v[140:143], v[232:235]
s_waitcnt lgkmcnt(2)
v_fmac_f32 v173, v205, v252
v_fmac_f32 v177, v229, v252
v_mfma_f32_16x16x32_bf16 v[232:235], v[110:113], v[148:151], v[232:235]
s_waitcnt lgkmcnt(1)
ds_read_b128 v[204:207], v236 offset:4992
v_fmac_f32 v176, v228, v252
v_mfma_f32_16x16x32_bf16 v[232:235], v[68:71], v[136:139], v[232:235]
v_fmac_f32 v178, v230, v252
v_fmac_f32 v179, v231, v252
v_mfma_f32_16x16x32_bf16 v[188:191], a[0:3], v[212:215], 0
v_cvt_pk_bf16_f32 v176, v176, v177
v_cvt_pk_bf16_f32 v168, v168, v169
v_mfma_f32_16x16x32_bf16 v[188:191], a[4:7], v[224:227], v[188:191]
s_waitcnt lgkmcnt(1)
v_cvt_pk_bf16_f32 v169, v170, v171
v_fmac_f32 v181, v233, v252
v_mfma_f32_16x16x32_bf16 v[188:191], a[8:11], v[196:199], v[188:191]
v_fmac_f32 v182, v234, v252
v_fmac_f32 v180, v232, v252
v_fmac_f32 v183, v235, v252
v_cvt_pk_bf16_f32 v170, v172, v173
v_pk_max_i16 v170, v170, 0
s_waitcnt lgkmcnt(0)
v_mfma_f32_16x16x32_bf16 v[188:191], a[12:15], v[204:207], v[188:191]
v_cvt_pk_bf16_f32 v171, v174, v175
v_pk_max_i16 v176, v176, 0
v_mfma_f32_16x16x32_bf16 v[232:235], a[28:31], v[204:207], 0
v_pk_max_i16 v171, v171, 0
v_cvt_pk_bf16_f32 v177, v178, v179
v_mfma_f32_16x16x32_bf16 v[232:235], a[24:27], v[196:199], v[232:235]
v_cvt_pk_bf16_f32 v178, v180, v181
v_pk_max_i16 v177, v177, 0
v_mfma_f32_16x16x32_bf16 v[232:235], a[20:23], v[224:227], v[232:235]
v_cvt_pk_bf16_f32 v112, v188, v189
v_cvt_pk_bf16_f32 v113, v190, v191
v_mfma_f32_16x16x32_bf16 v[232:235], a[16:19], v[212:215], v[232:235]
v_pk_max_i16 v168, v168, 0
v_cvt_pk_bf16_f32 v179, v182, v183
v_mfma_f32_16x16x32_bf16 v[188:191], a[32:35], v[212:215], 0
v_pk_max_i16 v179, v179, 0
v_pk_max_i16 v169, v169, 0
v_mfma_f32_16x16x32_bf16 v[188:191], a[36:39], v[224:227], v[188:191]
v_pk_max_i16 v178, v178, 0
v_sub_f32 v192, v192, v254
v_mfma_f32_16x16x32_bf16 v[188:191], a[40:43], v[196:199], v[188:191]
buffer_store_dwordx4 v[168:171], v239, s[20:23], s53 offen offset:0 nt
buffer_store_dwordx4 v[176:179], v239, s[20:23], s53 offen offset:64 nt
v_sub_f32 v193, v193, v254
v_exp_f32 v192, v192
v_exp_f32 v193, v193
v_sub_f32 v195, v195, v254
v_exp_f32 v195, v195
v_mfma_f32_16x16x32_bf16 v[188:191], a[44:47], v[204:207], v[188:191]
s_add_u32 s53, s46, 4096
v_add_f32 v248, v248, v192
v_sub_f32 v194, v194, v254
v_mfma_f32_16x16x32_bf16 v[228:231], a[60:63], v[204:207], 0
s_add_u32 s46, s46, 13107200
v_cvt_pk_bf16_f32 v114, v232, v233
v_cvt_pk_bf16_f32 v115, v234, v235
v_mfma_f32_16x16x32_bf16 v[228:231], a[56:59], v[196:199], v[228:231]
v_cvt_pk_bf16_f32 v117, v190, v191
v_cvt_pk_bf16_f32 v116, v188, v189
v_mfma_f32_16x16x32_bf16 v[228:231], a[52:55], v[224:227], v[228:231]
v_exp_f32 v194, v194
v_mfma_f32_16x16x32_bf16 v[228:231], a[48:51], v[212:215], v[228:231]
v_add_f32 v248, v248, v193
v_add_f32 v248, v248, v194
v_mfma_f32_16x16x32_bf16 v[168:171], a[192:195], v[212:215], 0
v_add_f32 v248, v248, v195
v_cvt_pk_bf16_f32 v122, v192, v193
v_mfma_f32_16x16x32_bf16 v[168:171], a[196:199], v[224:227], v[168:171]
v_cvt_pk_bf16_f32 v123, v194, v195
v_sub_f32 v201, v201, v254
v_mfma_f32_16x16x32_bf16 v[168:171], a[200:203], v[196:199], v[168:171]
v_cvt_pk_bf16_f32 v119, v230, v231
v_cvt_pk_bf16_f32 v118, v228, v229
v_mfma_f32_16x16x32_bf16 v[168:171], a[204:207], v[204:207], v[168:171]
v_sub_f32 v202, v202, v254
v_sub_f32 v200, v200, v254
v_mfma_f32_16x16x32_bf16 v[172:175], a[220:223], v[204:207], 0
v_exp_f32 v200, v200
v_mfma_f32_16x16x32_bf16 v[172:175], a[216:219], v[196:199], v[172:175]
v_exp_f32 v202, v202
v_mfma_f32_16x16x32_bf16 v[172:175], a[212:215], v[224:227], v[172:175]
v_exp_f32 v201, v201
v_mfma_f32_16x16x32_bf16 v[172:175], a[208:211], v[212:215], v[172:175]
v_sub_f32 v203, v203, v254
v_add_f32 v248, v248, v200
v_mfma_f32_16x16x32_bf16 v[176:179], a[224:227], v[212:215], 0
v_exp_f32 v203, v203
v_mfma_f32_16x16x32_bf16 v[176:179], a[228:231], v[224:227], v[176:179]
v_cvt_pk_bf16_f32 v125, v202, v203
v_add_f32 v248, v248, v201
v_mfma_f32_16x16x32_bf16 v[176:179], a[232:235], v[196:199], v[176:179]
v_add_f32 v248, v248, v202
v_cvt_pk_bf16_f32 v124, v200, v201
v_mfma_f32_16x16x32_bf16 v[176:179], a[236:239], v[204:207], v[176:179]
v_add_f32 v248, v248, v203
v_sub_f32 v184, v184, v254
v_mfma_f32_16x16x32_bf16 v[180:183], a[252:255], v[204:207], 0
v_sub_f32 v185, v185, v254
v_sub_f32 v187, v187, v254
v_mfma_f32_16x16x32_bf16 v[180:183], a[248:251], v[196:199], v[180:183]
v_sub_f32 v186, v186, v254
v_sub_f32 v220, v220, v254
v_mfma_f32_16x16x32_bf16 v[180:183], a[244:247], v[224:227], v[180:183]
v_exp_f32 v184, v184
v_mfma_f32_16x16x32_bf16 v[180:183], a[240:243], v[212:215], v[180:183]
v_add_f32 v248, v248, v184
v_sub_f32 v216, v216, v254
v_mfma_f32_16x16x32_bf16 v[188:191], v[0:3], v[112:115], 0
v_exp_f32 v187, v187
v_mfma_f32_16x16x32_bf16 v[188:191], v[4:7], v[116:119], v[188:191]
v_exp_f32 v186, v186
v_mfma_f32_16x16x32_bf16 v[192:195], v[12:15], v[116:119], 0
v_exp_f32 v185, v185
v_mfma_f32_16x16x32_bf16 v[192:195], v[8:11], v[112:115], v[192:195]
v_add_f32 v248, v248, v185
v_add_f32 v248, v248, v186
v_mfma_f32_16x16x32_bf16 v[196:199], v[16:19], v[112:115], 0
v_add_f32 v248, v248, v187
v_cvt_pk_bf16_f32 v127, v186, v187
v_mfma_f32_16x16x32_bf16 v[196:199], v[20:23], v[116:119], v[196:199]
v_cvt_pk_bf16_f32 v126, v184, v185
v_sub_f32 v218, v218, v254
v_mfma_f32_16x16x32_bf16 v[200:203], v[28:31], v[116:119], 0
v_exp_f32 v220, v220
v_mfma_f32_16x16x32_bf16 v[200:203], v[24:27], v[112:115], v[200:203]
v_cvt_pk_bf16_f32 v132, v220, 0
v_sub_f32 v217, v217, v254
v_mfma_f32_16x16x32_bf16 v[204:207], v[32:35], v[112:115], 0
v_sub_f32 v211, v211, v254
v_sub_f32 v210, v210, v254
v_mfma_f32_16x16x32_bf16 v[204:207], v[36:39], v[116:119], v[204:207]
v_sub_f32 v219, v219, v254
v_sub_f32 v208, v208, v254
v_mfma_f32_16x16x32_bf16 v[212:215], v[44:47], v[116:119], 0
v_sub_f32 v209, v209, v254
v_max3_f32 v254, v188, v189, v190
v_mfma_f32_16x16x32_bf16 v[212:215], v[40:43], v[112:115], v[212:215]
v_exp_f32 v209, v209
v_mfma_f32_16x16x32_bf16 v[224:227], v[48:51], v[112:115], 0
v_exp_f32 v208, v208
v_mfma_f32_16x16x32_bf16 v[224:227], v[52:55], v[116:119], v[224:227]
v_exp_f32 v217, v217
v_mfma_f32_16x16x32_bf16 v[184:187], v[56:59], v[120:123], 0
v_exp_f32 v210, v210
v_mfma_f32_16x16x32_bf16 v[184:187], v[104:107], v[132:135], v[184:187]
v_exp_f32 v218, v218
v_mfma_f32_16x16x32_bf16 v[184:187], v[72:75], v[124:127], v[184:187]
v_exp_f32 v211, v211
v_exp_f32 v216, v216
v_exp_f32 v219, v219
v_cvt_pk_bf16_f32 v129, v210, v211
v_cvt_pk_bf16_f32 v131, v218, v219
v_cvt_pk_bf16_f32 v130, v216, v217
v_cvt_pk_bf16_f32 v128, v208, v209
v_add_f32 v248, v248, v208
v_add_f32 v248, v248, v209
v_mfma_f32_16x16x32_bf16 v[184:187], v[88:91], v[128:131], v[184:187]
v_add_f32 v248, v248, v210
v_add_f32 v248, v248, v211
v_mfma_f32_16x16x32_bf16 v[208:211], v[92:95], v[128:131], 0
v_max3_f32 v254, v254, v191, v192
v_max3_f32 v254, v254, v193, v194
v_mfma_f32_16x16x32_bf16 v[208:211], v[76:79], v[124:127], v[208:211]
v_max3_f32 v254, v254, v195, v196
v_max3_f32 v254, v254, v197, v198
v_mfma_f32_16x16x32_bf16 v[208:211], v[106:109], v[132:135], v[208:211]
v_max3_f32 v254, v254, v199, v200
v_max3_f32 v254, v254, v201, v202
v_mfma_f32_16x16x32_bf16 v[208:211], v[60:63], v[120:123], v[208:211]
v_max3_f32 v254, v254, v203, v204
v_max3_f32 v254, v254, v205, v206
v_mfma_f32_16x16x32_bf16 v[228:231], v[64:67], v[120:123], 0
v_max3_f32 v254, v254, v207, v212
v_max3_f32 v254, v254, v213, v214
v_mfma_f32_16x16x32_bf16 v[228:231], v[108:111], v[132:135], v[228:231]
v_max3_f32 v254, v254, v215, v224
v_add_f32 v248, v248, v216
v_mfma_f32_16x16x32_bf16 v[228:231], v[80:83], v[124:127], v[228:231]
ds_swizzle_b32 v255, v254 offset:0x401F
v_add_f32 v248, v248, v217
v_mfma_f32_16x16x32_bf16 v[228:231], v[96:99], v[128:131], v[228:231]
v_add_f32 v248, v248, v218
v_add_f32 v248, v248, v219
v_mfma_f32_16x16x32_bf16 v[232:235], v[100:103], v[128:131], 0
ds_read_b128 v[216:219], v236 offset:8448
v_add_f32 v248, v248, v220
v_mfma_f32_16x16x32_bf16 v[232:235], v[84:87], v[124:127], v[232:235]
ds_read_b128 v[220:223], v236 offset:8704
ds_swizzle_b32 v250, v248 offset:0x401F
v_mfma_f32_16x16x32_bf16 v[232:235], v[110:113], v[132:135], v[232:235]
v_mfma_f32_16x16x32_bf16 v[232:235], v[68:71], v[120:123], v[232:235]
s_waitcnt lgkmcnt(3)
v_max_f32 v254, v254, v255
ds_bpermute_b32 v255, v247, v254
s_waitcnt lgkmcnt(1)
v_add_f32 v248, v248, v250
ds_bpermute_b32 v250, v247, v248
s_waitcnt lgkmcnt(1)
v_max_f32 v254, v254, v255
v_sub_f32 v188, v188, v254
v_exp_f32 v188, v188
v_sub_f32 v189, v189, v254
v_sub_f32 v190, v190, v254
v_sub_f32 v191, v191, v254
v_exp_f32 v189, v189
v_exp_f32 v191, v191
v_exp_f32 v190, v190
v_add_f32 v249, v188, v189
v_add_f32 v249, v249, v190
v_add_f32 v249, v249, v191
v_cvt_pk_bf16_f32 v137, v190, v191
v_cvt_pk_bf16_f32 v136, v188, v189
v_mfma_f32_16x16x32_bf16 v[188:191], a[0:3], v[216:219], 0
s_waitcnt lgkmcnt(0)
v_sub_f32 v192, v192, v254
v_sub_f32 v195, v195, v254
v_mfma_f32_16x16x32_bf16 v[188:191], a[4:7], v[220:223], v[188:191]
v_exp_f32 v192, v192
v_sub_f32 v193, v193, v254
v_sub_f32 v194, v194, v254
v_exp_f32 v195, v195
v_exp_f32 v193, v193
v_exp_f32 v194, v194
v_add_f32 v249, v249, v192
v_add_f32 v249, v249, v193
v_add_f32 v249, v249, v194
v_add_f32 v249, v249, v195
v_cvt_pk_bf16_f32 v139, v194, v195
v_cvt_pk_bf16_f32 v138, v192, v193
ds_read_b128 v[192:195], v236 offset:8960
v_sub_f32 v198, v198, v254
v_sub_f32 v197, v197, v254
v_sub_f32 v196, v196, v254
v_exp_f32 v196, v196
v_exp_f32 v198, v198
v_sub_f32 v202, v202, v254
v_sub_f32 v200, v200, v254
v_exp_f32 v197, v197
v_sub_f32 v201, v201, v254
v_sub_f32 v199, v199, v254
v_exp_f32 v199, v199
v_exp_f32 v200, v200
v_add_f32 v249, v249, v196
v_add_f32 v249, v249, v197
v_add_f32 v249, v249, v198
s_waitcnt lgkmcnt(0)
v_mfma_f32_16x16x32_bf16 v[188:191], a[8:11], v[192:195], v[188:191]
v_sub_f32 v203, v203, v254
v_add_f32 v249, v249, v199
v_add_f32 v249, v249, v200
v_exp_f32 v201, v201
v_exp_f32 v202, v202
v_exp_f32 v203, v203
v_sub_f32 v204, v204, v254
v_exp_f32 v204, v204
v_add_f32 v249, v249, v201
v_add_f32 v249, v249, v202
v_add_f32 v249, v249, v203
v_sub_f32 v205, v205, v254
v_sub_f32 v206, v206, v254
v_exp_f32 v205, v205
v_exp_f32 v206, v206
v_add_f32 v249, v249, v204
v_add_f32 v249, v249, v205
v_sub_f32 v207, v207, v254
v_exp_f32 v207, v207
v_add_f32 v249, v249, v206
v_add_f32 v249, v249, v207
v_cvt_pk_bf16_f32 v145, v206, v207
v_cvt_pk_bf16_f32 v144, v204, v205
ds_read_b128 v[204:207], v236 offset:9216
v_add_f32 v248, v248, v250
v_rcp_f32 v251, v248
v_sub_f32 v212, v212, v254
v_fmac_f32 v152, v184, v251
v_fmac_f32 v153, v185, v251
v_fmac_f32 v155, v187, v251
v_fmac_f32 v154, v186, v251
v_fmac_f32 v157, v209, v251
v_fmac_f32 v159, v211, v251
v_fmac_f32 v158, v210, v251
v_fmac_f32 v156, v208, v251
v_exp_f32 v212, v212
v_sub_f32 v213, v213, v254
v_exp_f32 v213, v213
v_sub_f32 v214, v214, v254
v_exp_f32 v214, v214
s_waitcnt lgkmcnt(0)
v_mfma_f32_16x16x32_bf16 v[188:191], a[12:15], v[204:207], v[188:191]
v_sub_f32 v215, v215, v254
v_add_f32 v249, v249, v212
v_mfma_f32_16x16x32_bf16 v[184:187], a[28:31], v[204:207], 0
v_exp_f32 v215, v215
v_mfma_f32_16x16x32_bf16 v[184:187], a[24:27], v[192:195], v[184:187]
v_add_f32 v249, v249, v213
v_add_f32 v249, v249, v214
v_mfma_f32_16x16x32_bf16 v[184:187], a[20:23], v[220:223], v[184:187]
v_add_f32 v249, v249, v215
v_cvt_pk_bf16_f32 v147, v214, v215
v_mfma_f32_16x16x32_bf16 v[184:187], a[16:19], v[216:219], v[184:187]
v_cvt_pk_bf16_f32 v146, v212, v213
v_fmac_f32 v163, v231, v251
v_mfma_f32_16x16x32_bf16 v[208:211], a[32:35], v[216:219], 0
v_fmac_f32 v161, v229, v251
v_cvt_pk_bf16_f32 v152, v152, v153
v_mfma_f32_16x16x32_bf16 v[208:211], a[36:39], v[220:223], v[208:211]
v_fmac_f32 v167, v235, v251
v_fmac_f32 v160, v228, v251
v_mfma_f32_16x16x32_bf16 v[208:211], a[40:43], v[192:195], v[208:211]
v_fmac_f32 v164, v232, v251
v_cvt_pk_bf16_f32 v160, v160, v161
v_mfma_f32_16x16x32_bf16 v[208:211], a[44:47], v[204:207], v[208:211]
v_cvt_pk_bf16_f32 v153, v154, v155
v_cvt_pk_bf16_f32 v154, v156, v157
v_mfma_f32_16x16x32_bf16 v[212:215], a[60:63], v[204:207], 0
v_fmac_f32 v166, v234, v251
v_fmac_f32 v162, v230, v251
v_mfma_f32_16x16x32_bf16 v[212:215], a[56:59], v[192:195], v[212:215]
v_fmac_f32 v165, v233, v251
v_cvt_pk_bf16_f32 v155, v158, v159
v_mfma_f32_16x16x32_bf16 v[212:215], a[52:55], v[220:223], v[212:215]
v_cvt_pk_bf16_f32 v161, v162, v163
v_cvt_pk_bf16_f32 v162, v164, v165
v_mfma_f32_16x16x32_bf16 v[212:215], a[48:51], v[216:219], v[212:215]
v_cvt_pk_bf16_f32 v163, v166, v167
v_pk_max_i16 v162, v162, 0
v_pk_max_i16 v161, v161, 0
v_pk_max_i16 v163, v163, 0
v_pk_max_i16 v153, v153, 0
v_pk_max_i16 v155, v155, 0
v_pk_max_i16 v152, v152, 0
v_pk_max_i16 v160, v160, 0
v_pk_max_i16 v154, v154, 0
buffer_store_dwordx4 v[152:155], v239, s[20:23], s52 offen offset:0 nt
buffer_store_dwordx4 v[160:163], v239, s[20:23], s52 offen offset:64 nt
v_cvt_pk_bf16_f32 v112, v188, v189
v_cvt_pk_bf16_f32 v113, v190, v191
v_cvt_pk_bf16_f32 v114, v184, v185
v_cvt_pk_bf16_f32 v115, v186, v187
v_cvt_pk_bf16_f32 v118, v212, v213
v_cvt_pk_bf16_f32 v119, v214, v215
v_cvt_pk_bf16_f32 v116, v208, v209
v_cvt_pk_bf16_f32 v117, v210, v211
v_mfma_f32_16x16x32_bf16 v[152:155], a[192:195], v[216:219], 0
v_sub_f32 v224, v224, v254
v_cvt_pk_bf16_f32 v142, v200, v201
v_mfma_f32_16x16x32_bf16 v[152:155], a[196:199], v[220:223], v[152:155]
v_exp_f32 v224, v224
v_mfma_f32_16x16x32_bf16 v[152:155], a[200:203], v[192:195], v[152:155]
v_cvt_pk_bf16_f32 v141, v198, v199
v_cvt_pk_bf16_f32 v140, v196, v197
v_mfma_f32_16x16x32_bf16 v[152:155], a[204:207], v[204:207], v[152:155]
v_add_f32 v249, v249, v224
v_cvt_pk_bf16_f32 v143, v202, v203
v_mfma_f32_16x16x32_bf16 v[156:159], a[220:223], v[204:207], 0
ds_swizzle_b32 v250, v249 offset:0x401F
v_cvt_pk_bf16_f32 v148, v224, 0
v_mfma_f32_16x16x32_bf16 v[156:159], a[216:219], v[192:195], v[156:159]
v_mfma_f32_16x16x32_bf16 v[156:159], a[212:215], v[220:223], v[156:159]
v_mfma_f32_16x16x32_bf16 v[156:159], a[208:211], v[216:219], v[156:159]
v_mfma_f32_16x16x32_bf16 v[160:163], a[224:227], v[216:219], 0
v_mfma_f32_16x16x32_bf16 v[160:163], a[228:231], v[220:223], v[160:163]
v_mfma_f32_16x16x32_bf16 v[160:163], a[232:235], v[192:195], v[160:163]
s_waitcnt lgkmcnt(0)
v_add_f32 v249, v249, v250
v_mfma_f32_16x16x32_bf16 v[160:163], a[236:239], v[204:207], v[160:163]
ds_bpermute_b32 v250, v247, v249
v_mfma_f32_16x16x32_bf16 v[164:167], a[252:255], v[204:207], 0
v_mfma_f32_16x16x32_bf16 v[164:167], a[248:251], v[192:195], v[164:167]
v_mfma_f32_16x16x32_bf16 v[164:167], a[244:247], v[220:223], v[164:167]
v_mfma_f32_16x16x32_bf16 v[164:167], a[240:243], v[216:219], v[164:167]
v_mfma_f32_16x16x32_bf16 v[184:187], v[0:3], v[112:115], 0
v_mfma_f32_16x16x32_bf16 v[184:187], v[4:7], v[116:119], v[184:187]
s_waitcnt lgkmcnt(0)
v_add_f32 v249, v249, v250
s_nop 0
v_mfma_f32_16x16x32_bf16 v[188:191], v[12:15], v[116:119], 0
v_rcp_f32 v252, v249
v_mfma_f32_16x16x32_bf16 v[188:191], v[8:11], v[112:115], v[188:191]
s_nop 1
v_max3_f32 v254, v184, v185, v186
v_mfma_f32_16x16x32_bf16 v[192:195], v[16:19], v[112:115], 0
s_nop 2
v_mfma_f32_16x16x32_bf16 v[192:195], v[20:23], v[116:119], v[192:195]
v_max3_f32 v254, v254, v187, v188
v_max3_f32 v254, v254, v189, v190
v_mfma_f32_16x16x32_bf16 v[196:199], v[28:31], v[116:119], 0
s_nop 2
v_mfma_f32_16x16x32_bf16 v[196:199], v[24:27], v[112:115], v[196:199]
s_nop 0
v_max3_f32 v254, v254, v191, v192
v_max3_f32 v254, v254, v193, v194
v_mfma_f32_16x16x32_bf16 v[200:203], v[32:35], v[112:115], 0
s_nop 2
v_mfma_f32_16x16x32_bf16 v[200:203], v[36:39], v[116:119], v[200:203]
v_max3_f32 v254, v254, v195, v196
v_max3_f32 v254, v254, v197, v198
v_mfma_f32_16x16x32_bf16 v[204:207], v[44:47], v[116:119], 0
s_nop 2
v_mfma_f32_16x16x32_bf16 v[204:207], v[40:43], v[112:115], v[204:207]
s_nop 0
v_max3_f32 v254, v254, v199, v200
v_max3_f32 v254, v254, v201, v202
v_mfma_f32_16x16x32_bf16 v[208:211], v[48:51], v[112:115], 0
s_nop 2
v_mfma_f32_16x16x32_bf16 v[208:211], v[52:55], v[116:119], v[208:211]
v_max3_f32 v254, v254, v203, v204
v_max3_f32 v254, v254, v205, v206
v_mfma_f32_16x16x32_bf16 v[212:215], v[56:59], v[136:139], 0
s_nop 2
v_mfma_f32_16x16x32_bf16 v[212:215], v[104:107], v[148:151], v[212:215]
s_nop 0
v_max3_f32 v254, v254, v207, v208
v_mfma_f32_16x16x32_bf16 v[212:215], v[72:75], v[140:143], v[212:215]
ds_swizzle_b32 v255, v254 offset:0x401F
v_mfma_f32_16x16x32_bf16 v[212:215], v[88:91], v[144:147], v[212:215]
s_nop 2
v_mfma_f32_16x16x32_bf16 v[216:219], v[92:95], v[144:147], 0
s_nop 2
v_mfma_f32_16x16x32_bf16 v[216:219], v[76:79], v[140:143], v[216:219]
v_fmac_f32 v169, v213, v252
v_fmac_f32 v168, v212, v252
v_mfma_f32_16x16x32_bf16 v[216:219], v[106:109], v[148:151], v[216:219]
v_fmac_f32 v171, v215, v252
v_fmac_f32 v170, v214, v252
v_mfma_f32_16x16x32_bf16 v[216:219], v[60:63], v[136:139], v[216:219]
ds_read_b128 v[220:223], v236 offset:12672
ds_read_b128 v[224:227], v236 offset:12928
v_mfma_f32_16x16x32_bf16 v[228:231], v[64:67], v[136:139], 0
s_waitcnt lgkmcnt(2)
ds_read_b128 v[212:215], v236 offset:13184
v_cvt_pk_bf16_f32 v168, v168, v169
v_mfma_f32_16x16x32_bf16 v[228:231], v[108:111], v[148:151], v[228:231]
s_nop 0
v_fmac_f32 v172, v216, v252
v_fmac_f32 v174, v218, v252
v_mfma_f32_16x16x32_bf16 v[228:231], v[80:83], v[140:143], v[228:231]
v_fmac_f32 v173, v217, v252
v_fmac_f32 v175, v219, v252
v_mfma_f32_16x16x32_bf16 v[228:231], v[96:99], v[144:147], v[228:231]
ds_read_b128 v[216:219], v236 offset:13440
v_cvt_pk_bf16_f32 v169, v170, v171
v_mfma_f32_16x16x32_bf16 v[232:235], v[100:103], v[144:147], 0
v_cvt_pk_bf16_f32 v170, v172, v173
v_cvt_pk_bf16_f32 v171, v174, v175
v_mfma_f32_16x16x32_bf16 v[232:235], v[84:87], v[140:143], v[232:235]
s_waitcnt lgkmcnt(2)
v_pk_max_i16 v170, v170, 0
v_fmac_f32 v178, v230, v252
v_mfma_f32_16x16x32_bf16 v[232:235], v[110:113], v[148:151], v[232:235]
s_waitcnt lgkmcnt(1)
v_fmac_f32 v179, v231, v252
v_fmac_f32 v176, v228, v252
v_mfma_f32_16x16x32_bf16 v[232:235], v[68:71], v[136:139], v[232:235]
v_fmac_f32 v177, v229, v252
v_cvt_pk_bf16_f32 v176, v176, v177
v_mfma_f32_16x16x32_bf16 v[228:231], a[0:3], v[220:223], 0
v_cvt_pk_bf16_f32 v177, v178, v179
v_pk_max_i16 v169, v169, 0
v_mfma_f32_16x16x32_bf16 v[228:231], a[4:7], v[224:227], v[228:231]
s_waitcnt lgkmcnt(0)
v_pk_max_i16 v171, v171, 0
v_fmac_f32 v182, v234, v252
v_mfma_f32_16x16x32_bf16 v[228:231], a[8:11], v[212:215], v[228:231]
v_fmac_f32 v181, v233, v252
v_fmac_f32 v183, v235, v252
v_mfma_f32_16x16x32_bf16 v[228:231], a[12:15], v[216:219], v[228:231]
v_fmac_f32 v180, v232, v252
v_cvt_pk_bf16_f32 v179, v182, v183
v_mfma_f32_16x16x32_bf16 v[232:235], a[28:31], v[216:219], 0
v_cvt_pk_bf16_f32 v178, v180, v181
v_pk_max_i16 v178, v178, 0
v_mfma_f32_16x16x32_bf16 v[232:235], a[24:27], v[212:215], v[232:235]
v_pk_max_i16 v179, v179, 0
v_pk_max_i16 v176, v176, 0
v_mfma_f32_16x16x32_bf16 v[232:235], a[20:23], v[224:227], v[232:235]
v_cvt_pk_bf16_f32 v113, v230, v231
v_cvt_pk_bf16_f32 v112, v228, v229
v_mfma_f32_16x16x32_bf16 v[232:235], a[16:19], v[220:223], v[232:235]
v_pk_max_i16 v168, v168, 0
v_pk_max_i16 v177, v177, 0
v_mfma_f32_16x16x32_bf16 v[228:231], a[32:35], v[220:223], 0
buffer_store_dwordx4 v[168:171], v239, s[20:23], s53 offen offset:0 nt
buffer_store_dwordx4 v[176:179], v239, s[20:23], s53 offen offset:64 nt
v_add_u32 v236, s56, v236
v_max_f32 v254, v254, v255
s_sub_u32 s56, 0, s56
v_cvt_pk_bf16_f32 v115, v234, v235
v_cvt_pk_bf16_f32 v114, v232, v233
v_mfma_f32_16x16x32_bf16 v[228:231], a[36:39], v[224:227], v[228:231]
ds_bpermute_b32 v255, v247, v254
v_mfma_f32_16x16x32_bf16 v[228:231], a[40:43], v[212:215], v[228:231]
v_mfma_f32_16x16x32_bf16 v[228:231], a[44:47], v[216:219], v[228:231]
s_nop 2
v_mfma_f32_16x16x32_bf16 v[232:235], a[60:63], v[216:219], 0
s_nop 2
v_mfma_f32_16x16x32_bf16 v[232:235], a[56:59], v[212:215], v[232:235]
v_cvt_pk_bf16_f32 v116, v228, v229
v_cvt_pk_bf16_f32 v117, v230, v231
v_mfma_f32_16x16x32_bf16 v[232:235], a[52:55], v[224:227], v[232:235]
v_mfma_f32_16x16x32_bf16 v[232:235], a[48:51], v[220:223], v[232:235]
s_waitcnt lgkmcnt(0)
v_max_f32 v254, v254, v255
v_sub_f32 v184, v184, v254
v_mfma_f32_16x16x32_bf16 v[168:171], a[192:195], v[220:223], 0
v_exp_f32 v184, v184
v_mfma_f32_16x16x32_bf16 v[168:171], a[196:199], v[224:227], v[168:171]
v_sub_f32 v185, v185, v254
v_sub_f32 v186, v186, v254
v_mfma_f32_16x16x32_bf16 v[168:171], a[200:203], v[212:215], v[168:171]
v_cvt_pk_bf16_f32 v119, v234, v235
v_cvt_pk_bf16_f32 v118, v232, v233
v_mfma_f32_16x16x32_bf16 v[168:171], a[204:207], v[216:219], v[168:171]
v_exp_f32 v186, v186
v_mfma_f32_16x16x32_bf16 v[172:175], a[220:223], v[216:219], 0
v_exp_f32 v185, v185
v_mfma_f32_16x16x32_bf16 v[172:175], a[216:219], v[212:215], v[172:175]
v_sub_f32 v189, v189, v254
v_sub_f32 v187, v187, v254
v_mfma_f32_16x16x32_bf16 v[172:175], a[212:215], v[224:227], v[172:175]
v_sub_f32 v188, v188, v254
v_sub_f32 v190, v190, v254
v_mfma_f32_16x16x32_bf16 v[172:175], a[208:211], v[220:223], v[172:175]
s_cmp_lg_u32 s45, 0
s_cbranch_scc1 L_loops
v_mfma_f32_16x16x32_bf16 v[176:179], a[224:227], v[220:223], 0
s_waitcnt vmcnt(8)
s_barrier
v_mfma_f32_16x16x32_bf16 v[176:179], a[228:231], v[224:227], v[176:179]
s_add_u32 s52, s47, 8192
ds_read_b128 v[232:235], v236 offset:0
v_add_f32 v248, v184, v185
v_mfma_f32_16x16x32_bf16 v[176:179], a[232:235], v[212:215], v[176:179]
s_add_u32 s53, s47, 12288
v_exp_f32 v188, v188
v_mfma_f32_16x16x32_bf16 v[176:179], a[236:239], v[216:219], v[176:179]
v_add_f32 v248, v248, v186
v_sub_f32 v191, v191, v254
v_mfma_f32_16x16x32_bf16 v[180:183], a[252:255], v[216:219], 0
v_exp_f32 v187, v187
v_mfma_f32_16x16x32_bf16 v[180:183], a[248:251], v[212:215], v[180:183]
v_exp_f32 v190, v190
v_mfma_f32_16x16x32_bf16 v[180:183], a[244:247], v[224:227], v[180:183]
v_add_f32 v248, v248, v187
v_add_f32 v248, v248, v188
v_mfma_f32_16x16x32_bf16 v[180:183], a[240:243], v[220:223], v[180:183]
s_waitcnt lgkmcnt(0)
v_exp_f32 v189, v189
v_mfma_f32_16x16x32_bf16 v[228:231], v[0:3], v[112:115], 0
v_add_f32 v248, v248, v189
v_add_f32 v248, v248, v190
v_mfma_f32_16x16x32_bf16 v[228:231], v[4:7], v[116:119], v[228:231]
v_exp_f32 v191, v191
v_cvt_pk_bf16_f32 v122, v188, v189
v_add_f32 v248, v248, v191
v_cvt_pk_bf16_f32 v123, v190, v191
v_mfma_f32_16x16x32_bf16 v[188:191], v[12:15], v[116:119], 0
v_sub_f32 v193, v193, v254
v_sub_f32 v194, v194, v254
v_mfma_f32_16x16x32_bf16 v[188:191], v[8:11], v[112:115], v[188:191]
v_sub_f32 v195, v195, v254
v_exp_f32 v194, v194
v_sub_f32 v192, v192, v254
v_exp_f32 v192, v192
v_sub_f32 v196, v196, v254
v_exp_f32 v193, v193
v_sub_f32 v197, v197, v254
v_sub_f32 v199, v199, v254
v_sub_f32 v198, v198, v254
v_exp_f32 v195, v195
v_add_f32 v248, v248, v192
v_add_f32 v248, v248, v193
v_exp_f32 v196, v196
v_exp_f32 v197, v197
v_add_f32 v248, v248, v194
v_add_f32 v248, v248, v195
v_add_f32 v248, v248, v196
v_add_f32 v248, v248, v197
v_exp_f32 v198, v198
v_sub_f32 v200, v200, v254
v_sub_f32 v203, v203, v254
v_exp_f32 v199, v199
v_sub_f32 v201, v201, v254
v_exp_f32 v201, v201
v_sub_f32 v202, v202, v254
v_exp_f32 v202, v202
v_add_f32 v248, v248, v198
v_exp_f32 v200, v200
v_add_f32 v248, v248, v199
v_add_f32 v248, v248, v200
v_add_f32 v248, v248, v201
v_exp_f32 v203, v203
v_add_f32 v248, v248, v202
v_add_f32 v248, v248, v203
v_cvt_pk_bf16_f32 v128, v200, v201
v_cvt_pk_bf16_f32 v129, v202, v203
v_mfma_f32_16x16x32_bf16 v[200:203], v[16:19], v[112:115], 0
v_sub_f32 v204, v204, v254
v_sub_f32 v205, v205, v254
v_mfma_f32_16x16x32_bf16 v[200:203], v[20:23], v[116:119], v[200:203]
v_exp_f32 v204, v204
v_sub_f32 v206, v206, v254
v_add_f32 v248, v248, v204
v_exp_f32 v206, v206
v_sub_f32 v207, v207, v254
v_exp_f32 v205, v205
v_exp_f32 v207, v207
v_add_f32 v248, v248, v205
v_add_f32 v248, v248, v206
v_add_f32 v248, v248, v207
v_cvt_pk_bf16_f32 v130, v204, v205
v_cvt_pk_bf16_f32 v131, v206, v207
v_mfma_f32_16x16x32_bf16 v[204:207], v[28:31], v[116:119], 0
v_sub_f32 v208, v208, v254
v_cvt_pk_bf16_f32 v120, v184, v185
v_mfma_f32_16x16x32_bf16 v[204:207], v[24:27], v[112:115], v[204:207]
v_exp_f32 v208, v208
s_nop 0
v_add_f32 v248, v248, v208
v_cvt_pk_bf16_f32 v132, v208, 0
v_mfma_f32_16x16x32_bf16 v[208:211], v[32:35], v[112:115], 0
ds_swizzle_b32 v250, v248 offset:0x401F
v_cvt_pk_bf16_f32 v121, v186, v187
v_mfma_f32_16x16x32_bf16 v[208:211], v[36:39], v[116:119], v[208:211]
ds_read_b128 v[184:187], v236 offset:256
v_cvt_pk_bf16_f32 v126, v196, v197
v_mfma_f32_16x16x32_bf16 v[212:215], v[44:47], v[116:119], 0
v_cvt_pk_bf16_f32 v125, v194, v195
v_cvt_pk_bf16_f32 v127, v198, v199
v_mfma_f32_16x16x32_bf16 v[212:215], v[40:43], v[112:115], v[212:215]
ds_read_b128 v[196:199], v236 offset:768
v_cvt_pk_bf16_f32 v124, v192, v193
v_mfma_f32_16x16x32_bf16 v[216:219], v[48:51], v[112:115], 0
ds_read_b128 v[192:195], v236 offset:512
v_max3_f32 v254, v228, v229, v230
v_mfma_f32_16x16x32_bf16 v[216:219], v[52:55], v[116:119], v[216:219]
v_max3_f32 v254, v254, v231, v188
v_max3_f32 v254, v254, v189, v190
v_mfma_f32_16x16x32_bf16 v[220:223], v[56:59], v[120:123], 0
s_waitcnt lgkmcnt(3)
v_add_f32 v248, v248, v250
v_max3_f32 v254, v254, v191, v200
v_mfma_f32_16x16x32_bf16 v[220:223], v[104:107], v[132:135], v[220:223]
s_waitcnt lgkmcnt(2)
ds_bpermute_b32 v250, v247, v248
v_mfma_f32_16x16x32_bf16 v[220:223], v[72:75], v[124:127], v[220:223]
v_max3_f32 v254, v254, v201, v202
v_max3_f32 v254, v254, v203, v204
v_mfma_f32_16x16x32_bf16 v[220:223], v[88:91], v[128:131], v[220:223]
s_waitcnt lgkmcnt(2)
v_max3_f32 v254, v254, v205, v206
v_max3_f32 v254, v254, v207, v208
v_mfma_f32_16x16x32_bf16 v[224:227], v[92:95], v[128:131], 0
s_waitcnt lgkmcnt(1)
v_max3_f32 v254, v254, v209, v210
v_max3_f32 v254, v254, v211, v212
v_mfma_f32_16x16x32_bf16 v[224:227], v[76:79], v[124:127], v[224:227]
v_max3_f32 v254, v254, v213, v214
v_max3_f32 v254, v254, v215, v216
v_mfma_f32_16x16x32_bf16 v[224:227], v[106:109], v[132:135], v[224:227]
ds_swizzle_b32 v255, v254 offset:0x401F
v_mbcnt_lo_u32_b32 v242, -1, 0
v_mfma_f32_16x16x32_bf16 v[224:227], v[60:63], v[120:123], v[224:227]
s_waitcnt lgkmcnt(1)
v_add_f32 v248, v248, v250
v_rcp_f32 v251, v248
s_nop 0
v_fmac_f32 v152, v220, v251
v_fmac_f32 v153, v221, v251
v_fmac_f32 v154, v222, v251
v_fmac_f32 v155, v223, v251
v_mfma_f32_16x16x32_bf16 v[220:223], v[64:67], v[120:123], 0
v_fmac_f32 v156, v224, v251
v_fmac_f32 v157, v225, v251
v_mfma_f32_16x16x32_bf16 v[220:223], v[108:111], v[132:135], v[220:223]
v_fmac_f32 v158, v226, v251
v_fmac_f32 v159, v227, v251
v_mfma_f32_16x16x32_bf16 v[220:223], v[80:83], v[124:127], v[220:223]
s_waitcnt lgkmcnt(0)
v_cvt_pk_bf16_f32 v152, v152, v153
v_cvt_pk_bf16_f32 v153, v154, v155
v_mfma_f32_16x16x32_bf16 v[220:223], v[96:99], v[128:131], v[220:223]
v_cvt_pk_bf16_f32 v154, v156, v157
v_cvt_pk_bf16_f32 v155, v158, v159
v_mfma_f32_16x16x32_bf16 v[224:227], v[100:103], v[128:131], 0
v_pk_max_i16 v152, v152, 0
v_pk_max_i16 v153, v153, 0
v_mfma_f32_16x16x32_bf16 v[224:227], v[84:87], v[124:127], v[224:227]
v_max_f32 v254, v254, v255
v_pk_max_i16 v154, v154, 0
v_mfma_f32_16x16x32_bf16 v[224:227], v[110:113], v[132:135], v[224:227]
ds_bpermute_b32 v255, v247, v254
v_mfma_f32_16x16x32_bf16 v[224:227], v[68:71], v[120:123], v[224:227]
v_fmac_f32 v160, v220, v251
v_fmac_f32 v161, v221, v251
v_mfma_f32_16x16x32_bf16 v[0:3], a[192:195], v[232:235], 0
v_fmac_f32 v162, v222, v251
v_fmac_f32 v163, v223, v251
v_mfma_f32_16x16x32_bf16 v[0:3], a[196:199], v[184:187], v[0:3]
v_cvt_pk_bf16_f32 v160, v160, v161
v_cvt_pk_bf16_f32 v161, v162, v163
v_mfma_f32_16x16x32_bf16 v[0:3], a[200:203], v[192:195], v[0:3]
v_fmac_f32 v164, v224, v251
v_fmac_f32 v165, v225, v251
v_mfma_f32_16x16x32_bf16 v[0:3], a[204:207], v[196:199], v[0:3]
v_fmac_f32 v166, v226, v251
v_fmac_f32 v167, v227, v251
v_mfma_f32_16x16x32_bf16 v[4:7], a[220:223], v[196:199], 0
s_waitcnt lgkmcnt(0)
v_max_f32 v254, v254, v255
v_sub_f32 v228, v228, v254
v_mfma_f32_16x16x32_bf16 v[4:7], a[216:219], v[192:195], v[4:7]
v_sub_f32 v229, v229, v254
v_sub_f32 v230, v230, v254
v_mfma_f32_16x16x32_bf16 v[4:7], a[212:215], v[184:187], v[4:7]
v_exp_f32 v228, v228
v_mfma_f32_16x16x32_bf16 v[4:7], a[208:211], v[232:235], v[4:7]
ds_read_b128 v[220:223], v236 offset:4224
v_sub_f32 v231, v231, v254
v_mfma_f32_16x16x32_bf16 v[8:11], a[224:227], v[232:235], 0
v_exp_f32 v229, v229
v_mfma_f32_16x16x32_bf16 v[8:11], a[228:231], v[184:187], v[8:11]
v_exp_f32 v230, v230
v_mfma_f32_16x16x32_bf16 v[8:11], a[232:235], v[192:195], v[8:11]
v_exp_f32 v231, v231
v_mfma_f32_16x16x32_bf16 v[8:11], a[236:239], v[196:199], v[8:11]
v_add_f32 v249, v228, v229
v_add_f32 v249, v249, v230
v_mfma_f32_16x16x32_bf16 v[12:15], a[252:255], v[196:199], 0
ds_read_b128 v[196:199], v236 offset:4736
v_add_f32 v249, v249, v231
v_mfma_f32_16x16x32_bf16 v[12:15], a[248:251], v[192:195], v[12:15]
s_waitcnt lgkmcnt(1)
ds_read_b128 v[192:195], v236 offset:4992
v_cvt_pk_bf16_f32 v136, v228, v229
v_mfma_f32_16x16x32_bf16 v[12:15], a[244:247], v[184:187], v[12:15]
v_cvt_pk_bf16_f32 v137, v230, v231
v_sub_f32 v188, v188, v254
v_mfma_f32_16x16x32_bf16 v[12:15], a[240:243], v[232:235], v[12:15]
ds_read_b128 v[228:231], v236 offset:4480
v_sub_f32 v189, v189, v254
v_mfma_f32_16x16x32_bf16 v[16:19], a[192:195], v[220:223], 0
v_exp_f32 v188, v188
v_exp_f32 v189, v189
v_sub_f32 v190, v190, v254
v_cvt_pk_bf16_f32 v138, v188, v189
v_sub_f32 v191, v191, v254
v_exp_f32 v190, v190
v_exp_f32 v191, v191
v_sub_f32 v216, v216, v254
v_cvt_pk_bf16_f32 v139, v190, v191
v_exp_f32 v216, v216
v_sub_f32 v200, v200, v254
v_cvt_pk_bf16_f32 v148, v216, 0
s_waitcnt lgkmcnt(0)
v_mfma_f32_16x16x32_bf16 v[16:19], a[196:199], v[228:231], v[16:19]
v_sub_f32 v201, v201, v254
v_sub_f32 v202, v202, v254
v_mfma_f32_16x16x32_bf16 v[16:19], a[200:203], v[196:199], v[16:19]
v_exp_f32 v200, v200
v_mfma_f32_16x16x32_bf16 v[16:19], a[204:207], v[192:195], v[16:19]
v_exp_f32 v201, v201
v_mfma_f32_16x16x32_bf16 v[20:23], a[220:223], v[192:195], 0
v_exp_f32 v202, v202
v_mfma_f32_16x16x32_bf16 v[20:23], a[216:219], v[196:199], v[20:23]
v_sub_f32 v203, v203, v254
v_sub_f32 v204, v204, v254
v_mfma_f32_16x16x32_bf16 v[20:23], a[212:215], v[228:231], v[20:23]
v_exp_f32 v203, v203
v_mfma_f32_16x16x32_bf16 v[20:23], a[208:211], v[220:223], v[20:23]
v_exp_f32 v204, v204
v_mfma_f32_16x16x32_bf16 v[24:27], a[224:227], v[220:223], 0
v_sub_f32 v205, v205, v254
v_sub_f32 v206, v206, v254
v_mfma_f32_16x16x32_bf16 v[24:27], a[228:231], v[228:231], v[24:27]
v_exp_f32 v205, v205
v_mfma_f32_16x16x32_bf16 v[24:27], a[232:235], v[196:199], v[24:27]
v_exp_f32 v206, v206
v_mfma_f32_16x16x32_bf16 v[24:27], a[236:239], v[192:195], v[24:27]
v_sub_f32 v207, v207, v254
v_cvt_pk_bf16_f32 v140, v200, v201
v_mfma_f32_16x16x32_bf16 v[28:31], a[252:255], v[192:195], 0
v_exp_f32 v207, v207
v_mfma_f32_16x16x32_bf16 v[28:31], a[248:251], v[196:199], v[28:31]
v_cvt_pk_bf16_f32 v141, v202, v203
v_cvt_pk_bf16_f32 v142, v204, v205
v_mfma_f32_16x16x32_bf16 v[28:31], a[244:247], v[228:231], v[28:31]
v_cvt_pk_bf16_f32 v143, v206, v207
v_sub_f32 v208, v208, v254
v_mfma_f32_16x16x32_bf16 v[28:31], a[240:243], v[220:223], v[28:31]
v_sub_f32 v209, v209, v254
v_sub_f32 v210, v210, v254
v_mfma_f32_16x16x32_bf16 v[228:231], v[56:59], v[136:139], 0
v_exp_f32 v208, v208
v_mfma_f32_16x16x32_bf16 v[228:231], v[104:107], v[148:151], v[228:231]
v_exp_f32 v209, v209
v_mfma_f32_16x16x32_bf16 v[228:231], v[72:75], v[140:143], v[228:231]
v_exp_f32 v210, v210
v_sub_f32 v211, v211, v254
v_exp_f32 v211, v211
v_sub_f32 v212, v212, v254
v_exp_f32 v212, v212
v_sub_f32 v213, v213, v254
v_exp_f32 v213, v213
v_sub_f32 v214, v214, v254
v_exp_f32 v214, v214
v_sub_f32 v215, v215, v254
v_exp_f32 v215, v215
v_cvt_pk_bf16_f32 v144, v208, v209
v_cvt_pk_bf16_f32 v145, v210, v211
v_cvt_pk_bf16_f32 v146, v212, v213
v_cvt_pk_bf16_f32 v147, v214, v215
v_cvt_pk_bf16_f32 v162, v164, v165
v_cvt_pk_bf16_f32 v163, v166, v167
v_mfma_f32_16x16x32_bf16 v[228:231], v[88:91], v[144:147], v[228:231]
v_pk_max_i16 v155, v155, 0
v_pk_max_i16 v160, v160, 0
v_mfma_f32_16x16x32_bf16 v[192:195], v[92:95], v[144:147], 0
v_pk_max_i16 v161, v161, 0
v_pk_max_i16 v162, v162, 0
v_mfma_f32_16x16x32_bf16 v[192:195], v[76:79], v[140:143], v[192:195]
v_pk_max_i16 v163, v163, 0
v_mbcnt_hi_u32_b32 v242, -1, v242
v_mfma_f32_16x16x32_bf16 v[192:195], v[106:109], v[148:151], v[192:195]
buffer_store_dwordx4 v[152:155], v239, s[20:23], s52 offen offset:0 nt
buffer_store_dwordx4 v[160:163], v239, s[20:23], s52 offen offset:64 nt
s_mul_i32 s54, s41, 12288
s_add_u32 s54, s54, 105472
v_mov_b32 v244, s54
v_bfe_u32 v243, v242, 0, 4
v_lshl_add_u32 v244, v243, 7, v244
v_lshlrev_b32 v243, 4, v242
v_xor_b32 v243, v243, v242
v_and_b32 v243, 48, v243
v_mfma_f32_16x16x32_bf16 v[192:195], v[60:63], v[136:139], v[192:195]
v_add_u32 v244, v243, v244
v_add_u32 v244, v243, v244
v_mfma_f32_16x16x32_bf16 v[220:223], v[64:67], v[136:139], 0
ds_read_b128 v[184:187], v244 offset:0
ds_read_b128 v[232:235], v244 offset:16
v_mfma_f32_16x16x32_bf16 v[220:223], v[108:111], v[148:151], v[220:223]
ds_read_b128 v[196:199], v244 offset:2048
v_add_f32 v249, v249, v188
v_mfma_f32_16x16x32_bf16 v[220:223], v[80:83], v[140:143], v[220:223]
ds_read_b32 v188, v244 offset:4096
v_add_f32 v249, v249, v189
v_mfma_f32_16x16x32_bf16 v[220:223], v[96:99], v[144:147], v[220:223]
v_add_f32 v249, v249, v190
v_add_f32 v249, v249, v191
v_mfma_f32_16x16x32_bf16 v[224:227], v[100:103], v[144:147], 0
v_mov_b32 v245, 24576
v_bfe_u32 v243, v242, 0, 2
v_mfma_f32_16x16x32_bf16 v[224:227], v[84:87], v[140:143], v[224:227]
v_lshl_add_u32 v245, v243, 8, v245
v_bfe_u32 v243, v242, 2, 2
v_mfma_f32_16x16x32_bf16 v[224:227], v[110:113], v[148:151], v[224:227]
s_waitcnt lgkmcnt(2)
v_lshlrev_b32 v190, 16, v184
v_lshlrev_b32 v191, 16, v185
v_mfma_f32_16x16x32_bf16 v[224:227], v[68:71], v[136:139], v[224:227]
s_waitcnt lgkmcnt(1)
s_waitcnt lgkmcnt(0)
ds_swizzle_b32 v189, v188 offset:0x401F
v_and_b32 v184, 0xffff0000, v184
v_and_b32 v185, 0xffff0000, v185
v_mul_u32_u24 v243, 13107200, v243
v_add_u32 v245, v243, v245
s_lshl_b32 s48, s43, 7
s_add_u32 s48, s48, s44
s_add_u32 s48, s48, 0
v_bfe_u32 v243, v242, 4, 2
v_lshl_add_u32 v245, v243, 4, v245
v_add_f32 v249, v249, v200
v_add_f32 v249, v249, v201
v_add_f32 v249, v249, v202
v_add_f32 v249, v249, v203
ds_read_b128 v[200:203], v244 offset:2064
v_add_f32 v249, v249, v204
ds_read_b32 v204, v244 offset:6144
v_add_f32 v249, v249, v205
v_add_f32 v249, v249, v206
v_add_f32 v249, v249, v207
v_add_f32 v249, v249, v208
v_add_f32 v249, v249, v209
v_add_f32 v249, v249, v210
v_add_f32 v249, v249, v211
v_add_f32 v249, v249, v212
v_add_f32 v249, v249, v213
v_add_f32 v249, v249, v214
v_add_f32 v249, v249, v215
v_add_f32 v249, v249, v216
ds_swizzle_b32 v250, v249 offset:0x401F
v_lshlrev_b32 v206, 16, v196
v_lshlrev_b32 v207, 16, v197
v_and_b32 v196, 0xffff0000, v196
v_and_b32 v197, 0xffff0000, v197
s_waitcnt lgkmcnt(1)
ds_swizzle_b32 v205, v204 offset:0x401F
v_add_f32 v188, v188, v189
ds_bpermute_b32 v189, v247, v188
s_lshl_b32 s51, s43, 7
s_add_u32 s51, s51, s44
s_add_u32 s51, s51, 52428800
s_waitcnt lgkmcnt(2)
v_add_f32 v249, v249, v250
ds_bpermute_b32 v250, v247, v249
s_waitcnt lgkmcnt(2)
v_add_f32 v204, v204, v205
ds_bpermute_b32 v205, v247, v204
s_waitcnt lgkmcnt(2)
v_add_f32 v188, v188, v189
v_rcp_f32 v189, v188
s_nop 0
v_fmac_f32 v0, v190, v189
v_fmac_f32 v2, v191, v189
v_lshlrev_b32 v190, 16, v186
v_lshlrev_b32 v191, 16, v187
v_fmac_f32 v4, v190, v189
v_fmac_f32 v6, v191, v189
v_lshlrev_b32 v190, 16, v232
v_lshlrev_b32 v191, 16, v233
v_and_b32 v232, 0xffff0000, v232
v_fmac_f32 v8, v190, v189
v_fmac_f32 v10, v191, v189
v_fmac_f32 v1, v184, v189
v_fmac_f32 v9, v232, v189
v_and_b32 v233, 0xffff0000, v233
v_lshlrev_b32 v190, 16, v234
v_lshlrev_b32 v191, 16, v235
v_fmac_f32 v3, v185, v189
v_and_b32 v186, 0xffff0000, v186
v_and_b32 v187, 0xffff0000, v187
v_fmac_f32 v11, v233, v189
v_and_b32 v234, 0xffff0000, v234
v_and_b32 v235, 0xffff0000, v235
v_cvt_pk_bf16_f32 v0, v0, v1
v_cvt_pk_bf16_f32 v8, v8, v9
v_fmac_f32 v5, v186, v189
v_fmac_f32 v7, v187, v189
v_fmac_f32 v12, v190, v189
v_fmac_f32 v13, v234, v189
v_fmac_f32 v14, v191, v189
v_fmac_f32 v15, v235, v189
v_cvt_pk_bf16_f32 v1, v2, v3
v_cvt_pk_bf16_f32 v9, v10, v11
v_cvt_pk_bf16_f32 v2, v4, v5
v_cvt_pk_bf16_f32 v3, v6, v7
v_cvt_pk_bf16_f32 v10, v12, v13
v_cvt_pk_bf16_f32 v11, v14, v15
v_pk_max_i16 v0, v0, 0
v_pk_max_i16 v1, v1, 0
v_pk_max_i16 v2, v2, 0
v_pk_max_i16 v3, v3, 0
v_pk_max_i16 v8, v8, 0
v_pk_max_i16 v9, v9, 0
v_pk_max_i16 v10, v10, 0
v_pk_max_i16 v11, v11, 0
buffer_store_dwordx4 v[0:3], v245, s[20:23], s48 offen offset:0 nt
buffer_store_dwordx4 v[8:11], v245, s[20:23], s48 offen offset:64 nt
s_waitcnt lgkmcnt(1)
v_add_f32 v249, v249, v250
v_rcp_f32 v252, v249
s_nop 0
v_fmac_f32 v168, v228, v252
v_fmac_f32 v169, v229, v252
v_fmac_f32 v176, v220, v252
v_fmac_f32 v177, v221, v252
v_fmac_f32 v170, v230, v252
v_fmac_f32 v171, v231, v252
v_cvt_pk_bf16_f32 v168, v168, v169
v_fmac_f32 v178, v222, v252
v_fmac_f32 v179, v223, v252
v_cvt_pk_bf16_f32 v176, v176, v177
v_fmac_f32 v172, v192, v252
v_fmac_f32 v173, v193, v252
v_fmac_f32 v174, v194, v252
v_fmac_f32 v175, v195, v252
v_cvt_pk_bf16_f32 v169, v170, v171
v_fmac_f32 v180, v224, v252
v_fmac_f32 v181, v225, v252
v_fmac_f32 v182, v226, v252
v_fmac_f32 v183, v227, v252
v_cvt_pk_bf16_f32 v177, v178, v179
v_cvt_pk_bf16_f32 v170, v172, v173
v_cvt_pk_bf16_f32 v171, v174, v175
v_cvt_pk_bf16_f32 v178, v180, v181
v_cvt_pk_bf16_f32 v179, v182, v183
v_pk_max_i16 v168, v168, 0
v_pk_max_i16 v169, v169, 0
v_pk_max_i16 v170, v170, 0
v_pk_max_i16 v171, v171, 0
v_pk_max_i16 v176, v176, 0
v_pk_max_i16 v177, v177, 0
v_pk_max_i16 v178, v178, 0
v_pk_max_i16 v179, v179, 0
buffer_store_dwordx4 v[168:171], v239, s[20:23], s53 offen offset:0 nt
buffer_store_dwordx4 v[176:179], v239, s[20:23], s53 offen offset:64 nt
s_waitcnt lgkmcnt(0)
v_add_f32 v204, v204, v205
v_rcp_f32 v205, v204
s_nop 0
v_fmac_f32 v16, v206, v205
v_fmac_f32 v18, v207, v205
v_lshlrev_b32 v206, 16, v198
v_lshlrev_b32 v207, 16, v199
v_fmac_f32 v20, v206, v205
v_fmac_f32 v22, v207, v205
v_lshlrev_b32 v206, 16, v200
v_lshlrev_b32 v207, 16, v201
v_and_b32 v200, 0xffff0000, v200
v_fmac_f32 v24, v206, v205
v_fmac_f32 v26, v207, v205
v_fmac_f32 v17, v196, v205
v_fmac_f32 v25, v200, v205
v_and_b32 v201, 0xffff0000, v201
v_lshlrev_b32 v206, 16, v202
v_lshlrev_b32 v207, 16, v203
v_fmac_f32 v19, v197, v205
v_and_b32 v198, 0xffff0000, v198
v_and_b32 v199, 0xffff0000, v199
v_fmac_f32 v27, v201, v205
v_and_b32 v202, 0xffff0000, v202
v_and_b32 v203, 0xffff0000, v203
v_cvt_pk_bf16_f32 v16, v16, v17
v_cvt_pk_bf16_f32 v24, v24, v25
v_fmac_f32 v21, v198, v205
v_fmac_f32 v23, v199, v205
v_fmac_f32 v28, v206, v205
v_fmac_f32 v29, v202, v205
v_fmac_f32 v30, v207, v205
v_fmac_f32 v31, v203, v205
v_cvt_pk_bf16_f32 v17, v18, v19
v_cvt_pk_bf16_f32 v25, v26, v27
v_cvt_pk_bf16_f32 v18, v20, v21
v_cvt_pk_bf16_f32 v19, v22, v23
v_cvt_pk_bf16_f32 v26, v28, v29
v_cvt_pk_bf16_f32 v27, v30, v31
v_pk_max_i16 v16, v16, 0
v_pk_max_i16 v17, v17, 0
v_pk_max_i16 v18, v18, 0
v_pk_max_i16 v19, v19, 0
v_pk_max_i16 v24, v24, 0
v_pk_max_i16 v25, v25, 0
v_pk_max_i16 v26, v26, 0
v_pk_max_i16 v27, v27, 0
buffer_store_dwordx4 v[16:19], v245, s[20:23], s51 offen offset:0 nt
buffer_store_dwordx4 v[24:27], v245, s[20:23], s51 offen offset:64 nt
L_end:
s_endpgm
.section .rodata,"a"
.p2align 6
.amdhsa_kernel standalone__attention_interact_autoint__recsys_kernel
  .amdhsa_next_free_vgpr 512
  .amdhsa_next_free_sgpr 102
  .amdhsa_accum_offset 256
  .amdhsa_group_segment_fixed_size 0
  .amdhsa_kernarg_size 64
  .amdhsa_user_sgpr_count 2
  .amdhsa_user_sgpr_kernarg_segment_ptr 1
  .amdhsa_system_sgpr_workgroup_id_x 1
.end_amdhsa_kernel
```

```asm
; @launch grid=(256,1,1) block=(256,1,1) lds=163840
.amdgcn_target "amdgcn-amd-amdhsa--gfx950"
.text
.globl standalone__attention_interact_autoint__recsys_kernel
.p2align 8
.type standalone__attention_interact_autoint__recsys_kernel,@function
standalone__attention_interact_autoint__recsys_kernel:
s_cmp_ge_u32 s2, 256
s_cbranch_scc1 L_end
s_load_dwordx2 s[24:25], s[0:1], 8
s_load_dwordx2 s[28:29], s[0:1], 16
s_load_dwordx2 s[32:33], s[0:1], 24
s_load_dwordx2 s[36:37], s[0:1], 32
s_getpc_b64 s[58:59]
L_pc:
s_lshl_b32 s3, s2, 8
s_and_b32 s3, s3, 0x7800
v_lshrrev_b32 v2, 4, v0
v_lshl_add_u32 v2, v2, 7, s3
v_min_u32 v2, L_fast_end-L_pc-4, v2
global_load_dword v96, v2, s[58:59]
v_lshrrev_b32 v1, 6, v0
s_mov_b32 s27, 0x20000
v_readfirstlane_b32 s41, v1
s_mov_b32 s26, 32768
s_mov_b64 s[30:31], s[26:27]
s_mov_b64 s[34:35], s[26:27]
s_mov_b64 s[38:39], s[26:27]
s_lshl_b32 s54, s41, 13
s_lshl_b32 s6, s2, 7
s_and_b32 s6, s6, 0x7c00
s_add_u32 s57, s54, 4096
v_and_b32 v168, 63, v0
v_lshrrev_b32 v169, 5, v0
v_lshlrev_b32 v175, 4, v168
v_lshlrev_b32 v169, 7, v169
s_waitcnt lgkmcnt(0)
buffer_load_dword v97, v169, s[24:27], s6 offen
buffer_load_dword v98, v169, s[28:31], s6 offen
buffer_load_dword v99, v169, s[32:35], s6 offen
buffer_load_dword v100, v169, s[36:39], s6 offen
buffer_load_dwordx4 v[104:107], v175, s[24:27], s54 offen offset:0
buffer_load_dwordx4 v[108:111], v175, s[24:27], s54 offen offset:1024
buffer_load_dwordx4 v[112:115], v175, s[24:27], s54 offen offset:2048
buffer_load_dwordx4 v[116:119], v175, s[24:27], s54 offen offset:3072
buffer_load_dwordx4 v[120:123], v175, s[24:27], s57 offen offset:0
buffer_load_dwordx4 v[124:127], v175, s[24:27], s57 offen offset:1024
buffer_load_dwordx4 v[128:131], v175, s[24:27], s57 offen offset:2048
buffer_load_dwordx4 v[132:135], v175, s[24:27], s57 offen offset:3072
s_load_dwordx2 s[16:17], s[0:1], 0
s_load_dwordx2 s[20:21], s[0:1], 40
s_mov_b32 s18, 104857600
s_mov_b32 s19, s27
s_lshr_b32 s42, s41, 1
s_and_b32 s43, s41, 1
s_lshl1_add_u32 s44, s2, s42
s_mul_i32 s44, s44, 25600
s_mov_b32 s40, 0x3e38aa3b
s_mov_b64 s[22:23], s[18:19]
s_mov_b32 s45, 8
s_mov_b32 s3, 64
s_mov_b32 s46, s44
s_mov_b32 s47, 0x7ff00000
s_mov_b32 s56, 50688
s_mov_b32 s96, 0x3b8265d9
s_mov_b32 s97, 0
s_mov_b32 s13, 0x07060302
s_mov_b32 s12, 0x3e38aa3b
s_mov_b32 s14, 0x55555555
s_mov_b32 s15, 0x55555555
s_mul_i32 s49, s42, 25344
s_mul_i32 s53, s43, 1056
s_add_u32 s49, s49, s53
s_lshl_b32 s55, s43, 10
s_add_u32 s55, s55, s44
s_waitcnt lgkmcnt(0)
s_add_u32 m0, s49, 21120
s_add_u32 s48, s55, 20480
s_mul_i32 s98, s42, 25344
s_lshl_b32 s53, s43, 13
s_add_u32 s98, s98, s53
s_add_u32 s53, s98, 4224
v_and_b32 v243, 48, v175
v_and_b32 v169, 48, v168
v_lshl_add_u32 v243, v169, 2, v243
v_and_b32 v169, 12, v168
v_lshl_add_u32 v243, v169, 6, v243
buffer_load_dwordx4 v243, s[16:19], s48 offen nt lds
s_add_u32 m0, s49, 23232
s_add_u32 s48, s55, 22528
buffer_load_dwordx4 v243, s[16:19], s48 offen nt lds
s_add_u32 m0, s49, 0
s_add_u32 s48, s55, 0
s_mov_b64 exec, 0
s_cmp_eq_u32 s41, 0
s_cbranch_scc1 L_h0
s_cmp_eq_u32 s41, 1
s_cbranch_scc1 L_h1
s_cmp_eq_u32 s41, 2
s_cbranch_scc1 L_h2
s_branch L_h3
L_ret:
s_mov_b64 exec, -1
buffer_load_dwordx4 v243, s[16:19], s48 offen nt lds
s_add_u32 m0, s49, 2112
s_add_u32 s48, s55, 2048
buffer_load_dwordx4 v243, s[16:19], s48 offen nt lds
s_add_u32 m0, s98, 102400
v_and_b32 v169, 16, v168
v_mov_b32 v180, v169
v_lshlrev_b32 v169, 1, v169
v_xor_b32 v170, v175, v169
v_add_u32 v172, s53, v170
v_xor_b32 v171, 64, v170
v_add_u32 v173, s53, v171
s_mul_i32 s53, s43, 25344
s_add_u32 s7, s53, 4224
v_lshrrev_b32 v82, 4, v168
v_lshl_add_u32 v176, v82, 10, s7
v_bfe_u32 v83, v168, 2, 2
v_lshl_add_u32 v176, v83, 7, v176
v_bfe_u32 v84, v168, 3, 1
v_lshl_add_u32 v176, v84, 5, v176
v_bfe_u32 v85, v168, 4, 1
v_lshl_add_u32 v176, v85, 6, v176
v_and_b32 v86, 3, v168
v_lshl_add_u32 v176, v86, 3, v176
v_xor_b32 v177, 32, v176
v_xor_b32 v178, 64, v176
s_mul_i32 s53, s42, 25344
v_lshl_add_u32 v242, v86, 6, s53
v_lshl_add_u32 v242, v82, 4, v242
s_mov_b32 s6, 1056
v_mad_u32_u24 v242, v83, s6, v242
v_xor_b32 v179, 96, v176
s_mul_i32 s4, s43, 13107200
s_add_u32 s4, s4, s44
s_add_u32 s4, s4, 24576
s_mul_i32 s5, s43, -52424704
s_add_u32 s5, s5, 104833024
s_add_u32 s99, s4, 0
s_add_u32 s100, s4, 26212288
v_lshrrev_b32 v80, 3, v168
v_lshlrev_b32 v174, 8, v80
v_and_b32 v81, 7, v168
v_lshl_add_u32 v174, v81, 4, v174
v_xor_b32 v174, v174, v180
v_xor_b32 v180, v175, v180
s_mul_i32 s53, s41, 816
s_add_u32 s53, s53, 157696
v_and_b32 v88, 1, v168
v_lshl_add_u32 v249, v83, 6, s53
v_lshl_add_u32 v249, v88, 5, v249
s_add_u32 s8, s53, 256
s_mov_b32 vcc_lo, 0x33333333
s_mov_b32 vcc_hi, 0xcccccccc
v_lshl_add_u32 v249, v85, 4, v249
v_mov_b32 v166, s8
v_cndmask_b32 v249, v166, v249, vcc
s_add_u32 s9, s53, 256
v_lshl_add_u32 v166, v83, 2, s9
s_mov_b32 s8, 272
v_lshl_add_u32 v248, v82, 6, s53
v_mov_b32 v236, 0
v_mad_u32_u24 v166, v86, s8, v166
s_lshl_b32 s53, s41, 8
s_add_u32 s10, s53, 101376
ds_write_b32 v166, v236 offset:0
s_add_u32 s58, s53, 36096
s_xor_b32 s59, s53, 256
s_add_u32 s59, s59, 36096
v_lshl_add_u32 v166, v168, 2, s10
v_bfe_u32 v87, v168, 1, 1
v_lshl_add_u32 v248, v87, 5, v248
v_lshl_add_u32 v248, v83, 3, v248
v_lshl_add_u32 v248, v88, 1, v248
ds_write_b32 v166, v166 offset:0
s_waitcnt vmcnt(11)
v_and_b32 v160, 0xffff0000, v104
v_and_b32 v161, 0xffff0000, v105
v_and_b32 v162, 0xffff0000, v106
v_and_b32 v163, 0xffff0000, v107
v_lshlrev_b32 v104, 16, v104
v_lshlrev_b32 v105, 16, v105
v_lshlrev_b32 v106, 16, v106
v_lshlrev_b32 v107, 16, v107
v_mul_f32 v160, s12, v160
v_mul_f32 v104, s12, v104
v_mul_f32 v161, s12, v161
v_mul_f32 v105, s12, v105
v_mul_f32 v162, s12, v162
v_mul_f32 v106, s12, v106
v_mul_f32 v163, s12, v163
v_mul_f32 v107, s12, v107
v_cvt_pk_bf16_f32 v104, v104, v160
v_cvt_pk_bf16_f32 v105, v105, v161
v_cvt_pk_bf16_f32 v106, v106, v162
v_cvt_pk_bf16_f32 v107, v107, v163
ds_write_b128 v172, v[104:107] offset:0
buffer_load_dwordx4 v170, s[28:31], s54 offen offset:0 lds
s_waitcnt vmcnt(11)
v_and_b32 v160, 0xffff0000, v108
v_and_b32 v161, 0xffff0000, v109
v_and_b32 v162, 0xffff0000, v110
v_and_b32 v163, 0xffff0000, v111
v_lshlrev_b32 v108, 16, v108
v_lshlrev_b32 v109, 16, v109
v_lshlrev_b32 v110, 16, v110
v_lshlrev_b32 v111, 16, v111
v_mul_f32 v160, s12, v160
v_mul_f32 v108, s12, v108
v_mul_f32 v161, s12, v161
v_mul_f32 v109, s12, v109
v_mul_f32 v162, s12, v162
v_mul_f32 v110, s12, v110
v_mul_f32 v163, s12, v163
v_mul_f32 v111, s12, v111
v_cvt_pk_bf16_f32 v108, v108, v160
v_cvt_pk_bf16_f32 v109, v109, v161
v_cvt_pk_bf16_f32 v110, v110, v162
v_cvt_pk_bf16_f32 v111, v111, v163
ds_write_b128 v173, v[108:111] offset:1024
buffer_load_dwordx4 v171, s[28:31], s54 offen offset:1024 lds
s_waitcnt vmcnt(11)
v_and_b32 v160, 0xffff0000, v112
v_and_b32 v161, 0xffff0000, v113
v_and_b32 v162, 0xffff0000, v114
v_and_b32 v163, 0xffff0000, v115
v_lshlrev_b32 v112, 16, v112
v_lshlrev_b32 v113, 16, v113
v_lshlrev_b32 v114, 16, v114
v_lshlrev_b32 v115, 16, v115
v_mul_f32 v160, s12, v160
v_mul_f32 v112, s12, v112
v_mul_f32 v161, s12, v161
v_mul_f32 v113, s12, v113
v_mul_f32 v162, s12, v162
v_mul_f32 v114, s12, v114
v_mul_f32 v163, s12, v163
v_mul_f32 v115, s12, v115
v_cvt_pk_bf16_f32 v112, v112, v160
v_cvt_pk_bf16_f32 v113, v113, v161
v_cvt_pk_bf16_f32 v114, v114, v162
v_cvt_pk_bf16_f32 v115, v115, v163
ds_write_b128 v172, v[112:115] offset:2048
buffer_load_dwordx4 v170, s[28:31], s54 offen offset:2048 lds
s_waitcnt vmcnt(11)
v_and_b32 v160, 0xffff0000, v116
v_and_b32 v161, 0xffff0000, v117
v_and_b32 v162, 0xffff0000, v118
v_and_b32 v163, 0xffff0000, v119
v_lshlrev_b32 v116, 16, v116
v_lshlrev_b32 v117, 16, v117
v_lshlrev_b32 v118, 16, v118
v_lshlrev_b32 v119, 16, v119
v_mul_f32 v160, s12, v160
v_mul_f32 v116, s12, v116
v_mul_f32 v161, s12, v161
v_mul_f32 v117, s12, v117
v_mul_f32 v162, s12, v162
v_mul_f32 v118, s12, v118
v_mul_f32 v163, s12, v163
v_mul_f32 v119, s12, v119
v_cvt_pk_bf16_f32 v116, v116, v160
v_cvt_pk_bf16_f32 v117, v117, v161
v_cvt_pk_bf16_f32 v118, v118, v162
v_cvt_pk_bf16_f32 v119, v119, v163
ds_write_b128 v173, v[116:119] offset:3072
buffer_load_dwordx4 v171, s[28:31], s54 offen offset:3072 lds
s_add_u32 m0, s98, 106496
s_waitcnt vmcnt(11)
v_and_b32 v160, 0xffff0000, v120
v_and_b32 v161, 0xffff0000, v121
v_and_b32 v162, 0xffff0000, v122
v_and_b32 v163, 0xffff0000, v123
v_lshlrev_b32 v120, 16, v120
v_lshlrev_b32 v121, 16, v121
v_lshlrev_b32 v122, 16, v122
v_lshlrev_b32 v123, 16, v123
v_mul_f32 v160, s12, v160
v_mul_f32 v120, s12, v120
v_mul_f32 v161, s12, v161
v_mul_f32 v121, s12, v121
v_mul_f32 v162, s12, v162
v_mul_f32 v122, s12, v122
v_mul_f32 v163, s12, v163
v_mul_f32 v123, s12, v123
v_cvt_pk_bf16_f32 v120, v120, v160
v_cvt_pk_bf16_f32 v121, v121, v161
v_cvt_pk_bf16_f32 v122, v122, v162
v_cvt_pk_bf16_f32 v123, v123, v163
ds_write_b128 v172, v[120:123] offset:4096
buffer_load_dwordx4 v170, s[28:31], s57 offen offset:0 lds
s_waitcnt vmcnt(11)
v_and_b32 v160, 0xffff0000, v124
v_and_b32 v161, 0xffff0000, v125
v_and_b32 v162, 0xffff0000, v126
v_and_b32 v163, 0xffff0000, v127
v_lshlrev_b32 v124, 16, v124
v_lshlrev_b32 v125, 16, v125
v_lshlrev_b32 v126, 16, v126
v_lshlrev_b32 v127, 16, v127
v_mul_f32 v160, s12, v160
v_mul_f32 v124, s12, v124
v_mul_f32 v161, s12, v161
v_mul_f32 v125, s12, v125
v_mul_f32 v162, s12, v162
v_mul_f32 v126, s12, v126
v_mul_f32 v163, s12, v163
v_mul_f32 v127, s12, v127
v_cvt_pk_bf16_f32 v124, v124, v160
v_cvt_pk_bf16_f32 v125, v125, v161
v_cvt_pk_bf16_f32 v126, v126, v162
v_cvt_pk_bf16_f32 v127, v127, v163
ds_write_b128 v173, v[124:127] offset:5120
buffer_load_dwordx4 v171, s[28:31], s57 offen offset:1024 lds
s_waitcnt vmcnt(11)
v_and_b32 v160, 0xffff0000, v128
v_and_b32 v161, 0xffff0000, v129
v_and_b32 v162, 0xffff0000, v130
v_and_b32 v163, 0xffff0000, v131
v_lshlrev_b32 v128, 16, v128
v_lshlrev_b32 v129, 16, v129
v_lshlrev_b32 v130, 16, v130
v_lshlrev_b32 v131, 16, v131
v_mul_f32 v160, s12, v160
v_mul_f32 v128, s12, v128
v_mul_f32 v161, s12, v161
v_mul_f32 v129, s12, v129
v_mul_f32 v162, s12, v162
v_mul_f32 v130, s12, v130
v_mul_f32 v163, s12, v163
v_mul_f32 v131, s12, v131
v_cvt_pk_bf16_f32 v128, v128, v160
v_cvt_pk_bf16_f32 v129, v129, v161
v_cvt_pk_bf16_f32 v130, v130, v162
v_cvt_pk_bf16_f32 v131, v131, v163
ds_write_b128 v172, v[128:131] offset:6144
buffer_load_dwordx4 v170, s[28:31], s57 offen offset:2048 lds
s_waitcnt vmcnt(11)
v_and_b32 v160, 0xffff0000, v132
v_and_b32 v161, 0xffff0000, v133
v_and_b32 v162, 0xffff0000, v134
v_and_b32 v163, 0xffff0000, v135
v_lshlrev_b32 v132, 16, v132
v_lshlrev_b32 v133, 16, v133
v_lshlrev_b32 v134, 16, v134
v_lshlrev_b32 v135, 16, v135
v_mul_f32 v160, s12, v160
v_mul_f32 v132, s12, v132
v_mul_f32 v161, s12, v161
v_mul_f32 v133, s12, v133
v_mul_f32 v162, s12, v162
v_mul_f32 v134, s12, v134
v_mul_f32 v163, s12, v163
v_mul_f32 v135, s12, v135
v_cvt_pk_bf16_f32 v132, v132, v160
v_cvt_pk_bf16_f32 v133, v133, v161
v_cvt_pk_bf16_f32 v134, v134, v162
v_cvt_pk_bf16_f32 v135, v135, v163
ds_write_b128 v173, v[132:135] offset:7168
buffer_load_dwordx4 v171, s[28:31], s57 offen offset:3072 lds
s_add_u32 m0, s49, 50688
s_waitcnt vmcnt(10) lgkmcnt(0)
s_barrier
ds_read_b64_tr_b16 a[28:29], v177 offset:12288
ds_read_b128 v[188:191], v242 offset:21120
ds_read_b64_tr_b16 a[30:31], v177 offset:12800
ds_read_b128 v[212:215], v242 offset:21376
ds_read_b64_tr_b16 a[0:1], v176 offset:0
ds_read_b128 v[224:227], v242 offset:21632
ds_read_b64_tr_b16 a[2:3], v176 offset:512
ds_read_b128 v[232:235], v242 offset:21888
ds_read_b64_tr_b16 a[24:25], v177 offset:8192
ds_read_b64_tr_b16 a[26:27], v177 offset:8704
ds_read_b64_tr_b16 a[4:5], v176 offset:4096
ds_read_b64_tr_b16 a[6:7], v176 offset:4608
ds_read_b64_tr_b16 a[20:21], v177 offset:4096
ds_read_b64_tr_b16 a[22:23], v177 offset:4608
ds_read_b64_tr_b16 a[8:9], v176 offset:8192
ds_read_b64_tr_b16 a[10:11], v176 offset:8704
ds_read_b64_tr_b16 a[16:17], v177 offset:0
ds_read_b64_tr_b16 a[18:19], v177 offset:512
ds_read_b64_tr_b16 a[12:13], v176 offset:12288
ds_read_b64_tr_b16 a[14:15], v176 offset:12800
ds_read_b64_tr_b16 a[32:33], v178 offset:0
ds_read_b64_tr_b16 a[34:35], v178 offset:512
ds_read_b64_tr_b16 a[36:37], v178 offset:4096
ds_read_b64_tr_b16 a[38:39], v178 offset:4608
ds_read_b64_tr_b16 a[40:41], v178 offset:8192
ds_read_b64_tr_b16 a[42:43], v178 offset:8704
ds_read_b64_tr_b16 a[44:45], v178 offset:12288
ds_read_b64_tr_b16 a[46:47], v178 offset:12800
s_waitcnt lgkmcnt(15)
v_mfma_f32_16x16x32_bf16 v[192:195], a[0:3], v[188:191], 0
s_waitcnt lgkmcnt(12)
ds_read_b64_tr_b16 a[48:49], v179 offset:0
v_add_u32 v176, 98176, v176
v_mfma_f32_16x16x32_bf16 v[192:195], a[4:7], v[212:215], v[192:195]
s_waitcnt lgkmcnt(9)
ds_read_b64_tr_b16 a[50:51], v179 offset:512
v_add_u32 v177, 98176, v177
v_mfma_f32_16x16x32_bf16 v[192:195], a[8:11], v[224:227], v[192:195]
s_mul_i32 s53, s43, 25344
ds_read_b64_tr_b16 a[52:53], v179 offset:4096
v_add_u32 v178, 98176, v178
v_mfma_f32_16x16x32_bf16 v[192:195], a[12:15], v[232:235], v[192:195]
s_add_u32 s11, s53, 59648
ds_read_b64_tr_b16 a[54:55], v179 offset:4608
v_lshl_add_u32 v182, v82, 10, s11
v_mfma_f32_16x16x32_bf16 v[196:199], a[28:31], v[232:235], 0
s_lshl_b32 s53, s43, 7
ds_read_b64_tr_b16 a[56:57], v179 offset:8192
v_lshl_add_u32 v182, v83, 7, v182
v_mfma_f32_16x16x32_bf16 v[196:199], a[24:27], v[224:227], v[196:199]
s_mov_b32 s51, -32
ds_read_b64_tr_b16 a[58:59], v179 offset:8704
v_cvt_pk_bf16_f32 v152, v192, v193
v_mfma_f32_16x16x32_bf16 v[196:199], a[20:23], v[212:215], v[196:199]
s_waitcnt lgkmcnt(12)
ds_read_b64_tr_b16 a[60:61], v179 offset:12288
v_cvt_pk_bf16_f32 v153, v194, v195
v_mfma_f32_16x16x32_bf16 v[196:199], a[16:19], v[188:191], v[196:199]
s_waitcnt lgkmcnt(11)
ds_read_b64_tr_b16 a[62:63], v179 offset:12800
v_add_u32 v179, 98176, v179
v_mfma_f32_16x16x32_bf16 v[200:203], a[32:35], v[188:191], 0
s_waitcnt lgkmcnt(10)
buffer_load_dwordx4 v243, s[16:19], s99 offen offset:0 nt lds
v_mfma_f32_16x16x32_bf16 v[200:203], a[36:39], v[212:215], v[200:203]
s_waitcnt lgkmcnt(8)
buffer_load_dwordx4 v243, s[16:19], s100 offen offset:2112 nt lds
v_mfma_f32_16x16x32_bf16 v[200:203], a[40:43], v[224:227], v[200:203]
s_add_u32 m0, s49, 54912
s_add_u32 s99, s4, 52428800
s_add_u32 s100, s4, 78641088
v_mfma_f32_16x16x32_bf16 v[200:203], a[44:47], v[232:235], v[200:203]
s_waitcnt lgkmcnt(4)
buffer_load_dwordx4 v243, s[16:19], s99 offen offset:0 nt lds
s_add_u32 s99, s55, 4096
v_cvt_pk_bf16_f32 v154, v196, v197
v_cvt_pk_bf16_f32 v155, v198, v199
s_waitcnt lgkmcnt(0)
v_mfma_f32_16x16x32_bf16 v[204:207], a[60:63], v[232:235], 0
buffer_load_dwordx4 v243, s[16:19], s100 offen offset:2112 nt lds
v_mfma_f32_16x16x32_bf16 v[204:207], a[52:55], v[212:215], v[204:207]
s_waitcnt vmcnt(12)
s_barrier
v_mfma_f32_16x16x32_bf16 v[204:207], a[48:51], v[188:191], v[204:207]
s_add_u32 m0, s98, 59648
ds_read_b128 v[208:211], v242 offset:512
ds_read_b128 v[216:219], v242 offset:768
v_mfma_f32_16x16x32_bf16 v[204:207], a[56:59], v[224:227], v[204:207]
s_add_u32 s100, s55, 4032
ds_read_b128 v[220:223], v242 offset:256
ds_read_b128 v[228:231], v242 offset:0
v_cvt_pk_bf16_f32 v156, v200, v201
v_cvt_pk_bf16_f32 v157, v202, v203
v_lshl_add_u32 v182, v84, 4, v182
v_lshl_add_u32 v182, v86, 5, v182
v_xor_b32 v183, 16, v182
s_mul_i32 s52, s41, 13824
s_add_u32 s52, s52, 102400
v_cvt_pk_bf16_f32 v158, v204, v205
v_cvt_pk_bf16_f32 v159, v206, v207
v_bfe_u32 v89, v168, 1, 3
v_lshl_add_u32 v244, v89, 9, s53
v_lshlrev_b32 v95, 4, v83
s_mov_b32 vcc_lo, 0x33333333
s_mov_b32 vcc_hi, 0x33333333
v_and_b32 v16, 15, v168
s_waitcnt lgkmcnt(3)
v_mfma_f32_16x16x32_bf16 v[192:195], a[56:59], v[208:211], 0
s_waitcnt lgkmcnt(2)
v_mov_b32 v169, 163024
v_bfe_u32 v90, v168, 3, 2
v_mfma_f32_16x16x32_bf16 v[192:195], a[60:63], v[216:219], v[192:195]
s_waitcnt lgkmcnt(0)
v_bfe_u32 v91, v168, 2, 1
v_lshl_add_u32 v245, v84, 8, s52
v_mfma_f32_16x16x32_bf16 v[192:195], a[52:55], v[220:223], v[192:195]
s_waitcnt vmcnt(4)
s_barrier
v_mfma_f32_16x16x32_bf16 v[192:195], a[48:51], v[228:231], v[192:195]
s_add_u32 s9, s52, 512
ds_read_b64_tr_b16 a[64:65], v176 offset:0
v_lshl_add_u32 v247, v83, 7, s9
v_mfma_f32_16x16x32_bf16 v[196:199], a[32:35], v[228:231], 0
s_lshl_b32 s53, s41, 9
ds_read_b64_tr_b16 a[66:67], v176 offset:512
v_lshl_add_u32 v247, v88, 6, v247
v_mfma_f32_16x16x32_bf16 v[196:199], a[36:39], v[220:223], v[196:199]
s_add_u32 s9, s53, 160960
ds_read_b64_tr_b16 a[68:69], v176 offset:4096
v_cvt_pk_bf16_f32 v102, v192, v193
v_mfma_f32_16x16x32_bf16 v[196:199], a[40:43], v[208:211], v[196:199]
s_add_u32 s10, s52, 1072
ds_read_b64_tr_b16 a[70:71], v176 offset:4608
v_cvt_pk_bf16_f32 v103, v194, v195
v_mfma_f32_16x16x32_bf16 v[196:199], a[44:47], v[216:219], v[196:199]
s_add_u32 s7, s52, 1136
ds_read_b64_tr_b16 a[72:73], v176 offset:8192
v_lshl_add_u32 v247, v82, 4, v247
v_mfma_f32_16x16x32_bf16 v[192:195], a[28:31], v[216:219], 0
s_add_u32 s11, s52, 1072
ds_read_b64_tr_b16 a[74:75], v176 offset:8704
v_mov_b32 v166, s10
v_mfma_f32_16x16x32_bf16 v[192:195], a[24:27], v[208:211], v[192:195]
s_mov_b32 s10, 1728
ds_read_b64_tr_b16 a[76:77], v176 offset:12288
v_cvt_pk_bf16_f32 v100, v196, v197
v_mfma_f32_16x16x32_bf16 v[192:195], a[20:23], v[220:223], v[192:195]
ds_read_b64_tr_b16 a[78:79], v176 offset:12800
v_cvt_pk_bf16_f32 v101, v198, v199
v_mfma_f32_16x16x32_bf16 v[192:195], a[16:19], v[228:231], v[192:195]
ds_read_b64_tr_b16 a[80:81], v177 offset:0
v_xor_b32 v247, v95, v247
v_mfma_f32_16x16x32_bf16 v[196:199], a[0:3], v[228:231], 0
ds_read_b64_tr_b16 a[82:83], v177 offset:512
v_cndmask_b32 v247, v166, v247, vcc
v_mfma_f32_16x16x32_bf16 v[196:199], a[4:7], v[220:223], v[196:199]
ds_read_b64_tr_b16 a[84:85], v177 offset:4096
v_lshl_add_u32 v167, v16, 4, s9
v_mfma_f32_16x16x32_bf16 v[196:199], a[8:11], v[208:211], v[196:199]
L_h0:
s_cbranch_execz L_h4
s_waitcnt lgkmcnt(9)
ds_read_b64_tr_b16 a[86:87], v177 offset:4608
v_cvt_pk_bf16_f32 v98, v192, v193
v_mfma_f32_16x16x32_bf16 v[196:199], a[12:15], v[216:219], v[196:199]
s_waitcnt lgkmcnt(8)
ds_read_b64_tr_b16 a[88:89], v177 offset:8192
v_cvt_pk_bf16_f32 v99, v194, v195
v_mfma_f32_16x16x32_bf16 v[192:195], a[64:67], v[188:191], 0
s_waitcnt lgkmcnt(7)
ds_read_b64_tr_b16 a[90:91], v177 offset:8704
v_lshl_add_u32 v246, v90, 7, s7
v_mfma_f32_16x16x32_bf16 v[192:195], a[68:71], v[212:215], v[192:195]
s_waitcnt lgkmcnt(6)
ds_read_b64_tr_b16 a[92:93], v177 offset:12288
v_cvt_pk_bf16_f32 v96, v196, v197
v_mfma_f32_16x16x32_bf16 v[192:195], a[72:75], v[224:227], v[192:195]
s_add_u32 s7, s52, 1136
ds_read_b64_tr_b16 a[94:95], v177 offset:12800
v_cvt_pk_bf16_f32 v97, v198, v199
v_mfma_f32_16x16x32_bf16 v[192:195], a[76:79], v[232:235], v[192:195]
ds_read_b64_tr_b16 a[96:97], v178 offset:0
v_lshl_add_u32 v246, v91, 6, v246
v_mfma_f32_16x16x32_bf16 v[196:199], a[76:79], v[216:219], 0
ds_read_b64_tr_b16 a[98:99], v178 offset:512
v_lshl_add_u32 v164, v86, 7, s52
v_mfma_f32_16x16x32_bf16 v[196:199], a[64:67], v[228:231], v[196:199]
ds_read_b64_tr_b16 a[100:101], v178 offset:4096
v_lshlrev_b32 v17, 4, v86
v_mfma_f32_16x16x32_bf16 v[196:199], a[68:71], v[220:223], v[196:199]
s_waitcnt lgkmcnt(5)
ds_read_b64_tr_b16 a[102:103], v178 offset:4608
v_cvt_pk_bf16_f32 v40, v192, v193
v_mfma_f32_16x16x32_bf16 v[196:199], a[72:75], v[208:211], v[196:199]
ds_read_b64_tr_b16 a[104:105], v178 offset:8192
v_cvt_pk_bf16_f32 v41, v194, v195
v_mfma_f32_16x16x32_bf16 v[200:203], a[88:91], v[208:211], 0
ds_read_b64_tr_b16 a[106:107], v178 offset:8704
v_lshl_add_u32 v245, v87, 7, v245
v_mfma_f32_16x16x32_bf16 v[200:203], a[84:87], v[220:223], v[200:203]
s_waitcnt lgkmcnt(6)
ds_read_b64_tr_b16 a[108:109], v178 offset:12288
v_cvt_pk_bf16_f32 v0, v196, v197
v_mfma_f32_16x16x32_bf16 v[200:203], a[80:83], v[228:231], v[200:203]
ds_read_b64_tr_b16 a[110:111], v178 offset:12800
v_cvt_pk_bf16_f32 v1, v198, v199
v_mfma_f32_16x16x32_bf16 v[200:203], a[92:95], v[216:219], v[200:203]
ds_read_b64_tr_b16 a[112:113], v179 offset:0
v_lshlrev_b32 v94, 4, v87
v_mfma_f32_16x16x32_bf16 v[192:195], a[92:95], v[232:235], 0
ds_read_b64_tr_b16 a[114:115], v179 offset:512
v_lshl_add_u32 v246, v86, 3, v246
v_mfma_f32_16x16x32_bf16 v[192:195], a[88:91], v[224:227], v[192:195]
ds_read_b64_tr_b16 a[116:117], v179 offset:4096
v_lshrrev_b32 v92, 5, v168
v_mfma_f32_16x16x32_bf16 v[192:195], a[84:87], v[212:215], v[192:195]
s_waitcnt lgkmcnt(9)
ds_read_b64_tr_b16 a[118:119], v179 offset:4608
v_cvt_pk_bf16_f32 v2, v200, v201
v_mfma_f32_16x16x32_bf16 v[192:195], a[80:83], v[188:191], v[192:195]
s_waitcnt lgkmcnt(8)
ds_read_b64_tr_b16 a[120:121], v179 offset:8192
v_cvt_pk_bf16_f32 v3, v202, v203
v_mfma_f32_16x16x32_bf16 v[196:199], a[96:99], v[188:191], 0
s_waitcnt lgkmcnt(7)
ds_read_b64_tr_b16 a[122:123], v179 offset:8704
v_lshl_add_u32 v164, v92, 4, v164
v_mfma_f32_16x16x32_bf16 v[196:199], a[100:103], v[212:215], v[196:199]
s_waitcnt lgkmcnt(6)
ds_read_b64_tr_b16 a[124:125], v179 offset:12288
v_cvt_pk_bf16_f32 v42, v192, v193
v_mfma_f32_16x16x32_bf16 v[196:199], a[104:107], v[224:227], v[196:199]
ds_read_b64_tr_b16 a[126:127], v179 offset:12800
v_cvt_pk_bf16_f32 v43, v194, v195
v_mfma_f32_16x16x32_bf16 v[196:199], a[108:111], v[232:235], v[196:199]
buffer_load_dwordx4 v180, s[32:35], s54 offen offset:0 lds
v_mfma_f32_16x16x32_bf16 v[192:195], a[108:111], v[216:219], 0
buffer_load_dwordx4 v180, s[32:35], s54 offen offset:1024 lds
v_mfma_f32_16x16x32_bf16 v[192:195], a[96:99], v[228:231], v[192:195]
s_mov_b32 vcc_lo, 0xf0000f
s_mov_b32 vcc_hi, 0xf0000f00
v_cndmask_b32 v167, v169, v167, vcc
v_mfma_f32_16x16x32_bf16 v[192:195], a[100:103], v[220:223], v[192:195]
s_waitcnt lgkmcnt(2)
buffer_load_dwordx4 v180, s[32:35], s54 offen offset:2048 lds
v_mfma_f32_16x16x32_bf16 v[192:195], a[104:107], v[208:211], v[192:195]
buffer_load_dwordx4 v180, s[32:35], s54 offen offset:3072 lds
v_mfma_f32_16x16x32_bf16 v[200:203], a[120:123], v[208:211], 0
s_add_u32 m0, s98, 63744
v_cvt_pk_bf16_f32 v44, v196, v197
v_cvt_pk_bf16_f32 v45, v198, v199
v_mfma_f32_16x16x32_bf16 v[200:203], a[116:119], v[220:223], v[200:203]
s_waitcnt lgkmcnt(0)
buffer_load_dwordx4 v180, s[32:35], s57 offen offset:0 lds
v_mfma_f32_16x16x32_bf16 v[200:203], a[112:115], v[228:231], v[200:203]
buffer_load_dwordx4 v180, s[32:35], s57 offen offset:1024 lds
v_mfma_f32_16x16x32_bf16 v[200:203], a[124:127], v[216:219], v[200:203]
v_cvt_pk_bf16_f32 v4, v192, v193
v_cvt_pk_bf16_f32 v5, v194, v195
v_mfma_f32_16x16x32_bf16 v[192:195], a[124:127], v[232:235], 0
buffer_load_dwordx4 v180, s[32:35], s57 offen offset:2048 lds
v_mfma_f32_16x16x32_bf16 v[192:195], a[120:123], v[224:227], v[192:195]
buffer_load_dwordx4 v180, s[32:35], s57 offen offset:3072 lds
v_mfma_f32_16x16x32_bf16 v[192:195], a[116:119], v[212:215], v[192:195]
s_add_u32 m0, s49, 4224
s_lshl_b32 s57, s43, 14
s_lshl_b32 s53, s42, 7
s_add_u32 s57, s57, s53
v_mfma_f32_16x16x32_bf16 v[192:195], a[112:115], v[188:191], v[192:195]
v_cvt_pk_bf16_f32 v6, v200, v201
v_cvt_pk_bf16_f32 v7, v202, v203
v_lshl_add_u32 v164, v85, 3, v164
v_mad_u32_u24 v164, v83, s10, v164
v_mfma_f32_16x16x32_bf16 v[196:199], v[4:7], v[156:159], 0
v_xor_b32 v164, v17, v164
v_xor_b32 v165, 32, v164
v_mfma_f32_16x16x32_bf16 v[196:199], v[0:3], v[152:155], v[196:199]
v_cvt_pk_bf16_f32 v46, v192, v193
v_cvt_pk_bf16_f32 v47, v194, v195
v_mfma_f32_16x16x32_bf16 v[192:195], v[40:43], v[152:155], 0
v_lshl_add_u32 v245, v88, 6, v245
v_lshl_add_u32 v245, v82, 4, v245
v_mfma_f32_16x16x32_bf16 v[192:195], v[44:47], v[156:159], v[192:195]
v_lshlrev_b32 v93, 5, v84
v_xor_b32 v245, v93, v245
v_mfma_f32_16x16x32_bf16 v[200:203], v[44:47], v[100:103], 0
v_exp_f32 v196, v196
v_mfma_f32_16x16x32_bf16 v[200:203], v[40:43], v[96:99], v[200:203]
v_exp_f32 v104, v197
v_mfma_f32_16x16x32_bf16 v[204:207], v[0:3], v[96:99], 0
s_nop 0
v_exp_f32 v192, v192
v_mfma_f32_16x16x32_bf16 v[204:207], v[4:7], v[100:103], v[204:207]
v_exp_f32 v114, v193
v_exp_f32 v194, v194
v_exp_f32 v115, v195
v_mov_b32_sdwa v114, v192 dst_sel:WORD_0 dst_unused:UNUSED_PRESERVE src0_sel:WORD_1
v_mov_b32_sdwa v115, v194 dst_sel:WORD_0 dst_unused:UNUSED_PRESERVE src0_sel:WORD_1
v_exp_f32 v198, v198
v_exp_f32 v105, v199
v_mov_b32_sdwa v104, v196 dst_sel:WORD_0 dst_unused:UNUSED_PRESERVE src0_sel:WORD_1
v_mov_b32_sdwa v105, v198 dst_sel:WORD_0 dst_unused:UNUSED_PRESERVE src0_sel:WORD_1
v_exp_f32 v200, v200
v_exp_f32 v130, v201
v_exp_f32 v202, v202
v_exp_f32 v131, v203
v_mov_b32_sdwa v130, v200 dst_sel:WORD_0 dst_unused:UNUSED_PRESERVE src0_sel:WORD_1
v_mov_b32_sdwa v131, v202 dst_sel:WORD_0 dst_unused:UNUSED_PRESERVE src0_sel:WORD_1
v_xor_b32 v245, v94, v245
s_mov_b32 vcc_lo, 0x33333333
s_mov_b32 vcc_hi, 0x33333333
v_mov_b32 v184, 0
v_mov_b32 v169, 0x3f803f80
v_cndmask_b32 v184, v184, v169, vcc
s_mov_b32 vcc_lo, 0xaaaaaaaa
s_mov_b32 vcc_hi, 0xaaaaaaaa
v_mov_b32 v251, 0x44444444
v_mov_b32 v169, 0xeeeeeeee
v_cndmask_b32 v251, v251, v169, vcc
s_mov_b32 vcc_lo, 0x0
s_mov_b32 vcc_hi, 0xaaaaaaaa
v_mov_b32 v169, 0xe4eeeeee
v_cndmask_b32 v251, v251, v169, vcc
s_mov_b32 vcc_lo, 0xffff
s_mov_b32 vcc_hi, 0xffff
v_mov_b32 v252, 0x0c0c0c0c
v_mov_b32 v169, 0x07060302
v_cndmask_b32 v252, v252, v169, vcc
s_mov_b32 vcc_lo, 0xffff0000
s_mov_b32 vcc_hi, 0xffff0000
s_waitcnt vmcnt(8)
s_barrier
ds_read_b128 v[48:51], v242 offset:50688
ds_read_b128 v[52:55], v242 offset:50944
ds_read_b128 v[56:59], v242 offset:51200
ds_read_b128 v[60:63], v242 offset:51456
ds_read_b128 v[64:67], v242 offset:54912
ds_read_b128 v[68:71], v242 offset:55168
ds_read_b128 v[72:75], v242 offset:55424
ds_read_b128 v[76:79], v242 offset:55680
v_mov_b32 v253, 0x0c0c0c0c
v_mov_b32 v169, 0x07060302
v_cndmask_b32 v253, v253, v169, vcc
v_lshl_add_u32 v181, v16, 3, s7
v_lshl_add_u32 v250, v16, 2, s52
v_exp_f32 v204, v204
v_exp_f32 v120, v205
v_exp_f32 v206, v206
v_exp_f32 v121, v207
s_waitcnt lgkmcnt(7)
v_mfma_f32_16x16x32_bf16 v[192:195], a[64:67], v[48:51], 0
s_waitcnt lgkmcnt(5)
buffer_load_dwordx4 v243, s[16:19], s99 offen offset:0 nt lds
v_mfma_f32_16x16x32_bf16 v[192:195], a[68:71], v[52:55], v[192:195]
s_waitcnt lgkmcnt(4)
buffer_load_dwordx4 v243, s[16:19], s100 offen offset:2112 nt lds
v_mfma_f32_16x16x32_bf16 v[192:195], a[72:75], v[56:59], v[192:195]
s_add_u32 s99, s55, 8192
s_add_u32 m0, s49, 8448
s_add_u32 s100, s55, 8128
v_mfma_f32_16x16x32_bf16 v[192:195], a[76:79], v[60:63], v[192:195]
v_mov_b32_sdwa v120, v204 dst_sel:WORD_0 dst_unused:UNUSED_PRESERVE src0_sel:WORD_1
v_mov_b32_sdwa v121, v206 dst_sel:WORD_0 dst_unused:UNUSED_PRESERVE src0_sel:WORD_1
v_mfma_f32_16x16x32_bf16 v[196:199], a[92:95], v[60:63], 0
v_lshl_add_u32 v166, v90, 2, s11
v_mad_u32_u24 v181, v82, s10, v181
v_mfma_f32_16x16x32_bf16 v[196:199], a[88:91], v[56:59], v[196:199]
v_lshl_add_u32 v244, v88, 4, v244
v_mad_u32_u24 v250, v82, s8, v250
v_mfma_f32_16x16x32_bf16 v[196:199], a[84:87], v[52:55], v[196:199]
v_cvt_pk_bf16_f32 v136, v192, v193
v_cvt_pk_bf16_f32 v138, v194, v195
v_mfma_f32_16x16x32_bf16 v[196:199], a[80:83], v[48:51], v[196:199]
v_lshl_add_u32 v244, v82, 5, v244
v_mad_u32_u24 v166, v81, s10, v166
v_mfma_f32_16x16x32_bf16 v[192:195], a[96:99], v[48:51], 0
s_waitcnt lgkmcnt(2)
ds_write_b32 v166, v236 offset:0
v_mfma_f32_16x16x32_bf16 v[192:195], a[100:103], v[52:55], v[192:195]
s_waitcnt lgkmcnt(1)
s_lshl_b32 s50, s43, 12
s_add_u32 s50, s50, s44
s_add_u32 s50, s50, 13107200
v_mfma_f32_16x16x32_bf16 v[192:195], a[104:107], v[56:59], v[192:195]
v_cvt_pk_bf16_f32 v137, v196, v197
v_cvt_pk_bf16_f32 v139, v198, v199
v_mfma_f32_16x16x32_bf16 v[192:195], a[108:111], v[60:63], v[192:195]
ds_write_b64 v164, v[136:137] offset:0
v_mfma_f32_16x16x32_bf16 v[196:199], a[124:127], v[60:63], 0
ds_write_b64 v164, v[138:139] offset:64
v_mfma_f32_16x16x32_bf16 v[196:199], a[116:119], v[52:55], v[196:199]
v_lshl_add_u32 v246, v92, 2, v246
v_mov_b32 v185, v184
v_mfma_f32_16x16x32_bf16 v[196:199], a[112:115], v[48:51], v[196:199]
s_nop 0
v_cvt_pk_bf16_f32 v140, v192, v193
v_cvt_pk_bf16_f32 v142, v194, v195
v_mfma_f32_16x16x32_bf16 v[196:199], a[120:123], v[56:59], v[196:199]
v_mov_b32 v186, v184
v_mov_b32 v187, v184
v_mfma_f32_16x16x32_bf16 v[192:195], a[56:59], v[56:59], 0
buffer_load_dwordx4 v243, s[16:19], s99 offen offset:0 nt lds
v_mfma_f32_16x16x32_bf16 v[192:195], a[60:63], v[60:63], v[192:195]
s_add_u32 s99, s55, 12288
buffer_load_dwordx4 v243, s[16:19], s100 offen offset:2112 nt lds
v_mfma_f32_16x16x32_bf16 v[192:195], a[52:55], v[52:55], v[192:195]
s_add_u32 m0, s49, 12672
s_add_u32 s100, s55, 12224
v_cvt_pk_bf16_f32 v141, v196, v197
v_mfma_f32_16x16x32_bf16 v[192:195], a[48:51], v[48:51], v[192:195]
ds_write_b64 v165, v[140:141] offset:0
v_mfma_f32_16x16x32_bf16 v[200:203], a[32:35], v[48:51], 0
v_cvt_pk_bf16_f32 v143, v198, v199
v_mov_b32 v118, 0
v_mfma_f32_16x16x32_bf16 v[200:203], a[36:39], v[52:55], v[200:203]
ds_write_b64 v165, v[142:143] offset:64
v_mfma_f32_16x16x32_bf16 v[200:203], a[40:43], v[56:59], v[200:203]
ds_read_b128 v[238:241], v245 offset:0
v_cvt_pk_bf16_f32 v149, v192, v193
v_mfma_f32_16x16x32_bf16 v[200:203], a[44:47], v[60:63], v[200:203]
v_cvt_pk_bf16_f32 v151, v194, v195
v_mov_b32 v119, 0
v_mfma_f32_16x16x32_bf16 v[192:195], a[28:31], v[60:63], 0
v_mov_b32 v255, 0
v_mov_b32 v134, 0
v_mfma_f32_16x16x32_bf16 v[192:195], a[24:27], v[56:59], v[192:195]
v_mov_b32 v135, 0
v_mfma_f32_16x16x32_bf16 v[192:195], a[20:23], v[52:55], v[192:195]
v_cvt_pk_bf16_f32 v148, v200, v201
v_cvt_pk_bf16_f32 v150, v202, v203
v_mfma_f32_16x16x32_bf16 v[192:195], a[16:19], v[48:51], v[192:195]
s_nop 2
v_mfma_f32_16x16x32_bf16 v[196:199], a[0:3], v[48:51], 0
s_nop 2
v_mfma_f32_16x16x32_bf16 v[196:199], a[8:11], v[56:59], v[196:199]
v_cvt_pk_bf16_f32 v145, v192, v193
v_cvt_pk_bf16_f32 v147, v194, v195
v_mfma_f32_16x16x32_bf16 v[196:199], a[12:15], v[60:63], v[196:199]
v_mfma_f32_16x16x32_bf16 v[196:199], a[4:7], v[52:55], v[196:199]
s_nop 2
v_mfma_f32_16x16x32_bf16 v[192:195], a[4:7], v[68:71], 0
s_nop 2
v_mfma_f32_16x16x32_bf16 v[192:195], a[0:3], v[64:67], v[192:195]
v_cvt_pk_bf16_f32 v144, v196, v197
v_cvt_pk_bf16_f32 v146, v198, v199
v_mfma_f32_16x16x32_bf16 v[192:195], a[8:11], v[72:75], v[192:195]
ds_write_b64 v164, v[144:145] offset:512
v_mfma_f32_16x16x32_bf16 v[192:195], a[12:15], v[76:79], v[192:195]
s_waitcnt lgkmcnt(1)
ds_write_b64 v164, v[146:147] offset:576
v_mfma_f32_16x16x32_bf16 v[196:199], v[136:139], v[144:147], 0
ds_write_b64 v165, v[148:149] offset:512
v_mfma_f32_16x16x32_bf16 v[196:199], v[140:143], v[148:151], v[196:199]
s_waitcnt vmcnt(4)
s_barrier
v_mfma_f32_16x16x32_bf16 v[200:203], a[28:31], v[76:79], 0
ds_read_b64_tr_b16 a[176:177], v183 offset:8
v_cvt_pk_bf16_f32 v32, v192, v193
v_mfma_f32_16x16x32_bf16 v[200:203], a[24:27], v[72:75], v[200:203]
ds_read_b64_tr_b16 a[178:179], v183 offset:520
v_cvt_pk_bf16_f32 v34, v194, v195
v_mfma_f32_16x16x32_bf16 v[200:203], a[20:23], v[68:71], v[200:203]
ds_read_b64_tr_b16 a[180:181], v183 offset:4104
v_mfma_f32_16x16x32_bf16 v[200:203], a[16:19], v[64:67], v[200:203]
ds_read_b64_tr_b16 a[182:183], v183 offset:4616
s_nop 0
v_mfma_f32_16x16x32_bf16 v[192:195], a[32:35], v[64:67], 0
ds_read_b64_tr_b16 a[184:185], v183 offset:8200
s_nop 0
v_mfma_f32_16x16x32_bf16 v[192:195], a[36:39], v[68:71], v[192:195]
ds_read_b64_tr_b16 a[186:187], v183 offset:8712
v_mfma_f32_16x16x32_bf16 v[192:195], a[40:43], v[72:75], v[192:195]
ds_read_b64_tr_b16 a[188:189], v183 offset:12296
v_cvt_pk_bf16_f32 v33, v200, v201
v_mfma_f32_16x16x32_bf16 v[192:195], a[44:47], v[76:79], v[192:195]
ds_read_b64_tr_b16 a[190:191], v183 offset:12808
v_cvt_pk_bf16_f32 v35, v202, v203
v_mfma_f32_16x16x32_bf16 v[200:203], a[60:63], v[76:79], 0
ds_read_b64_tr_b16 a[160:161], v183 offset:0
s_nop 0
v_mfma_f32_16x16x32_bf16 v[200:203], a[52:55], v[68:71], v[200:203]
ds_read_b64_tr_b16 a[162:163], v183 offset:512
v_mfma_f32_16x16x32_bf16 v[200:203], a[48:51], v[64:67], v[200:203]
ds_read_b64_tr_b16 a[164:165], v183 offset:4096
v_cvt_pk_bf16_f32 v36, v192, v193
v_mfma_f32_16x16x32_bf16 v[200:203], a[56:59], v[72:75], v[200:203]
ds_read_b64_tr_b16 a[166:167], v183 offset:4608
v_cvt_pk_bf16_f32 v38, v194, v195
v_mfma_f32_16x16x32_bf16 v[192:195], a[120:123], v[72:75], 0
ds_read_b64_tr_b16 a[168:169], v183 offset:8192
s_nop 0
v_mfma_f32_16x16x32_bf16 v[192:195], a[124:127], v[76:79], v[192:195]
s_waitcnt lgkmcnt(12)
ds_read_b64_tr_b16 a[170:171], v183 offset:8704
v_cvt_pk_bf16_f32 v37, v200, v201
v_mfma_f32_16x16x32_bf16 v[192:195], a[116:119], v[68:71], v[192:195]
s_waitcnt lgkmcnt(12)
ds_read_b64_tr_b16 a[172:173], v183 offset:12288
v_cvt_pk_bf16_f32 v39, v202, v203
v_mfma_f32_16x16x32_bf16 v[192:195], a[112:115], v[64:67], v[192:195]
s_waitcnt lgkmcnt(12)
ds_read_b64_tr_b16 a[174:175], v183 offset:12800
s_nop 0
v_mfma_f32_16x16x32_bf16 v[200:203], a[96:99], v[64:67], 0
s_waitcnt lgkmcnt(12)
ds_read_b64_tr_b16 a[144:145], v182 offset:8
s_nop 0
v_mfma_f32_16x16x32_bf16 v[200:203], a[100:103], v[68:71], v[200:203]
s_waitcnt lgkmcnt(12)
ds_read_b64_tr_b16 a[146:147], v182 offset:520
v_cvt_pk_bf16_f32 v29, v192, v193
v_mfma_f32_16x16x32_bf16 v[200:203], a[104:107], v[72:75], v[200:203]
s_waitcnt lgkmcnt(12)
ds_read_b64_tr_b16 a[148:149], v182 offset:4104
v_cvt_pk_bf16_f32 v31, v194, v195
v_mfma_f32_16x16x32_bf16 v[200:203], a[108:111], v[76:79], v[200:203]
s_waitcnt lgkmcnt(12)
ds_read_b64_tr_b16 a[150:151], v182 offset:4616
s_nop 0
v_mfma_f32_16x16x32_bf16 v[192:195], a[92:95], v[76:79], 0
s_waitcnt lgkmcnt(12)
ds_read_b64_tr_b16 a[152:153], v182 offset:8200
s_nop 0
v_mfma_f32_16x16x32_bf16 v[192:195], a[88:91], v[72:75], v[192:195]
s_waitcnt lgkmcnt(12)
ds_read_b64_tr_b16 a[154:155], v182 offset:8712
v_cvt_pk_bf16_f32 v28, v200, v201
v_mfma_f32_16x16x32_bf16 v[192:195], a[84:87], v[68:71], v[192:195]
s_waitcnt lgkmcnt(12)
ds_read_b64_tr_b16 a[156:157], v182 offset:12296
v_cvt_pk_bf16_f32 v30, v202, v203
v_mfma_f32_16x16x32_bf16 v[192:195], a[80:83], v[64:67], v[192:195]
s_waitcnt lgkmcnt(12)
ds_read_b64_tr_b16 a[158:159], v182 offset:12808
s_nop 0
v_mfma_f32_16x16x32_bf16 v[200:203], a[64:67], v[64:67], 0
s_waitcnt lgkmcnt(12)
ds_read_b64_tr_b16 a[128:129], v182 offset:0
s_nop 0
v_mfma_f32_16x16x32_bf16 v[200:203], a[68:71], v[68:71], v[200:203]
s_waitcnt lgkmcnt(12)
ds_read_b64_tr_b16 a[130:131], v182 offset:512
v_cvt_pk_bf16_f32 v25, v192, v193
v_mfma_f32_16x16x32_bf16 v[200:203], a[72:75], v[72:75], v[200:203]
s_waitcnt lgkmcnt(12)
ds_read_b64_tr_b16 a[132:133], v182 offset:4096
v_cvt_pk_bf16_f32 v27, v194, v195
v_mfma_f32_16x16x32_bf16 v[200:203], a[76:79], v[76:79], v[200:203]
s_waitcnt lgkmcnt(12)
ds_read_b64_tr_b16 a[134:135], v182 offset:4608
s_nop 0
v_mfma_f32_16x16x32_bf16 v[192:195], v[76:79], a[188:191], 0
s_waitcnt lgkmcnt(12)
ds_read_b64_tr_b16 a[136:137], v182 offset:8192
s_nop 0
v_mfma_f32_16x16x32_bf16 v[192:195], v[72:75], a[184:187], v[192:195]
s_waitcnt lgkmcnt(12)
ds_read_b64_tr_b16 a[138:139], v182 offset:8704
v_cvt_pk_bf16_f32 v24, v200, v201
v_mfma_f32_16x16x32_bf16 v[192:195], v[68:71], a[180:183], v[192:195]
s_waitcnt lgkmcnt(12)
ds_read_b64_tr_b16 a[140:141], v182 offset:12288
v_cvt_pk_bf16_f32 v26, v202, v203
v_mfma_f32_16x16x32_bf16 v[192:195], v[64:67], a[176:179], v[192:195]
s_waitcnt lgkmcnt(12)
ds_read_b64_tr_b16 a[142:143], v182 offset:12800
s_nop 0
v_mfma_f32_16x16x32_bf16 v[200:203], v[64:67], a[160:163], 0
s_waitcnt lgkmcnt(12)
ds_write_b64 v165, v[150:151] offset:576
v_mfma_f32_16x16x32_bf16 v[200:203], v[68:71], a[164:167], v[200:203]
s_waitcnt lgkmcnt(12)
ds_write_b64 v164, v[32:33] offset:7424
v_mfma_f32_16x16x32_bf16 v[200:203], v[72:75], a[168:171], v[200:203]
s_waitcnt lgkmcnt(12)
ds_write_b64 v164, v[34:35] offset:7488
v_mfma_f32_16x16x32_bf16 v[200:203], v[76:79], a[172:175], v[200:203]
s_waitcnt lgkmcnt(11)
ds_write_b64 v165, v[36:37] offset:7424
v_mfma_f32_16x16x32_bf16 v[204:207], v[24:27], v[32:35], 0
s_waitcnt lgkmcnt(11)
ds_write_b64 v165, v[38:39] offset:7488
v_mfma_f32_16x16x32_bf16 v[204:207], v[28:31], v[36:39], v[204:207]
s_waitcnt lgkmcnt(11)
ds_write_b64 v164, v[24:25] offset:6912
v_mfma_f32_16x16x32_bf16 v[208:211], v[76:79], a[156:159], 0
s_waitcnt lgkmcnt(11)
ds_write_b64 v164, v[26:27] offset:6976
v_mfma_f32_16x16x32_bf16 v[208:211], v[72:75], a[152:155], v[208:211]
s_waitcnt lgkmcnt(10)
ds_write_b64 v165, v[28:29] offset:6912
v_mfma_f32_16x16x32_bf16 v[208:211], v[68:71], a[148:151], v[208:211]
s_waitcnt lgkmcnt(10)
ds_write_b64 v165, v[30:31] offset:6976
v_mfma_f32_16x16x32_bf16 v[208:211], v[64:67], a[144:147], v[208:211]
s_waitcnt lgkmcnt(10)
v_cvt_pk_bf16_f32 v14, v192, v193
v_cvt_pk_bf16_f32 v15, v194, v195
v_mfma_f32_16x16x32_bf16 v[192:195], v[64:67], a[128:131], 0
s_waitcnt lgkmcnt(9)
buffer_load_dwordx4 v243, s[16:19], s99 offen offset:0 nt lds
v_mfma_f32_16x16x32_bf16 v[192:195], v[72:75], a[136:139], v[192:195]
s_add_u32 s99, s55, 16384
buffer_load_dwordx4 v243, s[16:19], s100 offen offset:2112 nt lds
v_mfma_f32_16x16x32_bf16 v[192:195], v[76:79], a[140:143], v[192:195]
s_add_u32 m0, s49, 16896
s_add_u32 s100, s55, 16320
v_cvt_pk_bf16_f32 v12, v200, v201
v_mfma_f32_16x16x32_bf16 v[192:195], v[68:71], a[132:135], v[192:195]
ds_write_b64 v181, v[14:15] offset:7296
v_mfma_f32_16x16x32_bf16 v[216:219], v[52:55], a[132:135], 0
v_cvt_pk_bf16_f32 v13, v202, v203
v_cvt_pk_bf16_f32 v10, v208, v209
v_mfma_f32_16x16x32_bf16 v[216:219], v[48:51], a[128:131], v[216:219]
ds_write_b64 v181, v[12:13] offset:7168
v_mfma_f32_16x16x32_bf16 v[216:219], v[56:59], a[136:139], v[216:219]
s_nop 0
v_cvt_pk_bf16_f32 v8, v192, v193
v_cvt_pk_bf16_f32 v9, v194, v195
v_mfma_f32_16x16x32_bf16 v[216:219], v[60:63], a[140:143], v[216:219]
v_exp_f32 v196, v196
v_mfma_f32_16x16x32_bf16 v[200:203], v[60:63], a[156:159], 0
buffer_load_dwordx4 v243, s[16:19], s99 offen offset:0 nt lds
v_mfma_f32_16x16x32_bf16 v[200:203], v[56:59], a[152:155], v[200:203]
s_add_u32 s99, s57, 0
buffer_load_dwordx4 v243, s[16:19], s100 offen offset:2112 nt lds
v_mfma_f32_16x16x32_bf16 v[200:203], v[52:55], a[148:151], v[200:203]
s_add_u32 m0, s98, 59648
s_add_u32 s100, s57, 1024
v_cvt_pk_bf16_f32 v16, v216, v217
v_mfma_f32_16x16x32_bf16 v[200:203], v[48:51], a[144:147], v[200:203]
v_cvt_pk_bf16_f32 v17, v218, v219
v_cvt_pk_bf16_f32 v11, v210, v211
v_mfma_f32_16x16x32_bf16 v[192:195], v[48:51], a[160:163], 0
ds_write_b64 v181, v[10:11] offset:7040
v_mfma_f32_16x16x32_bf16 v[192:195], v[52:55], a[164:167], v[192:195]
ds_write_b64 v181, v[8:9] offset:6912
v_mfma_f32_16x16x32_bf16 v[192:195], v[56:59], a[168:171], v[192:195]
ds_read_b128 v[208:211], v242 offset:0
v_cvt_pk_bf16_f32 v18, v200, v201
v_mfma_f32_16x16x32_bf16 v[192:195], v[60:63], a[172:175], v[192:195]
ds_write_b64 v181, v[16:17] offset:0
v_mfma_f32_16x16x32_bf16 v[216:219], v[60:63], a[188:191], 0
v_mov_b64 v[220:221], 0
v_mov_b64 v[222:223], 0
v_mfma_f32_16x16x32_bf16 v[216:219], v[56:59], a[184:187], v[216:219]
v_mov_b64 v[228:229], 0
v_mov_b64 v[230:231], 0
v_mfma_f32_16x16x32_bf16 v[216:219], v[52:55], a[180:183], v[216:219]
v_exp_f32 v197, v197
v_mfma_f32_16x16x32_bf16 v[216:219], v[48:51], a[176:179], v[216:219]
v_add_f32 v160, v196, v197
v_cvt_pk_bf16_f32 v196, v196, v197
v_smfmac_f32_16x16x64_bf16 v[220:223], v[238:241], v[152:159], v251
ds_write_b32 v167, v196 offset:0
v_smfmac_f32_16x16x64_bf16 v[228:231], v[238:241], v[96:103], v251
s_mul_i32 s48, s43, 3168
s_add_u32 s49, s49, s48
s_add_u32 s49, s49, 50688
s_mov_b32 s48, 8192
v_cvt_pk_bf16_f32 v22, v216, v217
v_cvt_pk_bf16_f32 v23, v218, v219
v_mfma_f32_16x16x32_bf16 v[216:219], v[232:235], a[188:191], 0
v_exp_f32 v198, v198
v_mfma_f32_16x16x32_bf16 v[216:219], v[224:227], a[184:187], v[216:219]
v_exp_f32 v199, v199
v_mfma_f32_16x16x32_bf16 v[216:219], v[212:215], a[180:183], v[216:219]
v_cvt_pk_bf16_f32 v197, v198, v199
v_add_f32 v161, v198, v199
v_mfma_f32_16x16x32_bf16 v[216:219], v[188:191], a[176:179], v[216:219]
ds_write_b32 v167, v197 offset:4
v_add_f32 v198, v160, v161
v_cvt_pk_bf16_f32 v19, v202, v203
v_cvt_pk_bf16_f32 v20, v192, v193
v_cvt_pk_bf16_f32 v21, v194, v195
s_nop 2
v_cvt_pk_bf16_f32 v94, v216, v217
v_cvt_pk_bf16_f32 v95, v218, v219
v_mfma_f32_16x16x32_bf16 v[216:219], v[188:191], a[160:163], 0
s_waitcnt lgkmcnt(2)
ds_write_b32 v167, v198 offset:8
v_mfma_f32_16x16x32_bf16 v[216:219], v[212:215], a[164:167], v[216:219]
ds_read_b128 v[200:203], v242 offset:256
ds_read_b128 v[192:195], v242 offset:512
v_mfma_f32_16x16x32_bf16 v[216:219], v[224:227], a[168:171], v[216:219]
ds_write_b64 v181, v[18:19] offset:128
v_mfma_f32_16x16x32_bf16 v[216:219], v[232:235], a[172:175], v[216:219]
ds_write_b64 v181, v[20:21] offset:256
v_mfma_f32_16x16x32_bf16 v[196:199], v[232:235], a[156:159], 0
ds_write_b64 v181, v[22:23] offset:384
v_mfma_f32_16x16x32_bf16 v[196:199], v[224:227], a[152:155], v[196:199]
ds_read2_b32 v[236:237], v246 offset0:0 offset1:8
v_add_f32 v220, v220, v221
v_mfma_f32_16x16x32_bf16 v[196:199], v[212:215], a[148:151], v[196:199]
s_nop 0
v_cvt_pk_bf16_f32 v90, v216, v217
v_cvt_pk_bf16_f32 v91, v218, v219
v_mfma_f32_16x16x32_bf16 v[196:199], v[188:191], a[144:147], v[196:199]
v_add_f32 v222, v222, v223
v_add_f32 v228, v228, v229
v_mfma_f32_16x16x32_bf16 v[216:219], v[188:191], a[128:131], 0
v_exp_f32 v220, v220
v_mfma_f32_16x16x32_bf16 v[216:219], v[224:227], a[136:139], v[216:219]
v_exp_f32 v222, v222
v_mfma_f32_16x16x32_bf16 v[216:219], v[232:235], a[140:143], v[216:219]
s_waitcnt lgkmcnt(5)
v_cvt_pk_bf16_f32 v86, v196, v197
v_cvt_pk_bf16_f32 v87, v198, v199
v_mfma_f32_16x16x32_bf16 v[216:219], v[212:215], a[132:135], v[216:219]
v_perm_b32 v116, v222, v220, v252
v_perm_b32 v117, v222, v220, v253
v_mfma_f32_16x16x32_bf16 v[196:199], v[200:203], a[132:135], 0
s_waitcnt lgkmcnt(4)
ds_read_b128 v[220:223], v242 offset:768
v_add_f32 v230, v230, v231
v_mfma_f32_16x16x32_bf16 v[196:199], v[208:211], a[128:131], v[196:199]
v_exp_f32 v204, v204
v_mfma_f32_16x16x32_bf16 v[196:199], v[192:195], a[136:139], v[196:199]
s_waitcnt vmcnt(4)
s_barrier
ds_read_b128 v[188:191], v242 offset:4224
v_exp_f32 v205, v205
v_exp_f32 v206, v206
v_add_f32 v160, v204, v205
v_cvt_pk_bf16_f32 v204, v204, v205
s_waitcnt lgkmcnt(1)
v_mfma_f32_16x16x32_bf16 v[196:199], v[220:223], a[140:143], v[196:199]
ds_write_b32 v167, v204 offset:256
v_exp_f32 v207, v207
s_nop 0
v_cvt_pk_bf16_f32 v205, v206, v207
v_add_f32 v161, v206, v207
v_add_f32 v206, v160, v161
ds_write_b32 v167, v205 offset:260
ds_write_b32 v167, v206 offset:264
v_cvt_pk_bf16_f32 v48, v196, v197
v_cvt_pk_bf16_f32 v49, v198, v199
v_mfma_f32_16x16x32_bf16 v[204:207], v[220:223], a[156:159], 0
ds_read_b128 v[212:215], v242 offset:4480
ds_read_b128 v[224:227], v242 offset:4736
v_mfma_f32_16x16x32_bf16 v[204:207], v[192:195], a[152:155], v[204:207]
ds_read_b128 v[232:235], v242 offset:4992
v_cvt_pk_bf16_f32 v82, v216, v217
v_mfma_f32_16x16x32_bf16 v[204:207], v[200:203], a[148:151], v[204:207]
v_cvt_pk_bf16_f32 v83, v218, v219
v_mfma_f32_16x16x32_bf16 v[204:207], v[208:211], a[144:147], v[204:207]
v_exp_f32 v228, v228
v_mfma_f32_16x16x32_bf16 v[196:199], v[208:211], a[160:163], 0
buffer_load_dwordx4 v174, s[36:39], s99 offen offset:0 lds
v_mfma_f32_16x16x32_bf16 v[196:199], v[200:203], a[164:167], v[196:199]
s_add_u32 s99, s57, 2048
buffer_load_dwordx4 v174, s[36:39], s100 offen offset:1024 lds
v_mfma_f32_16x16x32_bf16 v[196:199], v[192:195], a[168:171], v[196:199]
s_waitcnt lgkmcnt(6)
s_add_u32 s100, s57, 3072
v_cvt_pk_bf16_f32 v52, v204, v205
v_mfma_f32_16x16x32_bf16 v[196:199], v[220:223], a[172:175], v[196:199]
L_h1:
s_cbranch_execz L_h5
v_cvt_pk_bf16_f32 v53, v206, v207
s_nop 0
v_mfma_f32_16x16x32_bf16 v[204:207], v[220:223], a[188:191], 0
v_exp_f32 v230, v230
v_mfma_f32_16x16x32_bf16 v[204:207], v[192:195], a[184:187], v[204:207]
v_perm_b32 v132, v230, v228, v252
v_perm_b32 v133, v230, v228, v253
v_mfma_f32_16x16x32_bf16 v[204:207], v[200:203], a[180:183], v[204:207]
v_cvt_pk_bf16_f32 v56, v196, v197
v_cvt_pk_bf16_f32 v57, v198, v199
v_mfma_f32_16x16x32_bf16 v[204:207], v[208:211], a[176:179], v[204:207]
s_waitcnt lgkmcnt(2)
s_nop 1
v_mfma_f32_16x16x32_bf16 v[192:195], a[64:67], v[188:191], 0
s_waitcnt lgkmcnt(1)
s_nop 1
v_mfma_f32_16x16x32_bf16 v[192:195], a[68:71], v[212:215], v[192:195]
s_waitcnt lgkmcnt(0)
v_cvt_pk_bf16_f32 v60, v204, v205
v_cvt_pk_bf16_f32 v61, v206, v207
v_mfma_f32_16x16x32_bf16 v[192:195], a[72:75], v[224:227], v[192:195]
buffer_load_dwordx4 v174, s[36:39], s99 offen offset:2048 lds
v_mfma_f32_16x16x32_bf16 v[192:195], a[76:79], v[232:235], v[192:195]
s_add_u32 s99, s57, 8192
buffer_load_dwordx4 v174, s[36:39], s100 offen offset:3072 lds
v_mfma_f32_16x16x32_bf16 v[196:199], a[92:95], v[232:235], 0
s_add_u32 m0, s98, 63744
s_add_u32 s100, s57, 9216
s_mov_b32 s98, s50
v_mfma_f32_16x16x32_bf16 v[196:199], a[88:91], v[224:227], v[196:199]
s_nop 0
v_cvt_pk_bf16_f32 v8, v192, v193
v_cvt_pk_bf16_f32 v9, v194, v195
v_mfma_f32_16x16x32_bf16 v[196:199], a[84:87], v[212:215], v[196:199]
v_mfma_f32_16x16x32_bf16 v[196:199], a[80:83], v[188:191], v[196:199]
s_nop 2
v_mfma_f32_16x16x32_bf16 v[192:195], a[96:99], v[188:191], 0
s_nop 2
v_mfma_f32_16x16x32_bf16 v[192:195], a[100:103], v[212:215], v[192:195]
v_cvt_pk_bf16_f32 v10, v196, v197
v_cvt_pk_bf16_f32 v11, v198, v199
v_mfma_f32_16x16x32_bf16 v[192:195], a[104:107], v[224:227], v[192:195]
v_mfma_f32_16x16x32_bf16 v[192:195], a[108:111], v[232:235], v[192:195]
s_nop 2
v_mfma_f32_16x16x32_bf16 v[196:199], a[124:127], v[232:235], 0
buffer_load_dwordx4 v174, s[36:39], s99 offen offset:0 lds
v_mfma_f32_16x16x32_bf16 v[196:199], a[120:123], v[224:227], v[196:199]
s_add_u32 s99, s57, 10240
buffer_load_dwordx4 v174, s[36:39], s100 offen offset:1024 lds
v_mfma_f32_16x16x32_bf16 v[196:199], a[116:119], v[212:215], v[196:199]
s_add_u32 s100, s57, 11264
v_cvt_pk_bf16_f32 v12, v192, v193
v_cvt_pk_bf16_f32 v13, v194, v195
v_mfma_f32_16x16x32_bf16 v[196:199], a[112:115], v[188:191], v[196:199]
s_nop 2
v_mfma_f32_16x16x32_bf16 v[192:195], v[188:191], a[128:131], 0
s_nop 2
v_mfma_f32_16x16x32_bf16 v[192:195], v[212:215], a[132:135], v[192:195]
v_cvt_pk_bf16_f32 v14, v196, v197
v_cvt_pk_bf16_f32 v15, v198, v199
v_mfma_f32_16x16x32_bf16 v[192:195], v[224:227], a[136:139], v[192:195]
v_mfma_f32_16x16x32_bf16 v[192:195], v[232:235], a[140:143], v[192:195]
s_nop 2
v_mfma_f32_16x16x32_bf16 v[196:199], v[12:15], v[156:159], 0
s_nop 2
v_mfma_f32_16x16x32_bf16 v[196:199], v[8:11], v[152:155], v[196:199]
v_cvt_pk_bf16_f32 v50, v192, v193
v_cvt_pk_bf16_f32 v51, v194, v195
v_mfma_f32_16x16x32_bf16 v[192:195], v[8:11], v[96:99], 0
buffer_load_dwordx4 v174, s[36:39], s99 offen offset:2048 lds
v_mfma_f32_16x16x32_bf16 v[192:195], v[12:15], v[100:103], v[192:195]
s_add_u32 s99, s98, s51
buffer_load_dwordx4 v174, s[36:39], s100 offen offset:3072 lds
v_mfma_f32_16x16x32_bf16 v[200:203], v[232:235], a[156:159], 0
s_add_u32 s100, s99, s51
ds_read_b128 v[204:207], v242 offset:8448
ds_read_b128 v[208:211], v242 offset:8704
v_mfma_f32_16x16x32_bf16 v[200:203], v[224:227], a[152:155], v[200:203]
s_add_u32 m0, s49, 0
ds_read_b128 v[216:219], v242 offset:8960
ds_read_b128 v[220:223], v242 offset:9216
v_mfma_f32_16x16x32_bf16 v[200:203], v[212:215], a[148:151], v[200:203]
s_add_u32 s101, s100, s51
v_exp_f32 v196, v196
v_mfma_f32_16x16x32_bf16 v[200:203], v[188:191], a[144:147], v[200:203]
v_exp_f32 v106, v197
v_mfma_f32_16x16x32_bf16 v[228:231], v[188:191], a[160:163], 0
v_exp_f32 v198, v198
v_mfma_f32_16x16x32_bf16 v[228:231], v[212:215], a[164:167], v[228:231]
v_exp_f32 v107, v199
v_mfma_f32_16x16x32_bf16 v[228:231], v[224:227], a[168:171], v[228:231]
v_mov_b32_sdwa v106, v196 dst_sel:WORD_0 dst_unused:UNUSED_PRESERVE src0_sel:WORD_1
v_mov_b32_sdwa v107, v198 dst_sel:WORD_0 dst_unused:UNUSED_PRESERVE src0_sel:WORD_1
v_mfma_f32_16x16x32_bf16 v[228:231], v[232:235], a[172:175], v[228:231]
v_cvt_pk_bf16_f32 v54, v200, v201
v_cvt_pk_bf16_f32 v55, v202, v203
v_mfma_f32_16x16x32_bf16 v[196:199], v[232:235], a[188:191], 0
v_exp_f32 v192, v192
v_mfma_f32_16x16x32_bf16 v[196:199], v[224:227], a[184:187], v[196:199]
v_exp_f32 v122, v193
v_mfma_f32_16x16x32_bf16 v[196:199], v[212:215], a[180:183], v[196:199]
s_waitcnt lgkmcnt(3)
v_exp_f32 v194, v194
v_mfma_f32_16x16x32_bf16 v[196:199], v[188:191], a[176:179], v[196:199]
s_waitcnt lgkmcnt(2)
v_exp_f32 v123, v195
v_mfma_f32_16x16x32_bf16 v[200:203], a[64:67], v[204:207], 0
s_waitcnt lgkmcnt(1)
v_mov_b32_sdwa v122, v192 dst_sel:WORD_0 dst_unused:UNUSED_PRESERVE src0_sel:WORD_1
v_mov_b32_sdwa v123, v194 dst_sel:WORD_0 dst_unused:UNUSED_PRESERVE src0_sel:WORD_1
v_mfma_f32_16x16x32_bf16 v[200:203], a[68:71], v[208:211], v[200:203]
s_waitcnt lgkmcnt(0)
v_cvt_pk_bf16_f32 v62, v196, v197
v_cvt_pk_bf16_f32 v63, v198, v199
v_mfma_f32_16x16x32_bf16 v[200:203], a[72:75], v[216:219], v[200:203]
v_cvt_pk_bf16_f32 v58, v228, v229
v_cvt_pk_bf16_f32 v59, v230, v231
v_mfma_f32_16x16x32_bf16 v[200:203], a[76:79], v[220:223], v[200:203]
s_nop 2
v_mfma_f32_16x16x32_bf16 v[192:195], a[92:95], v[220:223], 0
s_nop 2
v_mfma_f32_16x16x32_bf16 v[192:195], a[88:91], v[216:219], v[192:195]
v_cvt_pk_bf16_f32 v16, v200, v201
v_cvt_pk_bf16_f32 v17, v202, v203
v_mfma_f32_16x16x32_bf16 v[192:195], a[84:87], v[208:211], v[192:195]
v_mfma_f32_16x16x32_bf16 v[192:195], a[80:83], v[204:207], v[192:195]
s_nop 2
v_mfma_f32_16x16x32_bf16 v[196:199], a[96:99], v[204:207], 0
s_nop 2
v_mfma_f32_16x16x32_bf16 v[196:199], a[100:103], v[208:211], v[196:199]
v_cvt_pk_bf16_f32 v18, v192, v193
v_cvt_pk_bf16_f32 v19, v194, v195
v_mfma_f32_16x16x32_bf16 v[196:199], a[104:107], v[216:219], v[196:199]
v_mfma_f32_16x16x32_bf16 v[196:199], a[108:111], v[220:223], v[196:199]
s_nop 2
v_mfma_f32_16x16x32_bf16 v[192:195], a[124:127], v[220:223], 0
s_nop 2
v_mfma_f32_16x16x32_bf16 v[192:195], a[120:123], v[216:219], v[192:195]
v_cvt_pk_bf16_f32 v20, v196, v197
v_cvt_pk_bf16_f32 v21, v198, v199
v_mfma_f32_16x16x32_bf16 v[192:195], a[116:119], v[208:211], v[192:195]
v_mfma_f32_16x16x32_bf16 v[192:195], a[112:115], v[204:207], v[192:195]
s_nop 2
v_mfma_f32_16x16x32_bf16 v[196:199], v[204:207], a[128:131], 0
s_nop 2
v_mfma_f32_16x16x32_bf16 v[196:199], v[208:211], a[132:135], v[196:199]
v_cvt_pk_bf16_f32 v22, v192, v193
v_cvt_pk_bf16_f32 v23, v194, v195
v_mfma_f32_16x16x32_bf16 v[196:199], v[216:219], a[136:139], v[196:199]
v_mfma_f32_16x16x32_bf16 v[196:199], v[220:223], a[140:143], v[196:199]
s_nop 2
v_mfma_f32_16x16x32_bf16 v[192:195], v[20:23], v[156:159], 0
s_nop 2
v_mfma_f32_16x16x32_bf16 v[192:195], v[16:19], v[152:155], v[192:195]
v_cvt_pk_bf16_f32 v64, v196, v197
v_cvt_pk_bf16_f32 v65, v198, v199
v_mfma_f32_16x16x32_bf16 v[196:199], v[16:19], v[96:99], 0
s_nop 2
v_mfma_f32_16x16x32_bf16 v[196:199], v[20:23], v[100:103], v[196:199]
s_nop 0
v_exp_f32 v192, v192
v_mfma_f32_16x16x32_bf16 v[200:203], v[220:223], a[156:159], 0
v_exp_f32 v108, v193
v_mfma_f32_16x16x32_bf16 v[200:203], v[216:219], a[152:155], v[200:203]
v_exp_f32 v194, v194
v_mfma_f32_16x16x32_bf16 v[200:203], v[208:211], a[148:151], v[200:203]
v_exp_f32 v109, v195
v_mfma_f32_16x16x32_bf16 v[200:203], v[204:207], a[144:147], v[200:203]
s_waitcnt vmcnt(0)
s_barrier
v_mfma_f32_16x16x32_bf16 v[228:231], v[204:207], a[160:163], 0
ds_read_b128 v[188:191], v242 offset:16896
v_mov_b32_sdwa v108, v192 dst_sel:WORD_0 dst_unused:UNUSED_PRESERVE src0_sel:WORD_1
v_mfma_f32_16x16x32_bf16 v[228:231], v[208:211], a[164:167], v[228:231]
ds_read_b128 v[212:215], v242 offset:17152
v_mov_b32_sdwa v109, v194 dst_sel:WORD_0 dst_unused:UNUSED_PRESERVE src0_sel:WORD_1
v_mfma_f32_16x16x32_bf16 v[228:231], v[216:219], a[168:171], v[228:231]
ds_read_b128 v[224:227], v242 offset:17408
v_cvt_pk_bf16_f32 v68, v200, v201
v_mfma_f32_16x16x32_bf16 v[228:231], v[220:223], a[172:175], v[228:231]
ds_read_b128 v[232:235], v242 offset:17664
v_cvt_pk_bf16_f32 v69, v202, v203
v_mfma_f32_16x16x32_bf16 v[192:195], v[220:223], a[188:191], 0
ds_read_b64_tr_b16 a[192:193], v182 offset:0
s_nop 0
v_mfma_f32_16x16x32_bf16 v[192:195], v[216:219], a[184:187], v[192:195]
ds_read_b64_tr_b16 a[194:195], v182 offset:512
v_mfma_f32_16x16x32_bf16 v[192:195], v[208:211], a[180:183], v[192:195]
s_waitcnt lgkmcnt(5)
ds_read_b64_tr_b16 a[196:197], v182 offset:4096
v_cvt_pk_bf16_f32 v72, v228, v229
v_mfma_f32_16x16x32_bf16 v[192:195], v[204:207], a[176:179], v[192:195]
buffer_load_dwordx4 v243, s[16:19], s98 offen offset:0 nt lds
v_mfma_f32_16x16x32_bf16 v[200:203], a[64:67], v[188:191], 0
s_waitcnt lgkmcnt(4)
ds_read_b64_tr_b16 a[198:199], v182 offset:4608
v_cvt_pk_bf16_f32 v73, v230, v231
v_mfma_f32_16x16x32_bf16 v[200:203], a[68:71], v[212:215], v[200:203]
s_waitcnt lgkmcnt(4)
ds_read_b64_tr_b16 a[200:201], v182 offset:8192
v_cvt_pk_bf16_f32 v76, v192, v193
v_mfma_f32_16x16x32_bf16 v[200:203], a[72:75], v[224:227], v[200:203]
ds_read_b64_tr_b16 a[202:203], v182 offset:8704
v_cvt_pk_bf16_f32 v77, v194, v195
v_mfma_f32_16x16x32_bf16 v[200:203], a[76:79], v[232:235], v[200:203]
ds_read_b64_tr_b16 a[204:205], v182 offset:12288
s_nop 0
v_mfma_f32_16x16x32_bf16 v[192:195], a[92:95], v[232:235], 0
ds_read_b64_tr_b16 a[206:207], v182 offset:12800
s_nop 0
v_mfma_f32_16x16x32_bf16 v[192:195], a[88:91], v[224:227], v[192:195]
ds_read_b64_tr_b16 a[208:209], v182 offset:8
v_mfma_f32_16x16x32_bf16 v[192:195], a[84:87], v[212:215], v[192:195]
ds_read_b64_tr_b16 a[210:211], v182 offset:520
v_cvt_pk_bf16_f32 v32, v200, v201
v_mfma_f32_16x16x32_bf16 v[192:195], a[80:83], v[188:191], v[192:195]
buffer_load_dwordx4 v243, s[16:19], s99 offen offset:1056 nt lds
v_mfma_f32_16x16x32_bf16 v[204:207], a[96:99], v[188:191], 0
ds_read_b64_tr_b16 a[212:213], v182 offset:4104
v_cvt_pk_bf16_f32 v33, v202, v203
v_mfma_f32_16x16x32_bf16 v[204:207], a[100:103], v[212:215], v[204:207]
s_waitcnt lgkmcnt(10)
ds_read_b64_tr_b16 a[214:215], v182 offset:4616
v_mfma_f32_16x16x32_bf16 v[204:207], a[104:107], v[224:227], v[204:207]
s_waitcnt lgkmcnt(10)
ds_read_b64_tr_b16 a[216:217], v182 offset:8200
v_cvt_pk_bf16_f32 v34, v192, v193
v_mfma_f32_16x16x32_bf16 v[204:207], a[108:111], v[232:235], v[204:207]
s_waitcnt lgkmcnt(10)
ds_read_b64_tr_b16 a[218:219], v182 offset:8712
v_cvt_pk_bf16_f32 v35, v194, v195
v_mfma_f32_16x16x32_bf16 v[192:195], a[124:127], v[232:235], 0
ds_read_b64_tr_b16 a[220:221], v182 offset:12296
s_nop 0
v_mfma_f32_16x16x32_bf16 v[192:195], a[120:123], v[224:227], v[192:195]
s_waitcnt lgkmcnt(11)
ds_read_b64_tr_b16 a[222:223], v182 offset:12808
v_cvt_pk_bf16_f32 v36, v204, v205
v_mfma_f32_16x16x32_bf16 v[192:195], a[116:119], v[212:215], v[192:195]
s_waitcnt lgkmcnt(11)
ds_read_b64_tr_b16 a[224:225], v183 offset:0
v_cvt_pk_bf16_f32 v37, v206, v207
v_mfma_f32_16x16x32_bf16 v[192:195], a[112:115], v[188:191], v[192:195]
buffer_load_dwordx4 v243, s[16:19], s100 offen offset:2112 nt lds
v_mfma_f32_16x16x32_bf16 v[200:203], v[188:191], a[128:131], 0
s_waitcnt lgkmcnt(10)
ds_read_b64_tr_b16 a[226:227], v183 offset:512
s_nop 0
v_mfma_f32_16x16x32_bf16 v[200:203], v[212:215], a[132:135], v[200:203]
s_waitcnt lgkmcnt(10)
ds_read_b64_tr_b16 a[228:229], v183 offset:4096
v_cvt_pk_bf16_f32 v38, v192, v193
v_mfma_f32_16x16x32_bf16 v[200:203], v[224:227], a[136:139], v[200:203]
s_waitcnt lgkmcnt(10)
ds_read_b64_tr_b16 a[230:231], v183 offset:4608
v_cvt_pk_bf16_f32 v39, v194, v195
v_mfma_f32_16x16x32_bf16 v[200:203], v[232:235], a[140:143], v[200:203]
s_waitcnt lgkmcnt(10)
ds_read_b64_tr_b16 a[232:233], v183 offset:8192
s_nop 0
v_mfma_f32_16x16x32_bf16 v[192:195], v[36:39], v[156:159], 0
ds_read_b64_tr_b16 a[234:235], v183 offset:8704
s_nop 0
v_mfma_f32_16x16x32_bf16 v[192:195], v[32:35], v[152:155], v[192:195]
s_waitcnt lgkmcnt(11)
ds_read_b64_tr_b16 a[236:237], v183 offset:12288
v_cvt_pk_bf16_f32 v80, v200, v201
v_mfma_f32_16x16x32_bf16 v[204:207], v[32:35], v[96:99], 0
s_waitcnt lgkmcnt(11)
ds_read_b64_tr_b16 a[238:239], v183 offset:12800
v_cvt_pk_bf16_f32 v81, v202, v203
v_mfma_f32_16x16x32_bf16 v[204:207], v[36:39], v[100:103], v[204:207]
s_waitcnt lgkmcnt(11)
ds_read_b64_tr_b16 a[240:241], v183 offset:8
s_nop 0
v_mfma_f32_16x16x32_bf16 v[200:203], v[232:235], a[156:159], 0
s_waitcnt lgkmcnt(11)
ds_read_b64_tr_b16 a[242:243], v183 offset:520
ds_read_b128 v[208:211], v242 offset:12672
v_mfma_f32_16x16x32_bf16 v[200:203], v[224:227], a[152:155], v[200:203]
s_waitcnt lgkmcnt(12)
ds_read_b128 v[216:219], v242 offset:12928
ds_read_b128 v[220:223], v242 offset:13184
v_mfma_f32_16x16x32_bf16 v[200:203], v[212:215], a[148:151], v[200:203]
s_waitcnt lgkmcnt(13)
v_exp_f32 v192, v192
v_mfma_f32_16x16x32_bf16 v[200:203], v[188:191], a[144:147], v[200:203]
buffer_load_dwordx4 v243, s[16:19], s101 offen offset:3168 nt lds
v_mfma_f32_16x16x32_bf16 v[228:231], v[188:191], a[160:163], 0
s_waitcnt lgkmcnt(12)
v_exp_f32 v112, v193
v_mfma_f32_16x16x32_bf16 v[228:231], v[212:215], a[164:167], v[228:231]
s_waitcnt lgkmcnt(11)
v_exp_f32 v194, v194
v_mfma_f32_16x16x32_bf16 v[228:231], v[224:227], a[168:171], v[228:231]
s_waitcnt lgkmcnt(10)
ds_read_b64_tr_b16 a[244:245], v183 offset:4104
v_mov_b32_sdwa v112, v192 dst_sel:WORD_0 dst_unused:UNUSED_PRESERVE src0_sel:WORD_1
v_mfma_f32_16x16x32_bf16 v[228:231], v[232:235], a[172:175], v[228:231]
s_waitcnt lgkmcnt(10)
ds_read_b64_tr_b16 a[246:247], v183 offset:4616
v_exp_f32 v113, v195
s_nop 0
v_mov_b32_sdwa v113, v194 dst_sel:WORD_0 dst_unused:UNUSED_PRESERVE src0_sel:WORD_1
v_mfma_f32_16x16x32_bf16 v[192:195], v[232:235], a[188:191], 0
s_waitcnt lgkmcnt(9)
ds_read_b64_tr_b16 a[248:249], v183 offset:8200
v_cvt_pk_bf16_f32 v88, v228, v229
v_mfma_f32_16x16x32_bf16 v[192:195], v[224:227], a[184:187], v[192:195]
s_waitcnt lgkmcnt(9)
ds_read_b64_tr_b16 a[250:251], v183 offset:8712
v_cvt_pk_bf16_f32 v89, v230, v231
v_mfma_f32_16x16x32_bf16 v[192:195], v[212:215], a[180:183], v[192:195]
s_waitcnt lgkmcnt(6)
ds_read_b64_tr_b16 a[252:253], v183 offset:12296
v_cvt_pk_bf16_f32 v84, v200, v201
v_mfma_f32_16x16x32_bf16 v[192:195], v[188:191], a[176:179], v[192:195]
s_waitcnt lgkmcnt(6)
ds_read_b64_tr_b16 a[254:255], v183 offset:12808
v_cvt_pk_bf16_f32 v85, v202, v203
v_mfma_f32_16x16x32_bf16 v[228:231], a[64:67], v[208:211], 0
s_waitcnt lgkmcnt(6)
ds_read_b128 v[200:203], v242 offset:13440
s_nop 0
v_mfma_f32_16x16x32_bf16 v[228:231], a[68:71], v[216:219], v[228:231]
v_cvt_pk_bf16_f32 v92, v192, v193
v_cvt_pk_bf16_f32 v93, v194, v195
v_mfma_f32_16x16x32_bf16 v[228:231], a[72:75], v[220:223], v[228:231]
v_exp_f32 v204, v204
v_exp_f32 v128, v205
v_exp_f32 v206, v206
v_exp_f32 v129, v207
v_mov_b32_sdwa v128, v204 dst_sel:WORD_0 dst_unused:UNUSED_PRESERVE src0_sel:WORD_1
v_mov_b32_sdwa v129, v206 dst_sel:WORD_0 dst_unused:UNUSED_PRESERVE src0_sel:WORD_1
v_exp_f32 v196, v196
s_waitcnt lgkmcnt(0)
v_mfma_f32_16x16x32_bf16 v[228:231], a[76:79], v[200:203], v[228:231]
s_barrier
v_mfma_f32_16x16x32_bf16 v[192:195], a[92:95], v[200:203], 0
s_add_u32 s98, s98, s48
v_exp_f32 v124, v197
v_mfma_f32_16x16x32_bf16 v[192:195], a[88:91], v[220:223], v[192:195]
s_add_u32 s99, s98, s51
v_exp_f32 v198, v198
v_mfma_f32_16x16x32_bf16 v[192:195], a[84:87], v[216:219], v[192:195]
s_add_u32 s100, s99, s51
s_add_u32 m0, s49, 8448
s_add_u32 s101, s100, s51
v_mfma_f32_16x16x32_bf16 v[192:195], a[80:83], v[208:211], v[192:195]
buffer_load_dwordx4 v243, s[16:19], s98 offen offset:0 nt lds
v_cvt_pk_bf16_f32 v24, v228, v229
v_cvt_pk_bf16_f32 v25, v230, v231
v_mfma_f32_16x16x32_bf16 v[228:231], a[96:99], v[208:211], 0
s_add_u32 s98, s98, s48
v_exp_f32 v125, v199
v_mfma_f32_16x16x32_bf16 v[228:231], a[100:103], v[216:219], v[228:231]
s_bfe_i32 s57, s3, 0x10000
v_cvt_pk_bf16_f32 v26, v192, v193
v_cvt_pk_bf16_f32 v27, v194, v195
v_mfma_f32_16x16x32_bf16 v[228:231], a[104:107], v[220:223], v[228:231]
s_and_b32 s54, s57, s5
v_mov_b32_sdwa v124, v196 dst_sel:WORD_0 dst_unused:UNUSED_PRESERVE src0_sel:WORD_1
v_mov_b32_sdwa v125, v198 dst_sel:WORD_0 dst_unused:UNUSED_PRESERVE src0_sel:WORD_1
v_mfma_f32_16x16x32_bf16 v[228:231], a[108:111], v[200:203], v[228:231]
s_add_u32 s50, s50, 13107200
ds_read_b128 v[196:199], v247 offset:0
v_add_u32 v245, 1728, v245
v_mfma_f32_16x16x32_bf16 v[192:195], a[124:127], v[200:203], 0
s_mov_b32 s47, s46
v_add_u32 v246, 1728, v246
v_add_u32 v247, 1728, v247
v_mfma_f32_16x16x32_bf16 v[192:195], a[120:123], v[220:223], v[192:195]
s_lshr_b32 s3, s3, 1
v_cvt_pk_bf16_f32 v28, v228, v229
v_cvt_pk_bf16_f32 v29, v230, v231
v_mfma_f32_16x16x32_bf16 v[192:195], a[116:119], v[216:219], v[192:195]
s_sub_u32 s45, s45, 1
s_sub_u32 s50, s50, s54
s_add_u32 s52, s46, 20480
v_mfma_f32_16x16x32_bf16 v[192:195], a[112:115], v[208:211], v[192:195]
buffer_load_dwordx4 v243, s[16:19], s99 offen offset:1056 nt lds
v_mfma_f32_16x16x32_bf16 v[204:207], v[208:211], a[128:131], 0
s_add_u32 s99, s98, s51
s_add_u32 s53, s46, 0
s_nop 0
v_mfma_f32_16x16x32_bf16 v[204:207], v[216:219], a[132:135], v[204:207]
s_nop 1
v_cvt_pk_bf16_f32 v30, v192, v193
v_mfma_f32_16x16x32_bf16 v[204:207], v[220:223], a[136:139], v[204:207]
v_cvt_pk_bf16_f32 v31, v194, v195
v_mfma_f32_16x16x32_bf16 v[204:207], v[200:203], a[140:143], v[204:207]
v_mov_b64 v[168:169], 0
v_mov_b64 v[170:171], 0
v_mfma_f32_16x16x32_bf16 v[192:195], v[28:31], v[156:159], 0
v_mov_b64 v[172:173], 0
v_mov_b64 v[174:175], 0
v_mfma_f32_16x16x32_bf16 v[192:195], v[24:27], v[152:155], v[192:195]
v_mov_b64 v[176:177], 0
s_nop 0
v_cvt_pk_bf16_f32 v66, v204, v205
v_cvt_pk_bf16_f32 v67, v206, v207
v_mfma_f32_16x16x32_bf16 v[204:207], v[24:27], v[96:99], 0
s_waitcnt lgkmcnt(0)
v_mov_b64 v[178:179], 0
v_mfma_f32_16x16x32_bf16 v[204:207], v[28:31], v[100:103], v[204:207]
ds_read_b128 v[152:155], v242 offset:21120
ds_read_b128 v[156:159], v242 offset:21376
v_smfmac_f32_16x16x64_bf16 v[168:171], v[196:199], v[0:7], v251
ds_read_b128 v[160:163], v242 offset:21632
ds_read_b128 v[164:167], v242 offset:21888
v_smfmac_f32_16x16x64_bf16 v[172:175], v[196:199], v[16:23], v251
s_nop 2
v_smfmac_f32_16x16x64_bf16 v[176:179], v[196:199], v[32:39], v251
s_nop 0
v_add_f32 v168, v168, v169
v_mfma_f32_16x16x32_bf16 v[228:231], v[200:203], a[156:159], 0
v_exp_f32 v192, v192
v_mfma_f32_16x16x32_bf16 v[228:231], v[220:223], a[152:155], v[228:231]
v_exp_f32 v110, v193
v_mfma_f32_16x16x32_bf16 v[228:231], v[216:219], a[148:151], v[228:231]
v_exp_f32 v194, v194
v_mfma_f32_16x16x32_bf16 v[228:231], v[208:211], a[144:147], v[228:231]
v_exp_f32 v111, v195
v_smfmac_f32_16x16x64_bf16 v[170:173], v[196:199], v[8:15], v251
v_mov_b32_sdwa v110, v192 dst_sel:WORD_0 dst_unused:UNUSED_PRESERVE src0_sel:WORD_1
v_smfmac_f32_16x16x64_bf16 v[174:177], v[196:199], v[24:31], v251
v_mov_b32_sdwa v111, v194 dst_sel:WORD_0 dst_unused:UNUSED_PRESERVE src0_sel:WORD_1
v_smfmac_f32_16x16x64_bf16 v[178:181], v[196:199], v[40:47], v251
s_nop 1
v_cvt_pk_bf16_f32 v70, v228, v229
v_mfma_f32_16x16x32_bf16 v[192:195], v[208:211], a[160:163], 0
v_cvt_pk_bf16_f32 v71, v230, v231
v_add_f32 v170, v170, v171
v_mfma_f32_16x16x32_bf16 v[192:195], v[216:219], a[164:167], v[192:195]
v_exp_f32 v204, v204
v_mfma_f32_16x16x32_bf16 v[192:195], v[220:223], a[168:171], v[192:195]
s_waitcnt lgkmcnt(2)
v_exp_f32 v126, v205
v_mfma_f32_16x16x32_bf16 v[192:195], v[200:203], a[172:175], v[192:195]
buffer_load_dwordx4 v243, s[16:19], s100 offen offset:2112 nt lds
v_mfma_f32_16x16x32_bf16 v[196:199], v[200:203], a[188:191], 0
s_waitcnt lgkmcnt(0)
ds_read_b128 v[200:203], v242 offset:0
v_mov_b64 v[228:229], 0
v_mfma_f32_16x16x32_bf16 v[196:199], v[220:223], a[184:187], v[196:199]
s_add_u32 s100, s99, s51
ds_read_b128 v[220:223], v242 offset:256
v_cvt_pk_bf16_f32 v74, v192, v193
v_mfma_f32_16x16x32_bf16 v[196:199], v[216:219], a[180:183], v[196:199]
ds_read_b128 v[216:219], v242 offset:512
v_cvt_pk_bf16_f32 v75, v194, v195
v_mfma_f32_16x16x32_bf16 v[196:199], v[208:211], a[176:179], v[196:199]
ds_read_b128 v[192:195], v242 offset:768
v_mov_b32_sdwa v126, v204 dst_sel:WORD_0 dst_unused:UNUSED_PRESERVE src0_sel:WORD_1
v_smfmac_f32_16x16x64_bf16 v[228:231], v[184:187], v[104:111], v251
v_add_f32 v172, v172, v173
v_smfmac_f32_16x16x64_bf16 v[228:231], v[184:187], v[112:119], v251 abid:1
v_add_f32 v174, v174, v175
v_mfma_f32_16x16x32_bf16 v[136:139], a[192:195], v[152:155], 0
v_exp_f32 v168, v168
v_mfma_f32_16x16x32_bf16 v[136:139], a[196:199], v[156:159], v[136:139]
v_exp_f32 v170, v170
v_mfma_f32_16x16x32_bf16 v[136:139], a[200:203], v[160:163], v[136:139]
v_exp_f32 v172, v172
v_mfma_f32_16x16x32_bf16 v[136:139], a[204:207], v[164:167], v[136:139]
buffer_load_dwordx4 v243, s[16:19], s101 offen offset:3168 nt lds
v_mfma_f32_16x16x32_bf16 v[140:143], a[220:223], v[164:167], 0
s_add_u32 m0, s49, 16896
v_exp_f32 v174, v174
v_mfma_f32_16x16x32_bf16 v[140:143], a[216:219], v[160:163], v[140:143]
s_add_u32 s101, s100, s51
v_add_f32 v176, v176, v177
v_add_f32 v178, v178, v179
v_mfma_f32_16x16x32_bf16 v[140:143], a[212:215], v[156:159], v[140:143]
s_and_b32 s51, s57, 13106176
v_exp_f32 v176, v176
v_mfma_f32_16x16x32_bf16 v[140:143], a[208:211], v[152:155], v[140:143]
s_waitcnt lgkmcnt(3)
v_add_f32 v180, v168, v170
v_cvt_pk_bf16_f32 v169, v168, v170
v_mfma_f32_16x16x32_bf16 v[144:147], a[224:227], v[152:155], 0
s_waitcnt lgkmcnt(2)
ds_write_b16 v248, v169 offset:0
v_mfma_f32_16x16x32_bf16 v[144:147], a[228:231], v[156:159], v[144:147]
s_waitcnt lgkmcnt(2)
ds_write_b16_d16_hi v248, v169 offset:4
v_mfma_f32_16x16x32_bf16 v[144:147], a[232:235], v[160:163], v[144:147]
s_waitcnt lgkmcnt(2)
v_exp_f32 v178, v178
v_mfma_f32_16x16x32_bf16 v[144:147], a[236:239], v[164:167], v[144:147]
buffer_load_dwordx4 v243, s[16:19], s98 offen offset:0 nt lds
v_mfma_f32_16x16x32_bf16 v[148:151], a[252:255], v[164:167], 0
s_lshl3_add_u32 s48, s51, 8192
v_add_f32 v180, v180, v172
v_add_f32 v180, v180, v174
v_mfma_f32_16x16x32_bf16 v[148:151], a[244:247], v[156:159], v[148:151]
s_sub_u32 s49, s49, s56
v_add_f32 v180, v180, v176
v_add_f32 v180, v180, v178
v_mfma_f32_16x16x32_bf16 v[148:151], a[240:243], v[152:155], v[148:151]
s_sub_u32 s51, s51, 32
v_cvt_pk_bf16_f32 v173, v172, v174
v_add_f32_dpp v180, v180, v180 row_ror:8 row_mask:0xf bank_mask:0xf
v_mfma_f32_16x16x32_bf16 v[148:151], a[248:251], v[160:163], v[148:151]
ds_write_b16 v248, v173 offset:272
v_mfma_f32_16x16x32_bf16 v[164:167], a[248:251], v[216:219], 0
ds_write_b16_d16_hi v248, v173 offset:276
v_mfma_f32_16x16x32_bf16 v[164:167], a[252:255], v[192:195], v[164:167]
v_cvt_pk_bf16_f32 v177, v176, v178
v_add_f32_dpp v180, v180, v180 row_ror:4 row_mask:0xf bank_mask:0xf
v_mfma_f32_16x16x32_bf16 v[164:167], a[244:247], v[220:223], v[164:167]
ds_write_b16 v248, v177 offset:544
v_mfma_f32_16x16x32_bf16 v[164:167], a[240:243], v[200:203], v[164:167]
buffer_load_dwordx4 v243, s[16:19], s99 offen offset:1056 nt lds
v_mfma_f32_16x16x32_bf16 v[160:163], a[224:227], v[200:203], 0
ds_write_b32 v250, v180 offset:256
v_mfma_f32_16x16x32_bf16 v[160:163], a[228:231], v[220:223], v[160:163]
ds_write_b16_d16_hi v248, v177 offset:548
v_mfma_f32_16x16x32_bf16 v[160:163], a[232:235], v[216:219], v[160:163]
ds_read_b128 v[208:211], v249 offset:0
v_add_f32 v228, v228, v229
v_mfma_f32_16x16x32_bf16 v[160:163], a[236:239], v[192:195], v[160:163]
v_exp_f32 v206, v206
v_mfma_f32_32x32x16_bf16 v[168:183], v[236:239], v[116:119], 0
v_exp_f32 v127, v207
v_rcp_f32 v254, v228
v_mov_b32_sdwa v127, v206 dst_sel:WORD_0 dst_unused:UNUSED_PRESERVE src0_sel:WORD_1
v_cvt_pk_bf16_f32 v78, v196, v197
v_mfma_f32_16x16x32_bf16 v[156:159], a[220:223], v[192:195], 0
v_cvt_pk_bf16_f32 v79, v198, v199
v_max3_f32 v255, v255, v228, v254
v_mfma_f32_16x16x32_bf16 v[156:159], a[216:219], v[216:219], v[156:159]
v_mfma_f32_16x16x32_bf16 v[156:159], a[212:215], v[220:223], v[156:159]
v_mfma_f32_16x16x32_bf16 v[156:159], a[208:211], v[200:203], v[156:159]
buffer_load_dwordx4 v243, s[16:19], s100 offen offset:2112 nt lds
v_mfma_f32_16x16x32_bf16 v[152:155], a[192:195], v[200:203], 0
v_mfma_f32_16x16x32_bf16 v[152:155], a[196:199], v[220:223], v[152:155]
ds_read_b128 v[220:223], v249 offset:544
v_mfma_f32_16x16x32_bf16 v[152:155], a[200:203], v[216:219], v[152:155]
ds_read_b128 v[216:219], v249 offset:272
v_mfma_f32_16x16x32_bf16 v[152:155], a[204:207], v[192:195], v[152:155]
buffer_load_dwordx4 v243, s[16:19], s101 offen offset:3168 nt lds
v_mfma_f32_16x16x32_bf16 v[168:171], v[48:51], v[104:107], v[168:171]
s_mov_b32 m0, s58
v_mfma_f32_16x16x32_bf16 v[168:171], v[64:67], v[108:111], v[168:171]
s_waitcnt lgkmcnt(2)
v_mfma_f32_16x16x32_bf16 v[168:171], v[80:83], v[112:115], v[168:171]
v_mfma_f32_16x16x32_bf16 v[172:175], v[84:87], v[112:115], v[172:175]
v_mfma_f32_16x16x32_bf16 v[172:175], v[52:55], v[104:107], v[172:175]
v_mfma_f32_16x16x32_bf16 v[172:175], v[68:71], v[108:111], v[172:175]
v_mfma_f32_16x16x32_bf16 v[176:179], v[72:75], v[108:111], v[176:179]
v_mfma_f32_16x16x32_bf16 v[176:179], v[88:91], v[112:115], v[176:179]
v_mfma_f32_16x16x32_bf16 v[176:179], v[56:59], v[104:107], v[176:179]
s_branch L_entryf
L_spin:
ds_read_addtid_b32 v192 offset:65280
s_waitcnt lgkmcnt(0)
v_cmp_lt_u32 vcc, s45, v192
s_nop 1
s_cbranch_vccnz L_spin
s_branch L_back
L_spine:
ds_read_addtid_b32 v188 offset:65280
s_waitcnt lgkmcnt(0)
v_cmp_lt_u32 vcc, s45, v188
s_nop 1
s_cbranch_vccnz L_spine
s_branch L_backe
.p2align 12
.fill 498, 4, 0xbf800000
L_h3:
s_cbranch_execz L_ret
L_loopf:
v_mfma_f32_16x16x32_bf16 v[152:155], a[192:195], v[188:191], 0
s_mov_b32 m0, s59
v_cvt_pk_bf16_f32 v102, v232, v233
v_cvt_pk_bf16_f32 v103, v234, v235
v_mfma_f32_16x16x32_bf16 v[152:155], a[196:199], v[208:211], v[152:155]
s_add_u32 s52, s47, 8192
ds_read_addtid_b32 v192 offset:65280
v_mov_b32_sdwa v106, v204 dst_sel:WORD_0 dst_unused:UNUSED_PRESERVE src0_sel:WORD_1
v_mfma_f32_16x16x32_bf16 v[152:155], a[200:203], v[212:215], v[152:155]
s_add_u32 s53, s47, 12288
v_exp_f32 v110, v221
v_mfma_f32_16x16x32_bf16 v[152:155], a[204:207], v[216:219], v[152:155]
s_bfe_i32 s57, s3, 0x10000
v_exp_f32 v222, v222
v_mfma_f32_16x16x32_bf16 v[156:159], a[220:223], v[216:219], 0
s_mov_b32 s47, s46
v_exp_f32 v111, v223
v_mfma_f32_16x16x32_bf16 v[156:159], a[216:219], v[212:215], v[156:159]
s_and_b32 s54, s57, s5
v_mov_b32_sdwa v110, v220 dst_sel:WORD_0 dst_unused:UNUSED_PRESERVE src0_sel:WORD_1
v_mov_b32_sdwa v111, v222 dst_sel:WORD_0 dst_unused:UNUSED_PRESERVE src0_sel:WORD_1
v_mfma_f32_16x16x32_bf16 v[156:159], a[212:215], v[208:211], v[156:159]
s_lshr_b32 s3, s3, 1
v_exp_f32 v196, v196
v_mfma_f32_16x16x32_bf16 v[156:159], a[208:211], v[188:191], v[156:159]
s_waitcnt lgkmcnt(0)
v_cmp_lt_u32 vcc, s45, v192
v_mov_b32_sdwa v107, v206 dst_sel:WORD_0 dst_unused:UNUSED_PRESERVE src0_sel:WORD_1
v_mfma_f32_16x16x32_bf16 v[160:163], a[224:227], v[188:191], 0
v_exp_f32 v104, v197
v_mfma_f32_16x16x32_bf16 v[160:163], a[228:231], v[208:211], v[160:163]
v_exp_f32 v198, v198
v_mfma_f32_16x16x32_bf16 v[160:163], a[232:235], v[212:215], v[160:163]
s_cbranch_vccnz L_spin
L_back:
v_exp_f32 v105, v199
v_mfma_f32_16x16x32_bf16 v[160:163], a[236:239], v[216:219], v[160:163]
s_mov_b32 s98, s50
ds_read_b128 v[192:195], v242 offset:0
v_mov_b32_sdwa v104, v196 dst_sel:WORD_0 dst_unused:UNUSED_PRESERVE src0_sel:WORD_1
v_mfma_f32_16x16x32_bf16 v[164:167], a[252:255], v[216:219], 0
s_add_u32 s99, s98, s51
ds_read_b128 v[216:219], v242 offset:512
v_mov_b32_sdwa v105, v198 dst_sel:WORD_0 dst_unused:UNUSED_PRESERVE src0_sel:WORD_1
v_mfma_f32_16x16x32_bf16 v[164:167], a[248:251], v[212:215], v[164:167]
s_add_u32 s100, s99, s51
ds_read_b128 v[196:199], v242 offset:256
v_mov_b64 v[212:213], 0
v_mfma_f32_16x16x32_bf16 v[164:167], a[244:247], v[208:211], v[164:167]
s_add_u32 m0, s49, 0
ds_read_b128 v[204:207], v242 offset:768
v_mov_b64 v[214:215], 0
v_mfma_f32_16x16x32_bf16 v[164:167], a[240:243], v[188:191], v[164:167]
s_add_u32 s101, s100, s51
v_exp_f32 v224, v224
v_mfma_f32_16x16x32_bf16 v[188:191], v[12:15], v[100:103], 0
s_sub_u32 s45, s45, 1
v_exp_f32 v108, v225
v_mfma_f32_16x16x32_bf16 v[188:191], v[8:11], v[96:99], v[188:191]
s_waitcnt lgkmcnt(3)
v_exp_f32 v226, v226
v_smfmac_f32_16x16x64_bf16 v[212:215], v[238:241], v[96:103], v251
s_add_u32 s50, s50, 13107200
s_sub_u32 s50, s50, s54
v_mov_b32_sdwa v108, v224 dst_sel:WORD_0 dst_unused:UNUSED_PRESERVE src0_sel:WORD_1
v_mfma_f32_16x16x32_bf16 v[208:211], v[0:3], v[96:99], 0
v_exp_f32 v109, v227
v_mfma_f32_16x16x32_bf16 v[208:211], v[4:7], v[100:103], v[208:211]
s_waitcnt lgkmcnt(1)
v_mov_b32_sdwa v109, v226 dst_sel:WORD_0 dst_unused:UNUSED_PRESERVE src0_sel:WORD_1
v_add_f32 v212, v212, v213
v_mfma_f32_16x16x32_bf16 v[220:223], a[64:67], v[192:195], 0
v_exp_f32 v200, v200
v_mfma_f32_16x16x32_bf16 v[220:223], a[68:71], v[196:199], v[220:223]
s_waitcnt lgkmcnt(0)
v_exp_f32 v112, v201
v_mfma_f32_16x16x32_bf16 v[220:223], a[72:75], v[216:219], v[220:223]
v_exp_f32 v202, v202
v_mfma_f32_16x16x32_bf16 v[220:223], a[76:79], v[204:207], v[220:223]
v_exp_f32 v113, v203
v_mfma_f32_16x16x32_bf16 v[224:227], a[92:95], v[204:207], 0
v_mov_b32_sdwa v112, v200 dst_sel:WORD_0 dst_unused:UNUSED_PRESERVE src0_sel:WORD_1
v_mov_b32_sdwa v113, v202 dst_sel:WORD_0 dst_unused:UNUSED_PRESERVE src0_sel:WORD_1
v_mfma_f32_16x16x32_bf16 v[224:227], a[88:91], v[216:219], v[224:227]
v_exp_f32 v228, v228
v_mfma_f32_16x16x32_bf16 v[224:227], a[84:87], v[196:199], v[224:227]
s_nop 0
v_cvt_pk_bf16_f32 v0, v220, v221
v_cvt_pk_bf16_f32 v1, v222, v223
v_mfma_f32_16x16x32_bf16 v[224:227], a[80:83], v[192:195], v[224:227]
buffer_load_dwordx4 v243, s[16:19], s98 offen offset:0 nt lds
v_mfma_f32_16x16x32_bf16 v[200:203], a[96:99], v[192:195], 0
s_add_u32 s98, s98, s48
v_exp_f32 v114, v229
v_mfma_f32_16x16x32_bf16 v[200:203], a[100:103], v[196:199], v[200:203]
v_exp_f32 v230, v230
v_mfma_f32_16x16x32_bf16 v[200:203], a[104:107], v[216:219], v[200:203]
v_exp_f32 v115, v231
v_mfma_f32_16x16x32_bf16 v[200:203], a[108:111], v[204:207], v[200:203]
v_mov_b64 v[220:221], 0
v_mov_b32_sdwa v114, v228 dst_sel:WORD_0 dst_unused:UNUSED_PRESERVE src0_sel:WORD_1
v_mfma_f32_16x16x32_bf16 v[232:235], a[124:127], v[204:207], 0
v_mov_b32_sdwa v115, v230 dst_sel:WORD_0 dst_unused:UNUSED_PRESERVE src0_sel:WORD_1
v_cvt_pk_bf16_f32 v2, v224, v225
v_mfma_f32_16x16x32_bf16 v[232:235], a[120:123], v[216:219], v[232:235]
v_exp_f32 v188, v188
v_mfma_f32_16x16x32_bf16 v[232:235], a[116:119], v[196:199], v[232:235]
v_cvt_pk_bf16_f32 v4, v200, v201
v_cvt_pk_bf16_f32 v5, v202, v203
v_mfma_f32_16x16x32_bf16 v[232:235], a[112:115], v[192:195], v[232:235]
v_exp_f32 v122, v189
v_smfmac_f32_16x16x64_bf16 v[220:223], v[184:187], v[104:111], v251
ds_read_b128 v[192:195], v242 offset:4992
v_mov_b32_sdwa v122, v188 dst_sel:WORD_0 dst_unused:UNUSED_PRESERVE src0_sel:WORD_1
v_smfmac_f32_16x16x64_bf16 v[220:223], v[184:187], v[112:119], v251 abid:1
ds_read_b128 v[196:199], v242 offset:4736
ds_read_b128 v[204:207], v242 offset:4480
v_mfma_f32_16x16x32_bf16 v[168:171], v[80:83], v[112:115], v[168:171]
ds_read_b128 v[216:219], v242 offset:4224
v_cvt_pk_bf16_f32 v3, v226, v227
v_mfma_f32_16x16x32_bf16 v[168:171], v[64:67], v[108:111], v[168:171]
v_exp_f32 v190, v190
v_mfma_f32_16x16x32_bf16 v[168:171], v[48:51], v[104:107], v[168:171]
v_exp_f32 v123, v191
v_mfma_f32_16x16x32_bf16 v[172:175], v[52:55], v[104:107], v[172:175]
v_mov_b32_sdwa v123, v190 dst_sel:WORD_0 dst_unused:UNUSED_PRESERVE src0_sel:WORD_1
v_add_f32 v220, v220, v221
v_mfma_f32_16x16x32_bf16 v[172:175], v[68:71], v[108:111], v[172:175]
s_waitcnt lgkmcnt(3)
v_rcp_f32 v254, v220
v_mfma_f32_16x16x32_bf16 v[172:175], v[84:87], v[112:115], v[172:175]
v_max3_f32 v255, v255, v220, v254
v_cvt_pk_bf16_f32 v6, v232, v233
v_mfma_f32_16x16x32_bf16 v[200:203], v[40:43], v[96:99], 0
v_exp_f32 v208, v208
v_mfma_f32_16x16x32_bf16 v[200:203], v[44:47], v[100:103], v[200:203]
v_exp_f32 v120, v209
v_mfma_f32_16x16x32_bf16 v[176:179], v[56:59], v[104:107], v[176:179]
v_exp_f32 v210, v210
v_mfma_f32_16x16x32_bf16 v[176:179], v[72:75], v[108:111], v[176:179]
v_exp_f32 v121, v211
v_mfma_f32_16x16x32_bf16 v[176:179], v[88:91], v[112:115], v[176:179]
v_mov_b32_sdwa v120, v208 dst_sel:WORD_0 dst_unused:UNUSED_PRESERVE src0_sel:WORD_1
v_mov_b32_sdwa v121, v210 dst_sel:WORD_0 dst_unused:UNUSED_PRESERVE src0_sel:WORD_1
v_mfma_f32_16x16x32_bf16 v[180:183], v[92:95], v[112:115], v[180:183]
v_cvt_pk_bf16_f32 v7, v234, v235
v_add_f32 v214, v214, v215
v_mfma_f32_16x16x32_bf16 v[180:183], v[76:79], v[108:111], v[180:183]
s_waitcnt lgkmcnt(1)
v_exp_f32 v212, v212
v_mfma_f32_16x16x32_bf16 v[180:183], v[60:63], v[104:107], v[180:183]
s_waitcnt lgkmcnt(0)
v_exp_f32 v214, v214
v_mfma_f32_16x16x32_bf16 v[188:191], v[16:19], v[96:99], 0
s_mov_b64 vcc, s[14:15]
v_perm_b32 v132, v214, v212, v252
v_perm_b32 v133, v214, v212, v253
v_mfma_f32_16x16x32_bf16 v[188:191], v[20:23], v[100:103], v[188:191]
v_exp_f32 v200, v200
v_mfma_f32_16x16x32_bf16 v[220:223], a[124:127], v[192:195], 0
v_exp_f32 v130, v201
v_mfma_f32_16x16x32_bf16 v[220:223], a[120:123], v[196:199], v[220:223]
v_exp_f32 v202, v202
v_mfma_f32_16x16x32_bf16 v[220:223], a[116:119], v[204:207], v[220:223]
v_exp_f32 v131, v203
v_mfma_f32_16x16x32_bf16 v[220:223], a[112:115], v[216:219], v[220:223]
buffer_load_dwordx4 v243, s[16:19], s99 offen offset:1056 nt lds
v_mfma_f32_16x16x32_bf16 v[224:227], a[96:99], v[216:219], 0
s_add_u32 s99, s98, s51
v_exp_f32 v188, v188
v_mfma_f32_16x16x32_bf16 v[224:227], a[100:103], v[204:207], v[224:227]
v_exp_f32 v124, v189
v_mfma_f32_16x16x32_bf16 v[224:227], a[104:107], v[196:199], v[224:227]
v_exp_f32 v190, v190
v_mfma_f32_16x16x32_bf16 v[224:227], a[108:111], v[192:195], v[224:227]
v_exp_f32 v125, v191
v_mfma_f32_16x16x32_bf16 v[228:231], a[92:95], v[192:195], 0
v_mov_b32_sdwa v124, v188 dst_sel:WORD_0 dst_unused:UNUSED_PRESERVE src0_sel:WORD_1
v_mov_b32_sdwa v125, v190 dst_sel:WORD_0 dst_unused:UNUSED_PRESERVE src0_sel:WORD_1
v_mfma_f32_16x16x32_bf16 v[228:231], a[88:91], v[196:199], v[228:231]
v_cvt_pk_bf16_f32 v14, v220, v221
v_cvt_pk_bf16_f32 v15, v222, v223
v_mfma_f32_16x16x32_bf16 v[228:231], a[84:87], v[204:207], v[228:231]
ds_read_b128 v[220:223], v242 offset:16896
v_cvt_pk_bf16_f32 v12, v224, v225
v_mfma_f32_16x16x32_bf16 v[228:231], a[80:83], v[216:219], v[228:231]
v_cvt_pk_bf16_f32 v13, v226, v227
v_mov_b32_sdwa v130, v200 dst_sel:WORD_0 dst_unused:UNUSED_PRESERVE src0_sel:WORD_1
v_mfma_f32_16x16x32_bf16 v[208:211], a[64:67], v[216:219], 0
ds_read_b128 v[224:227], v242 offset:17152
ds_read_b128 v[216:219], v242 offset:17408
v_mfma_f32_16x16x32_bf16 v[208:211], a[68:71], v[204:207], v[208:211]
v_mov_b32_sdwa v131, v202 dst_sel:WORD_0 dst_unused:UNUSED_PRESERVE src0_sel:WORD_1
v_fmac_f32 v136, v168, v254
v_mfma_f32_16x16x32_bf16 v[208:211], a[72:75], v[196:199], v[208:211]
v_cvt_pk_bf16_f32 v10, v228, v229
v_cvt_pk_bf16_f32 v11, v230, v231
v_mfma_f32_16x16x32_bf16 v[208:211], a[76:79], v[192:195], v[208:211]
ds_read_b128 v[228:231], v242 offset:17664
v_fmac_f32 v137, v169, v254
v_mfma_f32_16x16x32_bf16 v[188:191], v[28:31], v[100:103], 0
v_fmac_f32 v138, v170, v254
v_fmac_f32 v139, v171, v254
v_mfma_f32_16x16x32_bf16 v[188:191], v[24:27], v[96:99], v[188:191]
v_fmac_f32 v140, v172, v254
v_fmac_f32 v141, v173, v254
v_mfma_f32_16x16x32_bf16 v[192:195], v[32:35], v[96:99], 0
s_waitcnt lgkmcnt(3)
v_fmac_f32 v142, v174, v254
v_fmac_f32 v143, v175, v254
v_mfma_f32_16x16x32_bf16 v[192:195], v[36:39], v[100:103], v[192:195]
s_waitcnt lgkmcnt(2)
v_exp_f32 v188, v188
v_mfma_f32_16x16x32_bf16 v[196:199], a[64:67], v[220:223], 0
s_waitcnt lgkmcnt(1)
v_exp_f32 v126, v189
v_mfma_f32_16x16x32_bf16 v[196:199], a[68:71], v[224:227], v[196:199]
s_waitcnt lgkmcnt(0)
v_exp_f32 v190, v190
v_mfma_f32_16x16x32_bf16 v[196:199], a[72:75], v[216:219], v[196:199]
v_exp_f32 v127, v191
v_mfma_f32_16x16x32_bf16 v[196:199], a[76:79], v[228:231], v[196:199]
buffer_load_dwordx4 v243, s[16:19], s100 offen offset:2112 nt lds
v_mfma_f32_16x16x32_bf16 v[204:207], a[92:95], v[228:231], 0
s_add_u32 s100, s99, s51
ds_read_b128 v[212:215], v242 offset:8960
ds_read_b128 v[200:203], v242 offset:9216
v_mfma_f32_16x16x32_bf16 v[204:207], a[88:91], v[216:219], v[204:207]
ds_read_b128 v[232:235], v242 offset:8704
v_mov_b32_sdwa v126, v188 dst_sel:WORD_0 dst_unused:UNUSED_PRESERVE src0_sel:WORD_1
v_mfma_f32_16x16x32_bf16 v[204:207], a[84:87], v[224:227], v[204:207]
v_cvt_pk_bf16_f32 v32, v196, v197
v_cvt_pk_bf16_f32 v33, v198, v199
v_mfma_f32_16x16x32_bf16 v[204:207], a[80:83], v[220:223], v[204:207]
v_mov_b32_sdwa v127, v190 dst_sel:WORD_0 dst_unused:UNUSED_PRESERVE src0_sel:WORD_1
v_fmac_f32 v144, v176, v254
v_mfma_f32_16x16x32_bf16 v[196:199], a[96:99], v[220:223], 0
ds_read_b128 v[188:191], v242 offset:8448
v_fmac_f32 v145, v177, v254
v_mfma_f32_16x16x32_bf16 v[196:199], a[100:103], v[224:227], v[196:199]
v_exp_f32 v192, v192
v_mfma_f32_16x16x32_bf16 v[196:199], a[104:107], v[216:219], v[196:199]
v_cvt_pk_bf16_f32 v34, v204, v205
v_cvt_pk_bf16_f32 v35, v206, v207
v_mfma_f32_16x16x32_bf16 v[196:199], a[108:111], v[228:231], v[196:199]
s_waitcnt lgkmcnt(1)
v_exp_f32 v128, v193
v_mfma_f32_16x16x32_bf16 v[204:207], a[124:127], v[228:231], 0
v_exp_f32 v194, v194
v_mfma_f32_16x16x32_bf16 v[204:207], a[116:119], v[224:227], v[204:207]
v_exp_f32 v129, v195
v_mfma_f32_16x16x32_bf16 v[204:207], a[112:115], v[220:223], v[204:207]
v_mov_b32_sdwa v128, v192 dst_sel:WORD_0 dst_unused:UNUSED_PRESERVE src0_sel:WORD_1
v_mov_b32_sdwa v129, v194 dst_sel:WORD_0 dst_unused:UNUSED_PRESERVE src0_sel:WORD_1
v_mfma_f32_16x16x32_bf16 v[204:207], a[120:123], v[216:219], v[204:207]
v_cvt_pk_bf16_f32 v36, v196, v197
v_cvt_pk_bf16_f32 v37, v198, v199
v_mfma_f32_16x16x32_bf16 v[216:219], a[120:123], v[212:215], 0
v_fmac_f32 v146, v178, v254
v_fmac_f32 v147, v179, v254
v_mfma_f32_16x16x32_bf16 v[216:219], a[124:127], v[200:203], v[216:219]
s_waitcnt lgkmcnt(0)
v_fmac_f32 v148, v180, v254
v_fmac_f32 v149, v181, v254
v_mfma_f32_16x16x32_bf16 v[216:219], a[116:119], v[232:235], v[216:219]
v_fmac_f32 v150, v182, v254
v_fmac_f32 v151, v183, v254
v_mfma_f32_16x16x32_bf16 v[216:219], a[112:115], v[188:191], v[216:219]
v_cvt_pk_bf16_f32 v136, v136, v137
v_cvt_pk_bf16_f32 v144, v144, v145
v_mfma_f32_16x16x32_bf16 v[192:195], a[96:99], v[188:191], 0
v_cvt_pk_bf16_f32 v137, v138, v139
v_cvt_pk_bf16_f32 v145, v146, v147
v_mfma_f32_16x16x32_bf16 v[192:195], a[100:103], v[232:235], v[192:195]
v_cvt_pk_bf16_f32 v138, v140, v141
v_cvt_pk_bf16_f32 v139, v142, v143
v_mfma_f32_16x16x32_bf16 v[192:195], a[104:107], v[212:215], v[192:195]
v_cvt_pk_bf16_f32 v146, v148, v149
v_cvt_pk_bf16_f32 v147, v150, v151
v_mfma_f32_16x16x32_bf16 v[192:195], a[108:111], v[200:203], v[192:195]
v_pk_max_i16 v136, v136, 0
v_pk_max_i16 v137, v137, 0
v_mfma_f32_16x16x32_bf16 v[196:199], a[92:95], v[200:203], 0
v_pk_max_i16 v138, v138, 0
v_pk_max_i16 v139, v139, 0
v_mfma_f32_16x16x32_bf16 v[196:199], a[88:91], v[212:215], v[196:199]
v_pk_max_i16 v144, v144, 0
v_pk_max_i16 v145, v145, 0
v_mfma_f32_16x16x32_bf16 v[196:199], a[84:87], v[232:235], v[196:199]
v_cvt_pk_bf16_f32 v20, v192, v193
v_cvt_pk_bf16_f32 v21, v194, v195
v_mfma_f32_16x16x32_bf16 v[196:199], a[80:83], v[188:191], v[196:199]
v_pk_max_i16 v146, v146, 0
v_pk_max_i16 v147, v147, 0
v_mfma_f32_16x16x32_bf16 v[192:195], a[64:67], v[188:191], 0
v_cndmask_b32_dpp v140, v144, v136, vcc quad_perm:[1,0,3,2] row_mask:0xf bank_mask:0xf
v_cndmask_b32_dpp v141, v145, v137, vcc quad_perm:[1,0,3,2] row_mask:0xf bank_mask:0xf
v_mfma_f32_16x16x32_bf16 v[192:195], a[68:71], v[232:235], v[192:195]
v_cndmask_b32_dpp v142, v146, v138, vcc quad_perm:[1,0,3,2] row_mask:0xf bank_mask:0xf
v_cndmask_b32_dpp v143, v147, v139, vcc quad_perm:[1,0,3,2] row_mask:0xf bank_mask:0xf
v_mfma_f32_16x16x32_bf16 v[192:195], a[72:75], v[212:215], v[192:195]
s_not_b64 vcc, vcc
ds_read_b128 v[220:223], v242 offset:13440
v_cndmask_b32_dpp v144, v136, v144, vcc quad_perm:[1,0,3,2] row_mask:0xf bank_mask:0xf
v_mfma_f32_16x16x32_bf16 v[192:195], a[76:79], v[200:203], v[192:195]
v_cndmask_b32_dpp v145, v137, v145, vcc quad_perm:[1,0,3,2] row_mask:0xf bank_mask:0xf
v_cndmask_b32_dpp v146, v138, v146, vcc quad_perm:[1,0,3,2] row_mask:0xf bank_mask:0xf
v_cndmask_b32_dpp v147, v139, v147, vcc quad_perm:[1,0,3,2] row_mask:0xf bank_mask:0xf
v_mfma_f32_32x32x16_bf16 v[168:183], v[236:239], v[132:135], 0
buffer_store_dwordx4 v[140:143], v244, s[20:23], s52 offen offset:0 nt
buffer_store_dwordx4 v[144:147], v244, s[20:23], s52 offen offset:256 nt
v_cvt_pk_bf16_f32 v38, v204, v205
v_mov_b64 v[204:205], 0
v_cvt_pk_bf16_f32 v39, v206, v207
v_cvt_pk_bf16_f32 v16, v192, v193
v_smfmac_f32_16x16x64_bf16 v[204:207], v[184:187], v[120:127], v251
s_add_u32 s52, s46, 20480
v_cvt_pk_bf16_f32 v17, v194, v195
v_smfmac_f32_16x16x64_bf16 v[204:207], v[184:187], v[128:135], v251 abid:1
L_h4:
s_cbranch_execz L_ret
v_cvt_pk_bf16_f32 v22, v216, v217
v_mfma_f32_16x16x32_bf16 v[168:171], v[80:83], v[128:131], v[168:171]
v_cvt_pk_bf16_f32 v23, v218, v219
v_cvt_pk_bf16_f32 v8, v208, v209
v_mfma_f32_16x16x32_bf16 v[168:171], v[64:67], v[124:127], v[168:171]
ds_read_b128 v[216:219], v242 offset:13184
v_cvt_pk_bf16_f32 v9, v210, v211
v_mfma_f32_16x16x32_bf16 v[168:171], v[48:51], v[120:123], v[168:171]
ds_read_b128 v[208:211], v242 offset:12928
v_add_f32 v204, v204, v205
v_mfma_f32_16x16x32_bf16 v[172:175], v[52:55], v[120:123], v[172:175]
ds_read_b128 v[238:241], v245 offset:0
v_cvt_pk_bf16_f32 v18, v196, v197
v_mfma_f32_16x16x32_bf16 v[172:175], v[68:71], v[124:127], v[172:175]
ds_read2_b32 v[236:237], v246 offset0:0 offset1:8
v_cvt_pk_bf16_f32 v19, v198, v199
v_mfma_f32_16x16x32_bf16 v[172:175], v[84:87], v[128:131], v[172:175]
ds_read_b128 v[196:199], v242 offset:12672
v_add_u32 v245, 1728, v245
v_mfma_f32_16x16x32_bf16 v[176:179], v[88:91], v[128:131], v[176:179]
s_waitcnt lgkmcnt(5)
v_rcp_f32 v254, v204
v_mfma_f32_16x16x32_bf16 v[176:179], v[72:75], v[124:127], v[176:179]
v_max3_f32 v255, v255, v204, v254
v_fmac_f32 v152, v168, v254
v_mfma_f32_16x16x32_bf16 v[176:179], v[56:59], v[120:123], v[176:179]
v_fmac_f32 v153, v169, v254
v_fmac_f32 v154, v170, v254
v_mfma_f32_16x16x32_bf16 v[180:183], v[60:63], v[120:123], v[180:183]
v_fmac_f32 v155, v171, v254
v_fmac_f32 v156, v172, v254
v_mfma_f32_16x16x32_bf16 v[180:183], v[76:79], v[124:127], v[180:183]
v_fmac_f32 v157, v173, v254
v_fmac_f32 v158, v174, v254
v_mfma_f32_16x16x32_bf16 v[180:183], v[92:95], v[128:131], v[180:183]
s_mov_b64 vcc, s[14:15]
v_fmac_f32 v159, v175, v254
v_fmac_f32 v160, v176, v254
v_mfma_f32_16x16x32_bf16 v[192:195], v[188:191], a[128:131], 0
v_fmac_f32 v161, v177, v254
v_fmac_f32 v162, v178, v254
v_mfma_f32_16x16x32_bf16 v[192:195], v[232:235], a[132:135], v[192:195]
v_fmac_f32 v163, v179, v254
v_fmac_f32 v164, v180, v254
v_mfma_f32_16x16x32_bf16 v[192:195], v[212:215], a[136:139], v[192:195]
s_waitcnt lgkmcnt(4)
v_fmac_f32 v165, v181, v254
v_cvt_pk_bf16_f32 v152, v152, v153
v_mfma_f32_16x16x32_bf16 v[192:195], v[200:203], a[140:143], v[192:195]
s_waitcnt lgkmcnt(3)
v_cvt_pk_bf16_f32 v160, v160, v161
v_cvt_pk_bf16_f32 v153, v154, v155
v_mfma_f32_16x16x32_bf16 v[204:207], v[200:203], a[156:159], 0
s_waitcnt lgkmcnt(2)
v_fmac_f32 v166, v182, v254
v_fmac_f32 v167, v183, v254
v_mfma_f32_16x16x32_bf16 v[204:207], v[212:215], a[152:155], v[204:207]
s_waitcnt lgkmcnt(1)
v_cvt_pk_bf16_f32 v64, v192, v193
v_cvt_pk_bf16_f32 v65, v194, v195
v_mfma_f32_16x16x32_bf16 v[204:207], v[232:235], a[148:151], v[204:207]
s_waitcnt lgkmcnt(0)
v_cvt_pk_bf16_f32 v161, v162, v163
v_cvt_pk_bf16_f32 v154, v156, v157
v_mfma_f32_16x16x32_bf16 v[204:207], v[188:191], a[144:147], v[204:207]
v_cvt_pk_bf16_f32 v155, v158, v159
v_cvt_pk_bf16_f32 v162, v164, v165
v_mfma_f32_16x16x32_bf16 v[224:227], v[188:191], a[160:163], 0
v_cvt_pk_bf16_f32 v163, v166, v167
v_pk_max_i16 v152, v152, 0
v_mfma_f32_16x16x32_bf16 v[224:227], v[232:235], a[164:167], v[224:227]
v_pk_max_i16 v153, v153, 0
v_pk_max_i16 v154, v154, 0
v_mfma_f32_16x16x32_bf16 v[224:227], v[212:215], a[168:171], v[224:227]
v_cvt_pk_bf16_f32 v68, v204, v205
v_cvt_pk_bf16_f32 v69, v206, v207
v_mfma_f32_16x16x32_bf16 v[224:227], v[200:203], a[172:175], v[224:227]
buffer_load_dwordx4 v243, s[16:19], s101 offen offset:3168 nt lds
v_mfma_f32_16x16x32_bf16 v[192:195], v[200:203], a[188:191], 0
s_add_u32 m0, s49, 8448
v_pk_max_i16 v155, v155, 0
v_pk_max_i16 v160, v160, 0
v_mfma_f32_16x16x32_bf16 v[192:195], v[232:235], a[180:183], v[192:195]
s_add_u32 s101, s100, s51
v_pk_max_i16 v161, v161, 0
v_cvt_pk_bf16_f32 v72, v224, v225
v_mfma_f32_16x16x32_bf16 v[192:195], v[188:191], a[176:179], v[192:195]
v_cvt_pk_bf16_f32 v73, v226, v227
v_pk_max_i16 v162, v162, 0
v_mfma_f32_16x16x32_bf16 v[192:195], v[212:215], a[184:187], v[192:195]
v_pk_max_i16 v163, v163, 0
v_cndmask_b32_dpp v156, v160, v152, vcc quad_perm:[1,0,3,2] row_mask:0xf bank_mask:0xf
v_mfma_f32_16x16x32_bf16 v[188:191], v[216:219], a[184:187], 0
v_cndmask_b32_dpp v157, v161, v153, vcc quad_perm:[1,0,3,2] row_mask:0xf bank_mask:0xf
v_cndmask_b32_dpp v158, v162, v154, vcc quad_perm:[1,0,3,2] row_mask:0xf bank_mask:0xf
v_mfma_f32_16x16x32_bf16 v[188:191], v[220:223], a[188:191], v[188:191]
v_cndmask_b32_dpp v159, v163, v155, vcc quad_perm:[1,0,3,2] row_mask:0xf bank_mask:0xf
v_add_u32 v246, 1728, v246
v_mfma_f32_16x16x32_bf16 v[188:191], v[208:211], a[180:183], v[188:191]
s_not_b64 vcc, vcc
v_cvt_pk_bf16_f32 v76, v192, v193
v_cvt_pk_bf16_f32 v77, v194, v195
v_mfma_f32_16x16x32_bf16 v[188:191], v[196:199], a[176:179], v[188:191]
v_cndmask_b32_dpp v160, v152, v160, vcc quad_perm:[1,0,3,2] row_mask:0xf bank_mask:0xf
v_cndmask_b32_dpp v161, v153, v161, vcc quad_perm:[1,0,3,2] row_mask:0xf bank_mask:0xf
v_mfma_f32_16x16x32_bf16 v[192:195], v[196:199], a[160:163], 0
v_cndmask_b32_dpp v162, v154, v162, vcc quad_perm:[1,0,3,2] row_mask:0xf bank_mask:0xf
v_cndmask_b32_dpp v163, v155, v163, vcc quad_perm:[1,0,3,2] row_mask:0xf bank_mask:0xf
v_mfma_f32_16x16x32_bf16 v[192:195], v[208:211], a[164:167], v[192:195]
s_nop 1
v_cvt_pk_bf16_f32 v78, v188, v189
v_mfma_f32_16x16x32_bf16 v[192:195], v[216:219], a[168:171], v[192:195]
v_cvt_pk_bf16_f32 v79, v190, v191
v_mfma_f32_16x16x32_bf16 v[192:195], v[220:223], a[172:175], v[192:195]
s_nop 2
v_mfma_f32_16x16x32_bf16 v[188:191], v[220:223], a[156:159], 0
s_nop 2
v_mfma_f32_16x16x32_bf16 v[188:191], v[216:219], a[152:155], v[188:191]
v_cvt_pk_bf16_f32 v74, v192, v193
v_cvt_pk_bf16_f32 v75, v194, v195
v_mfma_f32_16x16x32_bf16 v[188:191], v[208:211], a[148:151], v[188:191]
v_mfma_f32_16x16x32_bf16 v[188:191], v[196:199], a[144:147], v[188:191]
s_nop 2
v_mfma_f32_16x16x32_bf16 v[192:195], v[196:199], a[128:131], 0
s_nop 2
v_mfma_f32_16x16x32_bf16 v[192:195], v[208:211], a[132:135], v[192:195]
v_cvt_pk_bf16_f32 v70, v188, v189
v_cvt_pk_bf16_f32 v71, v190, v191
v_mfma_f32_16x16x32_bf16 v[192:195], v[216:219], a[136:139], v[192:195]
v_mfma_f32_16x16x32_bf16 v[192:195], v[220:223], a[140:143], v[192:195]
s_nop 2
v_mfma_f32_16x16x32_bf16 v[188:191], a[64:67], v[196:199], 0
s_nop 2
v_mfma_f32_16x16x32_bf16 v[188:191], a[68:71], v[208:211], v[188:191]
v_cvt_pk_bf16_f32 v66, v192, v193
v_cvt_pk_bf16_f32 v67, v194, v195
v_mfma_f32_16x16x32_bf16 v[188:191], a[72:75], v[216:219], v[188:191]
v_mfma_f32_16x16x32_bf16 v[188:191], a[76:79], v[220:223], v[188:191]
buffer_load_dwordx4 v243, s[16:19], s98 offen offset:0 nt lds
v_mfma_f32_16x16x32_bf16 v[192:195], a[92:95], v[220:223], 0
s_add_u32 s98, s98, s48
ds_read_b128 v[200:203], v242 offset:21632
ds_read_b128 v[204:207], v242 offset:21888
v_mfma_f32_16x16x32_bf16 v[192:195], a[88:91], v[216:219], v[192:195]
ds_read_b128 v[212:215], v242 offset:21376
ds_read_b128 v[224:227], v242 offset:21120
v_mfma_f32_16x16x32_bf16 v[192:195], a[84:87], v[208:211], v[192:195]
v_cvt_pk_bf16_f32 v24, v188, v189
v_cvt_pk_bf16_f32 v25, v190, v191
v_mfma_f32_16x16x32_bf16 v[192:195], a[80:83], v[196:199], v[192:195]
s_nop 2
v_mfma_f32_16x16x32_bf16 v[188:191], a[96:99], v[196:199], 0
s_nop 2
v_mfma_f32_16x16x32_bf16 v[188:191], a[100:103], v[208:211], v[188:191]
v_cvt_pk_bf16_f32 v26, v192, v193
v_cvt_pk_bf16_f32 v27, v194, v195
v_mfma_f32_16x16x32_bf16 v[188:191], a[104:107], v[216:219], v[188:191]
v_mfma_f32_16x16x32_bf16 v[188:191], a[108:111], v[220:223], v[188:191]
s_nop 2
v_mfma_f32_16x16x32_bf16 v[192:195], a[124:127], v[220:223], 0
s_nop 2
v_mfma_f32_16x16x32_bf16 v[192:195], a[116:119], v[208:211], v[192:195]
v_cvt_pk_bf16_f32 v28, v188, v189
v_cvt_pk_bf16_f32 v29, v190, v191
v_mfma_f32_16x16x32_bf16 v[192:195], a[112:115], v[196:199], v[192:195]
s_waitcnt lgkmcnt(3)
v_mfma_f32_16x16x32_bf16 v[192:195], a[120:123], v[216:219], v[192:195]
s_waitcnt lgkmcnt(2)
s_nop 1
v_mfma_f32_16x16x32_bf16 v[188:191], a[120:123], v[200:203], 0
s_waitcnt lgkmcnt(1)
s_nop 1
v_mfma_f32_16x16x32_bf16 v[188:191], a[124:127], v[204:207], v[188:191]
s_waitcnt lgkmcnt(0)
v_cvt_pk_bf16_f32 v30, v192, v193
v_cvt_pk_bf16_f32 v31, v194, v195
v_mfma_f32_16x16x32_bf16 v[188:191], a[116:119], v[212:215], v[188:191]
v_mfma_f32_16x16x32_bf16 v[188:191], a[112:115], v[224:227], v[188:191]
s_nop 2
v_mfma_f32_16x16x32_bf16 v[192:195], a[96:99], v[224:227], 0
s_nop 2
v_mfma_f32_16x16x32_bf16 v[192:195], a[100:103], v[212:215], v[192:195]
v_cvt_pk_bf16_f32 v46, v188, v189
v_cvt_pk_bf16_f32 v47, v190, v191
v_mfma_f32_16x16x32_bf16 v[192:195], a[104:107], v[200:203], v[192:195]
v_mfma_f32_16x16x32_bf16 v[192:195], a[108:111], v[204:207], v[192:195]
buffer_load_dwordx4 v243, s[16:19], s99 offen offset:1056 nt lds
v_mfma_f32_16x16x32_bf16 v[188:191], a[92:95], v[204:207], 0
s_add_u32 s99, s98, s51
s_nop 1
v_mfma_f32_16x16x32_bf16 v[188:191], a[88:91], v[200:203], v[188:191]
s_nop 1
v_cvt_pk_bf16_f32 v44, v192, v193
v_mfma_f32_16x16x32_bf16 v[188:191], a[84:87], v[212:215], v[188:191]
v_cvt_pk_bf16_f32 v45, v194, v195
v_mfma_f32_16x16x32_bf16 v[188:191], a[80:83], v[224:227], v[188:191]
s_nop 2
v_mfma_f32_16x16x32_bf16 v[192:195], a[64:67], v[224:227], 0
s_nop 2
v_mfma_f32_16x16x32_bf16 v[192:195], a[72:75], v[200:203], v[192:195]
v_cvt_pk_bf16_f32 v42, v188, v189
v_cvt_pk_bf16_f32 v43, v190, v191
v_mfma_f32_16x16x32_bf16 v[192:195], a[76:79], v[204:207], v[192:195]
v_mfma_f32_16x16x32_bf16 v[192:195], a[68:71], v[212:215], v[192:195]
s_nop 2
v_mfma_f32_16x16x32_bf16 v[188:191], a[4:7], v[212:215], 0
s_nop 2
v_mfma_f32_16x16x32_bf16 v[188:191], a[0:3], v[224:227], v[188:191]
v_cvt_pk_bf16_f32 v40, v192, v193
v_cvt_pk_bf16_f32 v41, v194, v195
v_mfma_f32_16x16x32_bf16 v[188:191], a[8:11], v[200:203], v[188:191]
v_mfma_f32_16x16x32_bf16 v[188:191], a[12:15], v[204:207], v[188:191]
s_nop 2
v_mfma_f32_16x16x32_bf16 v[192:195], a[28:31], v[204:207], 0
s_nop 2
v_mfma_f32_16x16x32_bf16 v[192:195], a[24:27], v[200:203], v[192:195]
v_cvt_pk_bf16_f32 v96, v188, v189
v_cvt_pk_bf16_f32 v97, v190, v191
v_mfma_f32_16x16x32_bf16 v[192:195], a[20:23], v[212:215], v[192:195]
v_mfma_f32_16x16x32_bf16 v[192:195], a[16:19], v[224:227], v[192:195]
ds_read_b128 v[188:191], v247 offset:0
v_add_u32 v247, 1728, v247
v_mfma_f32_16x16x32_bf16 v[196:199], a[32:35], v[224:227], 0
s_nop 2
v_mfma_f32_16x16x32_bf16 v[196:199], a[36:39], v[212:215], v[196:199]
s_nop 0
v_cvt_pk_bf16_f32 v98, v192, v193
v_cvt_pk_bf16_f32 v99, v194, v195
v_mfma_f32_16x16x32_bf16 v[196:199], a[40:43], v[200:203], v[196:199]
v_mfma_f32_16x16x32_bf16 v[196:199], a[44:47], v[204:207], v[196:199]
v_mov_b64 v[168:169], 0
v_mov_b64 v[170:171], 0
v_mfma_f32_16x16x32_bf16 v[192:195], a[60:63], v[204:207], 0
v_mov_b64 v[172:173], 0
v_mov_b64 v[174:175], 0
v_mfma_f32_16x16x32_bf16 v[192:195], a[56:59], v[200:203], v[192:195]
v_mov_b64 v[176:177], 0
v_mov_b64 v[178:179], 0
v_mfma_f32_16x16x32_bf16 v[192:195], a[52:55], v[212:215], v[192:195]
s_waitcnt lgkmcnt(0)
v_cvt_pk_bf16_f32 v100, v196, v197
v_cvt_pk_bf16_f32 v101, v198, v199
v_mfma_f32_16x16x32_bf16 v[192:195], a[48:51], v[224:227], v[192:195]
s_nop 2
v_smfmac_f32_16x16x64_bf16 v[168:171], v[188:191], v[0:7], v251
s_nop 2
v_smfmac_f32_16x16x64_bf16 v[172:175], v[188:191], v[16:23], v251
v_cvt_pk_bf16_f32 v102, v192, v193
v_smfmac_f32_16x16x64_bf16 v[176:179], v[188:191], v[32:39], v251
v_cvt_pk_bf16_f32 v103, v194, v195
v_mfma_f32_16x16x32_bf16 v[136:139], a[192:195], v[224:227], 0
v_add_f32 v168, v168, v169
v_mfma_f32_16x16x32_bf16 v[136:139], a[196:199], v[212:215], v[136:139]
v_exp_f32 v168, v168
v_mfma_f32_16x16x32_bf16 v[136:139], a[200:203], v[200:203], v[136:139]
v_mfma_f32_16x16x32_bf16 v[136:139], a[204:207], v[204:207], v[136:139]
buffer_load_dwordx4 v243, s[16:19], s100 offen offset:2112 nt lds
v_mfma_f32_16x16x32_bf16 v[140:143], a[220:223], v[204:207], 0
s_add_u32 s100, s99, s51
v_mfma_f32_16x16x32_bf16 v[140:143], a[216:219], v[200:203], v[140:143]
v_mfma_f32_16x16x32_bf16 v[140:143], a[212:215], v[212:215], v[140:143]
v_mfma_f32_16x16x32_bf16 v[140:143], a[208:211], v[224:227], v[140:143]
v_mfma_f32_16x16x32_bf16 v[144:147], a[224:227], v[224:227], 0
v_mfma_f32_16x16x32_bf16 v[144:147], a[228:231], v[212:215], v[144:147]
v_mfma_f32_16x16x32_bf16 v[144:147], a[232:235], v[200:203], v[144:147]
v_mfma_f32_16x16x32_bf16 v[144:147], a[236:239], v[204:207], v[144:147]
v_mfma_f32_16x16x32_bf16 v[148:151], a[252:255], v[204:207], 0
v_mfma_f32_16x16x32_bf16 v[148:151], a[248:251], v[200:203], v[148:151]
v_mfma_f32_16x16x32_bf16 v[148:151], a[244:247], v[212:215], v[148:151]
v_mfma_f32_16x16x32_bf16 v[148:151], a[240:243], v[224:227], v[148:151]
v_smfmac_f32_16x16x64_bf16 v[170:173], v[188:191], v[8:15], v251
v_mov_b64 v[192:193], 0
v_smfmac_f32_16x16x64_bf16 v[174:177], v[188:191], v[24:31], v251
v_mov_b64 v[194:195], 0
v_smfmac_f32_16x16x64_bf16 v[178:181], v[188:191], v[40:47], v251
s_nop 2
v_mfma_f32_16x16x32_bf16 v[188:191], v[4:7], v[100:103], 0
v_add_f32 v170, v170, v171
v_add_f32 v172, v172, v173
v_mfma_f32_16x16x32_bf16 v[188:191], v[0:3], v[96:99], v[188:191]
v_exp_f32 v170, v170
v_smfmac_f32_16x16x64_bf16 v[192:195], v[238:241], v[96:103], v251
v_add_f32 v174, v174, v175
v_mfma_f32_16x16x32_bf16 v[196:199], v[224:227], a[128:131], 0
v_exp_f32 v172, v172
v_mfma_f32_16x16x32_bf16 v[196:199], v[212:215], a[132:135], v[196:199]
v_exp_f32 v174, v174
v_mfma_f32_16x16x32_bf16 v[196:199], v[200:203], a[136:139], v[196:199]
v_add_f32 v176, v176, v177
v_add_f32 v178, v178, v179
v_mfma_f32_16x16x32_bf16 v[196:199], v[204:207], a[140:143], v[196:199]
buffer_load_dwordx4 v243, s[16:19], s101 offen offset:3168 nt lds
v_mfma_f32_16x16x32_bf16 v[208:211], v[204:207], a[156:159], 0
s_add_u32 m0, s49, 16896
ds_read_b128 v[216:219], v242 offset:512
ds_read_b128 v[220:223], v242 offset:256
v_mfma_f32_16x16x32_bf16 v[208:211], v[200:203], a[152:155], v[208:211]
s_add_u32 s101, s100, s51
ds_read_b128 v[228:231], v242 offset:0
v_cvt_pk_bf16_f32 v82, v196, v197
v_mfma_f32_16x16x32_bf16 v[208:211], v[212:215], a[148:151], v[208:211]
s_and_b32 s51, s57, 13106176
v_cvt_pk_bf16_f32 v83, v198, v199
v_add_f32 v192, v192, v193
v_mfma_f32_16x16x32_bf16 v[208:211], v[224:227], a[144:147], v[208:211]
s_sub_u32 s49, s49, s56
ds_read_b128 v[196:199], v242 offset:768
v_add_f32 v194, v194, v195
v_mfma_f32_16x16x32_bf16 v[232:235], v[224:227], a[160:163], 0
s_lshl3_add_u32 s48, s51, 8192
v_exp_f32 v192, v192
v_mfma_f32_16x16x32_bf16 v[232:235], v[212:215], a[164:167], v[232:235]
s_sub_u32 s51, s51, 32
v_cvt_pk_bf16_f32 v86, v208, v209
v_cvt_pk_bf16_f32 v87, v210, v211
v_mfma_f32_16x16x32_bf16 v[232:235], v[200:203], a[168:171], v[232:235]
v_exp_f32 v194, v194
v_mfma_f32_16x16x32_bf16 v[232:235], v[204:207], a[172:175], v[232:235]
v_perm_b32 v116, v194, v192, v252
v_perm_b32 v117, v194, v192, v253
v_mfma_f32_16x16x32_bf16 v[208:211], v[204:207], a[188:191], 0
v_add_f32 v180, v168, v170
v_cvt_pk_bf16_f32 v169, v168, v170
v_mfma_f32_16x16x32_bf16 v[208:211], v[212:215], a[180:183], v[208:211]
ds_write_b16 v248, v169 offset:0
v_mfma_f32_16x16x32_bf16 v[208:211], v[224:227], a[176:179], v[208:211]
s_waitcnt lgkmcnt(4)
ds_write_b16_d16_hi v248, v169 offset:4
v_mfma_f32_16x16x32_bf16 v[208:211], v[200:203], a[184:187], v[208:211]
s_waitcnt lgkmcnt(2)
v_exp_f32 v176, v176
v_mfma_f32_16x16x32_bf16 v[200:203], v[216:219], a[184:187], 0
v_exp_f32 v178, v178
v_mfma_f32_16x16x32_bf16 v[200:203], v[196:199], a[188:191], v[200:203]
v_add_f32 v180, v180, v172
v_add_f32 v180, v180, v174
v_mfma_f32_16x16x32_bf16 v[200:203], v[220:223], a[180:183], v[200:203]
v_cvt_pk_bf16_f32 v94, v208, v209
v_cvt_pk_bf16_f32 v95, v210, v211
v_mfma_f32_16x16x32_bf16 v[200:203], v[228:231], a[176:179], v[200:203]
v_add_f32 v180, v180, v176
v_add_f32 v180, v180, v178
v_mfma_f32_16x16x32_bf16 v[204:207], v[228:231], a[160:163], 0
v_cvt_pk_bf16_f32 v173, v172, v174
v_add_f32_dpp v180, v180, v180 row_ror:8 row_mask:0xf bank_mask:0xf
v_mfma_f32_16x16x32_bf16 v[204:207], v[220:223], a[164:167], v[204:207]
ds_write_b16 v248, v173 offset:272
v_mfma_f32_16x16x32_bf16 v[204:207], v[216:219], a[168:171], v[204:207]
ds_write_b16_d16_hi v248, v173 offset:276
v_mfma_f32_16x16x32_bf16 v[204:207], v[196:199], a[172:175], v[204:207]
v_cvt_pk_bf16_f32 v60, v200, v201
v_cvt_pk_bf16_f32 v61, v202, v203
v_mfma_f32_16x16x32_bf16 v[212:215], v[24:27], v[96:99], 0
v_cvt_pk_bf16_f32 v177, v176, v178
v_add_f32_dpp v180, v180, v180 row_ror:4 row_mask:0xf bank_mask:0xf
v_mfma_f32_16x16x32_bf16 v[212:215], v[28:31], v[100:103], v[212:215]
ds_write_b16 v248, v177 offset:544
v_mfma_f32_16x16x32_bf16 v[192:195], v[36:39], v[100:103], 0
ds_write_b32 v250, v180 offset:256
v_mfma_f32_16x16x32_bf16 v[192:195], v[32:35], v[96:99], v[192:195]
ds_write_b16_d16_hi v248, v177 offset:548
v_mfma_f32_16x16x32_bf16 v[200:203], v[40:43], v[96:99], 0
v_cvt_pk_bf16_f32 v56, v204, v205
v_cvt_pk_bf16_f32 v57, v206, v207
v_mfma_f32_16x16x32_bf16 v[200:203], v[44:47], v[100:103], v[200:203]
v_cvt_pk_bf16_f32 v90, v232, v233
v_cvt_pk_bf16_f32 v91, v234, v235
v_mfma_f32_16x16x32_bf16 v[204:207], v[12:15], v[100:103], 0
v_exp_f32 v192, v192
v_mfma_f32_16x16x32_bf16 v[204:207], v[8:11], v[96:99], v[204:207]
v_exp_f32 v112, v193
v_mfma_f32_16x16x32_bf16 v[208:211], v[16:19], v[96:99], 0
v_exp_f32 v194, v194
v_mfma_f32_16x16x32_bf16 v[208:211], v[20:23], v[100:103], v[208:211]
v_exp_f32 v113, v195
v_mfma_f32_32x32x16_bf16 v[168:183], v[236:239], v[116:119], 0
buffer_store_dwordx4 v[156:159], v244, s[20:23], s53 offen offset:0 nt
buffer_store_dwordx4 v[160:163], v244, s[20:23], s53 offen offset:256 nt
v_exp_f32 v204, v204
v_exp_f32 v106, v205
v_mfma_f32_16x16x32_bf16 v[224:227], v[196:199], a[156:159], 0
s_add_u32 s53, s46, 0
v_exp_f32 v206, v206
v_mfma_f32_16x16x32_bf16 v[224:227], v[216:219], a[152:155], v[224:227]
v_exp_f32 v107, v207
v_mfma_f32_16x16x32_bf16 v[224:227], v[220:223], a[148:151], v[224:227]
v_mov_b32_sdwa v106, v204 dst_sel:WORD_0 dst_unused:UNUSED_PRESERVE src0_sel:WORD_1
v_mov_b32_sdwa v107, v206 dst_sel:WORD_0 dst_unused:UNUSED_PRESERVE src0_sel:WORD_1
v_mfma_f32_16x16x32_bf16 v[224:227], v[228:231], a[144:147], v[224:227]
v_exp_f32 v208, v208
v_mfma_f32_16x16x32_bf16 v[232:235], v[228:231], a[128:131], 0
v_exp_f32 v108, v209
v_mfma_f32_16x16x32_bf16 v[232:235], v[220:223], a[132:135], v[232:235]
v_exp_f32 v210, v210
v_mfma_f32_16x16x32_bf16 v[232:235], v[216:219], a[136:139], v[232:235]
v_exp_f32 v109, v211
v_mfma_f32_16x16x32_bf16 v[232:235], v[196:199], a[140:143], v[232:235]
v_mov_b32_sdwa v108, v208 dst_sel:WORD_0 dst_unused:UNUSED_PRESERVE src0_sel:WORD_1
v_mov_b32_sdwa v109, v210 dst_sel:WORD_0 dst_unused:UNUSED_PRESERVE src0_sel:WORD_1
v_mfma_f32_16x16x32_bf16 v[204:207], a[0:3], v[228:231], 0
v_mov_b32_sdwa v112, v192 dst_sel:WORD_0 dst_unused:UNUSED_PRESERVE src0_sel:WORD_1
v_mov_b32_sdwa v113, v194 dst_sel:WORD_0 dst_unused:UNUSED_PRESERVE src0_sel:WORD_1
v_mfma_f32_16x16x32_bf16 v[204:207], a[4:7], v[220:223], v[204:207]
v_exp_f32 v200, v200
v_mfma_f32_16x16x32_bf16 v[204:207], a[8:11], v[216:219], v[204:207]
v_exp_f32 v114, v201
v_mfma_f32_16x16x32_bf16 v[204:207], a[12:15], v[196:199], v[204:207]
buffer_load_dwordx4 v243, s[16:19], s98 offen offset:0 nt lds
v_mfma_f32_16x16x32_bf16 v[208:211], a[28:31], v[196:199], 0
v_exp_f32 v202, v202
v_mfma_f32_16x16x32_bf16 v[208:211], a[24:27], v[216:219], v[208:211]
v_exp_f32 v115, v203
v_mfma_f32_16x16x32_bf16 v[208:211], a[20:23], v[220:223], v[208:211]
v_mov_b32_sdwa v114, v200 dst_sel:WORD_0 dst_unused:UNUSED_PRESERVE src0_sel:WORD_1
v_mov_b32_sdwa v115, v202 dst_sel:WORD_0 dst_unused:UNUSED_PRESERVE src0_sel:WORD_1
v_mfma_f32_16x16x32_bf16 v[208:211], a[16:19], v[228:231], v[208:211]
v_cvt_pk_bf16_f32 v96, v204, v205
v_cvt_pk_bf16_f32 v97, v206, v207
v_mfma_f32_16x16x32_bf16 v[204:207], a[32:35], v[228:231], 0
v_exp_f32 v188, v188
v_mfma_f32_16x16x32_bf16 v[204:207], a[36:39], v[220:223], v[204:207]
v_exp_f32 v104, v189
v_mfma_f32_16x16x32_bf16 v[204:207], a[40:43], v[216:219], v[204:207]
s_nop 0
v_cvt_pk_bf16_f32 v98, v208, v209
v_cvt_pk_bf16_f32 v99, v210, v211
v_mfma_f32_16x16x32_bf16 v[204:207], a[44:47], v[196:199], v[204:207]
v_exp_f32 v190, v190
v_mfma_f32_16x16x32_bf16 v[192:195], a[60:63], v[196:199], 0
v_exp_f32 v105, v191
v_mfma_f32_16x16x32_bf16 v[192:195], a[56:59], v[216:219], v[192:195]
v_mov_b32_sdwa v104, v188 dst_sel:WORD_0 dst_unused:UNUSED_PRESERVE src0_sel:WORD_1
v_mov_b32_sdwa v105, v190 dst_sel:WORD_0 dst_unused:UNUSED_PRESERVE src0_sel:WORD_1
v_mfma_f32_16x16x32_bf16 v[192:195], a[52:55], v[220:223], v[192:195]
ds_read_b128 v[188:191], v242 offset:16896
v_cvt_pk_bf16_f32 v100, v204, v205
v_mfma_f32_16x16x32_bf16 v[192:195], a[48:51], v[228:231], v[192:195]
v_cvt_pk_bf16_f32 v101, v206, v207
v_cvt_pk_bf16_f32 v52, v224, v225
v_mfma_f32_16x16x32_bf16 v[152:155], a[192:195], v[228:231], 0
v_exp_f32 v212, v212
v_mfma_f32_16x16x32_bf16 v[152:155], a[196:199], v[220:223], v[152:155]
v_exp_f32 v110, v213
v_mfma_f32_16x16x32_bf16 v[152:155], a[200:203], v[216:219], v[152:155]
s_nop 0
v_cvt_pk_bf16_f32 v102, v192, v193
v_cvt_pk_bf16_f32 v103, v194, v195
v_mfma_f32_16x16x32_bf16 v[152:155], a[204:207], v[196:199], v[152:155]
v_exp_f32 v214, v214
v_mfma_f32_16x16x32_bf16 v[156:159], a[220:223], v[196:199], 0
v_exp_f32 v111, v215
v_mfma_f32_16x16x32_bf16 v[156:159], a[216:219], v[216:219], v[156:159]
v_mov_b32_sdwa v110, v212 dst_sel:WORD_0 dst_unused:UNUSED_PRESERVE src0_sel:WORD_1
v_mov_b32_sdwa v111, v214 dst_sel:WORD_0 dst_unused:UNUSED_PRESERVE src0_sel:WORD_1
v_mfma_f32_16x16x32_bf16 v[156:159], a[212:215], v[220:223], v[156:159]
ds_read_b128 v[192:195], v242 offset:4224
ds_read_b128 v[200:203], v242 offset:4480
v_mfma_f32_16x16x32_bf16 v[156:159], a[208:211], v[228:231], v[156:159]
buffer_load_dwordx4 v243, s[16:19], s99 offen offset:1056 nt lds
v_mfma_f32_16x16x32_bf16 v[160:163], a[224:227], v[228:231], 0
ds_read_b128 v[204:207], v242 offset:4736
ds_read_b128 v[212:215], v242 offset:17152
v_mfma_f32_16x16x32_bf16 v[160:163], a[228:231], v[220:223], v[160:163]
v_cvt_pk_bf16_f32 v53, v226, v227
v_cvt_pk_bf16_f32 v48, v232, v233
v_mfma_f32_16x16x32_bf16 v[160:163], a[232:235], v[216:219], v[160:163]
ds_read_b128 v[224:227], v242 offset:17408
v_cvt_pk_bf16_f32 v49, v234, v235
v_mfma_f32_16x16x32_bf16 v[160:163], a[236:239], v[196:199], v[160:163]
s_waitcnt lgkmcnt(5)
ds_read_b128 v[232:235], v242 offset:17664
v_mfma_f32_16x16x32_bf16 v[208:211], v[8:11], v[96:99], 0
s_waitcnt lgkmcnt(5)
v_mfma_f32_16x16x32_bf16 v[208:211], v[12:15], v[100:103], v[208:211]
s_nop 2
v_mfma_f32_16x16x32_bf16 v[164:167], a[252:255], v[196:199], 0
ds_read_b128 v[196:199], v242 offset:4992
s_nop 0
v_mfma_f32_16x16x32_bf16 v[164:167], a[248:251], v[216:219], v[164:167]
v_mov_b64 v[216:217], 0
v_mov_b64 v[218:219], 0
v_mfma_f32_16x16x32_bf16 v[164:167], a[244:247], v[220:223], v[164:167]
v_exp_f32 v208, v208
v_mfma_f32_16x16x32_bf16 v[164:167], a[240:243], v[228:231], v[164:167]
s_waitcnt lgkmcnt(1)
v_exp_f32 v122, v209
v_mfma_f32_16x16x32_bf16 v[220:223], v[4:7], v[100:103], 0
v_exp_f32 v210, v210
v_mfma_f32_16x16x32_bf16 v[220:223], v[0:3], v[96:99], v[220:223]
v_exp_f32 v123, v211
v_smfmac_f32_16x16x64_bf16 v[216:219], v[238:241], v[96:103], v251
v_mov_b32_sdwa v122, v208 dst_sel:WORD_0 dst_unused:UNUSED_PRESERVE src0_sel:WORD_1
v_mfma_f32_16x16x32_bf16 v[228:231], v[192:195], a[128:131], 0
v_mov_b32_sdwa v123, v210 dst_sel:WORD_0 dst_unused:UNUSED_PRESERVE src0_sel:WORD_1
s_nop 0
v_mfma_f32_16x16x32_bf16 v[228:231], v[200:203], a[132:135], v[228:231]
s_waitcnt lgkmcnt(0)
v_exp_f32 v220, v220
v_mfma_f32_16x16x32_bf16 v[228:231], v[204:207], a[136:139], v[228:231]
v_exp_f32 v120, v221
v_mfma_f32_16x16x32_bf16 v[228:231], v[196:199], a[140:143], v[228:231]
v_exp_f32 v222, v222
v_mfma_f32_16x16x32_bf16 v[208:211], v[196:199], a[156:159], 0
v_exp_f32 v121, v223
v_mfma_f32_16x16x32_bf16 v[208:211], v[204:207], a[152:155], v[208:211]
v_mov_b32_sdwa v120, v220 dst_sel:WORD_0 dst_unused:UNUSED_PRESERVE src0_sel:WORD_1
v_mov_b32_sdwa v121, v222 dst_sel:WORD_0 dst_unused:UNUSED_PRESERVE src0_sel:WORD_1
v_mfma_f32_16x16x32_bf16 v[208:211], v[200:203], a[148:151], v[208:211]
v_add_f32 v216, v216, v217
v_add_f32 v218, v218, v219
v_mfma_f32_16x16x32_bf16 v[208:211], v[192:195], a[144:147], v[208:211]
v_exp_f32 v216, v216
v_mfma_f32_16x16x32_bf16 v[220:223], v[192:195], a[160:163], 0
v_exp_f32 v218, v218
v_mfma_f32_16x16x32_bf16 v[220:223], v[200:203], a[164:167], v[220:223]
v_perm_b32 v132, v218, v216, v252
v_perm_b32 v133, v218, v216, v253
v_mfma_f32_16x16x32_bf16 v[220:223], v[204:207], a[168:171], v[220:223]
s_nop 0
v_cvt_pk_bf16_f32 v54, v208, v209
v_cvt_pk_bf16_f32 v55, v210, v211
v_mfma_f32_16x16x32_bf16 v[220:223], v[196:199], a[172:175], v[220:223]
buffer_load_dwordx4 v243, s[16:19], s100 offen offset:2112 nt lds
v_mfma_f32_16x16x32_bf16 v[208:211], v[196:199], a[188:191], 0
v_cvt_pk_bf16_f32 v50, v228, v229
v_cvt_pk_bf16_f32 v51, v230, v231
v_mfma_f32_16x16x32_bf16 v[208:211], v[204:207], a[184:187], v[208:211]
s_nop 1
v_mfma_f32_16x16x32_bf16 v[208:211], v[200:203], a[180:183], v[208:211]
v_cvt_pk_bf16_f32 v58, v220, v221
v_cvt_pk_bf16_f32 v59, v222, v223
v_mfma_f32_16x16x32_bf16 v[208:211], v[192:195], a[176:179], v[208:211]
s_nop 2
v_mfma_f32_16x16x32_bf16 v[192:195], v[16:19], v[96:99], 0
s_nop 2
v_mfma_f32_16x16x32_bf16 v[192:195], v[20:23], v[100:103], v[192:195]
v_mov_b64 v[196:197], 0
v_cvt_pk_bf16_f32 v62, v208, v209
v_mfma_f32_16x16x32_bf16 v[200:203], v[36:39], v[100:103], 0
v_cvt_pk_bf16_f32 v63, v210, v211
s_nop 0
v_mfma_f32_16x16x32_bf16 v[200:203], v[32:35], v[96:99], v[200:203]
s_nop 2
v_mfma_f32_16x16x32_bf16 v[204:207], v[24:27], v[96:99], 0
v_exp_f32 v192, v192
v_mfma_f32_16x16x32_bf16 v[204:207], v[28:31], v[100:103], v[204:207]
v_exp_f32 v124, v193
v_smfmac_f32_16x16x64_bf16 v[196:199], v[184:187], v[104:111], v251
v_mov_b32_sdwa v124, v192 dst_sel:WORD_0 dst_unused:UNUSED_PRESERVE src0_sel:WORD_1
v_smfmac_f32_16x16x64_bf16 v[196:199], v[184:187], v[112:119], v251 abid:1
s_nop 2
v_mfma_f32_16x16x32_bf16 v[208:211], v[232:235], a[188:191], 0
v_exp_f32 v194, v194
v_mfma_f32_16x16x32_bf16 v[208:211], v[224:227], a[184:187], v[208:211]
v_exp_f32 v125, v195
v_mfma_f32_16x16x32_bf16 v[208:211], v[212:215], a[180:183], v[208:211]
v_mov_b32_sdwa v125, v194 dst_sel:WORD_0 dst_unused:UNUSED_PRESERVE src0_sel:WORD_1
v_add_f32 v196, v196, v197
v_mfma_f32_16x16x32_bf16 v[208:211], v[188:191], a[176:179], v[208:211]
v_exp_f32 v204, v204
v_mfma_f32_16x16x32_bf16 v[192:195], v[188:191], a[160:163], 0
v_exp_f32 v126, v205
v_mfma_f32_16x16x32_bf16 v[192:195], v[212:215], a[164:167], v[192:195]
v_exp_f32 v206, v206
v_mfma_f32_16x16x32_bf16 v[192:195], v[224:227], a[168:171], v[192:195]
v_exp_f32 v127, v207
v_mfma_f32_16x16x32_bf16 v[192:195], v[232:235], a[172:175], v[192:195]
buffer_load_dwordx4 v243, s[16:19], s101 offen offset:3168 nt lds
v_mfma_f32_16x16x32_bf16 v[216:219], v[232:235], a[156:159], 0
s_mov_b32 m0, s58
v_mov_b32_sdwa v126, v204 dst_sel:WORD_0 dst_unused:UNUSED_PRESERVE src0_sel:WORD_1
v_mov_b32_sdwa v127, v206 dst_sel:WORD_0 dst_unused:UNUSED_PRESERVE src0_sel:WORD_1
v_mfma_f32_16x16x32_bf16 v[216:219], v[224:227], a[152:155], v[216:219]
v_cvt_pk_bf16_f32 v92, v208, v209
v_cvt_pk_bf16_f32 v93, v210, v211
v_mfma_f32_16x16x32_bf16 v[216:219], v[212:215], a[148:151], v[216:219]
v_cvt_pk_bf16_f32 v88, v192, v193
v_cvt_pk_bf16_f32 v89, v194, v195
v_mfma_f32_16x16x32_bf16 v[216:219], v[188:191], a[144:147], v[216:219]
v_rcp_f32 v254, v196
v_mfma_f32_16x16x32_bf16 v[192:195], v[188:191], a[128:131], 0
v_max3_f32 v255, v255, v196, v254
s_nop 0
v_mfma_f32_16x16x32_bf16 v[192:195], v[212:215], a[132:135], v[192:195]
v_exp_f32 v200, v200
v_mfma_f32_16x16x32_bf16 v[192:195], v[224:227], a[136:139], v[192:195]
s_nop 0
v_cvt_pk_bf16_f32 v84, v216, v217
v_cvt_pk_bf16_f32 v85, v218, v219
v_mfma_f32_16x16x32_bf16 v[192:195], v[232:235], a[140:143], v[192:195]
L_h2:
s_cbranch_execz L_ret
v_exp_f32 v128, v201
v_mfma_f32_16x16x32_bf16 v[204:207], v[40:43], v[96:99], 0
ds_read_b128 v[208:211], v249 offset:0
ds_read_b128 v[216:219], v249 offset:272
v_mfma_f32_16x16x32_bf16 v[204:207], v[44:47], v[100:103], v[204:207]
ds_read_b128 v[220:223], v249 offset:544
v_mov_b32_sdwa v128, v200 dst_sel:WORD_0 dst_unused:UNUSED_PRESERVE src0_sel:WORD_1
v_mfma_f32_16x16x32_bf16 v[168:171], v[48:51], v[104:107], v[168:171]
v_cvt_pk_bf16_f32 v80, v192, v193
v_cvt_pk_bf16_f32 v81, v194, v195
v_mfma_f32_16x16x32_bf16 v[168:171], v[64:67], v[108:111], v[168:171]
v_exp_f32 v202, v202
v_mfma_f32_16x16x32_bf16 v[168:171], v[80:83], v[112:115], v[168:171]
v_exp_f32 v129, v203
v_mfma_f32_16x16x32_bf16 v[172:175], v[84:87], v[112:115], v[172:175]
v_mov_b32_sdwa v129, v202 dst_sel:WORD_0 dst_unused:UNUSED_PRESERVE src0_sel:WORD_1
s_nop 0
v_mfma_f32_16x16x32_bf16 v[172:175], v[52:55], v[104:107], v[172:175]
v_exp_f32 v204, v204
v_mfma_f32_16x16x32_bf16 v[172:175], v[68:71], v[108:111], v[172:175]
v_exp_f32 v130, v205
v_mfma_f32_16x16x32_bf16 v[176:179], v[72:75], v[108:111], v[176:179]
v_exp_f32 v206, v206
v_mfma_f32_16x16x32_bf16 v[176:179], v[88:91], v[112:115], v[176:179]
v_exp_f32 v131, v207
v_mfma_f32_16x16x32_bf16 v[176:179], v[56:59], v[104:107], v[176:179]
v_mov_b32_sdwa v130, v204 dst_sel:WORD_0 dst_unused:UNUSED_PRESERVE src0_sel:WORD_1
v_mov_b32_sdwa v131, v206 dst_sel:WORD_0 dst_unused:UNUSED_PRESERVE src0_sel:WORD_1
L_entryf:
v_mfma_f32_16x16x32_bf16 v[180:183], v[60:63], v[104:107], v[180:183]
v_fmac_f32 v136, v168, v254
v_fmac_f32 v137, v169, v254
v_mfma_f32_16x16x32_bf16 v[180:183], v[76:79], v[108:111], v[180:183]
v_fmac_f32 v138, v170, v254
v_fmac_f32 v139, v171, v254
v_mfma_f32_16x16x32_bf16 v[180:183], v[92:95], v[112:115], v[180:183]
s_waitcnt lgkmcnt(1)
v_fmac_f32 v144, v176, v254
v_fmac_f32 v145, v177, v254
v_mfma_f32_16x16x32_bf16 v[192:195], a[0:3], v[188:191], 0
s_waitcnt lgkmcnt(0)
v_fmac_f32 v146, v178, v254
v_fmac_f32 v147, v179, v254
v_mfma_f32_16x16x32_bf16 v[192:195], a[4:7], v[212:215], v[192:195]
s_mov_b64 vcc, s[14:15]
v_cvt_pk_bf16_f32 v144, v144, v145
v_fmac_f32 v148, v180, v254
v_mfma_f32_16x16x32_bf16 v[192:195], a[8:11], v[224:227], v[192:195]
v_fmac_f32 v149, v181, v254
v_fmac_f32 v150, v182, v254
v_mfma_f32_16x16x32_bf16 v[192:195], a[12:15], v[232:235], v[192:195]
v_fmac_f32 v151, v183, v254
v_cvt_pk_bf16_f32 v145, v146, v147
v_mfma_f32_16x16x32_bf16 v[196:199], a[28:31], v[232:235], 0
v_cvt_pk_bf16_f32 v146, v148, v149
v_cvt_pk_bf16_f32 v147, v150, v151
v_mfma_f32_16x16x32_bf16 v[196:199], a[24:27], v[224:227], v[196:199]
v_cvt_pk_bf16_f32 v136, v136, v137
v_fmac_f32 v140, v172, v254
v_mfma_f32_16x16x32_bf16 v[196:199], a[20:23], v[212:215], v[196:199]
v_cvt_pk_bf16_f32 v96, v192, v193
v_cvt_pk_bf16_f32 v97, v194, v195
v_mfma_f32_16x16x32_bf16 v[196:199], a[16:19], v[188:191], v[196:199]
v_fmac_f32 v141, v173, v254
v_fmac_f32 v142, v174, v254
v_mfma_f32_16x16x32_bf16 v[192:195], a[32:35], v[188:191], 0
v_fmac_f32 v143, v175, v254
v_cvt_pk_bf16_f32 v137, v138, v139
v_mfma_f32_16x16x32_bf16 v[192:195], a[36:39], v[212:215], v[192:195]
v_cvt_pk_bf16_f32 v138, v140, v141
v_cvt_pk_bf16_f32 v139, v142, v143
v_mfma_f32_16x16x32_bf16 v[192:195], a[40:43], v[224:227], v[192:195]
v_cvt_pk_bf16_f32 v98, v196, v197
v_cvt_pk_bf16_f32 v99, v198, v199
v_mfma_f32_16x16x32_bf16 v[192:195], a[44:47], v[232:235], v[192:195]
v_mov_b64 v[196:197], 0
v_mov_b64 v[198:199], 0
v_mfma_f32_16x16x32_bf16 v[200:203], a[60:63], v[232:235], 0
v_pk_max_i16 v136, v136, 0
v_pk_max_i16 v137, v137, 0
v_mfma_f32_16x16x32_bf16 v[200:203], a[56:59], v[224:227], v[200:203]
v_pk_max_i16 v138, v138, 0
v_pk_max_i16 v139, v139, 0
v_mfma_f32_16x16x32_bf16 v[200:203], a[52:55], v[212:215], v[200:203]
v_mov_b64 v[204:205], 0
v_mov_b64 v[206:207], 0
v_mfma_f32_16x16x32_bf16 v[200:203], a[48:51], v[188:191], v[200:203]
v_cvt_pk_bf16_f32 v100, v192, v193
v_cvt_pk_bf16_f32 v101, v194, v195
v_smfmac_f32_16x16x64_bf16 v[196:199], v[208:211], v[48:55], v251
v_pk_max_i16 v144, v144, 0
v_smfmac_f32_16x16x64_bf16 v[196:199], v[216:219], v[64:71], v251
v_pk_max_i16 v145, v145, 0
v_smfmac_f32_16x16x64_bf16 v[196:199], v[220:223], v[80:87], v251
s_nop 0
v_cvt_pk_bf16_f32 v102, v200, v201
v_smfmac_f32_16x16x64_bf16 v[204:207], v[220:223], v[88:95], v251
v_cvt_pk_bf16_f32 v103, v202, v203
v_smfmac_f32_16x16x64_bf16 v[204:207], v[216:219], v[72:79], v251
v_mov_b64 v[192:193], 0
v_smfmac_f32_16x16x64_bf16 v[204:207], v[208:211], v[56:63], v251
v_mov_b64 v[194:195], 0
v_mfma_f32_16x16x32_bf16 v[200:203], v[4:7], v[100:103], 0
v_pk_max_i16 v146, v146, 0
v_pk_max_i16 v147, v147, 0
v_mfma_f32_16x16x32_bf16 v[200:203], v[0:3], v[96:99], v[200:203]
v_cndmask_b32_dpp v140, v144, v136, vcc quad_perm:[1,0,3,2] row_mask:0xf bank_mask:0xf
v_cndmask_b32_dpp v141, v145, v137, vcc quad_perm:[1,0,3,2] row_mask:0xf bank_mask:0xf
v_smfmac_f32_16x16x64_bf16 v[192:195], v[238:241], v[96:103], v251
v_cndmask_b32_dpp v142, v146, v138, vcc quad_perm:[1,0,3,2] row_mask:0xf bank_mask:0xf
v_mfma_f32_16x16x32_bf16 v[208:211], v[16:19], v[96:99], 0
v_cndmask_b32_dpp v143, v147, v139, vcc quad_perm:[1,0,3,2] row_mask:0xf bank_mask:0xf
v_add_f32 v196, v196, v197
v_mfma_f32_16x16x32_bf16 v[208:211], v[20:23], v[100:103], v[208:211]
s_not_b64 vcc, vcc
ds_write_b32 v250, v196 offset:0
v_mfma_f32_16x16x32_bf16 v[216:219], v[12:15], v[100:103], 0
v_cndmask_b32_dpp v144, v136, v144, vcc quad_perm:[1,0,3,2] row_mask:0xf bank_mask:0xf
v_cndmask_b32_dpp v145, v137, v145, vcc quad_perm:[1,0,3,2] row_mask:0xf bank_mask:0xf
v_mfma_f32_16x16x32_bf16 v[216:219], v[8:11], v[96:99], v[216:219]
v_cndmask_b32_dpp v146, v138, v146, vcc quad_perm:[1,0,3,2] row_mask:0xf bank_mask:0xf
v_cndmask_b32_dpp v147, v139, v147, vcc quad_perm:[1,0,3,2] row_mask:0xf bank_mask:0xf
v_mfma_f32_16x16x32_bf16 v[220:223], v[24:27], v[96:99], 0
v_add_f32 v198, v198, v199
v_add_f32 v192, v192, v193
v_mfma_f32_16x16x32_bf16 v[220:223], v[28:31], v[100:103], v[220:223]
ds_write_b32 v250, v198 offset:64
v_mfma_f32_32x32x16_bf16 v[168:183], v[236:239], v[132:135], 0
buffer_store_dwordx4 v[140:143], v244, s[20:23], s52 offen offset:0 nt
buffer_store_dwordx4 v[144:147], v244, s[20:23], s52 offen offset:256 nt
v_exp_f32 v200, v200
v_exp_f32 v104, v201
v_mfma_f32_16x16x32_bf16 v[136:139], a[192:195], v[188:191], 0
s_add_u32 s52, s46, 16384
v_exp_f32 v202, v202
v_mfma_f32_16x16x32_bf16 v[136:139], a[196:199], v[212:215], v[136:139]
v_exp_f32 v105, v203
v_mfma_f32_16x16x32_bf16 v[136:139], a[200:203], v[224:227], v[136:139]
v_exp_f32 v216, v216
v_mfma_f32_16x16x32_bf16 v[136:139], a[204:207], v[232:235], v[136:139]
v_exp_f32 v106, v217
v_mfma_f32_16x16x32_bf16 v[140:143], a[220:223], v[232:235], 0
v_exp_f32 v218, v218
v_mfma_f32_16x16x32_bf16 v[140:143], a[216:219], v[224:227], v[140:143]
v_exp_f32 v107, v219
v_mfma_f32_16x16x32_bf16 v[140:143], a[212:215], v[212:215], v[140:143]
v_mov_b32_sdwa v104, v200 dst_sel:WORD_0 dst_unused:UNUSED_PRESERVE src0_sel:WORD_1
v_mov_b32_sdwa v105, v202 dst_sel:WORD_0 dst_unused:UNUSED_PRESERVE src0_sel:WORD_1
v_mfma_f32_16x16x32_bf16 v[140:143], a[208:211], v[188:191], v[140:143]
v_mov_b32_sdwa v106, v216 dst_sel:WORD_0 dst_unused:UNUSED_PRESERVE src0_sel:WORD_1
v_mov_b32_sdwa v107, v218 dst_sel:WORD_0 dst_unused:UNUSED_PRESERVE src0_sel:WORD_1
v_mfma_f32_16x16x32_bf16 v[144:147], a[224:227], v[188:191], 0
v_add_f32 v194, v194, v195
v_add_f32 v204, v204, v205
v_mfma_f32_16x16x32_bf16 v[144:147], a[228:231], v[212:215], v[144:147]
ds_write_b32 v250, v204 offset:128
v_mfma_f32_16x16x32_bf16 v[144:147], a[232:235], v[224:227], v[144:147]
v_exp_f32 v192, v192
v_mfma_f32_16x16x32_bf16 v[144:147], a[236:239], v[232:235], v[144:147]
v_exp_f32 v194, v194
v_mfma_f32_16x16x32_bf16 v[148:151], a[252:255], v[232:235], 0
v_perm_b32 v116, v194, v192, v252
v_perm_b32 v117, v194, v192, v253
v_mfma_f32_16x16x32_bf16 v[148:151], a[248:251], v[224:227], v[148:151]
v_mov_b64 v[196:197], 0
v_add_f32 v206, v206, v207
v_mfma_f32_16x16x32_bf16 v[148:151], a[244:247], v[212:215], v[148:151]
ds_write_b32 v250, v206 offset:192
v_mfma_f32_16x16x32_bf16 v[148:151], a[240:243], v[188:191], v[148:151]
v_exp_f32 v220, v220
v_mfma_f32_16x16x32_bf16 v[188:191], v[40:43], v[96:99], 0
v_exp_f32 v110, v221
v_mfma_f32_16x16x32_bf16 v[188:191], v[44:47], v[100:103], v[188:191]
v_exp_f32 v222, v222
v_smfmac_f32_16x16x64_bf16 v[196:199], v[184:187], v[120:127], v251
ds_read_b128 v[200:203], v242 offset:4224
v_mov_b32_sdwa v110, v220 dst_sel:WORD_0 dst_unused:UNUSED_PRESERVE src0_sel:WORD_1
v_smfmac_f32_16x16x64_bf16 v[196:199], v[184:187], v[128:135], v251 abid:1
ds_read_b128 v[212:215], v242 offset:4736
ds_read_b128 v[216:219], v242 offset:4992
v_mfma_f32_16x16x32_bf16 v[168:171], v[80:83], v[128:131], v[168:171]
v_exp_f32 v111, v223
v_mfma_f32_16x16x32_bf16 v[168:171], v[64:67], v[124:127], v[168:171]
v_mov_b32_sdwa v111, v222 dst_sel:WORD_0 dst_unused:UNUSED_PRESERVE src0_sel:WORD_1
v_add_u32 v250, 1728, v250
v_mfma_f32_16x16x32_bf16 v[168:171], v[48:51], v[120:123], v[168:171]
v_exp_f32 v208, v208
v_mfma_f32_16x16x32_bf16 v[172:175], v[52:55], v[120:123], v[172:175]
v_exp_f32 v108, v209
v_mfma_f32_16x16x32_bf16 v[172:175], v[68:71], v[124:127], v[172:175]
v_exp_f32 v210, v210
v_mfma_f32_16x16x32_bf16 v[172:175], v[84:87], v[128:131], v[172:175]
v_exp_f32 v109, v211
v_mfma_f32_16x16x32_bf16 v[176:179], v[88:91], v[128:131], v[176:179]
v_mov_b32_sdwa v108, v208 dst_sel:WORD_0 dst_unused:UNUSED_PRESERVE src0_sel:WORD_1
v_mov_b32_sdwa v109, v210 dst_sel:WORD_0 dst_unused:UNUSED_PRESERVE src0_sel:WORD_1
v_mfma_f32_16x16x32_bf16 v[176:179], v[72:75], v[124:127], v[176:179]
ds_read_b128 v[208:211], v242 offset:4480
v_add_f32 v196, v196, v197
v_mfma_f32_16x16x32_bf16 v[176:179], v[56:59], v[120:123], v[176:179]
v_rcp_f32 v254, v196
v_mfma_f32_16x16x32_bf16 v[180:183], v[60:63], v[120:123], v[180:183]
v_max3_f32 v255, v255, v196, v254
v_fmac_f32 v152, v168, v254
v_mfma_f32_16x16x32_bf16 v[180:183], v[76:79], v[124:127], v[180:183]
v_fmac_f32 v153, v169, v254
v_fmac_f32 v154, v170, v254
v_mfma_f32_16x16x32_bf16 v[180:183], v[92:95], v[128:131], v[180:183]
s_waitcnt lgkmcnt(3)
v_fmac_f32 v160, v176, v254
v_fmac_f32 v161, v177, v254
v_mfma_f32_16x16x32_bf16 v[192:195], v[32:35], v[96:99], 0
s_waitcnt lgkmcnt(1)
v_fmac_f32 v155, v171, v254
v_cvt_pk_bf16_f32 v152, v152, v153
v_mfma_f32_16x16x32_bf16 v[192:195], v[36:39], v[100:103], v[192:195]
s_waitcnt lgkmcnt(0)
v_fmac_f32 v162, v178, v254
v_fmac_f32 v163, v179, v254
v_mfma_f32_16x16x32_bf16 v[220:223], a[0:3], v[200:203], 0
s_mov_b64 vcc, s[14:15]
v_cvt_pk_bf16_f32 v160, v160, v161
v_fmac_f32 v156, v172, v254
v_mfma_f32_16x16x32_bf16 v[220:223], a[4:7], v[208:211], v[220:223]
v_fmac_f32 v157, v173, v254
v_fmac_f32 v158, v174, v254
v_mfma_f32_16x16x32_bf16 v[220:223], a[8:11], v[212:215], v[220:223]
v_fmac_f32 v159, v175, v254
v_cvt_pk_bf16_f32 v153, v154, v155
v_mfma_f32_16x16x32_bf16 v[220:223], a[12:15], v[216:219], v[220:223]
v_fmac_f32 v164, v180, v254
v_fmac_f32 v165, v181, v254
v_mfma_f32_16x16x32_bf16 v[224:227], a[28:31], v[216:219], 0
v_fmac_f32 v166, v182, v254
v_fmac_f32 v167, v183, v254
v_mfma_f32_16x16x32_bf16 v[224:227], a[24:27], v[212:215], v[224:227]
v_cvt_pk_bf16_f32 v161, v162, v163
v_cvt_pk_bf16_f32 v154, v156, v157
v_mfma_f32_16x16x32_bf16 v[224:227], a[20:23], v[208:211], v[224:227]
v_cvt_pk_bf16_f32 v155, v158, v159
v_cvt_pk_bf16_f32 v162, v164, v165
v_mfma_f32_16x16x32_bf16 v[224:227], a[16:19], v[200:203], v[224:227]
v_cvt_pk_bf16_f32 v163, v166, v167
v_pk_max_i16 v152, v152, 0
v_mfma_f32_16x16x32_bf16 v[228:231], a[32:35], v[200:203], 0
v_pk_max_i16 v153, v153, 0
v_pk_max_i16 v154, v154, 0
v_mfma_f32_16x16x32_bf16 v[228:231], a[36:39], v[208:211], v[228:231]
v_pk_max_i16 v155, v155, 0
v_pk_max_i16 v160, v160, 0
v_mfma_f32_16x16x32_bf16 v[228:231], a[40:43], v[212:215], v[228:231]
v_pk_max_i16 v161, v161, 0
v_pk_max_i16 v162, v162, 0
v_mfma_f32_16x16x32_bf16 v[228:231], a[44:47], v[216:219], v[228:231]
v_pk_max_i16 v163, v163, 0
v_cndmask_b32_dpp v156, v160, v152, vcc quad_perm:[1,0,3,2] row_mask:0xf bank_mask:0xf
v_mfma_f32_16x16x32_bf16 v[196:199], a[60:63], v[216:219], 0
v_cndmask_b32_dpp v157, v161, v153, vcc quad_perm:[1,0,3,2] row_mask:0xf bank_mask:0xf
v_cndmask_b32_dpp v158, v162, v154, vcc quad_perm:[1,0,3,2] row_mask:0xf bank_mask:0xf
v_mfma_f32_16x16x32_bf16 v[196:199], a[56:59], v[212:215], v[196:199]
v_cndmask_b32_dpp v159, v163, v155, vcc quad_perm:[1,0,3,2] row_mask:0xf bank_mask:0xf
v_cvt_pk_bf16_f32 v96, v220, v221
v_mfma_f32_16x16x32_bf16 v[196:199], a[52:55], v[208:211], v[196:199]
s_not_b64 vcc, vcc
v_cndmask_b32_dpp v160, v152, v160, vcc quad_perm:[1,0,3,2] row_mask:0xf bank_mask:0xf
v_cndmask_b32_dpp v161, v153, v161, vcc quad_perm:[1,0,3,2] row_mask:0xf bank_mask:0xf
v_mfma_f32_16x16x32_bf16 v[196:199], a[48:51], v[200:203], v[196:199]
v_cndmask_b32_dpp v162, v154, v162, vcc quad_perm:[1,0,3,2] row_mask:0xf bank_mask:0xf
v_cndmask_b32_dpp v163, v155, v163, vcc quad_perm:[1,0,3,2] row_mask:0xf bank_mask:0xf
v_mfma_f32_32x32x16_bf16 v[168:183], v[236:239], v[116:119], 0
buffer_store_dwordx4 v[156:159], v244, s[20:23], s53 offen offset:0 nt
buffer_store_dwordx4 v[160:163], v244, s[20:23], s53 offen offset:256 nt
v_cvt_pk_bf16_f32 v100, v228, v229
v_cvt_pk_bf16_f32 v101, v230, v231
v_exp_f32 v188, v188
v_mfma_f32_16x16x32_bf16 v[152:155], a[192:195], v[200:203], 0
s_add_u32 s53, s46, 4096
v_cvt_pk_bf16_f32 v102, v196, v197
v_cvt_pk_bf16_f32 v103, v198, v199
v_mfma_f32_16x16x32_bf16 v[152:155], a[196:199], v[208:211], v[152:155]
s_add_u32 s46, s46, 13107200
v_exp_f32 v114, v189
v_mfma_f32_16x16x32_bf16 v[152:155], a[200:203], v[212:215], v[152:155]
v_exp_f32 v190, v190
v_mfma_f32_16x16x32_bf16 v[152:155], a[204:207], v[216:219], v[152:155]
v_exp_f32 v115, v191
v_mfma_f32_16x16x32_bf16 v[156:159], a[220:223], v[216:219], 0
v_mov_b32_sdwa v114, v188 dst_sel:WORD_0 dst_unused:UNUSED_PRESERVE src0_sel:WORD_1
v_mov_b32_sdwa v115, v190 dst_sel:WORD_0 dst_unused:UNUSED_PRESERVE src0_sel:WORD_1
v_mfma_f32_16x16x32_bf16 v[156:159], a[216:219], v[212:215], v[156:159]
v_cvt_pk_bf16_f32 v97, v222, v223
v_cvt_pk_bf16_f32 v98, v224, v225
v_mfma_f32_16x16x32_bf16 v[156:159], a[212:215], v[208:211], v[156:159]
v_cvt_pk_bf16_f32 v99, v226, v227
v_mfma_f32_16x16x32_bf16 v[156:159], a[208:211], v[200:203], v[156:159]
v_exp_f32 v192, v192
v_mfma_f32_16x16x32_bf16 v[160:163], a[224:227], v[200:203], 0
v_exp_f32 v112, v193
v_mfma_f32_16x16x32_bf16 v[160:163], a[228:231], v[208:211], v[160:163]
v_exp_f32 v194, v194
v_mfma_f32_16x16x32_bf16 v[160:163], a[232:235], v[212:215], v[160:163]
v_exp_f32 v113, v195
v_mfma_f32_16x16x32_bf16 v[160:163], a[236:239], v[216:219], v[160:163]
v_mov_b32_sdwa v112, v192 dst_sel:WORD_0 dst_unused:UNUSED_PRESERVE src0_sel:WORD_1
v_mov_b32_sdwa v113, v194 dst_sel:WORD_0 dst_unused:UNUSED_PRESERVE src0_sel:WORD_1
v_mfma_f32_16x16x32_bf16 v[188:191], v[36:39], v[100:103], 0
ds_read_b128 v[192:195], v242 offset:8448
ds_read_b128 v[204:207], v242 offset:8704
v_mfma_f32_16x16x32_bf16 v[188:191], v[32:35], v[96:99], v[188:191]
ds_read_b128 v[220:223], v242 offset:8960
ds_read_b128 v[196:199], v242 offset:9216
v_mfma_f32_16x16x32_bf16 v[224:227], v[8:11], v[96:99], 0
s_nop 2
v_mfma_f32_16x16x32_bf16 v[224:227], v[12:15], v[100:103], v[224:227]
v_mov_b64 v[228:229], 0
s_nop 0
v_mfma_f32_16x16x32_bf16 v[164:167], a[252:255], v[216:219], 0
v_exp_f32 v188, v188
v_mfma_f32_16x16x32_bf16 v[164:167], a[248:251], v[212:215], v[164:167]
v_exp_f32 v128, v189
v_mfma_f32_16x16x32_bf16 v[164:167], a[244:247], v[208:211], v[164:167]
s_waitcnt lgkmcnt(3)
v_exp_f32 v224, v224
v_mfma_f32_16x16x32_bf16 v[164:167], a[240:243], v[200:203], v[164:167]
v_mov_b64 v[200:201], 0
v_mov_b64 v[202:203], 0
v_smfmac_f32_16x16x64_bf16 v[228:231], v[184:187], v[104:111], v251
v_mov_b32_sdwa v128, v188 dst_sel:WORD_0 dst_unused:UNUSED_PRESERVE src0_sel:WORD_1
v_smfmac_f32_16x16x64_bf16 v[228:231], v[184:187], v[112:119], v251 abid:1
s_nop 2
v_mfma_f32_16x16x32_bf16 v[208:211], v[4:7], v[100:103], 0
v_exp_f32 v122, v225
v_mfma_f32_16x16x32_bf16 v[208:211], v[0:3], v[96:99], v[208:211]
v_exp_f32 v226, v226
v_smfmac_f32_16x16x64_bf16 v[200:203], v[238:241], v[96:103], v251
v_add_f32 v228, v228, v229
v_mfma_f32_16x16x32_bf16 v[168:171], v[48:51], v[104:107], v[168:171]
s_waitcnt lgkmcnt(2)
v_rcp_f32 v254, v228
v_mfma_f32_16x16x32_bf16 v[168:171], v[64:67], v[108:111], v[168:171]
s_waitcnt lgkmcnt(0)
v_max3_f32 v255, v255, v228, v254
v_mov_b32_sdwa v122, v224 dst_sel:WORD_0 dst_unused:UNUSED_PRESERVE src0_sel:WORD_1
v_mfma_f32_16x16x32_bf16 v[168:171], v[80:83], v[112:115], v[168:171]
v_add_f32 v200, v200, v201
v_add_f32 v202, v202, v203
v_mfma_f32_16x16x32_bf16 v[212:215], v[24:27], v[96:99], 0
v_exp_f32 v200, v200
v_mfma_f32_16x16x32_bf16 v[212:215], v[28:31], v[100:103], v[212:215]
v_exp_f32 v202, v202
v_mfma_f32_16x16x32_bf16 v[216:219], v[44:47], v[100:103], 0
v_perm_b32 v132, v202, v200, v252
v_perm_b32 v133, v202, v200, v253
v_mfma_f32_16x16x32_bf16 v[216:219], v[40:43], v[96:99], v[216:219]
v_exp_f32 v123, v227
v_mfma_f32_16x16x32_bf16 v[228:231], v[16:19], v[96:99], 0
v_mov_b32_sdwa v123, v226 dst_sel:WORD_0 dst_unused:UNUSED_PRESERVE src0_sel:WORD_1
v_fmac_f32 v136, v168, v254
v_mfma_f32_16x16x32_bf16 v[228:231], v[20:23], v[100:103], v[228:231]
v_exp_f32 v208, v208
v_mfma_f32_16x16x32_bf16 v[172:175], v[52:55], v[104:107], v[172:175]
v_exp_f32 v120, v209
v_mfma_f32_16x16x32_bf16 v[172:175], v[68:71], v[108:111], v[172:175]
v_exp_f32 v210, v210
v_mfma_f32_16x16x32_bf16 v[172:175], v[84:87], v[112:115], v[172:175]
v_exp_f32 v121, v211
v_mfma_f32_16x16x32_bf16 v[176:179], v[88:91], v[112:115], v[176:179]
v_mov_b32_sdwa v120, v208 dst_sel:WORD_0 dst_unused:UNUSED_PRESERVE src0_sel:WORD_1
v_mov_b32_sdwa v121, v210 dst_sel:WORD_0 dst_unused:UNUSED_PRESERVE src0_sel:WORD_1
v_mfma_f32_16x16x32_bf16 v[176:179], v[72:75], v[108:111], v[176:179]
v_fmac_f32 v137, v169, v254
v_fmac_f32 v138, v170, v254
v_mfma_f32_16x16x32_bf16 v[176:179], v[56:59], v[104:107], v[176:179]
v_fmac_f32 v139, v171, v254
v_cvt_pk_bf16_f32 v136, v136, v137
v_mfma_f32_16x16x32_bf16 v[180:183], v[60:63], v[104:107], v[180:183]
v_cvt_pk_bf16_f32 v137, v138, v139
v_fmac_f32 v140, v172, v254
v_mfma_f32_16x16x32_bf16 v[180:183], v[76:79], v[108:111], v[180:183]
v_fmac_f32 v141, v173, v254
v_fmac_f32 v142, v174, v254
v_mfma_f32_16x16x32_bf16 v[180:183], v[92:95], v[112:115], v[180:183]
s_mov_b64 vcc, s[14:15]
v_fmac_f32 v144, v176, v254
v_fmac_f32 v145, v177, v254
v_mfma_f32_16x16x32_bf16 v[200:203], a[0:3], v[192:195], 0
v_fmac_f32 v146, v178, v254
v_fmac_f32 v147, v179, v254
v_mfma_f32_16x16x32_bf16 v[200:203], a[4:7], v[204:207], v[200:203]
v_cvt_pk_bf16_f32 v144, v144, v145
v_fmac_f32 v143, v175, v254
v_mfma_f32_16x16x32_bf16 v[200:203], a[8:11], v[220:223], v[200:203]
v_fmac_f32 v148, v180, v254
v_fmac_f32 v149, v181, v254
v_mfma_f32_16x16x32_bf16 v[200:203], a[12:15], v[196:199], v[200:203]
v_fmac_f32 v150, v182, v254
v_fmac_f32 v151, v183, v254
v_mfma_f32_16x16x32_bf16 v[224:227], a[28:31], v[196:199], 0
v_cvt_pk_bf16_f32 v145, v146, v147
v_cvt_pk_bf16_f32 v138, v140, v141
v_mfma_f32_16x16x32_bf16 v[224:227], a[24:27], v[220:223], v[224:227]
v_cvt_pk_bf16_f32 v139, v142, v143
v_cvt_pk_bf16_f32 v146, v148, v149
v_mfma_f32_16x16x32_bf16 v[224:227], a[20:23], v[204:207], v[224:227]
v_cvt_pk_bf16_f32 v96, v200, v201
v_cvt_pk_bf16_f32 v97, v202, v203
v_mfma_f32_16x16x32_bf16 v[224:227], a[16:19], v[192:195], v[224:227]
v_cvt_pk_bf16_f32 v147, v150, v151
v_pk_max_i16 v136, v136, 0
v_mfma_f32_16x16x32_bf16 v[200:203], a[32:35], v[192:195], 0
v_pk_max_i16 v137, v137, 0
v_pk_max_i16 v138, v138, 0
v_mfma_f32_16x16x32_bf16 v[200:203], a[36:39], v[204:207], v[200:203]
v_pk_max_i16 v139, v139, 0
v_pk_max_i16 v144, v144, 0
v_mfma_f32_16x16x32_bf16 v[200:203], a[40:43], v[220:223], v[200:203]
v_pk_max_i16 v145, v145, 0
v_pk_max_i16 v146, v146, 0
v_mfma_f32_16x16x32_bf16 v[200:203], a[44:47], v[196:199], v[200:203]
v_pk_max_i16 v147, v147, 0
v_cndmask_b32_dpp v140, v144, v136, vcc quad_perm:[1,0,3,2] row_mask:0xf bank_mask:0xf
v_mfma_f32_16x16x32_bf16 v[208:211], a[60:63], v[196:199], 0
v_cndmask_b32_dpp v141, v145, v137, vcc quad_perm:[1,0,3,2] row_mask:0xf bank_mask:0xf
v_cndmask_b32_dpp v142, v146, v138, vcc quad_perm:[1,0,3,2] row_mask:0xf bank_mask:0xf
v_mfma_f32_16x16x32_bf16 v[208:211], a[56:59], v[220:223], v[208:211]
v_cndmask_b32_dpp v143, v147, v139, vcc quad_perm:[1,0,3,2] row_mask:0xf bank_mask:0xf
v_cvt_pk_bf16_f32 v98, v224, v225
v_mfma_f32_16x16x32_bf16 v[208:211], a[52:55], v[204:207], v[208:211]
s_not_b64 vcc, vcc
v_cndmask_b32_dpp v144, v136, v144, vcc quad_perm:[1,0,3,2] row_mask:0xf bank_mask:0xf
v_cndmask_b32_dpp v145, v137, v145, vcc quad_perm:[1,0,3,2] row_mask:0xf bank_mask:0xf
v_mfma_f32_16x16x32_bf16 v[208:211], a[48:51], v[192:195], v[208:211]
v_cndmask_b32_dpp v146, v138, v146, vcc quad_perm:[1,0,3,2] row_mask:0xf bank_mask:0xf
v_cndmask_b32_dpp v147, v139, v147, vcc quad_perm:[1,0,3,2] row_mask:0xf bank_mask:0xf
v_mfma_f32_32x32x16_bf16 v[168:183], v[236:239], v[132:135], 0
buffer_store_dwordx4 v[140:143], v244, s[20:23], s52 offen offset:0 nt
buffer_store_dwordx4 v[144:147], v244, s[20:23], s52 offen offset:256 nt
v_cvt_pk_bf16_f32 v100, v200, v201
v_cvt_pk_bf16_f32 v101, v202, v203
v_cvt_pk_bf16_f32 v99, v226, v227
v_cvt_pk_bf16_f32 v102, v208, v209
v_mfma_f32_16x16x32_bf16 v[136:139], a[192:195], v[192:195], 0
v_cvt_pk_bf16_f32 v103, v210, v211
v_mfma_f32_16x16x32_bf16 v[136:139], a[196:199], v[204:207], v[136:139]
v_exp_f32 v212, v212
v_mfma_f32_16x16x32_bf16 v[136:139], a[200:203], v[220:223], v[136:139]
v_exp_f32 v126, v213
v_mfma_f32_16x16x32_bf16 v[136:139], a[204:207], v[196:199], v[136:139]
v_exp_f32 v214, v214
v_mfma_f32_16x16x32_bf16 v[140:143], a[220:223], v[196:199], 0
v_exp_f32 v127, v215
v_mfma_f32_16x16x32_bf16 v[140:143], a[216:219], v[220:223], v[140:143]
v_exp_f32 v228, v228
v_mfma_f32_16x16x32_bf16 v[140:143], a[212:215], v[204:207], v[140:143]
v_exp_f32 v124, v229
v_mfma_f32_16x16x32_bf16 v[140:143], a[208:211], v[192:195], v[140:143]
v_exp_f32 v230, v230
v_mfma_f32_16x16x32_bf16 v[144:147], a[224:227], v[192:195], 0
v_exp_f32 v125, v231
v_mfma_f32_16x16x32_bf16 v[144:147], a[228:231], v[204:207], v[144:147]
v_mov_b32_sdwa v126, v212 dst_sel:WORD_0 dst_unused:UNUSED_PRESERVE src0_sel:WORD_1
v_mov_b32_sdwa v127, v214 dst_sel:WORD_0 dst_unused:UNUSED_PRESERVE src0_sel:WORD_1
v_mfma_f32_16x16x32_bf16 v[144:147], a[232:235], v[220:223], v[144:147]
v_mov_b32_sdwa v124, v228 dst_sel:WORD_0 dst_unused:UNUSED_PRESERVE src0_sel:WORD_1
v_mov_b32_sdwa v125, v230 dst_sel:WORD_0 dst_unused:UNUSED_PRESERVE src0_sel:WORD_1
v_mfma_f32_16x16x32_bf16 v[144:147], a[236:239], v[196:199], v[144:147]
v_mov_b64 v[200:201], 0
v_mov_b64 v[202:203], 0
v_mfma_f32_16x16x32_bf16 v[148:151], a[252:255], v[196:199], 0
v_exp_f32 v190, v190
v_mfma_f32_16x16x32_bf16 v[148:151], a[248:251], v[220:223], v[148:151]
v_exp_f32 v129, v191
v_mfma_f32_16x16x32_bf16 v[148:151], a[244:247], v[204:207], v[148:151]
v_exp_f32 v216, v216
v_mfma_f32_16x16x32_bf16 v[148:151], a[240:243], v[192:195], v[148:151]
v_exp_f32 v130, v217
v_smfmac_f32_16x16x64_bf16 v[200:203], v[238:241], v[96:103], v251
v_mov_b64 v[192:193], 0
v_mfma_f32_16x16x32_bf16 v[196:199], v[0:3], v[96:99], 0
v_exp_f32 v218, v218
v_mfma_f32_16x16x32_bf16 v[196:199], v[4:7], v[100:103], v[196:199]
v_exp_f32 v131, v219
v_mfma_f32_16x16x32_bf16 v[204:207], v[12:15], v[100:103], 0
v_mov_b32_sdwa v129, v190 dst_sel:WORD_0 dst_unused:UNUSED_PRESERVE src0_sel:WORD_1
v_mov_b32_sdwa v130, v216 dst_sel:WORD_0 dst_unused:UNUSED_PRESERVE src0_sel:WORD_1
v_mfma_f32_16x16x32_bf16 v[204:207], v[8:11], v[96:99], v[204:207]
v_mov_b32_sdwa v131, v218 dst_sel:WORD_0 dst_unused:UNUSED_PRESERVE src0_sel:WORD_1
v_add_f32 v200, v200, v201
v_smfmac_f32_16x16x64_bf16 v[192:195], v[184:187], v[120:127], v251
ds_read_b128 v[188:191], v242 offset:12672
v_add_f32 v202, v202, v203
v_smfmac_f32_16x16x64_bf16 v[192:195], v[184:187], v[128:135], v251 abid:1
ds_read_b128 v[208:211], v242 offset:12928
ds_read_b128 v[212:215], v242 offset:13184
v_mfma_f32_16x16x32_bf16 v[168:171], v[80:83], v[128:131], v[168:171]
ds_read_b128 v[216:219], v242 offset:13440
v_add_u32 v242, s56, v242
v_mfma_f32_16x16x32_bf16 v[168:171], v[64:67], v[124:127], v[168:171]
s_sub_u32 s56, 0, s56
v_exp_f32 v200, v200
v_mfma_f32_16x16x32_bf16 v[168:171], v[48:51], v[120:123], v[168:171]
v_exp_f32 v202, v202
v_mfma_f32_16x16x32_bf16 v[172:175], v[52:55], v[120:123], v[172:175]
v_perm_b32 v116, v202, v200, v252
v_perm_b32 v117, v202, v200, v253
v_mfma_f32_16x16x32_bf16 v[172:175], v[68:71], v[124:127], v[172:175]
v_add_f32 v192, v192, v193
v_mfma_f32_16x16x32_bf16 v[172:175], v[84:87], v[128:131], v[172:175]
v_rcp_f32 v254, v192
v_mfma_f32_16x16x32_bf16 v[176:179], v[88:91], v[128:131], v[176:179]
v_max3_f32 v255, v255, v192, v254
v_fmac_f32 v152, v168, v254
v_mfma_f32_16x16x32_bf16 v[176:179], v[72:75], v[124:127], v[176:179]
v_fmac_f32 v153, v169, v254
v_fmac_f32 v154, v170, v254
v_mfma_f32_16x16x32_bf16 v[176:179], v[56:59], v[120:123], v[176:179]
v_fmac_f32 v155, v171, v254
v_cvt_pk_bf16_f32 v152, v152, v153
v_mfma_f32_16x16x32_bf16 v[180:183], v[60:63], v[120:123], v[180:183]
v_fmac_f32 v156, v172, v254
v_fmac_f32 v157, v173, v254
v_mfma_f32_16x16x32_bf16 v[180:183], v[76:79], v[124:127], v[180:183]
v_fmac_f32 v158, v174, v254
v_fmac_f32 v159, v175, v254
v_mfma_f32_16x16x32_bf16 v[180:183], v[92:95], v[128:131], v[180:183]
s_waitcnt lgkmcnt(3)
v_fmac_f32 v160, v176, v254
v_fmac_f32 v161, v177, v254
v_mfma_f32_16x16x32_bf16 v[200:203], v[36:39], v[100:103], 0
s_waitcnt lgkmcnt(1)
v_fmac_f32 v162, v178, v254
v_fmac_f32 v163, v179, v254
v_mfma_f32_16x16x32_bf16 v[200:203], v[32:35], v[96:99], v[200:203]
s_waitcnt lgkmcnt(0)
v_cvt_pk_bf16_f32 v160, v160, v161
v_cvt_pk_bf16_f32 v153, v154, v155
v_mfma_f32_16x16x32_bf16 v[220:223], v[24:27], v[96:99], 0
s_mov_b64 vcc, s[14:15]
v_fmac_f32 v164, v180, v254
v_fmac_f32 v165, v181, v254
v_mfma_f32_16x16x32_bf16 v[220:223], v[28:31], v[100:103], v[220:223]
v_fmac_f32 v166, v182, v254
v_fmac_f32 v167, v183, v254
v_mfma_f32_16x16x32_bf16 v[224:227], v[20:23], v[100:103], 0
v_cvt_pk_bf16_f32 v161, v162, v163
v_cvt_pk_bf16_f32 v154, v156, v157
v_mfma_f32_16x16x32_bf16 v[224:227], v[16:19], v[96:99], v[224:227]
v_mov_b32 v232, s45
v_cvt_pk_bf16_f32 v155, v158, v159
v_mfma_f32_16x16x32_bf16 v[228:231], v[40:43], v[96:99], 0
s_waitcnt vmcnt(6)
ds_write_addtid_b32 v232 offset:65280
v_mfma_f32_16x16x32_bf16 v[228:231], v[44:47], v[100:103], v[228:231]
v_cvt_pk_bf16_f32 v162, v164, v165
v_cvt_pk_bf16_f32 v163, v166, v167
v_mfma_f32_16x16x32_bf16 v[192:195], a[0:3], v[188:191], 0
v_pk_max_i16 v152, v152, 0
v_pk_max_i16 v153, v153, 0
v_mfma_f32_16x16x32_bf16 v[192:195], a[4:7], v[208:211], v[192:195]
v_pk_max_i16 v154, v154, 0
v_pk_max_i16 v155, v155, 0
v_mfma_f32_16x16x32_bf16 v[192:195], a[8:11], v[212:215], v[192:195]
v_pk_max_i16 v160, v160, 0
v_pk_max_i16 v161, v161, 0
v_mfma_f32_16x16x32_bf16 v[192:195], a[12:15], v[216:219], v[192:195]
v_pk_max_i16 v162, v162, 0
v_pk_max_i16 v163, v163, 0
v_mfma_f32_16x16x32_bf16 v[232:235], a[28:31], v[216:219], 0
v_cndmask_b32_dpp v156, v160, v152, vcc quad_perm:[1,0,3,2] row_mask:0xf bank_mask:0xf
v_cndmask_b32_dpp v157, v161, v153, vcc quad_perm:[1,0,3,2] row_mask:0xf bank_mask:0xf
v_mfma_f32_16x16x32_bf16 v[232:235], a[24:27], v[212:215], v[232:235]
v_cndmask_b32_dpp v158, v162, v154, vcc quad_perm:[1,0,3,2] row_mask:0xf bank_mask:0xf
v_cndmask_b32_dpp v159, v163, v155, vcc quad_perm:[1,0,3,2] row_mask:0xf bank_mask:0xf
v_mfma_f32_16x16x32_bf16 v[232:235], a[20:23], v[208:211], v[232:235]
s_not_b64 vcc, vcc
v_cvt_pk_bf16_f32 v96, v192, v193
v_cvt_pk_bf16_f32 v97, v194, v195
v_mfma_f32_16x16x32_bf16 v[232:235], a[16:19], v[188:191], v[232:235]
v_cndmask_b32_dpp v160, v152, v160, vcc quad_perm:[1,0,3,2] row_mask:0xf bank_mask:0xf
v_cndmask_b32_dpp v161, v153, v161, vcc quad_perm:[1,0,3,2] row_mask:0xf bank_mask:0xf
v_mfma_f32_16x16x32_bf16 v[192:195], a[32:35], v[188:191], 0
v_cndmask_b32_dpp v162, v154, v162, vcc quad_perm:[1,0,3,2] row_mask:0xf bank_mask:0xf
v_cndmask_b32_dpp v163, v155, v163, vcc quad_perm:[1,0,3,2] row_mask:0xf bank_mask:0xf
v_mfma_f32_16x16x32_bf16 v[192:195], a[36:39], v[208:211], v[192:195]
v_exp_f32 v204, v204
v_mfma_f32_16x16x32_bf16 v[192:195], a[40:43], v[212:215], v[192:195]
v_cvt_pk_bf16_f32 v98, v232, v233
v_cvt_pk_bf16_f32 v99, v234, v235
v_mfma_f32_16x16x32_bf16 v[192:195], a[44:47], v[216:219], v[192:195]
v_exp_f32 v106, v205
v_mfma_f32_16x16x32_bf16 v[232:235], a[60:63], v[216:219], 0
v_exp_f32 v206, v206
v_mfma_f32_16x16x32_bf16 v[232:235], a[56:59], v[212:215], v[232:235]
v_exp_f32 v107, v207
v_mfma_f32_16x16x32_bf16 v[232:235], a[52:55], v[208:211], v[232:235]
v_exp_f32 v220, v220
v_mfma_f32_16x16x32_bf16 v[232:235], a[48:51], v[188:191], v[232:235]
v_cvt_pk_bf16_f32 v100, v192, v193
v_cvt_pk_bf16_f32 v101, v194, v195
v_mfma_f32_32x32x16_bf16 v[168:183], v[236:239], v[116:119], 0
s_cmp_lg_u32 s45, 0
buffer_store_dwordx4 v[156:159], v244, s[20:23], s53 offen offset:0 nt
buffer_store_dwordx4 v[160:163], v244, s[20:23], s53 offen offset:256 nt
s_cbranch_scc1 L_loopf
v_mfma_f32_16x16x32_bf16 v[152:155], a[192:195], v[188:191], 0
s_mov_b32 m0, s59
v_cvt_pk_bf16_f32 v102, v232, v233
v_cvt_pk_bf16_f32 v103, v234, v235
v_mfma_f32_16x16x32_bf16 v[152:155], a[196:199], v[208:211], v[152:155]
s_mul_i32 s54, s41, 13824
v_mov_b64 v[192:193], 0
v_mov_b64 v[194:195], 0
v_mfma_f32_16x16x32_bf16 v[152:155], a[200:203], v[212:215], v[152:155]
L_h5:
s_cbranch_execz L_ret
s_add_u32 s7, s54, 102400
v_exp_f32 v196, v196
v_mfma_f32_16x16x32_bf16 v[152:155], a[204:207], v[216:219], v[152:155]
s_mov_b32 s6, 1728
v_exp_f32 v104, v197
v_mfma_f32_16x16x32_bf16 v[156:159], a[220:223], v[216:219], 0
s_lshl_b32 s55, s41, 9
v_exp_f32 v198, v198
v_mfma_f32_16x16x32_bf16 v[156:159], a[216:219], v[212:215], v[156:159]
s_mov_b32 s11, 272
v_exp_f32 v105, v199
v_mfma_f32_16x16x32_bf16 v[156:159], a[212:215], v[208:211], v[156:159]
s_add_u32 s8, s54, 103536
v_mov_b32_sdwa v104, v196 dst_sel:WORD_0 dst_unused:UNUSED_PRESERVE src0_sel:WORD_1
v_mov_b32_sdwa v105, v198 dst_sel:WORD_0 dst_unused:UNUSED_PRESERVE src0_sel:WORD_1
v_mfma_f32_16x16x32_bf16 v[156:159], a[208:211], v[188:191], v[156:159]
s_add_u32 s9, s55, 160960
v_mov_b32_sdwa v106, v204 dst_sel:WORD_0 dst_unused:UNUSED_PRESERVE src0_sel:WORD_1
v_mov_b32_sdwa v107, v206 dst_sel:WORD_0 dst_unused:UNUSED_PRESERVE src0_sel:WORD_1
v_mfma_f32_16x16x32_bf16 v[160:163], a[224:227], v[188:191], 0
s_add_u32 s52, s47, 8192
v_exp_f32 v200, v200
v_mfma_f32_16x16x32_bf16 v[160:163], a[228:231], v[208:211], v[160:163]
s_mov_b32 s57, 13106176
v_exp_f32 v112, v201
v_mfma_f32_16x16x32_bf16 v[160:163], a[232:235], v[212:215], v[160:163]
s_add_u32 s98, s44, 24576
v_exp_f32 v202, v202
v_mfma_f32_16x16x32_bf16 v[160:163], a[236:239], v[216:219], v[160:163]
s_add_u32 s99, s44, 52453376
v_exp_f32 v113, v203
v_mfma_f32_16x16x32_bf16 v[164:167], a[252:255], v[216:219], 0
s_add_u32 s53, s47, 12288
v_mov_b32_sdwa v112, v200 dst_sel:WORD_0 dst_unused:UNUSED_PRESERVE src0_sel:WORD_1
v_mov_b32_sdwa v113, v202 dst_sel:WORD_0 dst_unused:UNUSED_PRESERVE src0_sel:WORD_1
v_mfma_f32_16x16x32_bf16 v[164:167], a[248:251], v[212:215], v[164:167]
v_mbcnt_lo_u32_b32 v245, -1, 0
v_mbcnt_hi_u32_b32 v245, -1, v245
v_mfma_f32_16x16x32_bf16 v[164:167], a[244:247], v[208:211], v[164:167]
v_mov_b32 v243, s7
v_bfe_u32 v246, v245, 2, 2
v_mfma_f32_16x16x32_bf16 v[164:167], a[240:243], v[188:191], v[164:167]
ds_read_addtid_b32 v188 offset:65280
v_and_b32 v200, 3, v245
v_smfmac_f32_16x16x64_bf16 v[192:195], v[238:241], v[96:103], v251
v_and_b32 v202, 15, v245
v_mfma_f32_16x16x32_bf16 v[196:199], v[0:3], v[96:99], 0
v_mad_u32_u24 v243, v246, s6, v243
v_lshrrev_b32 v201, 4, v245
v_mfma_f32_16x16x32_bf16 v[196:199], v[4:7], v[100:103], v[196:199]
v_mad_u32_u24 v243, v200, s11, v243
v_lshl_add_u32 v249, v202, 3, s8
v_mfma_f32_16x16x32_bf16 v[204:207], v[12:15], v[100:103], 0
v_lshl_add_u32 v250, v202, 4, s9
v_lshl_add_u32 v247, v201, 4, v243
v_mfma_f32_16x16x32_bf16 v[204:207], v[8:11], v[96:99], v[204:207]
v_mad_u32_u24 v249, v201, s6, v249
v_add_f32 v192, v192, v193
v_mfma_f32_16x16x32_bf16 v[208:211], v[16:19], v[96:99], 0
s_waitcnt lgkmcnt(0)
v_exp_f32 v224, v224
v_mfma_f32_16x16x32_bf16 v[208:211], v[20:23], v[100:103], v[208:211]
v_exp_f32 v108, v225
v_mfma_f32_16x16x32_bf16 v[212:215], v[28:31], v[100:103], 0
v_exp_f32 v226, v226
v_mfma_f32_16x16x32_bf16 v[212:215], v[24:27], v[96:99], v[212:215]
v_exp_f32 v109, v227
v_mfma_f32_16x16x32_bf16 v[200:203], v[32:35], v[96:99], 0
ds_read_b64 v[32:33], v249 offset:0
v_mov_b32_sdwa v108, v224 dst_sel:WORD_0 dst_unused:UNUSED_PRESERVE src0_sel:WORD_1
v_mfma_f32_16x16x32_bf16 v[200:203], v[36:39], v[100:103], v[200:203]
ds_read_b64 v[34:35], v249 offset:6912
v_mov_b32_sdwa v109, v226 dst_sel:WORD_0 dst_unused:UNUSED_PRESERVE src0_sel:WORD_1
v_mfma_f32_16x16x32_bf16 v[224:227], v[44:47], v[100:103], 0
ds_read_b64 v[36:37], v249 offset:128
v_cmp_lt_u32 vcc, s45, v188
v_mfma_f32_16x16x32_bf16 v[224:227], v[40:43], v[96:99], v[224:227]
ds_read_b64 v[96:97], v250 offset:0
v_exp_f32 v110, v221
v_exp_f32 v222, v222
v_exp_f32 v111, v223
s_cbranch_vccnz L_spine
L_backe:
v_mov_b32_sdwa v110, v220 dst_sel:WORD_0 dst_unused:UNUSED_PRESERVE src0_sel:WORD_1
v_mov_b32_sdwa v111, v222 dst_sel:WORD_0 dst_unused:UNUSED_PRESERVE src0_sel:WORD_1
v_mov_b64 v[188:189], 0
v_exp_f32 v228, v228
v_add_f32 v194, v194, v195
v_smfmac_f32_16x16x64_bf16 v[188:191], v[184:187], v[104:111], v251
ds_read_b128 v[216:219], v242 offset:0
v_exp_f32 v114, v229
v_exp_f32 v230, v230
v_exp_f32 v115, v231
v_mov_b32_sdwa v114, v228 dst_sel:WORD_0 dst_unused:UNUSED_PRESERVE src0_sel:WORD_1
v_mov_b32_sdwa v115, v230 dst_sel:WORD_0 dst_unused:UNUSED_PRESERVE src0_sel:WORD_1
v_exp_f32 v192, v192
v_mad_u32_u24 v248, v246, s57, v244
v_smfmac_f32_16x16x64_bf16 v[188:191], v[184:187], v[112:119], v251 abid:1
s_waitcnt lgkmcnt(1)
ds_read_b128 v[220:223], v242 offset:256
ds_read_b128 v[228:231], v242 offset:512
v_mfma_f32_16x16x32_bf16 v[168:171], v[80:83], v[112:115], v[168:171]
ds_read_b128 v[232:235], v242 offset:768
ds_read_b64 v[40:41], v249 offset:256
v_mfma_f32_16x16x32_bf16 v[168:171], v[64:67], v[108:111], v[168:171]
ds_read_b64 v[42:43], v249 offset:7168
v_add_f32 v188, v188, v189
v_mfma_f32_16x16x32_bf16 v[168:171], v[48:51], v[104:107], v[168:171]
ds_read_b64 v[38:39], v249 offset:7040
ds_read_b64 v[44:45], v249 offset:384
v_mfma_f32_16x16x32_bf16 v[172:175], v[52:55], v[104:107], v[172:175]
ds_read_b64 v[46:47], v249 offset:7296
ds_read_b32 v102, v250 offset:8
v_mfma_f32_16x16x32_bf16 v[172:175], v[68:71], v[108:111], v[172:175]
ds_read_b64 v[100:101], v250 offset:256
ds_read_b32 v103, v250 offset:264
v_mfma_f32_16x16x32_bf16 v[172:175], v[84:87], v[112:115], v[172:175]
v_exp_f32 v196, v196
v_mfma_f32_16x16x32_bf16 v[176:179], v[88:91], v[112:115], v[176:179]
v_exp_f32 v120, v197
v_mfma_f32_16x16x32_bf16 v[176:179], v[72:75], v[108:111], v[176:179]
v_exp_f32 v198, v198
v_mfma_f32_16x16x32_bf16 v[176:179], v[56:59], v[104:107], v[176:179]
v_exp_f32 v121, v199
v_mfma_f32_16x16x32_bf16 v[180:183], v[60:63], v[104:107], v[180:183]
s_waitcnt lgkmcnt(2)
v_mov_b32_sdwa v120, v196 dst_sel:WORD_0 dst_unused:UNUSED_PRESERVE src0_sel:WORD_1
v_mov_b32_sdwa v121, v198 dst_sel:WORD_0 dst_unused:UNUSED_PRESERVE src0_sel:WORD_1
v_mfma_f32_16x16x32_bf16 v[180:183], v[76:79], v[108:111], v[180:183]
s_waitcnt lgkmcnt(0)
v_exp_f32 v194, v194
v_mfma_f32_16x16x32_bf16 v[180:183], v[92:95], v[112:115], v[180:183]
s_mov_b64 vcc, s[14:15]
v_perm_b32 v132, v194, v192, v252
v_perm_b32 v133, v194, v192, v253
v_mfma_f32_16x16x32_bf16 v[0:3], a[192:195], v[216:219], 0
v_rcp_f32 v254, v188
v_mfma_f32_16x16x32_bf16 v[0:3], a[196:199], v[220:223], v[0:3]
v_max3_f32 v255, v255, v188, v254
v_fmac_f32 v136, v168, v254
v_mfma_f32_16x16x32_bf16 v[0:3], a[200:203], v[228:231], v[0:3]
v_fmac_f32 v137, v169, v254
v_fmac_f32 v144, v176, v254
v_mfma_f32_16x16x32_bf16 v[0:3], a[204:207], v[232:235], v[0:3]
v_fmac_f32 v145, v177, v254
v_fmac_f32 v138, v170, v254
v_mfma_f32_16x16x32_bf16 v[4:7], a[220:223], v[232:235], 0
ds_read_b128 v[196:199], v242 offset:4736
ds_read_b128 v[192:195], v242 offset:4480
v_mfma_f32_16x16x32_bf16 v[4:7], a[216:219], v[228:231], v[4:7]
ds_read_b128 v[188:191], v242 offset:4224
v_fmac_f32 v139, v171, v254
v_mfma_f32_16x16x32_bf16 v[4:7], a[212:215], v[220:223], v[4:7]
v_cvt_pk_bf16_f32 v136, v136, v137
v_fmac_f32 v146, v178, v254
v_mfma_f32_16x16x32_bf16 v[4:7], a[208:211], v[216:219], v[4:7]
v_fmac_f32 v147, v179, v254
v_cvt_pk_bf16_f32 v144, v144, v145
v_mfma_f32_16x16x32_bf16 v[8:11], a[224:227], v[216:219], 0
v_fmac_f32 v140, v172, v254
v_fmac_f32 v141, v173, v254
v_mfma_f32_16x16x32_bf16 v[8:11], a[228:231], v[220:223], v[8:11]
ds_read_b128 v[104:107], v247 offset:0
v_fmac_f32 v142, v174, v254
v_mfma_f32_16x16x32_bf16 v[8:11], a[232:235], v[228:231], v[8:11]
ds_read_b128 v[108:111], v247 offset:64
v_fmac_f32 v143, v175, v254
v_mfma_f32_16x16x32_bf16 v[8:11], a[236:239], v[232:235], v[8:11]
ds_read_b128 v[112:115], v247 offset:128
v_cvt_pk_bf16_f32 v137, v138, v139
v_mfma_f32_16x16x32_bf16 v[12:15], a[252:255], v[232:235], 0
ds_read_b128 v[232:235], v242 offset:4992
v_fmac_f32 v148, v180, v254
v_mfma_f32_16x16x32_bf16 v[12:15], a[244:247], v[220:223], v[12:15]
ds_read_b128 v[116:119], v247 offset:192
v_fmac_f32 v149, v181, v254
v_mfma_f32_16x16x32_bf16 v[12:15], a[240:243], v[216:219], v[12:15]
s_waitcnt lgkmcnt(7)
ds_read_b128 v[220:223], v243 offset:256
v_fmac_f32 v150, v182, v254
v_mfma_f32_16x16x32_bf16 v[12:15], a[248:251], v[228:231], v[12:15]
v_fmac_f32 v151, v183, v254
v_cvt_pk_bf16_f32 v145, v146, v147
v_mfma_f32_16x16x32_bf16 v[28:31], a[248:251], v[196:199], 0
s_waitcnt lgkmcnt(7)
v_cvt_pk_bf16_f32 v138, v140, v141
v_cvt_pk_bf16_f32 v139, v142, v143
v_cvt_pk_bf16_f32 v146, v148, v149
v_cvt_pk_bf16_f32 v147, v150, v151
v_pk_max_i16 v136, v136, 0
s_waitcnt lgkmcnt(2)
v_mfma_f32_16x16x32_bf16 v[28:31], a[252:255], v[232:235], v[28:31]
v_pk_max_i16 v137, v137, 0
v_pk_max_i16 v138, v138, 0
v_mfma_f32_16x16x32_bf16 v[28:31], a[244:247], v[192:195], v[28:31]
v_pk_max_i16 v139, v139, 0
v_pk_max_i16 v144, v144, 0
v_mfma_f32_16x16x32_bf16 v[28:31], a[240:243], v[188:191], v[28:31]
s_waitcnt lgkmcnt(0)
v_pk_max_i16 v145, v145, 0
v_pk_max_i16 v146, v146, 0
v_pk_max_i16 v147, v147, 0
v_cndmask_b32_dpp v140, v144, v136, vcc quad_perm:[1,0,3,2] row_mask:0xf bank_mask:0xf
v_cndmask_b32_dpp v141, v145, v137, vcc quad_perm:[1,0,3,2] row_mask:0xf bank_mask:0xf
v_cndmask_b32_dpp v142, v146, v138, vcc quad_perm:[1,0,3,2] row_mask:0xf bank_mask:0xf
v_cndmask_b32_dpp v143, v147, v139, vcc quad_perm:[1,0,3,2] row_mask:0xf bank_mask:0xf
s_not_b64 vcc, vcc
v_cndmask_b32_dpp v144, v136, v144, vcc quad_perm:[1,0,3,2] row_mask:0xf bank_mask:0xf
v_cndmask_b32_dpp v145, v137, v145, vcc quad_perm:[1,0,3,2] row_mask:0xf bank_mask:0xf
v_cndmask_b32_dpp v146, v138, v146, vcc quad_perm:[1,0,3,2] row_mask:0xf bank_mask:0xf
v_cndmask_b32_dpp v147, v139, v147, vcc quad_perm:[1,0,3,2] row_mask:0xf bank_mask:0xf
s_mov_b32 vcc_lo, 0xf0000f
s_mov_b32 vcc_hi, 0xf0000f00
v_mov_b64 v[98:99], 0
v_cndmask_b32 v96, 0, v96, vcc
v_cndmask_b32 v97, 0, v97, vcc
v_exp_f32 v204, v204
v_add_f32 v220, v220, v221
v_mfma_f32_16x16x32_bf16 v[104:107], v[32:35], v[96:99], v[104:107]
v_exp_f32 v122, v205
v_mfma_f32_16x16x32_bf16 v[108:111], v[36:39], v[96:99], v[108:111]
v_exp_f32 v206, v206
v_mfma_f32_16x16x32_bf16 v[112:115], v[40:43], v[96:99], v[112:115]
v_exp_f32 v123, v207
v_mfma_f32_16x16x32_bf16 v[116:119], v[44:47], v[96:99], v[116:119]
v_mov_b32_sdwa v122, v204 dst_sel:WORD_0 dst_unused:UNUSED_PRESERVE src0_sel:WORD_1
v_mov_b32_sdwa v123, v206 dst_sel:WORD_0 dst_unused:UNUSED_PRESERVE src0_sel:WORD_1
v_mfma_f32_16x16x32_bf16 v[24:27], a[224:227], v[188:191], 0
v_exp_f32 v208, v208
v_mfma_f32_16x16x32_bf16 v[24:27], a[228:231], v[192:195], v[24:27]
v_exp_f32 v124, v209
v_mfma_f32_16x16x32_bf16 v[24:27], a[232:235], v[196:199], v[24:27]
v_exp_f32 v210, v210
v_mfma_f32_16x16x32_bf16 v[24:27], a[236:239], v[232:235], v[24:27]
v_exp_f32 v125, v211
v_mfma_f32_32x32x16_bf16 v[168:183], v[236:239], v[132:135], 0
buffer_store_dwordx4 v[140:143], v244, s[20:23], s52 offen offset:0 nt
buffer_store_dwordx4 v[144:147], v244, s[20:23], s52 offen offset:256 nt
v_exp_f32 v212, v212
v_exp_f32 v126, v213
v_mfma_f32_16x16x32_bf16 v[20:23], a[220:223], v[232:235], 0
v_exp_f32 v214, v214
v_mfma_f32_16x16x32_bf16 v[20:23], a[216:219], v[196:199], v[20:23]
v_exp_f32 v127, v215
v_mfma_f32_16x16x32_bf16 v[20:23], a[212:215], v[192:195], v[20:23]
v_mov_b32_sdwa v124, v208 dst_sel:WORD_0 dst_unused:UNUSED_PRESERVE src0_sel:WORD_1
v_mov_b32_sdwa v125, v210 dst_sel:WORD_0 dst_unused:UNUSED_PRESERVE src0_sel:WORD_1
v_mfma_f32_16x16x32_bf16 v[20:23], a[208:211], v[188:191], v[20:23]
v_mov_b32_sdwa v126, v212 dst_sel:WORD_0 dst_unused:UNUSED_PRESERVE src0_sel:WORD_1
v_mov_b32_sdwa v127, v214 dst_sel:WORD_0 dst_unused:UNUSED_PRESERVE src0_sel:WORD_1
v_mfma_f32_16x16x32_bf16 v[16:19], a[192:195], v[188:191], 0
v_mov_b64 v[188:189], 0
v_cndmask_b32 v100, 0, v100, vcc
v_mfma_f32_16x16x32_bf16 v[16:19], a[196:199], v[192:195], v[16:19]
ds_read_b128 v[192:195], v247 offset:6912
v_cndmask_b32 v101, 0, v101, vcc
v_mfma_f32_16x16x32_bf16 v[16:19], a[200:203], v[196:199], v[16:19]
ds_read_b128 v[196:199], v247 offset:6976
ds_read_b128 v[204:207], v247 offset:7040
v_mfma_f32_16x16x32_bf16 v[16:19], a[204:207], v[232:235], v[16:19]
ds_read_b128 v[208:211], v247 offset:7104
v_add_f32 v222, v222, v223
v_smfmac_f32_16x16x64_bf16 v[188:191], v[184:187], v[120:127], v251
ds_read_b128 v[212:215], v243 offset:7168
v_exp_f32 v200, v200
v_exp_f32 v128, v201
v_exp_f32 v202, v202
v_exp_f32 v129, v203
v_exp_f32 v224, v224
v_exp_f32 v130, v225
v_exp_f32 v226, v226
v_exp_f32 v131, v227
v_mov_b32_sdwa v128, v200 dst_sel:WORD_0 dst_unused:UNUSED_PRESERVE src0_sel:WORD_1
v_mov_b32_sdwa v129, v202 dst_sel:WORD_0 dst_unused:UNUSED_PRESERVE src0_sel:WORD_1
v_mov_b32_sdwa v130, v224 dst_sel:WORD_0 dst_unused:UNUSED_PRESERVE src0_sel:WORD_1
v_mov_b32_sdwa v131, v226 dst_sel:WORD_0 dst_unused:UNUSED_PRESERVE src0_sel:WORD_1
v_add_f32 v220, v220, v102
v_add_f32 v220, v220, v222
v_smfmac_f32_16x16x64_bf16 v[188:191], v[184:187], v[128:135], v251 abid:1
s_waitcnt lgkmcnt(0)
v_add_f32 v212, v212, v213
v_mfma_f32_16x16x32_bf16 v[168:171], v[80:83], v[128:131], v[168:171]
v_rcp_f32 v252, v220
v_mfma_f32_16x16x32_bf16 v[168:171], v[64:67], v[124:127], v[168:171]
v_fmac_f32 v0, v104, v252
v_fmac_f32 v1, v105, v252
v_mfma_f32_16x16x32_bf16 v[168:171], v[48:51], v[120:123], v[168:171]
v_fmac_f32 v8, v112, v252
v_fmac_f32 v9, v113, v252
v_mfma_f32_16x16x32_bf16 v[172:175], v[52:55], v[120:123], v[172:175]
v_fmac_f32 v2, v106, v252
v_fmac_f32 v3, v107, v252
v_mfma_f32_16x16x32_bf16 v[172:175], v[68:71], v[124:127], v[172:175]
v_cvt_pk_bf16_f32 v0, v0, v1
v_fmac_f32 v10, v114, v252
v_mfma_f32_16x16x32_bf16 v[172:175], v[84:87], v[128:131], v[172:175]
v_fmac_f32 v11, v115, v252
v_cvt_pk_bf16_f32 v8, v8, v9
v_mfma_f32_16x16x32_bf16 v[192:195], v[32:35], v[98:101], v[192:195]
v_fmac_f32 v4, v108, v252
v_fmac_f32 v5, v109, v252
v_mfma_f32_16x16x32_bf16 v[196:199], v[36:39], v[98:101], v[196:199]
v_fmac_f32 v6, v110, v252
v_fmac_f32 v7, v111, v252
v_mfma_f32_16x16x32_bf16 v[204:207], v[40:43], v[98:101], v[204:207]
v_cvt_pk_bf16_f32 v1, v2, v3
v_fmac_f32 v12, v116, v252
v_mfma_f32_16x16x32_bf16 v[208:211], v[44:47], v[98:101], v[208:211]
v_fmac_f32 v13, v117, v252
v_fmac_f32 v14, v118, v252
v_mfma_f32_16x16x32_bf16 v[176:179], v[72:75], v[124:127], v[176:179]
v_fmac_f32 v15, v119, v252
v_cvt_pk_bf16_f32 v9, v10, v11
v_mfma_f32_16x16x32_bf16 v[176:179], v[88:91], v[128:131], v[176:179]
v_cvt_pk_bf16_f32 v2, v4, v5
v_cvt_pk_bf16_f32 v3, v6, v7
v_mfma_f32_16x16x32_bf16 v[176:179], v[56:59], v[120:123], v[176:179]
v_cvt_pk_bf16_f32 v10, v12, v13
v_cvt_pk_bf16_f32 v11, v14, v15
v_mfma_f32_16x16x32_bf16 v[180:183], v[60:63], v[120:123], v[180:183]
v_pk_max_i16 v0, v0, 0
v_pk_max_i16 v1, v1, 0
v_mfma_f32_16x16x32_bf16 v[180:183], v[76:79], v[124:127], v[180:183]
v_pk_max_i16 v2, v2, 0
v_pk_max_i16 v3, v3, 0
v_mfma_f32_16x16x32_bf16 v[180:183], v[92:95], v[128:131], v[180:183]
s_mov_b64 vcc, s[14:15]
v_pk_max_i16 v8, v8, 0
v_pk_max_i16 v9, v9, 0
v_pk_max_i16 v10, v10, 0
v_pk_max_i16 v11, v11, 0
v_cndmask_b32_dpp v4, v8, v0, vcc quad_perm:[1,0,3,2] row_mask:0xf bank_mask:0xf
v_cndmask_b32_dpp v5, v9, v1, vcc quad_perm:[1,0,3,2] row_mask:0xf bank_mask:0xf
v_cndmask_b32_dpp v6, v10, v2, vcc quad_perm:[1,0,3,2] row_mask:0xf bank_mask:0xf
v_cndmask_b32_dpp v7, v11, v3, vcc quad_perm:[1,0,3,2] row_mask:0xf bank_mask:0xf
s_not_b64 vcc, vcc
v_cndmask_b32_dpp v8, v0, v8, vcc quad_perm:[1,0,3,2] row_mask:0xf bank_mask:0xf
v_cndmask_b32_dpp v9, v1, v9, vcc quad_perm:[1,0,3,2] row_mask:0xf bank_mask:0xf
v_cndmask_b32_dpp v10, v2, v10, vcc quad_perm:[1,0,3,2] row_mask:0xf bank_mask:0xf
v_cndmask_b32_dpp v11, v3, v11, vcc quad_perm:[1,0,3,2] row_mask:0xf bank_mask:0xf
buffer_store_dwordx4 v[4:7], v248, s[20:23], s98 offen offset:0 nt
buffer_store_dwordx4 v[8:11], v248, s[20:23], s98 offen offset:256 nt
v_add_f32 v214, v214, v215
v_add_f32 v212, v212, v103
v_add_f32 v212, v212, v214
v_rcp_f32 v240, v212
s_mov_b64 vcc, s[14:15]
v_pk_fma_f32 v[16:17], v[192:193], v[240:241], v[16:17] op_sel_hi:[1,0,1]
v_pk_fma_f32 v[24:25], v[204:205], v[240:241], v[24:25] op_sel_hi:[1,0,1]
v_pk_fma_f32 v[18:19], v[194:195], v[240:241], v[18:19] op_sel_hi:[1,0,1]
v_cvt_pk_bf16_f32 v16, v16, v17
v_pk_fma_f32 v[26:27], v[206:207], v[240:241], v[26:27] op_sel_hi:[1,0,1]
v_cvt_pk_bf16_f32 v24, v24, v25
v_pk_fma_f32 v[20:21], v[196:197], v[240:241], v[20:21] op_sel_hi:[1,0,1]
v_pk_fma_f32 v[22:23], v[198:199], v[240:241], v[22:23] op_sel_hi:[1,0,1]
v_cvt_pk_bf16_f32 v17, v18, v19
v_pk_fma_f32 v[28:29], v[208:209], v[240:241], v[28:29] op_sel_hi:[1,0,1]
v_pk_fma_f32 v[30:31], v[210:211], v[240:241], v[30:31] op_sel_hi:[1,0,1]
v_cvt_pk_bf16_f32 v25, v26, v27
v_cvt_pk_bf16_f32 v18, v20, v21
v_cvt_pk_bf16_f32 v19, v22, v23
v_cvt_pk_bf16_f32 v26, v28, v29
v_cvt_pk_bf16_f32 v27, v30, v31
v_pk_max_i16 v16, v16, 0
v_pk_max_i16 v17, v17, 0
v_pk_max_i16 v18, v18, 0
v_pk_max_i16 v19, v19, 0
v_pk_max_i16 v24, v24, 0
v_pk_max_i16 v25, v25, 0
v_pk_max_i16 v26, v26, 0
v_pk_max_i16 v27, v27, 0
v_cndmask_b32_dpp v20, v24, v16, vcc quad_perm:[1,0,3,2] row_mask:0xf bank_mask:0xf
v_cndmask_b32_dpp v21, v25, v17, vcc quad_perm:[1,0,3,2] row_mask:0xf bank_mask:0xf
v_cndmask_b32_dpp v22, v26, v18, vcc quad_perm:[1,0,3,2] row_mask:0xf bank_mask:0xf
v_cndmask_b32_dpp v23, v27, v19, vcc quad_perm:[1,0,3,2] row_mask:0xf bank_mask:0xf
s_not_b64 vcc, vcc
v_cndmask_b32_dpp v24, v16, v24, vcc quad_perm:[1,0,3,2] row_mask:0xf bank_mask:0xf
v_cndmask_b32_dpp v25, v17, v25, vcc quad_perm:[1,0,3,2] row_mask:0xf bank_mask:0xf
v_cndmask_b32_dpp v26, v18, v26, vcc quad_perm:[1,0,3,2] row_mask:0xf bank_mask:0xf
v_cndmask_b32_dpp v27, v19, v27, vcc quad_perm:[1,0,3,2] row_mask:0xf bank_mask:0xf
buffer_store_dwordx4 v[20:23], v248, s[20:23], s99 offen offset:0 nt
buffer_store_dwordx4 v[24:27], v248, s[20:23], s99 offen offset:256 nt
v_add_f32 v188, v188, v189
v_rcp_f32 v254, v188
s_mov_b64 vcc, s[14:15]
v_pk_fma_f32 v[152:153], v[168:169], v[254:255], v[152:153] op_sel_hi:[1,0,1]
v_pk_fma_f32 v[160:161], v[176:177], v[254:255], v[160:161] op_sel_hi:[1,0,1]
v_pk_fma_f32 v[154:155], v[170:171], v[254:255], v[154:155] op_sel_hi:[1,0,1]
v_cvt_pk_bf16_f32 v152, v152, v153
v_pk_fma_f32 v[162:163], v[178:179], v[254:255], v[162:163] op_sel_hi:[1,0,1]
v_cvt_pk_bf16_f32 v160, v160, v161
v_pk_fma_f32 v[156:157], v[172:173], v[254:255], v[156:157] op_sel_hi:[1,0,1]
v_pk_fma_f32 v[158:159], v[174:175], v[254:255], v[158:159] op_sel_hi:[1,0,1]
v_cvt_pk_bf16_f32 v153, v154, v155
v_pk_fma_f32 v[164:165], v[180:181], v[254:255], v[164:165] op_sel_hi:[1,0,1]
v_pk_fma_f32 v[166:167], v[182:183], v[254:255], v[166:167] op_sel_hi:[1,0,1]
v_cvt_pk_bf16_f32 v161, v162, v163
v_cvt_pk_bf16_f32 v154, v156, v157
v_cvt_pk_bf16_f32 v155, v158, v159
v_cvt_pk_bf16_f32 v162, v164, v165
v_cvt_pk_bf16_f32 v163, v166, v167
v_pk_max_i16 v152, v152, 0
v_pk_max_i16 v153, v153, 0
v_pk_max_i16 v154, v154, 0
v_pk_max_i16 v155, v155, 0
v_pk_max_i16 v160, v160, 0
v_pk_max_i16 v161, v161, 0
v_pk_max_i16 v162, v162, 0
v_pk_max_i16 v163, v163, 0
v_cndmask_b32_dpp v156, v160, v152, vcc quad_perm:[1,0,3,2] row_mask:0xf bank_mask:0xf
v_cndmask_b32_dpp v157, v161, v153, vcc quad_perm:[1,0,3,2] row_mask:0xf bank_mask:0xf
v_cndmask_b32_dpp v158, v162, v154, vcc quad_perm:[1,0,3,2] row_mask:0xf bank_mask:0xf
v_cndmask_b32_dpp v159, v163, v155, vcc quad_perm:[1,0,3,2] row_mask:0xf bank_mask:0xf
s_not_b64 vcc, vcc
v_cndmask_b32_dpp v160, v152, v160, vcc quad_perm:[1,0,3,2] row_mask:0xf bank_mask:0xf
v_cndmask_b32_dpp v161, v153, v161, vcc quad_perm:[1,0,3,2] row_mask:0xf bank_mask:0xf
v_cndmask_b32_dpp v162, v154, v162, vcc quad_perm:[1,0,3,2] row_mask:0xf bank_mask:0xf
v_cndmask_b32_dpp v163, v155, v163, vcc quad_perm:[1,0,3,2] row_mask:0xf bank_mask:0xf
buffer_store_dwordx4 v[156:159], v244, s[20:23], s53 offen offset:0 nt
buffer_store_dwordx4 v[160:163], v244, s[20:23], s53 offen offset:256 nt
v_max3_f32 v255, v255, v220, v252
v_max3_f32 v255, v255, v188, v254
v_max3_f32 v255, v255, v212, v240
v_mov_b32 v1, 0x53800000
v_cmp_nle_f32 vcc, v255, v1
s_lshl_b32 s52, s41, 2
s_add_u32 s52, s52, 163008
s_or_b32 s3, vcc_lo, vcc_hi
v_mov_b32 v2, s52
v_mov_b32 v3, s3
ds_write_b32 v2, v3
v_mov_b32 v2, 163008
s_waitcnt lgkmcnt(0)
s_barrier
ds_read_b128 v[4:7], v2
s_waitcnt lgkmcnt(0)
v_or_b32 v4, v4, v5
v_or3_b32 v4, v4, v6, v7
s_nop 0
v_readfirstlane_b32 s3, v4
s_nop 3
s_cmp_eq_u32 s3, 0
s_cbranch_scc0 L_fast_end
s_endpgm
L_fast_end:
s_waitcnt vmcnt(0)
s_barrier
s_mov_b32 s45, 8
s_mov_b32 s3, 64
s_mov_b32 s46, s44
s_mov_b32 s47, 0x7ff00000
s_mov_b32 s56, 50688
v_mbcnt_lo_u32_b32 v48, -1, 0
v_mbcnt_hi_u32_b32 v48, -1, v48
v_lshlrev_b32 v53, 4, v48
s_lshl_b32 s54, s41, 13
s_add_u32 s57, s54, 4096
v_and_b32 v49, 16, v48
v_lshlrev_b32 v52, 2, v49
v_lshlrev_b32 v49, 1, v49
v_xor_b32 v50, v53, v49
s_mul_i32 s49, s42, 25344
s_mul_i32 s53, s43, 1056
s_add_u32 s49, s49, s53
s_add_u32 m0, s49, 0
s_lshl_b32 s55, s43, 10
s_add_u32 s55, s55, s44
s_add_u32 s48, s55, 0
v_mov_b32 v237, 0
v_bfe_u32 v49, v48, 0, 2
v_lshl_add_u32 v237, v49, 4, v237
v_bfe_u32 v49, v48, 4, 2
v_lshl_add_u32 v237, v49, 6, v237
v_bfe_u32 v49, v48, 2, 2
v_lshl_add_u32 v237, v49, 8, v237
v_xor_b32 v51, 64, v50
s_lshl_b32 s53, s43, 14
v_mov_b32 v248, s53
v_add_u32 v248, 50688, v248
v_bfe_u32 v49, v48, 4, 2
v_lshl_add_u32 v248, v49, 10, v248
v_bfe_u32 v49, v48, 2, 2
v_lshl_add_u32 v248, v49, 7, v248
v_bfe_u32 v49, v48, 3, 1
v_lshl_add_u32 v248, v49, 5, v248
v_bfe_u32 v49, v48, 4, 1
v_lshl_add_u32 v248, v49, 6, v248
v_bfe_u32 v49, v48, 0, 2
v_lshl_add_u32 v248, v49, 3, v248
v_mov_b32 v252, s53
v_add_u32 v252, 116224, v252
v_bfe_u32 v49, v48, 4, 2
v_lshl_add_u32 v252, v49, 10, v252
v_bfe_u32 v49, v48, 2, 2
v_lshl_add_u32 v252, v49, 7, v252
v_bfe_u32 v49, v48, 3, 1
v_lshl_add_u32 v252, v49, 6, v252
v_bfe_u32 v49, v48, 0, 2
v_lshl_add_u32 v252, v49, 4, v252
s_mul_i32 s53, s42, 25344
v_bfe_u32 v49, v48, 2, 2
v_mov_b32 v236, s53
v_mul_u32_u24 v49, 1056, v49
v_add_u32 v236, v49, v236
v_bfe_u32 v49, v48, 0, 2
s_add_u32 s53, s54, 83456
v_lshl_add_u32 v236, v49, 6, v236
v_add_u32 v104, s53, v50
v_add_u32 v105, s53, v51
v_bfe_u32 v49, v48, 4, 2
s_lshl_b32 s53, s41, 12
v_lshl_add_u32 v236, v49, 4, v236
v_mov_b32 v54, s53
v_add_u32 v54, 50688, v54
v_bfe_u32 v49, v48, 3, 1
v_lshl_add_u32 v54, v49, 14, v54
v_bfe_u32 v49, v48, 4, 2
v_lshl_add_u32 v54, v49, 7, v54
v_bfe_u32 v49, v48, 2, 1
v_lshl_add_u32 v54, v49, 6, v54
v_bfe_u32 v49, v48, 5, 1
v_lshl_add_u32 v54, v49, 5, v54
v_bfe_u32 v49, v48, 0, 2
v_lshl_add_u32 v54, v49, 3, v54
s_lshl_b32 s53, s43, 7
v_mov_b32 v239, s53
v_bfe_u32 v49, v48, 0, 4
v_lshl_add_u32 v239, v49, 8, v239
s_mul_i32 s52, s41, 12288
s_add_u32 s52, s52, 101376
v_bfe_u32 v49, v48, 4, 2
v_lshl_add_u32 v239, v49, 4, v239
v_mov_b32 v241, s52
v_add_u32 v241, 8192, v241
v_bfe_u32 v49, v48, 4, 2
v_lshl_add_u32 v241, v49, 1, v241
v_bfe_u32 v49, v48, 0, 4
v_lshl_add_u32 v241, v49, 3, v241
buffer_load_dwordx4 v[152:155], v53, s[24:27], s54 offen offset:0
v_mov_b32 v240, s52
v_bfe_u32 v49, v48, 2, 2
v_lshl_add_u32 v240, v49, 7, v240
buffer_load_dwordx4 v[156:159], v53, s[24:27], s54 offen offset:1024
v_lshlrev_b32 v49, 2, v48
v_xor_b32 v49, v49, v48
v_and_b32 v49, 48, v49
buffer_load_dwordx4 v[160:163], v53, s[24:27], s54 offen offset:2048
s_lshl_b32 s53, s41, 10
v_add_u32 v240, v49, v240
v_mov_b32 v254, s53
v_add_u32 v254, 150528, v254
buffer_load_dwordx4 v[164:167], v53, s[24:27], s54 offen offset:3072
v_bfe_u32 v49, v48, 0, 6
v_mov_b32 v40, 0
v_mov_b32 v41, 0
buffer_load_dwordx4 v[168:171], v53, s[24:27], s57 offen offset:0
v_mov_b32 v42, 0
v_mov_b32 v43, 0
v_lshl_add_u32 v254, v49, 4, v254
buffer_load_dwordx4 v[172:175], v53, s[24:27], s57 offen offset:1024
ds_write_b128 v254, v[40:43] offset:0
buffer_load_dwordx4 v[176:179], v53, s[24:27], s57 offen offset:2048
ds_write_b128 v254, v[40:43] offset:256
buffer_load_dwordx4 v[180:183], v53, s[24:27], s57 offen offset:3072
buffer_load_dwordx4 v237, s[16:19], s48 offen nt lds
s_add_u32 m0, s49, 2112
s_add_u32 s48, s55, 2048
v_mov_b32 v245, s52
v_add_u32 v245, 4096, v245
buffer_load_dwordx4 v237, s[16:19], s48 offen nt lds
s_add_u32 m0, s49, 4224
s_add_u32 s48, s55, 4096
v_bfe_u32 v49, v48, 0, 2
buffer_load_dwordx4 v237, s[16:19], s48 offen nt lds
s_add_u32 m0, s49, 6336
s_add_u32 s48, s55, 6144
s_mov_b32 vcc_lo, 0x11111111
s_mov_b32 vcc_hi, 0x11111111
buffer_load_dwordx4 v237, s[16:19], s48 offen nt lds
s_add_u32 m0, s54, 50688
v_lshl_add_u32 v245, v49, 7, v245
v_mov_b32 v254, 150528
v_lshlrev_b32 v49, 4, v48
buffer_load_dwordx4 v50, s[28:31], s54 offen offset:0 lds
v_cndmask_b32 v240, v254, v240, vcc
v_xor_b32 v49, v49, v48
v_and_b32 v49, 48, v49
buffer_load_dwordx4 v51, s[28:31], s54 offen offset:1024 lds
s_mov_b32 vcc_lo, 0xf000f
s_mov_b32 vcc_hi, 0xf000f
v_add_u32 v245, v49, v245
buffer_load_dwordx4 v50, s[28:31], s54 offen offset:2048 lds
v_cndmask_b32 v242, v254, v245, vcc
s_mov_b32 vcc_lo, 0xf000f0
s_mov_b32 vcc_hi, 0xf000f0
buffer_load_dwordx4 v51, s[28:31], s54 offen offset:3072 lds
s_add_u32 m0, s57, 50688
v_cndmask_b32 v243, v254, v245, vcc
s_mov_b32 vcc_lo, 0xf000f00
s_mov_b32 vcc_hi, 0xf000f00
buffer_load_dwordx4 v50, s[28:31], s57 offen offset:0 lds
v_cndmask_b32 v244, v254, v245, vcc
s_mov_b32 vcc_lo, 0xf000f000
s_mov_b32 vcc_hi, 0xf000f000
v_mov_b32 v246, s52
buffer_load_dwordx4 v51, s[28:31], s57 offen offset:1024 lds
v_add_u32 v246, 4096, v246
v_bfe_u32 v49, v48, 0, 2
v_cndmask_b32 v245, v254, v245, vcc
buffer_load_dwordx4 v50, s[28:31], s57 offen offset:2048 lds
v_lshl_add_u32 v246, v49, 7, v246
v_mov_b32 v254, 154880
v_bfe_u32 v49, v48, 2, 2
buffer_load_dwordx4 v51, s[28:31], s57 offen offset:3072 lds
s_add_u32 m0, s49, 16896
s_mov_b32 vcc_lo, 0xf000f
s_mov_b32 vcc_hi, 0xf000f
v_lshl_add_u32 v254, v49, 3, v254
v_cndmask_b32 v246, v254, v246, vcc
v_xor_b32 v249, 32, v248
v_xor_b32 v250, 64, v248
v_xor_b32 v251, 96, v248
s_mul_i32 s4, s43, 13107200
s_add_u32 s4, s4, s44
s_add_u32 s4, s4, 24576
s_add_u32 s5, s55, 104857600
s_sub_u32 s5, s5, s4
s_add_u32 s48, s4, 0
v_xor_b32 v52, v53, v52
v_xor_b32 v55, 96, v54
v_xor_b32 v253, 64, v252
v_lshlrev_b32 v49, 4, v48
v_xor_b32 v49, v49, v48
v_and_b32 v49, 48, v49
v_add_u32 v246, v49, v246
v_add_u32 v246, v49, v246
v_mov_b32 v50, s52
v_bfe_u32 v49, v48, 0, 4
v_lshl_add_u32 v50, v49, 7, v50
v_lshlrev_b32 v49, 4, v48
v_xor_b32 v49, v49, v48
v_and_b32 v49, 48, v49
v_add_u32 v50, v49, v50
v_mov_b32 v51, s52
v_add_u32 v51, 8192, v51
v_bfe_u32 v49, v48, 4, 2
v_lshl_add_u32 v51, v49, 9, v51
v_bfe_u32 v49, v48, 0, 4
v_lshl_add_u32 v51, v49, 3, v51
s_add_u32 s50, s55, 13107200
s_mov_b32 s51, 2048
v_xor_b32 v247, 32, v48
s_mov_b32 s52, 0x7ff00000
v_lshlrev_b32 v247, 2, v247
s_waitcnt vmcnt(19)
v_and_b32 v254, 0xffff0000, v152
buffer_load_dwordx4 v237, s[16:19], s48 offen nt lds
s_add_u32 m0, s49, 19008
s_add_u32 s48, s4, 26214400
v_and_b32 v255, 0xffff0000, v153
v_lshlrev_b32 v152, 16, v152
v_lshlrev_b32 v153, 16, v153
v_mul_f32 v254, s40, v254
v_mul_f32 v152, s40, v152
v_mul_f32 v255, s40, v255
v_mul_f32 v153, s40, v153
v_cvt_pk_bf16_f32 v152, v152, v254
v_cvt_pk_bf16_f32 v153, v153, v255
v_and_b32 v254, 0xffff0000, v154
v_and_b32 v255, 0xffff0000, v155
v_lshlrev_b32 v154, 16, v154
v_lshlrev_b32 v155, 16, v155
v_mul_f32 v254, s40, v254
v_mul_f32 v154, s40, v154
v_mul_f32 v255, s40, v255
v_mul_f32 v155, s40, v155
v_cvt_pk_bf16_f32 v154, v154, v254
v_cvt_pk_bf16_f32 v155, v155, v255
s_waitcnt vmcnt(19)
v_and_b32 v254, 0xffff0000, v156
v_and_b32 v255, 0xffff0000, v157
v_lshlrev_b32 v156, 16, v156
v_lshlrev_b32 v157, 16, v157
v_mul_f32 v254, s40, v254
v_mul_f32 v156, s40, v156
v_mul_f32 v255, s40, v255
v_mul_f32 v157, s40, v157
v_cvt_pk_bf16_f32 v156, v156, v254
buffer_load_dwordx4 v237, s[16:19], s48 offen nt lds
s_add_u32 m0, s49, 21120
s_add_u32 s48, s4, 52428800
v_cvt_pk_bf16_f32 v157, v157, v255
v_and_b32 v254, 0xffff0000, v158
v_and_b32 v255, 0xffff0000, v159
v_lshlrev_b32 v158, 16, v158
v_lshlrev_b32 v159, 16, v159
v_mul_f32 v254, s40, v254
v_mul_f32 v158, s40, v158
v_mul_f32 v255, s40, v255
v_mul_f32 v159, s40, v159
v_cvt_pk_bf16_f32 v158, v158, v254
v_cvt_pk_bf16_f32 v159, v159, v255
s_waitcnt vmcnt(19)
v_and_b32 v254, 0xffff0000, v160
v_and_b32 v255, 0xffff0000, v161
v_lshlrev_b32 v160, 16, v160
v_lshlrev_b32 v161, 16, v161
v_mul_f32 v254, s40, v254
v_mul_f32 v160, s40, v160
v_mul_f32 v255, s40, v255
v_mul_f32 v161, s40, v161
v_cvt_pk_bf16_f32 v160, v160, v254
v_cvt_pk_bf16_f32 v161, v161, v255
v_and_b32 v254, 0xffff0000, v162
v_and_b32 v255, 0xffff0000, v163
v_lshlrev_b32 v162, 16, v162
v_lshlrev_b32 v163, 16, v163
v_mul_f32 v254, s40, v254
v_mul_f32 v162, s40, v162
v_mul_f32 v255, s40, v255
v_mul_f32 v163, s40, v163
v_cvt_pk_bf16_f32 v162, v162, v254
buffer_load_dwordx4 v237, s[16:19], s48 offen nt lds
s_add_u32 m0, s49, 23232
s_add_u32 s48, s4, 78643200
ds_write_b128 v104, v[152:155] offset:0
ds_write_b128 v105, v[156:159] offset:1024
v_cvt_pk_bf16_f32 v163, v163, v255
s_waitcnt vmcnt(19)
v_and_b32 v254, 0xffff0000, v164
v_and_b32 v255, 0xffff0000, v165
v_lshlrev_b32 v164, 16, v164
v_lshlrev_b32 v165, 16, v165
v_mul_f32 v254, s40, v254
v_mul_f32 v164, s40, v164
v_mul_f32 v255, s40, v255
v_mul_f32 v165, s40, v165
v_cvt_pk_bf16_f32 v164, v164, v254
v_cvt_pk_bf16_f32 v165, v165, v255
v_and_b32 v254, 0xffff0000, v166
v_and_b32 v255, 0xffff0000, v167
v_lshlrev_b32 v166, 16, v166
v_lshlrev_b32 v167, 16, v167
v_mul_f32 v254, s40, v254
buffer_load_dwordx4 v237, s[16:19], s48 offen nt lds
s_add_u32 m0, s54, 116224
s_add_u32 s48, s55, 8192
ds_write_b128 v104, v[160:163] offset:2048
v_mul_f32 v166, s40, v166
v_mul_f32 v255, s40, v255
v_mul_f32 v167, s40, v167
v_cvt_pk_bf16_f32 v166, v166, v254
v_cvt_pk_bf16_f32 v167, v167, v255
s_waitcnt vmcnt(19)
v_and_b32 v254, 0xffff0000, v168
v_and_b32 v255, 0xffff0000, v169
v_lshlrev_b32 v168, 16, v168
v_lshlrev_b32 v169, 16, v169
v_mul_f32 v254, s40, v254
v_mul_f32 v168, s40, v168
v_mul_f32 v255, s40, v255
v_mul_f32 v169, s40, v169
v_cvt_pk_bf16_f32 v168, v168, v254
v_cvt_pk_bf16_f32 v169, v169, v255
v_and_b32 v254, 0xffff0000, v170
v_and_b32 v255, 0xffff0000, v171
v_lshlrev_b32 v170, 16, v170
v_lshlrev_b32 v171, 16, v171
v_mul_f32 v254, s40, v254
v_mul_f32 v170, s40, v170
v_mul_f32 v255, s40, v255
v_mul_f32 v171, s40, v171
buffer_load_dwordx4 v52, s[32:35], s54 offen offset:0 lds
ds_write_b128 v105, v[164:167] offset:3072
v_cvt_pk_bf16_f32 v170, v170, v254
v_cvt_pk_bf16_f32 v171, v171, v255
s_waitcnt vmcnt(19)
v_and_b32 v254, 0xffff0000, v172
v_and_b32 v255, 0xffff0000, v173
v_lshlrev_b32 v172, 16, v172
v_lshlrev_b32 v173, 16, v173
v_mul_f32 v254, s40, v254
v_mul_f32 v172, s40, v172
v_mul_f32 v255, s40, v255
v_mul_f32 v173, s40, v173
v_cvt_pk_bf16_f32 v172, v172, v254
v_cvt_pk_bf16_f32 v173, v173, v255
v_and_b32 v254, 0xffff0000, v174
v_and_b32 v255, 0xffff0000, v175
v_lshlrev_b32 v174, 16, v174
v_lshlrev_b32 v175, 16, v175
v_mul_f32 v254, s40, v254
v_mul_f32 v174, s40, v174
v_mul_f32 v255, s40, v255
v_mul_f32 v175, s40, v175
v_cvt_pk_bf16_f32 v174, v174, v254
v_cvt_pk_bf16_f32 v175, v175, v255
s_waitcnt vmcnt(18)
v_and_b32 v254, 0xffff0000, v176
v_and_b32 v255, 0xffff0000, v177
v_lshlrev_b32 v176, 16, v176
buffer_load_dwordx4 v52, s[32:35], s54 offen offset:1024 lds
ds_write_b128 v104, v[168:171] offset:4096
v_lshlrev_b32 v177, 16, v177
v_mul_f32 v254, s40, v254
v_mul_f32 v176, s40, v176
v_mul_f32 v255, s40, v255
v_mul_f32 v177, s40, v177
v_cvt_pk_bf16_f32 v176, v176, v254
v_cvt_pk_bf16_f32 v177, v177, v255
v_and_b32 v254, 0xffff0000, v178
v_and_b32 v255, 0xffff0000, v179
v_lshlrev_b32 v178, 16, v178
v_lshlrev_b32 v179, 16, v179
v_mul_f32 v254, s40, v254
v_mul_f32 v178, s40, v178
v_mul_f32 v255, s40, v255
v_mul_f32 v179, s40, v179
v_cvt_pk_bf16_f32 v178, v178, v254
v_cvt_pk_bf16_f32 v179, v179, v255
s_waitcnt vmcnt(18)
v_and_b32 v254, 0xffff0000, v180
v_and_b32 v255, 0xffff0000, v181
v_lshlrev_b32 v180, 16, v180
v_lshlrev_b32 v181, 16, v181
v_mul_f32 v254, s40, v254
v_mul_f32 v180, s40, v180
v_mul_f32 v255, s40, v255
v_mul_f32 v181, s40, v181
buffer_load_dwordx4 v52, s[32:35], s54 offen offset:2048 lds
ds_write_b128 v105, v[172:175] offset:5120
ds_write_b128 v104, v[176:179] offset:6144
v_cvt_pk_bf16_f32 v180, v180, v254
v_cvt_pk_bf16_f32 v181, v181, v255
v_and_b32 v254, 0xffff0000, v182
v_and_b32 v255, 0xffff0000, v183
v_lshlrev_b32 v182, 16, v182
v_lshlrev_b32 v183, 16, v183
v_mul_f32 v254, s40, v254
v_mul_f32 v182, s40, v182
v_mul_f32 v255, s40, v255
v_mul_f32 v183, s40, v183
v_cvt_pk_bf16_f32 v182, v182, v254
v_cvt_pk_bf16_f32 v183, v183, v255
ds_write_b128 v105, v[180:183] offset:7168
buffer_load_dwordx4 v52, s[32:35], s54 offen offset:3072 lds
s_add_u32 m0, s57, 116224
v_xor_b32 v254, 32, v54
v_xor_b32 v255, 64, v54
s_mov_b32 s53, 0x7ff00000
buffer_load_dwordx4 v52, s[32:35], s57 offen offset:0 lds
buffer_load_dwordx4 v52, s[32:35], s57 offen offset:1024 lds
s_waitcnt vmcnt(10) lgkmcnt(0)
s_barrier
ds_read_b64_tr_b16 a[64:65], v248 offset:0
ds_read_b64_tr_b16 a[66:67], v248 offset:512
ds_read_b128 v[188:191], v236 offset:0
ds_read_b64_tr_b16 a[68:69], v248 offset:4096
ds_read_b64_tr_b16 a[70:71], v248 offset:4608
buffer_load_dwordx4 v52, s[32:35], s57 offen offset:2048 lds
ds_read_b128 v[196:199], v236 offset:256
ds_read_b64_tr_b16 a[72:73], v248 offset:8192
ds_read_b64_tr_b16 a[74:75], v248 offset:8704
ds_read_b128 v[200:203], v236 offset:512
ds_read_b64_tr_b16 a[76:77], v248 offset:12288
ds_read_b64_tr_b16 a[78:79], v248 offset:12800
ds_read_b128 v[204:207], v236 offset:768
ds_read_b64_tr_b16 a[92:93], v249 offset:12288
ds_read_b64_tr_b16 a[94:95], v249 offset:12800
ds_read_b64_tr_b16 a[88:89], v249 offset:8192
ds_read_b64_tr_b16 a[90:91], v249 offset:8704
ds_read_b64_tr_b16 a[84:85], v249 offset:4096
ds_read_b64_tr_b16 a[86:87], v249 offset:4608
ds_read_b64_tr_b16 a[80:81], v249 offset:0
ds_read_b64_tr_b16 a[82:83], v249 offset:512
s_waitcnt lgkmcnt(15)
v_mfma_f32_16x16x32_bf16 v[192:195], a[64:67], v[188:191], 0
ds_read_b64_tr_b16 a[96:97], v250 offset:0
ds_read_b64_tr_b16 a[98:99], v250 offset:512
s_waitcnt lgkmcnt(15)
v_mfma_f32_16x16x32_bf16 v[192:195], a[68:71], v[196:199], v[192:195]
s_waitcnt lgkmcnt(14)
ds_read_b64_tr_b16 a[100:101], v250 offset:4096
s_waitcnt lgkmcnt(14)
v_mfma_f32_16x16x32_bf16 v[192:195], a[72:75], v[200:203], v[192:195]
s_waitcnt lgkmcnt(11)
ds_read_b64_tr_b16 a[102:103], v250 offset:4608
ds_read_b64_tr_b16 a[104:105], v250 offset:8192
v_mfma_f32_16x16x32_bf16 v[192:195], a[76:79], v[204:207], v[192:195]
s_waitcnt lgkmcnt(9)
ds_read_b64_tr_b16 a[106:107], v250 offset:8704
ds_read_b64_tr_b16 a[108:109], v250 offset:12288
v_mfma_f32_16x16x32_bf16 v[208:211], a[92:95], v[204:207], 0
s_waitcnt lgkmcnt(7)
buffer_load_dwordx4 v52, s[32:35], s57 offen offset:3072 lds
s_add_u32 m0, s49, 8448
v_mfma_f32_16x16x32_bf16 v[208:211], a[88:91], v[200:203], v[208:211]
ds_read_b64_tr_b16 a[110:111], v250 offset:12800
v_cvt_pk_bf16_f32 v0, v192, v193
v_mfma_f32_16x16x32_bf16 v[208:211], a[84:87], v[196:199], v[208:211]
s_waitcnt lgkmcnt(6)
ds_read_b64_tr_b16 a[124:125], v251 offset:12288
v_cvt_pk_bf16_f32 v1, v194, v195
v_mfma_f32_16x16x32_bf16 v[208:211], a[80:83], v[188:191], v[208:211]
s_waitcnt lgkmcnt(6)
ds_read_b64_tr_b16 a[126:127], v251 offset:12800
ds_read_b64_tr_b16 a[120:121], v251 offset:8192
v_mfma_f32_16x16x32_bf16 v[192:195], a[96:99], v[188:191], 0
s_waitcnt lgkmcnt(6)
ds_read_b64_tr_b16 a[122:123], v251 offset:8704
ds_read_b64_tr_b16 a[116:117], v251 offset:4096
v_mfma_f32_16x16x32_bf16 v[192:195], a[100:103], v[196:199], v[192:195]
s_waitcnt lgkmcnt(6)
ds_read_b64_tr_b16 a[118:119], v251 offset:4608
v_cvt_pk_bf16_f32 v2, v208, v209
v_mfma_f32_16x16x32_bf16 v[192:195], a[104:107], v[200:203], v[192:195]
ds_read_b64_tr_b16 a[112:113], v251 offset:0
s_waitcnt lgkmcnt(7)
v_mfma_f32_16x16x32_bf16 v[192:195], a[108:111], v[204:207], v[192:195]
ds_read_b64_tr_b16 a[114:115], v251 offset:512
v_cvt_pk_bf16_f32 v3, v210, v211
ds_read_b128 v[184:187], v236 offset:4992
s_waitcnt lgkmcnt(7)
v_mfma_f32_16x16x32_bf16 v[208:211], a[124:127], v[204:207], 0
s_waitcnt lgkmcnt(6)
buffer_load_dwordx4 v[120:123], v53, s[36:39], s54 offen offset:0
s_waitcnt lgkmcnt(5)
v_mfma_f32_16x16x32_bf16 v[208:211], a[120:123], v[200:203], v[208:211]
s_waitcnt lgkmcnt(4)
ds_read_b128 v[216:219], v236 offset:4736
s_waitcnt lgkmcnt(4)
v_mfma_f32_16x16x32_bf16 v[208:211], a[116:119], v[196:199], v[208:211]
ds_read_b128 v[204:207], v236 offset:4480
v_cvt_pk_bf16_f32 v5, v194, v195
v_cvt_pk_bf16_f32 v4, v192, v193
s_waitcnt lgkmcnt(3)
v_mfma_f32_16x16x32_bf16 v[208:211], a[112:115], v[188:191], v[208:211]
ds_read_b128 v[192:195], v236 offset:4224
s_waitcnt lgkmcnt(3)
v_mfma_f32_16x16x32_bf16 v[200:203], a[124:127], v[184:187], 0
ds_read_b64_tr_b16 a[0:1], v248 offset:32768
ds_read_b64_tr_b16 a[2:3], v248 offset:33280
v_mfma_f32_16x16x32_bf16 v[220:223], a[92:95], v[184:187], 0
ds_read_b64_tr_b16 a[4:5], v248 offset:36864
s_waitcnt lgkmcnt(5)
v_mfma_f32_16x16x32_bf16 v[200:203], a[120:123], v[216:219], v[200:203]
ds_read_b64_tr_b16 a[6:7], v248 offset:37376
s_waitcnt lgkmcnt(5)
v_mfma_f32_16x16x32_bf16 v[200:203], a[116:119], v[204:207], v[200:203]
ds_read_b64_tr_b16 a[8:9], v248 offset:40960
v_cvt_pk_bf16_f32 v6, v208, v209
v_mfma_f32_16x16x32_bf16 v[220:223], a[88:91], v[216:219], v[220:223]
buffer_load_dwordx4 v[124:127], v53, s[36:39], s54 offen offset:1024
s_waitcnt lgkmcnt(5)
v_mfma_f32_16x16x32_bf16 v[200:203], a[112:115], v[192:195], v[200:203]
ds_read_b64_tr_b16 a[10:11], v248 offset:41472
v_cvt_pk_bf16_f32 v7, v210, v211
v_mfma_f32_16x16x32_bf16 v[208:211], a[96:99], v[192:195], 0
s_waitcnt lgkmcnt(4)
ds_read_b64_tr_b16 a[12:13], v248 offset:45056
ds_read_b64_tr_b16 a[14:15], v248 offset:45568
v_mfma_f32_16x16x32_bf16 v[208:211], a[100:103], v[204:207], v[208:211]
s_waitcnt lgkmcnt(5)
ds_read_b64_tr_b16 a[16:17], v249 offset:32768
ds_read_b64_tr_b16 a[18:19], v249 offset:33280
v_mfma_f32_16x16x32_bf16 v[208:211], a[104:107], v[216:219], v[208:211]
s_waitcnt lgkmcnt(6)
ds_read_b64_tr_b16 a[20:21], v249 offset:36864
ds_read_b64_tr_b16 a[22:23], v249 offset:37376
v_mfma_f32_16x16x32_bf16 v[208:211], a[108:111], v[184:187], v[208:211]
s_waitcnt lgkmcnt(7)
ds_read_b64_tr_b16 a[24:25], v249 offset:40960
ds_read_b64_tr_b16 a[26:27], v249 offset:41472
v_mfma_f32_16x16x32_bf16 v[220:223], a[84:87], v[204:207], v[220:223]
ds_read_b64_tr_b16 a[28:29], v249 offset:45056
ds_read_b64_tr_b16 a[30:31], v249 offset:45568
v_mfma_f32_16x16x32_bf16 v[220:223], a[80:83], v[192:195], v[220:223]
s_waitcnt lgkmcnt(10)
ds_read_b64_tr_b16 a[32:33], v250 offset:32768
ds_read_b64_tr_b16 a[34:35], v250 offset:33280
v_mfma_f32_16x16x32_bf16 v[188:191], a[64:67], v[192:195], 0
s_waitcnt lgkmcnt(10)
ds_read_b64_tr_b16 a[36:37], v250 offset:36864
ds_read_b64_tr_b16 a[38:39], v250 offset:37376
v_mfma_f32_16x16x32_bf16 v[188:191], a[72:75], v[216:219], v[188:191]
s_waitcnt lgkmcnt(10)
buffer_load_dwordx4 v[128:131], v53, s[36:39], s54 offen offset:2048
ds_read_b64_tr_b16 a[40:41], v250 offset:40960
v_mfma_f32_16x16x32_bf16 v[188:191], a[76:79], v[184:187], v[188:191]
s_waitcnt lgkmcnt(9)
ds_read_b64_tr_b16 a[42:43], v250 offset:41472
ds_read_b64_tr_b16 a[44:45], v250 offset:45056
v_mfma_f32_16x16x32_bf16 v[188:191], a[68:71], v[204:207], v[188:191]
s_waitcnt lgkmcnt(9)
ds_read_b64_tr_b16 a[46:47], v250 offset:45568
ds_read_b64_tr_b16 a[48:49], v251 offset:32768
ds_read_b64_tr_b16 a[50:51], v251 offset:33280
ds_read_b64_tr_b16 a[52:53], v251 offset:36864
ds_read_b64_tr_b16 a[54:55], v251 offset:37376
ds_read_b64_tr_b16 a[56:57], v251 offset:40960
ds_read_b64_tr_b16 a[58:59], v251 offset:41472
s_waitcnt vmcnt(11)
s_barrier
ds_read_b128 v[56:59], v236 offset:16896
ds_read_b128 v[60:63], v236 offset:17152
ds_read_b128 v[64:67], v236 offset:17408
ds_read_b128 v[68:71], v236 offset:17664
ds_read_b128 v[72:75], v236 offset:21120
ds_read_b128 v[76:79], v236 offset:21376
ds_read_b128 v[80:83], v236 offset:21632
ds_read_b128 v[84:87], v236 offset:21888
ds_read_b64_tr_b16 a[60:61], v251 offset:45056
ds_read_b64_tr_b16 a[62:63], v251 offset:45568
v_cvt_pk_bf16_f32 v14, v200, v201
buffer_load_dwordx4 v[132:135], v53, s[36:39], s54 offen offset:3072
v_cvt_pk_bf16_f32 v15, v202, v203
v_cvt_pk_bf16_f32 v9, v190, v191
v_cvt_pk_bf16_f32 v8, v188, v189
v_cvt_pk_bf16_f32 v13, v210, v211
v_cvt_pk_bf16_f32 v12, v208, v209
v_cvt_pk_bf16_f32 v10, v220, v221
v_cvt_pk_bf16_f32 v11, v222, v223
s_waitcnt lgkmcnt(9)
v_mfma_f32_16x16x32_bf16 v[156:159], a[64:67], v[56:59], 0
s_waitcnt lgkmcnt(7)
v_mfma_f32_16x16x32_bf16 v[156:159], a[68:71], v[60:63], v[156:159]
s_waitcnt lgkmcnt(3)
v_mfma_f32_16x16x32_bf16 v[156:159], a[72:75], v[64:67], v[156:159]
s_waitcnt lgkmcnt(0)
v_mfma_f32_16x16x32_bf16 v[156:159], a[76:79], v[68:71], v[156:159]
s_nop 2
v_mfma_f32_16x16x32_bf16 v[160:163], a[92:95], v[68:71], 0
s_nop 2
v_mfma_f32_16x16x32_bf16 v[160:163], a[88:91], v[64:67], v[160:163]
s_waitcnt vmcnt(4)
s_barrier
v_mfma_f32_16x16x32_bf16 v[160:163], a[84:87], v[60:63], v[160:163]
buffer_load_dwordx4 v[136:139], v53, s[36:39], s57 offen offset:0
ds_read_b64_tr_b16 a[128:129], v252 offset:0
v_mfma_f32_16x16x32_bf16 v[160:163], a[80:83], v[56:59], v[160:163]
ds_read_b64_tr_b16 a[130:131], v252 offset:512
ds_read_b64_tr_b16 a[132:133], v252 offset:4096
v_mfma_f32_16x16x32_bf16 v[164:167], a[96:99], v[56:59], 0
ds_read_b64_tr_b16 a[134:135], v252 offset:4608
ds_read_b64_tr_b16 a[136:137], v252 offset:8192
v_mfma_f32_16x16x32_bf16 v[164:167], a[100:103], v[60:63], v[164:167]
ds_read_b64_tr_b16 a[138:139], v252 offset:8704
ds_read_b64_tr_b16 a[140:141], v252 offset:12288
v_mfma_f32_16x16x32_bf16 v[164:167], a[104:107], v[64:67], v[164:167]
ds_read_b64_tr_b16 a[142:143], v252 offset:12800
ds_read_b64_tr_b16 a[144:145], v252 offset:8
v_mfma_f32_16x16x32_bf16 v[164:167], a[108:111], v[68:71], v[164:167]
ds_read_b64_tr_b16 a[146:147], v252 offset:520
ds_read_b64_tr_b16 a[148:149], v252 offset:4104
v_mfma_f32_16x16x32_bf16 v[168:171], a[124:127], v[68:71], 0
s_waitcnt lgkmcnt(10)
ds_read_b64_tr_b16 a[150:151], v252 offset:4616
v_cvt_pk_bf16_f32 v88, v156, v157
v_mfma_f32_16x16x32_bf16 v[168:171], a[120:123], v[64:67], v[168:171]
s_waitcnt lgkmcnt(9)
ds_read_b64_tr_b16 a[152:153], v252 offset:8200
v_cvt_pk_bf16_f32 v89, v158, v159
v_mfma_f32_16x16x32_bf16 v[168:171], a[116:119], v[60:63], v[168:171]
s_waitcnt lgkmcnt(8)
ds_read_b64_tr_b16 a[154:155], v252 offset:8712
ds_read_b64_tr_b16 a[156:157], v252 offset:12296
v_mfma_f32_16x16x32_bf16 v[168:171], a[112:115], v[56:59], v[168:171]
s_waitcnt lgkmcnt(8)
buffer_load_dwordx4 v[140:143], v53, s[36:39], s57 offen offset:1024
ds_read_b64_tr_b16 a[158:159], v252 offset:12808
v_mfma_f32_16x16x32_bf16 v[172:175], a[64:67], v[72:75], 0
s_waitcnt lgkmcnt(7)
ds_read_b64_tr_b16 a[160:161], v253 offset:0
v_cvt_pk_bf16_f32 v90, v160, v161
v_mfma_f32_16x16x32_bf16 v[172:175], a[68:71], v[76:79], v[172:175]
s_waitcnt lgkmcnt(6)
ds_read_b64_tr_b16 a[162:163], v253 offset:512
v_cvt_pk_bf16_f32 v91, v162, v163
v_mfma_f32_16x16x32_bf16 v[172:175], a[72:75], v[80:83], v[172:175]
s_waitcnt lgkmcnt(6)
ds_read_b64_tr_b16 a[164:165], v253 offset:4096
ds_read_b64_tr_b16 a[166:167], v253 offset:4608
v_mfma_f32_16x16x32_bf16 v[172:175], a[76:79], v[84:87], v[172:175]
s_waitcnt lgkmcnt(7)
ds_read_b64_tr_b16 a[168:169], v253 offset:8192
ds_read_b64_tr_b16 a[170:171], v253 offset:8704
v_mfma_f32_16x16x32_bf16 v[176:179], a[92:95], v[84:87], 0
s_waitcnt lgkmcnt(7)
ds_read_b64_tr_b16 a[172:173], v253 offset:12288
v_cvt_pk_bf16_f32 v92, v164, v165
v_mfma_f32_16x16x32_bf16 v[176:179], a[88:91], v[80:83], v[176:179]
s_waitcnt lgkmcnt(7)
ds_read_b64_tr_b16 a[174:175], v253 offset:12800
v_cvt_pk_bf16_f32 v93, v166, v167
v_mfma_f32_16x16x32_bf16 v[176:179], a[84:87], v[76:79], v[176:179]
s_waitcnt lgkmcnt(7)
ds_read_b64_tr_b16 a[176:177], v253 offset:8
ds_read_b64_tr_b16 a[178:179], v253 offset:520
v_mfma_f32_16x16x32_bf16 v[176:179], a[80:83], v[72:75], v[176:179]
s_waitcnt lgkmcnt(8)
ds_read_b64_tr_b16 a[180:181], v253 offset:4104
ds_read_b64_tr_b16 a[182:183], v253 offset:4616
v_mfma_f32_16x16x32_bf16 v[180:183], a[96:99], v[72:75], 0
s_waitcnt lgkmcnt(8)
buffer_load_dwordx4 v[144:147], v53, s[36:39], s57 offen offset:2048
v_cvt_pk_bf16_f32 v94, v168, v169
v_mfma_f32_16x16x32_bf16 v[180:183], a[100:103], v[76:79], v[180:183]
s_waitcnt lgkmcnt(6)
ds_read_b64_tr_b16 a[184:185], v253 offset:8200
v_cvt_pk_bf16_f32 v95, v170, v171
v_mfma_f32_16x16x32_bf16 v[180:183], a[104:107], v[80:83], v[180:183]
s_waitcnt lgkmcnt(6)
ds_read_b64_tr_b16 a[186:187], v253 offset:8712
ds_read_b64_tr_b16 a[188:189], v253 offset:12296
v_mfma_f32_16x16x32_bf16 v[180:183], a[108:111], v[84:87], v[180:183]
s_waitcnt lgkmcnt(7)
ds_read_b64_tr_b16 a[190:191], v253 offset:12808
v_cvt_pk_bf16_f32 v96, v172, v173
v_mfma_f32_16x16x32_bf16 v[152:155], a[124:127], v[84:87], 0
s_waitcnt lgkmcnt(6)
v_cvt_pk_bf16_f32 v97, v174, v175
v_cvt_pk_bf16_f32 v98, v176, v177
v_mfma_f32_16x16x32_bf16 v[152:155], a[120:123], v[80:83], v[152:155]
s_waitcnt lgkmcnt(4)
v_cvt_pk_bf16_f32 v99, v178, v179
v_cvt_pk_bf16_f32 v100, v180, v181
v_mfma_f32_16x16x32_bf16 v[152:155], a[116:119], v[76:79], v[152:155]
v_cvt_pk_bf16_f32 v101, v182, v183
v_mov_b32 v253, 0
v_mfma_f32_16x16x32_bf16 v[152:155], a[112:115], v[72:75], v[152:155]
s_waitcnt lgkmcnt(3)
v_mov_b32 v252, 1.0
s_nop 0
v_mfma_f32_16x16x32_bf16 v[156:159], a[0:3], v[56:59], 0
s_waitcnt lgkmcnt(1)
s_nop 1
v_mfma_f32_16x16x32_bf16 v[156:159], a[4:7], v[60:63], v[156:159]
s_waitcnt lgkmcnt(0)
buffer_load_dwordx4 v[148:151], v53, s[36:39], s57 offen offset:3072
v_cvt_pk_bf16_f32 v102, v152, v153
v_mfma_f32_16x16x32_bf16 v[156:159], a[8:11], v[64:67], v[156:159]
v_cvt_pk_bf16_f32 v103, v154, v155
v_mfma_f32_16x16x32_bf16 v[156:159], a[12:15], v[68:71], v[156:159]
s_nop 2
v_mfma_f32_16x16x32_bf16 v[160:163], a[28:31], v[68:71], 0
s_nop 2
v_mfma_f32_16x16x32_bf16 v[160:163], a[24:27], v[64:67], v[160:163]
v_cvt_pk_bf16_f32 v104, v156, v157
v_cvt_pk_bf16_f32 v105, v158, v159
v_mfma_f32_16x16x32_bf16 v[160:163], a[20:23], v[60:63], v[160:163]
v_mfma_f32_16x16x32_bf16 v[160:163], a[16:19], v[56:59], v[160:163]
s_nop 2
v_mfma_f32_16x16x32_bf16 v[164:167], a[32:35], v[56:59], 0
s_nop 2
v_mfma_f32_16x16x32_bf16 v[164:167], a[36:39], v[60:63], v[164:167]
v_cvt_pk_bf16_f32 v106, v160, v161
v_cvt_pk_bf16_f32 v107, v162, v163
v_mfma_f32_16x16x32_bf16 v[164:167], a[40:43], v[64:67], v[164:167]
buffer_load_dwordx4 v237, s[16:19], s48 offen nt lds
s_add_u32 m0, s49, 10560
v_mfma_f32_16x16x32_bf16 v[164:167], a[44:47], v[68:71], v[164:167]
s_add_u32 s48, s55, 10240
s_nop 1
v_mfma_f32_16x16x32_bf16 v[168:171], a[60:63], v[68:71], 0
s_nop 2
v_mfma_f32_16x16x32_bf16 v[168:171], a[56:59], v[64:67], v[168:171]
v_cvt_pk_bf16_f32 v108, v164, v165
v_cvt_pk_bf16_f32 v109, v166, v167
v_mfma_f32_16x16x32_bf16 v[168:171], a[52:55], v[60:63], v[168:171]
v_mfma_f32_16x16x32_bf16 v[168:171], a[48:51], v[56:59], v[168:171]
s_nop 2
v_mfma_f32_16x16x32_bf16 v[172:175], a[0:3], v[72:75], 0
s_waitcnt vmcnt(8)
ds_write_b64 v54, v[120:121] offset:0
v_mfma_f32_16x16x32_bf16 v[172:175], a[4:7], v[76:79], v[172:175]
ds_write_b64 v254, v[122:123] offset:0
v_mfma_f32_16x16x32_bf16 v[172:175], a[8:11], v[80:83], v[172:175]
buffer_load_dwordx4 v237, s[16:19], s48 offen nt lds
v_mfma_f32_16x16x32_bf16 v[172:175], a[12:15], v[84:87], v[172:175]
s_add_u32 m0, s49, 12672
s_add_u32 s48, s55, 12288
v_cvt_pk_bf16_f32 v110, v168, v169
v_mfma_f32_16x16x32_bf16 v[176:179], a[28:31], v[84:87], 0
s_waitcnt vmcnt(8)
ds_write_b64 v54, v[124:125] offset:512
v_mfma_f32_16x16x32_bf16 v[176:179], a[24:27], v[80:83], v[176:179]
ds_write_b64 v254, v[126:127] offset:512
v_mfma_f32_16x16x32_bf16 v[176:179], a[20:23], v[76:79], v[176:179]
s_waitcnt vmcnt(7)
ds_write_b64 v255, v[128:129] offset:1024
v_mfma_f32_16x16x32_bf16 v[176:179], a[16:19], v[72:75], v[176:179]
ds_write_b64 v55, v[130:131] offset:1024
v_mfma_f32_16x16x32_bf16 v[180:183], a[32:35], v[72:75], 0
s_waitcnt vmcnt(6)
ds_write_b64 v255, v[132:133] offset:1536
v_mfma_f32_16x16x32_bf16 v[180:183], a[36:39], v[76:79], v[180:183]
ds_write_b64 v55, v[134:135] offset:1536
v_mfma_f32_16x16x32_bf16 v[180:183], a[40:43], v[80:83], v[180:183]
buffer_load_dwordx4 v237, s[16:19], s48 offen nt lds
s_add_u32 m0, s49, 14784
v_mfma_f32_16x16x32_bf16 v[180:183], a[44:47], v[84:87], v[180:183]
s_add_u32 s48, s55, 14336
v_cvt_pk_bf16_f32 v111, v170, v171
v_cvt_pk_bf16_f32 v112, v172, v173
v_mfma_f32_16x16x32_bf16 v[152:155], a[60:63], v[84:87], 0
s_waitcnt vmcnt(6)
ds_write_b64 v54, v[136:137] offset:2048
v_mfma_f32_16x16x32_bf16 v[152:155], a[56:59], v[80:83], v[152:155]
ds_write_b64 v254, v[138:139] offset:2048
v_mfma_f32_16x16x32_bf16 v[152:155], a[52:55], v[76:79], v[152:155]
s_waitcnt vmcnt(5)
ds_write_b64 v54, v[140:141] offset:2560
v_mfma_f32_16x16x32_bf16 v[152:155], a[48:51], v[72:75], v[152:155]
ds_write_b64 v254, v[142:143] offset:2560
v_mfma_f32_16x16x32_bf16 v[156:159], v[56:59], a[128:131], 0
s_waitcnt vmcnt(4)
ds_write_b64 v255, v[144:145] offset:3072
v_mfma_f32_16x16x32_bf16 v[156:159], v[60:63], a[132:135], v[156:159]
ds_write_b64 v55, v[146:147] offset:3072
v_mfma_f32_16x16x32_bf16 v[156:159], v[64:67], a[136:139], v[156:159]
buffer_load_dwordx4 v237, s[16:19], s48 offen nt lds
s_add_u32 m0, s49, 16896
v_mfma_f32_16x16x32_bf16 v[156:159], v[68:71], a[140:143], v[156:159]
s_add_u32 s48, s55, 16384
buffer_load_dwordx4 v237, s[16:19], s48 offen nt lds
s_add_u32 m0, s49, 19008
v_mfma_f32_16x16x32_bf16 v[160:163], v[68:71], a[156:159], 0
s_add_u32 s48, s55, 18432
buffer_load_dwordx4 v237, s[16:19], s48 offen nt lds
s_add_u32 m0, s49, 21120
v_mfma_f32_16x16x32_bf16 v[160:163], v[64:67], a[152:155], v[160:163]
s_add_u32 s48, s55, 20480
buffer_load_dwordx4 v237, s[16:19], s48 offen nt lds
s_add_u32 m0, s49, 23232
v_mfma_f32_16x16x32_bf16 v[160:163], v[60:63], a[148:151], v[160:163]
s_add_u32 s48, s55, 22528
buffer_load_dwordx4 v237, s[16:19], s48 offen nt lds
v_cvt_pk_bf16_f32 v113, v174, v175
v_mfma_f32_16x16x32_bf16 v[160:163], v[56:59], a[144:147], v[160:163]
s_add_u32 s49, s49, 50688
v_cvt_pk_bf16_f32 v114, v176, v177
v_cvt_pk_bf16_f32 v115, v178, v179
v_mfma_f32_16x16x32_bf16 v[164:167], v[56:59], a[160:163], 0
s_waitcnt vmcnt(8)
ds_write_b64 v255, v[148:149] offset:3584
v_mfma_f32_16x16x32_bf16 v[164:167], v[60:63], a[164:167], v[164:167]
ds_write_b64 v55, v[150:151] offset:3584
v_mfma_f32_16x16x32_bf16 v[164:167], v[64:67], a[168:171], v[164:167]
v_cvt_pk_bf16_f32 v116, v180, v181
v_cvt_pk_bf16_f32 v117, v182, v183
v_mfma_f32_16x16x32_bf16 v[164:167], v[68:71], a[172:175], v[164:167]
v_cvt_pk_bf16_f32 v118, v152, v153
v_cvt_pk_bf16_f32 v119, v154, v155
v_mfma_f32_16x16x32_bf16 v[168:171], v[68:71], a[188:191], 0
v_cvt_pk_bf16_f32 v156, v156, v157
v_cvt_pk_bf16_f32 v157, v158, v159
v_mfma_f32_16x16x32_bf16 v[168:171], v[64:67], a[184:187], v[168:171]
v_cvt_pk_bf16_f32 v160, v160, v161
v_cvt_pk_bf16_f32 v161, v162, v163
v_mfma_f32_16x16x32_bf16 v[168:171], v[60:63], a[180:183], v[168:171]
s_waitcnt lgkmcnt(0)
s_barrier
v_mfma_f32_16x16x32_bf16 v[168:171], v[56:59], a[176:179], v[168:171]
ds_read_b64_tr_b16 a[192:193], v248 offset:0
ds_read_b64_tr_b16 a[194:195], v248 offset:512
v_mfma_f32_16x16x32_bf16 v[172:175], v[72:75], a[128:131], 0
ds_read_b64_tr_b16 a[196:197], v248 offset:4096
ds_read_b64_tr_b16 a[198:199], v248 offset:4608
v_mfma_f32_16x16x32_bf16 v[172:175], v[76:79], a[132:135], v[172:175]
ds_read_b64_tr_b16 a[200:201], v248 offset:8192
ds_read_b64_tr_b16 a[202:203], v248 offset:8704
v_mfma_f32_16x16x32_bf16 v[172:175], v[80:83], a[136:139], v[172:175]
ds_read_b64_tr_b16 a[204:205], v248 offset:12288
ds_read_b64_tr_b16 a[206:207], v248 offset:12800
v_mfma_f32_16x16x32_bf16 v[172:175], v[84:87], a[140:143], v[172:175]
ds_read_b64_tr_b16 a[208:209], v249 offset:0
ds_read_b64_tr_b16 a[210:211], v249 offset:512
v_mfma_f32_16x16x32_bf16 v[176:179], v[84:87], a[156:159], 0
ds_read_b64_tr_b16 a[212:213], v249 offset:4096
ds_read_b64_tr_b16 a[214:215], v249 offset:4608
v_mfma_f32_16x16x32_bf16 v[176:179], v[80:83], a[152:155], v[176:179]
s_waitcnt lgkmcnt(10)
ds_read_b64_tr_b16 a[216:217], v249 offset:8192
ds_read_b64_tr_b16 a[218:219], v249 offset:8704
v_mfma_f32_16x16x32_bf16 v[176:179], v[76:79], a[148:151], v[176:179]
s_waitcnt lgkmcnt(10)
ds_read_b64_tr_b16 a[220:221], v249 offset:12288
ds_read_b64_tr_b16 a[222:223], v249 offset:12800
v_mfma_f32_16x16x32_bf16 v[176:179], v[72:75], a[144:147], v[176:179]
s_waitcnt lgkmcnt(10)
ds_read_b64_tr_b16 a[224:225], v250 offset:0
ds_read_b64_tr_b16 a[226:227], v250 offset:512
v_mfma_f32_16x16x32_bf16 v[180:183], v[72:75], a[160:163], 0
s_waitcnt lgkmcnt(10)
ds_read_b64_tr_b16 a[228:229], v250 offset:4096
ds_read_b64_tr_b16 a[230:231], v250 offset:4608
v_mfma_f32_16x16x32_bf16 v[180:183], v[76:79], a[164:167], v[180:183]
s_waitcnt lgkmcnt(10)
ds_read_b64_tr_b16 a[232:233], v250 offset:8192
ds_read_b64_tr_b16 a[234:235], v250 offset:8704
v_mfma_f32_16x16x32_bf16 v[180:183], v[80:83], a[168:171], v[180:183]
s_waitcnt lgkmcnt(10)
ds_read_b64_tr_b16 a[236:237], v250 offset:12288
ds_read_b64_tr_b16 a[238:239], v250 offset:12800
v_mfma_f32_16x16x32_bf16 v[180:183], v[84:87], a[172:175], v[180:183]
s_waitcnt lgkmcnt(10)
ds_read_b64_tr_b16 a[240:241], v251 offset:0
ds_read_b64_tr_b16 a[242:243], v251 offset:512
v_mfma_f32_16x16x32_bf16 v[152:155], v[84:87], a[188:191], 0
s_waitcnt lgkmcnt(10)
ds_read_b64_tr_b16 a[244:245], v251 offset:4096
ds_read_b64_tr_b16 a[246:247], v251 offset:4608
v_mfma_f32_16x16x32_bf16 v[152:155], v[80:83], a[184:187], v[152:155]
s_waitcnt lgkmcnt(10)
ds_read_b64_tr_b16 a[248:249], v251 offset:8192
ds_read_b64_tr_b16 a[250:251], v251 offset:8704
v_mfma_f32_16x16x32_bf16 v[152:155], v[76:79], a[180:183], v[152:155]
s_waitcnt lgkmcnt(10)
ds_read_b64_tr_b16 a[252:253], v251 offset:12288
ds_read_b64_tr_b16 a[254:255], v251 offset:12800
v_mfma_f32_16x16x32_bf16 v[152:155], v[72:75], a[176:179], v[152:155]
s_waitcnt lgkmcnt(10)
ds_write_b128 v50, v[88:91] offset:0
ds_write_b128 v50, v[104:107] offset:4096
ds_write_b64 v51, v[156:157] offset:0
ds_write_b128 v50, v[92:95] offset:64
ds_write_b128 v50, v[108:111] offset:4160
ds_write_b64 v51, v[160:161] offset:128
v_cvt_pk_bf16_f32 v164, v164, v165
v_cvt_pk_bf16_f32 v165, v166, v167
v_cvt_pk_bf16_f32 v168, v168, v169
v_cvt_pk_bf16_f32 v169, v170, v171
v_cvt_pk_bf16_f32 v172, v172, v173
v_cvt_pk_bf16_f32 v173, v174, v175
v_cvt_pk_bf16_f32 v176, v176, v177
v_cvt_pk_bf16_f32 v177, v178, v179
v_cvt_pk_bf16_f32 v180, v180, v181
v_cvt_pk_bf16_f32 v181, v182, v183
v_cvt_pk_bf16_f32 v152, v152, v153
v_cvt_pk_bf16_f32 v153, v154, v155
v_mov_b32 v105, 0
v_mov_b32 v107, 0
v_mov_b32 v109, 0
v_mov_b32 v111, 0
v_mov_b32 v133, 0
v_mov_b32 v134, 0
v_mov_b32 v135, 0
v_mov_b32 v149, 0
v_mov_b32 v150, 0
v_mov_b32 v151, 0
v_mov_b32 v248, 1.0
v_mov_b32 v249, 1.0
v_mov_b32 v251, 1.0
ds_write_b64 v51, v[164:165] offset:256
ds_write_b64 v51, v[168:169] offset:384
ds_write_b128 v50, v[96:99] offset:2048
ds_write_b128 v50, v[112:115] offset:6144
ds_write_b64 v51, v[172:173] offset:2048
ds_write_b64 v51, v[176:177] offset:2176
s_waitcnt vmcnt(4)
s_barrier
ds_read_b128 v[200:203], v236 offset:8704
ds_read_b128 v[212:215], v236 offset:8448
ds_read_b128 v[224:227], v236 offset:8960
ds_read_b128 v[228:231], v236 offset:9216
ds_read_b128 v[192:195], v236 offset:13440
ds_read_b128 v[204:207], v236 offset:12928
ds_read_b128 v[208:211], v236 offset:12672
ds_write_b128 v50, v[100:103] offset:2112
ds_write_b128 v50, v[116:119] offset:6208
s_waitcnt lgkmcnt(8)
v_mfma_f32_16x16x32_bf16 v[184:187], a[68:71], v[200:203], 0
s_waitcnt lgkmcnt(6)
ds_write_b64 v51, v[180:181] offset:2304
v_mfma_f32_16x16x32_bf16 v[184:187], a[64:67], v[212:215], v[184:187]
s_waitcnt lgkmcnt(2)
ds_write_b64 v51, v[152:153] offset:2432
v_mfma_f32_16x16x32_bf16 v[184:187], a[72:75], v[224:227], v[184:187]
v_mfma_f32_16x16x32_bf16 v[184:187], a[76:79], v[228:231], v[184:187]
s_nop 2
v_mfma_f32_16x16x32_bf16 v[188:191], a[92:95], v[228:231], 0
s_nop 2
v_mfma_f32_16x16x32_bf16 v[188:191], a[88:91], v[224:227], v[188:191]
v_cvt_pk_bf16_f32 v16, v184, v185
v_cvt_pk_bf16_f32 v17, v186, v187
v_mfma_f32_16x16x32_bf16 v[188:191], a[84:87], v[200:203], v[188:191]
ds_read_b128 v[184:187], v236 offset:13184
v_mfma_f32_16x16x32_bf16 v[188:191], a[80:83], v[212:215], v[188:191]
s_nop 2
v_mfma_f32_16x16x32_bf16 v[196:199], a[96:99], v[212:215], 0
s_nop 2
v_mfma_f32_16x16x32_bf16 v[196:199], a[100:103], v[200:203], v[196:199]
v_cvt_pk_bf16_f32 v18, v188, v189
v_cvt_pk_bf16_f32 v19, v190, v191
v_mfma_f32_16x16x32_bf16 v[196:199], a[104:107], v[224:227], v[196:199]
v_mfma_f32_16x16x32_bf16 v[196:199], a[108:111], v[228:231], v[196:199]
s_nop 2
v_mfma_f32_16x16x32_bf16 v[188:191], a[124:127], v[228:231], 0
s_waitcnt lgkmcnt(0)
s_nop 1
v_mfma_f32_16x16x32_bf16 v[188:191], a[116:119], v[200:203], v[188:191]
v_cvt_pk_bf16_f32 v21, v198, v199
v_cvt_pk_bf16_f32 v20, v196, v197
v_mfma_f32_16x16x32_bf16 v[188:191], a[112:115], v[212:215], v[188:191]
v_mfma_f32_16x16x32_bf16 v[188:191], a[120:123], v[224:227], v[188:191]
s_nop 2
v_mfma_f32_16x16x32_bf16 v[196:199], a[120:123], v[184:187], 0
s_nop 2
v_mfma_f32_16x16x32_bf16 v[196:199], a[124:127], v[192:195], v[196:199]
v_cvt_pk_bf16_f32 v23, v190, v191
v_cvt_pk_bf16_f32 v22, v188, v189
v_mfma_f32_16x16x32_bf16 v[196:199], a[116:119], v[204:207], v[196:199]
v_mfma_f32_16x16x32_bf16 v[196:199], a[112:115], v[208:211], v[196:199]
s_nop 2
v_mfma_f32_16x16x32_bf16 v[188:191], a[96:99], v[208:211], 0
s_nop 2
v_mfma_f32_16x16x32_bf16 v[188:191], a[100:103], v[204:207], v[188:191]
v_cvt_pk_bf16_f32 v30, v196, v197
v_cvt_pk_bf16_f32 v31, v198, v199
v_mfma_f32_16x16x32_bf16 v[188:191], a[104:107], v[184:187], v[188:191]
v_mfma_f32_16x16x32_bf16 v[188:191], a[108:111], v[192:195], v[188:191]
s_nop 2
v_mfma_f32_16x16x32_bf16 v[212:215], a[92:95], v[192:195], 0
s_nop 2
v_mfma_f32_16x16x32_bf16 v[212:215], a[88:91], v[184:187], v[212:215]
v_cvt_pk_bf16_f32 v29, v190, v191
v_cvt_pk_bf16_f32 v28, v188, v189
v_mfma_f32_16x16x32_bf16 v[212:215], a[84:87], v[204:207], v[212:215]
v_mfma_f32_16x16x32_bf16 v[212:215], a[80:83], v[208:211], v[212:215]
s_nop 2
v_mfma_f32_16x16x32_bf16 v[188:191], a[64:67], v[208:211], 0
s_nop 2
v_mfma_f32_16x16x32_bf16 v[188:191], a[72:75], v[184:187], v[188:191]
v_cvt_pk_bf16_f32 v27, v214, v215
v_cvt_pk_bf16_f32 v26, v212, v213
v_mfma_f32_16x16x32_bf16 v[188:191], a[76:79], v[192:195], v[188:191]
s_waitcnt vmcnt(0)
s_barrier
v_mfma_f32_16x16x32_bf16 v[188:191], a[68:71], v[204:207], v[188:191]
s_mov_b32 s48, s50
ds_read_b128 v[196:199], v236 offset:17152
ds_read_b128 v[200:203], v236 offset:16896
ds_read_b128 v[216:219], v236 offset:17408
ds_read_b128 v[220:223], v236 offset:17664
ds_read_u16 v108, v241 offset:256
ds_read_b128 v[204:207], v236 offset:21376
ds_read_b128 v[208:211], v236 offset:21120
ds_read_b128 v[52:55], v240 offset:64
v_cvt_pk_bf16_f32 v24, v188, v189
v_cvt_pk_bf16_f32 v25, v190, v191
s_add_u32 m0, s49, 0
s_add_u32 s50, s50, 13107200
buffer_load_dwordx4 v237, s[16:19], s48 offen nt lds
ds_read_b128 v[192:195], v236 offset:21888
ds_read_b128 v[48:51], v240 offset:0
ds_read_u16 v110, v241 offset:384
v_add_u32 v240, 0x200, v240
s_add_u32 s48, s48, s51
s_add_u32 m0, s49, 2112
ds_read_u16 v106, v241 offset:128
buffer_load_dwordx4 v237, s[16:19], s48 offen nt lds
s_waitcnt lgkmcnt(11)
v_mfma_f32_16x16x32_bf16 v[184:187], a[68:71], v[196:199], 0
s_waitcnt lgkmcnt(9)
ds_read_u16 v104, v241 offset:0
s_add_u32 m0, s49, 4224
v_mfma_f32_16x16x32_bf16 v[184:187], a[64:67], v[200:203], v[184:187]
s_waitcnt lgkmcnt(6)
s_add_u32 s48, s48, s51
buffer_load_dwordx4 v237, s[16:19], s48 offen nt lds
v_mfma_f32_16x16x32_bf16 v[184:187], a[72:75], v[216:219], v[184:187]
s_add_u32 m0, s49, 6336
s_add_u32 s48, s48, s51
buffer_load_dwordx4 v237, s[16:19], s48 offen nt lds
v_mfma_f32_16x16x32_bf16 v[184:187], a[76:79], v[220:223], v[184:187]
s_add_u32 m0, s49, 8448
s_add_u32 s48, s48, s51
buffer_load_dwordx4 v237, s[16:19], s48 offen nt lds
v_mfma_f32_16x16x32_bf16 v[188:191], a[92:95], v[220:223], 0
s_add_u32 m0, s49, 10560
s_mov_b32 s47, s46
s_add_u32 s48, s48, s51
v_mfma_f32_16x16x32_bf16 v[188:191], a[88:91], v[216:219], v[188:191]
s_bfe_i32 s57, s3, 0x10000
buffer_load_dwordx4 v237, s[16:19], s48 offen nt lds
v_cvt_pk_bf16_f32 v32, v184, v185
v_mfma_f32_16x16x32_bf16 v[188:191], a[84:87], v[196:199], v[188:191]
s_and_b32 s54, s57, s5
v_cvt_pk_bf16_f32 v33, v186, v187
s_sub_u32 s45, s45, 1
v_mfma_f32_16x16x32_bf16 v[188:191], a[80:83], v[200:203], v[188:191]
s_sub_u32 s50, s50, s54
s_add_u32 s52, s46, 20480
s_lshr_b32 s3, s3, 1
v_mfma_f32_16x16x32_bf16 v[184:187], a[96:99], v[200:203], 0
s_waitcnt lgkmcnt(0)
s_nop 1
v_mfma_f32_16x16x32_bf16 v[184:187], a[100:103], v[196:199], v[184:187]
v_cvt_pk_bf16_f32 v35, v190, v191
v_cvt_pk_bf16_f32 v34, v188, v189
v_mfma_f32_16x16x32_bf16 v[184:187], a[104:107], v[216:219], v[184:187]
v_mfma_f32_16x16x32_bf16 v[184:187], a[108:111], v[220:223], v[184:187]
s_nop 2
v_mfma_f32_16x16x32_bf16 v[188:191], a[124:127], v[220:223], 0
s_nop 2
v_mfma_f32_16x16x32_bf16 v[188:191], a[120:123], v[216:219], v[188:191]
v_cvt_pk_bf16_f32 v37, v186, v187
v_cvt_pk_bf16_f32 v36, v184, v185
v_mfma_f32_16x16x32_bf16 v[188:191], a[116:119], v[196:199], v[188:191]
ds_read_b128 v[196:199], v236 offset:21632
v_mfma_f32_16x16x32_bf16 v[188:191], a[112:115], v[200:203], v[188:191]
s_nop 7
v_cvt_pk_bf16_f32 v39, v190, v191
v_cvt_pk_bf16_f32 v38, v188, v189
s_nop 7
s_waitcnt lgkmcnt(0)
s_branch L_entrys
.p2align 6
L_loops:
s_waitcnt vmcnt(8)
s_barrier
v_mfma_f32_16x16x32_bf16 v[176:179], a[224:227], v[220:223], 0
s_add_u32 s52, s47, 8192
v_exp_f32 v187, v187
v_mfma_f32_16x16x32_bf16 v[176:179], a[228:231], v[224:227], v[176:179]
s_add_u32 s53, s47, 12288
v_add_f32 v248, v184, v185
v_add_f32 v248, v248, v186
v_mfma_f32_16x16x32_bf16 v[176:179], a[232:235], v[212:215], v[176:179]
s_mov_b32 s47, s46
v_add_f32 v248, v248, v187
v_cvt_pk_bf16_f32 v120, v184, v185
v_mfma_f32_16x16x32_bf16 v[176:179], a[236:239], v[216:219], v[176:179]
s_bfe_i32 s57, s3, 0x10000
v_cvt_pk_bf16_f32 v121, v186, v187
v_sub_f32 v193, v193, v254
v_mfma_f32_16x16x32_bf16 v[180:183], a[252:255], v[216:219], 0
s_and_b32 s54, s57, s5
v_exp_f32 v188, v188
v_mfma_f32_16x16x32_bf16 v[180:183], a[248:251], v[212:215], v[180:183]
s_sub_u32 s45, s45, 1
v_exp_f32 v190, v190
v_mfma_f32_16x16x32_bf16 v[180:183], a[244:247], v[224:227], v[180:183]
s_lshr_b32 s3, s3, 1
v_sub_f32 v194, v194, v254
v_add_f32 v248, v248, v188
v_mfma_f32_16x16x32_bf16 v[180:183], a[240:243], v[220:223], v[180:183]
v_exp_f32 v189, v189
v_mfma_f32_16x16x32_bf16 v[212:215], v[0:3], v[112:115], 0
v_add_f32 v248, v248, v189
v_sub_f32 v191, v191, v254
v_mfma_f32_16x16x32_bf16 v[212:215], v[4:7], v[116:119], v[212:215]
v_exp_f32 v191, v191
v_mfma_f32_16x16x32_bf16 v[216:219], v[12:15], v[116:119], 0
v_sub_f32 v195, v195, v254
v_sub_f32 v192, v192, v254
v_mfma_f32_16x16x32_bf16 v[216:219], v[8:11], v[112:115], v[216:219]
v_exp_f32 v192, v192
v_mfma_f32_16x16x32_bf16 v[220:223], v[16:19], v[112:115], 0
v_exp_f32 v194, v194
v_mfma_f32_16x16x32_bf16 v[220:223], v[20:23], v[116:119], v[220:223]
v_exp_f32 v193, v193
v_mfma_f32_16x16x32_bf16 v[224:227], v[28:31], v[116:119], 0
v_add_f32 v248, v248, v190
v_add_f32 v248, v248, v191
v_mfma_f32_16x16x32_bf16 v[224:227], v[24:27], v[112:115], v[224:227]
v_exp_f32 v195, v195
v_mfma_f32_16x16x32_bf16 v[228:231], v[32:35], v[112:115], 0
v_add_f32 v248, v248, v192
v_add_f32 v248, v248, v193
v_mfma_f32_16x16x32_bf16 v[228:231], v[36:39], v[116:119], v[228:231]
v_add_f32 v248, v248, v194
v_add_f32 v248, v248, v195
v_mfma_f32_16x16x32_bf16 v[232:235], v[44:47], v[116:119], 0
v_cvt_pk_bf16_f32 v123, v190, v191
v_cvt_pk_bf16_f32 v122, v188, v189
v_mfma_f32_16x16x32_bf16 v[232:235], v[40:43], v[112:115], v[232:235]
s_mov_b32 s48, s50
ds_read_b128 v[188:191], v236 offset:0
v_cvt_pk_bf16_f32 v125, v194, v195
v_mfma_f32_16x16x32_bf16 v[184:187], v[48:51], v[112:115], 0
s_add_u32 m0, s49, 0
ds_read_b128 v[48:51], v240 offset:0
v_cvt_pk_bf16_f32 v124, v192, v193
v_mfma_f32_16x16x32_bf16 v[184:187], v[52:55], v[116:119], v[184:187]
s_add_u32 s50, s50, 13107200
buffer_load_dwordx4 v237, s[16:19], s48 offen nt lds
v_sub_f32 v196, v196, v254
v_sub_f32 v197, v197, v254
v_sub_f32 v199, v199, v254
v_sub_f32 v198, v198, v254
v_exp_f32 v196, v196
v_exp_f32 v197, v197
v_add_f32 v248, v248, v196
v_add_f32 v248, v248, v197
v_exp_f32 v198, v198
s_waitcnt lgkmcnt(1)
v_mfma_f32_16x16x32_bf16 v[192:195], a[64:67], v[188:191], 0
s_sub_u32 s50, s50, s54
ds_read_b128 v[52:55], v240 offset:64
v_exp_f32 v199, v199
v_add_f32 v248, v248, v198
v_add_f32 v248, v248, v199
v_cvt_pk_bf16_f32 v126, v196, v197
v_cvt_pk_bf16_f32 v127, v198, v199
ds_read_b128 v[196:199], v236 offset:256
v_sub_f32 v200, v200, v254
v_sub_f32 v203, v203, v254
v_sub_f32 v201, v201, v254
v_exp_f32 v201, v201
v_sub_f32 v202, v202, v254
v_exp_f32 v202, v202
v_exp_f32 v200, v200
v_exp_f32 v203, v203
v_add_f32 v248, v248, v200
v_add_f32 v248, v248, v201
v_add_f32 v248, v248, v202
v_add_f32 v248, v248, v203
v_cvt_pk_bf16_f32 v128, v200, v201
v_cvt_pk_bf16_f32 v129, v202, v203
v_sub_f32 v204, v204, v254
v_sub_f32 v205, v205, v254
s_waitcnt lgkmcnt(0)
v_mfma_f32_16x16x32_bf16 v[192:195], a[68:71], v[196:199], v[192:195]
ds_read_b128 v[200:203], v236 offset:512
v_exp_f32 v204, v204
v_sub_f32 v206, v206, v254
v_add_f32 v248, v248, v204
v_exp_f32 v206, v206
v_sub_f32 v207, v207, v254
v_exp_f32 v205, v205
v_exp_f32 v207, v207
v_add_f32 v248, v248, v205
v_cvt_pk_bf16_f32 v130, v204, v205
v_add_f32 v248, v248, v206
v_add_f32 v248, v248, v207
v_cvt_pk_bf16_f32 v131, v206, v207
v_sub_f32 v208, v208, v254
v_exp_f32 v208, v208
v_max3_f32 v254, v212, v213, v214
s_waitcnt lgkmcnt(0)
v_mfma_f32_16x16x32_bf16 v[192:195], a[72:75], v[200:203], v[192:195]
ds_read_b128 v[204:207], v236 offset:768
v_add_f32 v248, v248, v208
v_cvt_pk_bf16_f32 v132, v208, 0
v_max3_f32 v254, v254, v215, v216
v_max3_f32 v254, v254, v217, v218
v_max3_f32 v254, v254, v219, v220
v_max3_f32 v254, v254, v221, v222
v_max3_f32 v254, v254, v223, v224
v_max3_f32 v254, v254, v225, v226
v_max3_f32 v254, v254, v227, v228
v_max3_f32 v254, v254, v229, v230
v_max3_f32 v254, v254, v231, v232
v_max3_f32 v254, v254, v233, v234
v_max3_f32 v254, v254, v235, v184
v_add_u32 v240, 0x200, v240
ds_swizzle_b32 v250, v248 offset:0x401F
ds_swizzle_b32 v255, v254 offset:0x401F
s_waitcnt lgkmcnt(2)
v_mfma_f32_16x16x32_bf16 v[192:195], a[76:79], v[204:207], v[192:195]
s_nop 2
v_mfma_f32_16x16x32_bf16 v[208:211], a[92:95], v[204:207], 0
s_nop 2
v_mfma_f32_16x16x32_bf16 v[208:211], a[88:91], v[200:203], v[208:211]
v_cvt_pk_bf16_f32 v0, v192, v193
v_cvt_pk_bf16_f32 v1, v194, v195
v_mfma_f32_16x16x32_bf16 v[208:211], a[84:87], v[196:199], v[208:211]
v_mfma_f32_16x16x32_bf16 v[208:211], a[80:83], v[188:191], v[208:211]
s_waitcnt lgkmcnt(0)
v_add_f32 v248, v248, v250
v_max_f32 v254, v254, v255
v_mfma_f32_16x16x32_bf16 v[192:195], a[96:99], v[188:191], 0
ds_bpermute_b32 v250, v247, v248
v_mfma_f32_16x16x32_bf16 v[192:195], a[100:103], v[196:199], v[192:195]
ds_bpermute_b32 v255, v247, v254
v_mfma_f32_16x16x32_bf16 v[192:195], a[104:107], v[200:203], v[192:195]
v_cvt_pk_bf16_f32 v2, v208, v209
v_cvt_pk_bf16_f32 v3, v210, v211
v_mfma_f32_16x16x32_bf16 v[192:195], a[108:111], v[204:207], v[192:195]
s_nop 2
v_mfma_f32_16x16x32_bf16 v[208:211], a[124:127], v[204:207], 0
s_nop 2
v_mfma_f32_16x16x32_bf16 v[208:211], a[120:123], v[200:203], v[208:211]
v_cvt_pk_bf16_f32 v5, v194, v195
v_cvt_pk_bf16_f32 v4, v192, v193
v_mfma_f32_16x16x32_bf16 v[208:211], a[116:119], v[196:199], v[208:211]
s_waitcnt lgkmcnt(1)
v_add_f32 v248, v248, v250
v_mfma_f32_16x16x32_bf16 v[208:211], a[112:115], v[188:191], v[208:211]
s_waitcnt lgkmcnt(0)
v_rcp_f32 v251, v248
v_mfma_f32_16x16x32_bf16 v[188:191], v[56:59], v[120:123], 0
v_max_f32 v254, v254, v255
v_sub_f32 v214, v214, v254
v_mfma_f32_16x16x32_bf16 v[188:191], v[104:107], v[132:135], v[188:191]
s_add_u32 s48, s48, s51
v_sub_f32 v215, v215, v254
v_cvt_pk_bf16_f32 v6, v208, v209
v_mfma_f32_16x16x32_bf16 v[188:191], v[72:75], v[124:127], v[188:191]
s_add_u32 m0, s49, 2112
v_cvt_pk_bf16_f32 v7, v210, v211
v_sub_f32 v212, v212, v254
v_mfma_f32_16x16x32_bf16 v[188:191], v[88:91], v[128:131], v[188:191]
buffer_load_dwordx4 v237, s[16:19], s48 offen nt lds
v_sub_f32 v213, v213, v254
v_mfma_f32_16x16x32_bf16 v[196:199], v[92:95], v[128:131], 0
v_exp_f32 v212, v212
v_mfma_f32_16x16x32_bf16 v[196:199], v[76:79], v[124:127], v[196:199]
v_exp_f32 v214, v214
v_mfma_f32_16x16x32_bf16 v[196:199], v[106:109], v[132:135], v[196:199]
v_exp_f32 v213, v213
v_mfma_f32_16x16x32_bf16 v[196:199], v[60:63], v[120:123], v[196:199]
ds_read_b128 v[204:207], v236 offset:4480
v_sub_f32 v216, v216, v254
v_mfma_f32_16x16x32_bf16 v[200:203], v[64:67], v[120:123], 0
ds_read_b128 v[192:195], v236 offset:4224
v_sub_f32 v217, v217, v254
v_mfma_f32_16x16x32_bf16 v[200:203], v[108:111], v[132:135], v[200:203]
v_exp_f32 v215, v215
v_mfma_f32_16x16x32_bf16 v[200:203], v[80:83], v[124:127], v[200:203]
v_exp_f32 v217, v217
v_mfma_f32_16x16x32_bf16 v[200:203], v[96:99], v[128:131], v[200:203]
v_sub_f32 v218, v218, v254
v_add_f32 v249, v212, v213
v_mfma_f32_16x16x32_bf16 v[208:211], v[100:103], v[128:131], 0
v_add_f32 v249, v249, v214
v_add_f32 v249, v249, v215
v_mfma_f32_16x16x32_bf16 v[208:211], v[84:87], v[124:127], v[208:211]
s_waitcnt lgkmcnt(1)
v_exp_f32 v216, v216
v_mfma_f32_16x16x32_bf16 v[208:211], v[110:113], v[132:135], v[208:211]
s_waitcnt lgkmcnt(0)
v_sub_f32 v219, v219, v254
v_sub_f32 v220, v220, v254
v_mfma_f32_16x16x32_bf16 v[208:211], v[68:71], v[120:123], v[208:211]
v_exp_f32 v218, v218
v_sub_f32 v223, v223, v254
v_add_f32 v249, v249, v216
v_add_f32 v249, v249, v217
v_exp_f32 v219, v219
v_add_f32 v249, v249, v218
v_add_f32 v249, v249, v219
v_exp_f32 v220, v220
v_sub_f32 v224, v224, v254
v_exp_f32 v223, v223
v_sub_f32 v221, v221, v254
v_exp_f32 v224, v224
v_exp_f32 v221, v221
v_sub_f32 v222, v222, v254
v_sub_f32 v225, v225, v254
v_add_f32 v249, v249, v220
v_add_f32 v249, v249, v221
v_exp_f32 v222, v222
v_exp_f32 v225, v225
v_add_f32 v249, v249, v222
v_add_f32 v249, v249, v223
v_add_f32 v249, v249, v224
v_sub_f32 v226, v226, v254
v_add_f32 v249, v249, v225
v_exp_f32 v226, v226
v_sub_f32 v227, v227, v254
v_exp_f32 v227, v227
v_sub_f32 v228, v228, v254
v_exp_f32 v228, v228
v_add_f32 v249, v249, v226
v_sub_f32 v232, v232, v254
v_sub_f32 v229, v229, v254
v_sub_f32 v230, v230, v254
v_exp_f32 v230, v230
v_exp_f32 v229, v229
v_add_f32 v249, v249, v227
v_add_f32 v249, v249, v228
v_add_f32 v249, v249, v229
v_exp_f32 v232, v232
v_sub_f32 v233, v233, v254
v_exp_f32 v233, v233
v_sub_f32 v231, v231, v254
v_exp_f32 v231, v231
v_sub_f32 v234, v234, v254
v_sub_f32 v235, v235, v254
v_add_f32 v249, v249, v230
v_add_f32 v249, v249, v231
v_add_f32 v249, v249, v232
v_exp_f32 v234, v234
v_exp_f32 v235, v235
v_sub_f32 v184, v184, v254
v_exp_f32 v184, v184
v_add_f32 v249, v249, v233
v_cvt_pk_bf16_f32 v148, v184, 0
v_add_f32 v249, v249, v234
v_add_f32 v249, v249, v235
v_add_f32 v249, v249, v184
v_fmac_f32 v161, v201, v251
v_fmac_f32 v163, v203, v251
v_fmac_f32 v160, v200, v251
v_fmac_f32 v162, v202, v251
ds_read_b128 v[184:187], v236 offset:4992
v_cvt_pk_bf16_f32 v138, v216, v217
v_cvt_pk_bf16_f32 v139, v218, v219
v_fmac_f32 v167, v211, v251
v_fmac_f32 v165, v209, v251
v_fmac_f32 v166, v210, v251
v_fmac_f32 v164, v208, v251
v_cvt_pk_bf16_f32 v140, v220, v221
v_cvt_pk_bf16_f32 v141, v222, v223
v_fmac_f32 v155, v191, v251
v_fmac_f32 v154, v190, v251
v_fmac_f32 v152, v188, v251
v_fmac_f32 v153, v189, v251
v_cvt_pk_bf16_f32 v137, v214, v215
v_cvt_pk_bf16_f32 v136, v212, v213
v_cvt_pk_bf16_f32 v143, v226, v227
v_cvt_pk_bf16_f32 v142, v224, v225
v_cvt_pk_bf16_f32 v145, v230, v231
v_cvt_pk_bf16_f32 v144, v228, v229
v_fmac_f32 v156, v196, v251
v_fmac_f32 v157, v197, v251
s_waitcnt lgkmcnt(0)
v_mfma_f32_16x16x32_bf16 v[200:203], a[124:127], v[184:187], 0
ds_read_b128 v[216:219], v236 offset:4736
v_fmac_f32 v158, v198, v251
v_fmac_f32 v159, v199, v251
v_cvt_pk_bf16_f32 v147, v234, v235
v_cvt_pk_bf16_f32 v146, v232, v233
v_cvt_pk_bf16_f32 v160, v160, v161
v_cvt_pk_bf16_f32 v161, v162, v163
v_cvt_pk_bf16_f32 v163, v166, v167
v_cvt_pk_bf16_f32 v162, v164, v165
v_cvt_pk_bf16_f32 v152, v152, v153
v_cvt_pk_bf16_f32 v153, v154, v155
v_pk_max_i16 v160, v160, 0
v_pk_max_i16 v162, v162, 0
v_pk_max_i16 v153, v153, 0
v_pk_max_i16 v161, v161, 0
v_pk_max_i16 v163, v163, 0
v_cvt_pk_bf16_f32 v155, v158, v159
v_pk_max_i16 v155, v155, 0
v_pk_max_i16 v152, v152, 0
v_cvt_pk_bf16_f32 v154, v156, v157
v_pk_max_i16 v154, v154, 0
s_waitcnt lgkmcnt(0)
v_mfma_f32_16x16x32_bf16 v[200:203], a[120:123], v[216:219], v[200:203]
ds_swizzle_b32 v250, v249 offset:0x401F
buffer_store_dwordx4 v[152:155], v239, s[20:23], s52 offen offset:0 nt
buffer_store_dwordx4 v[160:163], v239, s[20:23], s52 offen offset:64 nt
s_add_u32 s52, s46, 20480
v_mfma_f32_16x16x32_bf16 v[200:203], a[116:119], v[204:207], v[200:203]
v_mfma_f32_16x16x32_bf16 v[200:203], a[112:115], v[192:195], v[200:203]
s_nop 2
v_mfma_f32_16x16x32_bf16 v[208:211], a[96:99], v[192:195], 0
s_waitcnt lgkmcnt(0)
v_add_f32 v249, v249, v250
v_mfma_f32_16x16x32_bf16 v[208:211], a[100:103], v[204:207], v[208:211]
s_add_u32 m0, s49, 4224
ds_bpermute_b32 v250, v247, v249
v_mfma_f32_16x16x32_bf16 v[208:211], a[104:107], v[216:219], v[208:211]
s_add_u32 s48, s48, s51
buffer_load_dwordx4 v237, s[16:19], s48 offen nt lds
v_cvt_pk_bf16_f32 v14, v200, v201
v_mfma_f32_16x16x32_bf16 v[208:211], a[108:111], v[184:187], v[208:211]
ds_read_b128 v[212:215], v236 offset:8448
v_cvt_pk_bf16_f32 v15, v202, v203
v_mfma_f32_16x16x32_bf16 v[220:223], a[92:95], v[184:187], 0
ds_read_b128 v[200:203], v236 offset:8704
ds_read_b128 v[224:227], v236 offset:8960
v_mfma_f32_16x16x32_bf16 v[220:223], a[88:91], v[216:219], v[220:223]
ds_read_b128 v[228:231], v236 offset:9216
v_mfma_f32_16x16x32_bf16 v[220:223], a[84:87], v[204:207], v[220:223]
v_cvt_pk_bf16_f32 v13, v210, v211
v_cvt_pk_bf16_f32 v12, v208, v209
v_mfma_f32_16x16x32_bf16 v[220:223], a[80:83], v[192:195], v[220:223]
s_waitcnt lgkmcnt(4)
v_add_f32 v249, v249, v250
s_nop 0
v_mfma_f32_16x16x32_bf16 v[188:191], a[64:67], v[192:195], 0
v_rcp_f32 v252, v249
v_mfma_f32_16x16x32_bf16 v[188:191], a[72:75], v[216:219], v[188:191]
s_waitcnt lgkmcnt(3)
s_nop 0
v_cvt_pk_bf16_f32 v10, v220, v221
v_mfma_f32_16x16x32_bf16 v[188:191], a[76:79], v[184:187], v[188:191]
s_waitcnt lgkmcnt(1)
v_cvt_pk_bf16_f32 v11, v222, v223
v_mfma_f32_16x16x32_bf16 v[188:191], a[68:71], v[204:207], v[188:191]
s_waitcnt lgkmcnt(0)
s_nop 1
v_mfma_f32_16x16x32_bf16 v[184:187], a[68:71], v[200:203], 0
s_nop 2
v_mfma_f32_16x16x32_bf16 v[184:187], a[64:67], v[212:215], v[184:187]
v_cvt_pk_bf16_f32 v9, v190, v191
v_cvt_pk_bf16_f32 v8, v188, v189
v_mfma_f32_16x16x32_bf16 v[184:187], a[72:75], v[224:227], v[184:187]
v_mfma_f32_16x16x32_bf16 v[184:187], a[76:79], v[228:231], v[184:187]
s_nop 2
v_mfma_f32_16x16x32_bf16 v[188:191], a[92:95], v[228:231], 0
s_nop 2
v_mfma_f32_16x16x32_bf16 v[188:191], a[88:91], v[224:227], v[188:191]
v_cvt_pk_bf16_f32 v16, v184, v185
v_cvt_pk_bf16_f32 v17, v186, v187
v_mfma_f32_16x16x32_bf16 v[188:191], a[84:87], v[200:203], v[188:191]
v_mfma_f32_16x16x32_bf16 v[188:191], a[80:83], v[212:215], v[188:191]
ds_read_b128 v[184:187], v236 offset:13184
ds_read_b128 v[192:195], v236 offset:13440
v_mfma_f32_16x16x32_bf16 v[196:199], a[96:99], v[212:215], 0
ds_read_b128 v[204:207], v236 offset:12928
ds_read_b128 v[208:211], v236 offset:12672
v_mfma_f32_16x16x32_bf16 v[196:199], a[100:103], v[200:203], v[196:199]
s_add_u32 m0, s49, 6336
s_add_u32 s48, s48, s51
v_cvt_pk_bf16_f32 v18, v188, v189
v_mfma_f32_16x16x32_bf16 v[196:199], a[104:107], v[224:227], v[196:199]
buffer_load_dwordx4 v237, s[16:19], s48 offen nt lds
v_cvt_pk_bf16_f32 v19, v190, v191
v_mfma_f32_16x16x32_bf16 v[196:199], a[108:111], v[228:231], v[196:199]
s_nop 2
v_mfma_f32_16x16x32_bf16 v[188:191], a[124:127], v[228:231], 0
s_nop 2
v_mfma_f32_16x16x32_bf16 v[188:191], a[116:119], v[200:203], v[188:191]
s_waitcnt lgkmcnt(2)
v_cvt_pk_bf16_f32 v21, v198, v199
v_cvt_pk_bf16_f32 v20, v196, v197
v_mfma_f32_16x16x32_bf16 v[188:191], a[112:115], v[212:215], v[188:191]
s_waitcnt lgkmcnt(0)
v_mfma_f32_16x16x32_bf16 v[188:191], a[120:123], v[224:227], v[188:191]
s_nop 2
v_mfma_f32_16x16x32_bf16 v[196:199], a[120:123], v[184:187], 0
s_nop 2
v_mfma_f32_16x16x32_bf16 v[196:199], a[124:127], v[192:195], v[196:199]
v_cvt_pk_bf16_f32 v23, v190, v191
v_cvt_pk_bf16_f32 v22, v188, v189
v_mfma_f32_16x16x32_bf16 v[196:199], a[116:119], v[204:207], v[196:199]
v_mfma_f32_16x16x32_bf16 v[196:199], a[112:115], v[208:211], v[196:199]
s_nop 2
v_mfma_f32_16x16x32_bf16 v[188:191], a[96:99], v[208:211], 0
s_nop 2
v_mfma_f32_16x16x32_bf16 v[188:191], a[100:103], v[204:207], v[188:191]
v_cvt_pk_bf16_f32 v30, v196, v197
v_cvt_pk_bf16_f32 v31, v198, v199
v_mfma_f32_16x16x32_bf16 v[188:191], a[104:107], v[184:187], v[188:191]
v_mfma_f32_16x16x32_bf16 v[188:191], a[108:111], v[192:195], v[188:191]
ds_read_b128 v[196:199], v236 offset:17152
ds_read_b128 v[200:203], v236 offset:16896
v_mfma_f32_16x16x32_bf16 v[212:215], a[92:95], v[192:195], 0
ds_read_b128 v[216:219], v236 offset:17408
ds_read_b128 v[220:223], v236 offset:17664
v_mfma_f32_16x16x32_bf16 v[212:215], a[88:91], v[184:187], v[212:215]
s_nop 1
v_cvt_pk_bf16_f32 v29, v190, v191
v_mfma_f32_16x16x32_bf16 v[212:215], a[84:87], v[204:207], v[212:215]
v_cvt_pk_bf16_f32 v28, v188, v189
v_mfma_f32_16x16x32_bf16 v[212:215], a[80:83], v[208:211], v[212:215]
s_nop 2
v_mfma_f32_16x16x32_bf16 v[188:191], a[64:67], v[208:211], 0
s_nop 2
v_mfma_f32_16x16x32_bf16 v[188:191], a[72:75], v[184:187], v[188:191]
s_add_u32 m0, s49, 8448
v_cvt_pk_bf16_f32 v27, v214, v215
v_cvt_pk_bf16_f32 v26, v212, v213
v_mfma_f32_16x16x32_bf16 v[188:191], a[76:79], v[192:195], v[188:191]
s_add_u32 s48, s48, s51
buffer_load_dwordx4 v237, s[16:19], s48 offen nt lds
v_mfma_f32_16x16x32_bf16 v[188:191], a[68:71], v[204:207], v[188:191]
s_waitcnt lgkmcnt(0)
s_nop 1
v_mfma_f32_16x16x32_bf16 v[184:187], a[68:71], v[196:199], 0
s_nop 2
v_mfma_f32_16x16x32_bf16 v[184:187], a[64:67], v[200:203], v[184:187]
v_cvt_pk_bf16_f32 v24, v188, v189
v_cvt_pk_bf16_f32 v25, v190, v191
v_mfma_f32_16x16x32_bf16 v[184:187], a[72:75], v[216:219], v[184:187]
v_mfma_f32_16x16x32_bf16 v[184:187], a[76:79], v[220:223], v[184:187]
s_nop 2
v_mfma_f32_16x16x32_bf16 v[188:191], a[92:95], v[220:223], 0
s_nop 2
v_mfma_f32_16x16x32_bf16 v[188:191], a[88:91], v[216:219], v[188:191]
v_cvt_pk_bf16_f32 v32, v184, v185
v_cvt_pk_bf16_f32 v33, v186, v187
v_mfma_f32_16x16x32_bf16 v[188:191], a[84:87], v[196:199], v[188:191]
v_mfma_f32_16x16x32_bf16 v[188:191], a[80:83], v[200:203], v[188:191]
s_nop 2
v_mfma_f32_16x16x32_bf16 v[184:187], a[96:99], v[200:203], 0
s_nop 2
v_mfma_f32_16x16x32_bf16 v[184:187], a[100:103], v[196:199], v[184:187]
v_cvt_pk_bf16_f32 v35, v190, v191
v_cvt_pk_bf16_f32 v34, v188, v189
v_mfma_f32_16x16x32_bf16 v[184:187], a[104:107], v[216:219], v[184:187]
v_mfma_f32_16x16x32_bf16 v[184:187], a[108:111], v[220:223], v[184:187]
s_nop 2
v_mfma_f32_16x16x32_bf16 v[188:191], a[124:127], v[220:223], 0
s_nop 2
v_mfma_f32_16x16x32_bf16 v[188:191], a[120:123], v[216:219], v[188:191]
v_cvt_pk_bf16_f32 v37, v186, v187
v_cvt_pk_bf16_f32 v36, v184, v185
v_mfma_f32_16x16x32_bf16 v[188:191], a[116:119], v[196:199], v[188:191]
v_mfma_f32_16x16x32_bf16 v[188:191], a[112:115], v[200:203], v[188:191]
s_nop 2
v_mfma_f32_16x16x32_bf16 v[184:187], v[56:59], v[136:139], 0
s_nop 2
v_mfma_f32_16x16x32_bf16 v[184:187], v[104:107], v[148:151], v[184:187]
s_add_u32 m0, s49, 10560
ds_read_u16 v104, v241 offset:0
v_cvt_pk_bf16_f32 v39, v190, v191
v_mfma_f32_16x16x32_bf16 v[184:187], v[72:75], v[140:143], v[184:187]
s_add_u32 s48, s48, s51
buffer_load_dwordx4 v237, s[16:19], s48 offen nt lds
v_cvt_pk_bf16_f32 v38, v188, v189
v_mfma_f32_16x16x32_bf16 v[184:187], v[88:91], v[144:147], v[184:187]
s_nop 2
v_mfma_f32_16x16x32_bf16 v[188:191], v[92:95], v[144:147], 0
s_nop 2
v_mfma_f32_16x16x32_bf16 v[188:191], v[76:79], v[140:143], v[188:191]
v_fmac_f32 v170, v186, v252
v_fmac_f32 v168, v184, v252
v_mfma_f32_16x16x32_bf16 v[188:191], v[106:109], v[148:151], v[188:191]
ds_read_u16 v106, v241 offset:128
v_fmac_f32 v171, v187, v252
v_mfma_f32_16x16x32_bf16 v[188:191], v[60:63], v[136:139], v[188:191]
s_waitcnt lgkmcnt(1)
ds_read_b128 v[192:195], v236 offset:21888
v_fmac_f32 v169, v185, v252
v_mfma_f32_16x16x32_bf16 v[200:203], v[64:67], v[136:139], 0
ds_read_b128 v[196:199], v236 offset:21632
ds_read_b128 v[204:207], v236 offset:21376
v_mfma_f32_16x16x32_bf16 v[200:203], v[108:111], v[148:151], v[200:203]
ds_read_b128 v[208:211], v236 offset:21120
v_fmac_f32 v174, v190, v252
v_mfma_f32_16x16x32_bf16 v[200:203], v[80:83], v[140:143], v[200:203]
ds_read_u16 v108, v241 offset:256
v_fmac_f32 v175, v191, v252
v_mfma_f32_16x16x32_bf16 v[200:203], v[96:99], v[144:147], v[200:203]
v_fmac_f32 v172, v188, v252
v_fmac_f32 v173, v189, v252
v_mfma_f32_16x16x32_bf16 v[184:187], v[100:103], v[144:147], 0
s_waitcnt lgkmcnt(5)
v_cvt_pk_bf16_f32 v168, v168, v169
v_cvt_pk_bf16_f32 v169, v170, v171
v_mfma_f32_16x16x32_bf16 v[184:187], v[84:87], v[140:143], v[184:187]
s_waitcnt lgkmcnt(4)
v_fmac_f32 v178, v202, v252
v_fmac_f32 v176, v200, v252
v_mfma_f32_16x16x32_bf16 v[184:187], v[110:113], v[148:151], v[184:187]
s_waitcnt lgkmcnt(2)
ds_read_u16 v110, v241 offset:384
v_fmac_f32 v177, v201, v252
v_mfma_f32_16x16x32_bf16 v[184:187], v[68:71], v[136:139], v[184:187]
L_entrys:
s_waitcnt lgkmcnt(2)
v_fmac_f32 v179, v203, v252
v_cvt_pk_bf16_f32 v176, v176, v177
v_mfma_f32_16x16x32_bf16 v[188:191], a[124:127], v[192:195], 0
s_waitcnt lgkmcnt(1)
v_cvt_pk_bf16_f32 v177, v178, v179
v_cvt_pk_bf16_f32 v171, v174, v175
v_mfma_f32_16x16x32_bf16 v[188:191], a[120:123], v[196:199], v[188:191]
v_fmac_f32 v180, v184, v252
v_fmac_f32 v181, v185, v252
v_mfma_f32_16x16x32_bf16 v[188:191], a[116:119], v[204:207], v[188:191]
v_fmac_f32 v183, v187, v252
v_fmac_f32 v182, v186, v252
v_mfma_f32_16x16x32_bf16 v[188:191], a[112:115], v[208:211], v[188:191]
v_cvt_pk_bf16_f32 v178, v180, v181
v_cvt_pk_bf16_f32 v170, v172, v173
v_mfma_f32_16x16x32_bf16 v[184:187], a[96:99], v[208:211], 0
s_waitcnt lgkmcnt(0)
v_cvt_pk_bf16_f32 v179, v182, v183
v_pk_max_i16 v168, v168, 0
v_mfma_f32_16x16x32_bf16 v[184:187], a[100:103], v[204:207], v[184:187]
s_add_u32 s48, s48, s51
v_cvt_pk_bf16_f32 v46, v188, v189
v_cvt_pk_bf16_f32 v47, v190, v191
v_mfma_f32_16x16x32_bf16 v[184:187], a[104:107], v[196:199], v[184:187]
s_add_u32 m0, s49, 12672
v_pk_max_i16 v176, v176, 0
v_pk_max_i16 v170, v170, 0
v_mfma_f32_16x16x32_bf16 v[184:187], a[108:111], v[192:195], v[184:187]
buffer_load_dwordx4 v237, s[16:19], s48 offen nt lds
v_pk_max_i16 v179, v179, 0
v_mfma_f32_16x16x32_bf16 v[188:191], a[92:95], v[192:195], 0
v_pk_max_i16 v178, v178, 0
v_pk_max_i16 v169, v169, 0
v_mfma_f32_16x16x32_bf16 v[188:191], a[88:91], v[196:199], v[188:191]
v_pk_max_i16 v177, v177, 0
v_pk_max_i16 v171, v171, 0
v_mfma_f32_16x16x32_bf16 v[188:191], a[84:87], v[204:207], v[188:191]
buffer_store_dwordx4 v[168:171], v239, s[20:23], s53 offen offset:0 nt
buffer_store_dwordx4 v[176:179], v239, s[20:23], s53 offen offset:64 nt
v_cvt_pk_bf16_f32 v44, v184, v185
v_cvt_pk_bf16_f32 v45, v186, v187
v_add_u32 v241, 0x200, v241
s_add_u32 s53, s46, 0
v_mfma_f32_16x16x32_bf16 v[188:191], a[80:83], v[208:211], v[188:191]
s_nop 2
v_mfma_f32_16x16x32_bf16 v[184:187], a[64:67], v[208:211], 0
s_nop 2
v_mfma_f32_16x16x32_bf16 v[184:187], a[72:75], v[196:199], v[184:187]
v_cvt_pk_bf16_f32 v42, v188, v189
v_cvt_pk_bf16_f32 v43, v190, v191
v_mfma_f32_16x16x32_bf16 v[184:187], a[76:79], v[192:195], v[184:187]
v_mfma_f32_16x16x32_bf16 v[184:187], a[68:71], v[204:207], v[184:187]
s_nop 2
v_mfma_f32_16x16x32_bf16 v[188:191], a[4:7], v[204:207], 0
s_nop 2
v_mfma_f32_16x16x32_bf16 v[188:191], a[0:3], v[208:211], v[188:191]
v_cvt_pk_bf16_f32 v41, v186, v187
v_cvt_pk_bf16_f32 v40, v184, v185
v_mfma_f32_16x16x32_bf16 v[188:191], a[8:11], v[196:199], v[188:191]
v_mfma_f32_16x16x32_bf16 v[188:191], a[12:15], v[192:195], v[188:191]
s_nop 2
v_mfma_f32_16x16x32_bf16 v[184:187], a[28:31], v[192:195], 0
s_nop 2
v_mfma_f32_16x16x32_bf16 v[184:187], a[24:27], v[196:199], v[184:187]
v_cvt_pk_bf16_f32 v112, v188, v189
v_cvt_pk_bf16_f32 v113, v190, v191
v_mfma_f32_16x16x32_bf16 v[184:187], a[20:23], v[204:207], v[184:187]
v_mfma_f32_16x16x32_bf16 v[184:187], a[16:19], v[208:211], v[184:187]
s_nop 2
v_mfma_f32_16x16x32_bf16 v[188:191], a[32:35], v[208:211], 0
s_nop 2
v_mfma_f32_16x16x32_bf16 v[188:191], a[36:39], v[204:207], v[188:191]
s_add_u32 m0, s49, 14784
v_cvt_pk_bf16_f32 v114, v184, v185
v_cvt_pk_bf16_f32 v115, v186, v187
v_mfma_f32_16x16x32_bf16 v[188:191], a[40:43], v[196:199], v[188:191]
s_add_u32 s48, s48, s51
buffer_load_dwordx4 v237, s[16:19], s48 offen nt lds
v_mfma_f32_16x16x32_bf16 v[188:191], a[44:47], v[192:195], v[188:191]
s_nop 2
v_mfma_f32_16x16x32_bf16 v[184:187], a[60:63], v[192:195], 0
s_nop 2
v_mfma_f32_16x16x32_bf16 v[184:187], a[56:59], v[196:199], v[184:187]
v_cvt_pk_bf16_f32 v116, v188, v189
v_cvt_pk_bf16_f32 v117, v190, v191
v_mfma_f32_16x16x32_bf16 v[184:187], a[52:55], v[204:207], v[184:187]
v_mfma_f32_16x16x32_bf16 v[184:187], a[48:51], v[208:211], v[184:187]
s_nop 2
v_mfma_f32_16x16x32_bf16 v[152:155], a[192:195], v[208:211], 0
s_nop 2
v_mfma_f32_16x16x32_bf16 v[152:155], a[196:199], v[204:207], v[152:155]
v_cvt_pk_bf16_f32 v118, v184, v185
v_cvt_pk_bf16_f32 v119, v186, v187
v_mfma_f32_16x16x32_bf16 v[152:155], a[200:203], v[196:199], v[152:155]
v_mfma_f32_16x16x32_bf16 v[152:155], a[204:207], v[192:195], v[152:155]
v_mfma_f32_16x16x32_bf16 v[156:159], a[220:223], v[192:195], 0
v_mfma_f32_16x16x32_bf16 v[156:159], a[216:219], v[196:199], v[156:159]
v_mfma_f32_16x16x32_bf16 v[156:159], a[212:215], v[204:207], v[156:159]
v_mfma_f32_16x16x32_bf16 v[156:159], a[208:211], v[208:211], v[156:159]
v_mfma_f32_16x16x32_bf16 v[160:163], a[224:227], v[208:211], 0
v_mfma_f32_16x16x32_bf16 v[160:163], a[228:231], v[204:207], v[160:163]
v_mfma_f32_16x16x32_bf16 v[160:163], a[232:235], v[196:199], v[160:163]
v_mfma_f32_16x16x32_bf16 v[160:163], a[236:239], v[192:195], v[160:163]
v_mfma_f32_16x16x32_bf16 v[164:167], a[252:255], v[192:195], 0
v_mfma_f32_16x16x32_bf16 v[164:167], a[248:251], v[196:199], v[164:167]
s_add_u32 s48, s48, s51
s_add_u32 m0, s49, 16896
v_mfma_f32_16x16x32_bf16 v[164:167], a[244:247], v[204:207], v[164:167]
buffer_load_dwordx4 v237, s[16:19], s48 offen nt lds
v_mfma_f32_16x16x32_bf16 v[164:167], a[240:243], v[208:211], v[164:167]
v_mfma_f32_16x16x32_bf16 v[184:187], v[0:3], v[112:115], 0
v_mfma_f32_16x16x32_bf16 v[184:187], v[4:7], v[116:119], v[184:187]
s_nop 2
v_mfma_f32_16x16x32_bf16 v[188:191], v[12:15], v[116:119], 0
s_nop 2
v_mfma_f32_16x16x32_bf16 v[188:191], v[8:11], v[112:115], v[188:191]
v_max3_f32 v254, v184, v185, v186
s_nop 0
v_mfma_f32_16x16x32_bf16 v[200:203], v[16:19], v[112:115], 0
s_nop 2
v_mfma_f32_16x16x32_bf16 v[200:203], v[20:23], v[116:119], v[200:203]
s_nop 0
v_max3_f32 v254, v254, v187, v188
v_max3_f32 v254, v254, v189, v190
v_mfma_f32_16x16x32_bf16 v[212:215], v[28:31], v[116:119], 0
s_nop 2
v_mfma_f32_16x16x32_bf16 v[212:215], v[24:27], v[112:115], v[212:215]
v_max3_f32 v254, v254, v191, v200
v_max3_f32 v254, v254, v201, v202
v_mfma_f32_16x16x32_bf16 v[216:219], v[32:35], v[112:115], 0
s_nop 2
v_mfma_f32_16x16x32_bf16 v[216:219], v[36:39], v[116:119], v[216:219]
s_nop 0
v_max3_f32 v254, v254, v203, v212
v_max3_f32 v254, v254, v213, v214
v_mfma_f32_16x16x32_bf16 v[220:223], v[44:47], v[116:119], 0
s_nop 2
v_mfma_f32_16x16x32_bf16 v[220:223], v[40:43], v[112:115], v[220:223]
v_max3_f32 v254, v254, v215, v216
v_max3_f32 v254, v254, v217, v218
v_mfma_f32_16x16x32_bf16 v[224:227], v[48:51], v[112:115], 0
s_nop 2
v_mfma_f32_16x16x32_bf16 v[224:227], v[52:55], v[116:119], v[224:227]
s_nop 0
v_max3_f32 v254, v254, v219, v220
v_max3_f32 v254, v254, v221, v222
v_mfma_f32_16x16x32_bf16 v[228:231], v[208:211], a[128:131], 0
s_nop 2
v_mfma_f32_16x16x32_bf16 v[228:231], v[204:207], a[132:135], v[228:231]
v_max3_f32 v254, v254, v223, v224
v_mfma_f32_16x16x32_bf16 v[228:231], v[196:199], a[136:139], v[228:231]
ds_swizzle_b32 v255, v254 offset:0x401F
v_mfma_f32_16x16x32_bf16 v[228:231], v[192:195], a[140:143], v[228:231]
s_add_u32 m0, s49, 19008
s_add_u32 s48, s48, s51
buffer_load_dwordx4 v237, s[16:19], s48 offen nt lds
v_mfma_f32_16x16x32_bf16 v[232:235], v[192:195], a[156:159], 0
s_nop 2
v_mfma_f32_16x16x32_bf16 v[232:235], v[196:199], a[152:155], v[232:235]
v_cvt_pk_bf16_f32 v91, v230, v231
v_cvt_pk_bf16_f32 v90, v228, v229
v_mfma_f32_16x16x32_bf16 v[232:235], v[204:207], a[148:151], v[232:235]
v_mfma_f32_16x16x32_bf16 v[232:235], v[208:211], a[144:147], v[232:235]
s_nop 2
v_mfma_f32_16x16x32_bf16 v[228:231], v[208:211], a[160:163], 0
s_waitcnt lgkmcnt(0)
v_max_f32 v254, v254, v255
s_nop 0
v_mfma_f32_16x16x32_bf16 v[228:231], v[204:207], a[164:167], v[228:231]
ds_bpermute_b32 v255, v247, v254
v_mfma_f32_16x16x32_bf16 v[228:231], v[196:199], a[168:171], v[228:231]
v_cvt_pk_bf16_f32 v95, v234, v235
v_cvt_pk_bf16_f32 v94, v232, v233
v_mfma_f32_16x16x32_bf16 v[228:231], v[192:195], a[172:175], v[228:231]
s_nop 2
v_mfma_f32_16x16x32_bf16 v[232:235], v[192:195], a[188:191], 0
ds_read_b128 v[192:195], v236 offset:4224
s_nop 0
v_mfma_f32_16x16x32_bf16 v[232:235], v[204:207], a[180:183], v[232:235]
ds_read_b128 v[204:207], v236 offset:4480
v_cvt_pk_bf16_f32 v99, v230, v231
v_mfma_f32_16x16x32_bf16 v[232:235], v[208:211], a[176:179], v[232:235]
ds_read_b128 v[208:211], v236 offset:4736
v_cvt_pk_bf16_f32 v98, v228, v229
v_mfma_f32_16x16x32_bf16 v[232:235], v[196:199], a[184:187], v[232:235]
s_waitcnt lgkmcnt(3)
ds_read_b128 v[196:199], v236 offset:4992
v_max_f32 v254, v254, v255
v_sub_f32 v184, v184, v254
v_sub_f32 v185, v185, v254
v_exp_f32 v184, v184
v_exp_f32 v185, v185
v_sub_f32 v187, v187, v254
v_cvt_pk_bf16_f32 v103, v234, v235
v_cvt_pk_bf16_f32 v102, v232, v233
v_add_f32 v248, v184, v185
v_sub_f32 v186, v186, v254
v_exp_f32 v186, v186
v_cvt_pk_bf16_f32 v120, v184, v185
v_add_f32 v248, v248, v186
s_waitcnt lgkmcnt(1)
v_mfma_f32_16x16x32_bf16 v[228:231], v[208:211], a[184:187], 0
v_sub_f32 v188, v188, v254
s_waitcnt lgkmcnt(0)
v_mfma_f32_16x16x32_bf16 v[228:231], v[196:199], a[188:191], v[228:231]
v_exp_f32 v187, v187
v_mfma_f32_16x16x32_bf16 v[228:231], v[204:207], a[180:183], v[228:231]
v_cvt_pk_bf16_f32 v121, v186, v187
v_add_f32 v248, v248, v187
v_mfma_f32_16x16x32_bf16 v[228:231], v[192:195], a[176:179], v[228:231]
v_sub_f32 v189, v189, v254
v_sub_f32 v190, v190, v254
v_mfma_f32_16x16x32_bf16 v[232:235], v[192:195], a[160:163], 0
v_exp_f32 v189, v189
v_mfma_f32_16x16x32_bf16 v[232:235], v[204:207], a[164:167], v[232:235]
v_exp_f32 v190, v190
v_mfma_f32_16x16x32_bf16 v[232:235], v[208:211], a[168:171], v[232:235]
s_nop 0
v_cvt_pk_bf16_f32 v71, v230, v231
v_cvt_pk_bf16_f32 v70, v228, v229
v_mfma_f32_16x16x32_bf16 v[232:235], v[196:199], a[172:175], v[232:235]
s_add_u32 s48, s48, s51
v_exp_f32 v188, v188
v_mfma_f32_16x16x32_bf16 v[228:231], v[196:199], a[156:159], 0
s_add_u32 m0, s49, 21120
v_add_f32 v248, v248, v188
v_sub_f32 v191, v191, v254
v_mfma_f32_16x16x32_bf16 v[228:231], v[208:211], a[152:155], v[228:231]
buffer_load_dwordx4 v237, s[16:19], s48 offen nt lds
v_cvt_pk_bf16_f32 v66, v232, v233
v_mfma_f32_16x16x32_bf16 v[228:231], v[204:207], a[148:151], v[228:231]
v_cvt_pk_bf16_f32 v67, v234, v235
v_add_f32 v248, v248, v189
v_mfma_f32_16x16x32_bf16 v[228:231], v[192:195], a[144:147], v[228:231]
v_exp_f32 v191, v191
v_mfma_f32_16x16x32_bf16 v[232:235], v[192:195], a[128:131], 0
ds_read_b128 v[192:195], v236 offset:0
v_cvt_pk_bf16_f32 v122, v188, v189
v_mfma_f32_16x16x32_bf16 v[232:235], v[208:211], a[136:139], v[232:235]
ds_read_b128 v[208:211], v236 offset:256
v_add_f32 v248, v248, v190
v_mfma_f32_16x16x32_bf16 v[232:235], v[196:199], a[140:143], v[232:235]
ds_read_b128 v[196:199], v236 offset:512
v_cvt_pk_bf16_f32 v62, v228, v229
v_mfma_f32_16x16x32_bf16 v[232:235], v[204:207], a[132:135], v[232:235]
ds_read_b128 v[204:207], v236 offset:768
v_cvt_pk_bf16_f32 v63, v230, v231
v_add_f32 v248, v248, v191
v_cvt_pk_bf16_f32 v123, v190, v191
v_sub_f32 v200, v200, v254
v_exp_f32 v200, v200
v_sub_f32 v201, v201, v254
v_exp_f32 v201, v201
v_cvt_pk_bf16_f32 v59, v234, v235
v_cvt_pk_bf16_f32 v58, v232, v233
v_sub_f32 v203, v203, v254
s_waitcnt lgkmcnt(2)
v_mfma_f32_16x16x32_bf16 v[228:231], v[208:211], a[132:135], 0
ds_read_b128 v[188:191], v242 offset:64
v_sub_f32 v202, v202, v254
v_mfma_f32_16x16x32_bf16 v[228:231], v[192:195], a[128:131], v[228:231]
s_waitcnt lgkmcnt(2)
v_exp_f32 v203, v203
v_mfma_f32_16x16x32_bf16 v[228:231], v[196:199], a[136:139], v[228:231]
s_waitcnt lgkmcnt(1)
v_exp_f32 v202, v202
v_mfma_f32_16x16x32_bf16 v[228:231], v[204:207], a[140:143], v[228:231]
v_add_f32 v248, v248, v200
v_add_f32 v248, v248, v201
v_mfma_f32_16x16x32_bf16 v[184:187], v[204:207], a[156:159], 0
v_add_f32 v248, v248, v202
v_add_f32 v248, v248, v203
v_mfma_f32_16x16x32_bf16 v[184:187], v[196:199], a[152:155], v[184:187]
v_cvt_pk_bf16_f32 v124, v200, v201
v_cvt_pk_bf16_f32 v125, v202, v203
v_mfma_f32_16x16x32_bf16 v[184:187], v[208:211], a[148:151], v[184:187]
s_waitcnt lgkmcnt(0)
v_cvt_pk_bf16_f32 v56, v228, v229
v_cvt_pk_bf16_f32 v57, v230, v231
v_mfma_f32_16x16x32_bf16 v[184:187], v[192:195], a[144:147], v[184:187]
v_sub_f32 v212, v212, v254
v_sub_f32 v213, v213, v254
v_mfma_f32_16x16x32_bf16 v[228:231], v[192:195], a[160:163], 0
v_exp_f32 v212, v212
v_mfma_f32_16x16x32_bf16 v[228:231], v[208:211], a[164:167], v[228:231]
v_sub_f32 v214, v214, v254
v_add_f32 v248, v248, v212
v_mfma_f32_16x16x32_bf16 v[228:231], v[196:199], a[168:171], v[228:231]
v_cvt_pk_bf16_f32 v60, v184, v185
v_cvt_pk_bf16_f32 v61, v186, v187
v_mfma_f32_16x16x32_bf16 v[228:231], v[204:207], a[172:175], v[228:231]
s_add_u32 m0, s49, 23232
ds_read_b128 v[184:187], v242 offset:0
v_sub_f32 v215, v215, v254
v_mfma_f32_16x16x32_bf16 v[232:235], v[204:207], a[188:191], 0
s_add_u32 s48, s48, s51
buffer_load_dwordx4 v237, s[16:19], s48 offen nt lds
v_sub_f32 v216, v216, v254
v_mfma_f32_16x16x32_bf16 v[232:235], v[196:199], a[184:187], v[232:235]
s_sub_u32 s49, s49, s56
v_exp_f32 v213, v213
v_mfma_f32_16x16x32_bf16 v[232:235], v[208:211], a[180:183], v[232:235]
s_and_b32 s51, s57, 26212352
v_exp_f32 v214, v214
v_mfma_f32_16x16x32_bf16 v[232:235], v[192:195], a[176:179], v[232:235]
s_add_u32 s51, s51, 2048
v_cvt_pk_bf16_f32 v126, v212, v213
v_add_f32 v248, v248, v213
v_mfma_f32_16x16x32_bf16 v[200:203], v[4:7], v[188:191], 0
v_add_f32 v248, v248, v214
s_waitcnt lgkmcnt(0)
v_mfma_f32_16x16x32_bf16 v[200:203], v[0:3], v[184:187], v[200:203]
s_nop 0
v_cvt_pk_bf16_f32 v69, v234, v235
v_cvt_pk_bf16_f32 v68, v232, v233
v_mfma_f32_16x16x32_bf16 v[232:235], v[32:35], v[184:187], 0
ds_read_b128 v[184:187], v245 offset:64
v_sub_f32 v218, v218, v254
v_mfma_f32_16x16x32_bf16 v[232:235], v[36:39], v[188:191], v[232:235]
ds_read_b128 v[188:191], v243 offset:0
v_exp_f32 v215, v215
s_nop 0
v_add_f32 v248, v248, v215
v_cvt_pk_bf16_f32 v127, v214, v215
ds_read_b128 v[212:215], v243 offset:64
v_exp_f32 v216, v216
v_sub_f32 v217, v217, v254
v_add_f32 v248, v248, v216
v_exp_f32 v218, v218
v_sub_f32 v219, v219, v254
v_exp_f32 v217, v217
v_exp_f32 v219, v219
v_cvt_pk_bf16_f32 v128, v216, v217
v_cvt_pk_bf16_f32 v129, v218, v219
v_add_f32 v248, v248, v217
v_add_f32 v248, v248, v218
v_add_f32 v248, v248, v219
v_cvt_pk_bf16_f32 v64, v228, v229
v_cvt_pk_bf16_f32 v65, v230, v231
v_sub_f32 v220, v220, v254
v_sub_f32 v221, v221, v254
s_waitcnt lgkmcnt(0)
v_mfma_f32_16x16x32_bf16 v[200:203], v[12:15], v[212:215], v[200:203]
ds_read_b128 v[216:219], v244 offset:0
ds_read_b128 v[228:231], v245 offset:0
v_mfma_f32_16x16x32_bf16 v[200:203], v[8:11], v[188:191], v[200:203]
v_exp_f32 v220, v220
v_mfma_f32_16x16x32_bf16 v[232:235], v[40:43], v[188:191], v[232:235]
ds_read_b128 v[188:191], v244 offset:64
v_add_f32 v248, v248, v220
v_mfma_f32_16x16x32_bf16 v[232:235], v[44:47], v[212:215], v[232:235]
v_exp_f32 v221, v221
v_sub_f32 v223, v223, v254
v_add_f32 v248, v248, v221
v_exp_f32 v223, v223
v_sub_f32 v222, v222, v254
v_exp_f32 v222, v222
v_cvt_pk_bf16_f32 v130, v220, v221
v_mov_b32 v221, 0xff800000
v_add_f32 v248, v248, v222
v_cvt_pk_bf16_f32 v131, v222, v223
v_add_f32 v248, v248, v223
v_sub_f32 v224, v224, v254
v_exp_f32 v224, v224
s_waitcnt lgkmcnt(0)
v_mfma_f32_16x16x32_bf16 v[200:203], v[20:23], v[188:191], v[200:203]
v_cvt_pk_bf16_f32 v132, v224, 0
v_add_f32 v248, v248, v224
v_mfma_f32_16x16x32_bf16 v[200:203], v[16:19], v[216:219], v[200:203]
ds_swizzle_b32 v250, v248 offset:0x401F
v_add_u32 v245, 0x200, v245
v_mfma_f32_16x16x32_bf16 v[232:235], v[48:51], v[216:219], v[232:235]
v_add_u32 v244, 0x200, v244
v_add_u32 v243, 0x200, v243
v_mfma_f32_16x16x32_bf16 v[232:235], v[52:55], v[188:191], v[232:235]
v_add_u32 v242, 0x200, v242
s_nop 0
v_mfma_f32_16x16x32_bf16 v[200:203], v[24:27], v[228:231], v[200:203]
s_nop 2
v_mfma_f32_16x16x32_bf16 v[200:203], v[28:31], v[184:187], v[200:203]
s_nop 0
v_mov_b32_dpp v233, v221 quad_perm:[0,1,2,3] row_mask:0xf bank_mask:0xc
v_mov_b32_dpp v232, v221 quad_perm:[0,1,2,3] row_mask:0xf bank_mask:0x8
v_mfma_f32_16x16x32_bf16 v[184:187], a[0:3], v[192:195], 0
v_mov_b32_dpp v234, v221 quad_perm:[0,1,2,3] row_mask:0xf bank_mask:0xc
v_mov_b32_dpp v235, v221 quad_perm:[0,1,2,3] row_mask:0xf bank_mask:0xc
v_mfma_f32_16x16x32_bf16 v[184:187], a[4:7], v[208:211], v[184:187]
s_waitcnt lgkmcnt(0)
v_max3_f32 v223, v200, v201, v202
v_max3_f32 v223, v223, v203, v232
v_mfma_f32_16x16x32_bf16 v[184:187], a[8:11], v[196:199], v[184:187]
v_max3_f32 v223, v223, v233, v234
v_max_f32 v223, v223, v235
v_mfma_f32_16x16x32_bf16 v[184:187], a[12:15], v[204:207], v[184:187]
s_nop 0
v_max_f32_dpp v223, v223, v223 row_ror:8 row_mask:0xf bank_mask:0xf
v_add_f32 v248, v248, v250
v_mfma_f32_16x16x32_bf16 v[188:191], a[28:31], v[204:207], 0
ds_bpermute_b32 v250, v247, v248
v_mfma_f32_16x16x32_bf16 v[188:191], a[24:27], v[196:199], v[188:191]
v_max_f32_dpp v223, v223, v223 row_ror:4 row_mask:0xf bank_mask:0xf
v_mfma_f32_16x16x32_bf16 v[188:191], a[20:23], v[208:211], v[188:191]
ds_swizzle_b32 v221, v223 offset:0x401F
v_cvt_pk_bf16_f32 v113, v186, v187
v_mfma_f32_16x16x32_bf16 v[188:191], a[16:19], v[192:195], v[188:191]
v_cvt_pk_bf16_f32 v112, v184, v185
s_nop 0
v_mfma_f32_16x16x32_bf16 v[184:187], a[32:35], v[192:195], 0
s_nop 2
v_mfma_f32_16x16x32_bf16 v[184:187], a[36:39], v[208:211], v[184:187]
s_nop 0
v_cvt_pk_bf16_f32 v115, v190, v191
v_cvt_pk_bf16_f32 v114, v188, v189
v_mfma_f32_16x16x32_bf16 v[184:187], a[40:43], v[196:199], v[184:187]
s_waitcnt lgkmcnt(1)
v_add_f32 v248, v248, v250
v_mfma_f32_16x16x32_bf16 v[184:187], a[44:47], v[204:207], v[184:187]
v_rcp_f32 v251, v248
v_mfma_f32_16x16x32_bf16 v[188:191], a[60:63], v[204:207], 0
s_waitcnt lgkmcnt(0)
v_max_f32 v223, v223, v221
s_nop 0
v_mfma_f32_16x16x32_bf16 v[188:191], a[56:59], v[196:199], v[188:191]
ds_bpermute_b32 v221, v247, v223
v_mfma_f32_16x16x32_bf16 v[188:191], a[52:55], v[208:211], v[188:191]
v_cvt_pk_bf16_f32 v117, v186, v187
v_cvt_pk_bf16_f32 v116, v184, v185
v_mfma_f32_16x16x32_bf16 v[188:191], a[48:51], v[192:195], v[188:191]
s_nop 2
v_mfma_f32_16x16x32_bf16 v[168:171], a[192:195], v[192:195], 0
s_nop 2
v_mfma_f32_16x16x32_bf16 v[168:171], a[196:199], v[208:211], v[168:171]
v_cvt_pk_bf16_f32 v119, v190, v191
v_cvt_pk_bf16_f32 v118, v188, v189
v_mfma_f32_16x16x32_bf16 v[168:171], a[200:203], v[196:199], v[168:171]
v_mfma_f32_16x16x32_bf16 v[168:171], a[204:207], v[204:207], v[168:171]
s_waitcnt lgkmcnt(0)
v_max_f32 v223, v223, v221
v_sub_f32 v200, v200, v223
v_mfma_f32_16x16x32_bf16 v[172:175], a[220:223], v[204:207], 0
v_exp_f32 v200, v200
v_mfma_f32_16x16x32_bf16 v[172:175], a[216:219], v[196:199], v[172:175]
v_sub_f32 v201, v201, v223
v_sub_f32 v202, v202, v223
v_mfma_f32_16x16x32_bf16 v[172:175], a[212:215], v[208:211], v[172:175]
v_exp_f32 v202, v202
v_mfma_f32_16x16x32_bf16 v[172:175], a[208:211], v[192:195], v[172:175]
v_exp_f32 v201, v201
v_mfma_f32_16x16x32_bf16 v[176:179], a[224:227], v[192:195], 0
v_add_f32 v220, v200, v201
v_add_f32 v220, v220, v202
v_mfma_f32_16x16x32_bf16 v[176:179], a[228:231], v[208:211], v[176:179]
v_sub_f32 v203, v203, v223
v_sub_f32 v233, v233, v223
v_mfma_f32_16x16x32_bf16 v[176:179], a[232:235], v[196:199], v[176:179]
v_exp_f32 v233, v233
v_mfma_f32_16x16x32_bf16 v[176:179], a[236:239], v[204:207], v[176:179]
v_exp_f32 v203, v203
v_mfma_f32_16x16x32_bf16 v[180:183], a[252:255], v[204:207], 0
v_sub_f32 v232, v232, v223
v_sub_f32 v234, v234, v223
v_mfma_f32_16x16x32_bf16 v[180:183], a[248:251], v[196:199], v[180:183]
v_exp_f32 v232, v232
v_mfma_f32_16x16x32_bf16 v[180:183], a[244:247], v[208:211], v[180:183]
v_exp_f32 v234, v234
v_mfma_f32_16x16x32_bf16 v[180:183], a[240:243], v[192:195], v[180:183]
v_add_f32 v220, v220, v203
v_add_f32 v220, v220, v232
v_mfma_f32_16x16x32_bf16 v[184:187], v[0:3], v[112:115], 0
v_add_f32 v220, v220, v233
v_add_f32 v220, v220, v234
v_mfma_f32_16x16x32_bf16 v[184:187], v[4:7], v[116:119], v[184:187]
v_sub_f32 v235, v235, v223
v_cvt_pk_bf16_f32 v200, v200, v201
v_mfma_f32_16x16x32_bf16 v[188:191], v[12:15], v[116:119], 0
v_exp_f32 v235, v235
v_mfma_f32_16x16x32_bf16 v[188:191], v[8:11], v[112:115], v[188:191]
v_add_f32 v220, v220, v235
v_cvt_pk_bf16_f32 v201, v202, v203
v_mfma_f32_16x16x32_bf16 v[192:195], v[16:19], v[112:115], 0
v_cvt_pk_bf16_f32 v202, v232, v233
v_cvt_pk_bf16_f32 v203, v234, v235
v_mfma_f32_16x16x32_bf16 v[192:195], v[20:23], v[116:119], v[192:195]
ds_read_b128 v[196:199], v236 offset:8448
v_add_f32_dpp v220, v220, v220 row_ror:8 row_mask:0xf bank_mask:0xf
v_mfma_f32_16x16x32_bf16 v[208:211], v[28:31], v[116:119], 0
ds_read_b128 v[204:207], v236 offset:8704
v_add_f32_dpp v220, v220, v220 row_ror:4 row_mask:0xf bank_mask:0xf
v_mfma_f32_16x16x32_bf16 v[208:211], v[24:27], v[112:115], v[208:211]
ds_write_b32 v246, v220 offset:4096
ds_read_b128 v[212:215], v236 offset:8960
v_mfma_f32_16x16x32_bf16 v[216:219], v[32:35], v[112:115], 0
ds_read_b128 v[224:227], v236 offset:9216
v_max3_f32 v254, v184, v185, v186
v_mfma_f32_16x16x32_bf16 v[216:219], v[36:39], v[116:119], v[216:219]
v_max3_f32 v254, v254, v187, v188
v_max3_f32 v254, v254, v189, v190
v_mfma_f32_16x16x32_bf16 v[228:231], v[44:47], v[116:119], 0
v_max3_f32 v254, v254, v191, v192
v_max3_f32 v254, v254, v193, v194
v_mfma_f32_16x16x32_bf16 v[228:231], v[40:43], v[112:115], v[228:231]
s_waitcnt lgkmcnt(4)
v_max3_f32 v254, v254, v195, v208
v_max3_f32 v254, v254, v209, v210
v_mfma_f32_16x16x32_bf16 v[232:235], v[48:51], v[112:115], 0
s_waitcnt lgkmcnt(3)
v_max3_f32 v254, v254, v211, v216
v_max3_f32 v254, v254, v217, v218
v_mfma_f32_16x16x32_bf16 v[232:235], v[52:55], v[116:119], v[232:235]
s_waitcnt lgkmcnt(1)
v_max3_f32 v254, v254, v219, v228
v_max3_f32 v254, v254, v229, v230
v_mfma_f32_16x16x32_bf16 v[220:223], v[196:199], a[128:131], 0
s_waitcnt lgkmcnt(0)
s_nop 1
v_mfma_f32_16x16x32_bf16 v[220:223], v[204:207], a[132:135], v[220:223]
v_max3_f32 v254, v254, v231, v232
v_mfma_f32_16x16x32_bf16 v[220:223], v[212:215], a[136:139], v[220:223]
ds_swizzle_b32 v255, v254 offset:0x401F
v_mfma_f32_16x16x32_bf16 v[220:223], v[224:227], a[140:143], v[220:223]
s_nop 7
v_cvt_pk_bf16_f32 v73, v222, v223
v_cvt_pk_bf16_f32 v72, v220, v221
v_mfma_f32_16x16x32_bf16 v[220:223], v[224:227], a[156:159], 0
v_mfma_f32_16x16x32_bf16 v[220:223], v[212:215], a[152:155], v[220:223]
v_mfma_f32_16x16x32_bf16 v[220:223], v[204:207], a[148:151], v[220:223]
s_waitcnt lgkmcnt(0)
v_max_f32 v254, v254, v255
v_mfma_f32_16x16x32_bf16 v[220:223], v[196:199], a[144:147], v[220:223]
ds_bpermute_b32 v255, v247, v254
s_nop 6
v_cvt_pk_bf16_f32 v76, v220, v221
v_cvt_pk_bf16_f32 v77, v222, v223
v_mfma_f32_16x16x32_bf16 v[220:223], v[196:199], a[160:163], 0
v_mfma_f32_16x16x32_bf16 v[220:223], v[204:207], a[164:167], v[220:223]
v_mfma_f32_16x16x32_bf16 v[220:223], v[212:215], a[168:171], v[220:223]
s_waitcnt lgkmcnt(0)
v_max_f32 v254, v254, v255
v_mfma_f32_16x16x32_bf16 v[220:223], v[224:227], a[172:175], v[220:223]
v_sub_f32 v184, v184, v254
v_exp_f32 v184, v184
v_sub_f32 v185, v185, v254
v_sub_f32 v187, v187, v254
v_exp_f32 v185, v185
s_nop 2
v_cvt_pk_bf16_f32 v81, v222, v223
v_cvt_pk_bf16_f32 v80, v220, v221
v_mfma_f32_16x16x32_bf16 v[220:223], v[224:227], a[188:191], 0
ds_read_b128 v[224:227], v236 offset:12672
v_add_f32 v249, v184, v185
v_mfma_f32_16x16x32_bf16 v[220:223], v[204:207], a[180:183], v[220:223]
ds_read_b128 v[204:207], v236 offset:12928
v_sub_f32 v186, v186, v254
v_mfma_f32_16x16x32_bf16 v[220:223], v[196:199], a[176:179], v[220:223]
ds_read_b128 v[196:199], v236 offset:13184
v_cvt_pk_bf16_f32 v136, v184, v185
v_mfma_f32_16x16x32_bf16 v[220:223], v[212:215], a[184:187], v[220:223]
ds_read_b128 v[212:215], v236 offset:13440
v_exp_f32 v186, v186
v_exp_f32 v187, v187
v_add_f32 v249, v249, v186
v_add_f32 v249, v249, v187
v_cvt_pk_bf16_f32 v137, v186, v187
v_sub_f32 v189, v189, v254
v_sub_f32 v188, v188, v254
v_cvt_pk_bf16_f32 v84, v220, v221
v_cvt_pk_bf16_f32 v85, v222, v223
v_exp_f32 v188, v188
v_exp_f32 v189, v189
v_sub_f32 v191, v191, v254
s_waitcnt lgkmcnt(1)
v_mfma_f32_16x16x32_bf16 v[184:187], v[196:199], a[184:187], 0
v_sub_f32 v190, v190, v254
s_waitcnt lgkmcnt(0)
v_mfma_f32_16x16x32_bf16 v[184:187], v[212:215], a[188:191], v[184:187]
v_exp_f32 v190, v190
v_mfma_f32_16x16x32_bf16 v[184:187], v[204:207], a[180:183], v[184:187]
v_exp_f32 v191, v191
v_mfma_f32_16x16x32_bf16 v[184:187], v[224:227], a[176:179], v[184:187]
v_add_f32 v249, v249, v188
v_add_f32 v249, v249, v189
v_mfma_f32_16x16x32_bf16 v[220:223], v[224:227], a[160:163], 0
v_add_f32 v249, v249, v190
v_cvt_pk_bf16_f32 v139, v190, v191
v_mfma_f32_16x16x32_bf16 v[220:223], v[204:207], a[164:167], v[220:223]
v_cvt_pk_bf16_f32 v138, v188, v189
v_add_f32 v249, v249, v191
v_mfma_f32_16x16x32_bf16 v[220:223], v[196:199], a[168:171], v[220:223]
v_cvt_pk_bf16_f32 v86, v184, v185
v_cvt_pk_bf16_f32 v87, v186, v187
v_mfma_f32_16x16x32_bf16 v[220:223], v[212:215], a[172:175], v[220:223]
v_sub_f32 v192, v192, v254
v_sub_f32 v194, v194, v254
v_mfma_f32_16x16x32_bf16 v[184:187], v[212:215], a[156:159], 0
v_exp_f32 v192, v192
v_mfma_f32_16x16x32_bf16 v[184:187], v[196:199], a[152:155], v[184:187]
v_add_f32 v249, v249, v192
v_sub_f32 v193, v193, v254
v_mfma_f32_16x16x32_bf16 v[184:187], v[204:207], a[148:151], v[184:187]
v_cvt_pk_bf16_f32 v83, v222, v223
v_cvt_pk_bf16_f32 v82, v220, v221
v_mfma_f32_16x16x32_bf16 v[184:187], v[224:227], a[144:147], v[184:187]
v_exp_f32 v193, v193
v_mfma_f32_16x16x32_bf16 v[220:223], v[224:227], a[128:131], 0
ds_read_b128 v[224:227], v236 offset:16896
v_sub_f32 v209, v209, v254
v_mfma_f32_16x16x32_bf16 v[220:223], v[196:199], a[136:139], v[220:223]
ds_read_b128 v[196:199], v236 offset:17152
v_sub_f32 v208, v208, v254
v_mfma_f32_16x16x32_bf16 v[220:223], v[212:215], a[140:143], v[220:223]
ds_read_b128 v[212:215], v236 offset:17408
v_cvt_pk_bf16_f32 v79, v186, v187
v_mfma_f32_16x16x32_bf16 v[220:223], v[204:207], a[132:135], v[220:223]
ds_read_b128 v[204:207], v236 offset:17664
v_cvt_pk_bf16_f32 v78, v184, v185
v_exp_f32 v208, v208
v_exp_f32 v209, v209
v_exp_f32 v194, v194
v_add_f32 v249, v249, v193
v_add_f32 v249, v249, v194
v_sub_f32 v195, v195, v254
v_cvt_pk_bf16_f32 v74, v220, v221
v_cvt_pk_bf16_f32 v75, v222, v223
s_waitcnt lgkmcnt(2)
v_mfma_f32_16x16x32_bf16 v[184:187], v[196:199], a[132:135], 0
v_exp_f32 v195, v195
v_mfma_f32_16x16x32_bf16 v[184:187], v[224:227], a[128:131], v[184:187]
s_waitcnt lgkmcnt(1)
v_sub_f32 v216, v216, v254
v_sub_f32 v211, v211, v254
v_mfma_f32_16x16x32_bf16 v[184:187], v[212:215], a[136:139], v[184:187]
s_waitcnt lgkmcnt(0)
v_sub_f32 v210, v210, v254
v_add_f32 v249, v249, v195
v_mfma_f32_16x16x32_bf16 v[184:187], v[204:207], a[140:143], v[184:187]
v_exp_f32 v211, v211
v_mfma_f32_16x16x32_bf16 v[220:223], v[204:207], a[156:159], 0
v_exp_f32 v210, v210
v_mfma_f32_16x16x32_bf16 v[220:223], v[212:215], a[152:155], v[220:223]
v_add_f32 v249, v249, v208
v_sub_f32 v219, v219, v254
v_mfma_f32_16x16x32_bf16 v[220:223], v[196:199], a[148:151], v[220:223]
s_nop 0
v_cvt_pk_bf16_f32 v89, v186, v187
v_cvt_pk_bf16_f32 v88, v184, v185
v_mfma_f32_16x16x32_bf16 v[220:223], v[224:227], a[144:147], v[220:223]
v_exp_f32 v216, v216
v_mfma_f32_16x16x32_bf16 v[184:187], v[224:227], a[160:163], 0
v_sub_f32 v217, v217, v254
v_add_f32 v249, v249, v209
v_mfma_f32_16x16x32_bf16 v[184:187], v[196:199], a[164:167], v[184:187]
v_sub_f32 v228, v228, v254
v_add_f32 v249, v249, v210
v_mfma_f32_16x16x32_bf16 v[184:187], v[212:215], a[168:171], v[184:187]
v_exp_f32 v217, v217
v_mfma_f32_16x16x32_bf16 v[184:187], v[204:207], a[172:175], v[184:187]
v_sub_f32 v229, v229, v254
v_sub_f32 v218, v218, v254
v_mfma_f32_16x16x32_bf16 v[188:191], v[204:207], a[188:191], 0
v_exp_f32 v218, v218
v_mfma_f32_16x16x32_bf16 v[188:191], v[212:215], a[184:187], v[188:191]
v_add_f32 v249, v249, v211
v_add_f32 v249, v249, v216
v_mfma_f32_16x16x32_bf16 v[188:191], v[196:199], a[180:183], v[188:191]
v_cvt_pk_bf16_f32 v96, v184, v185
v_cvt_pk_bf16_f32 v97, v186, v187
v_mfma_f32_16x16x32_bf16 v[188:191], v[224:227], a[176:179], v[188:191]
v_exp_f32 v219, v219
v_mfma_f32_16x16x32_bf16 v[184:187], a[0:3], v[224:227], 0
v_add_f32 v249, v249, v217
v_add_f32 v249, v249, v218
v_mfma_f32_16x16x32_bf16 v[184:187], a[4:7], v[196:199], v[184:187]
v_add_f32 v249, v249, v219
v_cvt_pk_bf16_f32 v144, v216, v217
v_mfma_f32_16x16x32_bf16 v[184:187], a[8:11], v[212:215], v[184:187]
v_cvt_pk_bf16_f32 v100, v188, v189
v_cvt_pk_bf16_f32 v101, v190, v191
v_mfma_f32_16x16x32_bf16 v[184:187], a[12:15], v[204:207], v[184:187]
v_cvt_pk_bf16_f32 v145, v218, v219
v_cvt_pk_bf16_f32 v92, v220, v221
v_mfma_f32_16x16x32_bf16 v[188:191], a[28:31], v[204:207], 0
v_cvt_pk_bf16_f32 v93, v222, v223
v_sub_f32 v232, v232, v254
v_mfma_f32_16x16x32_bf16 v[188:191], a[24:27], v[212:215], v[188:191]
v_exp_f32 v228, v228
v_mfma_f32_16x16x32_bf16 v[188:191], a[20:23], v[196:199], v[188:191]
v_cvt_pk_bf16_f32 v112, v184, v185
v_cvt_pk_bf16_f32 v113, v186, v187
v_mfma_f32_16x16x32_bf16 v[188:191], a[16:19], v[224:227], v[188:191]
v_exp_f32 v229, v229
v_mfma_f32_16x16x32_bf16 v[184:187], a[32:35], v[224:227], 0
v_add_f32 v249, v249, v228
v_sub_f32 v231, v231, v254
v_mfma_f32_16x16x32_bf16 v[184:187], a[36:39], v[196:199], v[184:187]
v_exp_f32 v232, v232
v_mfma_f32_16x16x32_bf16 v[184:187], a[40:43], v[212:215], v[184:187]
s_nop 0
v_cvt_pk_bf16_f32 v115, v190, v191
v_cvt_pk_bf16_f32 v114, v188, v189
v_mfma_f32_16x16x32_bf16 v[184:187], a[44:47], v[204:207], v[184:187]
v_sub_f32 v230, v230, v254
v_add_f32 v249, v249, v229
v_mfma_f32_16x16x32_bf16 v[188:191], a[60:63], v[204:207], 0
v_cvt_pk_bf16_f32 v140, v192, v193
v_mov_b32 v192, v202
v_mfma_f32_16x16x32_bf16 v[188:191], a[56:59], v[212:215], v[188:191]
v_cvt_pk_bf16_f32 v142, v208, v209
v_mov_b32_dpp v209, v201 row_ror:8 row_mask:0xf bank_mask:0xf
v_mfma_f32_16x16x32_bf16 v[188:191], a[52:55], v[196:199], v[188:191]
v_cvt_pk_bf16_f32 v116, v184, v185
v_cvt_pk_bf16_f32 v117, v186, v187
v_mfma_f32_16x16x32_bf16 v[188:191], a[48:51], v[224:227], v[188:191]
v_mov_b32_dpp v208, v200 row_ror:8 row_mask:0xf bank_mask:0xf
v_cvt_pk_bf16_f32 v143, v210, v211
v_mfma_f32_16x16x32_bf16 v[216:219], v[56:59], v[120:123], 0
v_mov_b32_dpp v211, v201 row_ror:4 row_mask:0xf bank_mask:0xf
v_mov_b32_dpp v210, v200 row_ror:4 row_mask:0xf bank_mask:0xf
v_mfma_f32_16x16x32_bf16 v[216:219], v[104:107], v[132:135], v[216:219]
v_cvt_pk_bf16_f32 v141, v194, v195
v_mov_b32_dpp v194, v202 row_ror:12 row_mask:0xf bank_mask:0xf
v_mfma_f32_16x16x32_bf16 v[216:219], v[72:75], v[124:127], v[216:219]
v_cvt_pk_bf16_f32 v118, v188, v189
v_cvt_pk_bf16_f32 v119, v190, v191
v_mfma_f32_16x16x32_bf16 v[216:219], v[88:91], v[128:131], v[216:219]
v_mov_b32_dpp v195, v203 row_ror:12 row_mask:0xf bank_mask:0xf
v_mov_b32 v193, v203
v_mfma_f32_16x16x32_bf16 v[220:223], v[92:95], v[128:131], 0
v_mov_b32_dpp v203, v201 row_ror:12 row_mask:0xf bank_mask:0xf
v_mov_b32_dpp v202, v200 row_ror:12 row_mask:0xf bank_mask:0xf
v_mfma_f32_16x16x32_bf16 v[220:223], v[76:79], v[124:127], v[220:223]
v_exp_f32 v230, v230
v_mfma_f32_16x16x32_bf16 v[220:223], v[106:109], v[132:135], v[220:223]
v_fmac_f32 v154, v218, v251
v_fmac_f32 v152, v216, v251
v_mfma_f32_16x16x32_bf16 v[220:223], v[60:63], v[120:123], v[220:223]
v_fmac_f32 v155, v219, v251
v_fmac_f32 v153, v217, v251
v_mfma_f32_16x16x32_bf16 v[188:191], v[64:67], v[120:123], 0
v_exp_f32 v231, v231
v_mfma_f32_16x16x32_bf16 v[188:191], v[108:111], v[132:135], v[188:191]
v_add_f32 v249, v249, v230
v_add_f32 v249, v249, v231
v_mfma_f32_16x16x32_bf16 v[188:191], v[80:83], v[124:127], v[188:191]
v_cvt_pk_bf16_f32 v146, v228, v229
v_cvt_pk_bf16_f32 v147, v230, v231
v_mfma_f32_16x16x32_bf16 v[188:191], v[96:99], v[128:131], v[188:191]
v_add_f32 v249, v249, v232
v_fmac_f32 v156, v220, v251
v_mfma_f32_16x16x32_bf16 v[184:187], v[100:103], v[128:131], 0
ds_swizzle_b32 v250, v249 offset:0x401F
v_fmac_f32 v158, v222, v251
v_mfma_f32_16x16x32_bf16 v[184:187], v[84:87], v[124:127], v[184:187]
v_fmac_f32 v157, v221, v251
v_fmac_f32 v159, v223, v251
v_mfma_f32_16x16x32_bf16 v[184:187], v[68:71], v[120:123], v[184:187]
v_fmac_f32 v161, v189, v251
v_fmac_f32 v160, v188, v251
v_mfma_f32_16x16x32_bf16 v[184:187], v[110:113], v[132:135], v[184:187]
v_mov_b32_dpp v132, v192 row_ror:8 row_mask:0xf bank_mask:0xf
v_fmac_f32 v163, v191, v251
v_fmac_f32 v162, v190, v251
v_mfma_f32_16x16x32_bf16 v[216:219], v[110:113], v[132:135], 0
v_cvt_pk_bf16_f32 v152, v152, v153
v_cvt_pk_bf16_f32 v153, v154, v155
v_mfma_f32_16x16x32_bf16 v[216:219], v[84:87], v[208:211], v[216:219]
s_nop 0
v_fmac_f32 v167, v187, v251
v_fmac_f32 v164, v184, v251
v_mfma_f32_16x16x32_bf16 v[216:219], v[100:103], v[192:195], v[216:219]
s_waitcnt lgkmcnt(0)
v_fmac_f32 v165, v185, v251
v_fmac_f32 v166, v186, v251
v_mfma_f32_16x16x32_bf16 v[216:219], v[68:71], v[200:203], v[216:219]
v_add_f32 v249, v249, v250
v_pk_max_i16 v153, v153, 0
v_mfma_f32_16x16x32_bf16 v[188:191], v[64:67], v[200:203], 0
ds_bpermute_b32 v250, v247, v249
v_mfma_f32_16x16x32_bf16 v[188:191], v[80:83], v[208:211], v[188:191]
v_cvt_pk_bf16_f32 v160, v160, v161
v_cvt_pk_bf16_f32 v161, v162, v163
v_mfma_f32_16x16x32_bf16 v[188:191], v[96:99], v[192:195], v[188:191]
v_cvt_pk_bf16_f32 v216, v216, v217
v_cvt_pk_bf16_f32 v217, v218, v219
v_mfma_f32_16x16x32_bf16 v[188:191], v[108:111], v[132:135], v[188:191]
ds_write_b64 v246, v[216:217] offset:24
v_mfma_f32_16x16x32_bf16 v[228:231], v[106:109], v[132:135], 0
v_cvt_pk_bf16_f32 v162, v164, v165
v_pk_max_i16 v160, v160, 0
v_mfma_f32_16x16x32_bf16 v[228:231], v[76:79], v[208:211], v[228:231]
v_pk_max_i16 v161, v161, 0
v_cvt_pk_bf16_f32 v163, v166, v167
v_mfma_f32_16x16x32_bf16 v[228:231], v[92:95], v[192:195], v[228:231]
s_waitcnt lgkmcnt(1)
v_cvt_pk_bf16_f32 v188, v188, v189
v_cvt_pk_bf16_f32 v189, v190, v191
v_mfma_f32_16x16x32_bf16 v[228:231], v[60:63], v[200:203], v[228:231]
ds_write_b64 v246, v[188:189] offset:16
v_mfma_f32_16x16x32_bf16 v[184:187], v[56:59], v[200:203], 0
v_pk_max_i16 v163, v163, 0
v_cvt_pk_bf16_f32 v155, v158, v159
v_mfma_f32_16x16x32_bf16 v[184:187], v[72:75], v[208:211], v[184:187]
v_pk_max_i16 v162, v162, 0
v_cvt_pk_bf16_f32 v154, v156, v157
v_mfma_f32_16x16x32_bf16 v[184:187], v[88:91], v[192:195], v[184:187]
v_cvt_pk_bf16_f32 v228, v228, v229
v_cvt_pk_bf16_f32 v229, v230, v231
v_mfma_f32_16x16x32_bf16 v[184:187], v[104:107], v[132:135], v[184:187]
ds_write_b64 v246, v[228:229] offset:8
v_mfma_f32_16x16x32_bf16 v[188:191], v[0:3], v[112:115], 0
v_pk_max_i16 v154, v154, 0
v_pk_max_i16 v152, v152, 0
v_mfma_f32_16x16x32_bf16 v[188:191], v[4:7], v[116:119], v[188:191]
v_pk_max_i16 v155, v155, 0
v_add_f32 v249, v249, v250
v_mfma_f32_16x16x32_bf16 v[192:195], v[12:15], v[116:119], 0
buffer_store_dwordx4 v[152:155], v239, s[20:23], s52 offen offset:0 nt
buffer_store_dwordx4 v[160:163], v239, s[20:23], s52 offen offset:64 nt
v_cvt_pk_bf16_f32 v184, v184, v185
v_cvt_pk_bf16_f32 v185, v186, v187
v_rcp_f32 v252, v249
v_max3_f32 v254, v188, v189, v190
v_cvt_pk_bf16_f32 v148, v232, 0
s_add_u32 s52, s46, 16384
v_mfma_f32_16x16x32_bf16 v[192:195], v[8:11], v[112:115], v[192:195]
ds_write_b64 v246, v[184:185] offset:0
v_mfma_f32_16x16x32_bf16 v[200:203], v[16:19], v[112:115], 0
s_nop 0
v_add_u32 v246, 0x200, v246
s_nop 0
v_mfma_f32_16x16x32_bf16 v[200:203], v[20:23], v[116:119], v[200:203]
s_nop 1
v_max3_f32 v254, v254, v191, v192
v_mfma_f32_16x16x32_bf16 v[184:187], v[28:31], v[116:119], 0
v_max3_f32 v254, v254, v193, v194
s_nop 0
v_mfma_f32_16x16x32_bf16 v[184:187], v[24:27], v[112:115], v[184:187]
s_nop 0
v_max3_f32 v254, v254, v195, v200
v_max3_f32 v254, v254, v201, v202
v_mfma_f32_16x16x32_bf16 v[208:211], v[32:35], v[112:115], 0
s_nop 2
v_mfma_f32_16x16x32_bf16 v[208:211], v[36:39], v[116:119], v[208:211]
v_max3_f32 v254, v254, v203, v184
v_max3_f32 v254, v254, v185, v186
v_mfma_f32_16x16x32_bf16 v[216:219], v[44:47], v[116:119], 0
s_nop 2
v_mfma_f32_16x16x32_bf16 v[216:219], v[40:43], v[112:115], v[216:219]
s_nop 0
v_max3_f32 v254, v254, v187, v208
v_max3_f32 v254, v254, v209, v210
v_mfma_f32_16x16x32_bf16 v[220:223], v[48:51], v[112:115], 0
s_nop 2
v_mfma_f32_16x16x32_bf16 v[220:223], v[52:55], v[116:119], v[220:223]
v_max3_f32 v254, v254, v211, v216
v_max3_f32 v254, v254, v217, v218
v_mfma_f32_16x16x32_bf16 v[152:155], a[192:195], v[224:227], 0
s_nop 2
v_mfma_f32_16x16x32_bf16 v[152:155], a[196:199], v[196:199], v[152:155]
s_nop 0
v_max3_f32 v254, v254, v219, v220
v_mfma_f32_16x16x32_bf16 v[152:155], a[200:203], v[212:215], v[152:155]
ds_swizzle_b32 v255, v254 offset:0x401F
v_mfma_f32_16x16x32_bf16 v[152:155], a[204:207], v[204:207], v[152:155]
v_mfma_f32_16x16x32_bf16 v[156:159], a[220:223], v[204:207], 0
v_mfma_f32_16x16x32_bf16 v[156:159], a[216:219], v[212:215], v[156:159]
v_mfma_f32_16x16x32_bf16 v[156:159], a[212:215], v[196:199], v[156:159]
v_mfma_f32_16x16x32_bf16 v[156:159], a[208:211], v[224:227], v[156:159]
v_mfma_f32_16x16x32_bf16 v[160:163], a[224:227], v[224:227], 0
s_waitcnt lgkmcnt(0)
v_max_f32 v254, v254, v255
v_mfma_f32_16x16x32_bf16 v[160:163], a[228:231], v[196:199], v[160:163]
ds_bpermute_b32 v255, v247, v254
v_mfma_f32_16x16x32_bf16 v[160:163], a[232:235], v[212:215], v[160:163]
v_mfma_f32_16x16x32_bf16 v[160:163], a[236:239], v[204:207], v[160:163]
v_mfma_f32_16x16x32_bf16 v[164:167], a[252:255], v[204:207], 0
v_mfma_f32_16x16x32_bf16 v[164:167], a[248:251], v[212:215], v[164:167]
v_mfma_f32_16x16x32_bf16 v[164:167], a[244:247], v[196:199], v[164:167]
v_mfma_f32_16x16x32_bf16 v[164:167], a[240:243], v[224:227], v[164:167]
s_waitcnt lgkmcnt(0)
v_max_f32 v254, v254, v255
v_sub_f32 v188, v188, v254
v_mfma_f32_16x16x32_bf16 v[196:199], v[56:59], v[136:139], 0
v_sub_f32 v190, v190, v254
v_sub_f32 v189, v189, v254
v_mfma_f32_16x16x32_bf16 v[196:199], v[104:107], v[148:151], v[196:199]
v_exp_f32 v189, v189
v_mfma_f32_16x16x32_bf16 v[196:199], v[72:75], v[140:143], v[196:199]
v_exp_f32 v188, v188
v_mfma_f32_16x16x32_bf16 v[196:199], v[88:91], v[144:147], v[196:199]
v_add_f32 v248, v188, v189
v_sub_f32 v191, v191, v254
v_mfma_f32_16x16x32_bf16 v[204:207], v[92:95], v[144:147], 0
v_exp_f32 v191, v191
v_mfma_f32_16x16x32_bf16 v[204:207], v[76:79], v[140:143], v[204:207]
v_exp_f32 v190, v190
v_mfma_f32_16x16x32_bf16 v[204:207], v[106:109], v[148:151], v[204:207]
v_cvt_pk_bf16_f32 v120, v188, v189
v_add_f32 v248, v248, v190
v_mfma_f32_16x16x32_bf16 v[204:207], v[60:63], v[136:139], v[204:207]
ds_read_b128 v[212:215], v236 offset:4224
v_add_f32 v248, v248, v191
v_mfma_f32_16x16x32_bf16 v[228:231], v[64:67], v[136:139], 0
ds_read_b128 v[224:227], v236 offset:4480
v_cvt_pk_bf16_f32 v121, v190, v191
v_mfma_f32_16x16x32_bf16 v[228:231], v[108:111], v[148:151], v[228:231]
v_fmac_f32 v170, v198, v252
v_fmac_f32 v171, v199, v252
v_mfma_f32_16x16x32_bf16 v[228:231], v[80:83], v[140:143], v[228:231]
v_fmac_f32 v168, v196, v252
v_fmac_f32 v169, v197, v252
v_mfma_f32_16x16x32_bf16 v[228:231], v[96:99], v[144:147], v[228:231]
ds_read_b128 v[196:199], v236 offset:4736
v_fmac_f32 v175, v207, v252
v_mfma_f32_16x16x32_bf16 v[232:235], v[100:103], v[144:147], 0
v_fmac_f32 v172, v204, v252
v_fmac_f32 v174, v206, v252
v_mfma_f32_16x16x32_bf16 v[232:235], v[84:87], v[140:143], v[232:235]
s_waitcnt lgkmcnt(2)
v_fmac_f32 v173, v205, v252
v_fmac_f32 v177, v229, v252
v_mfma_f32_16x16x32_bf16 v[232:235], v[110:113], v[148:151], v[232:235]
s_waitcnt lgkmcnt(1)
ds_read_b128 v[204:207], v236 offset:4992
v_fmac_f32 v176, v228, v252
v_mfma_f32_16x16x32_bf16 v[232:235], v[68:71], v[136:139], v[232:235]
v_fmac_f32 v178, v230, v252
v_fmac_f32 v179, v231, v252
v_mfma_f32_16x16x32_bf16 v[188:191], a[0:3], v[212:215], 0
v_cvt_pk_bf16_f32 v176, v176, v177
v_cvt_pk_bf16_f32 v168, v168, v169
v_mfma_f32_16x16x32_bf16 v[188:191], a[4:7], v[224:227], v[188:191]
s_waitcnt lgkmcnt(1)
v_cvt_pk_bf16_f32 v169, v170, v171
v_fmac_f32 v181, v233, v252
v_mfma_f32_16x16x32_bf16 v[188:191], a[8:11], v[196:199], v[188:191]
v_fmac_f32 v182, v234, v252
v_fmac_f32 v180, v232, v252
v_fmac_f32 v183, v235, v252
v_cvt_pk_bf16_f32 v170, v172, v173
v_pk_max_i16 v170, v170, 0
s_waitcnt lgkmcnt(0)
v_mfma_f32_16x16x32_bf16 v[188:191], a[12:15], v[204:207], v[188:191]
v_cvt_pk_bf16_f32 v171, v174, v175
v_pk_max_i16 v176, v176, 0
v_mfma_f32_16x16x32_bf16 v[232:235], a[28:31], v[204:207], 0
v_pk_max_i16 v171, v171, 0
v_cvt_pk_bf16_f32 v177, v178, v179
v_mfma_f32_16x16x32_bf16 v[232:235], a[24:27], v[196:199], v[232:235]
v_cvt_pk_bf16_f32 v178, v180, v181
v_pk_max_i16 v177, v177, 0
v_mfma_f32_16x16x32_bf16 v[232:235], a[20:23], v[224:227], v[232:235]
v_cvt_pk_bf16_f32 v112, v188, v189
v_cvt_pk_bf16_f32 v113, v190, v191
v_mfma_f32_16x16x32_bf16 v[232:235], a[16:19], v[212:215], v[232:235]
v_pk_max_i16 v168, v168, 0
v_cvt_pk_bf16_f32 v179, v182, v183
v_mfma_f32_16x16x32_bf16 v[188:191], a[32:35], v[212:215], 0
v_pk_max_i16 v179, v179, 0
v_pk_max_i16 v169, v169, 0
v_mfma_f32_16x16x32_bf16 v[188:191], a[36:39], v[224:227], v[188:191]
v_pk_max_i16 v178, v178, 0
v_sub_f32 v192, v192, v254
v_mfma_f32_16x16x32_bf16 v[188:191], a[40:43], v[196:199], v[188:191]
buffer_store_dwordx4 v[168:171], v239, s[20:23], s53 offen offset:0 nt
buffer_store_dwordx4 v[176:179], v239, s[20:23], s53 offen offset:64 nt
v_sub_f32 v193, v193, v254
v_exp_f32 v192, v192
v_exp_f32 v193, v193
v_sub_f32 v195, v195, v254
v_exp_f32 v195, v195
v_mfma_f32_16x16x32_bf16 v[188:191], a[44:47], v[204:207], v[188:191]
s_add_u32 s53, s46, 4096
v_add_f32 v248, v248, v192
v_sub_f32 v194, v194, v254
v_mfma_f32_16x16x32_bf16 v[228:231], a[60:63], v[204:207], 0
s_add_u32 s46, s46, 13107200
v_cvt_pk_bf16_f32 v114, v232, v233
v_cvt_pk_bf16_f32 v115, v234, v235
v_mfma_f32_16x16x32_bf16 v[228:231], a[56:59], v[196:199], v[228:231]
v_cvt_pk_bf16_f32 v117, v190, v191
v_cvt_pk_bf16_f32 v116, v188, v189
v_mfma_f32_16x16x32_bf16 v[228:231], a[52:55], v[224:227], v[228:231]
v_exp_f32 v194, v194
v_mfma_f32_16x16x32_bf16 v[228:231], a[48:51], v[212:215], v[228:231]
v_add_f32 v248, v248, v193
v_add_f32 v248, v248, v194
v_mfma_f32_16x16x32_bf16 v[168:171], a[192:195], v[212:215], 0
v_add_f32 v248, v248, v195
v_cvt_pk_bf16_f32 v122, v192, v193
v_mfma_f32_16x16x32_bf16 v[168:171], a[196:199], v[224:227], v[168:171]
v_cvt_pk_bf16_f32 v123, v194, v195
v_sub_f32 v201, v201, v254
v_mfma_f32_16x16x32_bf16 v[168:171], a[200:203], v[196:199], v[168:171]
v_cvt_pk_bf16_f32 v119, v230, v231
v_cvt_pk_bf16_f32 v118, v228, v229
v_mfma_f32_16x16x32_bf16 v[168:171], a[204:207], v[204:207], v[168:171]
v_sub_f32 v202, v202, v254
v_sub_f32 v200, v200, v254
v_mfma_f32_16x16x32_bf16 v[172:175], a[220:223], v[204:207], 0
v_exp_f32 v200, v200
v_mfma_f32_16x16x32_bf16 v[172:175], a[216:219], v[196:199], v[172:175]
v_exp_f32 v202, v202
v_mfma_f32_16x16x32_bf16 v[172:175], a[212:215], v[224:227], v[172:175]
v_exp_f32 v201, v201
v_mfma_f32_16x16x32_bf16 v[172:175], a[208:211], v[212:215], v[172:175]
v_sub_f32 v203, v203, v254
v_add_f32 v248, v248, v200
v_mfma_f32_16x16x32_bf16 v[176:179], a[224:227], v[212:215], 0
v_exp_f32 v203, v203
v_mfma_f32_16x16x32_bf16 v[176:179], a[228:231], v[224:227], v[176:179]
v_cvt_pk_bf16_f32 v125, v202, v203
v_add_f32 v248, v248, v201
v_mfma_f32_16x16x32_bf16 v[176:179], a[232:235], v[196:199], v[176:179]
v_add_f32 v248, v248, v202
v_cvt_pk_bf16_f32 v124, v200, v201
v_mfma_f32_16x16x32_bf16 v[176:179], a[236:239], v[204:207], v[176:179]
v_add_f32 v248, v248, v203
v_sub_f32 v184, v184, v254
v_mfma_f32_16x16x32_bf16 v[180:183], a[252:255], v[204:207], 0
v_sub_f32 v185, v185, v254
v_sub_f32 v187, v187, v254
v_mfma_f32_16x16x32_bf16 v[180:183], a[248:251], v[196:199], v[180:183]
v_sub_f32 v186, v186, v254
v_sub_f32 v220, v220, v254
v_mfma_f32_16x16x32_bf16 v[180:183], a[244:247], v[224:227], v[180:183]
v_exp_f32 v184, v184
v_mfma_f32_16x16x32_bf16 v[180:183], a[240:243], v[212:215], v[180:183]
v_add_f32 v248, v248, v184
v_sub_f32 v216, v216, v254
v_mfma_f32_16x16x32_bf16 v[188:191], v[0:3], v[112:115], 0
v_exp_f32 v187, v187
v_mfma_f32_16x16x32_bf16 v[188:191], v[4:7], v[116:119], v[188:191]
v_exp_f32 v186, v186
v_mfma_f32_16x16x32_bf16 v[192:195], v[12:15], v[116:119], 0
v_exp_f32 v185, v185
v_mfma_f32_16x16x32_bf16 v[192:195], v[8:11], v[112:115], v[192:195]
v_add_f32 v248, v248, v185
v_add_f32 v248, v248, v186
v_mfma_f32_16x16x32_bf16 v[196:199], v[16:19], v[112:115], 0
v_add_f32 v248, v248, v187
v_cvt_pk_bf16_f32 v127, v186, v187
v_mfma_f32_16x16x32_bf16 v[196:199], v[20:23], v[116:119], v[196:199]
v_cvt_pk_bf16_f32 v126, v184, v185
v_sub_f32 v218, v218, v254
v_mfma_f32_16x16x32_bf16 v[200:203], v[28:31], v[116:119], 0
v_exp_f32 v220, v220
v_mfma_f32_16x16x32_bf16 v[200:203], v[24:27], v[112:115], v[200:203]
v_cvt_pk_bf16_f32 v132, v220, 0
v_sub_f32 v217, v217, v254
v_mfma_f32_16x16x32_bf16 v[204:207], v[32:35], v[112:115], 0
v_sub_f32 v211, v211, v254
v_sub_f32 v210, v210, v254
v_mfma_f32_16x16x32_bf16 v[204:207], v[36:39], v[116:119], v[204:207]
v_sub_f32 v219, v219, v254
v_sub_f32 v208, v208, v254
v_mfma_f32_16x16x32_bf16 v[212:215], v[44:47], v[116:119], 0
v_sub_f32 v209, v209, v254
v_max3_f32 v254, v188, v189, v190
v_mfma_f32_16x16x32_bf16 v[212:215], v[40:43], v[112:115], v[212:215]
v_exp_f32 v209, v209
v_mfma_f32_16x16x32_bf16 v[224:227], v[48:51], v[112:115], 0
v_exp_f32 v208, v208
v_mfma_f32_16x16x32_bf16 v[224:227], v[52:55], v[116:119], v[224:227]
v_exp_f32 v217, v217
v_mfma_f32_16x16x32_bf16 v[184:187], v[56:59], v[120:123], 0
v_exp_f32 v210, v210
v_mfma_f32_16x16x32_bf16 v[184:187], v[104:107], v[132:135], v[184:187]
v_exp_f32 v218, v218
v_mfma_f32_16x16x32_bf16 v[184:187], v[72:75], v[124:127], v[184:187]
v_exp_f32 v211, v211
v_exp_f32 v216, v216
v_exp_f32 v219, v219
v_cvt_pk_bf16_f32 v129, v210, v211
v_cvt_pk_bf16_f32 v131, v218, v219
v_cvt_pk_bf16_f32 v130, v216, v217
v_cvt_pk_bf16_f32 v128, v208, v209
v_add_f32 v248, v248, v208
v_add_f32 v248, v248, v209
v_mfma_f32_16x16x32_bf16 v[184:187], v[88:91], v[128:131], v[184:187]
v_add_f32 v248, v248, v210
v_add_f32 v248, v248, v211
v_mfma_f32_16x16x32_bf16 v[208:211], v[92:95], v[128:131], 0
v_max3_f32 v254, v254, v191, v192
v_max3_f32 v254, v254, v193, v194
v_mfma_f32_16x16x32_bf16 v[208:211], v[76:79], v[124:127], v[208:211]
v_max3_f32 v254, v254, v195, v196
v_max3_f32 v254, v254, v197, v198
v_mfma_f32_16x16x32_bf16 v[208:211], v[106:109], v[132:135], v[208:211]
v_max3_f32 v254, v254, v199, v200
v_max3_f32 v254, v254, v201, v202
v_mfma_f32_16x16x32_bf16 v[208:211], v[60:63], v[120:123], v[208:211]
v_max3_f32 v254, v254, v203, v204
v_max3_f32 v254, v254, v205, v206
v_mfma_f32_16x16x32_bf16 v[228:231], v[64:67], v[120:123], 0
v_max3_f32 v254, v254, v207, v212
v_max3_f32 v254, v254, v213, v214
v_mfma_f32_16x16x32_bf16 v[228:231], v[108:111], v[132:135], v[228:231]
v_max3_f32 v254, v254, v215, v224
v_add_f32 v248, v248, v216
v_mfma_f32_16x16x32_bf16 v[228:231], v[80:83], v[124:127], v[228:231]
ds_swizzle_b32 v255, v254 offset:0x401F
v_add_f32 v248, v248, v217
v_mfma_f32_16x16x32_bf16 v[228:231], v[96:99], v[128:131], v[228:231]
v_add_f32 v248, v248, v218
v_add_f32 v248, v248, v219
v_mfma_f32_16x16x32_bf16 v[232:235], v[100:103], v[128:131], 0
ds_read_b128 v[216:219], v236 offset:8448
v_add_f32 v248, v248, v220
v_mfma_f32_16x16x32_bf16 v[232:235], v[84:87], v[124:127], v[232:235]
ds_read_b128 v[220:223], v236 offset:8704
ds_swizzle_b32 v250, v248 offset:0x401F
v_mfma_f32_16x16x32_bf16 v[232:235], v[110:113], v[132:135], v[232:235]
v_mfma_f32_16x16x32_bf16 v[232:235], v[68:71], v[120:123], v[232:235]
s_waitcnt lgkmcnt(3)
v_max_f32 v254, v254, v255
ds_bpermute_b32 v255, v247, v254
s_waitcnt lgkmcnt(1)
v_add_f32 v248, v248, v250
ds_bpermute_b32 v250, v247, v248
s_waitcnt lgkmcnt(1)
v_max_f32 v254, v254, v255
v_sub_f32 v188, v188, v254
v_exp_f32 v188, v188
v_sub_f32 v189, v189, v254
v_sub_f32 v190, v190, v254
v_sub_f32 v191, v191, v254
v_exp_f32 v189, v189
v_exp_f32 v191, v191
v_exp_f32 v190, v190
v_add_f32 v249, v188, v189
v_add_f32 v249, v249, v190
v_add_f32 v249, v249, v191
v_cvt_pk_bf16_f32 v137, v190, v191
v_cvt_pk_bf16_f32 v136, v188, v189
v_mfma_f32_16x16x32_bf16 v[188:191], a[0:3], v[216:219], 0
s_waitcnt lgkmcnt(0)
v_sub_f32 v192, v192, v254
v_sub_f32 v195, v195, v254
v_mfma_f32_16x16x32_bf16 v[188:191], a[4:7], v[220:223], v[188:191]
v_exp_f32 v192, v192
v_sub_f32 v193, v193, v254
v_sub_f32 v194, v194, v254
v_exp_f32 v195, v195
v_exp_f32 v193, v193
v_exp_f32 v194, v194
v_add_f32 v249, v249, v192
v_add_f32 v249, v249, v193
v_add_f32 v249, v249, v194
v_add_f32 v249, v249, v195
v_cvt_pk_bf16_f32 v139, v194, v195
v_cvt_pk_bf16_f32 v138, v192, v193
ds_read_b128 v[192:195], v236 offset:8960
v_sub_f32 v198, v198, v254
v_sub_f32 v197, v197, v254
v_sub_f32 v196, v196, v254
v_exp_f32 v196, v196
v_exp_f32 v198, v198
v_sub_f32 v202, v202, v254
v_sub_f32 v200, v200, v254
v_exp_f32 v197, v197
v_sub_f32 v201, v201, v254
v_sub_f32 v199, v199, v254
v_exp_f32 v199, v199
v_exp_f32 v200, v200
v_add_f32 v249, v249, v196
v_add_f32 v249, v249, v197
v_add_f32 v249, v249, v198
s_waitcnt lgkmcnt(0)
v_mfma_f32_16x16x32_bf16 v[188:191], a[8:11], v[192:195], v[188:191]
v_sub_f32 v203, v203, v254
v_add_f32 v249, v249, v199
v_add_f32 v249, v249, v200
v_exp_f32 v201, v201
v_exp_f32 v202, v202
v_exp_f32 v203, v203
v_sub_f32 v204, v204, v254
v_exp_f32 v204, v204
v_add_f32 v249, v249, v201
v_add_f32 v249, v249, v202
v_add_f32 v249, v249, v203
v_sub_f32 v205, v205, v254
v_sub_f32 v206, v206, v254
v_exp_f32 v205, v205
v_exp_f32 v206, v206
v_add_f32 v249, v249, v204
v_add_f32 v249, v249, v205
v_sub_f32 v207, v207, v254
v_exp_f32 v207, v207
v_add_f32 v249, v249, v206
v_add_f32 v249, v249, v207
v_cvt_pk_bf16_f32 v145, v206, v207
v_cvt_pk_bf16_f32 v144, v204, v205
ds_read_b128 v[204:207], v236 offset:9216
v_add_f32 v248, v248, v250
v_rcp_f32 v251, v248
v_sub_f32 v212, v212, v254
v_fmac_f32 v152, v184, v251
v_fmac_f32 v153, v185, v251
v_fmac_f32 v155, v187, v251
v_fmac_f32 v154, v186, v251
v_fmac_f32 v157, v209, v251
v_fmac_f32 v159, v211, v251
v_fmac_f32 v158, v210, v251
v_fmac_f32 v156, v208, v251
v_exp_f32 v212, v212
v_sub_f32 v213, v213, v254
v_exp_f32 v213, v213
v_sub_f32 v214, v214, v254
v_exp_f32 v214, v214
s_waitcnt lgkmcnt(0)
v_mfma_f32_16x16x32_bf16 v[188:191], a[12:15], v[204:207], v[188:191]
v_sub_f32 v215, v215, v254
v_add_f32 v249, v249, v212
v_mfma_f32_16x16x32_bf16 v[184:187], a[28:31], v[204:207], 0
v_exp_f32 v215, v215
v_mfma_f32_16x16x32_bf16 v[184:187], a[24:27], v[192:195], v[184:187]
v_add_f32 v249, v249, v213
v_add_f32 v249, v249, v214
v_mfma_f32_16x16x32_bf16 v[184:187], a[20:23], v[220:223], v[184:187]
v_add_f32 v249, v249, v215
v_cvt_pk_bf16_f32 v147, v214, v215
v_mfma_f32_16x16x32_bf16 v[184:187], a[16:19], v[216:219], v[184:187]
v_cvt_pk_bf16_f32 v146, v212, v213
v_fmac_f32 v163, v231, v251
v_mfma_f32_16x16x32_bf16 v[208:211], a[32:35], v[216:219], 0
v_fmac_f32 v161, v229, v251
v_cvt_pk_bf16_f32 v152, v152, v153
v_mfma_f32_16x16x32_bf16 v[208:211], a[36:39], v[220:223], v[208:211]
v_fmac_f32 v167, v235, v251
v_fmac_f32 v160, v228, v251
v_mfma_f32_16x16x32_bf16 v[208:211], a[40:43], v[192:195], v[208:211]
v_fmac_f32 v164, v232, v251
v_cvt_pk_bf16_f32 v160, v160, v161
v_mfma_f32_16x16x32_bf16 v[208:211], a[44:47], v[204:207], v[208:211]
v_cvt_pk_bf16_f32 v153, v154, v155
v_cvt_pk_bf16_f32 v154, v156, v157
v_mfma_f32_16x16x32_bf16 v[212:215], a[60:63], v[204:207], 0
v_fmac_f32 v166, v234, v251
v_fmac_f32 v162, v230, v251
v_mfma_f32_16x16x32_bf16 v[212:215], a[56:59], v[192:195], v[212:215]
v_fmac_f32 v165, v233, v251
v_cvt_pk_bf16_f32 v155, v158, v159
v_mfma_f32_16x16x32_bf16 v[212:215], a[52:55], v[220:223], v[212:215]
v_cvt_pk_bf16_f32 v161, v162, v163
v_cvt_pk_bf16_f32 v162, v164, v165
v_mfma_f32_16x16x32_bf16 v[212:215], a[48:51], v[216:219], v[212:215]
v_cvt_pk_bf16_f32 v163, v166, v167
v_pk_max_i16 v162, v162, 0
v_pk_max_i16 v161, v161, 0
v_pk_max_i16 v163, v163, 0
v_pk_max_i16 v153, v153, 0
v_pk_max_i16 v155, v155, 0
v_pk_max_i16 v152, v152, 0
v_pk_max_i16 v160, v160, 0
v_pk_max_i16 v154, v154, 0
buffer_store_dwordx4 v[152:155], v239, s[20:23], s52 offen offset:0 nt
buffer_store_dwordx4 v[160:163], v239, s[20:23], s52 offen offset:64 nt
v_cvt_pk_bf16_f32 v112, v188, v189
v_cvt_pk_bf16_f32 v113, v190, v191
v_cvt_pk_bf16_f32 v114, v184, v185
v_cvt_pk_bf16_f32 v115, v186, v187
v_cvt_pk_bf16_f32 v118, v212, v213
v_cvt_pk_bf16_f32 v119, v214, v215
v_cvt_pk_bf16_f32 v116, v208, v209
v_cvt_pk_bf16_f32 v117, v210, v211
v_mfma_f32_16x16x32_bf16 v[152:155], a[192:195], v[216:219], 0
v_sub_f32 v224, v224, v254
v_cvt_pk_bf16_f32 v142, v200, v201
v_mfma_f32_16x16x32_bf16 v[152:155], a[196:199], v[220:223], v[152:155]
v_exp_f32 v224, v224
v_mfma_f32_16x16x32_bf16 v[152:155], a[200:203], v[192:195], v[152:155]
v_cvt_pk_bf16_f32 v141, v198, v199
v_cvt_pk_bf16_f32 v140, v196, v197
v_mfma_f32_16x16x32_bf16 v[152:155], a[204:207], v[204:207], v[152:155]
v_add_f32 v249, v249, v224
v_cvt_pk_bf16_f32 v143, v202, v203
v_mfma_f32_16x16x32_bf16 v[156:159], a[220:223], v[204:207], 0
ds_swizzle_b32 v250, v249 offset:0x401F
v_cvt_pk_bf16_f32 v148, v224, 0
v_mfma_f32_16x16x32_bf16 v[156:159], a[216:219], v[192:195], v[156:159]
v_mfma_f32_16x16x32_bf16 v[156:159], a[212:215], v[220:223], v[156:159]
v_mfma_f32_16x16x32_bf16 v[156:159], a[208:211], v[216:219], v[156:159]
v_mfma_f32_16x16x32_bf16 v[160:163], a[224:227], v[216:219], 0
v_mfma_f32_16x16x32_bf16 v[160:163], a[228:231], v[220:223], v[160:163]
v_mfma_f32_16x16x32_bf16 v[160:163], a[232:235], v[192:195], v[160:163]
s_waitcnt lgkmcnt(0)
v_add_f32 v249, v249, v250
v_mfma_f32_16x16x32_bf16 v[160:163], a[236:239], v[204:207], v[160:163]
ds_bpermute_b32 v250, v247, v249
v_mfma_f32_16x16x32_bf16 v[164:167], a[252:255], v[204:207], 0
v_mfma_f32_16x16x32_bf16 v[164:167], a[248:251], v[192:195], v[164:167]
v_mfma_f32_16x16x32_bf16 v[164:167], a[244:247], v[220:223], v[164:167]
v_mfma_f32_16x16x32_bf16 v[164:167], a[240:243], v[216:219], v[164:167]
v_mfma_f32_16x16x32_bf16 v[184:187], v[0:3], v[112:115], 0
v_mfma_f32_16x16x32_bf16 v[184:187], v[4:7], v[116:119], v[184:187]
s_waitcnt lgkmcnt(0)
v_add_f32 v249, v249, v250
s_nop 0
v_mfma_f32_16x16x32_bf16 v[188:191], v[12:15], v[116:119], 0
v_rcp_f32 v252, v249
v_mfma_f32_16x16x32_bf16 v[188:191], v[8:11], v[112:115], v[188:191]
s_nop 1
v_max3_f32 v254, v184, v185, v186
v_mfma_f32_16x16x32_bf16 v[192:195], v[16:19], v[112:115], 0
s_nop 2
v_mfma_f32_16x16x32_bf16 v[192:195], v[20:23], v[116:119], v[192:195]
v_max3_f32 v254, v254, v187, v188
v_max3_f32 v254, v254, v189, v190
v_mfma_f32_16x16x32_bf16 v[196:199], v[28:31], v[116:119], 0
s_nop 2
v_mfma_f32_16x16x32_bf16 v[196:199], v[24:27], v[112:115], v[196:199]
s_nop 0
v_max3_f32 v254, v254, v191, v192
v_max3_f32 v254, v254, v193, v194
v_mfma_f32_16x16x32_bf16 v[200:203], v[32:35], v[112:115], 0
s_nop 2
v_mfma_f32_16x16x32_bf16 v[200:203], v[36:39], v[116:119], v[200:203]
v_max3_f32 v254, v254, v195, v196
v_max3_f32 v254, v254, v197, v198
v_mfma_f32_16x16x32_bf16 v[204:207], v[44:47], v[116:119], 0
s_nop 2
v_mfma_f32_16x16x32_bf16 v[204:207], v[40:43], v[112:115], v[204:207]
s_nop 0
v_max3_f32 v254, v254, v199, v200
v_max3_f32 v254, v254, v201, v202
v_mfma_f32_16x16x32_bf16 v[208:211], v[48:51], v[112:115], 0
s_nop 2
v_mfma_f32_16x16x32_bf16 v[208:211], v[52:55], v[116:119], v[208:211]
v_max3_f32 v254, v254, v203, v204
v_max3_f32 v254, v254, v205, v206
v_mfma_f32_16x16x32_bf16 v[212:215], v[56:59], v[136:139], 0
s_nop 2
v_mfma_f32_16x16x32_bf16 v[212:215], v[104:107], v[148:151], v[212:215]
s_nop 0
v_max3_f32 v254, v254, v207, v208
v_mfma_f32_16x16x32_bf16 v[212:215], v[72:75], v[140:143], v[212:215]
ds_swizzle_b32 v255, v254 offset:0x401F
v_mfma_f32_16x16x32_bf16 v[212:215], v[88:91], v[144:147], v[212:215]
s_nop 2
v_mfma_f32_16x16x32_bf16 v[216:219], v[92:95], v[144:147], 0
s_nop 2
v_mfma_f32_16x16x32_bf16 v[216:219], v[76:79], v[140:143], v[216:219]
v_fmac_f32 v169, v213, v252
v_fmac_f32 v168, v212, v252
v_mfma_f32_16x16x32_bf16 v[216:219], v[106:109], v[148:151], v[216:219]
v_fmac_f32 v171, v215, v252
v_fmac_f32 v170, v214, v252
v_mfma_f32_16x16x32_bf16 v[216:219], v[60:63], v[136:139], v[216:219]
ds_read_b128 v[220:223], v236 offset:12672
ds_read_b128 v[224:227], v236 offset:12928
v_mfma_f32_16x16x32_bf16 v[228:231], v[64:67], v[136:139], 0
s_waitcnt lgkmcnt(2)
ds_read_b128 v[212:215], v236 offset:13184
v_cvt_pk_bf16_f32 v168, v168, v169
v_mfma_f32_16x16x32_bf16 v[228:231], v[108:111], v[148:151], v[228:231]
s_nop 0
v_fmac_f32 v172, v216, v252
v_fmac_f32 v174, v218, v252
v_mfma_f32_16x16x32_bf16 v[228:231], v[80:83], v[140:143], v[228:231]
v_fmac_f32 v173, v217, v252
v_fmac_f32 v175, v219, v252
v_mfma_f32_16x16x32_bf16 v[228:231], v[96:99], v[144:147], v[228:231]
ds_read_b128 v[216:219], v236 offset:13440
v_cvt_pk_bf16_f32 v169, v170, v171
v_mfma_f32_16x16x32_bf16 v[232:235], v[100:103], v[144:147], 0
v_cvt_pk_bf16_f32 v170, v172, v173
v_cvt_pk_bf16_f32 v171, v174, v175
v_mfma_f32_16x16x32_bf16 v[232:235], v[84:87], v[140:143], v[232:235]
s_waitcnt lgkmcnt(2)
v_pk_max_i16 v170, v170, 0
v_fmac_f32 v178, v230, v252
v_mfma_f32_16x16x32_bf16 v[232:235], v[110:113], v[148:151], v[232:235]
s_waitcnt lgkmcnt(1)
v_fmac_f32 v179, v231, v252
v_fmac_f32 v176, v228, v252
v_mfma_f32_16x16x32_bf16 v[232:235], v[68:71], v[136:139], v[232:235]
v_fmac_f32 v177, v229, v252
v_cvt_pk_bf16_f32 v176, v176, v177
v_mfma_f32_16x16x32_bf16 v[228:231], a[0:3], v[220:223], 0
v_cvt_pk_bf16_f32 v177, v178, v179
v_pk_max_i16 v169, v169, 0
v_mfma_f32_16x16x32_bf16 v[228:231], a[4:7], v[224:227], v[228:231]
s_waitcnt lgkmcnt(0)
v_pk_max_i16 v171, v171, 0
v_fmac_f32 v182, v234, v252
v_mfma_f32_16x16x32_bf16 v[228:231], a[8:11], v[212:215], v[228:231]
v_fmac_f32 v181, v233, v252
v_fmac_f32 v183, v235, v252
v_mfma_f32_16x16x32_bf16 v[228:231], a[12:15], v[216:219], v[228:231]
v_fmac_f32 v180, v232, v252
v_cvt_pk_bf16_f32 v179, v182, v183
v_mfma_f32_16x16x32_bf16 v[232:235], a[28:31], v[216:219], 0
v_cvt_pk_bf16_f32 v178, v180, v181
v_pk_max_i16 v178, v178, 0
v_mfma_f32_16x16x32_bf16 v[232:235], a[24:27], v[212:215], v[232:235]
v_pk_max_i16 v179, v179, 0
v_pk_max_i16 v176, v176, 0
v_mfma_f32_16x16x32_bf16 v[232:235], a[20:23], v[224:227], v[232:235]
v_cvt_pk_bf16_f32 v113, v230, v231
v_cvt_pk_bf16_f32 v112, v228, v229
v_mfma_f32_16x16x32_bf16 v[232:235], a[16:19], v[220:223], v[232:235]
v_pk_max_i16 v168, v168, 0
v_pk_max_i16 v177, v177, 0
v_mfma_f32_16x16x32_bf16 v[228:231], a[32:35], v[220:223], 0
buffer_store_dwordx4 v[168:171], v239, s[20:23], s53 offen offset:0 nt
buffer_store_dwordx4 v[176:179], v239, s[20:23], s53 offen offset:64 nt
v_add_u32 v236, s56, v236
v_max_f32 v254, v254, v255
s_sub_u32 s56, 0, s56
v_cvt_pk_bf16_f32 v115, v234, v235
v_cvt_pk_bf16_f32 v114, v232, v233
v_mfma_f32_16x16x32_bf16 v[228:231], a[36:39], v[224:227], v[228:231]
ds_bpermute_b32 v255, v247, v254
v_mfma_f32_16x16x32_bf16 v[228:231], a[40:43], v[212:215], v[228:231]
v_mfma_f32_16x16x32_bf16 v[228:231], a[44:47], v[216:219], v[228:231]
s_nop 2
v_mfma_f32_16x16x32_bf16 v[232:235], a[60:63], v[216:219], 0
s_nop 2
v_mfma_f32_16x16x32_bf16 v[232:235], a[56:59], v[212:215], v[232:235]
v_cvt_pk_bf16_f32 v116, v228, v229
v_cvt_pk_bf16_f32 v117, v230, v231
v_mfma_f32_16x16x32_bf16 v[232:235], a[52:55], v[224:227], v[232:235]
v_mfma_f32_16x16x32_bf16 v[232:235], a[48:51], v[220:223], v[232:235]
s_waitcnt lgkmcnt(0)
v_max_f32 v254, v254, v255
v_sub_f32 v184, v184, v254
v_mfma_f32_16x16x32_bf16 v[168:171], a[192:195], v[220:223], 0
v_exp_f32 v184, v184
v_mfma_f32_16x16x32_bf16 v[168:171], a[196:199], v[224:227], v[168:171]
v_sub_f32 v185, v185, v254
v_sub_f32 v186, v186, v254
v_mfma_f32_16x16x32_bf16 v[168:171], a[200:203], v[212:215], v[168:171]
v_cvt_pk_bf16_f32 v119, v234, v235
v_cvt_pk_bf16_f32 v118, v232, v233
v_mfma_f32_16x16x32_bf16 v[168:171], a[204:207], v[216:219], v[168:171]
v_exp_f32 v186, v186
v_mfma_f32_16x16x32_bf16 v[172:175], a[220:223], v[216:219], 0
v_exp_f32 v185, v185
v_mfma_f32_16x16x32_bf16 v[172:175], a[216:219], v[212:215], v[172:175]
v_sub_f32 v189, v189, v254
v_sub_f32 v187, v187, v254
v_mfma_f32_16x16x32_bf16 v[172:175], a[212:215], v[224:227], v[172:175]
v_sub_f32 v188, v188, v254
v_sub_f32 v190, v190, v254
v_mfma_f32_16x16x32_bf16 v[172:175], a[208:211], v[220:223], v[172:175]
s_cmp_lg_u32 s45, 0
s_cbranch_scc1 L_loops
v_mfma_f32_16x16x32_bf16 v[176:179], a[224:227], v[220:223], 0
s_waitcnt vmcnt(8)
s_barrier
v_mfma_f32_16x16x32_bf16 v[176:179], a[228:231], v[224:227], v[176:179]
s_add_u32 s52, s47, 8192
ds_read_b128 v[232:235], v236 offset:0
v_add_f32 v248, v184, v185
v_mfma_f32_16x16x32_bf16 v[176:179], a[232:235], v[212:215], v[176:179]
s_add_u32 s53, s47, 12288
v_exp_f32 v188, v188
v_mfma_f32_16x16x32_bf16 v[176:179], a[236:239], v[216:219], v[176:179]
v_add_f32 v248, v248, v186
v_sub_f32 v191, v191, v254
v_mfma_f32_16x16x32_bf16 v[180:183], a[252:255], v[216:219], 0
v_exp_f32 v187, v187
v_mfma_f32_16x16x32_bf16 v[180:183], a[248:251], v[212:215], v[180:183]
v_exp_f32 v190, v190
v_mfma_f32_16x16x32_bf16 v[180:183], a[244:247], v[224:227], v[180:183]
v_add_f32 v248, v248, v187
v_add_f32 v248, v248, v188
v_mfma_f32_16x16x32_bf16 v[180:183], a[240:243], v[220:223], v[180:183]
s_waitcnt lgkmcnt(0)
v_exp_f32 v189, v189
v_mfma_f32_16x16x32_bf16 v[228:231], v[0:3], v[112:115], 0
v_add_f32 v248, v248, v189
v_add_f32 v248, v248, v190
v_mfma_f32_16x16x32_bf16 v[228:231], v[4:7], v[116:119], v[228:231]
v_exp_f32 v191, v191
v_cvt_pk_bf16_f32 v122, v188, v189
v_add_f32 v248, v248, v191
v_cvt_pk_bf16_f32 v123, v190, v191
v_mfma_f32_16x16x32_bf16 v[188:191], v[12:15], v[116:119], 0
v_sub_f32 v193, v193, v254
v_sub_f32 v194, v194, v254
v_mfma_f32_16x16x32_bf16 v[188:191], v[8:11], v[112:115], v[188:191]
v_sub_f32 v195, v195, v254
v_exp_f32 v194, v194
v_sub_f32 v192, v192, v254
v_exp_f32 v192, v192
v_sub_f32 v196, v196, v254
v_exp_f32 v193, v193
v_sub_f32 v197, v197, v254
v_sub_f32 v199, v199, v254
v_sub_f32 v198, v198, v254
v_exp_f32 v195, v195
v_add_f32 v248, v248, v192
v_add_f32 v248, v248, v193
v_exp_f32 v196, v196
v_exp_f32 v197, v197
v_add_f32 v248, v248, v194
v_add_f32 v248, v248, v195
v_add_f32 v248, v248, v196
v_add_f32 v248, v248, v197
v_exp_f32 v198, v198
v_sub_f32 v200, v200, v254
v_sub_f32 v203, v203, v254
v_exp_f32 v199, v199
v_sub_f32 v201, v201, v254
v_exp_f32 v201, v201
v_sub_f32 v202, v202, v254
v_exp_f32 v202, v202
v_add_f32 v248, v248, v198
v_exp_f32 v200, v200
v_add_f32 v248, v248, v199
v_add_f32 v248, v248, v200
v_add_f32 v248, v248, v201
v_exp_f32 v203, v203
v_add_f32 v248, v248, v202
v_add_f32 v248, v248, v203
v_cvt_pk_bf16_f32 v128, v200, v201
v_cvt_pk_bf16_f32 v129, v202, v203
v_mfma_f32_16x16x32_bf16 v[200:203], v[16:19], v[112:115], 0
v_sub_f32 v204, v204, v254
v_sub_f32 v205, v205, v254
v_mfma_f32_16x16x32_bf16 v[200:203], v[20:23], v[116:119], v[200:203]
v_exp_f32 v204, v204
v_sub_f32 v206, v206, v254
v_add_f32 v248, v248, v204
v_exp_f32 v206, v206
v_sub_f32 v207, v207, v254
v_exp_f32 v205, v205
v_exp_f32 v207, v207
v_add_f32 v248, v248, v205
v_add_f32 v248, v248, v206
v_add_f32 v248, v248, v207
v_cvt_pk_bf16_f32 v130, v204, v205
v_cvt_pk_bf16_f32 v131, v206, v207
v_mfma_f32_16x16x32_bf16 v[204:207], v[28:31], v[116:119], 0
v_sub_f32 v208, v208, v254
v_cvt_pk_bf16_f32 v120, v184, v185
v_mfma_f32_16x16x32_bf16 v[204:207], v[24:27], v[112:115], v[204:207]
v_exp_f32 v208, v208
s_nop 0
v_add_f32 v248, v248, v208
v_cvt_pk_bf16_f32 v132, v208, 0
v_mfma_f32_16x16x32_bf16 v[208:211], v[32:35], v[112:115], 0
ds_swizzle_b32 v250, v248 offset:0x401F
v_cvt_pk_bf16_f32 v121, v186, v187
v_mfma_f32_16x16x32_bf16 v[208:211], v[36:39], v[116:119], v[208:211]
ds_read_b128 v[184:187], v236 offset:256
v_cvt_pk_bf16_f32 v126, v196, v197
v_mfma_f32_16x16x32_bf16 v[212:215], v[44:47], v[116:119], 0
v_cvt_pk_bf16_f32 v125, v194, v195
v_cvt_pk_bf16_f32 v127, v198, v199
v_mfma_f32_16x16x32_bf16 v[212:215], v[40:43], v[112:115], v[212:215]
ds_read_b128 v[196:199], v236 offset:768
v_cvt_pk_bf16_f32 v124, v192, v193
v_mfma_f32_16x16x32_bf16 v[216:219], v[48:51], v[112:115], 0
ds_read_b128 v[192:195], v236 offset:512
v_max3_f32 v254, v228, v229, v230
v_mfma_f32_16x16x32_bf16 v[216:219], v[52:55], v[116:119], v[216:219]
v_max3_f32 v254, v254, v231, v188
v_max3_f32 v254, v254, v189, v190
v_mfma_f32_16x16x32_bf16 v[220:223], v[56:59], v[120:123], 0
s_waitcnt lgkmcnt(3)
v_add_f32 v248, v248, v250
v_max3_f32 v254, v254, v191, v200
v_mfma_f32_16x16x32_bf16 v[220:223], v[104:107], v[132:135], v[220:223]
s_waitcnt lgkmcnt(2)
ds_bpermute_b32 v250, v247, v248
v_mfma_f32_16x16x32_bf16 v[220:223], v[72:75], v[124:127], v[220:223]
v_max3_f32 v254, v254, v201, v202
v_max3_f32 v254, v254, v203, v204
v_mfma_f32_16x16x32_bf16 v[220:223], v[88:91], v[128:131], v[220:223]
s_waitcnt lgkmcnt(2)
v_max3_f32 v254, v254, v205, v206
v_max3_f32 v254, v254, v207, v208
v_mfma_f32_16x16x32_bf16 v[224:227], v[92:95], v[128:131], 0
s_waitcnt lgkmcnt(1)
v_max3_f32 v254, v254, v209, v210
v_max3_f32 v254, v254, v211, v212
v_mfma_f32_16x16x32_bf16 v[224:227], v[76:79], v[124:127], v[224:227]
v_max3_f32 v254, v254, v213, v214
v_max3_f32 v254, v254, v215, v216
v_mfma_f32_16x16x32_bf16 v[224:227], v[106:109], v[132:135], v[224:227]
ds_swizzle_b32 v255, v254 offset:0x401F
v_mbcnt_lo_u32_b32 v242, -1, 0
v_mfma_f32_16x16x32_bf16 v[224:227], v[60:63], v[120:123], v[224:227]
s_waitcnt lgkmcnt(1)
v_add_f32 v248, v248, v250
v_rcp_f32 v251, v248
s_nop 0
v_fmac_f32 v152, v220, v251
v_fmac_f32 v153, v221, v251
v_fmac_f32 v154, v222, v251
v_fmac_f32 v155, v223, v251
v_mfma_f32_16x16x32_bf16 v[220:223], v[64:67], v[120:123], 0
v_fmac_f32 v156, v224, v251
v_fmac_f32 v157, v225, v251
v_mfma_f32_16x16x32_bf16 v[220:223], v[108:111], v[132:135], v[220:223]
v_fmac_f32 v158, v226, v251
v_fmac_f32 v159, v227, v251
v_mfma_f32_16x16x32_bf16 v[220:223], v[80:83], v[124:127], v[220:223]
s_waitcnt lgkmcnt(0)
v_cvt_pk_bf16_f32 v152, v152, v153
v_cvt_pk_bf16_f32 v153, v154, v155
v_mfma_f32_16x16x32_bf16 v[220:223], v[96:99], v[128:131], v[220:223]
v_cvt_pk_bf16_f32 v154, v156, v157
v_cvt_pk_bf16_f32 v155, v158, v159
v_mfma_f32_16x16x32_bf16 v[224:227], v[100:103], v[128:131], 0
v_pk_max_i16 v152, v152, 0
v_pk_max_i16 v153, v153, 0
v_mfma_f32_16x16x32_bf16 v[224:227], v[84:87], v[124:127], v[224:227]
v_max_f32 v254, v254, v255
v_pk_max_i16 v154, v154, 0
v_mfma_f32_16x16x32_bf16 v[224:227], v[110:113], v[132:135], v[224:227]
ds_bpermute_b32 v255, v247, v254
v_mfma_f32_16x16x32_bf16 v[224:227], v[68:71], v[120:123], v[224:227]
v_fmac_f32 v160, v220, v251
v_fmac_f32 v161, v221, v251
v_mfma_f32_16x16x32_bf16 v[0:3], a[192:195], v[232:235], 0
v_fmac_f32 v162, v222, v251
v_fmac_f32 v163, v223, v251
v_mfma_f32_16x16x32_bf16 v[0:3], a[196:199], v[184:187], v[0:3]
v_cvt_pk_bf16_f32 v160, v160, v161
v_cvt_pk_bf16_f32 v161, v162, v163
v_mfma_f32_16x16x32_bf16 v[0:3], a[200:203], v[192:195], v[0:3]
v_fmac_f32 v164, v224, v251
v_fmac_f32 v165, v225, v251
v_mfma_f32_16x16x32_bf16 v[0:3], a[204:207], v[196:199], v[0:3]
v_fmac_f32 v166, v226, v251
v_fmac_f32 v167, v227, v251
v_mfma_f32_16x16x32_bf16 v[4:7], a[220:223], v[196:199], 0
s_waitcnt lgkmcnt(0)
v_max_f32 v254, v254, v255
v_sub_f32 v228, v228, v254
v_mfma_f32_16x16x32_bf16 v[4:7], a[216:219], v[192:195], v[4:7]
v_sub_f32 v229, v229, v254
v_sub_f32 v230, v230, v254
v_mfma_f32_16x16x32_bf16 v[4:7], a[212:215], v[184:187], v[4:7]
v_exp_f32 v228, v228
v_mfma_f32_16x16x32_bf16 v[4:7], a[208:211], v[232:235], v[4:7]
ds_read_b128 v[220:223], v236 offset:4224
v_sub_f32 v231, v231, v254
v_mfma_f32_16x16x32_bf16 v[8:11], a[224:227], v[232:235], 0
v_exp_f32 v229, v229
v_mfma_f32_16x16x32_bf16 v[8:11], a[228:231], v[184:187], v[8:11]
v_exp_f32 v230, v230
v_mfma_f32_16x16x32_bf16 v[8:11], a[232:235], v[192:195], v[8:11]
v_exp_f32 v231, v231
v_mfma_f32_16x16x32_bf16 v[8:11], a[236:239], v[196:199], v[8:11]
v_add_f32 v249, v228, v229
v_add_f32 v249, v249, v230
v_mfma_f32_16x16x32_bf16 v[12:15], a[252:255], v[196:199], 0
ds_read_b128 v[196:199], v236 offset:4736
v_add_f32 v249, v249, v231
v_mfma_f32_16x16x32_bf16 v[12:15], a[248:251], v[192:195], v[12:15]
s_waitcnt lgkmcnt(1)
ds_read_b128 v[192:195], v236 offset:4992
v_cvt_pk_bf16_f32 v136, v228, v229
v_mfma_f32_16x16x32_bf16 v[12:15], a[244:247], v[184:187], v[12:15]
v_cvt_pk_bf16_f32 v137, v230, v231
v_sub_f32 v188, v188, v254
v_mfma_f32_16x16x32_bf16 v[12:15], a[240:243], v[232:235], v[12:15]
ds_read_b128 v[228:231], v236 offset:4480
v_sub_f32 v189, v189, v254
v_mfma_f32_16x16x32_bf16 v[16:19], a[192:195], v[220:223], 0
v_exp_f32 v188, v188
v_exp_f32 v189, v189
v_sub_f32 v190, v190, v254
v_cvt_pk_bf16_f32 v138, v188, v189
v_sub_f32 v191, v191, v254
v_exp_f32 v190, v190
v_exp_f32 v191, v191
v_sub_f32 v216, v216, v254
v_cvt_pk_bf16_f32 v139, v190, v191
v_exp_f32 v216, v216
v_sub_f32 v200, v200, v254
v_cvt_pk_bf16_f32 v148, v216, 0
s_waitcnt lgkmcnt(0)
v_mfma_f32_16x16x32_bf16 v[16:19], a[196:199], v[228:231], v[16:19]
v_sub_f32 v201, v201, v254
v_sub_f32 v202, v202, v254
v_mfma_f32_16x16x32_bf16 v[16:19], a[200:203], v[196:199], v[16:19]
v_exp_f32 v200, v200
v_mfma_f32_16x16x32_bf16 v[16:19], a[204:207], v[192:195], v[16:19]
v_exp_f32 v201, v201
v_mfma_f32_16x16x32_bf16 v[20:23], a[220:223], v[192:195], 0
v_exp_f32 v202, v202
v_mfma_f32_16x16x32_bf16 v[20:23], a[216:219], v[196:199], v[20:23]
v_sub_f32 v203, v203, v254
v_sub_f32 v204, v204, v254
v_mfma_f32_16x16x32_bf16 v[20:23], a[212:215], v[228:231], v[20:23]
v_exp_f32 v203, v203
v_mfma_f32_16x16x32_bf16 v[20:23], a[208:211], v[220:223], v[20:23]
v_exp_f32 v204, v204
v_mfma_f32_16x16x32_bf16 v[24:27], a[224:227], v[220:223], 0
v_sub_f32 v205, v205, v254
v_sub_f32 v206, v206, v254
v_mfma_f32_16x16x32_bf16 v[24:27], a[228:231], v[228:231], v[24:27]
v_exp_f32 v205, v205
v_mfma_f32_16x16x32_bf16 v[24:27], a[232:235], v[196:199], v[24:27]
v_exp_f32 v206, v206
v_mfma_f32_16x16x32_bf16 v[24:27], a[236:239], v[192:195], v[24:27]
v_sub_f32 v207, v207, v254
v_cvt_pk_bf16_f32 v140, v200, v201
v_mfma_f32_16x16x32_bf16 v[28:31], a[252:255], v[192:195], 0
v_exp_f32 v207, v207
v_mfma_f32_16x16x32_bf16 v[28:31], a[248:251], v[196:199], v[28:31]
v_cvt_pk_bf16_f32 v141, v202, v203
v_cvt_pk_bf16_f32 v142, v204, v205
v_mfma_f32_16x16x32_bf16 v[28:31], a[244:247], v[228:231], v[28:31]
v_cvt_pk_bf16_f32 v143, v206, v207
v_sub_f32 v208, v208, v254
v_mfma_f32_16x16x32_bf16 v[28:31], a[240:243], v[220:223], v[28:31]
v_sub_f32 v209, v209, v254
v_sub_f32 v210, v210, v254
v_mfma_f32_16x16x32_bf16 v[228:231], v[56:59], v[136:139], 0
v_exp_f32 v208, v208
v_mfma_f32_16x16x32_bf16 v[228:231], v[104:107], v[148:151], v[228:231]
v_exp_f32 v209, v209
v_mfma_f32_16x16x32_bf16 v[228:231], v[72:75], v[140:143], v[228:231]
v_exp_f32 v210, v210
v_sub_f32 v211, v211, v254
v_exp_f32 v211, v211
v_sub_f32 v212, v212, v254
v_exp_f32 v212, v212
v_sub_f32 v213, v213, v254
v_exp_f32 v213, v213
v_sub_f32 v214, v214, v254
v_exp_f32 v214, v214
v_sub_f32 v215, v215, v254
v_exp_f32 v215, v215
v_cvt_pk_bf16_f32 v144, v208, v209
v_cvt_pk_bf16_f32 v145, v210, v211
v_cvt_pk_bf16_f32 v146, v212, v213
v_cvt_pk_bf16_f32 v147, v214, v215
v_cvt_pk_bf16_f32 v162, v164, v165
v_cvt_pk_bf16_f32 v163, v166, v167
v_mfma_f32_16x16x32_bf16 v[228:231], v[88:91], v[144:147], v[228:231]
v_pk_max_i16 v155, v155, 0
v_pk_max_i16 v160, v160, 0
v_mfma_f32_16x16x32_bf16 v[192:195], v[92:95], v[144:147], 0
v_pk_max_i16 v161, v161, 0
v_pk_max_i16 v162, v162, 0
v_mfma_f32_16x16x32_bf16 v[192:195], v[76:79], v[140:143], v[192:195]
v_pk_max_i16 v163, v163, 0
v_mbcnt_hi_u32_b32 v242, -1, v242
v_mfma_f32_16x16x32_bf16 v[192:195], v[106:109], v[148:151], v[192:195]
buffer_store_dwordx4 v[152:155], v239, s[20:23], s52 offen offset:0 nt
buffer_store_dwordx4 v[160:163], v239, s[20:23], s52 offen offset:64 nt
s_mul_i32 s54, s41, 12288
s_add_u32 s54, s54, 105472
v_mov_b32 v244, s54
v_bfe_u32 v243, v242, 0, 4
v_lshl_add_u32 v244, v243, 7, v244
v_lshlrev_b32 v243, 4, v242
v_xor_b32 v243, v243, v242
v_and_b32 v243, 48, v243
v_mfma_f32_16x16x32_bf16 v[192:195], v[60:63], v[136:139], v[192:195]
v_add_u32 v244, v243, v244
v_add_u32 v244, v243, v244
v_mfma_f32_16x16x32_bf16 v[220:223], v[64:67], v[136:139], 0
ds_read_b128 v[184:187], v244 offset:0
ds_read_b128 v[232:235], v244 offset:16
v_mfma_f32_16x16x32_bf16 v[220:223], v[108:111], v[148:151], v[220:223]
ds_read_b128 v[196:199], v244 offset:2048
v_add_f32 v249, v249, v188
v_mfma_f32_16x16x32_bf16 v[220:223], v[80:83], v[140:143], v[220:223]
ds_read_b32 v188, v244 offset:4096
v_add_f32 v249, v249, v189
v_mfma_f32_16x16x32_bf16 v[220:223], v[96:99], v[144:147], v[220:223]
v_add_f32 v249, v249, v190
v_add_f32 v249, v249, v191
v_mfma_f32_16x16x32_bf16 v[224:227], v[100:103], v[144:147], 0
v_mov_b32 v245, 24576
v_bfe_u32 v243, v242, 0, 2
v_mfma_f32_16x16x32_bf16 v[224:227], v[84:87], v[140:143], v[224:227]
v_lshl_add_u32 v245, v243, 8, v245
v_bfe_u32 v243, v242, 2, 2
v_mfma_f32_16x16x32_bf16 v[224:227], v[110:113], v[148:151], v[224:227]
s_waitcnt lgkmcnt(2)
v_lshlrev_b32 v190, 16, v184
v_lshlrev_b32 v191, 16, v185
v_mfma_f32_16x16x32_bf16 v[224:227], v[68:71], v[136:139], v[224:227]
s_waitcnt lgkmcnt(1)
s_waitcnt lgkmcnt(0)
ds_swizzle_b32 v189, v188 offset:0x401F
v_and_b32 v184, 0xffff0000, v184
v_and_b32 v185, 0xffff0000, v185
v_mul_u32_u24 v243, 13107200, v243
v_add_u32 v245, v243, v245
s_lshl_b32 s48, s43, 7
s_add_u32 s48, s48, s44
s_add_u32 s48, s48, 0
v_bfe_u32 v243, v242, 4, 2
v_lshl_add_u32 v245, v243, 4, v245
v_add_f32 v249, v249, v200
v_add_f32 v249, v249, v201
v_add_f32 v249, v249, v202
v_add_f32 v249, v249, v203
ds_read_b128 v[200:203], v244 offset:2064
v_add_f32 v249, v249, v204
ds_read_b32 v204, v244 offset:6144
v_add_f32 v249, v249, v205
v_add_f32 v249, v249, v206
v_add_f32 v249, v249, v207
v_add_f32 v249, v249, v208
v_add_f32 v249, v249, v209
v_add_f32 v249, v249, v210
v_add_f32 v249, v249, v211
v_add_f32 v249, v249, v212
v_add_f32 v249, v249, v213
v_add_f32 v249, v249, v214
v_add_f32 v249, v249, v215
v_add_f32 v249, v249, v216
ds_swizzle_b32 v250, v249 offset:0x401F
v_lshlrev_b32 v206, 16, v196
v_lshlrev_b32 v207, 16, v197
v_and_b32 v196, 0xffff0000, v196
v_and_b32 v197, 0xffff0000, v197
s_waitcnt lgkmcnt(1)
ds_swizzle_b32 v205, v204 offset:0x401F
v_add_f32 v188, v188, v189
ds_bpermute_b32 v189, v247, v188
s_lshl_b32 s51, s43, 7
s_add_u32 s51, s51, s44
s_add_u32 s51, s51, 52428800
s_waitcnt lgkmcnt(2)
v_add_f32 v249, v249, v250
ds_bpermute_b32 v250, v247, v249
s_waitcnt lgkmcnt(2)
v_add_f32 v204, v204, v205
ds_bpermute_b32 v205, v247, v204
s_waitcnt lgkmcnt(2)
v_add_f32 v188, v188, v189
v_rcp_f32 v189, v188
s_nop 0
v_fmac_f32 v0, v190, v189
v_fmac_f32 v2, v191, v189
v_lshlrev_b32 v190, 16, v186
v_lshlrev_b32 v191, 16, v187
v_fmac_f32 v4, v190, v189
v_fmac_f32 v6, v191, v189
v_lshlrev_b32 v190, 16, v232
v_lshlrev_b32 v191, 16, v233
v_and_b32 v232, 0xffff0000, v232
v_fmac_f32 v8, v190, v189
v_fmac_f32 v10, v191, v189
v_fmac_f32 v1, v184, v189
v_fmac_f32 v9, v232, v189
v_and_b32 v233, 0xffff0000, v233
v_lshlrev_b32 v190, 16, v234
v_lshlrev_b32 v191, 16, v235
v_fmac_f32 v3, v185, v189
v_and_b32 v186, 0xffff0000, v186
v_and_b32 v187, 0xffff0000, v187
v_fmac_f32 v11, v233, v189
v_and_b32 v234, 0xffff0000, v234
v_and_b32 v235, 0xffff0000, v235
v_cvt_pk_bf16_f32 v0, v0, v1
v_cvt_pk_bf16_f32 v8, v8, v9
v_fmac_f32 v5, v186, v189
v_fmac_f32 v7, v187, v189
v_fmac_f32 v12, v190, v189
v_fmac_f32 v13, v234, v189
v_fmac_f32 v14, v191, v189
v_fmac_f32 v15, v235, v189
v_cvt_pk_bf16_f32 v1, v2, v3
v_cvt_pk_bf16_f32 v9, v10, v11
v_cvt_pk_bf16_f32 v2, v4, v5
v_cvt_pk_bf16_f32 v3, v6, v7
v_cvt_pk_bf16_f32 v10, v12, v13
v_cvt_pk_bf16_f32 v11, v14, v15
v_pk_max_i16 v0, v0, 0
v_pk_max_i16 v1, v1, 0
v_pk_max_i16 v2, v2, 0
v_pk_max_i16 v3, v3, 0
v_pk_max_i16 v8, v8, 0
v_pk_max_i16 v9, v9, 0
v_pk_max_i16 v10, v10, 0
v_pk_max_i16 v11, v11, 0
buffer_store_dwordx4 v[0:3], v245, s[20:23], s48 offen offset:0 nt
buffer_store_dwordx4 v[8:11], v245, s[20:23], s48 offen offset:64 nt
s_waitcnt lgkmcnt(1)
v_add_f32 v249, v249, v250
v_rcp_f32 v252, v249
s_nop 0
v_fmac_f32 v168, v228, v252
v_fmac_f32 v169, v229, v252
v_fmac_f32 v176, v220, v252
v_fmac_f32 v177, v221, v252
v_fmac_f32 v170, v230, v252
v_fmac_f32 v171, v231, v252
v_cvt_pk_bf16_f32 v168, v168, v169
v_fmac_f32 v178, v222, v252
v_fmac_f32 v179, v223, v252
v_cvt_pk_bf16_f32 v176, v176, v177
v_fmac_f32 v172, v192, v252
v_fmac_f32 v173, v193, v252
v_fmac_f32 v174, v194, v252
v_fmac_f32 v175, v195, v252
v_cvt_pk_bf16_f32 v169, v170, v171
v_fmac_f32 v180, v224, v252
v_fmac_f32 v181, v225, v252
v_fmac_f32 v182, v226, v252
v_fmac_f32 v183, v227, v252
v_cvt_pk_bf16_f32 v177, v178, v179
v_cvt_pk_bf16_f32 v170, v172, v173
v_cvt_pk_bf16_f32 v171, v174, v175
v_cvt_pk_bf16_f32 v178, v180, v181
v_cvt_pk_bf16_f32 v179, v182, v183
v_pk_max_i16 v168, v168, 0
v_pk_max_i16 v169, v169, 0
v_pk_max_i16 v170, v170, 0
v_pk_max_i16 v171, v171, 0
v_pk_max_i16 v176, v176, 0
v_pk_max_i16 v177, v177, 0
v_pk_max_i16 v178, v178, 0
v_pk_max_i16 v179, v179, 0
buffer_store_dwordx4 v[168:171], v239, s[20:23], s53 offen offset:0 nt
buffer_store_dwordx4 v[176:179], v239, s[20:23], s53 offen offset:64 nt
s_waitcnt lgkmcnt(0)
v_add_f32 v204, v204, v205
v_rcp_f32 v205, v204
s_nop 0
v_fmac_f32 v16, v206, v205
v_fmac_f32 v18, v207, v205
v_lshlrev_b32 v206, 16, v198
v_lshlrev_b32 v207, 16, v199
v_fmac_f32 v20, v206, v205
v_fmac_f32 v22, v207, v205
v_lshlrev_b32 v206, 16, v200
v_lshlrev_b32 v207, 16, v201
v_and_b32 v200, 0xffff0000, v200
v_fmac_f32 v24, v206, v205
v_fmac_f32 v26, v207, v205
v_fmac_f32 v17, v196, v205
v_fmac_f32 v25, v200, v205
v_and_b32 v201, 0xffff0000, v201
v_lshlrev_b32 v206, 16, v202
v_lshlrev_b32 v207, 16, v203
v_fmac_f32 v19, v197, v205
v_and_b32 v198, 0xffff0000, v198
v_and_b32 v199, 0xffff0000, v199
v_fmac_f32 v27, v201, v205
v_and_b32 v202, 0xffff0000, v202
v_and_b32 v203, 0xffff0000, v203
v_cvt_pk_bf16_f32 v16, v16, v17
v_cvt_pk_bf16_f32 v24, v24, v25
v_fmac_f32 v21, v198, v205
v_fmac_f32 v23, v199, v205
v_fmac_f32 v28, v206, v205
v_fmac_f32 v29, v202, v205
v_fmac_f32 v30, v207, v205
v_fmac_f32 v31, v203, v205
v_cvt_pk_bf16_f32 v17, v18, v19
v_cvt_pk_bf16_f32 v25, v26, v27
v_cvt_pk_bf16_f32 v18, v20, v21
v_cvt_pk_bf16_f32 v19, v22, v23
v_cvt_pk_bf16_f32 v26, v28, v29
v_cvt_pk_bf16_f32 v27, v30, v31
v_pk_max_i16 v16, v16, 0
v_pk_max_i16 v17, v17, 0
v_pk_max_i16 v18, v18, 0
v_pk_max_i16 v19, v19, 0
v_pk_max_i16 v24, v24, 0
v_pk_max_i16 v25, v25, 0
v_pk_max_i16 v26, v26, 0
v_pk_max_i16 v27, v27, 0
buffer_store_dwordx4 v[16:19], v245, s[20:23], s51 offen offset:0 nt
buffer_store_dwordx4 v[24:27], v245, s[20:23], s51 offen offset:64 nt
L_end:
s_endpgm
.section .rodata,"a"
.p2align 6
.amdhsa_kernel standalone__attention_interact_autoint__recsys_kernel
  .amdhsa_next_free_vgpr 512
  .amdhsa_next_free_sgpr 102
  .amdhsa_accum_offset 256
  .amdhsa_group_segment_fixed_size 0
  .amdhsa_kernarg_size 64
  .amdhsa_user_sgpr_count 2
  .amdhsa_user_sgpr_kernarg_segment_ptr 1
  .amdhsa_system_sgpr_workgroup_id_x 1
.end_amdhsa_kernel
```
